```python
import torch

def _softmax(x, axis=-1):
    return torch.softmax(x, dim=axis)

def _gelu(x):
    return torch.nn.functional.gelu(x, approximate='tanh')

def _silu(x):
    return torch.nn.functional.silu(x)

def _sigmoid(x):
    return torch.sigmoid(x)

def _layernorm(x, axis=-1, eps=1e-05):
    m = x.mean(dim=axis, keepdim=True)
    v = x.var(dim=axis, keepdim=True, unbiased=False)
    return (x - m) / torch.sqrt(v + eps)

def _scatter_add(tgt, idx, src, axis=0):
    return tgt.clone().index_add_(axis, idx, src)

def _segment_sum(src, seg, n):
    out = torch.zeros((n,) + src.shape[1:], dtype=src.dtype)
    return out.index_add_(0, seg, src)

def _pad(x, pw):
    flat = tuple((v for pair in reversed(pw) for v in pair))
    return torch.nn.functional.pad(x, flat)
kernel_name = 'gated_mix__memory_aug_recurrent_mem_tr__spectral_gfnet__prompt'

def setup_inputs():

    _w = lambda a: (lambda t: t.to(torch.bfloat16) if t.is_floating_point() else t)(torch.as_tensor(a))

    def _A_setup():
        B, S, Dm = (1, 2048, 1024)
        H, Dh = (32, 128)
        M, seg = (8, 32)
        seg = min(seg, S)
        S = S // seg * seg
        return {'x': _w((lambda *s: torch.randn(*s, dtype=torch.bfloat16) * 0.05)(B, S, Dm)), 'mem0': _w((lambda *s: torch.randn(*s, dtype=torch.bfloat16) * 0.4)(B, M, Dm)), 'Wq': _w((lambda *s: torch.randn(*s, dtype=torch.bfloat16) * 6.4)(Dm, H, Dh) * Dm ** (-0.5)), 'Wk': _w((lambda *s: torch.randn(*s, dtype=torch.bfloat16) * 6.4)(Dm, H, Dh) * Dm ** (-0.5)), 'Wv': _w((lambda *s: torch.randn(*s, dtype=torch.bfloat16) * 0.4)(Dm, H, Dh) * Dm ** (-0.5)), 'Wo': _w((lambda *s: torch.randn(*s, dtype=torch.bfloat16) * 0.4)(H, Dh, Dm) * (H * Dh) ** (-0.5)), 'seg_len': seg}
    _A_in = _A_setup()

    def _B_setup():
        B, S, D = (1, 2048, 1024)
        Df = D // 2 + 1
        return {'x': _w((lambda *s: torch.randn(*s, dtype=torch.bfloat16) * 0.05)(B, S, D)), 'w_r': _w((lambda *s: torch.randn(*s, dtype=torch.bfloat16) * 3.2)(S, Df) * 0.02), 'w_i': _w((lambda *s: torch.randn(*s, dtype=torch.bfloat16) * 3.2)(S, Df) * 0.02)}
    _B_in = _B_setup()
    return {'A_x': _A_in['x'], 'A_mem0': _A_in['mem0'], 'A_Wq': _A_in['Wq'], 'A_Wk': _A_in['Wk'], 'A_Wv': _A_in['Wv'], 'A_Wo': _A_in['Wo'], 'A_seg_len': _A_in['seg_len'], 'B_x': _B_in['x'], 'B_w_r': _B_in['w_r'], 'B_w_i': _B_in['w_i'], 'gate_w': _w((lambda *s: torch.randn(*s, dtype=torch.bfloat16) * 0.05)(1024) * 16.0)}

def reference(A_x, A_mem0, A_Wq, A_Wk, A_Wv, A_Wo, A_seg_len, B_x, B_w_r, B_w_i, gate_w):

    def _A_ref(x, mem0, Wq, Wk, Wv, Wo, seg_len):
        B, S, Dm = x.shape
        H, Dh = (Wq.shape[1], Wq.shape[2])
        M = mem0.shape[1]
        scale = Dh ** (-0.5)
        n_seg = S // seg_len
        L = M + seg_len
        idx = torch.arange(L)
        mask = (idx[:, None] < M) | (idx[:, None] >= idx[None, :])
        mem = mem0
        outs = []
        for s in range(n_seg):
            xs = x[:, s * seg_len:(s + 1) * seg_len, :].clone()
            h = torch.concatenate([mem, xs], axis=1)
            q = torch.einsum('btd,dhe->bhte', h, Wq)
            k = torch.einsum('btd,dhe->bhte', h, Wk)
            v = torch.einsum('btd,dhe->bhte', h, Wv)
            scores = torch.einsum('bhqe,bhke->bhqk', q, k) * scale
            scores = torch.where(mask[None, None], scores, -1000000000.0)
            p = _softmax(scores, axis=-1)
            o = torch.einsum('bhqk,bhke->bhqe', p, v)
            o = torch.einsum('bhte,hed->btd', o, Wo)
            mem = o[:, :M, :].clone()
            outs.append(o[:, M:, :])
        return torch.concatenate(outs, axis=1)

    def _B_ref(x, w_r, w_i):
        B, S, D = x.shape
        X = (lambda x, axes=(-2, -1): torch.fft.rfft2(x.float(), dim=axes))(x, axes=(-2, -1))
        W = w_r + 1j * w_i
        X = X * W
        y = (lambda x, s, axes=(-2, -1): torch.fft.irfft2(x, s=s, dim=axes).to(torch.bfloat16))(X, (S, D), axes=(-2, -1))
        return y
    x = A_x
    g = _sigmoid((x * gate_w).sum(-1, keepdims=True))
    a = _A_ref(x, A_mem0, A_Wq, A_Wk, A_Wv, A_Wo, A_seg_len)
    b = _B_ref(x, B_w_r, B_w_i)
    return g * a + (1 - g) * b
```

```asm
; @launch grid=(256,1,1) block=(256,1,1) lds=163840
.amdgcn_target "amdgcn-amd-amdhsa--gfx950"
.text
.globl gated_mix__memory_aug_recurrent_mem_tr__spectral_gfnet__prompt_kernel
.p2align 8
.type gated_mix__memory_aug_recurrent_mem_tr__spectral_gfnet__prompt_kernel,@function
gated_mix__memory_aug_recurrent_mem_tr__spectral_gfnet__prompt_kernel:
 s_cmp_ge_u32 s2, 256
 s_cbranch_scc0 L_start
 s_endpgm
L_start:
 s_load_dwordx4 s[36:39], s[0:1], 0
 s_load_dwordx4 s[40:43], s[0:1], 16
 s_load_dwordx4 s[44:47], s[0:1], 32
 s_load_dwordx4 s[48:51], s[0:1], 64
 s_load_dwordx4 s[52:55], s[0:1], 80
 s_load_dwordx4 s[56:59], s[0:1], 96
 s_getreg_b32 s60, hwreg(HW_REG_XCC_ID)
 s_and_b32 s60, s60, 15
 v_lshrrev_b32 v1, 6, v0
 v_and_b32 v0, 63, v0
 v_readfirstlane_b32 s62, v1
 s_mov_b32 s63, 1000000
 s_mov_b32 s64, -2
 s_mov_b32 s101, 0
 s_mov_b32 s3, 0
 s_waitcnt lgkmcnt(0)
 s_mov_b32 s4, s58
 s_mov_b32 s5, s59
 s_mov_b32 s6, 0x8000000
 s_mov_b32 s7, 0x00020000
 s_mov_b32 s8, s36
 s_mov_b32 s9, s37
 s_mov_b32 s10, 0x400000
 s_mov_b32 s11, 0x00020000
 s_mov_b32 s16, s56
 s_mov_b32 s17, s57
 s_mov_b32 s18, 0x100
 s_mov_b32 s19, 0x00020000
 s_lshr_b32 s61, s2, 3
 s_cmp_ge_u32 s60, 8
 s_cbranch_scc1 L_badxcc
 s_cmp_eq_u32 s62, 0
 s_cbranch_scc0 L_local
 s_lshl_b32 s65, s60, 5
 s_add_u32 s65, s65, 20
 s_lshl_b32 s3, 1, s61
 s_atomic_or s3, s[56:57], s65 glc
L_local:
 s_cmp_lt_u32 s61, 12
 s_cbranch_scc1 L_role_p_0
 s_cmp_lt_u32 s61, 20
 s_cbranch_scc1 L_role_o_0
 s_cmp_lt_u32 s61, 28
 s_cbranch_scc1 L_role_t_0
 s_branch L_role_f
L_role_p_0_abort:
 s_endpgm
.p2align 6
L_role_p_0:
 s_and_b32 s66, s61, 3
 s_lshr_b32 s24, s61, 2
 s_lshl_b32 s67, s60, 2
 s_add_u32 s66, s66, s67
 s_cmp_eq_u32 s24, 0
 s_cselect_b64 s[12:13], s[40:41], s[42:43]
 s_cmp_eq_u32 s24, 2
 s_cselect_b64 s[12:13], s[44:45], s[12:13]
 s_lshl_b32 s67, s66, 8
 s_add_u32 s12, s12, s67
 s_addc_u32 s13, s13, 0
 s_sub_u32 s14, 0x800000, s67
 s_mov_b32 s15, 0x00020000
 s_lshl_b32 s27, s24, 5
 s_add_u32 s27, s27, s66
 s_lshl_b32 s22, s27, 13
 s_add_u32 s22, s22, 0x6200000
 s_lshl_b32 s23, s60, 16
 s_lshl_b32 s68, s62, 12
 s_add_u32 s23, s23, s68
 s_add_u32 s23, s23, 0x6100000
 v_lshrrev_b32 v6, 4, v0
 v_lshlrev_b32 v7, 2, v6
 v_and_b32 v1, 15, v0
 v_xor_b32 v1, v1, v7
 v_lshlrev_b32 v1, 4, v1
 v_mul_u32_u24 v6, 8192, v6
 v_add_u32 v1, v1, v6
 v_bfe_u32 v6, v0, 2, 2
 v_and_b32 v7, 3, v0
 s_lshl_b32 s65, s62, 2
 v_add_u32 v7, s65, v7
 v_and_b32 v2, 3, v6
 v_lshlrev_b32 v2, 2, v2
 v_xor_b32 v7, v7, v2
 v_lshlrev_b32 v7, 4, v7
 v_lshrrev_b32 v2, 4, v0
 v_lshlrev_b32 v2, 3, v2
 v_add_u32 v2, v2, v6
 v_lshlrev_b32 v2, 8, v2
 v_add_u32 v2, v2, v7
 v_add_u32 v3, 1024, v2
 v_add_u32 v4, 0x10000, v2
 v_add_u32 v5, 0x10000, v3
 s_mul_i32 s20, s62, 524288
 s_lshl_b32 s21, s62, 14
 s_add_u32 m0, s21, 0
 s_add_u32 s65, s20, 0
 buffer_load_dwordx4 v1, s[12:15], s65 offen nt lds
 s_add_u32 m0, s21, 1024
 s_add_u32 s65, s20, 32768
 buffer_load_dwordx4 v1, s[12:15], s65 offen nt lds
 s_add_u32 m0, s21, 2048
 s_add_u32 s65, s20, 65536
 buffer_load_dwordx4 v1, s[12:15], s65 offen nt lds
 s_add_u32 m0, s21, 3072
 s_add_u32 s65, s20, 98304
 buffer_load_dwordx4 v1, s[12:15], s65 offen nt lds
 s_add_u32 m0, s21, 4096
 s_add_u32 s65, s20, 131072
 buffer_load_dwordx4 v1, s[12:15], s65 offen nt lds
 s_add_u32 m0, s21, 5120
 s_add_u32 s65, s20, 163840
 buffer_load_dwordx4 v1, s[12:15], s65 offen nt lds
 s_add_u32 m0, s21, 6144
 s_add_u32 s65, s20, 196608
 buffer_load_dwordx4 v1, s[12:15], s65 offen nt lds
 s_add_u32 m0, s21, 7168
 s_add_u32 s65, s20, 229376
 buffer_load_dwordx4 v1, s[12:15], s65 offen nt lds
 s_add_u32 m0, s21, 8192
 s_add_u32 s65, s20, 262144
 buffer_load_dwordx4 v1, s[12:15], s65 offen nt lds
 s_add_u32 m0, s21, 9216
 s_add_u32 s65, s20, 294912
 buffer_load_dwordx4 v1, s[12:15], s65 offen nt lds
 s_add_u32 m0, s21, 10240
 s_add_u32 s65, s20, 327680
 buffer_load_dwordx4 v1, s[12:15], s65 offen nt lds
 s_add_u32 m0, s21, 11264
 s_add_u32 s65, s20, 360448
 buffer_load_dwordx4 v1, s[12:15], s65 offen nt lds
 s_add_u32 m0, s21, 12288
 s_add_u32 s65, s20, 393216
 buffer_load_dwordx4 v1, s[12:15], s65 offen nt lds
 s_add_u32 m0, s21, 13312
 s_add_u32 s65, s20, 425984
 buffer_load_dwordx4 v1, s[12:15], s65 offen nt lds
 s_add_u32 m0, s21, 14336
 s_add_u32 s65, s20, 458752
 buffer_load_dwordx4 v1, s[12:15], s65 offen nt lds
 s_add_u32 m0, s21, 15360
 s_add_u32 s65, s20, 491520
 buffer_load_dwordx4 v1, s[12:15], s65 offen nt lds
 s_add_u32 m0, s21, 65536
 s_add_u32 s65, s20, 2097152
 buffer_load_dwordx4 v1, s[12:15], s65 offen nt lds
 s_add_u32 m0, s21, 66560
 s_add_u32 s65, s20, 2129920
 buffer_load_dwordx4 v1, s[12:15], s65 offen nt lds
 s_add_u32 m0, s21, 67584
 s_add_u32 s65, s20, 2162688
 buffer_load_dwordx4 v1, s[12:15], s65 offen nt lds
 s_add_u32 m0, s21, 68608
 s_add_u32 s65, s20, 2195456
 buffer_load_dwordx4 v1, s[12:15], s65 offen nt lds
 s_add_u32 m0, s21, 69632
 s_add_u32 s65, s20, 2228224
 buffer_load_dwordx4 v1, s[12:15], s65 offen nt lds
 s_add_u32 m0, s21, 70656
 s_add_u32 s65, s20, 2260992
 buffer_load_dwordx4 v1, s[12:15], s65 offen nt lds
 s_add_u32 m0, s21, 71680
 s_add_u32 s65, s20, 2293760
 buffer_load_dwordx4 v1, s[12:15], s65 offen nt lds
 s_add_u32 m0, s21, 72704
 s_add_u32 s65, s20, 2326528
 buffer_load_dwordx4 v1, s[12:15], s65 offen nt lds
 s_add_u32 m0, s21, 73728
 s_add_u32 s65, s20, 2359296
 buffer_load_dwordx4 v1, s[12:15], s65 offen nt lds
 s_add_u32 m0, s21, 74752
 s_add_u32 s65, s20, 2392064
 buffer_load_dwordx4 v1, s[12:15], s65 offen nt lds
 s_add_u32 m0, s21, 75776
 s_add_u32 s65, s20, 2424832
 buffer_load_dwordx4 v1, s[12:15], s65 offen nt lds
 s_add_u32 m0, s21, 76800
 s_add_u32 s65, s20, 2457600
 buffer_load_dwordx4 v1, s[12:15], s65 offen nt lds
 s_add_u32 m0, s21, 77824
 s_add_u32 s65, s20, 2490368
 buffer_load_dwordx4 v1, s[12:15], s65 offen nt lds
 s_add_u32 m0, s21, 78848
 s_add_u32 s65, s20, 2523136
 buffer_load_dwordx4 v1, s[12:15], s65 offen nt lds
 s_add_u32 m0, s21, 79872
 s_add_u32 s65, s20, 2555904
 buffer_load_dwordx4 v1, s[12:15], s65 offen nt lds
 s_add_u32 m0, s21, 80896
 s_add_u32 s65, s20, 2588672
 buffer_load_dwordx4 v1, s[12:15], s65 offen nt lds
 v_lshlrev_b32 v10, 4, v0
 s_cmp_eq_u32 s24, 2
 s_cselect_b64 vcc, -1, 0
 v_and_b32 v6, 15, v0
 v_lshrrev_b32 v7, 5, v0
 v_lshl_add_u32 v6, v7, 4, v6
 v_lshlrev_b32 v6, 4, v6
 v_bfe_u32 v7, v0, 4, 1
 v_lshl_add_u32 v8, v7, 3, v6
 v_lshrrev_b32 v6, 4, v0
 v_lshlrev_b32 v6, 7, v6
 v_and_b32 v7, 7, v0
 v_lshl_add_u32 v6, v7, 4, v6
 v_bfe_u32 v7, v0, 3, 1
 v_lshl_add_u32 v9, v7, 3, v6
 v_cndmask_b32 v8, v9, v8, vcc
 s_lshl_b32 s68, s62, 9
 v_add_u32 v11, s68, v8
 v_cndmask_b32 v7, v7, 0, vcc
 v_lshl_add_u32 v12, v7, 28, v11
 v_mov_b32 v16, -1
 v_mov_b32 v17, -1
 v_mov_b32 v18, -1
 v_mov_b32 v19, -1
 s_add_u32 s68, s62, 0
 s_and_b32 s68, s68, 3
 s_lshl_b32 s69, s68, 12
 s_add_u32 s69, s69, 131072
 v_add_u32 v20, s69, v10
 s_add_u32 s68, s62, 1
 s_and_b32 s68, s68, 3
 s_lshl_b32 s69, s68, 12
 s_add_u32 s69, s69, 131072
 v_add_u32 v21, s69, v10
 s_add_u32 s68, s62, 2
 s_and_b32 s68, s68, 3
 s_lshl_b32 s69, s68, 12
 s_add_u32 s69, s69, 131072
 v_add_u32 v22, s69, v10
 s_add_u32 s68, s62, 3
 s_and_b32 s68, s68, 3
 s_lshl_b32 s69, s68, 12
 s_add_u32 s69, s69, 131072
 v_add_u32 v23, s69, v10
 v_and_b32 v6, 8, v0
 v_cmp_ne_u32 vcc, 0, v6
 v_mov_b32 v24, 0x44444444
 v_mov_b32 v6, 0xeeeeeeee
 s_nop 1
 v_cndmask_b32 v24, v24, v6, vcc
 v_and_b32 v7, 1, v0
 v_lshlrev_b32 v7, 4, v7
 v_mov_b32 v8, 0x3f80
 v_lshlrev_b32 v7, v7, v8
 v_bfe_u32 v6, v0, 3, 1
 v_bfe_u32 v8, v0, 1, 1
 v_lshl_add_u32 v6, v6, 1, v8
 v_bfe_u32 v8, v0, 4, 1
 v_bfe_u32 v9, v0, 2, 1
 v_xor_b32 v8, v8, v9
 v_lshl_add_u32 v6, v8, 2, v6
 v_cmp_eq_u32 vcc, 0, v6
 s_nop 1
 v_cndmask_b32 v28, 0, v7, vcc
 v_cmp_eq_u32 vcc, 1, v6
 s_nop 1
 v_cndmask_b32 v29, 0, v7, vcc
 v_cmp_eq_u32 vcc, 2, v6
 s_nop 1
 v_cndmask_b32 v30, 0, v7, vcc
 v_cmp_eq_u32 vcc, 3, v6
 s_nop 1
 v_cndmask_b32 v31, 0, v7, vcc
 v_mov_b32 v48, 0
 v_mov_b32 v49, 0
 v_mov_b32 v50, 0
 v_mov_b32 v51, 0
 s_lshl_b32 s76, s27, 15
 s_lshl_b32 s68, s62, 10
 s_add_u32 s76, s76, s68
 v_lshrrev_b32 v6, 3, v0
 v_lshrrev_b32 v7, 4, v0
 s_and_b32 s68, s62, 1
 s_lshl_b32 s68, s68, 2
 v_add_u32 v7, s68, v7
 v_and_b32 v8, 7, v0
 v_xor_b32 v7, v7, v8
 v_lshlrev_b32 v7, 4, v7
 s_lshl_b32 s68, s62, 3
 v_add_u32 v6, s68, v6
 v_lshl_add_u32 v55, v6, 11, v7
 v_bfe_u32 v6, v0, 3, 1
 v_lshlrev_b32 v6, 10, v6
 v_and_b32 v7, 7, v0
 v_lshl_add_u32 v6, v7, 7, v6
 v_bfe_u32 v7, v0, 1, 3
 v_lshrrev_b32 v8, 4, v0
 v_xor_b32 v7, v7, v8
 v_lshl_add_u32 v6, v7, 4, v6
 s_add_u32 s68, s62, 0
 s_and_b32 s68, s68, 3
 s_lshl_b32 s69, s68, 14
 v_add_u32 v56, s69, v6
 v_xor_b32 v57, 64, v56
 s_add_u32 s68, s62, 1
 s_and_b32 s68, s68, 3
 s_lshl_b32 s69, s68, 14
 v_add_u32 v58, s69, v6
 v_xor_b32 v59, 64, v58
 s_add_u32 s68, s62, 2
 s_and_b32 s68, s68, 3
 s_lshl_b32 s69, s68, 14
 v_add_u32 v60, s69, v6
 v_xor_b32 v61, 64, v60
 s_add_u32 s68, s62, 3
 s_and_b32 s68, s68, 3
 s_lshl_b32 s69, s68, 14
 v_add_u32 v62, s69, v6
 v_xor_b32 v63, 64, v62
 v_lshrrev_b32 v6, 4, v0
 s_lshr_b32 s65, s61, 3
 v_or_b32 v6, s65, v6
 v_min_u32 v6, 1, v6
 v_lshlrev_b32 v6, 28, v6
 v_lshl_add_u32 v6, v0, 7, v6
 s_lshl_b32 s65, s61, 2
 s_add_u32 s65, s65, s62
 s_lshl_b32 s65, s65, 11
 v_add_u32 v64, s65, v6
 s_cmp_eq_u32 s24, 2
 s_cselect_b32 s65, 0, 1
 v_or_b32 v6, s65, v0
 v_min_u32 v6, 1, v6
 v_lshlrev_b32 v66, 28, v6
 s_and_b32 s83, s27, 31
 s_lshl_b32 s83, s83, 5
 s_add_u32 s83, s83, s62
 s_lshl_b32 s83, s83, 2
 s_add_u32 s83, s83, 0x5010000
 s_or_b32 s65, s61, s62
 v_or_b32 v6, s65, v0
 v_min_u32 v6, 1, v6
 v_lshlrev_b32 v68, 28, v6
 s_xor_b32 s88, s61, 1
 s_or_b32 s88, s88, s62
 v_lshrrev_b32 v6, 3, v0
 v_or_b32 v6, s88, v6
 v_min_u32 v6, 1, v6
 v_lshlrev_b32 v6, 28, v6
 v_lshl_add_u32 v70, v0, 7, v6
 v_mov_b32 v69, 0
 s_mov_b32 s85, 0x6742000
 s_mov_b32 s86, 0x6742000
 s_lshl_b32 s87, s60, 7
 s_add_u32 s87, s87, 0x5001000
 s_or_b32 s65, s62, s101
 s_cbranch_scc1 L_clm_1
 s_waitcnt lgkmcnt(0)
 s_bitcmp1_b32 s3, s61
 s_cbranch_scc0 L_clm_1
 s_mov_b32 s66, 1
 s_atomic_or s66, s[56:57], 36
 s_waitcnt lgkmcnt(0)
L_clm_1:
 s_waitcnt vmcnt(16)
 s_barrier
 s_sub_u32 s68, 4, s62
 s_and_b32 s68, s68, 3
 s_cmp_eq_u32 s68, 0
 s_cbranch_scc0 L_wl_next_3
 ds_read_b64_tr_b16 a[0:1], v2 offset:0
 ds_read_b64_tr_b16 a[2:3], v3 offset:0
 ds_read_b64_tr_b16 a[8:9], v2 offset:8
 ds_read_b64_tr_b16 a[10:11], v3 offset:8
 ds_read_b64_tr_b16 a[4:5], v2 offset:8192
 ds_read_b64_tr_b16 a[6:7], v3 offset:8192
 ds_read_b64_tr_b16 a[12:13], v2 offset:8200
 ds_read_b64_tr_b16 a[14:15], v3 offset:8200
 ds_read_b64_tr_b16 a[16:17], v2 offset:16384
 ds_read_b64_tr_b16 a[18:19], v3 offset:16384
 ds_read_b64_tr_b16 a[24:25], v2 offset:16392
 ds_read_b64_tr_b16 a[26:27], v3 offset:16392
 ds_read_b64_tr_b16 a[20:21], v2 offset:24576
 ds_read_b64_tr_b16 a[22:23], v3 offset:24576
 ds_read_b64_tr_b16 a[28:29], v2 offset:24584
 ds_read_b64_tr_b16 a[30:31], v3 offset:24584
 ds_read_b64_tr_b16 a[32:33], v2 offset:32768
 ds_read_b64_tr_b16 a[34:35], v3 offset:32768
 ds_read_b64_tr_b16 a[40:41], v2 offset:32776
 ds_read_b64_tr_b16 a[42:43], v3 offset:32776
 ds_read_b64_tr_b16 a[36:37], v2 offset:40960
 ds_read_b64_tr_b16 a[38:39], v3 offset:40960
 ds_read_b64_tr_b16 a[44:45], v2 offset:40968
 ds_read_b64_tr_b16 a[46:47], v3 offset:40968
 ds_read_b64_tr_b16 a[48:49], v2 offset:49152
 ds_read_b64_tr_b16 a[50:51], v3 offset:49152
 ds_read_b64_tr_b16 a[56:57], v2 offset:49160
 ds_read_b64_tr_b16 a[58:59], v3 offset:49160
 ds_read_b64_tr_b16 a[52:53], v2 offset:57344
 ds_read_b64_tr_b16 a[54:55], v3 offset:57344
 ds_read_b64_tr_b16 a[60:61], v2 offset:57352
 ds_read_b64_tr_b16 a[62:63], v3 offset:57352
 s_waitcnt lgkmcnt(0)
 s_branch L_wl_done_2
L_wl_next_3:
 s_cmp_eq_u32 s68, 1
 s_cbranch_scc0 L_wl_next_4
 ds_read_b64_tr_b16 a[64:65], v2 offset:0
 ds_read_b64_tr_b16 a[66:67], v3 offset:0
 ds_read_b64_tr_b16 a[72:73], v2 offset:8
 ds_read_b64_tr_b16 a[74:75], v3 offset:8
 ds_read_b64_tr_b16 a[68:69], v2 offset:8192
 ds_read_b64_tr_b16 a[70:71], v3 offset:8192
 ds_read_b64_tr_b16 a[76:77], v2 offset:8200
 ds_read_b64_tr_b16 a[78:79], v3 offset:8200
 ds_read_b64_tr_b16 a[80:81], v2 offset:16384
 ds_read_b64_tr_b16 a[82:83], v3 offset:16384
 ds_read_b64_tr_b16 a[88:89], v2 offset:16392
 ds_read_b64_tr_b16 a[90:91], v3 offset:16392
 ds_read_b64_tr_b16 a[84:85], v2 offset:24576
 ds_read_b64_tr_b16 a[86:87], v3 offset:24576
 ds_read_b64_tr_b16 a[92:93], v2 offset:24584
 ds_read_b64_tr_b16 a[94:95], v3 offset:24584
 ds_read_b64_tr_b16 a[96:97], v2 offset:32768
 ds_read_b64_tr_b16 a[98:99], v3 offset:32768
 ds_read_b64_tr_b16 a[104:105], v2 offset:32776
 ds_read_b64_tr_b16 a[106:107], v3 offset:32776
 ds_read_b64_tr_b16 a[100:101], v2 offset:40960
 ds_read_b64_tr_b16 a[102:103], v3 offset:40960
 ds_read_b64_tr_b16 a[108:109], v2 offset:40968
 ds_read_b64_tr_b16 a[110:111], v3 offset:40968
 ds_read_b64_tr_b16 a[112:113], v2 offset:49152
 ds_read_b64_tr_b16 a[114:115], v3 offset:49152
 ds_read_b64_tr_b16 a[120:121], v2 offset:49160
 ds_read_b64_tr_b16 a[122:123], v3 offset:49160
 ds_read_b64_tr_b16 a[116:117], v2 offset:57344
 ds_read_b64_tr_b16 a[118:119], v3 offset:57344
 ds_read_b64_tr_b16 a[124:125], v2 offset:57352
 ds_read_b64_tr_b16 a[126:127], v3 offset:57352
 s_waitcnt lgkmcnt(0)
 s_branch L_wl_done_2
L_wl_next_4:
 s_cmp_eq_u32 s68, 2
 s_cbranch_scc0 L_wl_next_5
 ds_read_b64_tr_b16 a[128:129], v2 offset:0
 ds_read_b64_tr_b16 a[130:131], v3 offset:0
 ds_read_b64_tr_b16 a[136:137], v2 offset:8
 ds_read_b64_tr_b16 a[138:139], v3 offset:8
 ds_read_b64_tr_b16 a[132:133], v2 offset:8192
 ds_read_b64_tr_b16 a[134:135], v3 offset:8192
 ds_read_b64_tr_b16 a[140:141], v2 offset:8200
 ds_read_b64_tr_b16 a[142:143], v3 offset:8200
 ds_read_b64_tr_b16 a[144:145], v2 offset:16384
 ds_read_b64_tr_b16 a[146:147], v3 offset:16384
 ds_read_b64_tr_b16 a[152:153], v2 offset:16392
 ds_read_b64_tr_b16 a[154:155], v3 offset:16392
 ds_read_b64_tr_b16 a[148:149], v2 offset:24576
 ds_read_b64_tr_b16 a[150:151], v3 offset:24576
 ds_read_b64_tr_b16 a[156:157], v2 offset:24584
 ds_read_b64_tr_b16 a[158:159], v3 offset:24584
 ds_read_b64_tr_b16 a[160:161], v2 offset:32768
 ds_read_b64_tr_b16 a[162:163], v3 offset:32768
 ds_read_b64_tr_b16 a[168:169], v2 offset:32776
 ds_read_b64_tr_b16 a[170:171], v3 offset:32776
 ds_read_b64_tr_b16 a[164:165], v2 offset:40960
 ds_read_b64_tr_b16 a[166:167], v3 offset:40960
 ds_read_b64_tr_b16 a[172:173], v2 offset:40968
 ds_read_b64_tr_b16 a[174:175], v3 offset:40968
 ds_read_b64_tr_b16 a[176:177], v2 offset:49152
 ds_read_b64_tr_b16 a[178:179], v3 offset:49152
 ds_read_b64_tr_b16 a[184:185], v2 offset:49160
 ds_read_b64_tr_b16 a[186:187], v3 offset:49160
 ds_read_b64_tr_b16 a[180:181], v2 offset:57344
 ds_read_b64_tr_b16 a[182:183], v3 offset:57344
 ds_read_b64_tr_b16 a[188:189], v2 offset:57352
 ds_read_b64_tr_b16 a[190:191], v3 offset:57352
 s_waitcnt lgkmcnt(0)
 s_branch L_wl_done_2
L_wl_next_5:
 ds_read_b64_tr_b16 a[192:193], v2 offset:0
 ds_read_b64_tr_b16 a[194:195], v3 offset:0
 ds_read_b64_tr_b16 a[200:201], v2 offset:8
 ds_read_b64_tr_b16 a[202:203], v3 offset:8
 ds_read_b64_tr_b16 a[196:197], v2 offset:8192
 ds_read_b64_tr_b16 a[198:199], v3 offset:8192
 ds_read_b64_tr_b16 a[204:205], v2 offset:8200
 ds_read_b64_tr_b16 a[206:207], v3 offset:8200
 ds_read_b64_tr_b16 a[208:209], v2 offset:16384
 ds_read_b64_tr_b16 a[210:211], v3 offset:16384
 ds_read_b64_tr_b16 a[216:217], v2 offset:16392
 ds_read_b64_tr_b16 a[218:219], v3 offset:16392
 ds_read_b64_tr_b16 a[212:213], v2 offset:24576
 ds_read_b64_tr_b16 a[214:215], v3 offset:24576
 ds_read_b64_tr_b16 a[220:221], v2 offset:24584
 ds_read_b64_tr_b16 a[222:223], v3 offset:24584
 ds_read_b64_tr_b16 a[224:225], v2 offset:32768
 ds_read_b64_tr_b16 a[226:227], v3 offset:32768
 ds_read_b64_tr_b16 a[232:233], v2 offset:32776
 ds_read_b64_tr_b16 a[234:235], v3 offset:32776
 ds_read_b64_tr_b16 a[228:229], v2 offset:40960
 ds_read_b64_tr_b16 a[230:231], v3 offset:40960
 ds_read_b64_tr_b16 a[236:237], v2 offset:40968
 ds_read_b64_tr_b16 a[238:239], v3 offset:40968
 ds_read_b64_tr_b16 a[240:241], v2 offset:49152
 ds_read_b64_tr_b16 a[242:243], v3 offset:49152
 ds_read_b64_tr_b16 a[248:249], v2 offset:49160
 ds_read_b64_tr_b16 a[250:251], v3 offset:49160
 ds_read_b64_tr_b16 a[244:245], v2 offset:57344
 ds_read_b64_tr_b16 a[246:247], v3 offset:57344
 ds_read_b64_tr_b16 a[252:253], v2 offset:57352
 ds_read_b64_tr_b16 a[254:255], v3 offset:57352
 s_waitcnt lgkmcnt(0)
L_wl_done_2:
 s_barrier
 s_add_u32 m0, s21, 0
 s_add_u32 s65, s20, 4194304
 buffer_load_dwordx4 v1, s[12:15], s65 offen nt lds
 s_add_u32 m0, s21, 1024
 s_add_u32 s65, s20, 4227072
 buffer_load_dwordx4 v1, s[12:15], s65 offen nt lds
 s_add_u32 m0, s21, 2048
 s_add_u32 s65, s20, 4259840
 buffer_load_dwordx4 v1, s[12:15], s65 offen nt lds
 s_add_u32 m0, s21, 3072
 s_add_u32 s65, s20, 4292608
 buffer_load_dwordx4 v1, s[12:15], s65 offen nt lds
 s_add_u32 m0, s21, 4096
 s_add_u32 s65, s20, 4325376
 buffer_load_dwordx4 v1, s[12:15], s65 offen nt lds
 s_add_u32 m0, s21, 5120
 s_add_u32 s65, s20, 4358144
 buffer_load_dwordx4 v1, s[12:15], s65 offen nt lds
 s_add_u32 m0, s21, 6144
 s_add_u32 s65, s20, 4390912
 buffer_load_dwordx4 v1, s[12:15], s65 offen nt lds
 s_add_u32 m0, s21, 7168
 s_add_u32 s65, s20, 4423680
 buffer_load_dwordx4 v1, s[12:15], s65 offen nt lds
 s_add_u32 m0, s21, 8192
 s_add_u32 s65, s20, 4456448
 buffer_load_dwordx4 v1, s[12:15], s65 offen nt lds
 s_add_u32 m0, s21, 9216
 s_add_u32 s65, s20, 4489216
 buffer_load_dwordx4 v1, s[12:15], s65 offen nt lds
 s_add_u32 m0, s21, 10240
 s_add_u32 s65, s20, 4521984
 buffer_load_dwordx4 v1, s[12:15], s65 offen nt lds
 s_add_u32 m0, s21, 11264
 s_add_u32 s65, s20, 4554752
 buffer_load_dwordx4 v1, s[12:15], s65 offen nt lds
 s_add_u32 m0, s21, 12288
 s_add_u32 s65, s20, 4587520
 buffer_load_dwordx4 v1, s[12:15], s65 offen nt lds
 s_add_u32 m0, s21, 13312
 s_add_u32 s65, s20, 4620288
 buffer_load_dwordx4 v1, s[12:15], s65 offen nt lds
 s_add_u32 m0, s21, 14336
 s_add_u32 s65, s20, 4653056
 buffer_load_dwordx4 v1, s[12:15], s65 offen nt lds
 s_add_u32 m0, s21, 15360
 s_add_u32 s65, s20, 4685824
 buffer_load_dwordx4 v1, s[12:15], s65 offen nt lds
 s_waitcnt vmcnt(16)
 s_barrier
 s_sub_u32 s68, 5, s62
 s_and_b32 s68, s68, 3
 s_cmp_eq_u32 s68, 0
 s_cbranch_scc0 L_wl_next_8
 ds_read_b64_tr_b16 a[0:1], v4 offset:0
 ds_read_b64_tr_b16 a[2:3], v5 offset:0
 ds_read_b64_tr_b16 a[8:9], v4 offset:8
 ds_read_b64_tr_b16 a[10:11], v5 offset:8
 ds_read_b64_tr_b16 a[4:5], v4 offset:8192
 ds_read_b64_tr_b16 a[6:7], v5 offset:8192
 ds_read_b64_tr_b16 a[12:13], v4 offset:8200
 ds_read_b64_tr_b16 a[14:15], v5 offset:8200
 ds_read_b64_tr_b16 a[16:17], v4 offset:16384
 ds_read_b64_tr_b16 a[18:19], v5 offset:16384
 ds_read_b64_tr_b16 a[24:25], v4 offset:16392
 ds_read_b64_tr_b16 a[26:27], v5 offset:16392
 ds_read_b64_tr_b16 a[20:21], v4 offset:24576
 ds_read_b64_tr_b16 a[22:23], v5 offset:24576
 ds_read_b64_tr_b16 a[28:29], v4 offset:24584
 ds_read_b64_tr_b16 a[30:31], v5 offset:24584
 ds_read_b64_tr_b16 a[32:33], v4 offset:32768
 ds_read_b64_tr_b16 a[34:35], v5 offset:32768
 ds_read_b64_tr_b16 a[40:41], v4 offset:32776
 ds_read_b64_tr_b16 a[42:43], v5 offset:32776
 ds_read_b64_tr_b16 a[36:37], v4 offset:40960
 ds_read_b64_tr_b16 a[38:39], v5 offset:40960
 ds_read_b64_tr_b16 a[44:45], v4 offset:40968
 ds_read_b64_tr_b16 a[46:47], v5 offset:40968
 ds_read_b64_tr_b16 a[48:49], v4 offset:49152
 ds_read_b64_tr_b16 a[50:51], v5 offset:49152
 ds_read_b64_tr_b16 a[56:57], v4 offset:49160
 ds_read_b64_tr_b16 a[58:59], v5 offset:49160
 ds_read_b64_tr_b16 a[52:53], v4 offset:57344
 ds_read_b64_tr_b16 a[54:55], v5 offset:57344
 ds_read_b64_tr_b16 a[60:61], v4 offset:57352
 ds_read_b64_tr_b16 a[62:63], v5 offset:57352
 s_waitcnt lgkmcnt(0)
 s_branch L_wl_done_7
L_wl_next_8:
 s_cmp_eq_u32 s68, 1
 s_cbranch_scc0 L_wl_next_9
 ds_read_b64_tr_b16 a[64:65], v4 offset:0
 ds_read_b64_tr_b16 a[66:67], v5 offset:0
 ds_read_b64_tr_b16 a[72:73], v4 offset:8
 ds_read_b64_tr_b16 a[74:75], v5 offset:8
 ds_read_b64_tr_b16 a[68:69], v4 offset:8192
 ds_read_b64_tr_b16 a[70:71], v5 offset:8192
 ds_read_b64_tr_b16 a[76:77], v4 offset:8200
 ds_read_b64_tr_b16 a[78:79], v5 offset:8200
 ds_read_b64_tr_b16 a[80:81], v4 offset:16384
 ds_read_b64_tr_b16 a[82:83], v5 offset:16384
 ds_read_b64_tr_b16 a[88:89], v4 offset:16392
 ds_read_b64_tr_b16 a[90:91], v5 offset:16392
 ds_read_b64_tr_b16 a[84:85], v4 offset:24576
 ds_read_b64_tr_b16 a[86:87], v5 offset:24576
 ds_read_b64_tr_b16 a[92:93], v4 offset:24584
 ds_read_b64_tr_b16 a[94:95], v5 offset:24584
 ds_read_b64_tr_b16 a[96:97], v4 offset:32768
 ds_read_b64_tr_b16 a[98:99], v5 offset:32768
 ds_read_b64_tr_b16 a[104:105], v4 offset:32776
 ds_read_b64_tr_b16 a[106:107], v5 offset:32776
 ds_read_b64_tr_b16 a[100:101], v4 offset:40960
 ds_read_b64_tr_b16 a[102:103], v5 offset:40960
 ds_read_b64_tr_b16 a[108:109], v4 offset:40968
 ds_read_b64_tr_b16 a[110:111], v5 offset:40968
 ds_read_b64_tr_b16 a[112:113], v4 offset:49152
 ds_read_b64_tr_b16 a[114:115], v5 offset:49152
 ds_read_b64_tr_b16 a[120:121], v4 offset:49160
 ds_read_b64_tr_b16 a[122:123], v5 offset:49160
 ds_read_b64_tr_b16 a[116:117], v4 offset:57344
 ds_read_b64_tr_b16 a[118:119], v5 offset:57344
 ds_read_b64_tr_b16 a[124:125], v4 offset:57352
 ds_read_b64_tr_b16 a[126:127], v5 offset:57352
 s_waitcnt lgkmcnt(0)
 s_branch L_wl_done_7
L_wl_next_9:
 s_cmp_eq_u32 s68, 2
 s_cbranch_scc0 L_wl_next_10
 ds_read_b64_tr_b16 a[128:129], v4 offset:0
 ds_read_b64_tr_b16 a[130:131], v5 offset:0
 ds_read_b64_tr_b16 a[136:137], v4 offset:8
 ds_read_b64_tr_b16 a[138:139], v5 offset:8
 ds_read_b64_tr_b16 a[132:133], v4 offset:8192
 ds_read_b64_tr_b16 a[134:135], v5 offset:8192
 ds_read_b64_tr_b16 a[140:141], v4 offset:8200
 ds_read_b64_tr_b16 a[142:143], v5 offset:8200
 ds_read_b64_tr_b16 a[144:145], v4 offset:16384
 ds_read_b64_tr_b16 a[146:147], v5 offset:16384
 ds_read_b64_tr_b16 a[152:153], v4 offset:16392
 ds_read_b64_tr_b16 a[154:155], v5 offset:16392
 ds_read_b64_tr_b16 a[148:149], v4 offset:24576
 ds_read_b64_tr_b16 a[150:151], v5 offset:24576
 ds_read_b64_tr_b16 a[156:157], v4 offset:24584
 ds_read_b64_tr_b16 a[158:159], v5 offset:24584
 ds_read_b64_tr_b16 a[160:161], v4 offset:32768
 ds_read_b64_tr_b16 a[162:163], v5 offset:32768
 ds_read_b64_tr_b16 a[168:169], v4 offset:32776
 ds_read_b64_tr_b16 a[170:171], v5 offset:32776
 ds_read_b64_tr_b16 a[164:165], v4 offset:40960
 ds_read_b64_tr_b16 a[166:167], v5 offset:40960
 ds_read_b64_tr_b16 a[172:173], v4 offset:40968
 ds_read_b64_tr_b16 a[174:175], v5 offset:40968
 ds_read_b64_tr_b16 a[176:177], v4 offset:49152
 ds_read_b64_tr_b16 a[178:179], v5 offset:49152
 ds_read_b64_tr_b16 a[184:185], v4 offset:49160
 ds_read_b64_tr_b16 a[186:187], v5 offset:49160
 ds_read_b64_tr_b16 a[180:181], v4 offset:57344
 ds_read_b64_tr_b16 a[182:183], v5 offset:57344
 ds_read_b64_tr_b16 a[188:189], v4 offset:57352
 ds_read_b64_tr_b16 a[190:191], v5 offset:57352
 s_waitcnt lgkmcnt(0)
 s_branch L_wl_done_7
L_wl_next_10:
 ds_read_b64_tr_b16 a[192:193], v4 offset:0
 ds_read_b64_tr_b16 a[194:195], v5 offset:0
 ds_read_b64_tr_b16 a[200:201], v4 offset:8
 ds_read_b64_tr_b16 a[202:203], v5 offset:8
 ds_read_b64_tr_b16 a[196:197], v4 offset:8192
 ds_read_b64_tr_b16 a[198:199], v5 offset:8192
 ds_read_b64_tr_b16 a[204:205], v4 offset:8200
 ds_read_b64_tr_b16 a[206:207], v5 offset:8200
 ds_read_b64_tr_b16 a[208:209], v4 offset:16384
 ds_read_b64_tr_b16 a[210:211], v5 offset:16384
 ds_read_b64_tr_b16 a[216:217], v4 offset:16392
 ds_read_b64_tr_b16 a[218:219], v5 offset:16392
 ds_read_b64_tr_b16 a[212:213], v4 offset:24576
 ds_read_b64_tr_b16 a[214:215], v5 offset:24576
 ds_read_b64_tr_b16 a[220:221], v4 offset:24584
 ds_read_b64_tr_b16 a[222:223], v5 offset:24584
 ds_read_b64_tr_b16 a[224:225], v4 offset:32768
 ds_read_b64_tr_b16 a[226:227], v5 offset:32768
 ds_read_b64_tr_b16 a[232:233], v4 offset:32776
 ds_read_b64_tr_b16 a[234:235], v5 offset:32776
 ds_read_b64_tr_b16 a[228:229], v4 offset:40960
 ds_read_b64_tr_b16 a[230:231], v5 offset:40960
 ds_read_b64_tr_b16 a[236:237], v4 offset:40968
 ds_read_b64_tr_b16 a[238:239], v5 offset:40968
 ds_read_b64_tr_b16 a[240:241], v4 offset:49152
 ds_read_b64_tr_b16 a[242:243], v5 offset:49152
 ds_read_b64_tr_b16 a[248:249], v4 offset:49160
 ds_read_b64_tr_b16 a[250:251], v5 offset:49160
 ds_read_b64_tr_b16 a[244:245], v4 offset:57344
 ds_read_b64_tr_b16 a[246:247], v5 offset:57344
 ds_read_b64_tr_b16 a[252:253], v4 offset:57352
 ds_read_b64_tr_b16 a[254:255], v5 offset:57352
 s_waitcnt lgkmcnt(0)
L_wl_done_7:
 s_barrier
 s_add_u32 m0, s21, 65536
 s_add_u32 s65, s20, 6291456
 buffer_load_dwordx4 v1, s[12:15], s65 offen nt lds
 s_add_u32 m0, s21, 66560
 s_add_u32 s65, s20, 6324224
 buffer_load_dwordx4 v1, s[12:15], s65 offen nt lds
 s_add_u32 m0, s21, 67584
 s_add_u32 s65, s20, 6356992
 buffer_load_dwordx4 v1, s[12:15], s65 offen nt lds
 s_add_u32 m0, s21, 68608
 s_add_u32 s65, s20, 6389760
 buffer_load_dwordx4 v1, s[12:15], s65 offen nt lds
 s_add_u32 m0, s21, 69632
 s_add_u32 s65, s20, 6422528
 buffer_load_dwordx4 v1, s[12:15], s65 offen nt lds
 s_add_u32 m0, s21, 70656
 s_add_u32 s65, s20, 6455296
 buffer_load_dwordx4 v1, s[12:15], s65 offen nt lds
 s_add_u32 m0, s21, 71680
 s_add_u32 s65, s20, 6488064
 buffer_load_dwordx4 v1, s[12:15], s65 offen nt lds
 s_add_u32 m0, s21, 72704
 s_add_u32 s65, s20, 6520832
 buffer_load_dwordx4 v1, s[12:15], s65 offen nt lds
 s_add_u32 m0, s21, 73728
 s_add_u32 s65, s20, 6553600
 buffer_load_dwordx4 v1, s[12:15], s65 offen nt lds
 s_add_u32 m0, s21, 74752
 s_add_u32 s65, s20, 6586368
 buffer_load_dwordx4 v1, s[12:15], s65 offen nt lds
 s_add_u32 m0, s21, 75776
 s_add_u32 s65, s20, 6619136
 buffer_load_dwordx4 v1, s[12:15], s65 offen nt lds
 s_add_u32 m0, s21, 76800
 s_add_u32 s65, s20, 6651904
 buffer_load_dwordx4 v1, s[12:15], s65 offen nt lds
 s_add_u32 m0, s21, 77824
 s_add_u32 s65, s20, 6684672
 buffer_load_dwordx4 v1, s[12:15], s65 offen nt lds
 s_add_u32 m0, s21, 78848
 s_add_u32 s65, s20, 6717440
 buffer_load_dwordx4 v1, s[12:15], s65 offen nt lds
 s_add_u32 m0, s21, 79872
 s_add_u32 s65, s20, 6750208
 buffer_load_dwordx4 v1, s[12:15], s65 offen nt lds
 s_add_u32 m0, s21, 80896
 s_add_u32 s65, s20, 6782976
 buffer_load_dwordx4 v1, s[12:15], s65 offen nt lds
 s_waitcnt vmcnt(16)
 s_barrier
 s_sub_u32 s68, 6, s62
 s_and_b32 s68, s68, 3
 s_cmp_eq_u32 s68, 0
 s_cbranch_scc0 L_wl_next_13
 ds_read_b64_tr_b16 a[0:1], v2 offset:0
 ds_read_b64_tr_b16 a[2:3], v3 offset:0
 ds_read_b64_tr_b16 a[8:9], v2 offset:8
 ds_read_b64_tr_b16 a[10:11], v3 offset:8
 ds_read_b64_tr_b16 a[4:5], v2 offset:8192
 ds_read_b64_tr_b16 a[6:7], v3 offset:8192
 ds_read_b64_tr_b16 a[12:13], v2 offset:8200
 ds_read_b64_tr_b16 a[14:15], v3 offset:8200
 ds_read_b64_tr_b16 a[16:17], v2 offset:16384
 ds_read_b64_tr_b16 a[18:19], v3 offset:16384
 ds_read_b64_tr_b16 a[24:25], v2 offset:16392
 ds_read_b64_tr_b16 a[26:27], v3 offset:16392
 ds_read_b64_tr_b16 a[20:21], v2 offset:24576
 ds_read_b64_tr_b16 a[22:23], v3 offset:24576
 ds_read_b64_tr_b16 a[28:29], v2 offset:24584
 ds_read_b64_tr_b16 a[30:31], v3 offset:24584
 ds_read_b64_tr_b16 a[32:33], v2 offset:32768
 ds_read_b64_tr_b16 a[34:35], v3 offset:32768
 ds_read_b64_tr_b16 a[40:41], v2 offset:32776
 ds_read_b64_tr_b16 a[42:43], v3 offset:32776
 ds_read_b64_tr_b16 a[36:37], v2 offset:40960
 ds_read_b64_tr_b16 a[38:39], v3 offset:40960
 ds_read_b64_tr_b16 a[44:45], v2 offset:40968
 ds_read_b64_tr_b16 a[46:47], v3 offset:40968
 ds_read_b64_tr_b16 a[48:49], v2 offset:49152
 ds_read_b64_tr_b16 a[50:51], v3 offset:49152
 ds_read_b64_tr_b16 a[56:57], v2 offset:49160
 ds_read_b64_tr_b16 a[58:59], v3 offset:49160
 ds_read_b64_tr_b16 a[52:53], v2 offset:57344
 ds_read_b64_tr_b16 a[54:55], v3 offset:57344
 ds_read_b64_tr_b16 a[60:61], v2 offset:57352
 ds_read_b64_tr_b16 a[62:63], v3 offset:57352
 s_waitcnt lgkmcnt(0)
 s_branch L_wl_done_12
L_wl_next_13:
 s_cmp_eq_u32 s68, 1
 s_cbranch_scc0 L_wl_next_14
 ds_read_b64_tr_b16 a[64:65], v2 offset:0
 ds_read_b64_tr_b16 a[66:67], v3 offset:0
 ds_read_b64_tr_b16 a[72:73], v2 offset:8
 ds_read_b64_tr_b16 a[74:75], v3 offset:8
 ds_read_b64_tr_b16 a[68:69], v2 offset:8192
 ds_read_b64_tr_b16 a[70:71], v3 offset:8192
 ds_read_b64_tr_b16 a[76:77], v2 offset:8200
 ds_read_b64_tr_b16 a[78:79], v3 offset:8200
 ds_read_b64_tr_b16 a[80:81], v2 offset:16384
 ds_read_b64_tr_b16 a[82:83], v3 offset:16384
 ds_read_b64_tr_b16 a[88:89], v2 offset:16392
 ds_read_b64_tr_b16 a[90:91], v3 offset:16392
 ds_read_b64_tr_b16 a[84:85], v2 offset:24576
 ds_read_b64_tr_b16 a[86:87], v3 offset:24576
 ds_read_b64_tr_b16 a[92:93], v2 offset:24584
 ds_read_b64_tr_b16 a[94:95], v3 offset:24584
 ds_read_b64_tr_b16 a[96:97], v2 offset:32768
 ds_read_b64_tr_b16 a[98:99], v3 offset:32768
 ds_read_b64_tr_b16 a[104:105], v2 offset:32776
 ds_read_b64_tr_b16 a[106:107], v3 offset:32776
 ds_read_b64_tr_b16 a[100:101], v2 offset:40960
 ds_read_b64_tr_b16 a[102:103], v3 offset:40960
 ds_read_b64_tr_b16 a[108:109], v2 offset:40968
 ds_read_b64_tr_b16 a[110:111], v3 offset:40968
 ds_read_b64_tr_b16 a[112:113], v2 offset:49152
 ds_read_b64_tr_b16 a[114:115], v3 offset:49152
 ds_read_b64_tr_b16 a[120:121], v2 offset:49160
 ds_read_b64_tr_b16 a[122:123], v3 offset:49160
 ds_read_b64_tr_b16 a[116:117], v2 offset:57344
 ds_read_b64_tr_b16 a[118:119], v3 offset:57344
 ds_read_b64_tr_b16 a[124:125], v2 offset:57352
 ds_read_b64_tr_b16 a[126:127], v3 offset:57352
 s_waitcnt lgkmcnt(0)
 s_branch L_wl_done_12
L_wl_next_14:
 s_cmp_eq_u32 s68, 2
 s_cbranch_scc0 L_wl_next_15
 ds_read_b64_tr_b16 a[128:129], v2 offset:0
 ds_read_b64_tr_b16 a[130:131], v3 offset:0
 ds_read_b64_tr_b16 a[136:137], v2 offset:8
 ds_read_b64_tr_b16 a[138:139], v3 offset:8
 ds_read_b64_tr_b16 a[132:133], v2 offset:8192
 ds_read_b64_tr_b16 a[134:135], v3 offset:8192
 ds_read_b64_tr_b16 a[140:141], v2 offset:8200
 ds_read_b64_tr_b16 a[142:143], v3 offset:8200
 ds_read_b64_tr_b16 a[144:145], v2 offset:16384
 ds_read_b64_tr_b16 a[146:147], v3 offset:16384
 ds_read_b64_tr_b16 a[152:153], v2 offset:16392
 ds_read_b64_tr_b16 a[154:155], v3 offset:16392
 ds_read_b64_tr_b16 a[148:149], v2 offset:24576
 ds_read_b64_tr_b16 a[150:151], v3 offset:24576
 ds_read_b64_tr_b16 a[156:157], v2 offset:24584
 ds_read_b64_tr_b16 a[158:159], v3 offset:24584
 ds_read_b64_tr_b16 a[160:161], v2 offset:32768
 ds_read_b64_tr_b16 a[162:163], v3 offset:32768
 ds_read_b64_tr_b16 a[168:169], v2 offset:32776
 ds_read_b64_tr_b16 a[170:171], v3 offset:32776
 ds_read_b64_tr_b16 a[164:165], v2 offset:40960
 ds_read_b64_tr_b16 a[166:167], v3 offset:40960
 ds_read_b64_tr_b16 a[172:173], v2 offset:40968
 ds_read_b64_tr_b16 a[174:175], v3 offset:40968
 ds_read_b64_tr_b16 a[176:177], v2 offset:49152
 ds_read_b64_tr_b16 a[178:179], v3 offset:49152
 ds_read_b64_tr_b16 a[184:185], v2 offset:49160
 ds_read_b64_tr_b16 a[186:187], v3 offset:49160
 ds_read_b64_tr_b16 a[180:181], v2 offset:57344
 ds_read_b64_tr_b16 a[182:183], v3 offset:57344
 ds_read_b64_tr_b16 a[188:189], v2 offset:57352
 ds_read_b64_tr_b16 a[190:191], v3 offset:57352
 s_waitcnt lgkmcnt(0)
 s_branch L_wl_done_12
L_wl_next_15:
 ds_read_b64_tr_b16 a[192:193], v2 offset:0
 ds_read_b64_tr_b16 a[194:195], v3 offset:0
 ds_read_b64_tr_b16 a[200:201], v2 offset:8
 ds_read_b64_tr_b16 a[202:203], v3 offset:8
 ds_read_b64_tr_b16 a[196:197], v2 offset:8192
 ds_read_b64_tr_b16 a[198:199], v3 offset:8192
 ds_read_b64_tr_b16 a[204:205], v2 offset:8200
 ds_read_b64_tr_b16 a[206:207], v3 offset:8200
 ds_read_b64_tr_b16 a[208:209], v2 offset:16384
 ds_read_b64_tr_b16 a[210:211], v3 offset:16384
 ds_read_b64_tr_b16 a[216:217], v2 offset:16392
 ds_read_b64_tr_b16 a[218:219], v3 offset:16392
 ds_read_b64_tr_b16 a[212:213], v2 offset:24576
 ds_read_b64_tr_b16 a[214:215], v3 offset:24576
 ds_read_b64_tr_b16 a[220:221], v2 offset:24584
 ds_read_b64_tr_b16 a[222:223], v3 offset:24584
 ds_read_b64_tr_b16 a[224:225], v2 offset:32768
 ds_read_b64_tr_b16 a[226:227], v3 offset:32768
 ds_read_b64_tr_b16 a[232:233], v2 offset:32776
 ds_read_b64_tr_b16 a[234:235], v3 offset:32776
 ds_read_b64_tr_b16 a[228:229], v2 offset:40960
 ds_read_b64_tr_b16 a[230:231], v3 offset:40960
 ds_read_b64_tr_b16 a[236:237], v2 offset:40968
 ds_read_b64_tr_b16 a[238:239], v3 offset:40968
 ds_read_b64_tr_b16 a[240:241], v2 offset:49152
 ds_read_b64_tr_b16 a[242:243], v3 offset:49152
 ds_read_b64_tr_b16 a[248:249], v2 offset:49160
 ds_read_b64_tr_b16 a[250:251], v3 offset:49160
 ds_read_b64_tr_b16 a[244:245], v2 offset:57344
 ds_read_b64_tr_b16 a[246:247], v3 offset:57344
 ds_read_b64_tr_b16 a[252:253], v2 offset:57352
 ds_read_b64_tr_b16 a[254:255], v3 offset:57352
 s_waitcnt lgkmcnt(0)
L_wl_done_12:
 s_barrier
 s_lshl_b32 s80, s62, 10
 s_mov_b32 s81, 0
 s_add_u32 m0, s80, 0
 s_nop 0
 buffer_load_dwordx4 v55, s[8:11], s81 offen offset:0 lds
 s_add_u32 m0, s80, 3968
 s_nop 0
 buffer_load_dwordx4 v55, s[8:11], s81 offen offset:128 lds
 s_add_u32 m0, s80, 7936
 s_nop 0
 buffer_load_dwordx4 v55, s[8:11], s81 offen offset:256 lds
 s_add_u32 m0, s80, 11904
 s_nop 0
 buffer_load_dwordx4 v55, s[8:11], s81 offen offset:384 lds
 s_add_u32 m0, s80, 15872
 s_nop 0
 buffer_load_dwordx4 v55, s[8:11], s81 offen offset:512 lds
 s_add_u32 m0, s80, 19840
 s_nop 0
 buffer_load_dwordx4 v55, s[8:11], s81 offen offset:640 lds
 s_add_u32 m0, s80, 23808
 s_nop 0
 buffer_load_dwordx4 v55, s[8:11], s81 offen offset:768 lds
 s_add_u32 m0, s80, 27776
 s_nop 0
 buffer_load_dwordx4 v55, s[8:11], s81 offen offset:896 lds
 s_add_u32 m0, s80, 31744
 s_nop 0
 buffer_load_dwordx4 v55, s[8:11], s81 offen offset:1024 lds
 s_add_u32 m0, s80, 35712
 s_nop 0
 buffer_load_dwordx4 v55, s[8:11], s81 offen offset:1152 lds
 s_add_u32 m0, s80, 39680
 s_nop 0
 buffer_load_dwordx4 v55, s[8:11], s81 offen offset:1280 lds
 s_add_u32 m0, s80, 43648
 s_nop 0
 buffer_load_dwordx4 v55, s[8:11], s81 offen offset:1408 lds
 s_add_u32 m0, s80, 47616
 s_nop 0
 buffer_load_dwordx4 v55, s[8:11], s81 offen offset:1536 lds
 s_add_u32 m0, s80, 51584
 s_nop 0
 buffer_load_dwordx4 v55, s[8:11], s81 offen offset:1664 lds
 s_add_u32 m0, s80, 55552
 s_nop 0
 buffer_load_dwordx4 v55, s[8:11], s81 offen offset:1792 lds
 s_add_u32 m0, s80, 59520
 s_nop 0
 buffer_load_dwordx4 v55, s[8:11], s81 offen offset:1920 lds
 s_waitcnt vmcnt(16)
 s_barrier
 s_sub_u32 s68, 7, s62
 s_and_b32 s68, s68, 3
 s_cmp_eq_u32 s68, 0
 s_cbranch_scc0 L_wl_next_18
 ds_read_b64_tr_b16 a[0:1], v4 offset:0
 ds_read_b64_tr_b16 a[2:3], v5 offset:0
 ds_read_b64_tr_b16 a[8:9], v4 offset:8
 ds_read_b64_tr_b16 a[10:11], v5 offset:8
 ds_read_b64_tr_b16 a[4:5], v4 offset:8192
 ds_read_b64_tr_b16 a[6:7], v5 offset:8192
 ds_read_b64_tr_b16 a[12:13], v4 offset:8200
 ds_read_b64_tr_b16 a[14:15], v5 offset:8200
 ds_read_b64_tr_b16 a[16:17], v4 offset:16384
 ds_read_b64_tr_b16 a[18:19], v5 offset:16384
 ds_read_b64_tr_b16 a[24:25], v4 offset:16392
 ds_read_b64_tr_b16 a[26:27], v5 offset:16392
 ds_read_b64_tr_b16 a[20:21], v4 offset:24576
 ds_read_b64_tr_b16 a[22:23], v5 offset:24576
 ds_read_b64_tr_b16 a[28:29], v4 offset:24584
 ds_read_b64_tr_b16 a[30:31], v5 offset:24584
 ds_read_b64_tr_b16 a[32:33], v4 offset:32768
 ds_read_b64_tr_b16 a[34:35], v5 offset:32768
 ds_read_b64_tr_b16 a[40:41], v4 offset:32776
 ds_read_b64_tr_b16 a[42:43], v5 offset:32776
 ds_read_b64_tr_b16 a[36:37], v4 offset:40960
 ds_read_b64_tr_b16 a[38:39], v5 offset:40960
 ds_read_b64_tr_b16 a[44:45], v4 offset:40968
 ds_read_b64_tr_b16 a[46:47], v5 offset:40968
 ds_read_b64_tr_b16 a[48:49], v4 offset:49152
 ds_read_b64_tr_b16 a[50:51], v5 offset:49152
 ds_read_b64_tr_b16 a[56:57], v4 offset:49160
 ds_read_b64_tr_b16 a[58:59], v5 offset:49160
 ds_read_b64_tr_b16 a[52:53], v4 offset:57344
 ds_read_b64_tr_b16 a[54:55], v5 offset:57344
 ds_read_b64_tr_b16 a[60:61], v4 offset:57352
 ds_read_b64_tr_b16 a[62:63], v5 offset:57352
 s_waitcnt lgkmcnt(0)
 s_branch L_wl_done_17
L_wl_next_18:
 s_cmp_eq_u32 s68, 1
 s_cbranch_scc0 L_wl_next_19
 ds_read_b64_tr_b16 a[64:65], v4 offset:0
 ds_read_b64_tr_b16 a[66:67], v5 offset:0
 ds_read_b64_tr_b16 a[72:73], v4 offset:8
 ds_read_b64_tr_b16 a[74:75], v5 offset:8
 ds_read_b64_tr_b16 a[68:69], v4 offset:8192
 ds_read_b64_tr_b16 a[70:71], v5 offset:8192
 ds_read_b64_tr_b16 a[76:77], v4 offset:8200
 ds_read_b64_tr_b16 a[78:79], v5 offset:8200
 ds_read_b64_tr_b16 a[80:81], v4 offset:16384
 ds_read_b64_tr_b16 a[82:83], v5 offset:16384
 ds_read_b64_tr_b16 a[88:89], v4 offset:16392
 ds_read_b64_tr_b16 a[90:91], v5 offset:16392
 ds_read_b64_tr_b16 a[84:85], v4 offset:24576
 ds_read_b64_tr_b16 a[86:87], v5 offset:24576
 ds_read_b64_tr_b16 a[92:93], v4 offset:24584
 ds_read_b64_tr_b16 a[94:95], v5 offset:24584
 ds_read_b64_tr_b16 a[96:97], v4 offset:32768
 ds_read_b64_tr_b16 a[98:99], v5 offset:32768
 ds_read_b64_tr_b16 a[104:105], v4 offset:32776
 ds_read_b64_tr_b16 a[106:107], v5 offset:32776
 ds_read_b64_tr_b16 a[100:101], v4 offset:40960
 ds_read_b64_tr_b16 a[102:103], v5 offset:40960
 ds_read_b64_tr_b16 a[108:109], v4 offset:40968
 ds_read_b64_tr_b16 a[110:111], v5 offset:40968
 ds_read_b64_tr_b16 a[112:113], v4 offset:49152
 ds_read_b64_tr_b16 a[114:115], v5 offset:49152
 ds_read_b64_tr_b16 a[120:121], v4 offset:49160
 ds_read_b64_tr_b16 a[122:123], v5 offset:49160
 ds_read_b64_tr_b16 a[116:117], v4 offset:57344
 ds_read_b64_tr_b16 a[118:119], v5 offset:57344
 ds_read_b64_tr_b16 a[124:125], v4 offset:57352
 ds_read_b64_tr_b16 a[126:127], v5 offset:57352
 s_waitcnt lgkmcnt(0)
 s_branch L_wl_done_17
L_wl_next_19:
 s_cmp_eq_u32 s68, 2
 s_cbranch_scc0 L_wl_next_20
 ds_read_b64_tr_b16 a[128:129], v4 offset:0
 ds_read_b64_tr_b16 a[130:131], v5 offset:0
 ds_read_b64_tr_b16 a[136:137], v4 offset:8
 ds_read_b64_tr_b16 a[138:139], v5 offset:8
 ds_read_b64_tr_b16 a[132:133], v4 offset:8192
 ds_read_b64_tr_b16 a[134:135], v5 offset:8192
 ds_read_b64_tr_b16 a[140:141], v4 offset:8200
 ds_read_b64_tr_b16 a[142:143], v5 offset:8200
 ds_read_b64_tr_b16 a[144:145], v4 offset:16384
 ds_read_b64_tr_b16 a[146:147], v5 offset:16384
 ds_read_b64_tr_b16 a[152:153], v4 offset:16392
 ds_read_b64_tr_b16 a[154:155], v5 offset:16392
 ds_read_b64_tr_b16 a[148:149], v4 offset:24576
 ds_read_b64_tr_b16 a[150:151], v5 offset:24576
 ds_read_b64_tr_b16 a[156:157], v4 offset:24584
 ds_read_b64_tr_b16 a[158:159], v5 offset:24584
 ds_read_b64_tr_b16 a[160:161], v4 offset:32768
 ds_read_b64_tr_b16 a[162:163], v5 offset:32768
 ds_read_b64_tr_b16 a[168:169], v4 offset:32776
 ds_read_b64_tr_b16 a[170:171], v5 offset:32776
 ds_read_b64_tr_b16 a[164:165], v4 offset:40960
 ds_read_b64_tr_b16 a[166:167], v5 offset:40960
 ds_read_b64_tr_b16 a[172:173], v4 offset:40968
 ds_read_b64_tr_b16 a[174:175], v5 offset:40968
 ds_read_b64_tr_b16 a[176:177], v4 offset:49152
 ds_read_b64_tr_b16 a[178:179], v5 offset:49152
 ds_read_b64_tr_b16 a[184:185], v4 offset:49160
 ds_read_b64_tr_b16 a[186:187], v5 offset:49160
 ds_read_b64_tr_b16 a[180:181], v4 offset:57344
 ds_read_b64_tr_b16 a[182:183], v5 offset:57344
 ds_read_b64_tr_b16 a[188:189], v4 offset:57352
 ds_read_b64_tr_b16 a[190:191], v5 offset:57352
 s_waitcnt lgkmcnt(0)
 s_branch L_wl_done_17
L_wl_next_20:
 ds_read_b64_tr_b16 a[192:193], v4 offset:0
 ds_read_b64_tr_b16 a[194:195], v5 offset:0
 ds_read_b64_tr_b16 a[200:201], v4 offset:8
 ds_read_b64_tr_b16 a[202:203], v5 offset:8
 ds_read_b64_tr_b16 a[196:197], v4 offset:8192
 ds_read_b64_tr_b16 a[198:199], v5 offset:8192
 ds_read_b64_tr_b16 a[204:205], v4 offset:8200
 ds_read_b64_tr_b16 a[206:207], v5 offset:8200
 ds_read_b64_tr_b16 a[208:209], v4 offset:16384
 ds_read_b64_tr_b16 a[210:211], v5 offset:16384
 ds_read_b64_tr_b16 a[216:217], v4 offset:16392
 ds_read_b64_tr_b16 a[218:219], v5 offset:16392
 ds_read_b64_tr_b16 a[212:213], v4 offset:24576
 ds_read_b64_tr_b16 a[214:215], v5 offset:24576
 ds_read_b64_tr_b16 a[220:221], v4 offset:24584
 ds_read_b64_tr_b16 a[222:223], v5 offset:24584
 ds_read_b64_tr_b16 a[224:225], v4 offset:32768
 ds_read_b64_tr_b16 a[226:227], v5 offset:32768
 ds_read_b64_tr_b16 a[232:233], v4 offset:32776
 ds_read_b64_tr_b16 a[234:235], v5 offset:32776
 ds_read_b64_tr_b16 a[228:229], v4 offset:40960
 ds_read_b64_tr_b16 a[230:231], v5 offset:40960
 ds_read_b64_tr_b16 a[236:237], v4 offset:40968
 ds_read_b64_tr_b16 a[238:239], v5 offset:40968
 ds_read_b64_tr_b16 a[240:241], v4 offset:49152
 ds_read_b64_tr_b16 a[242:243], v5 offset:49152
 ds_read_b64_tr_b16 a[248:249], v4 offset:49160
 ds_read_b64_tr_b16 a[250:251], v5 offset:49160
 ds_read_b64_tr_b16 a[244:245], v4 offset:57344
 ds_read_b64_tr_b16 a[246:247], v5 offset:57344
 ds_read_b64_tr_b16 a[252:253], v4 offset:57352
 ds_read_b64_tr_b16 a[254:255], v5 offset:57352
 s_waitcnt lgkmcnt(0)
L_wl_done_17:
 s_barrier
 v_lshlrev_b32 v6, 2, v0
 s_lshr_b32 s66, s101, 2
 s_add_u32 s66, s66, 1
 s_branch L_hs1_23
L_hs_22:
 s_sleep 8
 s_sub_u32 s63, s63, 1
 s_cbranch_scc1 L_role_p_0_abort
L_hs1_23:
 buffer_load_dword v7, v6, s[16:19], 0 offen sc1
 s_waitcnt vmcnt(0)
 v_readlane_b32 s65, v7, s66
 s_cmp_eq_u32 s101, 128
 s_cbranch_scc1 L_hs2_24
 s_cmp_eq_u32 s101, 64
 s_cbranch_scc1 L_hs3_25
 v_readlane_b32 s67, v7, 9
 v_cmp_eq_u32 s[96:97], -1, v7
 s_mov_b32 vcc_lo, 0x20202020
 s_mov_b32 vcc_hi, 0x20202020
 s_nop 1
 s_cmp_lg_u32 s67, 0
 s_cbranch_scc1 L_retry
 s_andn2_b64 s[96:97], vcc, s[96:97]
 s_cbranch_scc1 L_hs_22
 s_branch L_hs2_24
L_hs3_25:
 v_readlane_b32 s67, v7, 10
 v_cmp_eq_u32 s[96:97], 32, v7
 s_mov_b32 vcc_lo, 0x01010101
 s_mov_b32 vcc_hi, 0x01010101
 s_nop 1
 s_cmp_lg_u32 s67, 0
 s_cbranch_scc1 L_fallback
 s_andn2_b64 s[96:97], vcc, s[96:97]
 s_cbranch_scc1 L_hs_22
L_hs2_24:
 s_cmp_ge_u32 s65, 64
 s_cbranch_scc0 L_hs_22
 s_mov_b32 s64, -2
 s_add_u32 s25, s22, 4096
L_proj_loop_26:
 s_cmp_ge_i32 s64, 0
 s_cbranch_scc1 L_proj_crit_27
 s_waitcnt vmcnt(0)
 s_barrier
 s_cmp_eq_i32 s64, -2
 s_cbranch_scc1 L_proj_x_28
 s_add_u32 s65, s22, 6144
 buffer_store_dwordx2 v[48:49], v11, s[4:7], s65 offen
 v_mov_b32 v67, 1
 buffer_store_dword v67, v66, s[4:7], s83 offen
 s_branch L_proj_x_28
L_proj_half_30:
 s_cmp_eq_u32 s64, 0
 s_cbranch_scc1 L_proj_noidle_32
 s_sleep 4
L_proj_noidle_32:
 buffer_load_dwordx4 v[32:35], v10, s[4:7], s20 offen offset:0 sc1
 buffer_load_dwordx4 v[36:39], v10, s[4:7], s20 offen offset:1024 sc1
 buffer_load_dwordx4 v[40:43], v10, s[4:7], s20 offen offset:2048 sc1
 buffer_load_dwordx4 v[44:47], v10, s[4:7], s20 offen offset:3072 sc1
 s_add_u32 s25, s64, 0
 s_and_b32 s25, s25, 3
 s_lshl_b32 s26, s25, 11
 s_xor_b32 s25, s26, 4096
 s_add_u32 s26, s26, s22
 s_add_u32 s25, s25, s22
 v_mov_b64 v[120:121], 0
 v_mov_b64 v[122:123], 0
 v_mov_b64 v[124:125], 0
 v_mov_b64 v[126:127], 0
 s_branch L_pq_33_0123
L_pq_33_0123f:
 buffer_load_dwordx4 v[32:35], v10, s[4:7], s20 offen offset:0 sc1
 s_sub_u32 s63, s63, 1
 s_cbranch_scc1 L_role_p_0_abort
L_pq_33_1230:
 s_waitcnt vmcnt(3)
 v_max_u32 v54, v36, v38
 v_cmp_eq_u32 vcc, -1, v54
 ds_write_b128 v20, v[36:39] offset:1024
 s_cbranch_vccnz L_pq_33_1230f
L_pq_33_230:
 s_waitcnt vmcnt(2)
 v_max_u32 v54, v40, v42
 v_cmp_eq_u32 vcc, -1, v54
 ds_write_b128 v20, v[40:43] offset:2048
 s_cbranch_vccnz L_pq_33_230f
L_pq_33_30:
 s_waitcnt vmcnt(1)
 v_max_u32 v54, v44, v46
 v_cmp_eq_u32 vcc, -1, v54
 ds_write_b128 v20, v[44:47] offset:3072
 s_cbranch_vccnz L_pq_33_30f
L_pq_33_0:
 buffer_load_dwordx4 v[32:35], v10, s[4:7], s20 offen offset:0 sc1
 s_sub_u32 s63, s63, 1
 s_cbranch_scc1 L_role_p_0_abort
 s_waitcnt vmcnt(1)
 v_max_u32 v54, v32, v34
 v_cmp_eq_u32 vcc, -1, v54
 ds_write_b128 v20, v[32:35] offset:0
 s_cbranch_vccnz L_pq_33_0
 s_branch L_pq_33_done
L_pq_33_1230f:
 buffer_load_dwordx4 v[36:39], v10, s[4:7], s20 offen offset:1024 sc1
L_pq_33_2301:
 s_waitcnt vmcnt(3)
 v_max_u32 v54, v40, v42
 v_cmp_eq_u32 vcc, -1, v54
 ds_write_b128 v20, v[40:43] offset:2048
 s_cbranch_vccnz L_pq_33_2301f
L_pq_33_301:
 s_waitcnt vmcnt(2)
 v_max_u32 v54, v44, v46
 v_cmp_eq_u32 vcc, -1, v54
 ds_write_b128 v20, v[44:47] offset:3072
 s_cbranch_vccnz L_pq_33_301f
L_pq_33_01:
 s_waitcnt vmcnt(1)
 v_max_u32 v54, v32, v34
 v_cmp_eq_u32 vcc, -1, v54
 ds_write_b128 v20, v[32:35] offset:0
 s_cbranch_vccnz L_pq_33_01f
L_pq_33_1:
 buffer_load_dwordx4 v[36:39], v10, s[4:7], s20 offen offset:1024 sc1
 s_sub_u32 s63, s63, 1
 s_cbranch_scc1 L_role_p_0_abort
 s_waitcnt vmcnt(1)
 v_max_u32 v54, v36, v38
 v_cmp_eq_u32 vcc, -1, v54
 ds_write_b128 v20, v[36:39] offset:1024
 s_cbranch_vccnz L_pq_33_1
 s_branch L_pq_33_done
L_pq_33_2301f:
 buffer_load_dwordx4 v[40:43], v10, s[4:7], s20 offen offset:2048 sc1
L_pq_33_3012:
 s_waitcnt vmcnt(3)
 v_max_u32 v54, v44, v46
 v_cmp_eq_u32 vcc, -1, v54
 ds_write_b128 v20, v[44:47] offset:3072
 s_cbranch_vccnz L_pq_33_3012f
L_pq_33_012:
 s_waitcnt vmcnt(2)
 v_max_u32 v54, v32, v34
 v_cmp_eq_u32 vcc, -1, v54
 ds_write_b128 v20, v[32:35] offset:0
 s_cbranch_vccnz L_pq_33_012f
L_pq_33_12:
 s_waitcnt vmcnt(1)
 v_max_u32 v54, v36, v38
 v_cmp_eq_u32 vcc, -1, v54
 ds_write_b128 v20, v[36:39] offset:1024
 s_cbranch_vccnz L_pq_33_12f
L_pq_33_2:
 buffer_load_dwordx4 v[40:43], v10, s[4:7], s20 offen offset:2048 sc1
 s_sub_u32 s63, s63, 1
 s_cbranch_scc1 L_role_p_0_abort
 s_waitcnt vmcnt(1)
 v_max_u32 v54, v40, v42
 v_cmp_eq_u32 vcc, -1, v54
 ds_write_b128 v20, v[40:43] offset:2048
 s_cbranch_vccnz L_pq_33_2
 s_branch L_pq_33_done
L_pq_33_3012f:
 buffer_load_dwordx4 v[44:47], v10, s[4:7], s20 offen offset:3072 sc1
 s_branch L_pq_33_0123
L_pq_33_012f:
 buffer_load_dwordx4 v[32:35], v10, s[4:7], s20 offen offset:0 sc1
 s_sub_u32 s63, s63, 1
 s_cbranch_scc1 L_role_p_0_abort
L_pq_33_120:
 s_waitcnt vmcnt(2)
 v_max_u32 v54, v36, v38
 v_cmp_eq_u32 vcc, -1, v54
 ds_write_b128 v20, v[36:39] offset:1024
 s_cbranch_vccnz L_pq_33_120f
L_pq_33_20:
 s_waitcnt vmcnt(1)
 v_max_u32 v54, v40, v42
 v_cmp_eq_u32 vcc, -1, v54
 ds_write_b128 v20, v[40:43] offset:2048
 s_cbranch_vccnz L_pq_33_20f
 s_branch L_pq_33_0
L_pq_33_120f:
 buffer_load_dwordx4 v[36:39], v10, s[4:7], s20 offen offset:1024 sc1
L_pq_33_201:
 s_waitcnt vmcnt(2)
 v_max_u32 v54, v40, v42
 v_cmp_eq_u32 vcc, -1, v54
 ds_write_b128 v20, v[40:43] offset:2048
 s_cbranch_vccnz L_pq_33_201f
 s_branch L_pq_33_01
L_pq_33_201f:
 buffer_load_dwordx4 v[40:43], v10, s[4:7], s20 offen offset:2048 sc1
 s_branch L_pq_33_012
L_pq_33_013f:
 buffer_load_dwordx4 v[32:35], v10, s[4:7], s20 offen offset:0 sc1
 s_sub_u32 s63, s63, 1
 s_cbranch_scc1 L_role_p_0_abort
L_pq_33_130:
 s_waitcnt vmcnt(2)
 v_max_u32 v54, v36, v38
 v_cmp_eq_u32 vcc, -1, v54
 ds_write_b128 v20, v[36:39] offset:1024
 s_cbranch_vccnz L_pq_33_130f
 s_branch L_pq_33_30
L_pq_33_130f:
 buffer_load_dwordx4 v[36:39], v10, s[4:7], s20 offen offset:1024 sc1
 s_branch L_pq_33_301
L_pq_33_301f:
 buffer_load_dwordx4 v[44:47], v10, s[4:7], s20 offen offset:3072 sc1
L_pq_33_013:
 s_waitcnt vmcnt(2)
 v_max_u32 v54, v32, v34
 v_cmp_eq_u32 vcc, -1, v54
 ds_write_b128 v20, v[32:35] offset:0
 s_cbranch_vccnz L_pq_33_013f
L_pq_33_13:
 s_waitcnt vmcnt(1)
 v_max_u32 v54, v36, v38
 v_cmp_eq_u32 vcc, -1, v54
 ds_write_b128 v20, v[36:39] offset:1024
 s_cbranch_vccnz L_pq_33_13f
 s_branch L_pq_33_3
L_pq_33_023f:
 buffer_load_dwordx4 v[32:35], v10, s[4:7], s20 offen offset:0 sc1
 s_sub_u32 s63, s63, 1
 s_cbranch_scc1 L_role_p_0_abort
 s_branch L_pq_33_230
L_pq_33_230f:
 buffer_load_dwordx4 v[40:43], v10, s[4:7], s20 offen offset:2048 sc1
L_pq_33_302:
 s_waitcnt vmcnt(2)
 v_max_u32 v54, v44, v46
 v_cmp_eq_u32 vcc, -1, v54
 ds_write_b128 v20, v[44:47] offset:3072
 s_cbranch_vccnz L_pq_33_302f
L_pq_33_02:
 s_waitcnt vmcnt(1)
 v_max_u32 v54, v32, v34
 v_cmp_eq_u32 vcc, -1, v54
 ds_write_b128 v20, v[32:35] offset:0
 s_cbranch_vccnz L_pq_33_02f
 s_branch L_pq_33_2
L_pq_33_302f:
 buffer_load_dwordx4 v[44:47], v10, s[4:7], s20 offen offset:3072 sc1
L_pq_33_023:
 s_waitcnt vmcnt(2)
 v_max_u32 v54, v32, v34
 v_cmp_eq_u32 vcc, -1, v54
 ds_write_b128 v20, v[32:35] offset:0
 s_cbranch_vccnz L_pq_33_023f
 s_branch L_pq_33_23
L_pq_33_123f:
 buffer_load_dwordx4 v[36:39], v10, s[4:7], s20 offen offset:1024 sc1
 s_sub_u32 s63, s63, 1
 s_cbranch_scc1 L_role_p_0_abort
L_pq_33_231:
 s_waitcnt vmcnt(2)
 v_max_u32 v54, v40, v42
 v_cmp_eq_u32 vcc, -1, v54
 ds_write_b128 v20, v[40:43] offset:2048
 s_cbranch_vccnz L_pq_33_231f
L_pq_33_31:
 s_waitcnt vmcnt(1)
 v_max_u32 v54, v44, v46
 v_cmp_eq_u32 vcc, -1, v54
 ds_write_b128 v20, v[44:47] offset:3072
 s_cbranch_vccnz L_pq_33_31f
 s_branch L_pq_33_1
L_pq_33_231f:
 buffer_load_dwordx4 v[40:43], v10, s[4:7], s20 offen offset:2048 sc1
L_pq_33_312:
 s_waitcnt vmcnt(2)
 v_max_u32 v54, v44, v46
 v_cmp_eq_u32 vcc, -1, v54
 ds_write_b128 v20, v[44:47] offset:3072
 s_cbranch_vccnz L_pq_33_312f
 s_branch L_pq_33_12
L_pq_33_312f:
 buffer_load_dwordx4 v[44:47], v10, s[4:7], s20 offen offset:3072 sc1
 s_branch L_pq_33_123
L_pq_33_01f:
 buffer_load_dwordx4 v[32:35], v10, s[4:7], s20 offen offset:0 sc1
 s_sub_u32 s63, s63, 1
 s_cbranch_scc1 L_role_p_0_abort
L_pq_33_10:
 s_waitcnt vmcnt(1)
 v_max_u32 v54, v36, v38
 v_cmp_eq_u32 vcc, -1, v54
 ds_write_b128 v20, v[36:39] offset:1024
 s_cbranch_vccnz L_pq_33_10f
 s_branch L_pq_33_0
L_pq_33_10f:
 buffer_load_dwordx4 v[36:39], v10, s[4:7], s20 offen offset:1024 sc1
 s_branch L_pq_33_01
L_pq_33_02f:
 buffer_load_dwordx4 v[32:35], v10, s[4:7], s20 offen offset:0 sc1
 s_sub_u32 s63, s63, 1
 s_cbranch_scc1 L_role_p_0_abort
 s_branch L_pq_33_20
L_pq_33_20f:
 buffer_load_dwordx4 v[40:43], v10, s[4:7], s20 offen offset:2048 sc1
 s_branch L_pq_33_02
L_pq_33_03f:
 buffer_load_dwordx4 v[32:35], v10, s[4:7], s20 offen offset:0 sc1
 s_sub_u32 s63, s63, 1
 s_cbranch_scc1 L_role_p_0_abort
 s_branch L_pq_33_30
L_pq_33_30f:
 buffer_load_dwordx4 v[44:47], v10, s[4:7], s20 offen offset:3072 sc1
L_pq_33_03:
 s_waitcnt vmcnt(1)
 v_max_u32 v54, v32, v34
 v_cmp_eq_u32 vcc, -1, v54
 ds_write_b128 v20, v[32:35] offset:0
 s_cbranch_vccnz L_pq_33_03f
 s_branch L_pq_33_3
L_pq_33_12f:
 buffer_load_dwordx4 v[36:39], v10, s[4:7], s20 offen offset:1024 sc1
 s_sub_u32 s63, s63, 1
 s_cbranch_scc1 L_role_p_0_abort
L_pq_33_21:
 s_waitcnt vmcnt(1)
 v_max_u32 v54, v40, v42
 v_cmp_eq_u32 vcc, -1, v54
 ds_write_b128 v20, v[40:43] offset:2048
 s_cbranch_vccnz L_pq_33_21f
 s_branch L_pq_33_1
L_pq_33_21f:
 buffer_load_dwordx4 v[40:43], v10, s[4:7], s20 offen offset:2048 sc1
 s_branch L_pq_33_12
L_pq_33_13f:
 buffer_load_dwordx4 v[36:39], v10, s[4:7], s20 offen offset:1024 sc1
 s_sub_u32 s63, s63, 1
 s_cbranch_scc1 L_role_p_0_abort
 s_branch L_pq_33_31
L_pq_33_31f:
 buffer_load_dwordx4 v[44:47], v10, s[4:7], s20 offen offset:3072 sc1
 s_branch L_pq_33_13
L_pq_33_23f:
 buffer_load_dwordx4 v[40:43], v10, s[4:7], s20 offen offset:2048 sc1
 s_sub_u32 s63, s63, 1
 s_cbranch_scc1 L_role_p_0_abort
L_pq_33_32:
 s_waitcnt vmcnt(1)
 v_max_u32 v54, v44, v46
 v_cmp_eq_u32 vcc, -1, v54
 ds_write_b128 v20, v[44:47] offset:3072
 s_cbranch_vccnz L_pq_33_32f
 s_branch L_pq_33_2
L_pq_33_32f:
 buffer_load_dwordx4 v[44:47], v10, s[4:7], s20 offen offset:3072 sc1
 s_branch L_pq_33_23
.p2align 6
L_pq_33_0123:
 s_waitcnt vmcnt(3)
 v_max_u32 v54, v32, v34
 v_cmp_eq_u32 vcc, -1, v54
 ds_write_b128 v20, v[32:35] offset:0
 s_cbranch_vccnz L_pq_33_0123f
L_pq_33_123:
 s_waitcnt vmcnt(2)
 v_max_u32 v54, v36, v38
 v_cmp_eq_u32 vcc, -1, v54
 ds_write_b128 v20, v[36:39] offset:1024
 s_cbranch_vccnz L_pq_33_123f
L_pq_33_23:
 s_waitcnt vmcnt(1)
 v_max_u32 v54, v40, v42
 v_cmp_eq_u32 vcc, -1, v54
 ds_write_b128 v20, v[40:43] offset:2048
 s_cbranch_vccnz L_pq_33_23f
L_pq_33_3:
 buffer_load_dwordx4 v[44:47], v10, s[4:7], s20 offen offset:3072 sc1
 s_sub_u32 s63, s63, 1
 s_cbranch_scc1 L_role_p_0_abort
 s_waitcnt vmcnt(1)
 v_max_u32 v54, v44, v46
 v_cmp_eq_u32 vcc, -1, v54
 ds_write_b128 v20, v[44:47] offset:3072
 s_cbranch_vccnz L_pq_33_3
L_pq_33_done:
 v_smfmac_f32_16x16x64_bf16 v[120:123], v[32:35], a[0:7], v24
 v_smfmac_f32_16x16x64_bf16 v[120:123], v[36:39], a[16:23], v24
 s_waitcnt lgkmcnt(0)
 s_barrier
 ds_read_b128 v[72:75], v21 offset:0
 ds_read_b128 v[76:79], v21 offset:1024
 ds_read_b128 v[80:83], v21 offset:2048
 ds_read_b128 v[84:87], v21 offset:3072
 v_smfmac_f32_16x16x64_bf16 v[120:123], v[40:43], a[32:39], v24
 ds_read_b128 v[88:91], v22 offset:0
 ds_read_b128 v[92:95], v22 offset:1024
 ds_read_b128 v[96:99], v22 offset:2048
 ds_read_b128 v[100:103], v22 offset:3072
 v_smfmac_f32_16x16x64_bf16 v[120:123], v[44:47], a[48:55], v24
 ds_read_b128 v[104:107], v23 offset:0
 ds_read_b128 v[108:111], v23 offset:1024
 ds_read_b128 v[112:115], v23 offset:2048
 ds_read_b128 v[116:119], v23 offset:3072
 s_waitcnt lgkmcnt(11)
 v_smfmac_f32_16x16x64_bf16 v[120:123], v[72:75], a[64:71], v24
 s_waitcnt lgkmcnt(10)
 v_smfmac_f32_16x16x64_bf16 v[120:123], v[76:79], a[80:87], v24
 s_waitcnt lgkmcnt(9)
 v_smfmac_f32_16x16x64_bf16 v[120:123], v[80:83], a[96:103], v24
 s_waitcnt lgkmcnt(8)
 v_smfmac_f32_16x16x64_bf16 v[120:123], v[84:87], a[112:119], v24
 s_waitcnt lgkmcnt(7)
 v_smfmac_f32_16x16x64_bf16 v[120:123], v[88:91], a[128:135], v24
 s_waitcnt lgkmcnt(6)
 v_smfmac_f32_16x16x64_bf16 v[120:123], v[92:95], a[144:151], v24
 s_waitcnt lgkmcnt(5)
 v_smfmac_f32_16x16x64_bf16 v[120:123], v[96:99], a[160:167], v24
 s_waitcnt lgkmcnt(4)
 v_smfmac_f32_16x16x64_bf16 v[120:123], v[100:103], a[176:183], v24
 s_waitcnt lgkmcnt(3)
 v_smfmac_f32_16x16x64_bf16 v[120:123], v[104:107], a[192:199], v24
 s_waitcnt lgkmcnt(2)
 v_smfmac_f32_16x16x64_bf16 v[120:123], v[108:111], a[208:215], v24
 s_waitcnt lgkmcnt(1)
 v_smfmac_f32_16x16x64_bf16 v[120:123], v[112:115], a[224:231], v24
 s_waitcnt lgkmcnt(0)
 v_smfmac_f32_16x16x64_bf16 v[120:123], v[116:119], a[240:247], v24
 s_nop 7
 v_cvt_pk_bf16_f32 v48, v120, v121
 v_cvt_pk_bf16_f32 v49, v122, v123
 s_nop 1
 v_mfma_f32_16x16x32_bf16 v[128:131], v[48:51], v[28:31], 0
 s_nop 7
 v_cvt_pk_bf16_f32 v52, v128, v129
 v_cvt_pk_bf16_f32 v53, v130, v131
 v_min_u32 v52, -2, v52
 buffer_store_dwordx2 v[52:53], v12, s[4:7], s26 offen
 s_branch L_proj_pub_31
L_proj_crit_27:
 s_add_u32 s20, s64, 0
 s_and_b32 s20, s20, 3
 s_lshl_b32 s20, s20, 14
 s_add_u32 s20, s20, s23
 s_cmp_eq_u32 s24, 2
 s_cbranch_scc0 L_proj_half_30
 buffer_load_dwordx4 v[32:35], v10, s[4:7], s20 offen offset:0 sc1
 buffer_load_dwordx4 v[36:39], v10, s[4:7], s20 offen offset:1024 sc1
 buffer_load_dwordx4 v[40:43], v10, s[4:7], s20 offen offset:2048 sc1
 buffer_load_dwordx4 v[44:47], v10, s[4:7], s20 offen offset:3072 sc1
 s_add_u32 s65, s64, 2
 v_mov_b32 v67, s65
 s_waitcnt vmcnt(4)
 buffer_store_dword v67, v66, s[4:7], s83 offen
 s_add_u32 s25, s64, 0
 s_and_b32 s25, s25, 3
 s_lshl_b32 s26, s25, 11
 s_xor_b32 s25, s26, 4096
 s_add_u32 s26, s26, s22
 s_add_u32 s25, s25, s22
 v_mov_b64 v[120:121], 0
 v_mov_b64 v[122:123], 0
 v_mov_b64 v[124:125], 0
 v_mov_b64 v[126:127], 0
 s_branch L_pq_34_0123
L_pq_34_0123f:
 buffer_load_dwordx4 v[32:35], v10, s[4:7], s20 offen offset:0 sc1
 s_sub_u32 s63, s63, 1
 s_cbranch_scc1 L_role_p_0_abort
L_pq_34_1230:
 s_waitcnt vmcnt(3)
 v_max_u32 v54, v36, v38
 v_cmp_eq_u32 vcc, -1, v54
 ds_write_b128 v20, v[36:39] offset:1024
 s_cbranch_vccnz L_pq_34_1230f
L_pq_34_230:
 s_waitcnt vmcnt(2)
 v_max_u32 v54, v40, v42
 v_cmp_eq_u32 vcc, -1, v54
 ds_write_b128 v20, v[40:43] offset:2048
 s_cbranch_vccnz L_pq_34_230f
L_pq_34_30:
 s_waitcnt vmcnt(1)
 v_max_u32 v54, v44, v46
 v_cmp_eq_u32 vcc, -1, v54
 ds_write_b128 v20, v[44:47] offset:3072
 s_cbranch_vccnz L_pq_34_30f
L_pq_34_0:
 buffer_load_dwordx4 v[32:35], v10, s[4:7], s20 offen offset:0 sc1
 s_sub_u32 s63, s63, 1
 s_cbranch_scc1 L_role_p_0_abort
 s_waitcnt vmcnt(1)
 v_max_u32 v54, v32, v34
 v_cmp_eq_u32 vcc, -1, v54
 ds_write_b128 v20, v[32:35] offset:0
 s_cbranch_vccnz L_pq_34_0
 s_branch L_pq_34_done
L_pq_34_1230f:
 buffer_load_dwordx4 v[36:39], v10, s[4:7], s20 offen offset:1024 sc1
L_pq_34_2301:
 s_waitcnt vmcnt(3)
 v_max_u32 v54, v40, v42
 v_cmp_eq_u32 vcc, -1, v54
 ds_write_b128 v20, v[40:43] offset:2048
 s_cbranch_vccnz L_pq_34_2301f
L_pq_34_301:
 s_waitcnt vmcnt(2)
 v_max_u32 v54, v44, v46
 v_cmp_eq_u32 vcc, -1, v54
 ds_write_b128 v20, v[44:47] offset:3072
 s_cbranch_vccnz L_pq_34_301f
L_pq_34_01:
 s_waitcnt vmcnt(1)
 v_max_u32 v54, v32, v34
 v_cmp_eq_u32 vcc, -1, v54
 ds_write_b128 v20, v[32:35] offset:0
 s_cbranch_vccnz L_pq_34_01f
L_pq_34_1:
 buffer_load_dwordx4 v[36:39], v10, s[4:7], s20 offen offset:1024 sc1
 s_sub_u32 s63, s63, 1
 s_cbranch_scc1 L_role_p_0_abort
 s_waitcnt vmcnt(1)
 v_max_u32 v54, v36, v38
 v_cmp_eq_u32 vcc, -1, v54
 ds_write_b128 v20, v[36:39] offset:1024
 s_cbranch_vccnz L_pq_34_1
 s_branch L_pq_34_done
L_pq_34_2301f:
 buffer_load_dwordx4 v[40:43], v10, s[4:7], s20 offen offset:2048 sc1
L_pq_34_3012:
 s_waitcnt vmcnt(3)
 v_max_u32 v54, v44, v46
 v_cmp_eq_u32 vcc, -1, v54
 ds_write_b128 v20, v[44:47] offset:3072
 s_cbranch_vccnz L_pq_34_3012f
L_pq_34_012:
 s_waitcnt vmcnt(2)
 v_max_u32 v54, v32, v34
 v_cmp_eq_u32 vcc, -1, v54
 ds_write_b128 v20, v[32:35] offset:0
 s_cbranch_vccnz L_pq_34_012f
L_pq_34_12:
 s_waitcnt vmcnt(1)
 v_max_u32 v54, v36, v38
 v_cmp_eq_u32 vcc, -1, v54
 ds_write_b128 v20, v[36:39] offset:1024
 s_cbranch_vccnz L_pq_34_12f
L_pq_34_2:
 buffer_load_dwordx4 v[40:43], v10, s[4:7], s20 offen offset:2048 sc1
 s_sub_u32 s63, s63, 1
 s_cbranch_scc1 L_role_p_0_abort
 s_waitcnt vmcnt(1)
 v_max_u32 v54, v40, v42
 v_cmp_eq_u32 vcc, -1, v54
 ds_write_b128 v20, v[40:43] offset:2048
 s_cbranch_vccnz L_pq_34_2
 s_branch L_pq_34_done
L_pq_34_3012f:
 buffer_load_dwordx4 v[44:47], v10, s[4:7], s20 offen offset:3072 sc1
 s_branch L_pq_34_0123
L_pq_34_012f:
 buffer_load_dwordx4 v[32:35], v10, s[4:7], s20 offen offset:0 sc1
 s_sub_u32 s63, s63, 1
 s_cbranch_scc1 L_role_p_0_abort
L_pq_34_120:
 s_waitcnt vmcnt(2)
 v_max_u32 v54, v36, v38
 v_cmp_eq_u32 vcc, -1, v54
 ds_write_b128 v20, v[36:39] offset:1024
 s_cbranch_vccnz L_pq_34_120f
L_pq_34_20:
 s_waitcnt vmcnt(1)
 v_max_u32 v54, v40, v42
 v_cmp_eq_u32 vcc, -1, v54
 ds_write_b128 v20, v[40:43] offset:2048
 s_cbranch_vccnz L_pq_34_20f
 s_branch L_pq_34_0
L_pq_34_120f:
 buffer_load_dwordx4 v[36:39], v10, s[4:7], s20 offen offset:1024 sc1
L_pq_34_201:
 s_waitcnt vmcnt(2)
 v_max_u32 v54, v40, v42
 v_cmp_eq_u32 vcc, -1, v54
 ds_write_b128 v20, v[40:43] offset:2048
 s_cbranch_vccnz L_pq_34_201f
 s_branch L_pq_34_01
L_pq_34_201f:
 buffer_load_dwordx4 v[40:43], v10, s[4:7], s20 offen offset:2048 sc1
 s_branch L_pq_34_012
L_pq_34_013f:
 buffer_load_dwordx4 v[32:35], v10, s[4:7], s20 offen offset:0 sc1
 s_sub_u32 s63, s63, 1
 s_cbranch_scc1 L_role_p_0_abort
L_pq_34_130:
 s_waitcnt vmcnt(2)
 v_max_u32 v54, v36, v38
 v_cmp_eq_u32 vcc, -1, v54
 ds_write_b128 v20, v[36:39] offset:1024
 s_cbranch_vccnz L_pq_34_130f
 s_branch L_pq_34_30
L_pq_34_130f:
 buffer_load_dwordx4 v[36:39], v10, s[4:7], s20 offen offset:1024 sc1
 s_branch L_pq_34_301
L_pq_34_301f:
 buffer_load_dwordx4 v[44:47], v10, s[4:7], s20 offen offset:3072 sc1
L_pq_34_013:
 s_waitcnt vmcnt(2)
 v_max_u32 v54, v32, v34
 v_cmp_eq_u32 vcc, -1, v54
 ds_write_b128 v20, v[32:35] offset:0
 s_cbranch_vccnz L_pq_34_013f
L_pq_34_13:
 s_waitcnt vmcnt(1)
 v_max_u32 v54, v36, v38
 v_cmp_eq_u32 vcc, -1, v54
 ds_write_b128 v20, v[36:39] offset:1024
 s_cbranch_vccnz L_pq_34_13f
 s_branch L_pq_34_3
L_pq_34_023f:
 buffer_load_dwordx4 v[32:35], v10, s[4:7], s20 offen offset:0 sc1
 s_sub_u32 s63, s63, 1
 s_cbranch_scc1 L_role_p_0_abort
 s_branch L_pq_34_230
L_pq_34_230f:
 buffer_load_dwordx4 v[40:43], v10, s[4:7], s20 offen offset:2048 sc1
L_pq_34_302:
 s_waitcnt vmcnt(2)
 v_max_u32 v54, v44, v46
 v_cmp_eq_u32 vcc, -1, v54
 ds_write_b128 v20, v[44:47] offset:3072
 s_cbranch_vccnz L_pq_34_302f
L_pq_34_02:
 s_waitcnt vmcnt(1)
 v_max_u32 v54, v32, v34
 v_cmp_eq_u32 vcc, -1, v54
 ds_write_b128 v20, v[32:35] offset:0
 s_cbranch_vccnz L_pq_34_02f
 s_branch L_pq_34_2
L_pq_34_302f:
 buffer_load_dwordx4 v[44:47], v10, s[4:7], s20 offen offset:3072 sc1
L_pq_34_023:
 s_waitcnt vmcnt(2)
 v_max_u32 v54, v32, v34
 v_cmp_eq_u32 vcc, -1, v54
 ds_write_b128 v20, v[32:35] offset:0
 s_cbranch_vccnz L_pq_34_023f
 s_branch L_pq_34_23
L_pq_34_123f:
 buffer_load_dwordx4 v[36:39], v10, s[4:7], s20 offen offset:1024 sc1
 s_sub_u32 s63, s63, 1
 s_cbranch_scc1 L_role_p_0_abort
L_pq_34_231:
 s_waitcnt vmcnt(2)
 v_max_u32 v54, v40, v42
 v_cmp_eq_u32 vcc, -1, v54
 ds_write_b128 v20, v[40:43] offset:2048
 s_cbranch_vccnz L_pq_34_231f
L_pq_34_31:
 s_waitcnt vmcnt(1)
 v_max_u32 v54, v44, v46
 v_cmp_eq_u32 vcc, -1, v54
 ds_write_b128 v20, v[44:47] offset:3072
 s_cbranch_vccnz L_pq_34_31f
 s_branch L_pq_34_1
L_pq_34_231f:
 buffer_load_dwordx4 v[40:43], v10, s[4:7], s20 offen offset:2048 sc1
L_pq_34_312:
 s_waitcnt vmcnt(2)
 v_max_u32 v54, v44, v46
 v_cmp_eq_u32 vcc, -1, v54
 ds_write_b128 v20, v[44:47] offset:3072
 s_cbranch_vccnz L_pq_34_312f
 s_branch L_pq_34_12
L_pq_34_312f:
 buffer_load_dwordx4 v[44:47], v10, s[4:7], s20 offen offset:3072 sc1
 s_branch L_pq_34_123
L_pq_34_01f:
 buffer_load_dwordx4 v[32:35], v10, s[4:7], s20 offen offset:0 sc1
 s_sub_u32 s63, s63, 1
 s_cbranch_scc1 L_role_p_0_abort
L_pq_34_10:
 s_waitcnt vmcnt(1)
 v_max_u32 v54, v36, v38
 v_cmp_eq_u32 vcc, -1, v54
 ds_write_b128 v20, v[36:39] offset:1024
 s_cbranch_vccnz L_pq_34_10f
 s_branch L_pq_34_0
L_pq_34_10f:
 buffer_load_dwordx4 v[36:39], v10, s[4:7], s20 offen offset:1024 sc1
 s_branch L_pq_34_01
L_pq_34_02f:
 buffer_load_dwordx4 v[32:35], v10, s[4:7], s20 offen offset:0 sc1
 s_sub_u32 s63, s63, 1
 s_cbranch_scc1 L_role_p_0_abort
 s_branch L_pq_34_20
L_pq_34_20f:
 buffer_load_dwordx4 v[40:43], v10, s[4:7], s20 offen offset:2048 sc1
 s_branch L_pq_34_02
L_pq_34_03f:
 buffer_load_dwordx4 v[32:35], v10, s[4:7], s20 offen offset:0 sc1
 s_sub_u32 s63, s63, 1
 s_cbranch_scc1 L_role_p_0_abort
 s_branch L_pq_34_30
L_pq_34_30f:
 buffer_load_dwordx4 v[44:47], v10, s[4:7], s20 offen offset:3072 sc1
L_pq_34_03:
 s_waitcnt vmcnt(1)
 v_max_u32 v54, v32, v34
 v_cmp_eq_u32 vcc, -1, v54
 ds_write_b128 v20, v[32:35] offset:0
 s_cbranch_vccnz L_pq_34_03f
 s_branch L_pq_34_3
L_pq_34_12f:
 buffer_load_dwordx4 v[36:39], v10, s[4:7], s20 offen offset:1024 sc1
 s_sub_u32 s63, s63, 1
 s_cbranch_scc1 L_role_p_0_abort
L_pq_34_21:
 s_waitcnt vmcnt(1)
 v_max_u32 v54, v40, v42
 v_cmp_eq_u32 vcc, -1, v54
 ds_write_b128 v20, v[40:43] offset:2048
 s_cbranch_vccnz L_pq_34_21f
 s_branch L_pq_34_1
L_pq_34_21f:
 buffer_load_dwordx4 v[40:43], v10, s[4:7], s20 offen offset:2048 sc1
 s_branch L_pq_34_12
L_pq_34_13f:
 buffer_load_dwordx4 v[36:39], v10, s[4:7], s20 offen offset:1024 sc1
 s_sub_u32 s63, s63, 1
 s_cbranch_scc1 L_role_p_0_abort
 s_branch L_pq_34_31
L_pq_34_31f:
 buffer_load_dwordx4 v[44:47], v10, s[4:7], s20 offen offset:3072 sc1
 s_branch L_pq_34_13
L_pq_34_23f:
 buffer_load_dwordx4 v[40:43], v10, s[4:7], s20 offen offset:2048 sc1
 s_sub_u32 s63, s63, 1
 s_cbranch_scc1 L_role_p_0_abort
L_pq_34_32:
 s_waitcnt vmcnt(1)
 v_max_u32 v54, v44, v46
 v_cmp_eq_u32 vcc, -1, v54
 ds_write_b128 v20, v[44:47] offset:3072
 s_cbranch_vccnz L_pq_34_32f
 s_branch L_pq_34_2
L_pq_34_32f:
 buffer_load_dwordx4 v[44:47], v10, s[4:7], s20 offen offset:3072 sc1
 s_branch L_pq_34_23
.p2align 6
L_pq_34_0123:
 s_waitcnt vmcnt(3)
 v_max_u32 v54, v32, v34
 v_cmp_eq_u32 vcc, -1, v54
 ds_write_b128 v20, v[32:35] offset:0
 s_cbranch_vccnz L_pq_34_0123f
L_pq_34_123:
 s_waitcnt vmcnt(2)
 v_max_u32 v54, v36, v38
 v_cmp_eq_u32 vcc, -1, v54
 ds_write_b128 v20, v[36:39] offset:1024
 s_cbranch_vccnz L_pq_34_123f
L_pq_34_23:
 s_waitcnt vmcnt(1)
 v_max_u32 v54, v40, v42
 v_cmp_eq_u32 vcc, -1, v54
 ds_write_b128 v20, v[40:43] offset:2048
 s_cbranch_vccnz L_pq_34_23f
L_pq_34_3:
 buffer_load_dwordx4 v[44:47], v10, s[4:7], s20 offen offset:3072 sc1
 s_sub_u32 s63, s63, 1
 s_cbranch_scc1 L_role_p_0_abort
 s_waitcnt vmcnt(1)
 v_max_u32 v54, v44, v46
 v_cmp_eq_u32 vcc, -1, v54
 ds_write_b128 v20, v[44:47] offset:3072
 s_cbranch_vccnz L_pq_34_3
L_pq_34_done:
 v_smfmac_f32_16x16x64_bf16 v[120:123], v[32:35], a[0:7], v24
 v_smfmac_f32_16x16x64_bf16 v[124:127], v[32:35], a[8:15], v24
 v_smfmac_f32_16x16x64_bf16 v[120:123], v[36:39], a[16:23], v24
 v_smfmac_f32_16x16x64_bf16 v[124:127], v[36:39], a[24:31], v24
 s_waitcnt lgkmcnt(0)
 s_barrier
 ds_read_b128 v[72:75], v21 offset:0
 ds_read_b128 v[76:79], v21 offset:1024
 ds_read_b128 v[80:83], v21 offset:2048
 ds_read_b128 v[84:87], v21 offset:3072
 v_smfmac_f32_16x16x64_bf16 v[120:123], v[40:43], a[32:39], v24
 v_smfmac_f32_16x16x64_bf16 v[124:127], v[40:43], a[40:47], v24
 ds_read_b128 v[88:91], v22 offset:0
 ds_read_b128 v[92:95], v22 offset:1024
 ds_read_b128 v[96:99], v22 offset:2048
 ds_read_b128 v[100:103], v22 offset:3072
 v_smfmac_f32_16x16x64_bf16 v[120:123], v[44:47], a[48:55], v24
 v_smfmac_f32_16x16x64_bf16 v[124:127], v[44:47], a[56:63], v24
 ds_read_b128 v[104:107], v23 offset:0
 ds_read_b128 v[108:111], v23 offset:1024
 ds_read_b128 v[112:115], v23 offset:2048
 ds_read_b128 v[116:119], v23 offset:3072
 s_waitcnt lgkmcnt(11)
 v_smfmac_f32_16x16x64_bf16 v[120:123], v[72:75], a[64:71], v24
 v_smfmac_f32_16x16x64_bf16 v[124:127], v[72:75], a[72:79], v24
 s_waitcnt lgkmcnt(10)
 v_smfmac_f32_16x16x64_bf16 v[120:123], v[76:79], a[80:87], v24
 v_smfmac_f32_16x16x64_bf16 v[124:127], v[76:79], a[88:95], v24
 s_waitcnt lgkmcnt(9)
 v_smfmac_f32_16x16x64_bf16 v[120:123], v[80:83], a[96:103], v24
 v_smfmac_f32_16x16x64_bf16 v[124:127], v[80:83], a[104:111], v24
 s_waitcnt lgkmcnt(8)
 v_smfmac_f32_16x16x64_bf16 v[120:123], v[84:87], a[112:119], v24
 v_smfmac_f32_16x16x64_bf16 v[124:127], v[84:87], a[120:127], v24
 s_waitcnt lgkmcnt(7)
 v_smfmac_f32_16x16x64_bf16 v[120:123], v[88:91], a[128:135], v24
 v_smfmac_f32_16x16x64_bf16 v[124:127], v[88:91], a[136:143], v24
 s_waitcnt lgkmcnt(6)
 v_smfmac_f32_16x16x64_bf16 v[120:123], v[92:95], a[144:151], v24
 v_smfmac_f32_16x16x64_bf16 v[124:127], v[92:95], a[152:159], v24
 s_waitcnt lgkmcnt(5)
 v_smfmac_f32_16x16x64_bf16 v[120:123], v[96:99], a[160:167], v24
 v_smfmac_f32_16x16x64_bf16 v[124:127], v[96:99], a[168:175], v24
 s_waitcnt lgkmcnt(4)
 v_smfmac_f32_16x16x64_bf16 v[120:123], v[100:103], a[176:183], v24
 v_smfmac_f32_16x16x64_bf16 v[124:127], v[100:103], a[184:191], v24
 s_waitcnt lgkmcnt(3)
 v_smfmac_f32_16x16x64_bf16 v[120:123], v[104:107], a[192:199], v24
 v_smfmac_f32_16x16x64_bf16 v[124:127], v[104:107], a[200:207], v24
 s_waitcnt lgkmcnt(2)
 v_smfmac_f32_16x16x64_bf16 v[120:123], v[108:111], a[208:215], v24
 v_smfmac_f32_16x16x64_bf16 v[124:127], v[108:111], a[216:223], v24
 s_waitcnt lgkmcnt(1)
 v_smfmac_f32_16x16x64_bf16 v[120:123], v[112:115], a[224:231], v24
 v_smfmac_f32_16x16x64_bf16 v[124:127], v[112:115], a[232:239], v24
 s_waitcnt lgkmcnt(0)
 v_smfmac_f32_16x16x64_bf16 v[120:123], v[116:119], a[240:247], v24
 v_smfmac_f32_16x16x64_bf16 v[124:127], v[116:119], a[248:255], v24
 s_nop 6
 v_cvt_pk_bf16_f32 v48, v120, v121
 v_cvt_pk_bf16_f32 v49, v122, v123
 v_cvt_pk_bf16_f32 v50, v124, v125
 v_cvt_pk_bf16_f32 v51, v126, v127
 s_nop 1
 v_mfma_f32_16x16x32_bf16 v[128:131], v[48:51], v[28:31], 0
 s_nop 7
 v_cvt_pk_bf16_f32 v52, v128, v129
 v_cvt_pk_bf16_f32 v53, v130, v131
 v_min_u32 v52, -2, v52
 buffer_store_dwordx2 v[52:53], v12, s[4:7], s26 offen
L_proj_pub_31:
 v_xor_b32 v20, 0x4000, v20
 v_xor_b32 v21, 0x4000, v21
 v_xor_b32 v22, 0x4000, v22
 v_xor_b32 v23, 0x4000, v23
 s_cmp_ge_i32 s64, 62
 s_cbranch_scc1 L_proj_end_29
L_proj_x_28:
 s_add_u32 s65, s64, 3
 s_min_u32 s66, s65, 63
 s_lshl_b32 s81, s66, 16
 s_and_b32 s65, s65, 1
 s_lshl_b32 s65, s65, 16
 s_lshl_b32 s80, s62, 10
 s_add_u32 s80, s80, s65
 s_add_u32 s82, s64, 5
 s_min_u32 s82, s82, 63
 s_lshl_b32 s82, s82, 16
 ds_read_b128 v[136:139], v56 offset:0
 ds_read_b128 v[140:143], v56 offset:2048
 ds_read_b128 v[144:147], v57 offset:0
 ds_read_b128 v[148:151], v57 offset:2048
 ds_read_b128 v[152:155], v56 offset:4096
 ds_read_b128 v[156:159], v56 offset:6144
 s_waitcnt lgkmcnt(4)
 v_mfma_f32_16x16x32_bf16 v[120:123], a[0:3], v[136:139], 0
 ds_read_b128 v[160:163], v57 offset:4096
 v_mfma_f32_16x16x32_bf16 v[124:127], a[8:11], v[136:139], 0
 v_mfma_f32_16x16x32_bf16 v[128:131], a[0:3], v[140:143], 0
 ds_read_b128 v[164:167], v57 offset:6144
 v_mfma_f32_16x16x32_bf16 v[132:135], a[8:11], v[140:143], 0
 s_waitcnt lgkmcnt(4)
 v_mfma_f32_16x16x32_bf16 v[120:123], a[4:7], v[144:147], v[120:123]
 ds_read_b128 v[136:139], v56 offset:8192
 v_mfma_f32_16x16x32_bf16 v[124:127], a[12:15], v[144:147], v[124:127]
 buffer_load_dword v65, v64, s[8:11], s82 offen
 v_mfma_f32_16x16x32_bf16 v[128:131], a[4:7], v[148:151], v[128:131]
 ds_read_b128 v[140:143], v56 offset:10240
 v_mfma_f32_16x16x32_bf16 v[132:135], a[12:15], v[148:151], v[132:135]
 s_waitcnt lgkmcnt(4)
 v_mfma_f32_16x16x32_bf16 v[120:123], a[16:19], v[152:155], v[120:123]
 ds_read_b128 v[144:147], v57 offset:8192
 v_mfma_f32_16x16x32_bf16 v[124:127], a[24:27], v[152:155], v[124:127]
 v_mfma_f32_16x16x32_bf16 v[128:131], a[16:19], v[156:159], v[128:131]
 ds_read_b128 v[148:151], v57 offset:10240
 v_mfma_f32_16x16x32_bf16 v[132:135], a[24:27], v[156:159], v[132:135]
 s_waitcnt lgkmcnt(4)
 v_mfma_f32_16x16x32_bf16 v[120:123], a[20:23], v[160:163], v[120:123]
 ds_read_b128 v[152:155], v56 offset:12288
 v_mfma_f32_16x16x32_bf16 v[124:127], a[28:31], v[160:163], v[124:127]
 v_mfma_f32_16x16x32_bf16 v[128:131], a[20:23], v[164:167], v[128:131]
 ds_read_b128 v[156:159], v56 offset:14336
 v_mfma_f32_16x16x32_bf16 v[132:135], a[28:31], v[164:167], v[132:135]
 s_waitcnt lgkmcnt(4)
 v_mfma_f32_16x16x32_bf16 v[120:123], a[32:35], v[136:139], v[120:123]
 ds_read_b128 v[160:163], v57 offset:12288
 v_mfma_f32_16x16x32_bf16 v[124:127], a[40:43], v[136:139], v[124:127]
 buffer_store_dwordx2 v[16:17], v12, s[4:7], s25 offen
 v_mfma_f32_16x16x32_bf16 v[128:131], a[32:35], v[140:143], v[128:131]
 ds_read_b128 v[164:167], v57 offset:14336
 v_mfma_f32_16x16x32_bf16 v[132:135], a[40:43], v[140:143], v[132:135]
 s_waitcnt lgkmcnt(4)
 v_mfma_f32_16x16x32_bf16 v[120:123], a[36:39], v[144:147], v[120:123]
 ds_read_b128 v[136:139], v58 offset:0
 v_mfma_f32_16x16x32_bf16 v[124:127], a[44:47], v[144:147], v[124:127]
 v_mfma_f32_16x16x32_bf16 v[128:131], a[36:39], v[148:151], v[128:131]
 ds_read_b128 v[140:143], v58 offset:2048
 v_mfma_f32_16x16x32_bf16 v[132:135], a[44:47], v[148:151], v[132:135]
 s_waitcnt lgkmcnt(4)
 v_mfma_f32_16x16x32_bf16 v[120:123], a[48:51], v[152:155], v[120:123]
 ds_read_b128 v[144:147], v59 offset:0
 v_mfma_f32_16x16x32_bf16 v[124:127], a[56:59], v[152:155], v[124:127]
 v_mfma_f32_16x16x32_bf16 v[128:131], a[48:51], v[156:159], v[128:131]
 ds_read_b128 v[148:151], v59 offset:2048
 v_mfma_f32_16x16x32_bf16 v[132:135], a[56:59], v[156:159], v[132:135]
 s_waitcnt lgkmcnt(4)
 s_xor_b32 s67, s81, 0
 v_mfma_f32_16x16x32_bf16 v[120:123], a[52:55], v[160:163], v[120:123]
 ds_read_b128 v[152:155], v58 offset:4096
 v_mfma_f32_16x16x32_bf16 v[124:127], a[60:63], v[160:163], v[124:127]
 s_xor_b32 m0, s80, 0
 v_mfma_f32_16x16x32_bf16 v[128:131], a[52:55], v[164:167], v[128:131]
 ds_read_b128 v[156:159], v58 offset:6144
 v_mfma_f32_16x16x32_bf16 v[132:135], a[60:63], v[164:167], v[132:135]
 buffer_load_dwordx4 v55, s[8:11], s67 offen lds
 s_waitcnt lgkmcnt(4)
 v_mfma_f32_16x16x32_bf16 v[120:123], a[64:67], v[136:139], v[120:123]
 ds_read_b128 v[160:163], v59 offset:4096
 v_mfma_f32_16x16x32_bf16 v[124:127], a[72:75], v[136:139], v[124:127]
 s_xor_b32 s67, s81, 128
 v_mfma_f32_16x16x32_bf16 v[128:131], a[64:67], v[140:143], v[128:131]
 ds_read_b128 v[164:167], v59 offset:6144
 v_mfma_f32_16x16x32_bf16 v[132:135], a[72:75], v[140:143], v[132:135]
 s_waitcnt lgkmcnt(4)
 s_xor_b32 m0, s80, 4096
 v_mfma_f32_16x16x32_bf16 v[120:123], a[68:71], v[144:147], v[120:123]
 ds_read_b128 v[136:139], v58 offset:8192
 v_mfma_f32_16x16x32_bf16 v[124:127], a[76:79], v[144:147], v[124:127]
 buffer_load_dwordx4 v55, s[8:11], s67 offen lds
 v_mfma_f32_16x16x32_bf16 v[128:131], a[68:71], v[148:151], v[128:131]
 ds_read_b128 v[140:143], v58 offset:10240
 v_mfma_f32_16x16x32_bf16 v[132:135], a[76:79], v[148:151], v[132:135]
 s_waitcnt lgkmcnt(4)
 s_xor_b32 s67, s81, 256
 v_mfma_f32_16x16x32_bf16 v[120:123], a[80:83], v[152:155], v[120:123]
 ds_read_b128 v[144:147], v59 offset:8192
 v_mfma_f32_16x16x32_bf16 v[124:127], a[88:91], v[152:155], v[124:127]
 s_xor_b32 m0, s80, 8192
 v_mfma_f32_16x16x32_bf16 v[128:131], a[80:83], v[156:159], v[128:131]
 ds_read_b128 v[148:151], v59 offset:10240
 v_mfma_f32_16x16x32_bf16 v[132:135], a[88:91], v[156:159], v[132:135]
 buffer_load_dwordx4 v55, s[8:11], s67 offen lds
 s_waitcnt lgkmcnt(4)
 v_mfma_f32_16x16x32_bf16 v[120:123], a[84:87], v[160:163], v[120:123]
 ds_read_b128 v[152:155], v58 offset:12288
 v_mfma_f32_16x16x32_bf16 v[124:127], a[92:95], v[160:163], v[124:127]
 s_xor_b32 s67, s81, 384
 v_mfma_f32_16x16x32_bf16 v[128:131], a[84:87], v[164:167], v[128:131]
 ds_read_b128 v[156:159], v58 offset:14336
 v_mfma_f32_16x16x32_bf16 v[132:135], a[92:95], v[164:167], v[132:135]
 s_waitcnt lgkmcnt(4)
 s_xor_b32 m0, s80, 12288
 v_mfma_f32_16x16x32_bf16 v[120:123], a[96:99], v[136:139], v[120:123]
 ds_read_b128 v[160:163], v59 offset:12288
 v_mfma_f32_16x16x32_bf16 v[124:127], a[104:107], v[136:139], v[124:127]
 buffer_load_dwordx4 v55, s[8:11], s67 offen lds
 v_mfma_f32_16x16x32_bf16 v[128:131], a[96:99], v[140:143], v[128:131]
 ds_read_b128 v[164:167], v59 offset:14336
 v_mfma_f32_16x16x32_bf16 v[132:135], a[104:107], v[140:143], v[132:135]
 s_waitcnt lgkmcnt(4)
 s_xor_b32 s67, s81, 512
 v_mfma_f32_16x16x32_bf16 v[120:123], a[100:103], v[144:147], v[120:123]
 ds_read_b128 v[136:139], v60 offset:0
 v_mfma_f32_16x16x32_bf16 v[124:127], a[108:111], v[144:147], v[124:127]
 s_xor_b32 m0, s80, 16384
 v_mfma_f32_16x16x32_bf16 v[128:131], a[100:103], v[148:151], v[128:131]
 ds_read_b128 v[140:143], v60 offset:2048
 v_mfma_f32_16x16x32_bf16 v[132:135], a[108:111], v[148:151], v[132:135]
 buffer_load_dwordx4 v55, s[8:11], s67 offen lds
 s_waitcnt lgkmcnt(4)
 v_mfma_f32_16x16x32_bf16 v[120:123], a[112:115], v[152:155], v[120:123]
 ds_read_b128 v[144:147], v61 offset:0
 v_mfma_f32_16x16x32_bf16 v[124:127], a[120:123], v[152:155], v[124:127]
 s_xor_b32 s67, s81, 640
 v_mfma_f32_16x16x32_bf16 v[128:131], a[112:115], v[156:159], v[128:131]
 ds_read_b128 v[148:151], v61 offset:2048
 v_mfma_f32_16x16x32_bf16 v[132:135], a[120:123], v[156:159], v[132:135]
 s_waitcnt lgkmcnt(4)
 s_xor_b32 m0, s80, 20480
 v_mfma_f32_16x16x32_bf16 v[120:123], a[116:119], v[160:163], v[120:123]
 ds_read_b128 v[152:155], v60 offset:4096
 v_mfma_f32_16x16x32_bf16 v[124:127], a[124:127], v[160:163], v[124:127]
 buffer_load_dwordx4 v55, s[8:11], s67 offen lds
 v_mfma_f32_16x16x32_bf16 v[128:131], a[116:119], v[164:167], v[128:131]
 ds_read_b128 v[156:159], v60 offset:6144
 v_mfma_f32_16x16x32_bf16 v[132:135], a[124:127], v[164:167], v[132:135]
 s_waitcnt lgkmcnt(4)
 s_xor_b32 s67, s81, 768
 v_mfma_f32_16x16x32_bf16 v[120:123], a[128:131], v[136:139], v[120:123]
 ds_read_b128 v[160:163], v61 offset:4096
 v_mfma_f32_16x16x32_bf16 v[124:127], a[136:139], v[136:139], v[124:127]
 s_xor_b32 m0, s80, 24576
 v_mfma_f32_16x16x32_bf16 v[128:131], a[128:131], v[140:143], v[128:131]
 ds_read_b128 v[164:167], v61 offset:6144
 v_mfma_f32_16x16x32_bf16 v[132:135], a[136:139], v[140:143], v[132:135]
 buffer_load_dwordx4 v55, s[8:11], s67 offen lds
 s_waitcnt lgkmcnt(4)
 v_mfma_f32_16x16x32_bf16 v[120:123], a[132:135], v[144:147], v[120:123]
 ds_read_b128 v[136:139], v60 offset:8192
 v_mfma_f32_16x16x32_bf16 v[124:127], a[140:143], v[144:147], v[124:127]
 s_xor_b32 s67, s81, 896
 v_mfma_f32_16x16x32_bf16 v[128:131], a[132:135], v[148:151], v[128:131]
 ds_read_b128 v[140:143], v60 offset:10240
 v_mfma_f32_16x16x32_bf16 v[132:135], a[140:143], v[148:151], v[132:135]
 s_waitcnt lgkmcnt(4)
 s_xor_b32 m0, s80, 28672
 v_mfma_f32_16x16x32_bf16 v[120:123], a[144:147], v[152:155], v[120:123]
 ds_read_b128 v[144:147], v61 offset:8192
 v_mfma_f32_16x16x32_bf16 v[124:127], a[152:155], v[152:155], v[124:127]
 buffer_load_dwordx4 v55, s[8:11], s67 offen lds
 v_mfma_f32_16x16x32_bf16 v[128:131], a[144:147], v[156:159], v[128:131]
 ds_read_b128 v[148:151], v61 offset:10240
 v_mfma_f32_16x16x32_bf16 v[132:135], a[152:155], v[156:159], v[132:135]
 s_waitcnt lgkmcnt(4)
 s_xor_b32 s67, s81, 1024
 v_mfma_f32_16x16x32_bf16 v[120:123], a[148:151], v[160:163], v[120:123]
 ds_read_b128 v[152:155], v60 offset:12288
 v_mfma_f32_16x16x32_bf16 v[124:127], a[156:159], v[160:163], v[124:127]
 s_xor_b32 m0, s80, 32768
 v_mfma_f32_16x16x32_bf16 v[128:131], a[148:151], v[164:167], v[128:131]
 ds_read_b128 v[156:159], v60 offset:14336
 v_mfma_f32_16x16x32_bf16 v[132:135], a[156:159], v[164:167], v[132:135]
 buffer_load_dwordx4 v55, s[8:11], s67 offen lds
 s_waitcnt lgkmcnt(4)
 v_mfma_f32_16x16x32_bf16 v[120:123], a[160:163], v[136:139], v[120:123]
 ds_read_b128 v[160:163], v61 offset:12288
 v_mfma_f32_16x16x32_bf16 v[124:127], a[168:171], v[136:139], v[124:127]
 s_xor_b32 s67, s81, 1152
 v_mfma_f32_16x16x32_bf16 v[128:131], a[160:163], v[140:143], v[128:131]
 ds_read_b128 v[164:167], v61 offset:14336
 v_mfma_f32_16x16x32_bf16 v[132:135], a[168:171], v[140:143], v[132:135]
 s_waitcnt lgkmcnt(4)
 s_xor_b32 m0, s80, 36864
 v_mfma_f32_16x16x32_bf16 v[120:123], a[164:167], v[144:147], v[120:123]
 ds_read_b128 v[136:139], v62 offset:0
 v_mfma_f32_16x16x32_bf16 v[124:127], a[172:175], v[144:147], v[124:127]
 buffer_load_dwordx4 v55, s[8:11], s67 offen lds
 v_mfma_f32_16x16x32_bf16 v[128:131], a[164:167], v[148:151], v[128:131]
 ds_read_b128 v[140:143], v62 offset:2048
 v_mfma_f32_16x16x32_bf16 v[132:135], a[172:175], v[148:151], v[132:135]
 s_waitcnt lgkmcnt(4)
 s_xor_b32 s67, s81, 1280
 v_mfma_f32_16x16x32_bf16 v[120:123], a[176:179], v[152:155], v[120:123]
 ds_read_b128 v[144:147], v63 offset:0
 v_mfma_f32_16x16x32_bf16 v[124:127], a[184:187], v[152:155], v[124:127]
 s_xor_b32 m0, s80, 40960
 v_mfma_f32_16x16x32_bf16 v[128:131], a[176:179], v[156:159], v[128:131]
 ds_read_b128 v[148:151], v63 offset:2048
 v_mfma_f32_16x16x32_bf16 v[132:135], a[184:187], v[156:159], v[132:135]
 buffer_load_dwordx4 v55, s[8:11], s67 offen lds
 s_waitcnt lgkmcnt(4)
 v_mfma_f32_16x16x32_bf16 v[120:123], a[180:183], v[160:163], v[120:123]
 ds_read_b128 v[152:155], v62 offset:4096
 v_mfma_f32_16x16x32_bf16 v[124:127], a[188:191], v[160:163], v[124:127]
 s_xor_b32 s67, s81, 1408
 v_mfma_f32_16x16x32_bf16 v[128:131], a[180:183], v[164:167], v[128:131]
 ds_read_b128 v[156:159], v62 offset:6144
 v_mfma_f32_16x16x32_bf16 v[132:135], a[188:191], v[164:167], v[132:135]
 s_waitcnt lgkmcnt(4)
 s_xor_b32 m0, s80, 45056
 v_mfma_f32_16x16x32_bf16 v[120:123], a[192:195], v[136:139], v[120:123]
 ds_read_b128 v[160:163], v63 offset:4096
 v_mfma_f32_16x16x32_bf16 v[124:127], a[200:203], v[136:139], v[124:127]
 buffer_load_dwordx4 v55, s[8:11], s67 offen lds
 v_mfma_f32_16x16x32_bf16 v[128:131], a[192:195], v[140:143], v[128:131]
 ds_read_b128 v[164:167], v63 offset:6144
 v_mfma_f32_16x16x32_bf16 v[132:135], a[200:203], v[140:143], v[132:135]
 s_waitcnt lgkmcnt(4)
 s_xor_b32 s67, s81, 1536
 v_mfma_f32_16x16x32_bf16 v[120:123], a[196:199], v[144:147], v[120:123]
 ds_read_b128 v[136:139], v62 offset:8192
 v_mfma_f32_16x16x32_bf16 v[124:127], a[204:207], v[144:147], v[124:127]
 s_xor_b32 m0, s80, 49152
 v_mfma_f32_16x16x32_bf16 v[128:131], a[196:199], v[148:151], v[128:131]
 ds_read_b128 v[140:143], v62 offset:10240
 v_mfma_f32_16x16x32_bf16 v[132:135], a[204:207], v[148:151], v[132:135]
 buffer_load_dwordx4 v55, s[8:11], s67 offen lds
 s_waitcnt lgkmcnt(4)
 v_mfma_f32_16x16x32_bf16 v[120:123], a[208:211], v[152:155], v[120:123]
 ds_read_b128 v[144:147], v63 offset:8192
 v_mfma_f32_16x16x32_bf16 v[124:127], a[216:219], v[152:155], v[124:127]
 s_xor_b32 s67, s81, 1664
 v_mfma_f32_16x16x32_bf16 v[128:131], a[208:211], v[156:159], v[128:131]
 ds_read_b128 v[148:151], v63 offset:10240
 v_mfma_f32_16x16x32_bf16 v[132:135], a[216:219], v[156:159], v[132:135]
 s_waitcnt lgkmcnt(4)
 s_xor_b32 m0, s80, 53248
 v_mfma_f32_16x16x32_bf16 v[120:123], a[212:215], v[160:163], v[120:123]
 ds_read_b128 v[152:155], v62 offset:12288
 v_mfma_f32_16x16x32_bf16 v[124:127], a[220:223], v[160:163], v[124:127]
 buffer_load_dwordx4 v55, s[8:11], s67 offen lds
 v_mfma_f32_16x16x32_bf16 v[128:131], a[212:215], v[164:167], v[128:131]
 ds_read_b128 v[156:159], v62 offset:14336
 v_mfma_f32_16x16x32_bf16 v[132:135], a[220:223], v[164:167], v[132:135]
 s_waitcnt lgkmcnt(4)
 s_xor_b32 s67, s81, 1792
 v_mfma_f32_16x16x32_bf16 v[120:123], a[224:227], v[136:139], v[120:123]
 ds_read_b128 v[160:163], v63 offset:12288
 v_mfma_f32_16x16x32_bf16 v[124:127], a[232:235], v[136:139], v[124:127]
 s_xor_b32 m0, s80, 57344
 v_mfma_f32_16x16x32_bf16 v[128:131], a[224:227], v[140:143], v[128:131]
 ds_read_b128 v[164:167], v63 offset:14336
 v_mfma_f32_16x16x32_bf16 v[132:135], a[232:235], v[140:143], v[132:135]
 buffer_load_dwordx4 v55, s[8:11], s67 offen lds
 s_waitcnt lgkmcnt(4)
 v_mfma_f32_16x16x32_bf16 v[120:123], a[228:231], v[144:147], v[120:123]
 v_mfma_f32_16x16x32_bf16 v[124:127], a[236:239], v[144:147], v[124:127]
 s_xor_b32 s67, s81, 1920
 v_mfma_f32_16x16x32_bf16 v[128:131], a[228:231], v[148:151], v[128:131]
 v_mfma_f32_16x16x32_bf16 v[132:135], a[236:239], v[148:151], v[132:135]
 s_waitcnt lgkmcnt(2)
 s_xor_b32 m0, s80, 61440
 v_mfma_f32_16x16x32_bf16 v[120:123], a[240:243], v[152:155], v[120:123]
 v_xor_b32 v56, 0x10000, v56
 v_xor_b32 v57, 0x10000, v57
 v_mfma_f32_16x16x32_bf16 v[124:127], a[248:251], v[152:155], v[124:127]
 buffer_load_dwordx4 v55, s[8:11], s67 offen lds
 v_mfma_f32_16x16x32_bf16 v[128:131], a[240:243], v[156:159], v[128:131]
 v_xor_b32 v58, 0x10000, v58
 v_xor_b32 v59, 0x10000, v59
 v_mfma_f32_16x16x32_bf16 v[132:135], a[248:251], v[156:159], v[132:135]
 s_waitcnt lgkmcnt(0)
 v_mfma_f32_16x16x32_bf16 v[120:123], a[244:247], v[160:163], v[120:123]
 v_xor_b32 v60, 0x10000, v60
 v_xor_b32 v61, 0x10000, v61
 v_mfma_f32_16x16x32_bf16 v[124:127], a[252:255], v[160:163], v[124:127]
 v_mfma_f32_16x16x32_bf16 v[128:131], a[244:247], v[164:167], v[128:131]
 v_xor_b32 v62, 0x10000, v62
 v_xor_b32 v63, 0x10000, v63
 v_mfma_f32_16x16x32_bf16 v[132:135], a[252:255], v[164:167], v[132:135]
 s_add_u32 s65, s64, 2
 s_and_b32 s65, s65, 3
 s_lshl_b32 s65, s65, 13
 s_add_u32 s65, s65, s76
 s_add_u32 s66, s65, 4096
 s_nop 0
 v_cvt_pk_bf16_f32 v168, v120, v121
 v_cvt_pk_bf16_f32 v169, v122, v123
 v_cvt_pk_bf16_f32 v170, v124, v125
 v_cvt_pk_bf16_f32 v171, v126, v127
 v_cvt_pk_bf16_f32 v172, v128, v129
 v_cvt_pk_bf16_f32 v173, v130, v131
 v_cvt_pk_bf16_f32 v174, v132, v133
 v_cvt_pk_bf16_f32 v175, v134, v135
 s_cmp_eq_u32 s24, 2
 s_cbranch_scc0 L_proj_noswap_35
 v_swap_b32 v169, v170
 v_swap_b32 v173, v174
L_proj_noswap_35:
 buffer_store_dwordx4 v[168:171], v10, s[4:7], s65 offen
 buffer_store_dwordx4 v[172:175], v10, s[4:7], s66 offen
L_proj_end_29:
 s_add_u32 s64, s64, 1
 s_cmp_lt_i32 s64, 64
 s_cbranch_scc1 L_proj_loop_26
 s_endpgm
L_role_t_0_abort:
 s_endpgm
.p2align 6
L_role_t_0:
 s_sub_u32 s84, s61, 20
 s_and_b32 s77, s84, 3
 s_lshl_b32 s84, s84, 2
 s_add_u32 s84, s84, s62
 s_lshl_b32 s67, s60, 2
 s_add_u32 s66, s77, s67
 s_lshl_b32 s72, s66, 13
 s_add_u32 s72, s72, 0x6200000
 s_add_u32 s73, s72, 262144
 s_lshl_b32 s74, s66, 15
 s_add_u32 s75, s74, 0x100000
 s_mov_b32 s82, 0x3e0293ee
 s_mov_b32 s83, 0x3e0293ee
 s_sub_u32 s69, s61, 20
 s_and_b32 s66, s69, 3
 s_lshr_b32 s24, s69, 2
 s_lshl_b32 s67, s60, 2
 s_add_u32 s66, s66, s67
 s_cmp_eq_u32 s24, 0
 s_cselect_b64 s[12:13], s[40:41], s[42:43]
 s_cmp_eq_u32 s24, 2
 s_cselect_b64 s[12:13], s[44:45], s[12:13]
 s_lshl_b32 s67, s66, 8
 s_add_u32 s12, s12, s67
 s_addc_u32 s13, s13, 0
 s_sub_u32 s14, 0x800000, s67
 s_mov_b32 s15, 0x00020000
 s_lshl_b32 s27, s24, 5
 s_add_u32 s27, s27, s66
 s_lshl_b32 s22, s27, 13
 s_add_u32 s22, s22, 0x6200000
 s_lshl_b32 s23, s60, 16
 s_lshl_b32 s68, s62, 12
 s_add_u32 s23, s23, s68
 s_add_u32 s23, s23, 0x6100000
 v_lshrrev_b32 v6, 4, v0
 v_lshlrev_b32 v7, 2, v6
 v_and_b32 v1, 15, v0
 v_xor_b32 v1, v1, v7
 v_lshlrev_b32 v1, 4, v1
 v_mul_u32_u24 v6, 8192, v6
 v_add_u32 v1, v1, v6
 v_bfe_u32 v6, v0, 2, 2
 v_and_b32 v7, 3, v0
 s_lshl_b32 s65, s62, 2
 v_add_u32 v7, s65, v7
 v_and_b32 v2, 3, v6
 v_lshlrev_b32 v2, 2, v2
 v_xor_b32 v7, v7, v2
 v_lshlrev_b32 v7, 4, v7
 v_lshrrev_b32 v2, 4, v0
 v_lshlrev_b32 v2, 3, v2
 v_add_u32 v2, v2, v6
 v_lshlrev_b32 v2, 8, v2
 v_add_u32 v2, v2, v7
 v_add_u32 v3, 1024, v2
 v_add_u32 v4, 0x10000, v2
 v_add_u32 v5, 0x10000, v3
 s_mul_i32 s20, s62, 524288
 s_lshl_b32 s21, s62, 14
 s_mov_b32 s32, s38
 s_mov_b32 s33, s39
 s_mov_b32 s34, 0x4000
 s_mov_b32 s35, 0x00020000
 s_mov_b32 s85, 0x6600000
 s_lshl_b32 s66, s84, 9
 s_lshl_b32 s67, s60, 16
 s_add_u32 s86, s66, s67
 s_add_u32 s86, s86, 0x6100000
 s_lshl_b32 s87, s60, 12
 s_add_u32 s87, s87, 0x6500000
 v_mov_b32 v78, -1
 v_mov_b32 v79, -1
 s_and_b32 s66, s84, 15
 s_lshl_b32 s66, s66, 9
 s_lshr_b32 s67, s84, 4
 s_lshl_b32 s67, s67, 14
 s_add_u32 s66, s66, s67
 s_lshl_b32 s67, s60, 15
 s_add_u32 s66, s66, s67
 v_and_b32 v56, 31, v0
 v_lshlrev_b32 v56, 4, v56
 v_add_u32 v56, s66, v56
 v_lshrrev_b32 v57, 5, v0
 v_lshlrev_b32 v57, 15, v57
 v_xor_b32 v60, v56, v57
 v_xor_b32 v61, 0x10000, v60
 v_xor_b32 v62, 0x20000, v60
 v_xor_b32 v63, 0x30000, v60
 v_and_b32 v56, 31, v0
 v_and_b32 v65, 7, v0
 v_lshlrev_b32 v65, 7, v65
 v_lshlrev_b32 v56, 4, v56
 v_lshrrev_b32 v57, 5, v0
 v_lshl_add_u32 v64, v57, 3, v56
 s_add_u32 s65, s86, 16384
 buffer_store_dwordx2 v[78:79], v64, s[4:7], s65 offen
 s_add_u32 s65, s86, 32768
 buffer_store_dwordx2 v[78:79], v64, s[4:7], s65 offen
 s_add_u32 s65, s86, 49152
 buffer_store_dwordx2 v[78:79], v64, s[4:7], s65 offen
 v_and_b32 v56, 7, v0
 v_lshlrev_b32 v56, 11, v56
 v_bfe_u32 v57, v0, 4, 1
 v_lshl_add_u32 v56, v57, 5, v56
 v_lshrrev_b32 v57, 5, v0
 v_lshl_add_u32 v56, v57, 4, v56
 v_bfe_u32 v57, v0, 3, 1
 v_lshl_add_u32 v56, v57, 2, v56
 s_lshl_b32 s65, s84, 6
 buffer_load_dword v76, v56, s[32:35], s65 offen
 buffer_load_dword v77, v56, s[32:35], s65 offen offset:8
 v_and_b32 v57, 1, v0
 v_lshlrev_b32 v57, 4, v57
 v_mov_b32 v58, 0x3f80
 v_lshlrev_b32 v57, v57, v58
 v_bfe_u32 v56, v0, 1, 1
 v_bfe_u32 v58, v0, 4, 1
 v_xor_b32 v56, v56, v58
 v_bfe_u32 v58, v0, 2, 1
 v_lshl_add_u32 v56, v56, 1, v58
 v_bfe_u32 v58, v0, 3, 1
 v_lshl_add_u32 v56, v56, 1, v58
 v_cmp_eq_u32 vcc, 0, v56
 s_nop 1
 v_cndmask_b32 v68, 0, v57, vcc
 v_cmp_eq_u32 vcc, 1, v56
 s_nop 1
 v_cndmask_b32 v69, 0, v57, vcc
 v_cmp_eq_u32 vcc, 2, v56
 s_nop 1
 v_cndmask_b32 v70, 0, v57, vcc
 v_cmp_eq_u32 vcc, 3, v56
 s_nop 1
 v_cndmask_b32 v71, 0, v57, vcc
 v_min_u32 v66, 1, v0
 v_lshlrev_b32 v66, 28, v66
 v_mov_b32 v186, 0
 v_lshlrev_b32 v84, 4, v0
 v_lshrrev_b32 v80, 4, v0
 v_lshlrev_b32 v80, 7, v80
 v_and_b32 v81, 7, v0
 v_lshl_add_u32 v85, v81, 4, v80
 v_bfe_u32 v80, v0, 3, 1
 v_lshl_add_u32 v86, v80, 18, v85
 v_mov_b32 v92, -1
 v_mov_b32 v93, -1
 v_mov_b32 v94, -1
 v_mov_b32 v95, -1
 s_lshl_b32 s65, s60, 15
 s_lshl_b32 s66, s84, 10
 s_add_u32 s65, s65, s66
 s_add_u32 s66, s65, 0x6200000
 buffer_store_dwordx4 v[92:95], v84, s[4:7], s66 offen
 s_add_u32 s66, s65, 0x6240000
 buffer_store_dwordx4 v[92:95], v84, s[4:7], s66 offen
 s_add_u32 s66, s65, 0x6280000
 buffer_store_dwordx4 v[92:95], v84, s[4:7], s66 offen
 s_add_u32 s66, s65, 0x6600000
 buffer_store_dwordx4 v[92:95], v84, s[4:7], s66 offen sc1
 s_add_u32 s66, s65, 0x6640000
 buffer_store_dwordx4 v[92:95], v84, s[4:7], s66 offen sc1
 s_cmp_eq_u32 s84, 18
 s_cselect_b32 s66, 0, 0x10000000
 v_or_b32 v187, s66, v66
 v_mov_b32 v188, 0
 s_lshl_b32 s30, s60, 7
 s_add_u32 s30, s30, 0x5000000
 buffer_store_dword v188, v187, s[4:7], s30 offen
 s_lshr_b32 s66, s84, 2
 s_and_b32 s66, s66, 3
 s_lshl_b32 s67, s60, 2
 s_add_u32 s66, s66, s67
 s_lshl_b32 s66, s66, 5
 s_add_u32 s66, s66, s62
 s_lshl_b32 s66, s66, 2
 s_add_u32 s66, s66, 0x5010000
 buffer_store_dword v188, v66, s[4:7], s66 offen
 s_lshr_b32 s65, s65, 3
 s_add_u32 s66, s65, 0x6500000
 buffer_store_dword v92, v66, s[4:7], s66 offen
 s_cmp_lt_u32 s61, 24
 s_cbranch_scc0 L_t_xw_36
 v_bfe_u32 v80, v0, 1, 2
 v_lshlrev_b32 v80, 2, v80
 v_bfe_u32 v81, v0, 3, 1
 v_lshl_add_u32 v80, v81, 1, v80
 v_and_b32 v81, 1, v0
 v_add_u32 v80, v80, v81
 v_lshlrev_b32 v80, 4, v80
 v_bfe_u32 v81, v0, 4, 1
 v_lshl_add_u32 v80, v81, 3, v80
 v_lshrrev_b32 v81, 5, v0
 v_lshl_add_u32 v82, v81, 8, v80
 s_lshl_b32 s65, s77, 9
 v_add_u32 v87, s65, v82
 s_lshr_b32 s65, s77, 1
 s_lshl_b32 s65, s65, 9
 s_and_b32 s66, s77, 1
 s_lshl_b32 s66, s66, 2
 s_add_u32 s65, s65, s66
 s_add_u32 s65, s65, 2048
 v_add_u32 v88, s65, v80
 v_xor_b32 v81, 1, v81
 v_lshl_add_u32 v88, v81, 28, v88
 v_mov_b32 v80, 0xff800000
 v_cmp_gt_u32 vcc, 32, v0
 s_nop 1
 v_cndmask_b32 v176, 0, v80, vcc
 v_cndmask_b32 v177, 0, v80, vcc
 v_cndmask_b32 v178, 0, v80, vcc
 v_cndmask_b32 v179, 0, v80, vcc
 s_lshl_b32 s76, s60, 14
 s_add_u32 s76, s76, 0x6300000
 s_cmp_eq_u32 s62, 0
 s_cbranch_scc0 L_t_join_37
 s_add_u32 s65, s76, 0
 buffer_store_dwordx2 v[92:93], v87, s[4:7], s65 offen
 buffer_store_dword v92, v88, s[4:7], s65 offen
 buffer_store_dword v92, v88, s[4:7], s65 offen offset:256
 s_add_u32 s65, s76, 4096
 buffer_store_dwordx2 v[92:93], v87, s[4:7], s65 offen
 buffer_store_dword v92, v88, s[4:7], s65 offen
 buffer_store_dword v92, v88, s[4:7], s65 offen offset:256
 s_add_u32 s65, s76, 8192
 buffer_store_dwordx2 v[92:93], v87, s[4:7], s65 offen
 buffer_store_dword v92, v88, s[4:7], s65 offen
 buffer_store_dword v92, v88, s[4:7], s65 offen offset:256
 s_add_u32 s65, s76, 12288
 buffer_store_dwordx2 v[92:93], v87, s[4:7], s65 offen
 buffer_store_dword v92, v88, s[4:7], s65 offen
 buffer_store_dword v92, v88, s[4:7], s65 offen offset:256
 s_branch L_t_join_37
L_t_xw_36:
 s_and_b32 s67, s62, 1
 s_mul_i32 s68, s67, 6144
 s_lshl_b32 s65, s77, 10
 s_add_u32 s65, s65, s68
 v_add_u32 v87, s65, v84
 s_lshr_b32 s65, s77, 1
 s_lshl_b32 s65, s65, 10
 s_and_b32 s66, s77, 1
 s_lshl_b32 s66, s66, 3
 s_add_u32 s65, s65, s66
 s_add_u32 s65, s65, s68
 s_add_u32 s65, s65, 4096
 v_add_u32 v88, s65, v84
 s_lshl_b32 s65, s67, 4
 v_and_b32 v80, 15, v0
 v_add_u32 v80, s65, v80
 v_lshrrev_b32 v81, 4, v0
 v_lshlrev_b32 v81, 2, v81
 v_sub_u32 v186, v80, v81
 v_mov_b32 v185, 0xd028965f
 s_lshl_b32 s67, s67, 12
 s_add_u32 s74, s74, s67
 s_lshl_b32 s76, s60, 16
 s_add_u32 s76, s76, 0x6400000
 s_cmp_lt_u32 s62, 2
 s_cbranch_scc0 L_t_join_37
 s_add_u32 s65, s76, 0
 buffer_store_dwordx4 v[92:95], v87, s[4:7], s65 offen
 buffer_store_dwordx2 v[92:93], v88, s[4:7], s65 offen
 s_add_u32 s65, s76, 16384
 buffer_store_dwordx4 v[92:95], v87, s[4:7], s65 offen
 buffer_store_dwordx2 v[92:93], v88, s[4:7], s65 offen
 s_add_u32 s65, s76, 32768
 buffer_store_dwordx4 v[92:95], v87, s[4:7], s65 offen
 buffer_store_dwordx2 v[92:93], v88, s[4:7], s65 offen
 s_add_u32 s65, s76, 49152
 buffer_store_dwordx4 v[92:95], v87, s[4:7], s65 offen
 buffer_store_dwordx2 v[92:93], v88, s[4:7], s65 offen
L_t_join_37:
 s_waitcnt vmcnt(7)
 v_min_u32 v76, -2, v76
 buffer_store_dwordx2 v[76:77], v64, s[4:7], s86 offen
 v_lshlrev_b32 v191, 4, v0
 s_cmp_eq_u32 s24, 2
 s_cselect_b64 vcc, -1, 0
 v_and_b32 v6, 15, v0
 v_lshrrev_b32 v7, 5, v0
 v_lshl_add_u32 v6, v7, 4, v6
 v_lshlrev_b32 v6, 4, v6
 v_bfe_u32 v7, v0, 4, 1
 v_lshl_add_u32 v189, v7, 3, v6
 v_lshrrev_b32 v6, 4, v0
 v_lshlrev_b32 v6, 7, v6
 v_and_b32 v7, 7, v0
 v_lshl_add_u32 v6, v7, 4, v6
 v_bfe_u32 v7, v0, 3, 1
 v_lshl_add_u32 v190, v7, 3, v6
 v_cndmask_b32 v189, v190, v189, vcc
 s_lshl_b32 s68, s62, 9
 v_add_u32 v192, s68, v189
 v_xor_b32 v7, 1, v7
 v_cndmask_b32 v7, v7, 0, vcc
 v_lshl_add_u32 v193, v7, 28, v192
 v_mov_b32 v196, -1
 v_mov_b32 v197, -1
 v_mov_b32 v198, -1
 v_mov_b32 v199, -1
 s_add_u32 s68, s62, 0
 s_and_b32 s68, s68, 3
 s_lshl_b32 s69, s68, 12
 s_add_u32 s69, s69, 131072
 v_add_u32 v200, s69, v191
 s_add_u32 s68, s62, 1
 s_and_b32 s68, s68, 3
 s_lshl_b32 s69, s68, 12
 s_add_u32 s69, s69, 131072
 v_add_u32 v201, s69, v191
 s_add_u32 s68, s62, 2
 s_and_b32 s68, s68, 3
 s_lshl_b32 s69, s68, 12
 s_add_u32 s69, s69, 131072
 v_add_u32 v202, s69, v191
 s_add_u32 s68, s62, 3
 s_and_b32 s68, s68, 3
 s_lshl_b32 s69, s68, 12
 s_add_u32 s69, s69, 131072
 v_add_u32 v203, s69, v191
 v_and_b32 v6, 8, v0
 v_cmp_ne_u32 vcc, 0, v6
 v_mov_b32 v204, 0x44444444
 v_mov_b32 v6, 0xeeeeeeee
 s_nop 1
 v_cndmask_b32 v204, v204, v6, vcc
 v_and_b32 v7, 1, v0
 v_lshlrev_b32 v7, 4, v7
 v_mov_b32 v189, 0x3f80
 v_lshlrev_b32 v7, v7, v189
 v_bfe_u32 v6, v0, 3, 1
 v_bfe_u32 v189, v0, 1, 1
 v_lshl_add_u32 v6, v6, 1, v189
 v_bfe_u32 v189, v0, 4, 1
 v_bfe_u32 v190, v0, 2, 1
 v_xor_b32 v189, v189, v190
 v_lshl_add_u32 v6, v189, 2, v6
 v_cmp_eq_u32 vcc, 0, v6
 s_nop 1
 v_cndmask_b32 v208, 0, v7, vcc
 v_cmp_eq_u32 vcc, 1, v6
 s_nop 1
 v_cndmask_b32 v209, 0, v7, vcc
 v_cmp_eq_u32 vcc, 2, v6
 s_nop 1
 v_cndmask_b32 v210, 0, v7, vcc
 v_cmp_eq_u32 vcc, 3, v6
 s_nop 1
 v_cndmask_b32 v211, 0, v7, vcc
 v_mov_b32 v228, 0
 v_mov_b32 v229, 0
 v_mov_b32 v230, 0
 v_mov_b32 v231, 0
 s_or_b32 s65, s62, s101
 s_cbranch_scc1 L_clm_38
 s_waitcnt lgkmcnt(0)
 s_bitcmp1_b32 s3, s61
 s_cbranch_scc0 L_clm_38
 s_mov_b32 s66, 1
 s_atomic_or s66, s[56:57], 36
 s_waitcnt lgkmcnt(0)
L_clm_38:
 s_waitcnt vmcnt(0)
 s_barrier
 s_add_u32 m0, s21, 0
 s_add_u32 s65, s20, 4194304
 buffer_load_dwordx4 v1, s[12:15], s65 offen nt lds
 s_add_u32 m0, s21, 1024
 s_add_u32 s65, s20, 4227072
 buffer_load_dwordx4 v1, s[12:15], s65 offen nt lds
 s_add_u32 m0, s21, 2048
 s_add_u32 s65, s20, 4259840
 buffer_load_dwordx4 v1, s[12:15], s65 offen nt lds
 s_add_u32 m0, s21, 3072
 s_add_u32 s65, s20, 4292608
 buffer_load_dwordx4 v1, s[12:15], s65 offen nt lds
 s_add_u32 m0, s21, 4096
 s_add_u32 s65, s20, 4325376
 buffer_load_dwordx4 v1, s[12:15], s65 offen nt lds
 s_add_u32 m0, s21, 5120
 s_add_u32 s65, s20, 4358144
 buffer_load_dwordx4 v1, s[12:15], s65 offen nt lds
 s_add_u32 m0, s21, 6144
 s_add_u32 s65, s20, 4390912
 buffer_load_dwordx4 v1, s[12:15], s65 offen nt lds
 s_add_u32 m0, s21, 7168
 s_add_u32 s65, s20, 4423680
 buffer_load_dwordx4 v1, s[12:15], s65 offen nt lds
 s_add_u32 m0, s21, 8192
 s_add_u32 s65, s20, 4456448
 buffer_load_dwordx4 v1, s[12:15], s65 offen nt lds
 s_add_u32 m0, s21, 9216
 s_add_u32 s65, s20, 4489216
 buffer_load_dwordx4 v1, s[12:15], s65 offen nt lds
 s_add_u32 m0, s21, 10240
 s_add_u32 s65, s20, 4521984
 buffer_load_dwordx4 v1, s[12:15], s65 offen nt lds
 s_add_u32 m0, s21, 11264
 s_add_u32 s65, s20, 4554752
 buffer_load_dwordx4 v1, s[12:15], s65 offen nt lds
 s_add_u32 m0, s21, 12288
 s_add_u32 s65, s20, 4587520
 buffer_load_dwordx4 v1, s[12:15], s65 offen nt lds
 s_add_u32 m0, s21, 13312
 s_add_u32 s65, s20, 4620288
 buffer_load_dwordx4 v1, s[12:15], s65 offen nt lds
 s_add_u32 m0, s21, 14336
 s_add_u32 s65, s20, 4653056
 buffer_load_dwordx4 v1, s[12:15], s65 offen nt lds
 s_add_u32 m0, s21, 15360
 s_add_u32 s65, s20, 4685824
 buffer_load_dwordx4 v1, s[12:15], s65 offen nt lds
 s_add_u32 m0, s21, 65536
 s_add_u32 s65, s20, 6291456
 buffer_load_dwordx4 v1, s[12:15], s65 offen nt lds
 s_add_u32 m0, s21, 66560
 s_add_u32 s65, s20, 6324224
 buffer_load_dwordx4 v1, s[12:15], s65 offen nt lds
 s_add_u32 m0, s21, 67584
 s_add_u32 s65, s20, 6356992
 buffer_load_dwordx4 v1, s[12:15], s65 offen nt lds
 s_add_u32 m0, s21, 68608
 s_add_u32 s65, s20, 6389760
 buffer_load_dwordx4 v1, s[12:15], s65 offen nt lds
 s_add_u32 m0, s21, 69632
 s_add_u32 s65, s20, 6422528
 buffer_load_dwordx4 v1, s[12:15], s65 offen nt lds
 s_add_u32 m0, s21, 70656
 s_add_u32 s65, s20, 6455296
 buffer_load_dwordx4 v1, s[12:15], s65 offen nt lds
 s_add_u32 m0, s21, 71680
 s_add_u32 s65, s20, 6488064
 buffer_load_dwordx4 v1, s[12:15], s65 offen nt lds
 s_add_u32 m0, s21, 72704
 s_add_u32 s65, s20, 6520832
 buffer_load_dwordx4 v1, s[12:15], s65 offen nt lds
 s_add_u32 m0, s21, 73728
 s_add_u32 s65, s20, 6553600
 buffer_load_dwordx4 v1, s[12:15], s65 offen nt lds
 s_add_u32 m0, s21, 74752
 s_add_u32 s65, s20, 6586368
 buffer_load_dwordx4 v1, s[12:15], s65 offen nt lds
 s_add_u32 m0, s21, 75776
 s_add_u32 s65, s20, 6619136
 buffer_load_dwordx4 v1, s[12:15], s65 offen nt lds
 s_add_u32 m0, s21, 76800
 s_add_u32 s65, s20, 6651904
 buffer_load_dwordx4 v1, s[12:15], s65 offen nt lds
 s_add_u32 m0, s21, 77824
 s_add_u32 s65, s20, 6684672
 buffer_load_dwordx4 v1, s[12:15], s65 offen nt lds
 s_add_u32 m0, s21, 78848
 s_add_u32 s65, s20, 6717440
 buffer_load_dwordx4 v1, s[12:15], s65 offen nt lds
 s_add_u32 m0, s21, 79872
 s_add_u32 s65, s20, 6750208
 buffer_load_dwordx4 v1, s[12:15], s65 offen nt lds
 s_add_u32 m0, s21, 80896
 s_add_u32 s65, s20, 6782976
 buffer_load_dwordx4 v1, s[12:15], s65 offen nt lds
 s_cmp_eq_u32 s62, 0
 s_cbranch_scc0 L_nosig_39
 s_add_u32 s65, s101, 4
 s_mov_b32 s66, 0x1
 s_atomic_add s66, s[56:57], s65
 s_waitcnt lgkmcnt(0)
L_nosig_39:
 s_waitcnt vmcnt(16)
 s_barrier
 s_sub_u32 s68, 6, s62
 s_and_b32 s68, s68, 3
 s_cmp_eq_u32 s68, 0
 s_cbranch_scc0 L_wl_next_41
 ds_read_b64_tr_b16 a[8:9], v2 offset:8
 ds_read_b64_tr_b16 a[10:11], v3 offset:8
 ds_read_b64_tr_b16 a[12:13], v2 offset:8200
 ds_read_b64_tr_b16 a[14:15], v3 offset:8200
 ds_read_b64_tr_b16 a[24:25], v2 offset:16392
 ds_read_b64_tr_b16 a[26:27], v3 offset:16392
 ds_read_b64_tr_b16 a[28:29], v2 offset:24584
 ds_read_b64_tr_b16 a[30:31], v3 offset:24584
 ds_read_b64_tr_b16 a[40:41], v2 offset:32776
 ds_read_b64_tr_b16 a[42:43], v3 offset:32776
 ds_read_b64_tr_b16 a[44:45], v2 offset:40968
 ds_read_b64_tr_b16 a[46:47], v3 offset:40968
 ds_read_b64_tr_b16 a[56:57], v2 offset:49160
 ds_read_b64_tr_b16 a[58:59], v3 offset:49160
 ds_read_b64_tr_b16 a[60:61], v2 offset:57352
 ds_read_b64_tr_b16 a[62:63], v3 offset:57352
 s_waitcnt lgkmcnt(0)
 s_branch L_wl_done_40
L_wl_next_41:
 s_cmp_eq_u32 s68, 1
 s_cbranch_scc0 L_wl_next_42
 ds_read_b64_tr_b16 a[72:73], v2 offset:8
 ds_read_b64_tr_b16 a[74:75], v3 offset:8
 ds_read_b64_tr_b16 a[76:77], v2 offset:8200
 ds_read_b64_tr_b16 a[78:79], v3 offset:8200
 ds_read_b64_tr_b16 a[88:89], v2 offset:16392
 ds_read_b64_tr_b16 a[90:91], v3 offset:16392
 ds_read_b64_tr_b16 a[92:93], v2 offset:24584
 ds_read_b64_tr_b16 a[94:95], v3 offset:24584
 ds_read_b64_tr_b16 a[104:105], v2 offset:32776
 ds_read_b64_tr_b16 a[106:107], v3 offset:32776
 ds_read_b64_tr_b16 a[108:109], v2 offset:40968
 ds_read_b64_tr_b16 a[110:111], v3 offset:40968
 ds_read_b64_tr_b16 a[120:121], v2 offset:49160
 ds_read_b64_tr_b16 a[122:123], v3 offset:49160
 ds_read_b64_tr_b16 a[124:125], v2 offset:57352
 ds_read_b64_tr_b16 a[126:127], v3 offset:57352
 s_waitcnt lgkmcnt(0)
 s_branch L_wl_done_40
L_wl_next_42:
 s_cmp_eq_u32 s68, 2
 s_cbranch_scc0 L_wl_next_43
 ds_read_b64_tr_b16 a[136:137], v2 offset:8
 ds_read_b64_tr_b16 a[138:139], v3 offset:8
 ds_read_b64_tr_b16 a[140:141], v2 offset:8200
 ds_read_b64_tr_b16 a[142:143], v3 offset:8200
 ds_read_b64_tr_b16 a[152:153], v2 offset:16392
 ds_read_b64_tr_b16 a[154:155], v3 offset:16392
 ds_read_b64_tr_b16 a[156:157], v2 offset:24584
 ds_read_b64_tr_b16 a[158:159], v3 offset:24584
 ds_read_b64_tr_b16 a[168:169], v2 offset:32776
 ds_read_b64_tr_b16 a[170:171], v3 offset:32776
 ds_read_b64_tr_b16 a[172:173], v2 offset:40968
 ds_read_b64_tr_b16 a[174:175], v3 offset:40968
 ds_read_b64_tr_b16 a[184:185], v2 offset:49160
 ds_read_b64_tr_b16 a[186:187], v3 offset:49160
 ds_read_b64_tr_b16 a[188:189], v2 offset:57352
 ds_read_b64_tr_b16 a[190:191], v3 offset:57352
 s_waitcnt lgkmcnt(0)
 s_branch L_wl_done_40
L_wl_next_43:
 ds_read_b64_tr_b16 a[200:201], v2 offset:8
 ds_read_b64_tr_b16 a[202:203], v3 offset:8
 ds_read_b64_tr_b16 a[204:205], v2 offset:8200
 ds_read_b64_tr_b16 a[206:207], v3 offset:8200
 ds_read_b64_tr_b16 a[216:217], v2 offset:16392
 ds_read_b64_tr_b16 a[218:219], v3 offset:16392
 ds_read_b64_tr_b16 a[220:221], v2 offset:24584
 ds_read_b64_tr_b16 a[222:223], v3 offset:24584
 ds_read_b64_tr_b16 a[232:233], v2 offset:32776
 ds_read_b64_tr_b16 a[234:235], v3 offset:32776
 ds_read_b64_tr_b16 a[236:237], v2 offset:40968
 ds_read_b64_tr_b16 a[238:239], v3 offset:40968
 ds_read_b64_tr_b16 a[248:249], v2 offset:49160
 ds_read_b64_tr_b16 a[250:251], v3 offset:49160
 ds_read_b64_tr_b16 a[252:253], v2 offset:57352
 ds_read_b64_tr_b16 a[254:255], v3 offset:57352
 s_waitcnt lgkmcnt(0)
L_wl_done_40:
 s_barrier
 s_add_u32 m0, s21, 0
 s_add_u32 s65, s20, 0
 buffer_load_dwordx4 v1, s[12:15], s65 offen nt lds
 s_add_u32 m0, s21, 1024
 s_add_u32 s65, s20, 32768
 buffer_load_dwordx4 v1, s[12:15], s65 offen nt lds
 s_add_u32 m0, s21, 2048
 s_add_u32 s65, s20, 65536
 buffer_load_dwordx4 v1, s[12:15], s65 offen nt lds
 s_add_u32 m0, s21, 3072
 s_add_u32 s65, s20, 98304
 buffer_load_dwordx4 v1, s[12:15], s65 offen nt lds
 s_add_u32 m0, s21, 4096
 s_add_u32 s65, s20, 131072
 buffer_load_dwordx4 v1, s[12:15], s65 offen nt lds
 s_add_u32 m0, s21, 5120
 s_add_u32 s65, s20, 163840
 buffer_load_dwordx4 v1, s[12:15], s65 offen nt lds
 s_add_u32 m0, s21, 6144
 s_add_u32 s65, s20, 196608
 buffer_load_dwordx4 v1, s[12:15], s65 offen nt lds
 s_add_u32 m0, s21, 7168
 s_add_u32 s65, s20, 229376
 buffer_load_dwordx4 v1, s[12:15], s65 offen nt lds
 s_add_u32 m0, s21, 8192
 s_add_u32 s65, s20, 262144
 buffer_load_dwordx4 v1, s[12:15], s65 offen nt lds
 s_add_u32 m0, s21, 9216
 s_add_u32 s65, s20, 294912
 buffer_load_dwordx4 v1, s[12:15], s65 offen nt lds
 s_add_u32 m0, s21, 10240
 s_add_u32 s65, s20, 327680
 buffer_load_dwordx4 v1, s[12:15], s65 offen nt lds
 s_add_u32 m0, s21, 11264
 s_add_u32 s65, s20, 360448
 buffer_load_dwordx4 v1, s[12:15], s65 offen nt lds
 s_add_u32 m0, s21, 12288
 s_add_u32 s65, s20, 393216
 buffer_load_dwordx4 v1, s[12:15], s65 offen nt lds
 s_add_u32 m0, s21, 13312
 s_add_u32 s65, s20, 425984
 buffer_load_dwordx4 v1, s[12:15], s65 offen nt lds
 s_add_u32 m0, s21, 14336
 s_add_u32 s65, s20, 458752
 buffer_load_dwordx4 v1, s[12:15], s65 offen nt lds
 s_add_u32 m0, s21, 15360
 s_add_u32 s65, s20, 491520
 buffer_load_dwordx4 v1, s[12:15], s65 offen nt lds
 s_waitcnt vmcnt(16)
 s_barrier
 s_sub_u32 s68, 7, s62
 s_and_b32 s68, s68, 3
 s_cmp_eq_u32 s68, 0
 s_cbranch_scc0 L_wl_next_46
 ds_read_b64_tr_b16 a[8:9], v4 offset:8
 ds_read_b64_tr_b16 a[10:11], v5 offset:8
 ds_read_b64_tr_b16 a[12:13], v4 offset:8200
 ds_read_b64_tr_b16 a[14:15], v5 offset:8200
 ds_read_b64_tr_b16 a[24:25], v4 offset:16392
 ds_read_b64_tr_b16 a[26:27], v5 offset:16392
 ds_read_b64_tr_b16 a[28:29], v4 offset:24584
 ds_read_b64_tr_b16 a[30:31], v5 offset:24584
 ds_read_b64_tr_b16 a[40:41], v4 offset:32776
 ds_read_b64_tr_b16 a[42:43], v5 offset:32776
 ds_read_b64_tr_b16 a[44:45], v4 offset:40968
 ds_read_b64_tr_b16 a[46:47], v5 offset:40968
 ds_read_b64_tr_b16 a[56:57], v4 offset:49160
 ds_read_b64_tr_b16 a[58:59], v5 offset:49160
 ds_read_b64_tr_b16 a[60:61], v4 offset:57352
 ds_read_b64_tr_b16 a[62:63], v5 offset:57352
 s_waitcnt lgkmcnt(0)
 s_branch L_wl_done_45
L_wl_next_46:
 s_cmp_eq_u32 s68, 1
 s_cbranch_scc0 L_wl_next_47
 ds_read_b64_tr_b16 a[72:73], v4 offset:8
 ds_read_b64_tr_b16 a[74:75], v5 offset:8
 ds_read_b64_tr_b16 a[76:77], v4 offset:8200
 ds_read_b64_tr_b16 a[78:79], v5 offset:8200
 ds_read_b64_tr_b16 a[88:89], v4 offset:16392
 ds_read_b64_tr_b16 a[90:91], v5 offset:16392
 ds_read_b64_tr_b16 a[92:93], v4 offset:24584
 ds_read_b64_tr_b16 a[94:95], v5 offset:24584
 ds_read_b64_tr_b16 a[104:105], v4 offset:32776
 ds_read_b64_tr_b16 a[106:107], v5 offset:32776
 ds_read_b64_tr_b16 a[108:109], v4 offset:40968
 ds_read_b64_tr_b16 a[110:111], v5 offset:40968
 ds_read_b64_tr_b16 a[120:121], v4 offset:49160
 ds_read_b64_tr_b16 a[122:123], v5 offset:49160
 ds_read_b64_tr_b16 a[124:125], v4 offset:57352
 ds_read_b64_tr_b16 a[126:127], v5 offset:57352
 s_waitcnt lgkmcnt(0)
 s_branch L_wl_done_45
L_wl_next_47:
 s_cmp_eq_u32 s68, 2
 s_cbranch_scc0 L_wl_next_48
 ds_read_b64_tr_b16 a[136:137], v4 offset:8
 ds_read_b64_tr_b16 a[138:139], v5 offset:8
 ds_read_b64_tr_b16 a[140:141], v4 offset:8200
 ds_read_b64_tr_b16 a[142:143], v5 offset:8200
 ds_read_b64_tr_b16 a[152:153], v4 offset:16392
 ds_read_b64_tr_b16 a[154:155], v5 offset:16392
 ds_read_b64_tr_b16 a[156:157], v4 offset:24584
 ds_read_b64_tr_b16 a[158:159], v5 offset:24584
 ds_read_b64_tr_b16 a[168:169], v4 offset:32776
 ds_read_b64_tr_b16 a[170:171], v5 offset:32776
 ds_read_b64_tr_b16 a[172:173], v4 offset:40968
 ds_read_b64_tr_b16 a[174:175], v5 offset:40968
 ds_read_b64_tr_b16 a[184:185], v4 offset:49160
 ds_read_b64_tr_b16 a[186:187], v5 offset:49160
 ds_read_b64_tr_b16 a[188:189], v4 offset:57352
 ds_read_b64_tr_b16 a[190:191], v5 offset:57352
 s_waitcnt lgkmcnt(0)
 s_branch L_wl_done_45
L_wl_next_48:
 ds_read_b64_tr_b16 a[200:201], v4 offset:8
 ds_read_b64_tr_b16 a[202:203], v5 offset:8
 ds_read_b64_tr_b16 a[204:205], v4 offset:8200
 ds_read_b64_tr_b16 a[206:207], v5 offset:8200
 ds_read_b64_tr_b16 a[216:217], v4 offset:16392
 ds_read_b64_tr_b16 a[218:219], v5 offset:16392
 ds_read_b64_tr_b16 a[220:221], v4 offset:24584
 ds_read_b64_tr_b16 a[222:223], v5 offset:24584
 ds_read_b64_tr_b16 a[232:233], v4 offset:32776
 ds_read_b64_tr_b16 a[234:235], v5 offset:32776
 ds_read_b64_tr_b16 a[236:237], v4 offset:40968
 ds_read_b64_tr_b16 a[238:239], v5 offset:40968
 ds_read_b64_tr_b16 a[248:249], v4 offset:49160
 ds_read_b64_tr_b16 a[250:251], v5 offset:49160
 ds_read_b64_tr_b16 a[252:253], v4 offset:57352
 ds_read_b64_tr_b16 a[254:255], v5 offset:57352
 s_waitcnt lgkmcnt(0)
L_wl_done_45:
 s_barrier
 s_add_u32 m0, s21, 65536
 s_add_u32 s65, s20, 2097152
 buffer_load_dwordx4 v1, s[12:15], s65 offen nt lds
 s_add_u32 m0, s21, 66560
 s_add_u32 s65, s20, 2129920
 buffer_load_dwordx4 v1, s[12:15], s65 offen nt lds
 s_add_u32 m0, s21, 67584
 s_add_u32 s65, s20, 2162688
 buffer_load_dwordx4 v1, s[12:15], s65 offen nt lds
 s_add_u32 m0, s21, 68608
 s_add_u32 s65, s20, 2195456
 buffer_load_dwordx4 v1, s[12:15], s65 offen nt lds
 s_add_u32 m0, s21, 69632
 s_add_u32 s65, s20, 2228224
 buffer_load_dwordx4 v1, s[12:15], s65 offen nt lds
 s_add_u32 m0, s21, 70656
 s_add_u32 s65, s20, 2260992
 buffer_load_dwordx4 v1, s[12:15], s65 offen nt lds
 s_add_u32 m0, s21, 71680
 s_add_u32 s65, s20, 2293760
 buffer_load_dwordx4 v1, s[12:15], s65 offen nt lds
 s_add_u32 m0, s21, 72704
 s_add_u32 s65, s20, 2326528
 buffer_load_dwordx4 v1, s[12:15], s65 offen nt lds
 s_add_u32 m0, s21, 73728
 s_add_u32 s65, s20, 2359296
 buffer_load_dwordx4 v1, s[12:15], s65 offen nt lds
 s_add_u32 m0, s21, 74752
 s_add_u32 s65, s20, 2392064
 buffer_load_dwordx4 v1, s[12:15], s65 offen nt lds
 s_add_u32 m0, s21, 75776
 s_add_u32 s65, s20, 2424832
 buffer_load_dwordx4 v1, s[12:15], s65 offen nt lds
 s_add_u32 m0, s21, 76800
 s_add_u32 s65, s20, 2457600
 buffer_load_dwordx4 v1, s[12:15], s65 offen nt lds
 s_add_u32 m0, s21, 77824
 s_add_u32 s65, s20, 2490368
 buffer_load_dwordx4 v1, s[12:15], s65 offen nt lds
 s_add_u32 m0, s21, 78848
 s_add_u32 s65, s20, 2523136
 buffer_load_dwordx4 v1, s[12:15], s65 offen nt lds
 s_add_u32 m0, s21, 79872
 s_add_u32 s65, s20, 2555904
 buffer_load_dwordx4 v1, s[12:15], s65 offen nt lds
 s_add_u32 m0, s21, 80896
 s_add_u32 s65, s20, 2588672
 buffer_load_dwordx4 v1, s[12:15], s65 offen nt lds
 s_waitcnt vmcnt(16)
 s_barrier
 s_sub_u32 s68, 4, s62
 s_and_b32 s68, s68, 3
 s_cmp_eq_u32 s68, 0
 s_cbranch_scc0 L_wl_next_51
 ds_read_b64_tr_b16 a[8:9], v2 offset:8
 ds_read_b64_tr_b16 a[10:11], v3 offset:8
 ds_read_b64_tr_b16 a[12:13], v2 offset:8200
 ds_read_b64_tr_b16 a[14:15], v3 offset:8200
 ds_read_b64_tr_b16 a[24:25], v2 offset:16392
 ds_read_b64_tr_b16 a[26:27], v3 offset:16392
 ds_read_b64_tr_b16 a[28:29], v2 offset:24584
 ds_read_b64_tr_b16 a[30:31], v3 offset:24584
 ds_read_b64_tr_b16 a[40:41], v2 offset:32776
 ds_read_b64_tr_b16 a[42:43], v3 offset:32776
 ds_read_b64_tr_b16 a[44:45], v2 offset:40968
 ds_read_b64_tr_b16 a[46:47], v3 offset:40968
 ds_read_b64_tr_b16 a[56:57], v2 offset:49160
 ds_read_b64_tr_b16 a[58:59], v3 offset:49160
 ds_read_b64_tr_b16 a[60:61], v2 offset:57352
 ds_read_b64_tr_b16 a[62:63], v3 offset:57352
 s_waitcnt lgkmcnt(0)
 s_branch L_wl_done_50
L_wl_next_51:
 s_cmp_eq_u32 s68, 1
 s_cbranch_scc0 L_wl_next_52
 ds_read_b64_tr_b16 a[72:73], v2 offset:8
 ds_read_b64_tr_b16 a[74:75], v3 offset:8
 ds_read_b64_tr_b16 a[76:77], v2 offset:8200
 ds_read_b64_tr_b16 a[78:79], v3 offset:8200
 ds_read_b64_tr_b16 a[88:89], v2 offset:16392
 ds_read_b64_tr_b16 a[90:91], v3 offset:16392
 ds_read_b64_tr_b16 a[92:93], v2 offset:24584
 ds_read_b64_tr_b16 a[94:95], v3 offset:24584
 ds_read_b64_tr_b16 a[104:105], v2 offset:32776
 ds_read_b64_tr_b16 a[106:107], v3 offset:32776
 ds_read_b64_tr_b16 a[108:109], v2 offset:40968
 ds_read_b64_tr_b16 a[110:111], v3 offset:40968
 ds_read_b64_tr_b16 a[120:121], v2 offset:49160
 ds_read_b64_tr_b16 a[122:123], v3 offset:49160
 ds_read_b64_tr_b16 a[124:125], v2 offset:57352
 ds_read_b64_tr_b16 a[126:127], v3 offset:57352
 s_waitcnt lgkmcnt(0)
 s_branch L_wl_done_50
L_wl_next_52:
 s_cmp_eq_u32 s68, 2
 s_cbranch_scc0 L_wl_next_53
 ds_read_b64_tr_b16 a[136:137], v2 offset:8
 ds_read_b64_tr_b16 a[138:139], v3 offset:8
 ds_read_b64_tr_b16 a[140:141], v2 offset:8200
 ds_read_b64_tr_b16 a[142:143], v3 offset:8200
 ds_read_b64_tr_b16 a[152:153], v2 offset:16392
 ds_read_b64_tr_b16 a[154:155], v3 offset:16392
 ds_read_b64_tr_b16 a[156:157], v2 offset:24584
 ds_read_b64_tr_b16 a[158:159], v3 offset:24584
 ds_read_b64_tr_b16 a[168:169], v2 offset:32776
 ds_read_b64_tr_b16 a[170:171], v3 offset:32776
 ds_read_b64_tr_b16 a[172:173], v2 offset:40968
 ds_read_b64_tr_b16 a[174:175], v3 offset:40968
 ds_read_b64_tr_b16 a[184:185], v2 offset:49160
 ds_read_b64_tr_b16 a[186:187], v3 offset:49160
 ds_read_b64_tr_b16 a[188:189], v2 offset:57352
 ds_read_b64_tr_b16 a[190:191], v3 offset:57352
 s_waitcnt lgkmcnt(0)
 s_branch L_wl_done_50
L_wl_next_53:
 ds_read_b64_tr_b16 a[200:201], v2 offset:8
 ds_read_b64_tr_b16 a[202:203], v3 offset:8
 ds_read_b64_tr_b16 a[204:205], v2 offset:8200
 ds_read_b64_tr_b16 a[206:207], v3 offset:8200
 ds_read_b64_tr_b16 a[216:217], v2 offset:16392
 ds_read_b64_tr_b16 a[218:219], v3 offset:16392
 ds_read_b64_tr_b16 a[220:221], v2 offset:24584
 ds_read_b64_tr_b16 a[222:223], v3 offset:24584
 ds_read_b64_tr_b16 a[232:233], v2 offset:32776
 ds_read_b64_tr_b16 a[234:235], v3 offset:32776
 ds_read_b64_tr_b16 a[236:237], v2 offset:40968
 ds_read_b64_tr_b16 a[238:239], v3 offset:40968
 ds_read_b64_tr_b16 a[248:249], v2 offset:49160
 ds_read_b64_tr_b16 a[250:251], v3 offset:49160
 ds_read_b64_tr_b16 a[252:253], v2 offset:57352
 ds_read_b64_tr_b16 a[254:255], v3 offset:57352
 s_waitcnt lgkmcnt(0)
L_wl_done_50:
 s_barrier
 s_waitcnt vmcnt(0)
 s_barrier
 s_sub_u32 s68, 5, s62
 s_and_b32 s68, s68, 3
 s_cmp_eq_u32 s68, 0
 s_cbranch_scc0 L_wl_next_56
 ds_read_b64_tr_b16 a[8:9], v4 offset:8
 ds_read_b64_tr_b16 a[10:11], v5 offset:8
 ds_read_b64_tr_b16 a[12:13], v4 offset:8200
 ds_read_b64_tr_b16 a[14:15], v5 offset:8200
 ds_read_b64_tr_b16 a[24:25], v4 offset:16392
 ds_read_b64_tr_b16 a[26:27], v5 offset:16392
 ds_read_b64_tr_b16 a[28:29], v4 offset:24584
 ds_read_b64_tr_b16 a[30:31], v5 offset:24584
 ds_read_b64_tr_b16 a[40:41], v4 offset:32776
 ds_read_b64_tr_b16 a[42:43], v5 offset:32776
 ds_read_b64_tr_b16 a[44:45], v4 offset:40968
 ds_read_b64_tr_b16 a[46:47], v5 offset:40968
 ds_read_b64_tr_b16 a[56:57], v4 offset:49160
 ds_read_b64_tr_b16 a[58:59], v5 offset:49160
 ds_read_b64_tr_b16 a[60:61], v4 offset:57352
 ds_read_b64_tr_b16 a[62:63], v5 offset:57352
 s_waitcnt lgkmcnt(0)
 s_branch L_wl_done_55
L_wl_next_56:
 s_cmp_eq_u32 s68, 1
 s_cbranch_scc0 L_wl_next_57
 ds_read_b64_tr_b16 a[72:73], v4 offset:8
 ds_read_b64_tr_b16 a[74:75], v5 offset:8
 ds_read_b64_tr_b16 a[76:77], v4 offset:8200
 ds_read_b64_tr_b16 a[78:79], v5 offset:8200
 ds_read_b64_tr_b16 a[88:89], v4 offset:16392
 ds_read_b64_tr_b16 a[90:91], v5 offset:16392
 ds_read_b64_tr_b16 a[92:93], v4 offset:24584
 ds_read_b64_tr_b16 a[94:95], v5 offset:24584
 ds_read_b64_tr_b16 a[104:105], v4 offset:32776
 ds_read_b64_tr_b16 a[106:107], v5 offset:32776
 ds_read_b64_tr_b16 a[108:109], v4 offset:40968
 ds_read_b64_tr_b16 a[110:111], v5 offset:40968
 ds_read_b64_tr_b16 a[120:121], v4 offset:49160
 ds_read_b64_tr_b16 a[122:123], v5 offset:49160
 ds_read_b64_tr_b16 a[124:125], v4 offset:57352
 ds_read_b64_tr_b16 a[126:127], v5 offset:57352
 s_waitcnt lgkmcnt(0)
 s_branch L_wl_done_55
L_wl_next_57:
 s_cmp_eq_u32 s68, 2
 s_cbranch_scc0 L_wl_next_58
 ds_read_b64_tr_b16 a[136:137], v4 offset:8
 ds_read_b64_tr_b16 a[138:139], v5 offset:8
 ds_read_b64_tr_b16 a[140:141], v4 offset:8200
 ds_read_b64_tr_b16 a[142:143], v5 offset:8200
 ds_read_b64_tr_b16 a[152:153], v4 offset:16392
 ds_read_b64_tr_b16 a[154:155], v5 offset:16392
 ds_read_b64_tr_b16 a[156:157], v4 offset:24584
 ds_read_b64_tr_b16 a[158:159], v5 offset:24584
 ds_read_b64_tr_b16 a[168:169], v4 offset:32776
 ds_read_b64_tr_b16 a[170:171], v5 offset:32776
 ds_read_b64_tr_b16 a[172:173], v4 offset:40968
 ds_read_b64_tr_b16 a[174:175], v5 offset:40968
 ds_read_b64_tr_b16 a[184:185], v4 offset:49160
 ds_read_b64_tr_b16 a[186:187], v5 offset:49160
 ds_read_b64_tr_b16 a[188:189], v4 offset:57352
 ds_read_b64_tr_b16 a[190:191], v5 offset:57352
 s_waitcnt lgkmcnt(0)
 s_branch L_wl_done_55
L_wl_next_58:
 ds_read_b64_tr_b16 a[200:201], v4 offset:8
 ds_read_b64_tr_b16 a[202:203], v5 offset:8
 ds_read_b64_tr_b16 a[204:205], v4 offset:8200
 ds_read_b64_tr_b16 a[206:207], v5 offset:8200
 ds_read_b64_tr_b16 a[216:217], v4 offset:16392
 ds_read_b64_tr_b16 a[218:219], v5 offset:16392
 ds_read_b64_tr_b16 a[220:221], v4 offset:24584
 ds_read_b64_tr_b16 a[222:223], v5 offset:24584
 ds_read_b64_tr_b16 a[232:233], v4 offset:32776
 ds_read_b64_tr_b16 a[234:235], v5 offset:32776
 ds_read_b64_tr_b16 a[236:237], v4 offset:40968
 ds_read_b64_tr_b16 a[238:239], v5 offset:40968
 ds_read_b64_tr_b16 a[248:249], v4 offset:49160
 ds_read_b64_tr_b16 a[250:251], v5 offset:49160
 ds_read_b64_tr_b16 a[252:253], v4 offset:57352
 ds_read_b64_tr_b16 a[254:255], v5 offset:57352
 s_waitcnt lgkmcnt(0)
L_wl_done_55:
 s_barrier
 s_lshl_b32 s65, s60, 15
 s_lshl_b32 s66, s84, 10
 s_add_u32 s65, s65, s66
 s_add_u32 s66, s65, 0x6200000
 buffer_load_dword v252, v84, s[4:7], s66 offen sc1
 s_add_u32 s66, s65, 0x6240000
 buffer_load_dword v253, v84, s[4:7], s66 offen sc1
 s_add_u32 s66, s65, 0x6280000
 buffer_load_dword v254, v84, s[4:7], s66 offen sc1
 s_lshl_b32 s66, s65, 1
 s_add_u32 s67, s66, 0x6100000
 buffer_load_dword v255, v84, s[4:7], s67 offen offset:0 sc1
 buffer_load_dword v255, v84, s[4:7], s67 offen offset:1024 sc1
 s_add_u32 s67, s66, 0x6400000
 buffer_load_dword v255, v84, s[4:7], s67 offen offset:0 sc1
 buffer_load_dword v255, v84, s[4:7], s67 offen offset:1024 sc1
 s_lshr_b32 s66, s65, 1
 s_and_b32 s66, s66, 0xfffffc00
 s_add_u32 s67, s66, 0x6300000
 buffer_load_dword v255, v84, s[4:7], s67 offen sc1
 v_lshlrev_b32 v80, 2, v0
 s_lshr_b32 s66, s101, 2
 s_add_u32 s66, s66, 1
 s_branch L_hs1_61
L_hs_60:
 s_sleep 8
 s_sub_u32 s63, s63, 1
 s_cbranch_scc1 L_role_t_0_abort
L_hs1_61:
 buffer_load_dword v81, v80, s[16:19], 0 offen sc1
 s_waitcnt vmcnt(0)
 v_readlane_b32 s65, v81, s66
 s_cmp_eq_u32 s101, 128
 s_cbranch_scc1 L_hs2_62
 s_cmp_eq_u32 s101, 64
 s_cbranch_scc1 L_hs3_63
 v_readlane_b32 s67, v81, 9
 v_cmp_eq_u32 s[96:97], -1, v81
 s_mov_b32 vcc_lo, 0x20202020
 s_mov_b32 vcc_hi, 0x20202020
 s_nop 1
 s_cmp_lg_u32 s67, 0
 s_cbranch_scc1 L_retry
 s_andn2_b64 s[96:97], vcc, s[96:97]
 s_cbranch_scc1 L_hs_60
 s_branch L_hs2_62
L_hs3_63:
 v_readlane_b32 s67, v81, 10
 v_cmp_eq_u32 s[96:97], 32, v81
 s_mov_b32 vcc_lo, 0x01010101
 s_mov_b32 vcc_hi, 0x01010101
 s_nop 1
 s_cmp_lg_u32 s67, 0
 s_cbranch_scc1 L_fallback
 s_andn2_b64 s[96:97], vcc, s[96:97]
 s_cbranch_scc1 L_hs_60
L_hs2_62:
 s_cmp_ge_u32 s65, 64
 s_cbranch_scc0 L_hs_60
 s_lshl_b32 s67, s60, 3
 s_add_u32 s67, s67, 6
 s_lshr_b32 s65, s101, 7
 s_add_u32 s67, s67, s65
 v_readlane_b32 s65, v81, s67
 s_nop 3
 s_cmp_eq_u32 s65, 0
 s_cbranch_scc1 L_hs_60
 s_and_b32 s65, s65, 2
 s_lshl_b32 s65, s65, 12
 s_add_u32 s85, s85, s65
 s_cmp_lt_u32 s61, 24
 s_cselect_b32 s65, 1, 2
 s_cselect_b32 s93, 0, 1
 s_cselect_b32 s28, 63, 64
 s_cselect_b32 s29, 12, 14
 s_cmp_lt_u32 s62, s65
 s_cselect_b32 s93, s93, 2
 s_cmp_eq_u32 s62, 3
 s_cselect_b32 s93, 3, s93
 v_lshrrev_b32 v82, 4, v0
 v_lshlrev_b32 v82, 9, v82
 v_cmp_le_i32 s[40:41], 0, v186
 v_cmp_le_i32 s[42:43], 1, v186
 v_cmp_le_i32 s[44:45], 2, v186
 v_cmp_le_i32 s[46:47], 3, v186
 v_cmp_le_i32 s[48:49], 16, v186
 v_cmp_le_i32 s[50:51], 17, v186
 v_cmp_le_i32 s[52:53], 18, v186
 v_cmp_le_i32 s[54:55], 19, v186
 s_mov_b32 s64, -1
 s_add_u32 s65, s64, 0
 s_and_b32 s65, s65, 3
 s_lshl_b32 s66, s65, 11
 s_add_u32 s78, s66, s72
 s_add_u32 s79, s66, s73
 s_lshl_b32 s80, s65, s29
 s_xor_b32 s65, s65, 2
 s_lshl_b32 s81, s65, s29
 s_add_u32 s80, s80, s76
 s_add_u32 s81, s81, s76
 s_cmp_ge_u32 s93, 2
 s_cbranch_scc1 L_t_go_70
 s_branch L_pfirst_73
L_poll_72:
 s_sleep 4
 s_sub_u32 s63, s63, 1
 s_cbranch_scc1 L_role_t_0_abort
L_pfirst_73:
 buffer_load_dwordx4 v[8:11], v85, s[4:7], s79 offen offset:0 sc1
 buffer_load_dwordx4 v[12:15], v85, s[4:7], s79 offen offset:512 sc1
 buffer_load_dwordx4 v[16:19], v85, s[4:7], s79 offen offset:1024 sc1
 buffer_load_dwordx4 v[20:23], v85, s[4:7], s79 offen offset:1536 sc1
 buffer_load_dword v24, v82, s[4:7], s78 offen sc1
 s_waitcnt vmcnt(0)
 v_max3_u32 v83, v8, v10, v12
 v_max3_u32 v83, v83, v14, v16
 v_max3_u32 v83, v83, v18, v20
 v_max3_u32 v83, v83, v22, v24
 v_cmp_eq_u32 vcc, -1, v83
 s_cbranch_vccnz L_poll_72
 s_cmp_eq_u32 s93, 1
 s_cbranch_scc1 L_t_px0_71
 s_add_u32 s65, s64, 1
 s_and_b32 s65, s65, 3
 s_lshl_b32 s65, s65, 13
 s_add_u32 s66, s65, s75
 s_add_u32 s67, s66, 4096
 buffer_load_dwordx4 v[96:99], v84, s[4:7], s66 offen offset:0 sc1
 buffer_load_dwordx4 v[100:103], v84, s[4:7], s66 offen offset:1024 sc1
 buffer_load_dwordx4 v[104:107], v84, s[4:7], s66 offen offset:2048 sc1
 buffer_load_dwordx4 v[108:111], v84, s[4:7], s66 offen offset:3072 sc1
 buffer_load_dwordx4 v[112:115], v84, s[4:7], s67 offen offset:0 sc1
 buffer_load_dwordx4 v[116:119], v84, s[4:7], s67 offen offset:1024 sc1
 buffer_load_dwordx4 v[120:123], v84, s[4:7], s67 offen offset:2048 sc1
 buffer_load_dwordx4 v[124:127], v84, s[4:7], s67 offen offset:3072 sc1
 s_branch L_t_go_70
L_t_px0_71:
 s_add_u32 s65, s64, 1
 s_and_b32 s65, s65, 3
 s_lshl_b32 s65, s65, 13
 s_add_u32 s66, s65, s75
 s_add_u32 s67, s66, 4096
 buffer_load_dwordx4 v[96:99], v84, s[4:7], s66 offen offset:0 sc1
 buffer_load_dwordx4 v[100:103], v84, s[4:7], s66 offen offset:1024 sc1
 buffer_load_dwordx4 v[104:107], v84, s[4:7], s66 offen offset:2048 sc1
 buffer_load_dwordx4 v[108:111], v84, s[4:7], s66 offen offset:3072 sc1
 buffer_load_dwordx4 v[112:115], v84, s[4:7], s67 offen offset:0 sc1
 buffer_load_dwordx4 v[116:119], v84, s[4:7], s67 offen offset:1024 sc1
 buffer_load_dwordx4 v[120:123], v84, s[4:7], s67 offen offset:2048 sc1
 buffer_load_dwordx4 v[124:127], v84, s[4:7], s67 offen offset:3072 sc1
 s_add_u32 s65, s65, s74
 buffer_load_dwordx4 v[128:131], v84, s[4:7], s65 offen offset:0 sc1
 buffer_load_dwordx4 v[132:135], v84, s[4:7], s65 offen offset:1024 sc1
 buffer_load_dwordx4 v[136:139], v84, s[4:7], s65 offen offset:2048 sc1
 buffer_load_dwordx4 v[140:143], v84, s[4:7], s65 offen offset:3072 sc1
 s_waitcnt vmcnt(3)
 v_mfma_f32_16x16x32_bf16 v[144:147], v[96:99], v[128:131], 0
 s_waitcnt vmcnt(2)
 v_mfma_f32_16x16x32_bf16 v[144:147], v[100:103], v[132:135], v[144:147]
 s_waitcnt vmcnt(1)
 v_mfma_f32_16x16x32_bf16 v[144:147], v[104:107], v[136:139], v[144:147]
 s_waitcnt vmcnt(0)
 v_mfma_f32_16x16x32_bf16 v[144:147], v[108:111], v[140:143], v[144:147]
 v_mfma_f32_16x16x32_bf16 v[148:151], v[112:115], v[128:131], 0
 v_mfma_f32_16x16x32_bf16 v[148:151], v[116:119], v[132:135], v[148:151]
 v_mfma_f32_16x16x32_bf16 v[148:151], v[120:123], v[136:139], v[148:151]
 v_mfma_f32_16x16x32_bf16 v[148:151], v[124:127], v[140:143], v[148:151]
 s_nop 3
 v_cndmask_b32 v144, v185, v144, s[40:41]
 v_cndmask_b32 v145, v185, v145, s[42:43]
 v_cndmask_b32 v146, v185, v146, s[44:45]
 v_cndmask_b32 v147, v185, v147, s[46:47]
 v_cndmask_b32 v148, v185, v148, s[48:49]
 v_cndmask_b32 v149, v185, v149, s[50:51]
 v_cndmask_b32 v150, v185, v150, s[52:53]
 v_cndmask_b32 v151, v185, v151, s[54:55]
L_t_go_70:
 s_mov_b32 s64, 0
 s_add_u32 s20, s64, 0
 s_and_b32 s20, s20, 3
 s_lshl_b32 s20, s20, 14
 s_add_u32 s20, s20, s23
 s_add_u32 s25, s64, 0
 s_and_b32 s25, s25, 3
 s_lshl_b32 s26, s25, 11
 s_xor_b32 s25, s26, 4096
 s_add_u32 s26, s26, s22
 s_add_u32 s25, s25, s22
 v_mov_b64 v[156:157], 0
 v_mov_b64 v[158:159], 0
 v_mov_b64 v[160:161], 0
 v_mov_b64 v[162:163], 0
 s_add_u32 s65, s64, 0
 s_and_b32 s65, s65, 3
 s_lshl_b32 s66, s65, 11
 s_add_u32 s78, s66, s72
 s_add_u32 s79, s66, s73
 s_lshl_b32 s80, s65, s29
 s_xor_b32 s65, s65, 2
 s_lshl_b32 s81, s65, s29
 s_add_u32 s80, s80, s76
 s_add_u32 s81, s81, s76
L_t_loop_64:
 s_nop 15
 s_nop 3
 buffer_load_dwordx4 v[212:215], v191, s[4:7], s20 offen offset:0 sc1
 buffer_load_dwordx4 v[216:219], v191, s[4:7], s20 offen offset:1024 sc1
 buffer_load_dwordx4 v[220:223], v191, s[4:7], s20 offen offset:2048 sc1
 buffer_load_dwordx4 v[224:227], v191, s[4:7], s20 offen offset:3072 sc1
L_t_loop2_74:
 s_branch L_pq_75_0123
L_pq_75_0123f:
 buffer_load_dwordx4 v[212:215], v191, s[4:7], s20 offen offset:0 sc1
 s_sub_u32 s63, s63, 1
 s_cbranch_scc1 L_role_t_0_abort
L_pq_75_1230:
 s_waitcnt vmcnt(3)
 v_max_u32 v234, v216, v218
 v_cmp_eq_u32 vcc, -1, v234
 ds_write_b128 v200, v[216:219] offset:1024
 s_cbranch_vccnz L_pq_75_1230f
L_pq_75_230:
 s_waitcnt vmcnt(2)
 v_max_u32 v234, v220, v222
 v_cmp_eq_u32 vcc, -1, v234
 ds_write_b128 v200, v[220:223] offset:2048
 s_cbranch_vccnz L_pq_75_230f
L_pq_75_30:
 s_waitcnt vmcnt(1)
 v_max_u32 v234, v224, v226
 v_cmp_eq_u32 vcc, -1, v234
 ds_write_b128 v200, v[224:227] offset:3072
 s_cbranch_vccnz L_pq_75_30f
L_pq_75_0:
 buffer_load_dwordx4 v[212:215], v191, s[4:7], s20 offen offset:0 sc1
 s_sub_u32 s63, s63, 1
 s_cbranch_scc1 L_role_t_0_abort
 s_waitcnt vmcnt(1)
 v_max_u32 v234, v212, v214
 v_cmp_eq_u32 vcc, -1, v234
 ds_write_b128 v200, v[212:215] offset:0
 s_cbranch_vccnz L_pq_75_0
 s_branch L_pq_75_done
L_pq_75_1230f:
 buffer_load_dwordx4 v[216:219], v191, s[4:7], s20 offen offset:1024 sc1
L_pq_75_2301:
 s_waitcnt vmcnt(3)
 v_max_u32 v234, v220, v222
 v_cmp_eq_u32 vcc, -1, v234
 ds_write_b128 v200, v[220:223] offset:2048
 s_cbranch_vccnz L_pq_75_2301f
L_pq_75_301:
 s_waitcnt vmcnt(2)
 v_max_u32 v234, v224, v226
 v_cmp_eq_u32 vcc, -1, v234
 ds_write_b128 v200, v[224:227] offset:3072
 s_cbranch_vccnz L_pq_75_301f
L_pq_75_01:
 s_waitcnt vmcnt(1)
 v_max_u32 v234, v212, v214
 v_cmp_eq_u32 vcc, -1, v234
 ds_write_b128 v200, v[212:215] offset:0
 s_cbranch_vccnz L_pq_75_01f
L_pq_75_1:
 buffer_load_dwordx4 v[216:219], v191, s[4:7], s20 offen offset:1024 sc1
 s_sub_u32 s63, s63, 1
 s_cbranch_scc1 L_role_t_0_abort
 s_waitcnt vmcnt(1)
 v_max_u32 v234, v216, v218
 v_cmp_eq_u32 vcc, -1, v234
 ds_write_b128 v200, v[216:219] offset:1024
 s_cbranch_vccnz L_pq_75_1
 s_branch L_pq_75_done
L_pq_75_2301f:
 buffer_load_dwordx4 v[220:223], v191, s[4:7], s20 offen offset:2048 sc1
L_pq_75_3012:
 s_waitcnt vmcnt(3)
 v_max_u32 v234, v224, v226
 v_cmp_eq_u32 vcc, -1, v234
 ds_write_b128 v200, v[224:227] offset:3072
 s_cbranch_vccnz L_pq_75_3012f
L_pq_75_012:
 s_waitcnt vmcnt(2)
 v_max_u32 v234, v212, v214
 v_cmp_eq_u32 vcc, -1, v234
 ds_write_b128 v200, v[212:215] offset:0
 s_cbranch_vccnz L_pq_75_012f
L_pq_75_12:
 s_waitcnt vmcnt(1)
 v_max_u32 v234, v216, v218
 v_cmp_eq_u32 vcc, -1, v234
 ds_write_b128 v200, v[216:219] offset:1024
 s_cbranch_vccnz L_pq_75_12f
L_pq_75_2:
 buffer_load_dwordx4 v[220:223], v191, s[4:7], s20 offen offset:2048 sc1
 s_sub_u32 s63, s63, 1
 s_cbranch_scc1 L_role_t_0_abort
 s_waitcnt vmcnt(1)
 v_max_u32 v234, v220, v222
 v_cmp_eq_u32 vcc, -1, v234
 ds_write_b128 v200, v[220:223] offset:2048
 s_cbranch_vccnz L_pq_75_2
 s_branch L_pq_75_done
L_pq_75_3012f:
 buffer_load_dwordx4 v[224:227], v191, s[4:7], s20 offen offset:3072 sc1
 s_branch L_pq_75_0123
L_pq_75_012f:
 buffer_load_dwordx4 v[212:215], v191, s[4:7], s20 offen offset:0 sc1
 s_sub_u32 s63, s63, 1
 s_cbranch_scc1 L_role_t_0_abort
L_pq_75_120:
 s_waitcnt vmcnt(2)
 v_max_u32 v234, v216, v218
 v_cmp_eq_u32 vcc, -1, v234
 ds_write_b128 v200, v[216:219] offset:1024
 s_cbranch_vccnz L_pq_75_120f
L_pq_75_20:
 s_waitcnt vmcnt(1)
 v_max_u32 v234, v220, v222
 v_cmp_eq_u32 vcc, -1, v234
 ds_write_b128 v200, v[220:223] offset:2048
 s_cbranch_vccnz L_pq_75_20f
 s_branch L_pq_75_0
L_pq_75_120f:
 buffer_load_dwordx4 v[216:219], v191, s[4:7], s20 offen offset:1024 sc1
L_pq_75_201:
 s_waitcnt vmcnt(2)
 v_max_u32 v234, v220, v222
 v_cmp_eq_u32 vcc, -1, v234
 ds_write_b128 v200, v[220:223] offset:2048
 s_cbranch_vccnz L_pq_75_201f
 s_branch L_pq_75_01
L_pq_75_201f:
 buffer_load_dwordx4 v[220:223], v191, s[4:7], s20 offen offset:2048 sc1
 s_branch L_pq_75_012
L_pq_75_013f:
 buffer_load_dwordx4 v[212:215], v191, s[4:7], s20 offen offset:0 sc1
 s_sub_u32 s63, s63, 1
 s_cbranch_scc1 L_role_t_0_abort
L_pq_75_130:
 s_waitcnt vmcnt(2)
 v_max_u32 v234, v216, v218
 v_cmp_eq_u32 vcc, -1, v234
 ds_write_b128 v200, v[216:219] offset:1024
 s_cbranch_vccnz L_pq_75_130f
 s_branch L_pq_75_30
L_pq_75_130f:
 buffer_load_dwordx4 v[216:219], v191, s[4:7], s20 offen offset:1024 sc1
 s_branch L_pq_75_301
L_pq_75_301f:
 buffer_load_dwordx4 v[224:227], v191, s[4:7], s20 offen offset:3072 sc1
L_pq_75_013:
 s_waitcnt vmcnt(2)
 v_max_u32 v234, v212, v214
 v_cmp_eq_u32 vcc, -1, v234
 ds_write_b128 v200, v[212:215] offset:0
 s_cbranch_vccnz L_pq_75_013f
L_pq_75_13:
 s_waitcnt vmcnt(1)
 v_max_u32 v234, v216, v218
 v_cmp_eq_u32 vcc, -1, v234
 ds_write_b128 v200, v[216:219] offset:1024
 s_cbranch_vccnz L_pq_75_13f
 s_branch L_pq_75_3
L_pq_75_023f:
 buffer_load_dwordx4 v[212:215], v191, s[4:7], s20 offen offset:0 sc1
 s_sub_u32 s63, s63, 1
 s_cbranch_scc1 L_role_t_0_abort
 s_branch L_pq_75_230
L_pq_75_230f:
 buffer_load_dwordx4 v[220:223], v191, s[4:7], s20 offen offset:2048 sc1
L_pq_75_302:
 s_waitcnt vmcnt(2)
 v_max_u32 v234, v224, v226
 v_cmp_eq_u32 vcc, -1, v234
 ds_write_b128 v200, v[224:227] offset:3072
 s_cbranch_vccnz L_pq_75_302f
L_pq_75_02:
 s_waitcnt vmcnt(1)
 v_max_u32 v234, v212, v214
 v_cmp_eq_u32 vcc, -1, v234
 ds_write_b128 v200, v[212:215] offset:0
 s_cbranch_vccnz L_pq_75_02f
 s_branch L_pq_75_2
L_pq_75_302f:
 buffer_load_dwordx4 v[224:227], v191, s[4:7], s20 offen offset:3072 sc1
L_pq_75_023:
 s_waitcnt vmcnt(2)
 v_max_u32 v234, v212, v214
 v_cmp_eq_u32 vcc, -1, v234
 ds_write_b128 v200, v[212:215] offset:0
 s_cbranch_vccnz L_pq_75_023f
 s_branch L_pq_75_23
L_pq_75_123f:
 buffer_load_dwordx4 v[216:219], v191, s[4:7], s20 offen offset:1024 sc1
 s_sub_u32 s63, s63, 1
 s_cbranch_scc1 L_role_t_0_abort
L_pq_75_231:
 s_waitcnt vmcnt(2)
 v_max_u32 v234, v220, v222
 v_cmp_eq_u32 vcc, -1, v234
 ds_write_b128 v200, v[220:223] offset:2048
 s_cbranch_vccnz L_pq_75_231f
L_pq_75_31:
 s_waitcnt vmcnt(1)
 v_max_u32 v234, v224, v226
 v_cmp_eq_u32 vcc, -1, v234
 ds_write_b128 v200, v[224:227] offset:3072
 s_cbranch_vccnz L_pq_75_31f
 s_branch L_pq_75_1
L_pq_75_231f:
 buffer_load_dwordx4 v[220:223], v191, s[4:7], s20 offen offset:2048 sc1
L_pq_75_312:
 s_waitcnt vmcnt(2)
 v_max_u32 v234, v224, v226
 v_cmp_eq_u32 vcc, -1, v234
 ds_write_b128 v200, v[224:227] offset:3072
 s_cbranch_vccnz L_pq_75_312f
 s_branch L_pq_75_12
L_pq_75_312f:
 buffer_load_dwordx4 v[224:227], v191, s[4:7], s20 offen offset:3072 sc1
 s_branch L_pq_75_123
L_pq_75_01f:
 buffer_load_dwordx4 v[212:215], v191, s[4:7], s20 offen offset:0 sc1
 s_sub_u32 s63, s63, 1
 s_cbranch_scc1 L_role_t_0_abort
L_pq_75_10:
 s_waitcnt vmcnt(1)
 v_max_u32 v234, v216, v218
 v_cmp_eq_u32 vcc, -1, v234
 ds_write_b128 v200, v[216:219] offset:1024
 s_cbranch_vccnz L_pq_75_10f
 s_branch L_pq_75_0
L_pq_75_10f:
 buffer_load_dwordx4 v[216:219], v191, s[4:7], s20 offen offset:1024 sc1
 s_branch L_pq_75_01
L_pq_75_02f:
 buffer_load_dwordx4 v[212:215], v191, s[4:7], s20 offen offset:0 sc1
 s_sub_u32 s63, s63, 1
 s_cbranch_scc1 L_role_t_0_abort
 s_branch L_pq_75_20
L_pq_75_20f:
 buffer_load_dwordx4 v[220:223], v191, s[4:7], s20 offen offset:2048 sc1
 s_branch L_pq_75_02
L_pq_75_03f:
 buffer_load_dwordx4 v[212:215], v191, s[4:7], s20 offen offset:0 sc1
 s_sub_u32 s63, s63, 1
 s_cbranch_scc1 L_role_t_0_abort
 s_branch L_pq_75_30
L_pq_75_30f:
 buffer_load_dwordx4 v[224:227], v191, s[4:7], s20 offen offset:3072 sc1
L_pq_75_03:
 s_waitcnt vmcnt(1)
 v_max_u32 v234, v212, v214
 v_cmp_eq_u32 vcc, -1, v234
 ds_write_b128 v200, v[212:215] offset:0
 s_cbranch_vccnz L_pq_75_03f
 s_branch L_pq_75_3
L_pq_75_12f:
 buffer_load_dwordx4 v[216:219], v191, s[4:7], s20 offen offset:1024 sc1
 s_sub_u32 s63, s63, 1
 s_cbranch_scc1 L_role_t_0_abort
L_pq_75_21:
 s_waitcnt vmcnt(1)
 v_max_u32 v234, v220, v222
 v_cmp_eq_u32 vcc, -1, v234
 ds_write_b128 v200, v[220:223] offset:2048
 s_cbranch_vccnz L_pq_75_21f
 s_branch L_pq_75_1
L_pq_75_21f:
 buffer_load_dwordx4 v[220:223], v191, s[4:7], s20 offen offset:2048 sc1
 s_branch L_pq_75_12
L_pq_75_13f:
 buffer_load_dwordx4 v[216:219], v191, s[4:7], s20 offen offset:1024 sc1
 s_sub_u32 s63, s63, 1
 s_cbranch_scc1 L_role_t_0_abort
 s_branch L_pq_75_31
L_pq_75_31f:
 buffer_load_dwordx4 v[224:227], v191, s[4:7], s20 offen offset:3072 sc1
 s_branch L_pq_75_13
L_pq_75_23f:
 buffer_load_dwordx4 v[220:223], v191, s[4:7], s20 offen offset:2048 sc1
 s_sub_u32 s63, s63, 1
 s_cbranch_scc1 L_role_t_0_abort
L_pq_75_32:
 s_waitcnt vmcnt(1)
 v_max_u32 v234, v224, v226
 v_cmp_eq_u32 vcc, -1, v234
 ds_write_b128 v200, v[224:227] offset:3072
 s_cbranch_vccnz L_pq_75_32f
 s_branch L_pq_75_2
L_pq_75_32f:
 buffer_load_dwordx4 v[224:227], v191, s[4:7], s20 offen offset:3072 sc1
 s_branch L_pq_75_23
.p2align 6
L_pq_75_0123:
 s_waitcnt vmcnt(3)
 v_max_u32 v234, v212, v214
 v_cmp_eq_u32 vcc, -1, v234
 ds_write_b128 v200, v[212:215] offset:0
 s_cbranch_vccnz L_pq_75_0123f
L_pq_75_123:
 s_waitcnt vmcnt(2)
 v_max_u32 v234, v216, v218
 v_cmp_eq_u32 vcc, -1, v234
 ds_write_b128 v200, v[216:219] offset:1024
 s_cbranch_vccnz L_pq_75_123f
L_pq_75_23:
 s_waitcnt vmcnt(1)
 v_max_u32 v234, v220, v222
 v_cmp_eq_u32 vcc, -1, v234
 ds_write_b128 v200, v[220:223] offset:2048
 s_cbranch_vccnz L_pq_75_23f
L_pq_75_3:
 buffer_load_dwordx4 v[224:227], v191, s[4:7], s20 offen offset:3072 sc1
 s_sub_u32 s63, s63, 1
 s_cbranch_scc1 L_role_t_0_abort
 s_waitcnt vmcnt(1)
 v_max_u32 v234, v224, v226
 v_cmp_eq_u32 vcc, -1, v234
 ds_write_b128 v200, v[224:227] offset:3072
 s_cbranch_vccnz L_pq_75_3
L_pq_75_done:
 v_smfmac_f32_16x16x64_bf16 v[160:163], v[212:215], a[8:15], v204
 v_smfmac_f32_16x16x64_bf16 v[160:163], v[216:219], a[24:31], v204
 s_waitcnt lgkmcnt(0)
 s_barrier
 ds_read_b128 v[8:11], v201 offset:0
 ds_read_b128 v[12:15], v201 offset:1024
 ds_read_b128 v[16:19], v201 offset:2048
 ds_read_b128 v[20:23], v201 offset:3072
 v_smfmac_f32_16x16x64_bf16 v[160:163], v[220:223], a[40:47], v204
 ds_read_b128 v[24:27], v202 offset:0
 ds_read_b128 v[28:31], v202 offset:1024
 ds_read_b128 v[32:35], v202 offset:2048
 ds_read_b128 v[36:39], v202 offset:3072
 v_smfmac_f32_16x16x64_bf16 v[160:163], v[224:227], a[56:63], v204
 ds_read_b128 v[40:43], v203 offset:0
 ds_read_b128 v[44:47], v203 offset:1024
 ds_read_b128 v[48:51], v203 offset:2048
 ds_read_b128 v[52:55], v203 offset:3072
 s_waitcnt lgkmcnt(11)
 v_smfmac_f32_16x16x64_bf16 v[160:163], v[8:11], a[72:79], v204
 s_waitcnt lgkmcnt(10)
 v_smfmac_f32_16x16x64_bf16 v[160:163], v[12:15], a[88:95], v204
 s_waitcnt lgkmcnt(9)
 v_smfmac_f32_16x16x64_bf16 v[160:163], v[16:19], a[104:111], v204
 s_waitcnt lgkmcnt(8)
 v_smfmac_f32_16x16x64_bf16 v[160:163], v[20:23], a[120:127], v204
 s_waitcnt lgkmcnt(7)
 v_smfmac_f32_16x16x64_bf16 v[160:163], v[24:27], a[136:143], v204
 s_waitcnt lgkmcnt(6)
 v_smfmac_f32_16x16x64_bf16 v[160:163], v[28:31], a[152:159], v204
 s_waitcnt lgkmcnt(5)
 v_smfmac_f32_16x16x64_bf16 v[160:163], v[32:35], a[168:175], v204
 s_waitcnt lgkmcnt(4)
 v_smfmac_f32_16x16x64_bf16 v[160:163], v[36:39], a[184:191], v204
 s_waitcnt lgkmcnt(3)
 v_smfmac_f32_16x16x64_bf16 v[160:163], v[40:43], a[200:207], v204
 s_waitcnt lgkmcnt(2)
 v_smfmac_f32_16x16x64_bf16 v[160:163], v[44:47], a[216:223], v204
 s_waitcnt lgkmcnt(1)
 v_smfmac_f32_16x16x64_bf16 v[160:163], v[48:51], a[232:239], v204
 s_waitcnt lgkmcnt(0)
 v_smfmac_f32_16x16x64_bf16 v[160:163], v[52:55], a[248:255], v204
 s_nop 7
 v_cvt_pk_bf16_f32 v230, v160, v161
 v_cvt_pk_bf16_f32 v231, v162, v163
 s_nop 1
 v_mfma_f32_16x16x32_bf16 v[164:167], v[228:231], v[208:211], 0
 s_nop 7
 v_cvt_pk_bf16_f32 v232, v164, v165
 v_cvt_pk_bf16_f32 v233, v166, v167
 v_min_u32 v232, -2, v232
 buffer_store_dwordx2 v[232:233], v193, s[4:7], s26 offen
 s_nop 8
 s_and_b32 s65, s64, 3
 s_lshl_b32 s92, s65, 10
 s_add_u32 s92, s92, s87
 s_lshl_b32 s88, s65, 18
 s_add_u32 s88, s88, s85
 s_add_u32 s90, s64, 1
 s_and_b32 s90, s90, 3
 s_lshl_b32 s90, s90, 14
 s_xor_b32 s91, s90, 0x8000
 s_add_u32 s90, s90, s86
 s_add_u32 s91, s91, s86
 s_cmp_lg_u32 s93, 0
 s_cbranch_scc1 L_t_k1_65
 buffer_load_dwordx4 v[128:131], v86, s[4:7], s78 offen offset:0 sc1
 buffer_load_dwordx4 v[132:135], v86, s[4:7], s78 offen offset:512 sc1
 buffer_load_dwordx4 v[136:139], v86, s[4:7], s78 offen offset:1024 sc1
 buffer_load_dwordx4 v[140:143], v86, s[4:7], s78 offen offset:1536 sc1
 s_nop 15
 s_nop 3
 s_branch L_t0_rt_80
L_t0_rt_83:
 buffer_load_dwordx4 v[128:131], v86, s[4:7], s78 offen offset:0 sc1
 buffer_load_dwordx4 v[132:135], v86, s[4:7], s78 offen offset:512 sc1
 buffer_load_dwordx4 v[136:139], v86, s[4:7], s78 offen offset:1024 sc1
 buffer_load_dwordx4 v[140:143], v86, s[4:7], s78 offen offset:1536 sc1
 s_sub_u32 s63, s63, 1
 s_cbranch_scc1 L_role_t_0_abort
 s_waitcnt vmcnt(4)
 v_max_u32 v83, v140, v142
 v_cmp_eq_u32 vcc, -1, v83
 s_cbranch_vccnz L_t0_rt_83
 v_mfma_f32_16x16x32_bf16 v[144:147], v[108:111], v[140:143], v[144:147]
 v_mfma_f32_16x16x32_bf16 v[148:151], v[124:127], v[140:143], v[148:151]
 v_mfma_f32_16x16x32_bf16 v[152:155], v[140:143], v[140:143], v[152:155]
 s_branch L_t0_st_79
L_t0_rt_82:
 buffer_load_dwordx4 v[128:131], v86, s[4:7], s78 offen offset:0 sc1
 buffer_load_dwordx4 v[132:135], v86, s[4:7], s78 offen offset:512 sc1
 buffer_load_dwordx4 v[136:139], v86, s[4:7], s78 offen offset:1024 sc1
 buffer_load_dwordx4 v[140:143], v86, s[4:7], s78 offen offset:1536 sc1
 s_sub_u32 s63, s63, 1
 s_cbranch_scc1 L_role_t_0_abort
 s_waitcnt vmcnt(5)
 v_max_u32 v83, v136, v138
 v_cmp_eq_u32 vcc, -1, v83
 s_cbranch_vccnz L_t0_rt_82
 v_mfma_f32_16x16x32_bf16 v[144:147], v[104:107], v[136:139], v[144:147]
 s_waitcnt vmcnt(4)
 v_max_u32 v83, v140, v142
 v_cmp_eq_u32 vcc, -1, v83
 v_mfma_f32_16x16x32_bf16 v[148:151], v[120:123], v[136:139], v[148:151]
 v_mfma_f32_16x16x32_bf16 v[152:155], v[136:139], v[136:139], v[152:155]
 s_branch L_t0_st_78
L_t0_rt_81:
 buffer_load_dwordx4 v[128:131], v86, s[4:7], s78 offen offset:0 sc1
 buffer_load_dwordx4 v[132:135], v86, s[4:7], s78 offen offset:512 sc1
 buffer_load_dwordx4 v[136:139], v86, s[4:7], s78 offen offset:1024 sc1
 buffer_load_dwordx4 v[140:143], v86, s[4:7], s78 offen offset:1536 sc1
 s_sub_u32 s63, s63, 1
 s_cbranch_scc1 L_role_t_0_abort
 s_waitcnt vmcnt(6)
 v_max_u32 v83, v132, v134
 v_cmp_eq_u32 vcc, -1, v83
 s_cbranch_vccnz L_t0_rt_81
 v_mfma_f32_16x16x32_bf16 v[144:147], v[100:103], v[132:135], v[144:147]
 s_waitcnt vmcnt(5)
 v_max_u32 v83, v136, v138
 v_cmp_eq_u32 vcc, -1, v83
 v_mfma_f32_16x16x32_bf16 v[148:151], v[116:119], v[132:135], v[148:151]
 v_mfma_f32_16x16x32_bf16 v[152:155], v[132:135], v[132:135], v[152:155]
 s_branch L_t0_st_77
L_t0_rt_80:
 buffer_load_dwordx4 v[128:131], v86, s[4:7], s78 offen offset:0 sc1
 buffer_load_dwordx4 v[132:135], v86, s[4:7], s78 offen offset:512 sc1
 buffer_load_dwordx4 v[136:139], v86, s[4:7], s78 offen offset:1024 sc1
 buffer_load_dwordx4 v[140:143], v86, s[4:7], s78 offen offset:1536 sc1
 s_sub_u32 s63, s63, 1
 s_cbranch_scc1 L_role_t_0_abort
 s_waitcnt vmcnt(7)
 v_max_u32 v83, v128, v130
 v_cmp_eq_u32 vcc, -1, v83
 s_cbranch_vccnz L_t0_rt_80
 v_mfma_f32_16x16x32_bf16 v[144:147], v[96:99], v[128:131], 0
 s_waitcnt vmcnt(6)
 v_max_u32 v83, v132, v134
 v_cmp_eq_u32 vcc, -1, v83
 v_mfma_f32_16x16x32_bf16 v[148:151], v[112:115], v[128:131], 0
 v_mfma_f32_16x16x32_bf16 v[152:155], v[128:131], v[128:131], v[176:179]
L_t0_st_76:
 s_cbranch_vccnz L_t0_rt_81
 v_mfma_f32_16x16x32_bf16 v[144:147], v[100:103], v[132:135], v[144:147]
 s_waitcnt vmcnt(5)
 v_max_u32 v83, v136, v138
 v_cmp_eq_u32 vcc, -1, v83
 v_mfma_f32_16x16x32_bf16 v[148:151], v[116:119], v[132:135], v[148:151]
 v_mfma_f32_16x16x32_bf16 v[152:155], v[132:135], v[132:135], v[152:155]
L_t0_st_77:
 s_cbranch_vccnz L_t0_rt_82
 v_mfma_f32_16x16x32_bf16 v[144:147], v[104:107], v[136:139], v[144:147]
 s_waitcnt vmcnt(4)
 v_max_u32 v83, v140, v142
 v_cmp_eq_u32 vcc, -1, v83
 v_mfma_f32_16x16x32_bf16 v[148:151], v[120:123], v[136:139], v[148:151]
 v_mfma_f32_16x16x32_bf16 v[152:155], v[136:139], v[136:139], v[152:155]
L_t0_st_78:
 s_cbranch_vccnz L_t0_rt_83
 v_mfma_f32_16x16x32_bf16 v[144:147], v[108:111], v[140:143], v[144:147]
 v_mfma_f32_16x16x32_bf16 v[148:151], v[124:127], v[140:143], v[148:151]
 v_mfma_f32_16x16x32_bf16 v[152:155], v[140:143], v[140:143], v[152:155]
L_t0_st_79:
 s_nop 5
 v_mov_b32_dpp v144, v146 row_ror:8 row_mask:0xf bank_mask:0xc
 v_mov_b32_dpp v145, v147 row_ror:8 row_mask:0xf bank_mask:0xc
 v_mov_b32_dpp v148, v150 row_ror:8 row_mask:0xf bank_mask:0xc
 v_mov_b32_dpp v149, v151 row_ror:8 row_mask:0xf bank_mask:0xc
 v_mov_b32_dpp v152, v154 row_ror:8 row_mask:0xf bank_mask:0xc
 v_mov_b32_dpp v153, v155 row_ror:8 row_mask:0xf bank_mask:0xc
 v_max3_f32 v180, v144, v145, v148
 v_max3_f32 v180, v180, v149, v152
 v_max_f32 v180, v180, v153
 v_pk_mul_f32 v[24:25], v[144:145], s[82:83]
 v_pk_mul_f32 v[26:27], v[148:149], s[82:83]
 v_max_f32_dpp v180, v180, v180 row_ror:8 row_mask:0xf bank_mask:0xf
 v_mov_b32 v80, v180
 v_pk_mul_f32 v[28:29], v[152:153], s[82:83]
 s_nop 0
 v_permlane16_swap_b32 v180, v80
 v_max_f32 v180, v180, v80
 v_mov_b32 v80, v180
 s_nop 0
 s_nop 0
 v_permlane32_swap_b32 v180, v80
 v_max_f32 v180, v180, v80
 v_mul_f32 v180, s82, v180
 v_pk_add_f32 v[24:25], v[24:25], v[180:181] op_sel_hi:[1,0] neg_lo:[0,1] neg_hi:[0,1]
 v_pk_add_f32 v[26:27], v[26:27], v[180:181] op_sel_hi:[1,0] neg_lo:[0,1] neg_hi:[0,1]
 v_pk_add_f32 v[28:29], v[28:29], v[180:181] op_sel_hi:[1,0] neg_lo:[0,1] neg_hi:[0,1]
 v_exp_f32 v24, v24
 v_exp_f32 v25, v25
 v_exp_f32 v26, v26
 v_exp_f32 v27, v27
 v_exp_f32 v28, v28
 v_exp_f32 v29, v29
 v_pk_add_f32 v[182:183], v[24:25], v[26:27]
 v_pk_add_f32 v[182:183], v[182:183], v[28:29]
 v_add_f32 v182, v182, v183
 s_nop 1
 v_add_f32_dpp v182, v182, v182 row_ror:8 row_mask:0xf bank_mask:0xf
 v_mov_b32 v80, v182
 s_nop 1
 v_permlane16_swap_b32 v182, v80
 v_add_f32 v182, v182, v80
 v_mov_b32 v80, v182
 s_nop 1
 v_permlane32_swap_b32 v182, v80
 v_add_f32 v182, v182, v80
 v_rcp_f32 v182, v182
 s_nop 0
 v_pk_mul_f32 v[24:25], v[24:25], v[182:183] op_sel_hi:[1,0]
 v_pk_mul_f32 v[26:27], v[26:27], v[182:183] op_sel_hi:[1,0]
 v_pk_mul_f32 v[28:29], v[28:29], v[182:183] op_sel_hi:[1,0]
 v_cvt_pk_bf16_f32 v168, v24, abs(v25)
 v_cvt_pk_bf16_f32 v169, v26, abs(v27)
 v_cvt_pk_bf16_f32 v170, v28, abs(v29)
 buffer_store_dwordx2 v[168:169], v87, s[4:7], s80 offen
 buffer_store_dword v170, v88, s[4:7], s80 offen
 buffer_store_dword v170, v88, s[4:7], s80 offen offset:256
 s_nop 15
 s_nop 15
 s_nop 15
 s_nop 11
 buffer_store_dwordx2 v[92:93], v87, s[4:7], s81 offen
 buffer_store_dword v92, v88, s[4:7], s81 offen
 buffer_store_dword v92, v88, s[4:7], s81 offen offset:256
 s_add_u32 s65, s64, 1
 s_and_b32 s65, s65, 3
 s_lshl_b32 s65, s65, 13
 s_add_u32 s66, s65, s75
 s_add_u32 s67, s66, 4096
 buffer_load_dwordx4 v[96:99], v84, s[4:7], s66 offen offset:0 sc1
 buffer_load_dwordx4 v[100:103], v84, s[4:7], s66 offen offset:1024 sc1
 buffer_load_dwordx4 v[104:107], v84, s[4:7], s66 offen offset:2048 sc1
 buffer_load_dwordx4 v[108:111], v84, s[4:7], s66 offen offset:3072 sc1
 buffer_load_dwordx4 v[112:115], v84, s[4:7], s67 offen offset:0 sc1
 buffer_load_dwordx4 v[116:119], v84, s[4:7], s67 offen offset:1024 sc1
 buffer_load_dwordx4 v[120:123], v84, s[4:7], s67 offen offset:2048 sc1
 buffer_load_dwordx4 v[124:127], v84, s[4:7], s67 offen offset:3072 sc1
 s_branch L_t_jn_68
L_t_k1_65:
 s_cmp_lg_u32 s93, 1
 s_cbranch_scc1 L_t_k2_66
 s_nop 15
 s_nop 3
 s_branch L_pfirst_85
L_poll_84:
 s_sub_u32 s63, s63, 1
 s_cbranch_scc1 L_role_t_0_abort
L_pfirst_85:
 buffer_load_dwordx4 v[8:11], v85, s[4:7], s79 offen offset:0 sc1
 buffer_load_dwordx4 v[12:15], v85, s[4:7], s79 offen offset:512 sc1
 buffer_load_dwordx4 v[16:19], v85, s[4:7], s79 offen offset:1024 sc1
 buffer_load_dwordx4 v[20:23], v85, s[4:7], s79 offen offset:1536 sc1
 buffer_load_dword v24, v82, s[4:7], s78 offen sc1
 s_waitcnt vmcnt(0)
 v_max3_u32 v83, v8, v10, v12
 v_max3_u32 v83, v83, v14, v16
 v_max3_u32 v83, v83, v18, v20
 v_max3_u32 v83, v83, v22, v24
 v_cmp_eq_u32 vcc, -1, v83
 s_cbranch_vccnz L_poll_84
 v_mfma_f32_16x16x32_bf16 v[152:155], v[8:11], v[128:131], 0
 v_mfma_f32_16x16x32_bf16 v[152:155], v[12:15], v[132:135], v[152:155]
 v_mfma_f32_16x16x32_bf16 v[152:155], v[16:19], v[136:139], v[152:155]
 v_mfma_f32_16x16x32_bf16 v[152:155], v[20:23], v[140:143], v[152:155]
 s_cmp_eq_u32 s64, 63
 s_nop 2
 s_cbranch_scc1 L_t_nopf_86
 s_add_u32 s65, s64, 1
 s_and_b32 s65, s65, 3
 s_lshl_b32 s65, s65, 13
 s_add_u32 s66, s65, s75
 s_add_u32 s67, s66, 4096
 buffer_load_dwordx4 v[96:99], v84, s[4:7], s66 offen offset:0 sc1
 buffer_load_dwordx4 v[100:103], v84, s[4:7], s66 offen offset:1024 sc1
 buffer_load_dwordx4 v[104:107], v84, s[4:7], s66 offen offset:2048 sc1
 buffer_load_dwordx4 v[108:111], v84, s[4:7], s66 offen offset:3072 sc1
 buffer_load_dwordx4 v[112:115], v84, s[4:7], s67 offen offset:0 sc1
 buffer_load_dwordx4 v[116:119], v84, s[4:7], s67 offen offset:1024 sc1
 buffer_load_dwordx4 v[120:123], v84, s[4:7], s67 offen offset:2048 sc1
 buffer_load_dwordx4 v[124:127], v84, s[4:7], s67 offen offset:3072 sc1
 s_add_u32 s65, s65, s74
 buffer_load_dwordx4 v[128:131], v84, s[4:7], s65 offen offset:0 sc1
 buffer_load_dwordx4 v[132:135], v84, s[4:7], s65 offen offset:1024 sc1
 buffer_load_dwordx4 v[136:139], v84, s[4:7], s65 offen offset:2048 sc1
 buffer_load_dwordx4 v[140:143], v84, s[4:7], s65 offen offset:3072 sc1
L_t_nopf_86:
 v_max3_f32 v180, v144, v145, v146
 v_max3_f32 v180, v180, v147, v148
 v_max3_f32 v180, v180, v149, v150
 v_max3_f32 v180, v180, v151, v152
 v_max3_f32 v180, v180, v153, v154
 v_max_f32 v180, v180, v155
 v_mov_b32 v80, v180
 v_pk_mul_f32 v[24:25], v[144:145], s[82:83]
 v_pk_mul_f32 v[26:27], v[146:147], s[82:83]
 v_permlane16_swap_b32 v180, v80
 v_max_f32 v180, v180, v80
 v_mov_b32 v80, v180
 v_pk_mul_f32 v[28:29], v[148:149], s[82:83]
 v_pk_mul_f32 v[30:31], v[150:151], s[82:83]
 v_permlane32_swap_b32 v180, v80
 v_max_f32 v180, v180, v80
 v_pk_mul_f32 v[32:33], v[152:153], s[82:83]
 v_pk_mul_f32 v[34:35], v[154:155], s[82:83]
 v_mul_f32 v180, s82, v180
 v_pk_add_f32 v[24:25], v[24:25], v[180:181] op_sel_hi:[1,0] neg_lo:[0,1] neg_hi:[0,1]
 v_pk_add_f32 v[26:27], v[26:27], v[180:181] op_sel_hi:[1,0] neg_lo:[0,1] neg_hi:[0,1]
 v_pk_add_f32 v[28:29], v[28:29], v[180:181] op_sel_hi:[1,0] neg_lo:[0,1] neg_hi:[0,1]
 v_pk_add_f32 v[30:31], v[30:31], v[180:181] op_sel_hi:[1,0] neg_lo:[0,1] neg_hi:[0,1]
 v_pk_add_f32 v[32:33], v[32:33], v[180:181] op_sel_hi:[1,0] neg_lo:[0,1] neg_hi:[0,1]
 v_pk_add_f32 v[34:35], v[34:35], v[180:181] op_sel_hi:[1,0] neg_lo:[0,1] neg_hi:[0,1]
 v_exp_f32 v24, v24
 v_exp_f32 v25, v25
 v_exp_f32 v26, v26
 v_exp_f32 v27, v27
 v_exp_f32 v28, v28
 v_exp_f32 v29, v29
 v_exp_f32 v30, v30
 v_exp_f32 v31, v31
 v_exp_f32 v32, v32
 v_exp_f32 v33, v33
 v_exp_f32 v34, v34
 v_exp_f32 v35, v35
 v_add_f32 v182, v24, v25
 v_add_f32 v182, v182, v26
 v_add_f32 v182, v182, v27
 v_add_f32 v182, v182, v28
 v_add_f32 v182, v182, v29
 v_add_f32 v182, v182, v30
 v_add_f32 v182, v182, v31
 v_add_f32 v184, v32, v33
 v_add_f32 v184, v184, v34
 v_add_f32 v184, v184, v35
 v_fma_f32 v182, v184, 0.5, v182
 v_mov_b32 v80, v182
 s_nop 1
 v_permlane16_swap_b32 v182, v80
 v_add_f32 v182, v182, v80
 v_mov_b32 v80, v182
 s_nop 1
 v_permlane32_swap_b32 v182, v80
 v_add_f32 v182, v182, v80
 v_rcp_f32 v182, v182
 s_nop 0
 v_pk_mul_f32 v[24:25], v[24:25], v[182:183] op_sel_hi:[1,0]
 v_pk_mul_f32 v[26:27], v[26:27], v[182:183] op_sel_hi:[1,0]
 v_pk_mul_f32 v[28:29], v[28:29], v[182:183] op_sel_hi:[1,0]
 v_pk_mul_f32 v[30:31], v[30:31], v[182:183] op_sel_hi:[1,0]
 v_pk_mul_f32 v[32:33], v[32:33], v[182:183] op_sel_hi:[1,0]
 v_pk_mul_f32 v[34:35], v[34:35], v[182:183] op_sel_hi:[1,0]
 v_cvt_pk_bf16_f32 v168, v24, abs(v25)
 v_cvt_pk_bf16_f32 v169, v26, abs(v27)
 v_cvt_pk_bf16_f32 v170, v28, abs(v29)
 v_cvt_pk_bf16_f32 v171, v30, abs(v31)
 v_cvt_pk_bf16_f32 v172, v32, abs(v33)
 v_cvt_pk_bf16_f32 v173, v34, abs(v35)
 buffer_store_dwordx4 v[168:171], v87, s[4:7], s80 offen
 buffer_store_dwordx2 v[172:173], v88, s[4:7], s80 offen
 s_waitcnt vmcnt(2)
 v_mfma_f32_16x16x32_bf16 v[144:147], v[96:99], v[128:131], 0
 v_mfma_f32_16x16x32_bf16 v[144:147], v[100:103], v[132:135], v[144:147]
 v_mfma_f32_16x16x32_bf16 v[144:147], v[104:107], v[136:139], v[144:147]
 v_mfma_f32_16x16x32_bf16 v[144:147], v[108:111], v[140:143], v[144:147]
 v_mfma_f32_16x16x32_bf16 v[148:151], v[112:115], v[128:131], 0
 v_mfma_f32_16x16x32_bf16 v[148:151], v[116:119], v[132:135], v[148:151]
 v_mfma_f32_16x16x32_bf16 v[148:151], v[120:123], v[136:139], v[148:151]
 v_mfma_f32_16x16x32_bf16 v[148:151], v[124:127], v[140:143], v[148:151]
 s_nop 3
 v_cndmask_b32 v144, v185, v144, s[40:41]
 v_cndmask_b32 v145, v185, v145, s[42:43]
 v_cndmask_b32 v146, v185, v146, s[44:45]
 v_cndmask_b32 v147, v185, v147, s[46:47]
 v_cndmask_b32 v148, v185, v148, s[48:49]
 v_cndmask_b32 v149, v185, v149, s[50:51]
 v_cndmask_b32 v150, v185, v150, s[52:53]
 v_cndmask_b32 v151, v185, v151, s[54:55]
 buffer_store_dwordx4 v[92:95], v87, s[4:7], s81 offen
 buffer_store_dwordx2 v[92:93], v88, s[4:7], s81 offen
 s_cmp_ge_i32 s64, 63
 s_cbranch_scc1 L_t_end_69
 buffer_store_dwordx2 v[196:197], v193, s[4:7], s25 offen
 v_xor_b32 v200, 0x4000, v200
 v_xor_b32 v201, 0x4000, v201
 v_xor_b32 v202, 0x4000, v202
 v_xor_b32 v203, 0x4000, v203
 s_add_u32 s20, s64, 1
 s_and_b32 s20, s20, 3
 s_lshl_b32 s20, s20, 14
 s_add_u32 s20, s20, s23
 s_add_u32 s25, s64, 1
 s_and_b32 s25, s25, 3
 s_lshl_b32 s26, s25, 11
 s_xor_b32 s25, s26, 4096
 s_add_u32 s26, s26, s22
 s_add_u32 s25, s25, s22
 v_mov_b64 v[156:157], 0
 v_mov_b64 v[158:159], 0
 v_mov_b64 v[160:161], 0
 v_mov_b64 v[162:163], 0
 s_add_u32 s65, s64, 1
 s_and_b32 s65, s65, 3
 s_lshl_b32 s66, s65, 11
 s_add_u32 s78, s66, s72
 s_add_u32 s79, s66, s73
 s_lshl_b32 s80, s65, s29
 s_xor_b32 s65, s65, 2
 s_lshl_b32 s81, s65, s29
 s_add_u32 s80, s80, s76
 s_add_u32 s81, s81, s76
 buffer_store_dwordx2 v[78:79], v64, s[4:7], s91 offen
 s_branch L_t_k3_67
L_t_k2_66:
 v_mov_b32 v188, s64
 buffer_store_dword v188, v187, s[4:7], s30 offen
 s_cmp_ge_i32 s64, 63
 s_cbranch_scc1 L_t_end_69
 s_sleep 14
 buffer_store_dwordx2 v[196:197], v193, s[4:7], s25 offen
 v_xor_b32 v200, 0x4000, v200
 v_xor_b32 v201, 0x4000, v201
 v_xor_b32 v202, 0x4000, v202
 v_xor_b32 v203, 0x4000, v203
 s_add_u32 s20, s64, 1
 s_and_b32 s20, s20, 3
 s_lshl_b32 s20, s20, 14
 s_add_u32 s20, s20, s23
 s_add_u32 s25, s64, 1
 s_and_b32 s25, s25, 3
 s_lshl_b32 s26, s25, 11
 s_xor_b32 s25, s26, 4096
 s_add_u32 s26, s26, s22
 s_add_u32 s25, s25, s22
 v_mov_b64 v[156:157], 0
 v_mov_b64 v[158:159], 0
 v_mov_b64 v[160:161], 0
 v_mov_b64 v[162:163], 0
 s_add_u32 s65, s64, 1
 s_and_b32 s65, s65, 3
 s_lshl_b32 s66, s65, 11
 s_add_u32 s78, s66, s72
 s_add_u32 s79, s66, s73
 s_lshl_b32 s80, s65, s29
 s_xor_b32 s65, s65, 2
 s_lshl_b32 s81, s65, s29
 s_add_u32 s80, s80, s76
 s_add_u32 s81, s81, s76
 buffer_store_dwordx2 v[78:79], v64, s[4:7], s91 offen
 s_cmp_eq_u32 s93, 2
 s_cbranch_scc1 L_t_k3_67
 s_waitcnt vmcnt(0)
 s_mov_b64 exec, 0xff
 buffer_load_dword v57, v65, s[4:7], s92 offen sc1
 s_nop 15
 s_nop 11
L_poll_87:
 buffer_load_dword v57, v65, s[4:7], s92 offen sc1
 s_sub_u32 s63, s63, 1
 s_cbranch_scc1 L_role_t_0_abort
 s_waitcnt vmcnt(1)
 v_cmp_eq_u32 vcc, -1, v57
 s_cbranch_vccnz L_poll_87
 s_mov_b64 exec, -1
 s_nop 15
 s_nop 7
 s_branch L_t_k3_67
L_t_jn_68:
 s_cmp_ge_i32 s64, 63
 s_cbranch_scc1 L_t_end_69
 buffer_store_dwordx2 v[196:197], v193, s[4:7], s25 offen
 v_xor_b32 v200, 0x4000, v200
 v_xor_b32 v201, 0x4000, v201
 v_xor_b32 v202, 0x4000, v202
 v_xor_b32 v203, 0x4000, v203
 s_add_u32 s20, s64, 1
 s_and_b32 s20, s20, 3
 s_lshl_b32 s20, s20, 14
 s_add_u32 s20, s20, s23
 s_add_u32 s25, s64, 1
 s_and_b32 s25, s25, 3
 s_lshl_b32 s26, s25, 11
 s_xor_b32 s25, s26, 4096
 s_add_u32 s26, s26, s22
 s_add_u32 s25, s25, s22
 v_mov_b64 v[156:157], 0
 v_mov_b64 v[158:159], 0
 v_mov_b64 v[160:161], 0
 v_mov_b64 v[162:163], 0
 s_add_u32 s65, s64, 1
 s_and_b32 s65, s65, 3
 s_lshl_b32 s66, s65, 11
 s_add_u32 s78, s66, s72
 s_add_u32 s79, s66, s73
 s_lshl_b32 s80, s65, s29
 s_xor_b32 s65, s65, 2
 s_lshl_b32 s81, s65, s29
 s_add_u32 s80, s80, s76
 s_add_u32 s81, s81, s76
 buffer_store_dwordx2 v[78:79], v64, s[4:7], s91 offen
L_t_k3_67:
 s_barrier
 buffer_load_dwordx4 v[40:43], v60, s[4:7], s88 offen sc1
 buffer_load_dwordx4 v[44:47], v61, s[4:7], s88 offen sc1
 s_nop 12
 buffer_load_dwordx4 v[48:51], v62, s[4:7], s88 offen sc1
 buffer_load_dwordx4 v[52:55], v63, s[4:7], s88 offen sc1
 s_waitcnt vmcnt(2)
 v_max_u32 v56, v40, v44
 v_mfma_f32_16x16x32_bf16 v[72:75], v[40:43], v[68:71], 0
 v_mfma_f32_16x16x32_bf16 v[72:75], v[44:47], v[68:71], v[72:75]
 s_waitcnt vmcnt(1)
 v_mfma_f32_16x16x32_bf16 v[72:75], v[48:51], v[68:71], v[72:75]
 s_waitcnt vmcnt(0)
 v_max3_u32 v56, v56, v48, v52
 v_mfma_f32_16x16x32_bf16 v[72:75], v[52:55], v[68:71], v[72:75]
 v_cmp_eq_u32 vcc, -1, v56
 s_cbranch_vccnz L_rpoll_88
 s_nop 5
 v_cvt_pk_bf16_f32 v76, v72, v73
 v_cvt_pk_bf16_f32 v77, v74, v75
 v_min_u32 v76, -2, v76
 buffer_store_dwordx2 v[76:77], v64, s[4:7], s90 offen
 s_add_u32 s64, s64, 1
 s_cmp_lt_i32 s64, s28
 s_cbranch_scc1 L_t_loop_64
 s_branch L_t_end_69
L_rpoll_88:
 s_mov_b64 exec, vcc
 buffer_load_dwordx4 v[40:43], v60, s[4:7], s88 offen sc1
 buffer_load_dwordx4 v[44:47], v61, s[4:7], s88 offen sc1
 buffer_load_dwordx4 v[48:51], v62, s[4:7], s88 offen sc1
 buffer_load_dwordx4 v[52:55], v63, s[4:7], s88 offen sc1
 s_mov_b64 exec, -1
 s_sub_u32 s63, s63, 1
 s_cbranch_scc1 L_role_t_0_abort
 s_nop 15
 s_nop 15
 s_nop 15
 s_nop 6
 buffer_load_dwordx4 v[212:215], v191, s[4:7], s20 offen offset:0 sc1
 buffer_load_dwordx4 v[216:219], v191, s[4:7], s20 offen offset:1024 sc1
 buffer_load_dwordx4 v[220:223], v191, s[4:7], s20 offen offset:2048 sc1
 buffer_load_dwordx4 v[224:227], v191, s[4:7], s20 offen offset:3072 sc1
 s_waitcnt vmcnt(6)
 v_max_u32 v56, v40, v44
 v_mfma_f32_16x16x32_bf16 v[72:75], v[40:43], v[68:71], 0
 v_mfma_f32_16x16x32_bf16 v[72:75], v[44:47], v[68:71], v[72:75]
 s_waitcnt vmcnt(5)
 v_mfma_f32_16x16x32_bf16 v[72:75], v[48:51], v[68:71], v[72:75]
 s_waitcnt vmcnt(4)
 v_max3_u32 v56, v56, v48, v52
 v_mfma_f32_16x16x32_bf16 v[72:75], v[52:55], v[68:71], v[72:75]
 v_cmp_eq_u32 vcc, -1, v56
 s_cbranch_vccnz L_rpoll_88
 s_nop 5
 v_cvt_pk_bf16_f32 v76, v72, v73
 v_cvt_pk_bf16_f32 v77, v74, v75
 v_min_u32 v76, -2, v76
 buffer_store_dwordx2 v[76:77], v64, s[4:7], s90 offen
 s_add_u32 s64, s64, 1
 s_cmp_lt_i32 s64, s28
 s_cbranch_scc1 L_t_loop2_74
 s_branch L_t_end_69
L_t_end_69:
 s_endpgm
L_role_o_0_abort:
 s_endpgm
.p2align 6
L_role_o_0:
 s_sub_u32 s74, s61, 12
 s_lshl_b32 s67, s60, 20
 s_lshl_b32 s66, s74, 8
 s_add_u32 s67, s67, s66
 s_add_u32 s12, s46, s67
 s_addc_u32 s13, s47, 0
 s_sub_u32 s14, 0x800000, s67
 s_mov_b32 s15, 0x00020000
 s_lshl_b32 s75, s60, 2
 s_add_u32 s75, s75, s62
 s_lshl_b32 s75, s75, 13
 s_add_u32 s75, s75, 0x6280000
 s_lshl_b32 s65, s60, 2
 s_add_u32 s65, s65, s62
 s_lshl_b32 s76, s65, 15
 s_add_u32 s76, s76, 0x200000
 s_lshl_b32 s71, s65, 7
 s_add_u32 s71, s71, 0x5010000
 s_lshl_b32 s77, s60, 14
 s_add_u32 s77, s77, 0x6300000
 s_min_u32 s66, s62, 2
 s_lshl_b32 s66, s66, 10
 s_add_u32 s77, s77, s66
 s_lshl_b32 s81, s60, 12
 s_lshl_b32 s66, s74, 7
 s_add_u32 s81, s81, s66
 s_add_u32 s81, s81, 0x6500000
 s_lshl_b32 s78, s60, 16
 s_mul_i32 s66, s62, 3072
 s_add_u32 s78, s78, s66
 s_add_u32 s78, s78, 0x6400000
 s_lshl_b32 s65, s74, 2
 s_add_u32 s65, s65, s62
 s_and_b32 s66, s60, 3
 s_mul_i32 s66, s66, 0
 s_lshr_b32 s67, s60, 2
 s_mul_i32 s67, s67, 0
 s_xor_b32 s66, s66, s67
 s_xor_b32 s68, s66, s65
 s_and_b32 s66, s68, 15
 s_lshl_b32 s66, s66, 9
 s_lshr_b32 s67, s68, 4
 s_lshl_b32 s67, s67, 14
 s_add_u32 s66, s66, s67
 s_lshl_b32 s67, s60, 15
 s_add_u32 s66, s66, s67
 s_add_u32 s79, s66, 0x6600000
 s_lshl_b32 s66, s65, 17
 s_add_u32 s82, s66, 0x3000000
 s_lshl_b32 s67, s60, 22
 s_add_u32 s82, s82, s67
 v_lshrrev_b32 v6, 4, v0
 v_lshlrev_b32 v7, 2, v6
 v_and_b32 v1, 15, v0
 v_xor_b32 v1, v1, v7
 v_lshlrev_b32 v1, 4, v1
 v_mul_u32_u24 v6, 2048, v6
 v_add_u32 v1, v1, v6
 v_bfe_u32 v6, v0, 3, 1
 v_bfe_u32 v7, v0, 2, 1
 v_lshl_add_u32 v6, v6, 2, v7
 v_bfe_u32 v7, v0, 1, 1
 v_and_b32 v2, 1, v0
 v_lshl_add_u32 v7, v2, 1, v7
 s_lshl_b32 s65, s62, 2
 v_add_u32 v7, s65, v7
 v_and_b32 v2, 3, v6
 v_lshlrev_b32 v2, 2, v2
 v_xor_b32 v7, v7, v2
 v_lshlrev_b32 v7, 4, v7
 v_lshrrev_b32 v2, 4, v0
 v_lshlrev_b32 v2, 3, v2
 v_add_u32 v2, v2, v6
 v_lshlrev_b32 v2, 8, v2
 v_add_u32 v2, v2, v7
 v_xor_b32 v3, 128, v2
 v_add_u32 v3, 512, v3
 v_add_u32 v4, 0x10000, v2
 v_add_u32 v5, 0x10000, v3
 s_mul_i32 s72, s62, 131072
 s_lshl_b32 s73, s62, 14
 v_lshrrev_b32 v6, 4, v0
 v_min_u32 v6, 1, v6
 v_lshlrev_b32 v6, 28, v6
 v_lshl_add_u32 v6, v0, 7, v6
 s_lshl_b32 s65, s74, 2
 s_add_u32 s65, s65, s62
 s_lshl_b32 s65, s65, 11
 v_add_u32 v8, s65, v6
 s_mov_b32 s84, 0
 buffer_load_dword v9, v8, s[8:11], s84 offen
 s_mov_b32 s84, 65536
 buffer_load_dword v9, v8, s[8:11], s84 offen
 s_mov_b32 s84, 131072
 buffer_load_dword v9, v8, s[8:11], s84 offen
 s_or_b32 s65, s62, s101
 s_cbranch_scc1 L_clm_89
 s_waitcnt lgkmcnt(0)
 s_bitcmp1_b32 s3, s61
 s_cbranch_scc0 L_clm_89
 s_mov_b32 s66, 1
 s_atomic_or s66, s[56:57], 36
 s_waitcnt lgkmcnt(0)
L_clm_89:
 s_sleep 32
 s_sleep 32
 s_sleep 32
 s_sleep 32
 s_add_u32 m0, s73, 0
 s_add_u32 s65, s72, 0
 buffer_load_dwordx4 v1, s[12:15], s65 offen nt lds
 s_add_u32 m0, s73, 1024
 s_add_u32 s65, s72, 8192
 buffer_load_dwordx4 v1, s[12:15], s65 offen nt lds
 s_add_u32 m0, s73, 2048
 s_add_u32 s65, s72, 16384
 buffer_load_dwordx4 v1, s[12:15], s65 offen nt lds
 s_add_u32 m0, s73, 3072
 s_add_u32 s65, s72, 24576
 buffer_load_dwordx4 v1, s[12:15], s65 offen nt lds
 s_add_u32 m0, s73, 4096
 s_add_u32 s65, s72, 32768
 buffer_load_dwordx4 v1, s[12:15], s65 offen nt lds
 s_add_u32 m0, s73, 5120
 s_add_u32 s65, s72, 40960
 buffer_load_dwordx4 v1, s[12:15], s65 offen nt lds
 s_add_u32 m0, s73, 6144
 s_add_u32 s65, s72, 49152
 buffer_load_dwordx4 v1, s[12:15], s65 offen nt lds
 s_add_u32 m0, s73, 7168
 s_add_u32 s65, s72, 57344
 buffer_load_dwordx4 v1, s[12:15], s65 offen nt lds
 s_add_u32 m0, s73, 8192
 s_add_u32 s65, s72, 65536
 buffer_load_dwordx4 v1, s[12:15], s65 offen nt lds
 s_add_u32 m0, s73, 9216
 s_add_u32 s65, s72, 73728
 buffer_load_dwordx4 v1, s[12:15], s65 offen nt lds
 s_add_u32 m0, s73, 10240
 s_add_u32 s65, s72, 81920
 buffer_load_dwordx4 v1, s[12:15], s65 offen nt lds
 s_add_u32 m0, s73, 11264
 s_add_u32 s65, s72, 90112
 buffer_load_dwordx4 v1, s[12:15], s65 offen nt lds
 s_add_u32 m0, s73, 12288
 s_add_u32 s65, s72, 98304
 buffer_load_dwordx4 v1, s[12:15], s65 offen nt lds
 s_add_u32 m0, s73, 13312
 s_add_u32 s65, s72, 106496
 buffer_load_dwordx4 v1, s[12:15], s65 offen nt lds
 s_add_u32 m0, s73, 14336
 s_add_u32 s65, s72, 114688
 buffer_load_dwordx4 v1, s[12:15], s65 offen nt lds
 s_add_u32 m0, s73, 15360
 s_add_u32 s65, s72, 122880
 buffer_load_dwordx4 v1, s[12:15], s65 offen nt lds
 s_add_u32 m0, s73, 65536
 s_add_u32 s65, s72, 524288
 buffer_load_dwordx4 v1, s[12:15], s65 offen nt lds
 s_add_u32 m0, s73, 66560
 s_add_u32 s65, s72, 532480
 buffer_load_dwordx4 v1, s[12:15], s65 offen nt lds
 s_add_u32 m0, s73, 67584
 s_add_u32 s65, s72, 540672
 buffer_load_dwordx4 v1, s[12:15], s65 offen nt lds
 s_add_u32 m0, s73, 68608
 s_add_u32 s65, s72, 548864
 buffer_load_dwordx4 v1, s[12:15], s65 offen nt lds
 s_add_u32 m0, s73, 69632
 s_add_u32 s65, s72, 557056
 buffer_load_dwordx4 v1, s[12:15], s65 offen nt lds
 s_add_u32 m0, s73, 70656
 s_add_u32 s65, s72, 565248
 buffer_load_dwordx4 v1, s[12:15], s65 offen nt lds
 s_add_u32 m0, s73, 71680
 s_add_u32 s65, s72, 573440
 buffer_load_dwordx4 v1, s[12:15], s65 offen nt lds
 s_add_u32 m0, s73, 72704
 s_add_u32 s65, s72, 581632
 buffer_load_dwordx4 v1, s[12:15], s65 offen nt lds
 s_add_u32 m0, s73, 73728
 s_add_u32 s65, s72, 589824
 buffer_load_dwordx4 v1, s[12:15], s65 offen nt lds
 s_add_u32 m0, s73, 74752
 s_add_u32 s65, s72, 598016
 buffer_load_dwordx4 v1, s[12:15], s65 offen nt lds
 s_add_u32 m0, s73, 75776
 s_add_u32 s65, s72, 606208
 buffer_load_dwordx4 v1, s[12:15], s65 offen nt lds
 s_add_u32 m0, s73, 76800
 s_add_u32 s65, s72, 614400
 buffer_load_dwordx4 v1, s[12:15], s65 offen nt lds
 s_add_u32 m0, s73, 77824
 s_add_u32 s65, s72, 622592
 buffer_load_dwordx4 v1, s[12:15], s65 offen nt lds
 s_add_u32 m0, s73, 78848
 s_add_u32 s65, s72, 630784
 buffer_load_dwordx4 v1, s[12:15], s65 offen nt lds
 s_add_u32 m0, s73, 79872
 s_add_u32 s65, s72, 638976
 buffer_load_dwordx4 v1, s[12:15], s65 offen nt lds
 s_add_u32 m0, s73, 80896
 s_add_u32 s65, s72, 647168
 buffer_load_dwordx4 v1, s[12:15], s65 offen nt lds
 v_lshlrev_b32 v12, 4, v0
 v_and_b32 v6, 31, v0
 v_lshlrev_b32 v6, 4, v6
 v_lshrrev_b32 v7, 5, v0
 v_lshl_add_u32 v13, v7, 13, v6
 s_lshl_b32 s65, s62, 10
 s_add_u32 s65, s65, 57344
 v_add_u32 v14, s65, v12
 s_lshl_b32 s65, s62, 11
 s_add_u32 s65, s65, 49152
 v_add_u32 v15, s65, v12
 v_mov_b32 v20, -1
 v_mov_b32 v21, -1
 v_mov_b32 v22, -1
 v_mov_b32 v23, -1
 v_mov_b32 v17, 0
 v_min_u32 v6, 1, v0
 v_lshlrev_b32 v16, 28, v6
 s_cmp_eq_u32 s62, 3
 s_cselect_b32 s65, 0, 0x10000000
 v_or_b32 v24, s65, v16
 v_bfe_u32 v6, v0, 2, 2
 v_lshlrev_b32 v32, 8, v6
 v_bfe_u32 v6, v0, 4, 1
 v_lshl_add_u32 v32, v6, 7, v32
 v_lshrrev_b32 v6, 5, v0
 v_lshl_add_u32 v32, v6, 6, v32
 v_and_b32 v6, 3, v0
 v_lshl_add_u32 v32, v6, 4, v32
 v_and_b32 v6, 8, v0
 v_cmp_ne_u32 vcc, 0, v6
 v_mov_b32 v33, 0x44444444
 v_mov_b32 v6, 0xeeeeeeee
 s_nop 1
 v_cndmask_b32 v33, v33, v6, vcc
 v_and_b32 v6, 2, v0
 v_cmp_ne_u32 vcc, 0, v6
 v_mov_b32 v34, 0x44444444
 v_mov_b32 v6, 0xeeeeeeee
 s_nop 1
 v_cndmask_b32 v34, v34, v6, vcc
 v_and_b32 v6, 2, v0
 v_cmp_eq_u32 s[92:93], 0, v6
 v_cmp_ne_u32 s[94:95], 0, v6
 s_waitcnt vmcnt(16)
 s_barrier
 ds_read_b64_tr_b16 v[36:37], v2 offset:0
 ds_read_b64_tr_b16 v[38:39], v3 offset:0
 ds_read_b64_tr_b16 v[44:45], v2 offset:8
 ds_read_b64_tr_b16 v[46:47], v3 offset:8
 ds_read_b64_tr_b16 v[40:41], v2 offset:8192
 ds_read_b64_tr_b16 v[42:43], v3 offset:8192
 ds_read_b64_tr_b16 v[48:49], v2 offset:8200
 ds_read_b64_tr_b16 v[50:51], v3 offset:8200
 ds_read_b64_tr_b16 v[52:53], v2 offset:16384
 ds_read_b64_tr_b16 v[54:55], v3 offset:16384
 ds_read_b64_tr_b16 v[60:61], v2 offset:16392
 ds_read_b64_tr_b16 v[62:63], v3 offset:16392
 ds_read_b64_tr_b16 v[56:57], v2 offset:24576
 ds_read_b64_tr_b16 v[58:59], v3 offset:24576
 ds_read_b64_tr_b16 v[64:65], v2 offset:24584
 ds_read_b64_tr_b16 v[66:67], v3 offset:24584
 ds_read_b64_tr_b16 v[68:69], v2 offset:32768
 ds_read_b64_tr_b16 v[70:71], v3 offset:32768
 ds_read_b64_tr_b16 v[76:77], v2 offset:32776
 ds_read_b64_tr_b16 v[78:79], v3 offset:32776
 ds_read_b64_tr_b16 v[72:73], v2 offset:40960
 ds_read_b64_tr_b16 v[74:75], v3 offset:40960
 ds_read_b64_tr_b16 v[80:81], v2 offset:40968
 ds_read_b64_tr_b16 v[82:83], v3 offset:40968
 ds_read_b64_tr_b16 v[84:85], v2 offset:49152
 ds_read_b64_tr_b16 v[86:87], v3 offset:49152
 ds_read_b64_tr_b16 v[92:93], v2 offset:49160
 ds_read_b64_tr_b16 v[94:95], v3 offset:49160
 ds_read_b64_tr_b16 v[88:89], v2 offset:57344
 ds_read_b64_tr_b16 v[90:91], v3 offset:57344
 ds_read_b64_tr_b16 v[96:97], v2 offset:57352
 ds_read_b64_tr_b16 v[98:99], v3 offset:57352
 s_waitcnt lgkmcnt(0)
 s_mov_b64 vcc, s[92:93]
 v_cndmask_b32_dpp v11, v44, v36, vcc quad_perm:[0,1,0,1] row_mask:0xf bank_mask:0xf
 v_accvgpr_write_b32 a0, v11
 s_nop 0
 v_cndmask_b32_dpp v11, v45, v37, vcc quad_perm:[0,1,0,1] row_mask:0xf bank_mask:0xf
 v_accvgpr_write_b32 a1, v11
 s_nop 0
 v_cndmask_b32_dpp v11, v46, v38, vcc quad_perm:[0,1,0,1] row_mask:0xf bank_mask:0xf
 v_accvgpr_write_b32 a2, v11
 s_nop 0
 v_cndmask_b32_dpp v11, v47, v39, vcc quad_perm:[0,1,0,1] row_mask:0xf bank_mask:0xf
 v_accvgpr_write_b32 a3, v11
 s_nop 0
 v_cndmask_b32_dpp v11, v48, v40, vcc quad_perm:[0,1,0,1] row_mask:0xf bank_mask:0xf
 v_accvgpr_write_b32 a4, v11
 s_nop 0
 v_cndmask_b32_dpp v11, v49, v41, vcc quad_perm:[0,1,0,1] row_mask:0xf bank_mask:0xf
 v_accvgpr_write_b32 a5, v11
 s_nop 0
 v_cndmask_b32_dpp v11, v50, v42, vcc quad_perm:[0,1,0,1] row_mask:0xf bank_mask:0xf
 v_accvgpr_write_b32 a6, v11
 s_nop 0
 v_cndmask_b32_dpp v11, v51, v43, vcc quad_perm:[0,1,0,1] row_mask:0xf bank_mask:0xf
 v_accvgpr_write_b32 a7, v11
 s_nop 0
 v_cndmask_b32_dpp v11, v60, v52, vcc quad_perm:[0,1,0,1] row_mask:0xf bank_mask:0xf
 v_accvgpr_write_b32 a16, v11
 s_nop 0
 v_cndmask_b32_dpp v11, v61, v53, vcc quad_perm:[0,1,0,1] row_mask:0xf bank_mask:0xf
 v_accvgpr_write_b32 a17, v11
 s_nop 0
 v_cndmask_b32_dpp v11, v62, v54, vcc quad_perm:[0,1,0,1] row_mask:0xf bank_mask:0xf
 v_accvgpr_write_b32 a18, v11
 s_nop 0
 v_cndmask_b32_dpp v11, v63, v55, vcc quad_perm:[0,1,0,1] row_mask:0xf bank_mask:0xf
 v_accvgpr_write_b32 a19, v11
 s_nop 0
 v_cndmask_b32_dpp v11, v64, v56, vcc quad_perm:[0,1,0,1] row_mask:0xf bank_mask:0xf
 v_accvgpr_write_b32 a20, v11
 s_nop 0
 v_cndmask_b32_dpp v11, v65, v57, vcc quad_perm:[0,1,0,1] row_mask:0xf bank_mask:0xf
 v_accvgpr_write_b32 a21, v11
 s_nop 0
 v_cndmask_b32_dpp v11, v66, v58, vcc quad_perm:[0,1,0,1] row_mask:0xf bank_mask:0xf
 v_accvgpr_write_b32 a22, v11
 s_nop 0
 v_cndmask_b32_dpp v11, v67, v59, vcc quad_perm:[0,1,0,1] row_mask:0xf bank_mask:0xf
 v_accvgpr_write_b32 a23, v11
 s_nop 0
 v_cndmask_b32_dpp v11, v76, v68, vcc quad_perm:[0,1,0,1] row_mask:0xf bank_mask:0xf
 v_accvgpr_write_b32 a32, v11
 s_nop 0
 v_cndmask_b32_dpp v11, v77, v69, vcc quad_perm:[0,1,0,1] row_mask:0xf bank_mask:0xf
 v_accvgpr_write_b32 a33, v11
 s_nop 0
 v_cndmask_b32_dpp v11, v78, v70, vcc quad_perm:[0,1,0,1] row_mask:0xf bank_mask:0xf
 v_accvgpr_write_b32 a34, v11
 s_nop 0
 v_cndmask_b32_dpp v11, v79, v71, vcc quad_perm:[0,1,0,1] row_mask:0xf bank_mask:0xf
 v_accvgpr_write_b32 a35, v11
 s_nop 0
 v_cndmask_b32_dpp v11, v80, v72, vcc quad_perm:[0,1,0,1] row_mask:0xf bank_mask:0xf
 v_accvgpr_write_b32 a36, v11
 s_nop 0
 v_cndmask_b32_dpp v11, v81, v73, vcc quad_perm:[0,1,0,1] row_mask:0xf bank_mask:0xf
 v_accvgpr_write_b32 a37, v11
 s_nop 0
 v_cndmask_b32_dpp v11, v82, v74, vcc quad_perm:[0,1,0,1] row_mask:0xf bank_mask:0xf
 v_accvgpr_write_b32 a38, v11
 s_nop 0
 v_cndmask_b32_dpp v11, v83, v75, vcc quad_perm:[0,1,0,1] row_mask:0xf bank_mask:0xf
 v_accvgpr_write_b32 a39, v11
 s_nop 0
 v_cndmask_b32_dpp v11, v92, v84, vcc quad_perm:[0,1,0,1] row_mask:0xf bank_mask:0xf
 v_accvgpr_write_b32 a48, v11
 s_nop 0
 v_cndmask_b32_dpp v11, v93, v85, vcc quad_perm:[0,1,0,1] row_mask:0xf bank_mask:0xf
 v_accvgpr_write_b32 a49, v11
 s_nop 0
 v_cndmask_b32_dpp v11, v94, v86, vcc quad_perm:[0,1,0,1] row_mask:0xf bank_mask:0xf
 v_accvgpr_write_b32 a50, v11
 s_nop 0
 v_cndmask_b32_dpp v11, v95, v87, vcc quad_perm:[0,1,0,1] row_mask:0xf bank_mask:0xf
 v_accvgpr_write_b32 a51, v11
 s_nop 0
 v_cndmask_b32_dpp v11, v96, v88, vcc quad_perm:[0,1,0,1] row_mask:0xf bank_mask:0xf
 v_accvgpr_write_b32 a52, v11
 s_nop 0
 v_cndmask_b32_dpp v11, v97, v89, vcc quad_perm:[0,1,0,1] row_mask:0xf bank_mask:0xf
 v_accvgpr_write_b32 a53, v11
 s_nop 0
 v_cndmask_b32_dpp v11, v98, v90, vcc quad_perm:[0,1,0,1] row_mask:0xf bank_mask:0xf
 v_accvgpr_write_b32 a54, v11
 s_nop 0
 v_cndmask_b32_dpp v11, v99, v91, vcc quad_perm:[0,1,0,1] row_mask:0xf bank_mask:0xf
 v_accvgpr_write_b32 a55, v11
 s_nop 0
 s_mov_b64 vcc, s[94:95]
 v_cndmask_b32_dpp v11, v36, v44, vcc quad_perm:[2,3,2,3] row_mask:0xf bank_mask:0xf
 v_accvgpr_write_b32 a8, v11
 s_nop 0
 v_cndmask_b32_dpp v11, v37, v45, vcc quad_perm:[2,3,2,3] row_mask:0xf bank_mask:0xf
 v_accvgpr_write_b32 a9, v11
 s_nop 0
 v_cndmask_b32_dpp v11, v38, v46, vcc quad_perm:[2,3,2,3] row_mask:0xf bank_mask:0xf
 v_accvgpr_write_b32 a10, v11
 s_nop 0
 v_cndmask_b32_dpp v11, v39, v47, vcc quad_perm:[2,3,2,3] row_mask:0xf bank_mask:0xf
 v_accvgpr_write_b32 a11, v11
 s_nop 0
 v_cndmask_b32_dpp v11, v40, v48, vcc quad_perm:[2,3,2,3] row_mask:0xf bank_mask:0xf
 v_accvgpr_write_b32 a12, v11
 s_nop 0
 v_cndmask_b32_dpp v11, v41, v49, vcc quad_perm:[2,3,2,3] row_mask:0xf bank_mask:0xf
 v_accvgpr_write_b32 a13, v11
 s_nop 0
 v_cndmask_b32_dpp v11, v42, v50, vcc quad_perm:[2,3,2,3] row_mask:0xf bank_mask:0xf
 v_accvgpr_write_b32 a14, v11
 s_nop 0
 v_cndmask_b32_dpp v11, v43, v51, vcc quad_perm:[2,3,2,3] row_mask:0xf bank_mask:0xf
 v_accvgpr_write_b32 a15, v11
 s_nop 0
 v_cndmask_b32_dpp v11, v52, v60, vcc quad_perm:[2,3,2,3] row_mask:0xf bank_mask:0xf
 v_accvgpr_write_b32 a24, v11
 s_nop 0
 v_cndmask_b32_dpp v11, v53, v61, vcc quad_perm:[2,3,2,3] row_mask:0xf bank_mask:0xf
 v_accvgpr_write_b32 a25, v11
 s_nop 0
 v_cndmask_b32_dpp v11, v54, v62, vcc quad_perm:[2,3,2,3] row_mask:0xf bank_mask:0xf
 v_accvgpr_write_b32 a26, v11
 s_nop 0
 v_cndmask_b32_dpp v11, v55, v63, vcc quad_perm:[2,3,2,3] row_mask:0xf bank_mask:0xf
 v_accvgpr_write_b32 a27, v11
 s_nop 0
 v_cndmask_b32_dpp v11, v56, v64, vcc quad_perm:[2,3,2,3] row_mask:0xf bank_mask:0xf
 v_accvgpr_write_b32 a28, v11
 s_nop 0
 v_cndmask_b32_dpp v11, v57, v65, vcc quad_perm:[2,3,2,3] row_mask:0xf bank_mask:0xf
 v_accvgpr_write_b32 a29, v11
 s_nop 0
 v_cndmask_b32_dpp v11, v58, v66, vcc quad_perm:[2,3,2,3] row_mask:0xf bank_mask:0xf
 v_accvgpr_write_b32 a30, v11
 s_nop 0
 v_cndmask_b32_dpp v11, v59, v67, vcc quad_perm:[2,3,2,3] row_mask:0xf bank_mask:0xf
 v_accvgpr_write_b32 a31, v11
 s_nop 0
 v_cndmask_b32_dpp v11, v68, v76, vcc quad_perm:[2,3,2,3] row_mask:0xf bank_mask:0xf
 v_accvgpr_write_b32 a40, v11
 s_nop 0
 v_cndmask_b32_dpp v11, v69, v77, vcc quad_perm:[2,3,2,3] row_mask:0xf bank_mask:0xf
 v_accvgpr_write_b32 a41, v11
 s_nop 0
 v_cndmask_b32_dpp v11, v70, v78, vcc quad_perm:[2,3,2,3] row_mask:0xf bank_mask:0xf
 v_accvgpr_write_b32 a42, v11
 s_nop 0
 v_cndmask_b32_dpp v11, v71, v79, vcc quad_perm:[2,3,2,3] row_mask:0xf bank_mask:0xf
 v_accvgpr_write_b32 a43, v11
 s_nop 0
 v_cndmask_b32_dpp v11, v72, v80, vcc quad_perm:[2,3,2,3] row_mask:0xf bank_mask:0xf
 v_accvgpr_write_b32 a44, v11
 s_nop 0
 v_cndmask_b32_dpp v11, v73, v81, vcc quad_perm:[2,3,2,3] row_mask:0xf bank_mask:0xf
 v_accvgpr_write_b32 a45, v11
 s_nop 0
 v_cndmask_b32_dpp v11, v74, v82, vcc quad_perm:[2,3,2,3] row_mask:0xf bank_mask:0xf
 v_accvgpr_write_b32 a46, v11
 s_nop 0
 v_cndmask_b32_dpp v11, v75, v83, vcc quad_perm:[2,3,2,3] row_mask:0xf bank_mask:0xf
 v_accvgpr_write_b32 a47, v11
 s_nop 0
 v_cndmask_b32_dpp v11, v84, v92, vcc quad_perm:[2,3,2,3] row_mask:0xf bank_mask:0xf
 v_accvgpr_write_b32 a56, v11
 s_nop 0
 v_cndmask_b32_dpp v11, v85, v93, vcc quad_perm:[2,3,2,3] row_mask:0xf bank_mask:0xf
 v_accvgpr_write_b32 a57, v11
 s_nop 0
 v_cndmask_b32_dpp v11, v86, v94, vcc quad_perm:[2,3,2,3] row_mask:0xf bank_mask:0xf
 v_accvgpr_write_b32 a58, v11
 s_nop 0
 v_cndmask_b32_dpp v11, v87, v95, vcc quad_perm:[2,3,2,3] row_mask:0xf bank_mask:0xf
 v_accvgpr_write_b32 a59, v11
 s_nop 0
 v_cndmask_b32_dpp v11, v88, v96, vcc quad_perm:[2,3,2,3] row_mask:0xf bank_mask:0xf
 v_accvgpr_write_b32 a60, v11
 s_nop 0
 v_cndmask_b32_dpp v11, v89, v97, vcc quad_perm:[2,3,2,3] row_mask:0xf bank_mask:0xf
 v_accvgpr_write_b32 a61, v11
 s_nop 0
 v_cndmask_b32_dpp v11, v90, v98, vcc quad_perm:[2,3,2,3] row_mask:0xf bank_mask:0xf
 v_accvgpr_write_b32 a62, v11
 s_nop 0
 v_cndmask_b32_dpp v11, v91, v99, vcc quad_perm:[2,3,2,3] row_mask:0xf bank_mask:0xf
 v_accvgpr_write_b32 a63, v11
 s_nop 0
 s_waitcnt vmcnt(0)
 s_barrier
 ds_read_b64_tr_b16 v[36:37], v4 offset:0
 ds_read_b64_tr_b16 v[38:39], v5 offset:0
 ds_read_b64_tr_b16 v[44:45], v4 offset:8
 ds_read_b64_tr_b16 v[46:47], v5 offset:8
 ds_read_b64_tr_b16 v[40:41], v4 offset:8192
 ds_read_b64_tr_b16 v[42:43], v5 offset:8192
 ds_read_b64_tr_b16 v[48:49], v4 offset:8200
 ds_read_b64_tr_b16 v[50:51], v5 offset:8200
 ds_read_b64_tr_b16 v[52:53], v4 offset:16384
 ds_read_b64_tr_b16 v[54:55], v5 offset:16384
 ds_read_b64_tr_b16 v[60:61], v4 offset:16392
 ds_read_b64_tr_b16 v[62:63], v5 offset:16392
 ds_read_b64_tr_b16 v[56:57], v4 offset:24576
 ds_read_b64_tr_b16 v[58:59], v5 offset:24576
 ds_read_b64_tr_b16 v[64:65], v4 offset:24584
 ds_read_b64_tr_b16 v[66:67], v5 offset:24584
 ds_read_b64_tr_b16 v[68:69], v4 offset:32768
 ds_read_b64_tr_b16 v[70:71], v5 offset:32768
 ds_read_b64_tr_b16 v[76:77], v4 offset:32776
 ds_read_b64_tr_b16 v[78:79], v5 offset:32776
 ds_read_b64_tr_b16 v[72:73], v4 offset:40960
 ds_read_b64_tr_b16 v[74:75], v5 offset:40960
 ds_read_b64_tr_b16 v[80:81], v4 offset:40968
 ds_read_b64_tr_b16 v[82:83], v5 offset:40968
 ds_read_b64_tr_b16 v[84:85], v4 offset:49152
 ds_read_b64_tr_b16 v[86:87], v5 offset:49152
 ds_read_b64_tr_b16 v[92:93], v4 offset:49160
 ds_read_b64_tr_b16 v[94:95], v5 offset:49160
 ds_read_b64_tr_b16 v[88:89], v4 offset:57344
 ds_read_b64_tr_b16 v[90:91], v5 offset:57344
 ds_read_b64_tr_b16 v[96:97], v4 offset:57352
 ds_read_b64_tr_b16 v[98:99], v5 offset:57352
 s_waitcnt lgkmcnt(0)
 s_mov_b64 vcc, s[92:93]
 v_cndmask_b32_dpp v11, v44, v36, vcc quad_perm:[0,1,0,1] row_mask:0xf bank_mask:0xf
 v_accvgpr_write_b32 a64, v11
 s_nop 0
 v_cndmask_b32_dpp v11, v45, v37, vcc quad_perm:[0,1,0,1] row_mask:0xf bank_mask:0xf
 v_accvgpr_write_b32 a65, v11
 s_nop 0
 v_cndmask_b32_dpp v11, v46, v38, vcc quad_perm:[0,1,0,1] row_mask:0xf bank_mask:0xf
 v_accvgpr_write_b32 a66, v11
 s_nop 0
 v_cndmask_b32_dpp v11, v47, v39, vcc quad_perm:[0,1,0,1] row_mask:0xf bank_mask:0xf
 v_accvgpr_write_b32 a67, v11
 s_nop 0
 v_cndmask_b32_dpp v11, v48, v40, vcc quad_perm:[0,1,0,1] row_mask:0xf bank_mask:0xf
 v_accvgpr_write_b32 a68, v11
 s_nop 0
 v_cndmask_b32_dpp v11, v49, v41, vcc quad_perm:[0,1,0,1] row_mask:0xf bank_mask:0xf
 v_accvgpr_write_b32 a69, v11
 s_nop 0
 v_cndmask_b32_dpp v11, v50, v42, vcc quad_perm:[0,1,0,1] row_mask:0xf bank_mask:0xf
 v_accvgpr_write_b32 a70, v11
 s_nop 0
 v_cndmask_b32_dpp v11, v51, v43, vcc quad_perm:[0,1,0,1] row_mask:0xf bank_mask:0xf
 v_accvgpr_write_b32 a71, v11
 s_nop 0
 v_cndmask_b32_dpp v11, v60, v52, vcc quad_perm:[0,1,0,1] row_mask:0xf bank_mask:0xf
 v_accvgpr_write_b32 a80, v11
 s_nop 0
 v_cndmask_b32_dpp v11, v61, v53, vcc quad_perm:[0,1,0,1] row_mask:0xf bank_mask:0xf
 v_accvgpr_write_b32 a81, v11
 s_nop 0
 v_cndmask_b32_dpp v11, v62, v54, vcc quad_perm:[0,1,0,1] row_mask:0xf bank_mask:0xf
 v_accvgpr_write_b32 a82, v11
 s_nop 0
 v_cndmask_b32_dpp v11, v63, v55, vcc quad_perm:[0,1,0,1] row_mask:0xf bank_mask:0xf
 v_accvgpr_write_b32 a83, v11
 s_nop 0
 v_cndmask_b32_dpp v11, v64, v56, vcc quad_perm:[0,1,0,1] row_mask:0xf bank_mask:0xf
 v_accvgpr_write_b32 a84, v11
 s_nop 0
 v_cndmask_b32_dpp v11, v65, v57, vcc quad_perm:[0,1,0,1] row_mask:0xf bank_mask:0xf
 v_accvgpr_write_b32 a85, v11
 s_nop 0
 v_cndmask_b32_dpp v11, v66, v58, vcc quad_perm:[0,1,0,1] row_mask:0xf bank_mask:0xf
 v_accvgpr_write_b32 a86, v11
 s_nop 0
 v_cndmask_b32_dpp v11, v67, v59, vcc quad_perm:[0,1,0,1] row_mask:0xf bank_mask:0xf
 v_accvgpr_write_b32 a87, v11
 s_nop 0
 v_cndmask_b32_dpp v11, v76, v68, vcc quad_perm:[0,1,0,1] row_mask:0xf bank_mask:0xf
 v_accvgpr_write_b32 a96, v11
 s_nop 0
 v_cndmask_b32_dpp v11, v77, v69, vcc quad_perm:[0,1,0,1] row_mask:0xf bank_mask:0xf
 v_accvgpr_write_b32 a97, v11
 s_nop 0
 v_cndmask_b32_dpp v11, v78, v70, vcc quad_perm:[0,1,0,1] row_mask:0xf bank_mask:0xf
 v_accvgpr_write_b32 a98, v11
 s_nop 0
 v_cndmask_b32_dpp v11, v79, v71, vcc quad_perm:[0,1,0,1] row_mask:0xf bank_mask:0xf
 v_accvgpr_write_b32 a99, v11
 s_nop 0
 v_cndmask_b32_dpp v11, v80, v72, vcc quad_perm:[0,1,0,1] row_mask:0xf bank_mask:0xf
 v_accvgpr_write_b32 a100, v11
 s_nop 0
 v_cndmask_b32_dpp v11, v81, v73, vcc quad_perm:[0,1,0,1] row_mask:0xf bank_mask:0xf
 v_accvgpr_write_b32 a101, v11
 s_nop 0
 v_cndmask_b32_dpp v11, v82, v74, vcc quad_perm:[0,1,0,1] row_mask:0xf bank_mask:0xf
 v_accvgpr_write_b32 a102, v11
 s_nop 0
 v_cndmask_b32_dpp v11, v83, v75, vcc quad_perm:[0,1,0,1] row_mask:0xf bank_mask:0xf
 v_accvgpr_write_b32 a103, v11
 s_nop 0
 v_cndmask_b32_dpp v11, v92, v84, vcc quad_perm:[0,1,0,1] row_mask:0xf bank_mask:0xf
 v_accvgpr_write_b32 a112, v11
 s_nop 0
 v_cndmask_b32_dpp v11, v93, v85, vcc quad_perm:[0,1,0,1] row_mask:0xf bank_mask:0xf
 v_accvgpr_write_b32 a113, v11
 s_nop 0
 v_cndmask_b32_dpp v11, v94, v86, vcc quad_perm:[0,1,0,1] row_mask:0xf bank_mask:0xf
 v_accvgpr_write_b32 a114, v11
 s_nop 0
 v_cndmask_b32_dpp v11, v95, v87, vcc quad_perm:[0,1,0,1] row_mask:0xf bank_mask:0xf
 v_accvgpr_write_b32 a115, v11
 s_nop 0
 v_cndmask_b32_dpp v11, v96, v88, vcc quad_perm:[0,1,0,1] row_mask:0xf bank_mask:0xf
 v_accvgpr_write_b32 a116, v11
 s_nop 0
 v_cndmask_b32_dpp v11, v97, v89, vcc quad_perm:[0,1,0,1] row_mask:0xf bank_mask:0xf
 v_accvgpr_write_b32 a117, v11
 s_nop 0
 v_cndmask_b32_dpp v11, v98, v90, vcc quad_perm:[0,1,0,1] row_mask:0xf bank_mask:0xf
 v_accvgpr_write_b32 a118, v11
 s_nop 0
 v_cndmask_b32_dpp v11, v99, v91, vcc quad_perm:[0,1,0,1] row_mask:0xf bank_mask:0xf
 v_accvgpr_write_b32 a119, v11
 s_nop 0
 s_mov_b64 vcc, s[94:95]
 v_cndmask_b32_dpp v11, v36, v44, vcc quad_perm:[2,3,2,3] row_mask:0xf bank_mask:0xf
 v_accvgpr_write_b32 a72, v11
 s_nop 0
 v_cndmask_b32_dpp v11, v37, v45, vcc quad_perm:[2,3,2,3] row_mask:0xf bank_mask:0xf
 v_accvgpr_write_b32 a73, v11
 s_nop 0
 v_cndmask_b32_dpp v11, v38, v46, vcc quad_perm:[2,3,2,3] row_mask:0xf bank_mask:0xf
 v_accvgpr_write_b32 a74, v11
 s_nop 0
 v_cndmask_b32_dpp v11, v39, v47, vcc quad_perm:[2,3,2,3] row_mask:0xf bank_mask:0xf
 v_accvgpr_write_b32 a75, v11
 s_nop 0
 v_cndmask_b32_dpp v11, v40, v48, vcc quad_perm:[2,3,2,3] row_mask:0xf bank_mask:0xf
 v_accvgpr_write_b32 a76, v11
 s_nop 0
 v_cndmask_b32_dpp v11, v41, v49, vcc quad_perm:[2,3,2,3] row_mask:0xf bank_mask:0xf
 v_accvgpr_write_b32 a77, v11
 s_nop 0
 v_cndmask_b32_dpp v11, v42, v50, vcc quad_perm:[2,3,2,3] row_mask:0xf bank_mask:0xf
 v_accvgpr_write_b32 a78, v11
 s_nop 0
 v_cndmask_b32_dpp v11, v43, v51, vcc quad_perm:[2,3,2,3] row_mask:0xf bank_mask:0xf
 v_accvgpr_write_b32 a79, v11
 s_nop 0
 v_cndmask_b32_dpp v11, v52, v60, vcc quad_perm:[2,3,2,3] row_mask:0xf bank_mask:0xf
 v_accvgpr_write_b32 a88, v11
 s_nop 0
 v_cndmask_b32_dpp v11, v53, v61, vcc quad_perm:[2,3,2,3] row_mask:0xf bank_mask:0xf
 v_accvgpr_write_b32 a89, v11
 s_nop 0
 v_cndmask_b32_dpp v11, v54, v62, vcc quad_perm:[2,3,2,3] row_mask:0xf bank_mask:0xf
 v_accvgpr_write_b32 a90, v11
 s_nop 0
 v_cndmask_b32_dpp v11, v55, v63, vcc quad_perm:[2,3,2,3] row_mask:0xf bank_mask:0xf
 v_accvgpr_write_b32 a91, v11
 s_nop 0
 v_cndmask_b32_dpp v11, v56, v64, vcc quad_perm:[2,3,2,3] row_mask:0xf bank_mask:0xf
 v_accvgpr_write_b32 a92, v11
 s_nop 0
 v_cndmask_b32_dpp v11, v57, v65, vcc quad_perm:[2,3,2,3] row_mask:0xf bank_mask:0xf
 v_accvgpr_write_b32 a93, v11
 s_nop 0
 v_cndmask_b32_dpp v11, v58, v66, vcc quad_perm:[2,3,2,3] row_mask:0xf bank_mask:0xf
 v_accvgpr_write_b32 a94, v11
 s_nop 0
 v_cndmask_b32_dpp v11, v59, v67, vcc quad_perm:[2,3,2,3] row_mask:0xf bank_mask:0xf
 v_accvgpr_write_b32 a95, v11
 s_nop 0
 v_cndmask_b32_dpp v11, v68, v76, vcc quad_perm:[2,3,2,3] row_mask:0xf bank_mask:0xf
 v_accvgpr_write_b32 a104, v11
 s_nop 0
 v_cndmask_b32_dpp v11, v69, v77, vcc quad_perm:[2,3,2,3] row_mask:0xf bank_mask:0xf
 v_accvgpr_write_b32 a105, v11
 s_nop 0
 v_cndmask_b32_dpp v11, v70, v78, vcc quad_perm:[2,3,2,3] row_mask:0xf bank_mask:0xf
 v_accvgpr_write_b32 a106, v11
 s_nop 0
 v_cndmask_b32_dpp v11, v71, v79, vcc quad_perm:[2,3,2,3] row_mask:0xf bank_mask:0xf
 v_accvgpr_write_b32 a107, v11
 s_nop 0
 v_cndmask_b32_dpp v11, v72, v80, vcc quad_perm:[2,3,2,3] row_mask:0xf bank_mask:0xf
 v_accvgpr_write_b32 a108, v11
 s_nop 0
 v_cndmask_b32_dpp v11, v73, v81, vcc quad_perm:[2,3,2,3] row_mask:0xf bank_mask:0xf
 v_accvgpr_write_b32 a109, v11
 s_nop 0
 v_cndmask_b32_dpp v11, v74, v82, vcc quad_perm:[2,3,2,3] row_mask:0xf bank_mask:0xf
 v_accvgpr_write_b32 a110, v11
 s_nop 0
 v_cndmask_b32_dpp v11, v75, v83, vcc quad_perm:[2,3,2,3] row_mask:0xf bank_mask:0xf
 v_accvgpr_write_b32 a111, v11
 s_nop 0
 v_cndmask_b32_dpp v11, v84, v92, vcc quad_perm:[2,3,2,3] row_mask:0xf bank_mask:0xf
 v_accvgpr_write_b32 a120, v11
 s_nop 0
 v_cndmask_b32_dpp v11, v85, v93, vcc quad_perm:[2,3,2,3] row_mask:0xf bank_mask:0xf
 v_accvgpr_write_b32 a121, v11
 s_nop 0
 v_cndmask_b32_dpp v11, v86, v94, vcc quad_perm:[2,3,2,3] row_mask:0xf bank_mask:0xf
 v_accvgpr_write_b32 a122, v11
 s_nop 0
 v_cndmask_b32_dpp v11, v87, v95, vcc quad_perm:[2,3,2,3] row_mask:0xf bank_mask:0xf
 v_accvgpr_write_b32 a123, v11
 s_nop 0
 v_cndmask_b32_dpp v11, v88, v96, vcc quad_perm:[2,3,2,3] row_mask:0xf bank_mask:0xf
 v_accvgpr_write_b32 a124, v11
 s_nop 0
 v_cndmask_b32_dpp v11, v89, v97, vcc quad_perm:[2,3,2,3] row_mask:0xf bank_mask:0xf
 v_accvgpr_write_b32 a125, v11
 s_nop 0
 v_cndmask_b32_dpp v11, v90, v98, vcc quad_perm:[2,3,2,3] row_mask:0xf bank_mask:0xf
 v_accvgpr_write_b32 a126, v11
 s_nop 0
 v_cndmask_b32_dpp v11, v91, v99, vcc quad_perm:[2,3,2,3] row_mask:0xf bank_mask:0xf
 v_accvgpr_write_b32 a127, v11
 s_nop 0
 s_barrier
 s_getpc_b64 s[94:95]
L_or_pc_90:
 s_sub_u32 s94, s94, L_or_pc_90-L_role_p_0
 s_subb_u32 s95, s95, 0
 s_lshl_b32 s65, s74, 2
 s_add_u32 s65, s65, s62
 s_mul_i32 s65, s65, 1152
 v_min_u32 v6, 8, v0
 v_lshlrev_b32 v6, 7, v6
 v_add_u32 v6, s65, v6
 global_load_dword v9, v6, s[94:95]
 v_lshlrev_b32 v6, 2, v0
 s_lshr_b32 s66, s101, 2
 s_add_u32 s66, s66, 1
 s_branch L_hs1_92
L_hs_91:
 s_sleep 8
 s_sub_u32 s63, s63, 1
 s_cbranch_scc1 L_role_o_0_abort
L_hs1_92:
 buffer_load_dword v7, v6, s[16:19], 0 offen sc1
 s_waitcnt vmcnt(0)
 v_readlane_b32 s65, v7, s66
 s_cmp_eq_u32 s101, 128
 s_cbranch_scc1 L_hs2_93
 s_cmp_eq_u32 s101, 64
 s_cbranch_scc1 L_hs3_94
 v_readlane_b32 s67, v7, 9
 v_cmp_eq_u32 s[96:97], -1, v7
 s_mov_b32 vcc_lo, 0x20202020
 s_mov_b32 vcc_hi, 0x20202020
 s_nop 1
 s_cmp_lg_u32 s67, 0
 s_cbranch_scc1 L_retry
 s_andn2_b64 s[96:97], vcc, s[96:97]
 s_cbranch_scc1 L_hs_91
 s_branch L_hs2_93
L_hs3_94:
 v_readlane_b32 s67, v7, 10
 v_cmp_eq_u32 s[96:97], 32, v7
 s_mov_b32 vcc_lo, 0x01010101
 s_mov_b32 vcc_hi, 0x01010101
 s_nop 1
 s_cmp_lg_u32 s67, 0
 s_cbranch_scc1 L_fallback
 s_andn2_b64 s[96:97], vcc, s[96:97]
 s_cbranch_scc1 L_hs_91
L_hs2_93:
 s_cmp_ge_u32 s65, 64
 s_cbranch_scc0 L_hs_91
 s_mov_b32 s64, -1
 buffer_load_dwordx4 v[216:219], v17, s[4:7], s71 offen sc1
 s_add_u32 s65, s64, 1
 s_and_b32 s66, s65, 3
 s_lshl_b32 s66, s66, 13
 s_add_u32 s89, s66, s76
 s_add_u32 s90, s89, 4096
 s_branch L_or_xd1_96
L_or_xd_95:
 s_sleep 4
 buffer_load_dwordx4 v[216:219], v17, s[4:7], s71 offen sc1
 s_sub_u32 s63, s63, 1
 s_cbranch_scc1 L_role_o_0_abort
L_or_xd1_96:
 s_waitcnt vmcnt(0)
 v_min3_u32 v11, v216, v217, v218
 v_min_u32 v11, v11, v219
 v_cmp_ge_u32 vcc, s65, v11
 s_cbranch_vccnz L_or_xd_95
 s_lshl_b32 m0, s62, 13
 s_add_u32 m0, m0, 0
 s_nop 0
 buffer_load_dwordx4 v12, s[4:7], s89 offen offset:0 sc1 lds
 buffer_load_dwordx4 v12, s[4:7], s89 offen offset:1024 sc1 lds
 buffer_load_dwordx4 v12, s[4:7], s89 offen offset:2048 sc1 lds
 buffer_load_dwordx4 v12, s[4:7], s89 offen offset:3072 sc1 lds
 s_lshl_b32 m0, s62, 13
 s_add_u32 m0, m0, 4096
 s_nop 0
 buffer_load_dwordx4 v12, s[4:7], s90 offen offset:0 sc1 lds
 buffer_load_dwordx4 v12, s[4:7], s90 offen offset:1024 sc1 lds
 buffer_load_dwordx4 v12, s[4:7], s90 offen offset:2048 sc1 lds
 buffer_load_dwordx4 v12, s[4:7], s90 offen offset:3072 sc1 lds
 s_waitcnt vmcnt(0)
 s_barrier
 ds_read_b128 v[52:55], v12 offset:0
 ds_read_b128 v[56:59], v12 offset:1024
 ds_read_b128 v[60:63], v12 offset:2048
 ds_read_b128 v[64:67], v12 offset:3072
 ds_read_b128 v[68:71], v12 offset:8192
 ds_read_b128 v[72:75], v12 offset:9216
 s_waitcnt lgkmcnt(4)
 v_mfma_f32_16x16x32_bf16 v[84:87], v[52:55], a[0:3], 0
 ds_read_b128 v[76:79], v12 offset:10240
 v_mfma_f32_16x16x32_bf16 v[88:91], v[52:55], a[8:11], 0
 v_mfma_f32_16x16x32_bf16 v[84:87], v[56:59], a[4:7], v[84:87]
 ds_read_b128 v[80:83], v12 offset:11264
 v_mfma_f32_16x16x32_bf16 v[88:91], v[56:59], a[12:15], v[88:91]
 s_waitcnt lgkmcnt(4)
 v_mfma_f32_16x16x32_bf16 v[84:87], v[60:63], a[16:19], v[84:87]
 ds_read_b128 v[52:55], v12 offset:16384
 v_mfma_f32_16x16x32_bf16 v[88:91], v[60:63], a[24:27], v[88:91]
 v_mfma_f32_16x16x32_bf16 v[84:87], v[64:67], a[20:23], v[84:87]
 ds_read_b128 v[56:59], v12 offset:17408
 v_mfma_f32_16x16x32_bf16 v[88:91], v[64:67], a[28:31], v[88:91]
 s_waitcnt lgkmcnt(4)
 v_mfma_f32_16x16x32_bf16 v[92:95], v[68:71], a[32:35], 0
 ds_read_b128 v[60:63], v12 offset:18432
 v_mfma_f32_16x16x32_bf16 v[96:99], v[68:71], a[40:43], 0
 v_mfma_f32_16x16x32_bf16 v[92:95], v[72:75], a[36:39], v[92:95]
 ds_read_b128 v[64:67], v12 offset:19456
 v_mfma_f32_16x16x32_bf16 v[96:99], v[72:75], a[44:47], v[96:99]
 s_waitcnt lgkmcnt(4)
 v_mfma_f32_16x16x32_bf16 v[92:95], v[76:79], a[48:51], v[92:95]
 ds_read_b128 v[68:71], v12 offset:24576
 v_mfma_f32_16x16x32_bf16 v[96:99], v[76:79], a[56:59], v[96:99]
 v_mfma_f32_16x16x32_bf16 v[92:95], v[80:83], a[52:55], v[92:95]
 ds_read_b128 v[72:75], v12 offset:25600
 v_mfma_f32_16x16x32_bf16 v[96:99], v[80:83], a[60:63], v[96:99]
 s_waitcnt lgkmcnt(4)
 v_mfma_f32_16x16x32_bf16 v[100:103], v[52:55], a[64:67], 0
 ds_read_b128 v[76:79], v12 offset:26624
 v_mfma_f32_16x16x32_bf16 v[104:107], v[52:55], a[72:75], 0
 v_cvt_pk_bf16_f32 v120, v84, v85
 v_mfma_f32_16x16x32_bf16 v[100:103], v[56:59], a[68:71], v[100:103]
 ds_read_b128 v[80:83], v12 offset:27648
 v_mfma_f32_16x16x32_bf16 v[104:107], v[56:59], a[76:79], v[104:107]
 v_cvt_pk_bf16_f32 v121, v86, v87
 s_waitcnt lgkmcnt(4)
 v_mfma_f32_16x16x32_bf16 v[100:103], v[60:63], a[80:83], v[100:103]
 ds_read_b128 v[52:55], v12 offset:4096
 v_mfma_f32_16x16x32_bf16 v[104:107], v[60:63], a[88:91], v[104:107]
 v_cvt_pk_bf16_f32 v136, v88, v89
 v_mfma_f32_16x16x32_bf16 v[100:103], v[64:67], a[84:87], v[100:103]
 ds_read_b128 v[56:59], v12 offset:5120
 v_mfma_f32_16x16x32_bf16 v[104:107], v[64:67], a[92:95], v[104:107]
 v_cvt_pk_bf16_f32 v137, v90, v91
 s_waitcnt lgkmcnt(4)
 v_mfma_f32_16x16x32_bf16 v[108:111], v[68:71], a[96:99], 0
 ds_read_b128 v[60:63], v12 offset:6144
 v_mfma_f32_16x16x32_bf16 v[112:115], v[68:71], a[104:107], 0
 v_cvt_pk_bf16_f32 v124, v92, v93
 v_mfma_f32_16x16x32_bf16 v[108:111], v[72:75], a[100:103], v[108:111]
 ds_read_b128 v[64:67], v12 offset:7168
 v_mfma_f32_16x16x32_bf16 v[112:115], v[72:75], a[108:111], v[112:115]
 v_cvt_pk_bf16_f32 v125, v94, v95
 s_waitcnt lgkmcnt(4)
 v_mfma_f32_16x16x32_bf16 v[108:111], v[76:79], a[112:115], v[108:111]
 ds_read_b128 v[68:71], v12 offset:12288
 v_mfma_f32_16x16x32_bf16 v[112:115], v[76:79], a[120:123], v[112:115]
 v_cvt_pk_bf16_f32 v140, v96, v97
 v_mfma_f32_16x16x32_bf16 v[108:111], v[80:83], a[116:119], v[108:111]
 ds_read_b128 v[72:75], v12 offset:13312
 v_mfma_f32_16x16x32_bf16 v[112:115], v[80:83], a[124:127], v[112:115]
 v_cvt_pk_bf16_f32 v141, v98, v99
 s_waitcnt lgkmcnt(4)
 v_mfma_f32_16x16x32_bf16 v[84:87], v[52:55], a[0:3], 0
 ds_read_b128 v[76:79], v12 offset:14336
 v_mfma_f32_16x16x32_bf16 v[88:91], v[52:55], a[8:11], 0
 v_cvt_pk_bf16_f32 v128, v100, v101
 v_mfma_f32_16x16x32_bf16 v[84:87], v[56:59], a[4:7], v[84:87]
 ds_read_b128 v[80:83], v12 offset:15360
 v_mfma_f32_16x16x32_bf16 v[88:91], v[56:59], a[12:15], v[88:91]
 v_cvt_pk_bf16_f32 v129, v102, v103
 s_waitcnt lgkmcnt(4)
 v_mfma_f32_16x16x32_bf16 v[84:87], v[60:63], a[16:19], v[84:87]
 ds_read_b128 v[52:55], v12 offset:20480
 v_mfma_f32_16x16x32_bf16 v[88:91], v[60:63], a[24:27], v[88:91]
 v_cvt_pk_bf16_f32 v144, v104, v105
 v_mfma_f32_16x16x32_bf16 v[84:87], v[64:67], a[20:23], v[84:87]
 ds_read_b128 v[56:59], v12 offset:21504
 v_mfma_f32_16x16x32_bf16 v[88:91], v[64:67], a[28:31], v[88:91]
 v_cvt_pk_bf16_f32 v145, v106, v107
 s_waitcnt lgkmcnt(4)
 v_mfma_f32_16x16x32_bf16 v[92:95], v[68:71], a[32:35], 0
 ds_read_b128 v[60:63], v12 offset:22528
 v_mfma_f32_16x16x32_bf16 v[96:99], v[68:71], a[40:43], 0
 v_cvt_pk_bf16_f32 v132, v108, v109
 v_mfma_f32_16x16x32_bf16 v[92:95], v[72:75], a[36:39], v[92:95]
 ds_read_b128 v[64:67], v12 offset:23552
 v_mfma_f32_16x16x32_bf16 v[96:99], v[72:75], a[44:47], v[96:99]
 v_cvt_pk_bf16_f32 v133, v110, v111
 s_waitcnt lgkmcnt(4)
 v_mfma_f32_16x16x32_bf16 v[92:95], v[76:79], a[48:51], v[92:95]
 ds_read_b128 v[68:71], v12 offset:28672
 v_mfma_f32_16x16x32_bf16 v[96:99], v[76:79], a[56:59], v[96:99]
 v_cvt_pk_bf16_f32 v148, v112, v113
 v_mfma_f32_16x16x32_bf16 v[92:95], v[80:83], a[52:55], v[92:95]
 ds_read_b128 v[72:75], v12 offset:29696
 v_mfma_f32_16x16x32_bf16 v[96:99], v[80:83], a[60:63], v[96:99]
 v_cvt_pk_bf16_f32 v149, v114, v115
 s_waitcnt lgkmcnt(4)
 v_mfma_f32_16x16x32_bf16 v[100:103], v[52:55], a[64:67], 0
 ds_read_b128 v[76:79], v12 offset:30720
 v_mfma_f32_16x16x32_bf16 v[104:107], v[52:55], a[72:75], 0
 v_cvt_pk_bf16_f32 v122, v84, v85
 v_mfma_f32_16x16x32_bf16 v[100:103], v[56:59], a[68:71], v[100:103]
 ds_read_b128 v[80:83], v12 offset:31744
 v_mfma_f32_16x16x32_bf16 v[104:107], v[56:59], a[76:79], v[104:107]
 v_cvt_pk_bf16_f32 v123, v86, v87
 s_waitcnt lgkmcnt(4)
 v_mfma_f32_16x16x32_bf16 v[100:103], v[60:63], a[80:83], v[100:103]
 v_mfma_f32_16x16x32_bf16 v[104:107], v[60:63], a[88:91], v[104:107]
 v_cvt_pk_bf16_f32 v138, v88, v89
 v_mfma_f32_16x16x32_bf16 v[100:103], v[64:67], a[84:87], v[100:103]
 v_mfma_f32_16x16x32_bf16 v[104:107], v[64:67], a[92:95], v[104:107]
 v_cvt_pk_bf16_f32 v139, v90, v91
 s_waitcnt lgkmcnt(2)
 v_mfma_f32_16x16x32_bf16 v[108:111], v[68:71], a[96:99], 0
 v_mfma_f32_16x16x32_bf16 v[112:115], v[68:71], a[104:107], 0
 buffer_load_dwordx4 v[216:219], v17, s[4:7], s71 offen sc1
 v_cvt_pk_bf16_f32 v126, v92, v93
 v_mfma_f32_16x16x32_bf16 v[108:111], v[72:75], a[100:103], v[108:111]
 v_mfma_f32_16x16x32_bf16 v[112:115], v[72:75], a[108:111], v[112:115]
 v_cvt_pk_bf16_f32 v127, v94, v95
 s_waitcnt lgkmcnt(0)
 v_mfma_f32_16x16x32_bf16 v[108:111], v[76:79], a[112:115], v[108:111]
 v_mfma_f32_16x16x32_bf16 v[112:115], v[76:79], a[120:123], v[112:115]
 v_cvt_pk_bf16_f32 v142, v96, v97
 v_mfma_f32_16x16x32_bf16 v[108:111], v[80:83], a[116:119], v[108:111]
 v_mfma_f32_16x16x32_bf16 v[112:115], v[80:83], a[124:127], v[112:115]
 v_cvt_pk_bf16_f32 v143, v98, v99
 s_nop 3
 v_cvt_pk_bf16_f32 v130, v100, v101
 v_cvt_pk_bf16_f32 v131, v102, v103
 v_cvt_pk_bf16_f32 v146, v104, v105
 v_cvt_pk_bf16_f32 v147, v106, v107
 v_cvt_pk_bf16_f32 v134, v108, v109
 v_cvt_pk_bf16_f32 v135, v110, v111
 v_cvt_pk_bf16_f32 v150, v112, v113
 v_cvt_pk_bf16_f32 v151, v114, v115
 v_mov_b64 v[208:209], 0
 v_mov_b64 v[210:211], 0
 v_mov_b64 v[212:213], 0
 v_mov_b64 v[214:215], 0
 s_barrier
 s_mov_b32 s64, 0
 s_add_u32 s65, s64, 1
 s_and_b32 s66, s65, 3
 s_lshl_b32 s66, s66, 13
 s_add_u32 s89, s66, s76
 s_add_u32 s90, s89, 4096
 s_branch L_or_xd1_98
L_or_xd_97:
 buffer_load_dwordx4 v[216:219], v17, s[4:7], s71 offen sc1
 s_sub_u32 s63, s63, 1
 s_cbranch_scc1 L_role_o_0_abort
L_or_xd1_98:
 s_waitcnt vmcnt(0)
 v_min3_u32 v11, v216, v217, v218
 v_min_u32 v11, v11, v219
 v_cmp_ge_u32 vcc, s65, v11
 s_cbranch_vccnz L_or_xd_97
 s_lshl_b32 m0, s62, 13
 s_add_u32 m0, m0, 0
 s_nop 0
 buffer_load_dwordx4 v12, s[4:7], s89 offen offset:0 sc1 lds
 v_mov_b64 v[224:225], 0
 v_mov_b64 v[226:227], 0
 v_mov_b64 v[228:229], 0
 v_mov_b64 v[230:231], 0
 v_mov_b64 v[84:85], 0
 v_mov_b64 v[86:87], 0
 buffer_load_dwordx4 v12, s[4:7], s89 offen offset:1024 sc1 lds
 v_mov_b64 v[88:89], 0
 v_mov_b64 v[90:91], 0
 v_mov_b64 v[92:93], 0
 v_mov_b64 v[94:95], 0
 v_mov_b64 v[96:97], 0
 v_mov_b64 v[98:99], 0
 buffer_load_dwordx4 v12, s[4:7], s89 offen offset:2048 sc1 lds
 v_mov_b64 v[100:101], 0
 v_mov_b64 v[102:103], 0
 v_mov_b64 v[104:105], 0
 v_mov_b64 v[106:107], 0
 v_mov_b64 v[108:109], 0
 v_mov_b64 v[110:111], 0
 buffer_load_dwordx4 v12, s[4:7], s89 offen offset:3072 sc1 lds
 v_mov_b64 v[112:113], 0
 v_mov_b64 v[114:115], 0
 s_max_i32 s84, s64, 1
 s_sub_u32 s84, s84, 1
 s_lshl_b32 s84, s84, 11
 s_add_u32 s84, s84, s82
 s_lshl_b32 m0, s62, 13
 s_add_u32 m0, m0, 4096
 s_nop 0
 buffer_load_dwordx4 v12, s[4:7], s90 offen offset:0 sc1 lds
 s_and_b32 s65, s64, 3
 s_lshl_b32 s65, s65, 11
 s_add_u32 s85, s65, s75
 s_and_b32 s65, s64, 3
 s_lshl_b32 s86, s65, 12
 s_add_u32 s86, s86, s77
 buffer_load_dwordx4 v12, s[4:7], s90 offen offset:1024 sc1 lds
 s_lshl_b32 s91, s65, 14
 s_add_u32 s91, s91, s78
 s_lshl_b32 s87, s65, 18
 s_xor_b32 s88, s87, 0x80000
 s_add_u32 s87, s87, s79
 s_add_u32 s88, s88, s79
 buffer_load_dwordx4 v12, s[4:7], s90 offen offset:2048 sc1 lds
 s_lshl_b32 s69, s65, 10
 s_xor_b32 s70, s69, 2048
 s_add_u32 s69, s69, s81
 s_add_u32 s70, s70, s81
 s_cmp_lt_u32 s64, 63
 s_cselect_b32 s83, 3, 0
 buffer_load_dwordx4 v12, s[4:7], s90 offen offset:3072 sc1 lds
L_or_loop_99:
 buffer_load_dwordx4 v[200:203], v12, s[4:7], s85 offen offset:0 sc1
 buffer_load_dwordx4 v[204:207], v12, s[4:7], s85 offen offset:1024 sc1
 s_nop 15
 s_nop 11
L_poll_100:
 buffer_load_dwordx4 v[200:203], v12, s[4:7], s85 offen offset:0 sc1
 buffer_load_dwordx4 v[204:207], v12, s[4:7], s85 offen offset:1024 sc1
 s_sub_u32 s63, s63, 1
 s_cbranch_scc1 L_role_o_0_abort
 s_waitcnt vmcnt(2)
 v_max3_u32 v11, v200, v202, v204
 v_max_u32 v11, v11, v206
 v_cmp_eq_u32 vcc, -1, v11
 s_cbranch_vccnz L_poll_100
 ds_write_b128 v15, v[200:203] offset:0
 ds_write_b128 v15, v[204:207] offset:1024
 s_waitcnt lgkmcnt(0)
 s_barrier
 ds_read_b128 v[36:39], v12 offset:49152
 ds_read_b128 v[40:43], v12 offset:50176
 ds_read_b128 v[44:47], v12 offset:51200
 ds_read_b128 v[48:51], v12 offset:52224
 ds_read_b128 v[52:55], v12 offset:53248
 ds_read_b128 v[56:59], v12 offset:54272
 ds_read_b128 v[60:63], v12 offset:55296
 ds_read_b128 v[64:67], v12 offset:56320
 s_waitcnt lgkmcnt(7)
 v_smfmac_f32_16x16x64_bf16 v[84:87], v[36:39], a[0:7], v33
 v_smfmac_f32_16x16x64_bf16 v[88:91], v[36:39], a[8:15], v33
 s_waitcnt lgkmcnt(6)
 v_smfmac_f32_16x16x64_bf16 v[84:87], v[40:43], a[16:23], v33
 v_smfmac_f32_16x16x64_bf16 v[88:91], v[40:43], a[24:31], v33
 s_waitcnt lgkmcnt(5)
 v_smfmac_f32_16x16x64_bf16 v[92:95], v[44:47], a[32:39], v33
 v_smfmac_f32_16x16x64_bf16 v[96:99], v[44:47], a[40:47], v33
 s_waitcnt lgkmcnt(4)
 v_smfmac_f32_16x16x64_bf16 v[92:95], v[48:51], a[48:55], v33
 v_smfmac_f32_16x16x64_bf16 v[96:99], v[48:51], a[56:63], v33
 s_nop 0
 s_waitcnt lgkmcnt(3)
 v_smfmac_f32_16x16x64_bf16 v[100:103], v[52:55], a[64:71], v33
 v_cvt_pk_bf16_f32 v152, v84, v85
 v_smfmac_f32_16x16x64_bf16 v[104:107], v[52:55], a[72:79], v33
 v_cvt_pk_bf16_f32 v153, v86, v87
 s_waitcnt lgkmcnt(2)
 v_smfmac_f32_16x16x64_bf16 v[100:103], v[56:59], a[80:87], v33
 v_cvt_pk_bf16_f32 v160, v88, v89
 v_smfmac_f32_16x16x64_bf16 v[104:107], v[56:59], a[88:95], v33
 v_cvt_pk_bf16_f32 v161, v90, v91
 s_waitcnt lgkmcnt(1)
 v_smfmac_f32_16x16x64_bf16 v[108:111], v[60:63], a[96:103], v33
 v_cvt_pk_bf16_f32 v154, v92, v93
 v_smfmac_f32_16x16x64_bf16 v[112:115], v[60:63], a[104:111], v33
 buffer_load_dwordx4 v[220:223], v12, s[4:7], s86 offen sc1
 v_cvt_pk_bf16_f32 v155, v94, v95
 s_waitcnt lgkmcnt(0)
 v_smfmac_f32_16x16x64_bf16 v[108:111], v[64:67], a[112:119], v33
 v_cvt_pk_bf16_f32 v162, v96, v97
 v_smfmac_f32_16x16x64_bf16 v[112:115], v[64:67], a[120:127], v33
 v_cvt_pk_bf16_f32 v163, v98, v99
 v_cvt_pk_bf16_f32 v156, v100, v101
 v_cvt_pk_bf16_f32 v157, v102, v103
 v_cvt_pk_bf16_f32 v164, v104, v105
 v_cvt_pk_bf16_f32 v165, v106, v107
 s_mul_i32 m0, s62, 3072
 s_add_u32 m0, m0, 32768
 s_nop 1
 v_cvt_pk_bf16_f32 v158, v108, v109
 v_cvt_pk_bf16_f32 v159, v110, v111
 v_cvt_pk_bf16_f32 v166, v112, v113
 v_cvt_pk_bf16_f32 v167, v114, v115
 s_cmp_lt_u32 s62, s83
 s_cbranch_scc1 L_or_pp_103
 s_waitcnt vmcnt(0)
 s_cmp_lt_u32 s64, 63
 s_cbranch_scc1 L_or_ppd_104
 s_branch L_pfirst_106
L_poll_105:
 s_sub_u32 s63, s63, 1
 s_cbranch_scc1 L_role_o_0_abort
L_pfirst_106:
 buffer_load_dwordx4 v[36:39], v12, s[4:7], s91 offen offset:0 sc1
 buffer_load_dwordx4 v[40:43], v12, s[4:7], s91 offen offset:1024 sc1
 buffer_load_dwordx4 v[44:47], v12, s[4:7], s91 offen offset:2048 sc1
 s_waitcnt vmcnt(0)
 v_max3_u32 v11, v36, v38, v40
 v_max3_u32 v11, v11, v42, v44
 v_max_u32 v11, v11, v46
 v_cmp_eq_u32 vcc, -1, v11
 s_cbranch_vccnz L_poll_105
 v_add_u32 v11, m0, v12
 ds_write_b128 v11, v[36:39] offset:0
 ds_write_b128 v11, v[40:43] offset:1024
 ds_write_b128 v11, v[44:47] offset:2048
 s_waitcnt lgkmcnt(0)
 s_branch L_or_pxwait_102
L_or_pp_103:
 buffer_load_dwordx4 v[220:223], v12, s[4:7], s86 offen sc1
 s_sub_u32 s63, s63, 1
 s_cbranch_scc1 L_role_o_0_abort
 s_waitcnt vmcnt(1)
 v_max3_u32 v11, v220, v221, v222
 v_max_u32 v11, v11, v223
 ds_write_b128 v14, v[220:223]
 v_cmp_eq_u32 vcc, -1, v11
 s_cbranch_vccnz L_or_pp_103
L_or_ppd_104:
 s_waitcnt lgkmcnt(0)
 s_barrier
 ds_read_b128 v[36:39], v12 offset:57344
 ds_read_b128 v[40:43], v12 offset:58368
 ds_read_b128 v[44:47], v12 offset:59392
 buffer_store_dword v17, v24, s[4:7], s69 offen
 s_waitcnt lgkmcnt(2)
 v_smfmac_f32_16x16x64_bf16 v[224:227], v[36:39], v[120:127], v34
 v_smfmac_f32_16x16x64_bf16 v[228:231], v[36:39], v[136:143], v34
 s_waitcnt lgkmcnt(1)
 v_smfmac_f32_16x16x64_bf16 v[224:227], v[40:43], v[128:135], v34
 v_smfmac_f32_16x16x64_bf16 v[228:231], v[40:43], v[144:151], v34
 s_waitcnt lgkmcnt(0)
 v_smfmac_f32_16x16x64_bf16 v[224:227], v[44:47], v[152:159], v34
 v_smfmac_f32_16x16x64_bf16 v[228:231], v[44:47], v[160:167], v34
 s_nop 6
 v_pk_add_f32 v[224:225], v[224:225], v[226:227]
 v_pk_add_f32 v[228:229], v[228:229], v[230:231]
 v_cvt_pk_bf16_f32 v28, v224, v225
 v_cvt_pk_bf16_f32 v29, v228, v229
 v_cvt_pk_bf16_f32 v31, v228, v229
 v_min_u32 v30, -2, v28
 v_min_u32 v28, -2, v28
 v_permlane32_swap_b32 v29, v31
 s_nop 0
 v_permlane32_swap_b32 v28, v30
 buffer_store_dwordx4 v[28:31], v13, s[4:7], s87 offen sc1
 ds_read_b128 v[52:55], v12 offset:0
 ds_read_b128 v[56:59], v12 offset:1024
 ds_read_b128 v[60:63], v12 offset:2048
 ds_read_b128 v[64:67], v12 offset:3072
 ds_read_b128 v[68:71], v12 offset:8192
 ds_read_b128 v[72:75], v12 offset:9216
 s_waitcnt lgkmcnt(4)
 v_mfma_f32_16x16x32_bf16 v[84:87], v[52:55], a[0:3], 0
 ds_read_b128 v[76:79], v12 offset:10240
 v_mfma_f32_16x16x32_bf16 v[88:91], v[52:55], a[8:11], 0
 v_mfma_f32_16x16x32_bf16 v[84:87], v[56:59], a[4:7], v[84:87]
 ds_read_b128 v[80:83], v12 offset:11264
 v_mfma_f32_16x16x32_bf16 v[88:91], v[56:59], a[12:15], v[88:91]
 s_waitcnt lgkmcnt(4)
 v_mfma_f32_16x16x32_bf16 v[84:87], v[60:63], a[16:19], v[84:87]
 ds_read_b128 v[52:55], v12 offset:16384
 v_mfma_f32_16x16x32_bf16 v[88:91], v[60:63], a[24:27], v[88:91]
 v_mfma_f32_16x16x32_bf16 v[84:87], v[64:67], a[20:23], v[84:87]
 ds_read_b128 v[56:59], v12 offset:17408
 v_mfma_f32_16x16x32_bf16 v[88:91], v[64:67], a[28:31], v[88:91]
 s_waitcnt lgkmcnt(4)
 v_mfma_f32_16x16x32_bf16 v[92:95], v[68:71], a[32:35], 0
 ds_read_b128 v[60:63], v12 offset:18432
 v_mfma_f32_16x16x32_bf16 v[96:99], v[68:71], a[40:43], 0
 buffer_load_dwordx4 v12, s[4:7], s91 offen offset:0 sc1 lds
 v_mfma_f32_16x16x32_bf16 v[92:95], v[72:75], a[36:39], v[92:95]
 ds_read_b128 v[64:67], v12 offset:19456
 v_mfma_f32_16x16x32_bf16 v[96:99], v[72:75], a[44:47], v[96:99]
 s_waitcnt lgkmcnt(4)
 v_mfma_f32_16x16x32_bf16 v[92:95], v[76:79], a[48:51], v[92:95]
 ds_read_b128 v[68:71], v12 offset:24576
 v_mfma_f32_16x16x32_bf16 v[96:99], v[76:79], a[56:59], v[96:99]
 buffer_load_dwordx4 v12, s[4:7], s91 offen offset:1024 sc1 lds
 v_mfma_f32_16x16x32_bf16 v[92:95], v[80:83], a[52:55], v[92:95]
 ds_read_b128 v[72:75], v12 offset:25600
 v_mfma_f32_16x16x32_bf16 v[96:99], v[80:83], a[60:63], v[96:99]
 s_waitcnt lgkmcnt(4)
 v_mfma_f32_16x16x32_bf16 v[100:103], v[52:55], a[64:67], 0
 ds_read_b128 v[76:79], v12 offset:26624
 v_mfma_f32_16x16x32_bf16 v[104:107], v[52:55], a[72:75], 0
 buffer_load_dwordx4 v12, s[4:7], s91 offen offset:2048 sc1 lds
 v_cvt_pk_bf16_f32 v168, v84, v85
 v_mfma_f32_16x16x32_bf16 v[100:103], v[56:59], a[68:71], v[100:103]
 ds_read_b128 v[80:83], v12 offset:27648
 v_mfma_f32_16x16x32_bf16 v[104:107], v[56:59], a[76:79], v[104:107]
 v_cvt_pk_bf16_f32 v169, v86, v87
 s_waitcnt lgkmcnt(4)
 v_mfma_f32_16x16x32_bf16 v[100:103], v[60:63], a[80:83], v[100:103]
 ds_read_b128 v[52:55], v12 offset:4096
 v_mfma_f32_16x16x32_bf16 v[104:107], v[60:63], a[88:91], v[104:107]
 v_cvt_pk_bf16_f32 v184, v88, v89
 v_mfma_f32_16x16x32_bf16 v[100:103], v[64:67], a[84:87], v[100:103]
 ds_read_b128 v[56:59], v12 offset:5120
 v_mfma_f32_16x16x32_bf16 v[104:107], v[64:67], a[92:95], v[104:107]
 v_cvt_pk_bf16_f32 v185, v90, v91
 s_waitcnt lgkmcnt(4)
 v_mfma_f32_16x16x32_bf16 v[108:111], v[68:71], a[96:99], 0
 ds_read_b128 v[60:63], v12 offset:6144
 v_mfma_f32_16x16x32_bf16 v[112:115], v[68:71], a[104:107], 0
 v_cvt_pk_bf16_f32 v172, v92, v93
 v_mfma_f32_16x16x32_bf16 v[108:111], v[72:75], a[100:103], v[108:111]
 ds_read_b128 v[64:67], v12 offset:7168
 v_mfma_f32_16x16x32_bf16 v[112:115], v[72:75], a[108:111], v[112:115]
 v_cvt_pk_bf16_f32 v173, v94, v95
 s_waitcnt lgkmcnt(4)
 v_mfma_f32_16x16x32_bf16 v[108:111], v[76:79], a[112:115], v[108:111]
 ds_read_b128 v[68:71], v12 offset:12288
 v_mfma_f32_16x16x32_bf16 v[112:115], v[76:79], a[120:123], v[112:115]
 v_cvt_pk_bf16_f32 v188, v96, v97
 v_mfma_f32_16x16x32_bf16 v[108:111], v[80:83], a[116:119], v[108:111]
 ds_read_b128 v[72:75], v12 offset:13312
 v_mfma_f32_16x16x32_bf16 v[112:115], v[80:83], a[124:127], v[112:115]
 v_cvt_pk_bf16_f32 v189, v98, v99
 s_waitcnt lgkmcnt(4)
 v_mfma_f32_16x16x32_bf16 v[84:87], v[52:55], a[0:3], 0
 ds_read_b128 v[76:79], v12 offset:14336
 v_mfma_f32_16x16x32_bf16 v[88:91], v[52:55], a[8:11], 0
 v_cvt_pk_bf16_f32 v176, v100, v101
 v_mfma_f32_16x16x32_bf16 v[84:87], v[56:59], a[4:7], v[84:87]
 ds_read_b128 v[80:83], v12 offset:15360
 v_mfma_f32_16x16x32_bf16 v[88:91], v[56:59], a[12:15], v[88:91]
 v_cvt_pk_bf16_f32 v177, v102, v103
 s_waitcnt lgkmcnt(4)
 v_mfma_f32_16x16x32_bf16 v[84:87], v[60:63], a[16:19], v[84:87]
 ds_read_b128 v[52:55], v12 offset:20480
 v_mfma_f32_16x16x32_bf16 v[88:91], v[60:63], a[24:27], v[88:91]
 v_cvt_pk_bf16_f32 v192, v104, v105
 v_mfma_f32_16x16x32_bf16 v[84:87], v[64:67], a[20:23], v[84:87]
 ds_read_b128 v[56:59], v12 offset:21504
 v_mfma_f32_16x16x32_bf16 v[88:91], v[64:67], a[28:31], v[88:91]
 v_cvt_pk_bf16_f32 v193, v106, v107
 s_waitcnt lgkmcnt(4)
 v_mfma_f32_16x16x32_bf16 v[92:95], v[68:71], a[32:35], 0
 ds_read_b128 v[60:63], v12 offset:22528
 v_mfma_f32_16x16x32_bf16 v[96:99], v[68:71], a[40:43], 0
 v_cvt_pk_bf16_f32 v180, v108, v109
 v_mfma_f32_16x16x32_bf16 v[92:95], v[72:75], a[36:39], v[92:95]
 ds_read_b128 v[64:67], v12 offset:23552
 v_mfma_f32_16x16x32_bf16 v[96:99], v[72:75], a[44:47], v[96:99]
 buffer_store_dwordx4 v[20:23], v13, s[4:7], s88 offen sc1
 v_cvt_pk_bf16_f32 v181, v110, v111
 s_waitcnt lgkmcnt(4)
 v_mfma_f32_16x16x32_bf16 v[92:95], v[76:79], a[48:51], v[92:95]
 ds_read_b128 v[68:71], v12 offset:28672
 v_mfma_f32_16x16x32_bf16 v[96:99], v[76:79], a[56:59], v[96:99]
 v_cvt_pk_bf16_f32 v196, v112, v113
 v_mfma_f32_16x16x32_bf16 v[92:95], v[80:83], a[52:55], v[92:95]
 ds_read_b128 v[72:75], v12 offset:29696
 v_mfma_f32_16x16x32_bf16 v[96:99], v[80:83], a[60:63], v[96:99]
 buffer_store_dword v20, v24, s[4:7], s70 offen
 v_cvt_pk_bf16_f32 v197, v114, v115
 s_waitcnt lgkmcnt(4)
 v_mfma_f32_16x16x32_bf16 v[100:103], v[52:55], a[64:67], 0
 ds_read_b128 v[76:79], v12 offset:30720
 v_mfma_f32_16x16x32_bf16 v[104:107], v[52:55], a[72:75], 0
 v_cvt_pk_bf16_f32 v170, v84, v85
 v_mfma_f32_16x16x32_bf16 v[100:103], v[56:59], a[68:71], v[100:103]
 ds_read_b128 v[80:83], v12 offset:31744
 v_mfma_f32_16x16x32_bf16 v[104:107], v[56:59], a[76:79], v[104:107]
 buffer_store_dwordx4 v[208:211], v32, s[4:7], s84 offen offset:0 sc1
 v_cvt_pk_bf16_f32 v171, v86, v87
 s_waitcnt lgkmcnt(4)
 v_mfma_f32_16x16x32_bf16 v[100:103], v[60:63], a[80:83], v[100:103]
 v_mfma_f32_16x16x32_bf16 v[104:107], v[60:63], a[88:91], v[104:107]
 v_cvt_pk_bf16_f32 v186, v88, v89
 v_mfma_f32_16x16x32_bf16 v[100:103], v[64:67], a[84:87], v[100:103]
 v_mfma_f32_16x16x32_bf16 v[104:107], v[64:67], a[92:95], v[104:107]
 buffer_store_dwordx4 v[212:215], v32, s[4:7], s84 offen offset:1024 sc1
 v_cvt_pk_bf16_f32 v187, v90, v91
 s_waitcnt lgkmcnt(2)
 v_mfma_f32_16x16x32_bf16 v[108:111], v[68:71], a[96:99], 0
 v_mfma_f32_16x16x32_bf16 v[112:115], v[68:71], a[104:107], 0
 v_cvt_pk_bf16_f32 v174, v92, v93
 v_mfma_f32_16x16x32_bf16 v[108:111], v[72:75], a[100:103], v[108:111]
 v_mfma_f32_16x16x32_bf16 v[112:115], v[72:75], a[108:111], v[112:115]
 s_sub_u32 s67, s64, 8
 s_cmp_lt_u32 s67, 8
 s_cbranch_scc0 L_or_clr_107
 s_lshl_b32 s67, s67, 10
 s_add_u32 s67, s67, s82
 s_add_u32 s67, s67, 122880
 s_waitcnt vmcnt(4)
 buffer_store_dwordx4 v[20:23], v12, s[4:7], s67 offen sc1
 s_branch L_or_clr_107x
 L_or_clr_107:
 s_waitcnt vmcnt(4)
 L_or_clr_107x:
 v_cvt_pk_bf16_f32 v175, v94, v95
 s_waitcnt lgkmcnt(0)
 v_mfma_f32_16x16x32_bf16 v[108:111], v[76:79], a[112:115], v[108:111]
 v_mfma_f32_16x16x32_bf16 v[112:115], v[76:79], a[120:123], v[112:115]
 v_cvt_pk_bf16_f32 v190, v96, v97
 v_mfma_f32_16x16x32_bf16 v[108:111], v[80:83], a[116:119], v[108:111]
 v_mfma_f32_16x16x32_bf16 v[112:115], v[80:83], a[124:127], v[112:115]
 v_cvt_pk_bf16_f32 v191, v98, v99
 v_cvt_pk_bf16_f32 v178, v100, v101
 v_cvt_pk_bf16_f32 v179, v102, v103
 v_cvt_pk_bf16_f32 v194, v104, v105
 v_cvt_pk_bf16_f32 v195, v106, v107
 s_nop 3
 v_cvt_pk_bf16_f32 v182, v108, v109
 v_cvt_pk_bf16_f32 v183, v110, v111
 v_cvt_pk_bf16_f32 v198, v112, v113
 v_cvt_pk_bf16_f32 v199, v114, v115
L_or_pxwait_102:
L_or_pxagain_109:
 s_barrier
 ds_read_b128 v[36:39], v12 offset:32768
 ds_read_b128 v[60:63], v12 offset:38912
 ds_read_b128 v[40:43], v12 offset:33792
 ds_read_b128 v[64:67], v12 offset:39936
 ds_read_b128 v[44:47], v12 offset:34816
 ds_read_b128 v[68:71], v12 offset:40960
 ds_read_b128 v[48:51], v12 offset:35840
 ds_read_b128 v[72:75], v12 offset:41984
 ds_read_b128 v[52:55], v12 offset:36864
 ds_read_b128 v[76:79], v12 offset:43008
 ds_read_b128 v[56:59], v12 offset:37888
 ds_read_b128 v[80:83], v12 offset:44032
 s_waitcnt lgkmcnt(11)
 v_mfma_f32_16x16x32_bf16 v[84:87], v[120:123], v[36:39], 0
 v_max_u32 v11, v36, v38
 v_mfma_f32_16x16x32_bf16 v[88:91], v[136:139], v[36:39], 0
 s_waitcnt lgkmcnt(10)
 v_mfma_f32_16x16x32_bf16 v[92:95], v[120:123], v[60:63], 0
 v_max3_u32 v11, v11, v60, v62
 v_mfma_f32_16x16x32_bf16 v[96:99], v[136:139], v[60:63], 0
 s_waitcnt lgkmcnt(9)
 v_mfma_f32_16x16x32_bf16 v[84:87], v[124:127], v[40:43], v[84:87]
 v_max3_u32 v11, v11, v40, v42
 v_mfma_f32_16x16x32_bf16 v[88:91], v[140:143], v[40:43], v[88:91]
 s_waitcnt lgkmcnt(8)
 v_mfma_f32_16x16x32_bf16 v[92:95], v[124:127], v[64:67], v[92:95]
 v_max3_u32 v11, v11, v64, v66
 v_mfma_f32_16x16x32_bf16 v[96:99], v[140:143], v[64:67], v[96:99]
 s_waitcnt lgkmcnt(7)
 v_mfma_f32_16x16x32_bf16 v[84:87], v[128:131], v[44:47], v[84:87]
 v_max3_u32 v11, v11, v44, v46
 v_mfma_f32_16x16x32_bf16 v[88:91], v[144:147], v[44:47], v[88:91]
 s_waitcnt lgkmcnt(6)
 v_mfma_f32_16x16x32_bf16 v[92:95], v[128:131], v[68:71], v[92:95]
 v_max3_u32 v11, v11, v68, v70
 v_mfma_f32_16x16x32_bf16 v[96:99], v[144:147], v[68:71], v[96:99]
 s_waitcnt lgkmcnt(5)
 v_mfma_f32_16x16x32_bf16 v[84:87], v[132:135], v[48:51], v[84:87]
 v_max3_u32 v11, v11, v48, v50
 v_mfma_f32_16x16x32_bf16 v[88:91], v[148:151], v[48:51], v[88:91]
 buffer_load_dwordx4 v[216:219], v17, s[4:7], s71 offen sc1
 s_waitcnt lgkmcnt(4)
 v_mfma_f32_16x16x32_bf16 v[92:95], v[132:135], v[72:75], v[92:95]
 v_max3_u32 v11, v11, v72, v74
 v_mfma_f32_16x16x32_bf16 v[96:99], v[148:151], v[72:75], v[96:99]
 s_waitcnt lgkmcnt(3)
 v_mfma_f32_16x16x32_bf16 v[84:87], v[152:155], v[52:55], v[84:87]
 v_max3_u32 v11, v11, v52, v54
 v_mfma_f32_16x16x32_bf16 v[88:91], v[160:163], v[52:55], v[88:91]
 s_waitcnt lgkmcnt(2)
 v_mfma_f32_16x16x32_bf16 v[92:95], v[152:155], v[76:79], v[92:95]
 v_max3_u32 v11, v11, v76, v78
 v_mfma_f32_16x16x32_bf16 v[96:99], v[160:163], v[76:79], v[96:99]
 s_waitcnt lgkmcnt(1)
 v_mfma_f32_16x16x32_bf16 v[84:87], v[156:159], v[56:59], v[84:87]
 v_max3_u32 v11, v11, v56, v58
 v_mfma_f32_16x16x32_bf16 v[88:91], v[164:167], v[56:59], v[88:91]
 s_waitcnt lgkmcnt(0)
 v_mfma_f32_16x16x32_bf16 v[92:95], v[156:159], v[80:83], v[92:95]
 v_max3_u32 v11, v11, v80, v82
 v_cmp_eq_u32 vcc, -1, v11
 v_mfma_f32_16x16x32_bf16 v[96:99], v[164:167], v[80:83], v[96:99]
 s_cbranch_vccnz L_or_pxretry_108
 s_cmp_eq_u32 s64, 63
 s_cbranch_scc1 L_or_tail_110
 s_add_u32 s64, s64, 1
 s_cmp_eq_u32 s64, 63
 s_cbranch_scc1 L_or_nf_111
 s_add_u32 s65, s64, 1
 s_and_b32 s66, s65, 3
 s_lshl_b32 s66, s66, 13
 s_add_u32 s89, s66, s76
 s_add_u32 s90, s89, 4096
 s_branch L_or_xd1_113
L_or_xd_112:
 buffer_load_dwordx4 v[216:219], v17, s[4:7], s71 offen sc1
 s_sub_u32 s63, s63, 1
 s_cbranch_scc1 L_role_o_0_abort
L_or_xd1_113:
 s_waitcnt vmcnt(0)
 v_min3_u32 v11, v216, v217, v218
 v_min_u32 v11, v11, v219
 v_cmp_ge_u32 vcc, s65, v11
 s_cbranch_vccnz L_or_xd_112
 s_lshl_b32 m0, s62, 13
 s_add_u32 m0, m0, 0
 s_nop 0
 buffer_load_dwordx4 v12, s[4:7], s89 offen offset:0 sc1 lds
 v_mov_b64 v[120:121], v[168:169]
 v_mov_b64 v[122:123], v[170:171]
 v_mov_b64 v[124:125], v[172:173]
 v_mov_b64 v[126:127], v[174:175]
 v_mov_b64 v[128:129], v[176:177]
 v_mov_b64 v[130:131], v[178:179]
 v_mov_b64 v[132:133], v[180:181]
 v_mov_b64 v[134:135], v[182:183]
 v_mov_b64 v[136:137], v[184:185]
 buffer_load_dwordx4 v12, s[4:7], s89 offen offset:1024 sc1 lds
 v_mov_b64 v[138:139], v[186:187]
 v_mov_b64 v[140:141], v[188:189]
 v_mov_b64 v[142:143], v[190:191]
 v_mov_b64 v[144:145], v[192:193]
 v_mov_b64 v[146:147], v[194:195]
 v_mov_b64 v[148:149], v[196:197]
 v_mov_b64 v[150:151], v[198:199]
 v_cvt_pk_bf16_f32 v208, v84, v85
 v_cvt_pk_bf16_f32 v210, v86, v87
 buffer_load_dwordx4 v12, s[4:7], s89 offen offset:2048 sc1 lds
 v_cvt_pk_bf16_f32 v209, v88, v89
 v_cvt_pk_bf16_f32 v211, v90, v91
 v_cvt_pk_bf16_f32 v212, v92, v93
 v_cvt_pk_bf16_f32 v214, v94, v95
 v_cvt_pk_bf16_f32 v213, v96, v97
 v_cvt_pk_bf16_f32 v215, v98, v99
 v_min_u32 v208, -2, v208
 v_min_u32 v210, -2, v210
 v_min_u32 v212, -2, v212
 buffer_load_dwordx4 v12, s[4:7], s89 offen offset:3072 sc1 lds
 v_min_u32 v214, -2, v214
 v_mov_b64 v[224:225], 0
 v_mov_b64 v[226:227], 0
 v_mov_b64 v[228:229], 0
 v_mov_b64 v[230:231], 0
 v_mov_b64 v[84:85], 0
 v_mov_b64 v[86:87], 0
 v_mov_b64 v[88:89], 0
 v_mov_b64 v[90:91], 0
 s_lshl_b32 m0, s62, 13
 s_add_u32 m0, m0, 4096
 s_nop 0
 buffer_load_dwordx4 v12, s[4:7], s90 offen offset:0 sc1 lds
 v_mov_b64 v[92:93], 0
 v_mov_b64 v[94:95], 0
 v_mov_b64 v[96:97], 0
 v_mov_b64 v[98:99], 0
 v_mov_b64 v[100:101], 0
 v_mov_b64 v[102:103], 0
 v_mov_b64 v[104:105], 0
 v_mov_b64 v[106:107], 0
 v_mov_b64 v[108:109], 0
 buffer_load_dwordx4 v12, s[4:7], s90 offen offset:1024 sc1 lds
 v_mov_b64 v[110:111], 0
 v_mov_b64 v[112:113], 0
 v_mov_b64 v[114:115], 0
 s_max_i32 s84, s64, 1
 s_sub_u32 s84, s84, 1
 s_lshl_b32 s84, s84, 11
 s_add_u32 s84, s84, s82
 s_and_b32 s65, s64, 3
 s_lshl_b32 s65, s65, 11
 buffer_load_dwordx4 v12, s[4:7], s90 offen offset:2048 sc1 lds
 s_add_u32 s85, s65, s75
 s_and_b32 s65, s64, 3
 s_lshl_b32 s86, s65, 12
 s_add_u32 s86, s86, s77
 s_lshl_b32 s91, s65, 14
 s_add_u32 s91, s91, s78
 s_lshl_b32 s87, s65, 18
 s_xor_b32 s88, s87, 0x80000
 s_add_u32 s87, s87, s79
 buffer_load_dwordx4 v12, s[4:7], s90 offen offset:3072 sc1 lds
 s_add_u32 s88, s88, s79
 s_lshl_b32 s69, s65, 10
 s_xor_b32 s70, s69, 2048
 s_add_u32 s69, s69, s81
 s_add_u32 s70, s70, s81
 s_cmp_lt_u32 s64, 63
 s_cselect_b32 s83, 3, 0
 s_branch L_or_loop_99
L_or_nf_111:
 v_mov_b64 v[120:121], v[168:169]
 v_mov_b64 v[122:123], v[170:171]
 v_mov_b64 v[124:125], v[172:173]
 v_mov_b64 v[126:127], v[174:175]
 v_mov_b64 v[128:129], v[176:177]
 v_mov_b64 v[130:131], v[178:179]
 v_mov_b64 v[132:133], v[180:181]
 v_mov_b64 v[134:135], v[182:183]
 v_mov_b64 v[136:137], v[184:185]
 v_mov_b64 v[138:139], v[186:187]
 v_mov_b64 v[140:141], v[188:189]
 v_mov_b64 v[142:143], v[190:191]
 v_mov_b64 v[144:145], v[192:193]
 v_mov_b64 v[146:147], v[194:195]
 v_mov_b64 v[148:149], v[196:197]
 v_mov_b64 v[150:151], v[198:199]
 v_cvt_pk_bf16_f32 v208, v84, v85
 v_cvt_pk_bf16_f32 v210, v86, v87
 v_cvt_pk_bf16_f32 v209, v88, v89
 v_cvt_pk_bf16_f32 v211, v90, v91
 v_cvt_pk_bf16_f32 v212, v92, v93
 v_cvt_pk_bf16_f32 v214, v94, v95
 v_cvt_pk_bf16_f32 v213, v96, v97
 v_cvt_pk_bf16_f32 v215, v98, v99
 v_min_u32 v208, -2, v208
 v_min_u32 v210, -2, v210
 v_min_u32 v212, -2, v212
 v_min_u32 v214, -2, v214
 v_mov_b64 v[224:225], 0
 v_mov_b64 v[226:227], 0
 v_mov_b64 v[228:229], 0
 v_mov_b64 v[230:231], 0
 v_mov_b64 v[84:85], 0
 v_mov_b64 v[86:87], 0
 v_mov_b64 v[88:89], 0
 v_mov_b64 v[90:91], 0
 v_mov_b64 v[92:93], 0
 v_mov_b64 v[94:95], 0
 v_mov_b64 v[96:97], 0
 v_mov_b64 v[98:99], 0
 v_mov_b64 v[100:101], 0
 v_mov_b64 v[102:103], 0
 v_mov_b64 v[104:105], 0
 v_mov_b64 v[106:107], 0
 v_mov_b64 v[108:109], 0
 v_mov_b64 v[110:111], 0
 v_mov_b64 v[112:113], 0
 v_mov_b64 v[114:115], 0
 s_max_i32 s84, s64, 1
 s_sub_u32 s84, s84, 1
 s_lshl_b32 s84, s84, 11
 s_add_u32 s84, s84, s82
 s_and_b32 s65, s64, 3
 s_lshl_b32 s65, s65, 11
 s_add_u32 s85, s65, s75
 s_and_b32 s65, s64, 3
 s_lshl_b32 s86, s65, 12
 s_add_u32 s86, s86, s77
 s_lshl_b32 s91, s65, 14
 s_add_u32 s91, s91, s78
 s_lshl_b32 s87, s65, 18
 s_xor_b32 s88, s87, 0x80000
 s_add_u32 s87, s87, s79
 s_add_u32 s88, s88, s79
 s_lshl_b32 s69, s65, 10
 s_xor_b32 s70, s69, 2048
 s_add_u32 s69, s69, s81
 s_add_u32 s70, s70, s81
 s_cmp_lt_u32 s64, 63
 s_cselect_b32 s83, 3, 0
 buffer_store_dwordx4 v[208:211], v32, s[4:7], s84 offen offset:0 sc1
 buffer_store_dwordx4 v[212:215], v32, s[4:7], s84 offen offset:1024 sc1
 s_branch L_or_loop_99
L_or_pxretry_108:
 s_barrier
 s_mul_i32 m0, s62, 3072
 s_add_u32 m0, m0, 32768
 s_nop 0
 buffer_load_dwordx4 v12, s[4:7], s91 offen offset:0 sc1 lds
 buffer_load_dwordx4 v12, s[4:7], s91 offen offset:1024 sc1 lds
 buffer_load_dwordx4 v12, s[4:7], s91 offen offset:2048 sc1 lds
 s_waitcnt vmcnt(0)
 s_sub_u32 s63, s63, 1
 s_cbranch_scc0 L_or_pxagain_109
 s_endpgm
L_or_tail_110:
 buffer_store_dword v17, v24, s[4:7], s69 offen
 s_add_u32 s84, s84, 2048
 s_nop 2
 v_cvt_pk_bf16_f32 v208, v84, v85
 v_cvt_pk_bf16_f32 v210, v86, v87
 v_cvt_pk_bf16_f32 v209, v88, v89
 v_cvt_pk_bf16_f32 v211, v90, v91
 v_cvt_pk_bf16_f32 v212, v92, v93
 v_cvt_pk_bf16_f32 v214, v94, v95
 v_cvt_pk_bf16_f32 v213, v96, v97
 v_cvt_pk_bf16_f32 v215, v98, v99
 v_min_u32 v208, -2, v208
 v_min_u32 v210, -2, v210
 v_min_u32 v212, -2, v212
 v_min_u32 v214, -2, v214
 buffer_store_dwordx4 v[208:211], v32, s[4:7], s84 offen offset:0 sc1
 buffer_store_dwordx4 v[212:215], v32, s[4:7], s84 offen offset:1024 sc1
 s_endpgm
L_retry:
 s_mov_b64 exec, -1
 s_waitcnt vmcnt(0) lgkmcnt(0)
 s_barrier
 s_mov_b32 s101, 64
 s_mov_b32 s64, -2
 v_mov_b32 v3, 0
 s_cmp_eq_u32 s62, 0
 s_cbranch_scc0 L_noticket
 s_lshl_b32 s65, s60, 5
 s_mov_b32 s61, 1
 s_atomic_add s61, s[56:57], s65 glc
 s_waitcnt lgkmcnt(0)
 v_mov_b32 v2, s61
 ds_write_b32 v3, v2
 s_waitcnt lgkmcnt(0)
L_noticket:
 s_barrier
 ds_read_b32 v2, v3
 s_waitcnt lgkmcnt(0)
 v_readfirstlane_b32 s61, v2
 s_barrier
 s_cmp_lt_u32 s61, 32
 s_cbranch_scc1 L_local
L_badxcc:
 s_mov_b32 s66, 1
 s_atomic_or s66, s[56:57], 36
 s_atomic_or s66, s[56:57], 40
L_fallback:
 s_mov_b64 exec, -1
 s_waitcnt vmcnt(0) lgkmcnt(0)
 s_barrier
 s_mov_b32 s101, 128
 s_lshr_b32 s60, s2, 5
 s_and_b32 s61, s2, 31
 s_add_u32 s4, s58, 0x8000000
 s_addc_u32 s5, s59, 0
 s_mov_b32 s64, -2
 s_cmp_lt_u32 s61, 12
 s_cbranch_scc1 L_role_p_1
 s_cmp_lt_u32 s61, 20
 s_cbranch_scc1 L_role_o_1
 s_cmp_lt_u32 s61, 28
 s_cbranch_scc1 L_role_t_1
 s_branch L_role_f
L_role_f_abort:
 s_endpgm
.p2align 6
L_role_f:
 s_sub_u32 s72, s61, 28
 s_or_b32 s65, s62, s101
 s_cbranch_scc1 L_clm_114
 s_waitcnt lgkmcnt(0)
 s_bitcmp1_b32 s3, s61
 s_cbranch_scc0 L_clm_114
 s_mov_b32 s66, 1
 s_atomic_or s66, s[56:57], 36
 s_waitcnt lgkmcnt(0)
L_clm_114:
 v_min_u32 v3, 1, v0
 v_lshlrev_b32 v3, 28, v3
 s_cmp_eq_u32 s72, 0
 s_cbranch_scc0 L_f_noprobe_115
 s_cmp_eq_u32 s62, 0
 s_cbranch_scc0 L_f_probed_116
 s_lshl_b32 s65, s60, 7
 s_add_u32 s86, s65, 0x6700000
 s_add_u32 s87, s86, 8192
 s_mov_b32 s88, -1
 s_mov_b32 s89, -1
 s_mov_b32 s75, 5
L_f_probe_117:
 buffer_store_dword v3, v3, s[4:7], s86 offen sc1
 buffer_store_dword v3, v3, s[4:7], s87 offen sc1
 s_waitcnt vmcnt(0)
 s_memtime s[94:95]
 s_waitcnt lgkmcnt(0)
 buffer_load_dword v1, v3, s[4:7], s86 offen sc1
 s_waitcnt vmcnt(0)
 s_memtime s[96:97]
 s_waitcnt lgkmcnt(0)
 s_sub_u32 s96, s96, s94
 s_min_u32 s88, s88, s96
 s_memtime s[94:95]
 s_waitcnt lgkmcnt(0)
 buffer_load_dword v1, v3, s[4:7], s87 offen sc1
 s_waitcnt vmcnt(0)
 s_memtime s[96:97]
 s_waitcnt lgkmcnt(0)
 s_sub_u32 s96, s96, s94
 s_min_u32 s89, s89, s96
 s_sub_u32 s75, s75, 1
 s_cmp_lg_u32 s75, 0
 s_cbranch_scc1 L_f_probe_117
 s_cmp_lt_u32 s89, s88
 s_cselect_b32 s66, 2, 1
 s_lshl_b32 s65, s60, 5
 s_lshr_b32 s67, s101, 5
 s_and_b32 s67, s67, 4
 s_add_u32 s65, s65, s67
 s_add_u32 s65, s65, 24
 s_atomic_umax s66, s[56:57], s65
 s_waitcnt lgkmcnt(0)
L_f_probed_116:
 s_barrier
 s_branch L_f_go_118
L_f_noprobe_115:
 s_sub_u32 s68, s61, 20
 s_lshr_b32 s65, s68, 2
 s_cmp_eq_u32 s65, 0
 s_cselect_b64 s[94:95], s[40:41], s[42:43]
 s_cmp_eq_u32 s65, 2
 s_cselect_b64 s[94:95], s[44:45], s[94:95]
 s_and_b32 s65, s68, 3
 s_lshl_b32 s65, s65, 2
 s_add_u32 s65, s65, s62
 s_lshl_b32 s65, s65, 16
 s_lshl_b32 s66, s60, 10
 s_add_u32 s65, s65, s66
 v_lshrrev_b32 v1, 3, v0
 v_lshlrev_b32 v1, 13, v1
 v_and_b32 v2, 7, v0
 v_lshl_add_u32 v1, v2, 7, v1
 v_add_u32 v1, s65, v1
 v_add_u32 v2, 0x0, v1
 global_load_dword v252, v2, s[94:95] nt
 v_add_u32 v2, 0x100000, v1
 global_load_dword v253, v2, s[94:95] nt
 v_add_u32 v2, 0x200000, v1
 global_load_dword v254, v2, s[94:95] nt
 v_add_u32 v2, 0x300000, v1
 global_load_dword v255, v2, s[94:95] nt
 v_add_u32 v2, 0x400000, v1
 global_load_dword v252, v2, s[94:95] nt
 v_add_u32 v2, 0x500000, v1
 global_load_dword v253, v2, s[94:95] nt
 v_add_u32 v2, 0x600000, v1
 global_load_dword v254, v2, s[94:95] nt
 v_add_u32 v2, 0x700000, v1
 global_load_dword v255, v2, s[94:95] nt
 s_sleep 32
 s_sleep 32
 s_sleep 32
 s_sleep 32
 s_sleep 32
 s_sleep 32
L_f_go_118:
 s_mov_b32 s20, s54
 s_mov_b32 s21, s55
 s_mov_b32 s22, 0x400000
 s_mov_b32 s23, 0x00020000
 s_mov_b32 s24, s48
 s_mov_b32 s25, s49
 s_mov_b32 s26, 0x201000
 s_mov_b32 s27, 0x00020000
 s_mov_b32 s28, s50
 s_mov_b32 s29, s51
 s_mov_b32 s30, 0x201000
 s_mov_b32 s31, 0x00020000
 s_mov_b32 s32, s52
 s_mov_b32 s33, s53
 s_mov_b32 s34, 0x800
 s_mov_b32 s35, 0x00020000
 v_and_b32 v5, 31, v0
 v_lshrrev_b32 v6, 5, v0
 v_bfe_u32 v1, v0, 2, 1
 v_bfe_u32 v2, v0, 3, 2
 v_lshlrev_b32 v1, 4, v1
 v_lshl_add_u32 v1, v2, 2, v1
 v_and_b32 v2, 3, v0
 v_add_u32 v7, v1, v2
 s_lshl_b32 s65, s60, 2
 s_add_u32 s65, s65, s72
 s_lshl_b32 s65, s65, 2
 s_add_u32 s65, s65, s62
 s_lshl_b32 s66, s65, 15
 v_lshlrev_b32 v1, 4, v0
 buffer_load_dwordx4 v[28:31], v1, s[32:35], 0 offen offset:0
 buffer_load_dwordx4 v[32:35], v1, s[32:35], 0 offen offset:1024
 buffer_load_dwordx4 v[108:111], v1, s[8:11], s66 offen offset:0
 buffer_load_dwordx4 v[112:115], v1, s[8:11], s66 offen offset:1024
 s_add_u32 s66, s66, 2048
 buffer_load_dwordx4 v[116:119], v1, s[8:11], s66 offen offset:0
 buffer_load_dwordx4 v[120:123], v1, s[8:11], s66 offen offset:1024
 s_add_u32 s66, s66, 2048
 buffer_load_dwordx4 v[124:127], v1, s[8:11], s66 offen offset:0
 buffer_load_dwordx4 v[128:131], v1, s[8:11], s66 offen offset:1024
 s_add_u32 s66, s66, 2048
 buffer_load_dwordx4 v[132:135], v1, s[8:11], s66 offen offset:0
 buffer_load_dwordx4 v[136:139], v1, s[8:11], s66 offen offset:1024
 s_add_u32 s66, s66, 2048
 buffer_load_dwordx4 v[140:143], v1, s[8:11], s66 offen offset:0
 buffer_load_dwordx4 v[144:147], v1, s[8:11], s66 offen offset:1024
 s_add_u32 s66, s66, 2048
 buffer_load_dwordx4 v[148:151], v1, s[8:11], s66 offen offset:0
 buffer_load_dwordx4 v[152:155], v1, s[8:11], s66 offen offset:1024
 s_add_u32 s66, s66, 2048
 buffer_load_dwordx4 v[156:159], v1, s[8:11], s66 offen offset:0
 buffer_load_dwordx4 v[160:163], v1, s[8:11], s66 offen offset:1024
 s_add_u32 s66, s66, 2048
 buffer_load_dwordx4 v[164:167], v1, s[8:11], s66 offen offset:0
 buffer_load_dwordx4 v[168:171], v1, s[8:11], s66 offen offset:1024
 s_add_u32 s66, s66, 2048
 buffer_load_dwordx4 v[172:175], v1, s[8:11], s66 offen offset:0
 buffer_load_dwordx4 v[176:179], v1, s[8:11], s66 offen offset:1024
 s_add_u32 s66, s66, 2048
 buffer_load_dwordx4 v[180:183], v1, s[8:11], s66 offen offset:0
 buffer_load_dwordx4 v[184:187], v1, s[8:11], s66 offen offset:1024
 s_add_u32 s66, s66, 2048
 buffer_load_dwordx4 v[188:191], v1, s[8:11], s66 offen offset:0
 buffer_load_dwordx4 v[192:195], v1, s[8:11], s66 offen offset:1024
 s_add_u32 s66, s66, 2048
 buffer_load_dwordx4 v[196:199], v1, s[8:11], s66 offen offset:0
 buffer_load_dwordx4 v[200:203], v1, s[8:11], s66 offen offset:1024
 s_add_u32 s66, s66, 2048
 buffer_load_dwordx4 v[204:207], v1, s[8:11], s66 offen offset:0
 buffer_load_dwordx4 v[208:211], v1, s[8:11], s66 offen offset:1024
 s_add_u32 s66, s66, 2048
 buffer_load_dwordx4 v[212:215], v1, s[8:11], s66 offen offset:0
 buffer_load_dwordx4 v[216:219], v1, s[8:11], s66 offen offset:1024
 s_add_u32 s66, s66, 2048
 buffer_load_dwordx4 v[220:223], v1, s[8:11], s66 offen offset:0
 buffer_load_dwordx4 v[224:227], v1, s[8:11], s66 offen offset:1024
 s_add_u32 s66, s66, 2048
 buffer_load_dwordx4 v[228:231], v1, s[8:11], s66 offen offset:0
 buffer_load_dwordx4 v[232:235], v1, s[8:11], s66 offen offset:1024
 s_add_u32 s66, s66, 2048
 s_waitcnt vmcnt(0)
 v_mov_b32 v36, 0
 v_mov_b32 v37, 0
 v_mov_b32 v38, 0
 v_mov_b32 v39, 0
 v_mov_b32 v40, 0
 v_mov_b32 v41, 0
 v_mov_b32 v42, 0
 v_mov_b32 v43, 0
 v_mov_b32 v44, 0
 v_mov_b32 v45, 0
 v_mov_b32 v46, 0
 v_mov_b32 v47, 0
 v_mov_b32 v48, 0
 v_mov_b32 v49, 0
 v_mov_b32 v50, 0
 v_mov_b32 v51, 0
 v_dot2_f32_bf16 v36, v108, v28, v36
 v_dot2_f32_bf16 v37, v116, v28, v37
 v_dot2_f32_bf16 v38, v124, v28, v38
 v_dot2_f32_bf16 v39, v132, v28, v39
 v_dot2_f32_bf16 v40, v140, v28, v40
 v_dot2_f32_bf16 v41, v148, v28, v41
 v_dot2_f32_bf16 v42, v156, v28, v42
 v_dot2_f32_bf16 v43, v164, v28, v43
 v_dot2_f32_bf16 v44, v172, v28, v44
 v_dot2_f32_bf16 v45, v180, v28, v45
 v_dot2_f32_bf16 v46, v188, v28, v46
 v_dot2_f32_bf16 v47, v196, v28, v47
 v_dot2_f32_bf16 v48, v204, v28, v48
 v_dot2_f32_bf16 v49, v212, v28, v49
 v_dot2_f32_bf16 v50, v220, v28, v50
 v_dot2_f32_bf16 v51, v228, v28, v51
 v_dot2_f32_bf16 v36, v109, v29, v36
 v_dot2_f32_bf16 v37, v117, v29, v37
 v_dot2_f32_bf16 v38, v125, v29, v38
 v_dot2_f32_bf16 v39, v133, v29, v39
 v_dot2_f32_bf16 v40, v141, v29, v40
 v_dot2_f32_bf16 v41, v149, v29, v41
 v_dot2_f32_bf16 v42, v157, v29, v42
 v_dot2_f32_bf16 v43, v165, v29, v43
 v_dot2_f32_bf16 v44, v173, v29, v44
 v_dot2_f32_bf16 v45, v181, v29, v45
 v_dot2_f32_bf16 v46, v189, v29, v46
 v_dot2_f32_bf16 v47, v197, v29, v47
 v_dot2_f32_bf16 v48, v205, v29, v48
 v_dot2_f32_bf16 v49, v213, v29, v49
 v_dot2_f32_bf16 v50, v221, v29, v50
 v_dot2_f32_bf16 v51, v229, v29, v51
 v_dot2_f32_bf16 v36, v110, v30, v36
 v_dot2_f32_bf16 v37, v118, v30, v37
 v_dot2_f32_bf16 v38, v126, v30, v38
 v_dot2_f32_bf16 v39, v134, v30, v39
 v_dot2_f32_bf16 v40, v142, v30, v40
 v_dot2_f32_bf16 v41, v150, v30, v41
 v_dot2_f32_bf16 v42, v158, v30, v42
 v_dot2_f32_bf16 v43, v166, v30, v43
 v_dot2_f32_bf16 v44, v174, v30, v44
 v_dot2_f32_bf16 v45, v182, v30, v45
 v_dot2_f32_bf16 v46, v190, v30, v46
 v_dot2_f32_bf16 v47, v198, v30, v47
 v_dot2_f32_bf16 v48, v206, v30, v48
 v_dot2_f32_bf16 v49, v214, v30, v49
 v_dot2_f32_bf16 v50, v222, v30, v50
 v_dot2_f32_bf16 v51, v230, v30, v51
 v_dot2_f32_bf16 v36, v111, v31, v36
 v_dot2_f32_bf16 v37, v119, v31, v37
 v_dot2_f32_bf16 v38, v127, v31, v38
 v_dot2_f32_bf16 v39, v135, v31, v39
 v_dot2_f32_bf16 v40, v143, v31, v40
 v_dot2_f32_bf16 v41, v151, v31, v41
 v_dot2_f32_bf16 v42, v159, v31, v42
 v_dot2_f32_bf16 v43, v167, v31, v43
 v_dot2_f32_bf16 v44, v175, v31, v44
 v_dot2_f32_bf16 v45, v183, v31, v45
 v_dot2_f32_bf16 v46, v191, v31, v46
 v_dot2_f32_bf16 v47, v199, v31, v47
 v_dot2_f32_bf16 v48, v207, v31, v48
 v_dot2_f32_bf16 v49, v215, v31, v49
 v_dot2_f32_bf16 v50, v223, v31, v50
 v_dot2_f32_bf16 v51, v231, v31, v51
 v_dot2_f32_bf16 v36, v112, v32, v36
 v_dot2_f32_bf16 v37, v120, v32, v37
 v_dot2_f32_bf16 v38, v128, v32, v38
 v_dot2_f32_bf16 v39, v136, v32, v39
 v_dot2_f32_bf16 v40, v144, v32, v40
 v_dot2_f32_bf16 v41, v152, v32, v41
 v_dot2_f32_bf16 v42, v160, v32, v42
 v_dot2_f32_bf16 v43, v168, v32, v43
 v_dot2_f32_bf16 v44, v176, v32, v44
 v_dot2_f32_bf16 v45, v184, v32, v45
 v_dot2_f32_bf16 v46, v192, v32, v46
 v_dot2_f32_bf16 v47, v200, v32, v47
 v_dot2_f32_bf16 v48, v208, v32, v48
 v_dot2_f32_bf16 v49, v216, v32, v49
 v_dot2_f32_bf16 v50, v224, v32, v50
 v_dot2_f32_bf16 v51, v232, v32, v51
 v_dot2_f32_bf16 v36, v113, v33, v36
 v_dot2_f32_bf16 v37, v121, v33, v37
 v_dot2_f32_bf16 v38, v129, v33, v38
 v_dot2_f32_bf16 v39, v137, v33, v39
 v_dot2_f32_bf16 v40, v145, v33, v40
 v_dot2_f32_bf16 v41, v153, v33, v41
 v_dot2_f32_bf16 v42, v161, v33, v42
 v_dot2_f32_bf16 v43, v169, v33, v43
 v_dot2_f32_bf16 v44, v177, v33, v44
 v_dot2_f32_bf16 v45, v185, v33, v45
 v_dot2_f32_bf16 v46, v193, v33, v46
 v_dot2_f32_bf16 v47, v201, v33, v47
 v_dot2_f32_bf16 v48, v209, v33, v48
 v_dot2_f32_bf16 v49, v217, v33, v49
 v_dot2_f32_bf16 v50, v225, v33, v50
 v_dot2_f32_bf16 v51, v233, v33, v51
 v_dot2_f32_bf16 v36, v114, v34, v36
 v_dot2_f32_bf16 v37, v122, v34, v37
 v_dot2_f32_bf16 v38, v130, v34, v38
 v_dot2_f32_bf16 v39, v138, v34, v39
 v_dot2_f32_bf16 v40, v146, v34, v40
 v_dot2_f32_bf16 v41, v154, v34, v41
 v_dot2_f32_bf16 v42, v162, v34, v42
 v_dot2_f32_bf16 v43, v170, v34, v43
 v_dot2_f32_bf16 v44, v178, v34, v44
 v_dot2_f32_bf16 v45, v186, v34, v45
 v_dot2_f32_bf16 v46, v194, v34, v46
 v_dot2_f32_bf16 v47, v202, v34, v47
 v_dot2_f32_bf16 v48, v210, v34, v48
 v_dot2_f32_bf16 v49, v218, v34, v49
 v_dot2_f32_bf16 v50, v226, v34, v50
 v_dot2_f32_bf16 v51, v234, v34, v51
 v_dot2_f32_bf16 v36, v115, v35, v36
 v_dot2_f32_bf16 v37, v123, v35, v37
 v_dot2_f32_bf16 v38, v131, v35, v38
 v_dot2_f32_bf16 v39, v139, v35, v39
 v_dot2_f32_bf16 v40, v147, v35, v40
 v_dot2_f32_bf16 v41, v155, v35, v41
 v_dot2_f32_bf16 v42, v163, v35, v42
 v_dot2_f32_bf16 v43, v171, v35, v43
 v_dot2_f32_bf16 v44, v179, v35, v44
 v_dot2_f32_bf16 v45, v187, v35, v45
 v_dot2_f32_bf16 v46, v195, v35, v46
 v_dot2_f32_bf16 v47, v203, v35, v47
 v_dot2_f32_bf16 v48, v211, v35, v48
 v_dot2_f32_bf16 v49, v219, v35, v49
 v_dot2_f32_bf16 v50, v227, v35, v50
 v_dot2_f32_bf16 v51, v235, v35, v51
 s_nop 2
 v_add_f32_dpp v36, v36, v36 row_ror:8 row_mask:0xf bank_mask:0xf
 v_add_f32_dpp v37, v37, v37 row_ror:8 row_mask:0xf bank_mask:0xf
 v_add_f32_dpp v38, v38, v38 row_ror:8 row_mask:0xf bank_mask:0xf
 v_add_f32_dpp v39, v39, v39 row_ror:8 row_mask:0xf bank_mask:0xf
 v_add_f32_dpp v40, v40, v40 row_ror:8 row_mask:0xf bank_mask:0xf
 v_add_f32_dpp v41, v41, v41 row_ror:8 row_mask:0xf bank_mask:0xf
 v_add_f32_dpp v42, v42, v42 row_ror:8 row_mask:0xf bank_mask:0xf
 v_add_f32_dpp v43, v43, v43 row_ror:8 row_mask:0xf bank_mask:0xf
 v_add_f32_dpp v44, v44, v44 row_ror:8 row_mask:0xf bank_mask:0xf
 v_add_f32_dpp v45, v45, v45 row_ror:8 row_mask:0xf bank_mask:0xf
 v_add_f32_dpp v46, v46, v46 row_ror:8 row_mask:0xf bank_mask:0xf
 v_add_f32_dpp v47, v47, v47 row_ror:8 row_mask:0xf bank_mask:0xf
 v_add_f32_dpp v48, v48, v48 row_ror:8 row_mask:0xf bank_mask:0xf
 v_add_f32_dpp v49, v49, v49 row_ror:8 row_mask:0xf bank_mask:0xf
 v_add_f32_dpp v50, v50, v50 row_ror:8 row_mask:0xf bank_mask:0xf
 v_add_f32_dpp v51, v51, v51 row_ror:8 row_mask:0xf bank_mask:0xf
 v_add_f32_dpp v36, v36, v36 row_ror:4 row_mask:0xf bank_mask:0xf
 v_add_f32_dpp v37, v37, v37 row_ror:4 row_mask:0xf bank_mask:0xf
 v_add_f32_dpp v38, v38, v38 row_ror:4 row_mask:0xf bank_mask:0xf
 v_add_f32_dpp v39, v39, v39 row_ror:4 row_mask:0xf bank_mask:0xf
 v_add_f32_dpp v40, v40, v40 row_ror:4 row_mask:0xf bank_mask:0xf
 v_add_f32_dpp v41, v41, v41 row_ror:4 row_mask:0xf bank_mask:0xf
 v_add_f32_dpp v42, v42, v42 row_ror:4 row_mask:0xf bank_mask:0xf
 v_add_f32_dpp v43, v43, v43 row_ror:4 row_mask:0xf bank_mask:0xf
 v_add_f32_dpp v44, v44, v44 row_ror:4 row_mask:0xf bank_mask:0xf
 v_add_f32_dpp v45, v45, v45 row_ror:4 row_mask:0xf bank_mask:0xf
 v_add_f32_dpp v46, v46, v46 row_ror:4 row_mask:0xf bank_mask:0xf
 v_add_f32_dpp v47, v47, v47 row_ror:4 row_mask:0xf bank_mask:0xf
 v_add_f32_dpp v48, v48, v48 row_ror:4 row_mask:0xf bank_mask:0xf
 v_add_f32_dpp v49, v49, v49 row_ror:4 row_mask:0xf bank_mask:0xf
 v_add_f32_dpp v50, v50, v50 row_ror:4 row_mask:0xf bank_mask:0xf
 v_add_f32_dpp v51, v51, v51 row_ror:4 row_mask:0xf bank_mask:0xf
 v_add_f32_dpp v36, v36, v36 row_ror:2 row_mask:0xf bank_mask:0xf
 v_add_f32_dpp v37, v37, v37 row_ror:2 row_mask:0xf bank_mask:0xf
 v_add_f32_dpp v38, v38, v38 row_ror:2 row_mask:0xf bank_mask:0xf
 v_add_f32_dpp v39, v39, v39 row_ror:2 row_mask:0xf bank_mask:0xf
 v_add_f32_dpp v40, v40, v40 row_ror:2 row_mask:0xf bank_mask:0xf
 v_add_f32_dpp v41, v41, v41 row_ror:2 row_mask:0xf bank_mask:0xf
 v_add_f32_dpp v42, v42, v42 row_ror:2 row_mask:0xf bank_mask:0xf
 v_add_f32_dpp v43, v43, v43 row_ror:2 row_mask:0xf bank_mask:0xf
 v_add_f32_dpp v44, v44, v44 row_ror:2 row_mask:0xf bank_mask:0xf
 v_add_f32_dpp v45, v45, v45 row_ror:2 row_mask:0xf bank_mask:0xf
 v_add_f32_dpp v46, v46, v46 row_ror:2 row_mask:0xf bank_mask:0xf
 v_add_f32_dpp v47, v47, v47 row_ror:2 row_mask:0xf bank_mask:0xf
 v_add_f32_dpp v48, v48, v48 row_ror:2 row_mask:0xf bank_mask:0xf
 v_add_f32_dpp v49, v49, v49 row_ror:2 row_mask:0xf bank_mask:0xf
 v_add_f32_dpp v50, v50, v50 row_ror:2 row_mask:0xf bank_mask:0xf
 v_add_f32_dpp v51, v51, v51 row_ror:2 row_mask:0xf bank_mask:0xf
 v_add_f32_dpp v36, v36, v36 row_ror:1 row_mask:0xf bank_mask:0xf
 v_add_f32_dpp v37, v37, v37 row_ror:1 row_mask:0xf bank_mask:0xf
 v_add_f32_dpp v38, v38, v38 row_ror:1 row_mask:0xf bank_mask:0xf
 v_add_f32_dpp v39, v39, v39 row_ror:1 row_mask:0xf bank_mask:0xf
 v_add_f32_dpp v40, v40, v40 row_ror:1 row_mask:0xf bank_mask:0xf
 v_add_f32_dpp v41, v41, v41 row_ror:1 row_mask:0xf bank_mask:0xf
 v_add_f32_dpp v42, v42, v42 row_ror:1 row_mask:0xf bank_mask:0xf
 v_add_f32_dpp v43, v43, v43 row_ror:1 row_mask:0xf bank_mask:0xf
 v_add_f32_dpp v44, v44, v44 row_ror:1 row_mask:0xf bank_mask:0xf
 v_add_f32_dpp v45, v45, v45 row_ror:1 row_mask:0xf bank_mask:0xf
 v_add_f32_dpp v46, v46, v46 row_ror:1 row_mask:0xf bank_mask:0xf
 v_add_f32_dpp v47, v47, v47 row_ror:1 row_mask:0xf bank_mask:0xf
 v_add_f32_dpp v48, v48, v48 row_ror:1 row_mask:0xf bank_mask:0xf
 v_add_f32_dpp v49, v49, v49 row_ror:1 row_mask:0xf bank_mask:0xf
 v_add_f32_dpp v50, v50, v50 row_ror:1 row_mask:0xf bank_mask:0xf
 v_add_f32_dpp v51, v51, v51 row_ror:1 row_mask:0xf bank_mask:0xf
 v_mov_b32 v3, v36
 v_and_b32 v1, 15, v0
 v_cmp_eq_u32 vcc, 1, v1
 s_nop 1
 v_cndmask_b32 v3, v3, v37, vcc
 v_cmp_eq_u32 vcc, 2, v1
 s_nop 1
 v_cndmask_b32 v3, v3, v38, vcc
 v_cmp_eq_u32 vcc, 3, v1
 s_nop 1
 v_cndmask_b32 v3, v3, v39, vcc
 v_cmp_eq_u32 vcc, 4, v1
 s_nop 1
 v_cndmask_b32 v3, v3, v40, vcc
 v_cmp_eq_u32 vcc, 5, v1
 s_nop 1
 v_cndmask_b32 v3, v3, v41, vcc
 v_cmp_eq_u32 vcc, 6, v1
 s_nop 1
 v_cndmask_b32 v3, v3, v42, vcc
 v_cmp_eq_u32 vcc, 7, v1
 s_nop 1
 v_cndmask_b32 v3, v3, v43, vcc
 v_cmp_eq_u32 vcc, 8, v1
 s_nop 1
 v_cndmask_b32 v3, v3, v44, vcc
 v_cmp_eq_u32 vcc, 9, v1
 s_nop 1
 v_cndmask_b32 v3, v3, v45, vcc
 v_cmp_eq_u32 vcc, 10, v1
 s_nop 1
 v_cndmask_b32 v3, v3, v46, vcc
 v_cmp_eq_u32 vcc, 11, v1
 s_nop 1
 v_cndmask_b32 v3, v3, v47, vcc
 v_cmp_eq_u32 vcc, 12, v1
 s_nop 1
 v_cndmask_b32 v3, v3, v48, vcc
 v_cmp_eq_u32 vcc, 13, v1
 s_nop 1
 v_cndmask_b32 v3, v3, v49, vcc
 v_cmp_eq_u32 vcc, 14, v1
 s_nop 1
 v_cndmask_b32 v3, v3, v50, vcc
 v_cmp_eq_u32 vcc, 15, v1
 s_nop 1
 v_cndmask_b32 v3, v3, v51, vcc
 v_mov_b32 v2, v3
 s_nop 1
 v_permlane16_swap_b32 v3, v2
 v_add_f32 v3, v3, v2
 v_mov_b32 v2, v3
 s_nop 1
 v_permlane32_swap_b32 v3, v2
 v_add_f32 v3, v3, v2
 v_mul_f32 v3, 0xbfb8aa3b, v3
 v_exp_f32 v3, v3
 s_nop 0
 v_add_f32 v3, 1.0, v3
 v_rcp_f32 v3, v3
 v_lshrrev_b32 v2, 4, v0
 v_min_u32 v2, 1, v2
 v_lshlrev_b32 v2, 28, v2
 v_lshl_add_u32 v2, v0, 2, v2
 s_lshl_b32 s65, s65, 6
 s_add_u32 s65, s65, 0x6000000
 buffer_store_dword v3, v2, s[4:7], s65 offen sc1
 v_lshlrev_b32 v1, 2, v0
 s_lshr_b32 s66, s101, 2
 s_add_u32 s66, s66, 1
 s_branch L_hs1_120
L_hs_119:
 s_sleep 16
 s_sub_u32 s63, s63, 1
 s_cbranch_scc1 L_role_f_abort
L_hs1_120:
 buffer_load_dword v2, v1, s[16:19], 0 offen sc1
 s_waitcnt vmcnt(0)
 v_readlane_b32 s65, v2, s66
 s_cmp_eq_u32 s101, 128
 s_cbranch_scc1 L_hs2_121
 s_cmp_eq_u32 s101, 64
 s_cbranch_scc1 L_hs3_122
 v_readlane_b32 s67, v2, 9
 v_cmp_eq_u32 s[96:97], -1, v2
 s_mov_b32 vcc_lo, 0x20202020
 s_mov_b32 vcc_hi, 0x20202020
 s_nop 1
 s_cmp_lg_u32 s67, 0
 s_cbranch_scc1 L_retry
 s_andn2_b64 s[96:97], vcc, s[96:97]
 s_cbranch_scc1 L_hs_119
 s_branch L_hs2_121
L_hs3_122:
 v_readlane_b32 s67, v2, 10
 v_cmp_eq_u32 s[96:97], 32, v2
 s_mov_b32 vcc_lo, 0x01010101
 s_mov_b32 vcc_hi, 0x01010101
 s_nop 1
 s_cmp_lg_u32 s67, 0
 s_cbranch_scc1 L_fallback
 s_andn2_b64 s[96:97], vcc, s[96:97]
 s_cbranch_scc1 L_hs_119
L_hs2_121:
 s_cmp_ge_u32 s65, 64
 s_cbranch_scc0 L_hs_119
 s_lshr_b32 s73, s72, 1
 s_lshl_b32 s65, s60, 1
 s_and_b32 s66, s62, 1
 s_add_u32 s65, s65, s66
 s_lshr_b32 s66, s62, 1
 s_lshl_b32 s66, s66, 4
 s_add_u32 s65, s65, s66
 s_mul_i32 s65, s65, 131072
 v_lshrrev_b32 v1, 3, v0
 v_lshrrev_b32 v2, 2, v1
 v_and_b32 v3, 3, v1
 v_lshl_add_u32 v2, v2, 4, v3
 v_mul_u32_u24 v2, 2048, v2
 v_lshrrev_b32 v1, 1, v1
 v_and_b32 v3, 7, v0
 v_xor_b32 v1, v1, v3
 v_lshl_add_u32 v8, v1, 4, v2
 v_xor_b32 v9, 64, v8
 s_add_u32 s78, s65, 0x0
 s_add_u32 s79, s65, 0x2000
 s_add_u32 s80, s65, 0x4000
 s_add_u32 s81, s65, 0x6000
 s_add_u32 s82, s65, 0x10000
 s_add_u32 s83, s65, 0x12000
 s_add_u32 s84, s65, 0x14000
 s_add_u32 s85, s65, 0x16000
 s_lshl_b32 s76, s62, 13
 s_add_u32 m0, s76, 0
 s_nop 0
 buffer_load_dwordx4 v8, s[8:11], s78 offen  lds
 s_add_u32 m0, s76, 1024
 s_nop 0
 buffer_load_dwordx4 v9, s[8:11], s79 offen  lds
 s_add_u32 m0, s76, 2048
 s_nop 0
 buffer_load_dwordx4 v8, s[8:11], s80 offen  lds
 s_add_u32 m0, s76, 3072
 s_nop 0
 buffer_load_dwordx4 v9, s[8:11], s81 offen  lds
 s_add_u32 m0, s76, 4096
 s_nop 0
 buffer_load_dwordx4 v8, s[8:11], s82 offen  lds
 s_add_u32 m0, s76, 5120
 s_nop 0
 buffer_load_dwordx4 v9, s[8:11], s83 offen  lds
 s_add_u32 m0, s76, 6144
 s_nop 0
 buffer_load_dwordx4 v8, s[8:11], s84 offen  lds
 s_add_u32 m0, s76, 7168
 s_nop 0
 buffer_load_dwordx4 v9, s[8:11], s85 offen  lds
 v_add_u32 v8, 128, v8
 v_add_u32 v9, 128, v9
 s_add_u32 s76, s76, 32768
 s_and_b32 s76, s76, 0x1ffff
 s_add_u32 m0, s76, 0
 s_nop 0
 buffer_load_dwordx4 v8, s[8:11], s78 offen  lds
 s_add_u32 m0, s76, 1024
 s_nop 0
 buffer_load_dwordx4 v9, s[8:11], s79 offen  lds
 s_add_u32 m0, s76, 2048
 s_nop 0
 buffer_load_dwordx4 v8, s[8:11], s80 offen  lds
 s_add_u32 m0, s76, 3072
 s_nop 0
 buffer_load_dwordx4 v9, s[8:11], s81 offen  lds
 s_add_u32 m0, s76, 4096
 s_nop 0
 buffer_load_dwordx4 v8, s[8:11], s82 offen  lds
 s_add_u32 m0, s76, 5120
 s_nop 0
 buffer_load_dwordx4 v9, s[8:11], s83 offen  lds
 s_add_u32 m0, s76, 6144
 s_nop 0
 buffer_load_dwordx4 v8, s[8:11], s84 offen  lds
 s_add_u32 m0, s76, 7168
 s_nop 0
 buffer_load_dwordx4 v9, s[8:11], s85 offen  lds
 v_add_u32 v8, 128, v8
 v_add_u32 v9, 128, v9
 s_add_u32 s76, s76, 32768
 s_and_b32 s76, s76, 0x1ffff
 v_bfe_u32 v1, v0, 1, 3
 v_xor_b32 v1, v1, v6
 v_lshlrev_b32 v1, 4, v1
 v_lshl_add_u32 v10, v5, 7, v1
 v_xor_b32 v11, 32, v10
 v_xor_b32 v12, 64, v10
 v_xor_b32 v13, 96, v10
 s_mov_b32 s66, 0x3a800000
 s_and_b32 s65, s72, 1
 s_lshl_b32 s65, s65, 2
 s_add_u32 s65, s65, s62
 s_lshl_b32 s65, s65, 6
 s_add_u32 s65, s65, 0
 v_add_u32 v1, s65, v5
 v_and_b32 v2, -2, v1
 v_add_u32 v2, s73, v2
 v_and_b32 v3, 1, v1
 v_lshl_add_u32 v4, v2, 1, v3
 v_cmp_eq_u32 vcc, 1, v4
 v_cvt_f32_u32 v3, v3
 v_mul_f32 v3, 0xbe800000, v3
 v_mov_b32 v4, 512
 v_cndmask_b32 v2, v2, v4, vcc
 v_cndmask_b32 v3, v3, 0, vcc
 v_lshl_add_u32 v4, v6, 3, 0
 v_mul_u32_u24 v4, v4, v2
 v_and_b32 v4, 1023, v4
 v_cvt_f32_u32 v4, v4
 v_fma_f32 v28, v4, s66, v3
 v_lshl_add_u32 v4, v6, 3, 1
 v_mul_u32_u24 v4, v4, v2
 v_and_b32 v4, 1023, v4
 v_cvt_f32_u32 v4, v4
 v_fma_f32 v29, v4, s66, v3
 v_lshl_add_u32 v4, v6, 3, 2
 v_mul_u32_u24 v4, v4, v2
 v_and_b32 v4, 1023, v4
 v_cvt_f32_u32 v4, v4
 v_fma_f32 v30, v4, s66, v3
 v_lshl_add_u32 v4, v6, 3, 3
 v_mul_u32_u24 v4, v4, v2
 v_and_b32 v4, 1023, v4
 v_cvt_f32_u32 v4, v4
 v_fma_f32 v31, v4, s66, v3
 v_lshl_add_u32 v4, v6, 3, 4
 v_mul_u32_u24 v4, v4, v2
 v_and_b32 v4, 1023, v4
 v_cvt_f32_u32 v4, v4
 v_fma_f32 v32, v4, s66, v3
 v_lshl_add_u32 v4, v6, 3, 5
 v_mul_u32_u24 v4, v4, v2
 v_and_b32 v4, 1023, v4
 v_cvt_f32_u32 v4, v4
 v_fma_f32 v33, v4, s66, v3
 v_lshl_add_u32 v4, v6, 3, 6
 v_mul_u32_u24 v4, v4, v2
 v_and_b32 v4, 1023, v4
 v_cvt_f32_u32 v4, v4
 v_fma_f32 v34, v4, s66, v3
 v_lshl_add_u32 v4, v6, 3, 7
 v_mul_u32_u24 v4, v4, v2
 v_and_b32 v4, 1023, v4
 v_cvt_f32_u32 v4, v4
 v_fma_f32 v35, v4, s66, v3
 v_lshlrev_b32 v4, 4, v2
 v_and_b32 v4, 1023, v4
 v_cvt_f32_u32 v4, v4
 v_mul_f32 v14, s66, v4
 v_cos_f32 v44, v28
 v_cos_f32 v45, v29
 v_cos_f32 v46, v30
 v_cos_f32 v47, v31
 v_cos_f32 v48, v32
 v_cos_f32 v49, v33
 v_cos_f32 v50, v34
 v_cos_f32 v51, v35
 v_add_f32 v28, v28, v14
 v_add_f32 v29, v29, v14
 v_add_f32 v30, v30, v14
 v_add_f32 v31, v31, v14
 v_add_f32 v32, v32, v14
 v_add_f32 v33, v33, v14
 v_add_f32 v34, v34, v14
 v_add_f32 v35, v35, v14
 v_cvt_pk_bf16_f32 v60, v44, v45
 v_cvt_pk_bf16_f32 v61, v46, v47
 v_cvt_pk_bf16_f32 v62, v48, v49
 v_cvt_pk_bf16_f32 v63, v50, v51
 s_and_b32 s65, s72, 1
 s_lshl_b32 s65, s65, 2
 s_add_u32 s65, s65, s62
 s_lshl_b32 s65, s65, 6
 s_add_u32 s65, s65, 32
 v_add_u32 v1, s65, v5
 v_and_b32 v2, -2, v1
 v_add_u32 v2, s73, v2
 v_and_b32 v3, 1, v1
 v_lshl_add_u32 v4, v2, 1, v3
 v_cmp_eq_u32 vcc, 1, v4
 v_cvt_f32_u32 v3, v3
 v_mul_f32 v3, 0xbe800000, v3
 v_mov_b32 v4, 512
 v_cndmask_b32 v2, v2, v4, vcc
 v_cndmask_b32 v3, v3, 0, vcc
 v_lshl_add_u32 v4, v6, 3, 0
 v_mul_u32_u24 v4, v4, v2
 v_and_b32 v4, 1023, v4
 v_cvt_f32_u32 v4, v4
 v_fma_f32 v36, v4, s66, v3
 v_lshl_add_u32 v4, v6, 3, 1
 v_mul_u32_u24 v4, v4, v2
 v_and_b32 v4, 1023, v4
 v_cvt_f32_u32 v4, v4
 v_fma_f32 v37, v4, s66, v3
 v_lshl_add_u32 v4, v6, 3, 2
 v_mul_u32_u24 v4, v4, v2
 v_and_b32 v4, 1023, v4
 v_cvt_f32_u32 v4, v4
 v_fma_f32 v38, v4, s66, v3
 v_lshl_add_u32 v4, v6, 3, 3
 v_mul_u32_u24 v4, v4, v2
 v_and_b32 v4, 1023, v4
 v_cvt_f32_u32 v4, v4
 v_fma_f32 v39, v4, s66, v3
 v_lshl_add_u32 v4, v6, 3, 4
 v_mul_u32_u24 v4, v4, v2
 v_and_b32 v4, 1023, v4
 v_cvt_f32_u32 v4, v4
 v_fma_f32 v40, v4, s66, v3
 v_lshl_add_u32 v4, v6, 3, 5
 v_mul_u32_u24 v4, v4, v2
 v_and_b32 v4, 1023, v4
 v_cvt_f32_u32 v4, v4
 v_fma_f32 v41, v4, s66, v3
 v_lshl_add_u32 v4, v6, 3, 6
 v_mul_u32_u24 v4, v4, v2
 v_and_b32 v4, 1023, v4
 v_cvt_f32_u32 v4, v4
 v_fma_f32 v42, v4, s66, v3
 v_lshl_add_u32 v4, v6, 3, 7
 v_mul_u32_u24 v4, v4, v2
 v_and_b32 v4, 1023, v4
 v_cvt_f32_u32 v4, v4
 v_fma_f32 v43, v4, s66, v3
 v_lshlrev_b32 v4, 4, v2
 v_and_b32 v4, 1023, v4
 v_cvt_f32_u32 v4, v4
 v_mul_f32 v15, s66, v4
 v_cos_f32 v52, v36
 v_cos_f32 v53, v37
 v_cos_f32 v54, v38
 v_cos_f32 v55, v39
 v_cos_f32 v56, v40
 v_cos_f32 v57, v41
 v_cos_f32 v58, v42
 v_cos_f32 v59, v43
 v_add_f32 v36, v36, v15
 v_add_f32 v37, v37, v15
 v_add_f32 v38, v38, v15
 v_add_f32 v39, v39, v15
 v_add_f32 v40, v40, v15
 v_add_f32 v41, v41, v15
 v_add_f32 v42, v42, v15
 v_add_f32 v43, v43, v15
 v_cvt_pk_bf16_f32 v64, v52, v53
 v_cvt_pk_bf16_f32 v65, v54, v55
 v_cvt_pk_bf16_f32 v66, v56, v57
 v_cvt_pk_bf16_f32 v67, v58, v59
 v_mov_b32 v104, 0
 v_mov_b32 v105, 0
 v_mov_b32 v106, 0
 v_mov_b32 v107, 0
 s_nop 1
 v_mfma_f32_32x32x16_bf16 a[0:15], v[104:107], v[104:107], 0
 v_mfma_f32_32x32x16_bf16 a[16:31], v[104:107], v[104:107], 0
 v_mfma_f32_32x32x16_bf16 a[32:47], v[104:107], v[104:107], 0
 v_mfma_f32_32x32x16_bf16 a[48:63], v[104:107], v[104:107], 0
 v_mfma_f32_32x32x16_bf16 a[64:79], v[104:107], v[104:107], 0
 v_mfma_f32_32x32x16_bf16 a[80:95], v[104:107], v[104:107], 0
 v_mfma_f32_32x32x16_bf16 a[96:111], v[104:107], v[104:107], 0
 v_mfma_f32_32x32x16_bf16 a[112:127], v[104:107], v[104:107], 0
 v_mfma_f32_32x32x16_bf16 a[128:143], v[104:107], v[104:107], 0
 v_mfma_f32_32x32x16_bf16 a[144:159], v[104:107], v[104:107], 0
 v_mfma_f32_32x32x16_bf16 a[160:175], v[104:107], v[104:107], 0
 v_mfma_f32_32x32x16_bf16 a[176:191], v[104:107], v[104:107], 0
 v_mfma_f32_32x32x16_bf16 a[192:207], v[104:107], v[104:107], 0
 v_mfma_f32_32x32x16_bf16 a[208:223], v[104:107], v[104:107], 0
 v_mfma_f32_32x32x16_bf16 a[224:239], v[104:107], v[104:107], 0
 v_mfma_f32_32x32x16_bf16 a[240:255], v[104:107], v[104:107], 0
 s_waitcnt vmcnt(8)
 s_barrier
 ds_read_b128 v[76:79], v10 offset:0
 ds_read_b128 v[80:83], v10 offset:4096
 ds_read_b128 v[84:87], v10 offset:8192
 ds_read_b128 v[88:91], v10 offset:12288
 ds_read_b128 v[92:95], v10 offset:16384
 ds_read_b128 v[96:99], v10 offset:20480
 s_mov_b32 s75, 8
L_f_loop_123:
 s_waitcnt lgkmcnt(5)
 v_mfma_f32_32x32x16_bf16 a[0:15], v[76:79], v[60:63], a[0:15]
 ds_read_b128 v[100:103], v10 offset:24576
 v_cos_f32 v44, v28
 v_mfma_f32_32x32x16_bf16 a[128:143], v[76:79], v[64:67], a[128:143]
 v_cos_f32 v45, v29
 v_add_f32 v28, v28, v14
 s_waitcnt lgkmcnt(5)
 v_mfma_f32_32x32x16_bf16 a[16:31], v[80:83], v[60:63], a[16:31]
 ds_read_b128 v[104:107], v10 offset:28672
 v_cos_f32 v46, v30
 v_add_f32 v29, v29, v14
 v_cvt_pk_bf16_f32 v68, v44, v45
 v_mfma_f32_32x32x16_bf16 a[144:159], v[80:83], v[64:67], a[144:159]
 v_cos_f32 v47, v31
 v_add_f32 v30, v30, v14
 s_waitcnt lgkmcnt(5)
 s_add_u32 m0, s76, 0
 v_mfma_f32_32x32x16_bf16 a[32:47], v[84:87], v[60:63], a[32:47]
 ds_read_b128 v[76:79], v11 offset:0
 v_cos_f32 v48, v32
 v_add_f32 v31, v31, v14
 v_cvt_pk_bf16_f32 v69, v46, v47
 v_mfma_f32_32x32x16_bf16 a[160:175], v[84:87], v[64:67], a[160:175]
 buffer_load_dwordx4 v8, s[8:11], s78 offen  lds
 v_cos_f32 v49, v33
 v_add_f32 v32, v32, v14
 s_waitcnt lgkmcnt(5)
 v_mfma_f32_32x32x16_bf16 a[48:63], v[88:91], v[60:63], a[48:63]
 ds_read_b128 v[80:83], v11 offset:4096
 v_cos_f32 v50, v34
 v_add_f32 v33, v33, v14
 v_cvt_pk_bf16_f32 v70, v48, v49
 v_cos_f32 v52, v36
 v_mfma_f32_32x32x16_bf16 a[176:191], v[88:91], v[64:67], a[176:191]
 v_cos_f32 v51, v35
 v_add_f32 v34, v34, v14
 v_cos_f32 v53, v37
 v_add_f32 v36, v36, v15
 s_waitcnt lgkmcnt(5)
 v_mfma_f32_32x32x16_bf16 a[64:79], v[92:95], v[60:63], a[64:79]
 ds_read_b128 v[84:87], v11 offset:8192
 v_add_f32 v35, v35, v14
 v_cvt_pk_bf16_f32 v71, v50, v51
 v_cos_f32 v54, v38
 v_add_f32 v37, v37, v15
 v_cvt_pk_bf16_f32 v72, v52, v53
 v_mfma_f32_32x32x16_bf16 a[192:207], v[92:95], v[64:67], a[192:207]
 v_cos_f32 v55, v39
 v_add_f32 v38, v38, v15
 s_waitcnt lgkmcnt(5)
 s_add_u32 m0, s76, 1024
 v_mfma_f32_32x32x16_bf16 a[80:95], v[96:99], v[60:63], a[80:95]
 ds_read_b128 v[88:91], v11 offset:12288
 v_cos_f32 v56, v40
 v_add_f32 v39, v39, v15
 v_cvt_pk_bf16_f32 v73, v54, v55
 v_mfma_f32_32x32x16_bf16 a[208:223], v[96:99], v[64:67], a[208:223]
 buffer_load_dwordx4 v9, s[8:11], s79 offen  lds
 v_cos_f32 v57, v41
 v_add_f32 v40, v40, v15
 s_waitcnt lgkmcnt(5)
 v_mfma_f32_32x32x16_bf16 a[96:111], v[100:103], v[60:63], a[96:111]
 ds_read_b128 v[92:95], v11 offset:16384
 v_cos_f32 v58, v42
 v_add_f32 v41, v41, v15
 v_cvt_pk_bf16_f32 v74, v56, v57
 v_mfma_f32_32x32x16_bf16 a[224:239], v[100:103], v[64:67], a[224:239]
 v_cos_f32 v59, v43
 v_add_f32 v42, v42, v15
 s_waitcnt lgkmcnt(5)
 v_mfma_f32_32x32x16_bf16 a[112:127], v[104:107], v[60:63], a[112:127]
 ds_read_b128 v[96:99], v11 offset:20480
 v_add_f32 v43, v43, v15
 v_cvt_pk_bf16_f32 v75, v58, v59
 v_mfma_f32_32x32x16_bf16 a[240:255], v[104:107], v[64:67], a[240:255]
 s_waitcnt lgkmcnt(5)
 s_add_u32 m0, s76, 2048
 v_mfma_f32_32x32x16_bf16 a[0:15], v[76:79], v[68:71], a[0:15]
 ds_read_b128 v[100:103], v11 offset:24576
 v_cos_f32 v44, v28
 v_mfma_f32_32x32x16_bf16 a[128:143], v[76:79], v[72:75], a[128:143]
 buffer_load_dwordx4 v8, s[8:11], s80 offen  lds
 v_cos_f32 v45, v29
 v_add_f32 v28, v28, v14
 s_waitcnt lgkmcnt(5)
 v_mfma_f32_32x32x16_bf16 a[16:31], v[80:83], v[68:71], a[16:31]
 ds_read_b128 v[104:107], v11 offset:28672
 v_cos_f32 v46, v30
 v_add_f32 v29, v29, v14
 v_cvt_pk_bf16_f32 v60, v44, v45
 v_mfma_f32_32x32x16_bf16 a[144:159], v[80:83], v[72:75], a[144:159]
 v_cos_f32 v47, v31
 v_add_f32 v30, v30, v14
 s_waitcnt lgkmcnt(5)
 v_mfma_f32_32x32x16_bf16 a[32:47], v[84:87], v[68:71], a[32:47]
 ds_read_b128 v[76:79], v12 offset:0
 v_cos_f32 v48, v32
 v_add_f32 v31, v31, v14
 v_cvt_pk_bf16_f32 v61, v46, v47
 v_mfma_f32_32x32x16_bf16 a[160:175], v[84:87], v[72:75], a[160:175]
 v_cos_f32 v49, v33
 v_add_f32 v32, v32, v14
 s_waitcnt lgkmcnt(5)
 s_add_u32 m0, s76, 3072
 v_mfma_f32_32x32x16_bf16 a[48:63], v[88:91], v[68:71], a[48:63]
 ds_read_b128 v[80:83], v12 offset:4096
 v_cos_f32 v50, v34
 v_add_f32 v33, v33, v14
 v_cvt_pk_bf16_f32 v62, v48, v49
 v_cos_f32 v52, v36
 v_mfma_f32_32x32x16_bf16 a[176:191], v[88:91], v[72:75], a[176:191]
 buffer_load_dwordx4 v9, s[8:11], s81 offen  lds
 v_cos_f32 v51, v35
 v_add_f32 v34, v34, v14
 v_cos_f32 v53, v37
 v_add_f32 v36, v36, v15
 s_waitcnt lgkmcnt(5)
 v_mfma_f32_32x32x16_bf16 a[64:79], v[92:95], v[68:71], a[64:79]
 ds_read_b128 v[84:87], v12 offset:8192
 v_add_f32 v35, v35, v14
 v_cvt_pk_bf16_f32 v63, v50, v51
 v_cos_f32 v54, v38
 v_add_f32 v37, v37, v15
 v_cvt_pk_bf16_f32 v64, v52, v53
 v_mfma_f32_32x32x16_bf16 a[192:207], v[92:95], v[72:75], a[192:207]
 v_cos_f32 v55, v39
 v_add_f32 v38, v38, v15
 s_waitcnt lgkmcnt(5)
 v_mfma_f32_32x32x16_bf16 a[80:95], v[96:99], v[68:71], a[80:95]
 ds_read_b128 v[88:91], v12 offset:12288
 v_cos_f32 v56, v40
 v_add_f32 v39, v39, v15
 v_cvt_pk_bf16_f32 v65, v54, v55
 v_mfma_f32_32x32x16_bf16 a[208:223], v[96:99], v[72:75], a[208:223]
 v_cos_f32 v57, v41
 v_add_f32 v40, v40, v15
 s_waitcnt lgkmcnt(5)
 s_add_u32 m0, s76, 4096
 v_mfma_f32_32x32x16_bf16 a[96:111], v[100:103], v[68:71], a[96:111]
 ds_read_b128 v[92:95], v12 offset:16384
 v_cos_f32 v58, v42
 v_add_f32 v41, v41, v15
 v_cvt_pk_bf16_f32 v66, v56, v57
 v_mfma_f32_32x32x16_bf16 a[224:239], v[100:103], v[72:75], a[224:239]
 buffer_load_dwordx4 v8, s[8:11], s82 offen  lds
 v_cos_f32 v59, v43
 v_add_f32 v42, v42, v15
 s_waitcnt lgkmcnt(5)
 v_mfma_f32_32x32x16_bf16 a[112:127], v[104:107], v[68:71], a[112:127]
 ds_read_b128 v[96:99], v12 offset:20480
 v_add_f32 v43, v43, v15
 v_cvt_pk_bf16_f32 v67, v58, v59
 v_mfma_f32_32x32x16_bf16 a[240:255], v[104:107], v[72:75], a[240:255]
 s_waitcnt lgkmcnt(5)
 v_mfma_f32_32x32x16_bf16 a[0:15], v[76:79], v[60:63], a[0:15]
 ds_read_b128 v[100:103], v12 offset:24576
 v_cos_f32 v44, v28
 v_mfma_f32_32x32x16_bf16 a[128:143], v[76:79], v[64:67], a[128:143]
 v_cos_f32 v45, v29
 v_add_f32 v28, v28, v14
 s_waitcnt lgkmcnt(5)
 s_add_u32 m0, s76, 5120
 v_mfma_f32_32x32x16_bf16 a[16:31], v[80:83], v[60:63], a[16:31]
 ds_read_b128 v[104:107], v12 offset:28672
 v_cos_f32 v46, v30
 v_add_f32 v29, v29, v14
 v_cvt_pk_bf16_f32 v68, v44, v45
 v_mfma_f32_32x32x16_bf16 a[144:159], v[80:83], v[64:67], a[144:159]
 buffer_load_dwordx4 v9, s[8:11], s83 offen  lds
 v_cos_f32 v47, v31
 v_add_f32 v30, v30, v14
 s_waitcnt lgkmcnt(5)
 v_mfma_f32_32x32x16_bf16 a[32:47], v[84:87], v[60:63], a[32:47]
 ds_read_b128 v[76:79], v13 offset:0
 v_cos_f32 v48, v32
 v_add_f32 v31, v31, v14
 v_cvt_pk_bf16_f32 v69, v46, v47
 v_mfma_f32_32x32x16_bf16 a[160:175], v[84:87], v[64:67], a[160:175]
 v_cos_f32 v49, v33
 v_add_f32 v32, v32, v14
 s_waitcnt lgkmcnt(5)
 v_mfma_f32_32x32x16_bf16 a[48:63], v[88:91], v[60:63], a[48:63]
 ds_read_b128 v[80:83], v13 offset:4096
 v_cos_f32 v50, v34
 v_add_f32 v33, v33, v14
 v_cvt_pk_bf16_f32 v70, v48, v49
 v_cos_f32 v52, v36
 v_mfma_f32_32x32x16_bf16 a[176:191], v[88:91], v[64:67], a[176:191]
 v_cos_f32 v51, v35
 v_add_f32 v34, v34, v14
 v_cos_f32 v53, v37
 v_add_f32 v36, v36, v15
 s_waitcnt lgkmcnt(5)
 s_add_u32 m0, s76, 6144
 v_mfma_f32_32x32x16_bf16 a[64:79], v[92:95], v[60:63], a[64:79]
 ds_read_b128 v[84:87], v13 offset:8192
 v_add_f32 v35, v35, v14
 v_cvt_pk_bf16_f32 v71, v50, v51
 v_cos_f32 v54, v38
 v_add_f32 v37, v37, v15
 v_cvt_pk_bf16_f32 v72, v52, v53
 v_mfma_f32_32x32x16_bf16 a[192:207], v[92:95], v[64:67], a[192:207]
 buffer_load_dwordx4 v8, s[8:11], s84 offen  lds
 v_cos_f32 v55, v39
 v_add_f32 v38, v38, v15
 s_waitcnt lgkmcnt(5)
 v_mfma_f32_32x32x16_bf16 a[80:95], v[96:99], v[60:63], a[80:95]
 ds_read_b128 v[88:91], v13 offset:12288
 v_cos_f32 v56, v40
 v_add_f32 v39, v39, v15
 v_cvt_pk_bf16_f32 v73, v54, v55
 v_mfma_f32_32x32x16_bf16 a[208:223], v[96:99], v[64:67], a[208:223]
 v_cos_f32 v57, v41
 v_add_f32 v40, v40, v15
 s_waitcnt lgkmcnt(5)
 v_mfma_f32_32x32x16_bf16 a[96:111], v[100:103], v[60:63], a[96:111]
 ds_read_b128 v[92:95], v13 offset:16384
 v_cos_f32 v58, v42
 v_add_f32 v41, v41, v15
 v_cvt_pk_bf16_f32 v74, v56, v57
 v_mfma_f32_32x32x16_bf16 a[224:239], v[100:103], v[64:67], a[224:239]
 v_cos_f32 v59, v43
 v_add_f32 v42, v42, v15
 s_waitcnt lgkmcnt(5)
 s_add_u32 m0, s76, 7168
 v_mfma_f32_32x32x16_bf16 a[112:127], v[104:107], v[60:63], a[112:127]
 ds_read_b128 v[96:99], v13 offset:20480
 v_add_f32 v43, v43, v15
 v_cvt_pk_bf16_f32 v75, v58, v59
 v_mfma_f32_32x32x16_bf16 a[240:255], v[104:107], v[64:67], a[240:255]
 buffer_load_dwordx4 v9, s[8:11], s85 offen  lds
 s_waitcnt lgkmcnt(5)
 v_mfma_f32_32x32x16_bf16 a[0:15], v[76:79], v[68:71], a[0:15]
 ds_read_b128 v[100:103], v13 offset:24576
 v_cos_f32 v44, v28
 v_mfma_f32_32x32x16_bf16 a[128:143], v[76:79], v[72:75], a[128:143]
 v_cos_f32 v45, v29
 v_add_f32 v28, v28, v14
 v_add_u32 v8, 128, v8
 v_add_u32 v9, 128, v9
 s_add_u32 s76, s76, 32768
 s_and_b32 s76, s76, 0x1ffff
 s_waitcnt lgkmcnt(5)
 v_mfma_f32_32x32x16_bf16 a[16:31], v[80:83], v[68:71], a[16:31]
 ds_read_b128 v[104:107], v13 offset:28672
 v_cos_f32 v46, v30
 v_add_f32 v29, v29, v14
 v_cvt_pk_bf16_f32 v60, v44, v45
 v_mfma_f32_32x32x16_bf16 a[144:159], v[80:83], v[72:75], a[144:159]
 v_cos_f32 v47, v31
 v_add_f32 v30, v30, v14
 s_waitcnt vmcnt(8)
 s_barrier
 s_waitcnt lgkmcnt(5)
 v_mfma_f32_32x32x16_bf16 a[32:47], v[84:87], v[68:71], a[32:47]
 ds_read_b128 v[76:79], v10 offset:32768
 v_cos_f32 v48, v32
 v_add_f32 v31, v31, v14
 v_cvt_pk_bf16_f32 v61, v46, v47
 v_mfma_f32_32x32x16_bf16 a[160:175], v[84:87], v[72:75], a[160:175]
 v_cos_f32 v49, v33
 v_add_f32 v32, v32, v14
 s_waitcnt lgkmcnt(5)
 v_mfma_f32_32x32x16_bf16 a[48:63], v[88:91], v[68:71], a[48:63]
 ds_read_b128 v[80:83], v10 offset:36864
 v_cos_f32 v50, v34
 v_add_f32 v33, v33, v14
 v_cvt_pk_bf16_f32 v62, v48, v49
 v_cos_f32 v52, v36
 v_mfma_f32_32x32x16_bf16 a[176:191], v[88:91], v[72:75], a[176:191]
 v_cos_f32 v51, v35
 v_add_f32 v34, v34, v14
 v_cos_f32 v53, v37
 v_add_f32 v36, v36, v15
 s_waitcnt lgkmcnt(5)
 v_mfma_f32_32x32x16_bf16 a[64:79], v[92:95], v[68:71], a[64:79]
 ds_read_b128 v[84:87], v10 offset:40960
 v_add_f32 v35, v35, v14
 v_cvt_pk_bf16_f32 v63, v50, v51
 v_cos_f32 v54, v38
 v_add_f32 v37, v37, v15
 v_cvt_pk_bf16_f32 v64, v52, v53
 v_mfma_f32_32x32x16_bf16 a[192:207], v[92:95], v[72:75], a[192:207]
 v_cos_f32 v55, v39
 v_add_f32 v38, v38, v15
 s_waitcnt lgkmcnt(5)
 v_mfma_f32_32x32x16_bf16 a[80:95], v[96:99], v[68:71], a[80:95]
 ds_read_b128 v[88:91], v10 offset:45056
 v_cos_f32 v56, v40
 v_add_f32 v39, v39, v15
 v_cvt_pk_bf16_f32 v65, v54, v55
 v_mfma_f32_32x32x16_bf16 a[208:223], v[96:99], v[72:75], a[208:223]
 v_cos_f32 v57, v41
 v_add_f32 v40, v40, v15
 s_waitcnt lgkmcnt(5)
 v_mfma_f32_32x32x16_bf16 a[96:111], v[100:103], v[68:71], a[96:111]
 ds_read_b128 v[92:95], v10 offset:49152
 v_cos_f32 v58, v42
 v_add_f32 v41, v41, v15
 v_cvt_pk_bf16_f32 v66, v56, v57
 v_mfma_f32_32x32x16_bf16 a[224:239], v[100:103], v[72:75], a[224:239]
 v_cos_f32 v59, v43
 v_add_f32 v42, v42, v15
 s_waitcnt lgkmcnt(5)
 v_mfma_f32_32x32x16_bf16 a[112:127], v[104:107], v[68:71], a[112:127]
 ds_read_b128 v[96:99], v10 offset:53248
 v_add_f32 v43, v43, v15
 v_cvt_pk_bf16_f32 v67, v58, v59
 v_mfma_f32_32x32x16_bf16 a[240:255], v[104:107], v[72:75], a[240:255]
 s_waitcnt lgkmcnt(5)
 v_mfma_f32_32x32x16_bf16 a[0:15], v[76:79], v[60:63], a[0:15]
 ds_read_b128 v[100:103], v10 offset:57344
 v_cos_f32 v44, v28
 v_mfma_f32_32x32x16_bf16 a[128:143], v[76:79], v[64:67], a[128:143]
 v_cos_f32 v45, v29
 v_add_f32 v28, v28, v14
 s_waitcnt lgkmcnt(5)
 v_mfma_f32_32x32x16_bf16 a[16:31], v[80:83], v[60:63], a[16:31]
 ds_read_b128 v[104:107], v10 offset:61440
 v_xor_b32 v10, 0x10000, v10
 v_cos_f32 v46, v30
 v_add_f32 v29, v29, v14
 v_cvt_pk_bf16_f32 v68, v44, v45
 v_mfma_f32_32x32x16_bf16 a[144:159], v[80:83], v[64:67], a[144:159]
 v_cos_f32 v47, v31
 v_add_f32 v30, v30, v14
 s_waitcnt lgkmcnt(5)
 s_add_u32 m0, s76, 0
 v_mfma_f32_32x32x16_bf16 a[32:47], v[84:87], v[60:63], a[32:47]
 ds_read_b128 v[76:79], v11 offset:32768
 v_cos_f32 v48, v32
 v_add_f32 v31, v31, v14
 v_cvt_pk_bf16_f32 v69, v46, v47
 v_mfma_f32_32x32x16_bf16 a[160:175], v[84:87], v[64:67], a[160:175]
 buffer_load_dwordx4 v8, s[8:11], s78 offen  lds
 v_cos_f32 v49, v33
 v_add_f32 v32, v32, v14
 s_waitcnt lgkmcnt(5)
 v_mfma_f32_32x32x16_bf16 a[48:63], v[88:91], v[60:63], a[48:63]
 ds_read_b128 v[80:83], v11 offset:36864
 v_cos_f32 v50, v34
 v_add_f32 v33, v33, v14
 v_cvt_pk_bf16_f32 v70, v48, v49
 v_cos_f32 v52, v36
 v_mfma_f32_32x32x16_bf16 a[176:191], v[88:91], v[64:67], a[176:191]
 v_cos_f32 v51, v35
 v_add_f32 v34, v34, v14
 v_cos_f32 v53, v37
 v_add_f32 v36, v36, v15
 s_waitcnt lgkmcnt(5)
 v_mfma_f32_32x32x16_bf16 a[64:79], v[92:95], v[60:63], a[64:79]
 ds_read_b128 v[84:87], v11 offset:40960
 v_add_f32 v35, v35, v14
 v_cvt_pk_bf16_f32 v71, v50, v51
 v_cos_f32 v54, v38
 v_add_f32 v37, v37, v15
 v_cvt_pk_bf16_f32 v72, v52, v53
 v_mfma_f32_32x32x16_bf16 a[192:207], v[92:95], v[64:67], a[192:207]
 v_cos_f32 v55, v39
 v_add_f32 v38, v38, v15
 s_waitcnt lgkmcnt(5)
 s_add_u32 m0, s76, 1024
 v_mfma_f32_32x32x16_bf16 a[80:95], v[96:99], v[60:63], a[80:95]
 ds_read_b128 v[88:91], v11 offset:45056
 v_cos_f32 v56, v40
 v_add_f32 v39, v39, v15
 v_cvt_pk_bf16_f32 v73, v54, v55
 v_mfma_f32_32x32x16_bf16 a[208:223], v[96:99], v[64:67], a[208:223]
 buffer_load_dwordx4 v9, s[8:11], s79 offen  lds
 v_cos_f32 v57, v41
 v_add_f32 v40, v40, v15
 s_waitcnt lgkmcnt(5)
 v_mfma_f32_32x32x16_bf16 a[96:111], v[100:103], v[60:63], a[96:111]
 ds_read_b128 v[92:95], v11 offset:49152
 v_cos_f32 v58, v42
 v_add_f32 v41, v41, v15
 v_cvt_pk_bf16_f32 v74, v56, v57
 v_mfma_f32_32x32x16_bf16 a[224:239], v[100:103], v[64:67], a[224:239]
 v_cos_f32 v59, v43
 v_add_f32 v42, v42, v15
 s_waitcnt lgkmcnt(5)
 v_mfma_f32_32x32x16_bf16 a[112:127], v[104:107], v[60:63], a[112:127]
 ds_read_b128 v[96:99], v11 offset:53248
 v_add_f32 v43, v43, v15
 v_cvt_pk_bf16_f32 v75, v58, v59
 v_mfma_f32_32x32x16_bf16 a[240:255], v[104:107], v[64:67], a[240:255]
 s_waitcnt lgkmcnt(5)
 s_add_u32 m0, s76, 2048
 v_mfma_f32_32x32x16_bf16 a[0:15], v[76:79], v[68:71], a[0:15]
 ds_read_b128 v[100:103], v11 offset:57344
 v_cos_f32 v44, v28
 v_mfma_f32_32x32x16_bf16 a[128:143], v[76:79], v[72:75], a[128:143]
 buffer_load_dwordx4 v8, s[8:11], s80 offen  lds
 v_cos_f32 v45, v29
 v_add_f32 v28, v28, v14
 s_waitcnt lgkmcnt(5)
 v_mfma_f32_32x32x16_bf16 a[16:31], v[80:83], v[68:71], a[16:31]
 ds_read_b128 v[104:107], v11 offset:61440
 v_xor_b32 v11, 0x10000, v11
 v_cos_f32 v46, v30
 v_add_f32 v29, v29, v14
 v_cvt_pk_bf16_f32 v60, v44, v45
 v_mfma_f32_32x32x16_bf16 a[144:159], v[80:83], v[72:75], a[144:159]
 v_cos_f32 v47, v31
 v_add_f32 v30, v30, v14
 s_waitcnt lgkmcnt(5)
 v_mfma_f32_32x32x16_bf16 a[32:47], v[84:87], v[68:71], a[32:47]
 ds_read_b128 v[76:79], v12 offset:32768
 v_cos_f32 v48, v32
 v_add_f32 v31, v31, v14
 v_cvt_pk_bf16_f32 v61, v46, v47
 v_mfma_f32_32x32x16_bf16 a[160:175], v[84:87], v[72:75], a[160:175]
 v_cos_f32 v49, v33
 v_add_f32 v32, v32, v14
 s_waitcnt lgkmcnt(5)
 s_add_u32 m0, s76, 3072
 v_mfma_f32_32x32x16_bf16 a[48:63], v[88:91], v[68:71], a[48:63]
 ds_read_b128 v[80:83], v12 offset:36864
 v_cos_f32 v50, v34
 v_add_f32 v33, v33, v14
 v_cvt_pk_bf16_f32 v62, v48, v49
 v_cos_f32 v52, v36
 v_mfma_f32_32x32x16_bf16 a[176:191], v[88:91], v[72:75], a[176:191]
 buffer_load_dwordx4 v9, s[8:11], s81 offen  lds
 v_cos_f32 v51, v35
 v_add_f32 v34, v34, v14
 v_cos_f32 v53, v37
 v_add_f32 v36, v36, v15
 s_waitcnt lgkmcnt(5)
 v_mfma_f32_32x32x16_bf16 a[64:79], v[92:95], v[68:71], a[64:79]
 ds_read_b128 v[84:87], v12 offset:40960
 v_add_f32 v35, v35, v14
 v_cvt_pk_bf16_f32 v63, v50, v51
 v_cos_f32 v54, v38
 v_add_f32 v37, v37, v15
 v_cvt_pk_bf16_f32 v64, v52, v53
 v_mfma_f32_32x32x16_bf16 a[192:207], v[92:95], v[72:75], a[192:207]
 v_cos_f32 v55, v39
 v_add_f32 v38, v38, v15
 s_waitcnt lgkmcnt(5)
 v_mfma_f32_32x32x16_bf16 a[80:95], v[96:99], v[68:71], a[80:95]
 ds_read_b128 v[88:91], v12 offset:45056
 v_cos_f32 v56, v40
 v_add_f32 v39, v39, v15
 v_cvt_pk_bf16_f32 v65, v54, v55
 v_mfma_f32_32x32x16_bf16 a[208:223], v[96:99], v[72:75], a[208:223]
 v_cos_f32 v57, v41
 v_add_f32 v40, v40, v15
 s_waitcnt lgkmcnt(5)
 s_add_u32 m0, s76, 4096
 v_mfma_f32_32x32x16_bf16 a[96:111], v[100:103], v[68:71], a[96:111]
 ds_read_b128 v[92:95], v12 offset:49152
 v_cos_f32 v58, v42
 v_add_f32 v41, v41, v15
 v_cvt_pk_bf16_f32 v66, v56, v57
 v_mfma_f32_32x32x16_bf16 a[224:239], v[100:103], v[72:75], a[224:239]
 buffer_load_dwordx4 v8, s[8:11], s82 offen  lds
 v_cos_f32 v59, v43
 v_add_f32 v42, v42, v15
 s_waitcnt lgkmcnt(5)
 v_mfma_f32_32x32x16_bf16 a[112:127], v[104:107], v[68:71], a[112:127]
 ds_read_b128 v[96:99], v12 offset:53248
 v_add_f32 v43, v43, v15
 v_cvt_pk_bf16_f32 v67, v58, v59
 v_mfma_f32_32x32x16_bf16 a[240:255], v[104:107], v[72:75], a[240:255]
 s_waitcnt lgkmcnt(5)
 v_mfma_f32_32x32x16_bf16 a[0:15], v[76:79], v[60:63], a[0:15]
 ds_read_b128 v[100:103], v12 offset:57344
 v_cos_f32 v44, v28
 v_mfma_f32_32x32x16_bf16 a[128:143], v[76:79], v[64:67], a[128:143]
 v_cos_f32 v45, v29
 v_add_f32 v28, v28, v14
 s_waitcnt lgkmcnt(5)
 s_add_u32 m0, s76, 5120
 v_mfma_f32_32x32x16_bf16 a[16:31], v[80:83], v[60:63], a[16:31]
 ds_read_b128 v[104:107], v12 offset:61440
 v_xor_b32 v12, 0x10000, v12
 v_cos_f32 v46, v30
 v_add_f32 v29, v29, v14
 v_cvt_pk_bf16_f32 v68, v44, v45
 v_mfma_f32_32x32x16_bf16 a[144:159], v[80:83], v[64:67], a[144:159]
 buffer_load_dwordx4 v9, s[8:11], s83 offen  lds
 v_cos_f32 v47, v31
 v_add_f32 v30, v30, v14
 s_waitcnt lgkmcnt(5)
 v_mfma_f32_32x32x16_bf16 a[32:47], v[84:87], v[60:63], a[32:47]
 ds_read_b128 v[76:79], v13 offset:32768
 v_cos_f32 v48, v32
 v_add_f32 v31, v31, v14
 v_cvt_pk_bf16_f32 v69, v46, v47
 v_mfma_f32_32x32x16_bf16 a[160:175], v[84:87], v[64:67], a[160:175]
 v_cos_f32 v49, v33
 v_add_f32 v32, v32, v14
 s_waitcnt lgkmcnt(5)
 v_mfma_f32_32x32x16_bf16 a[48:63], v[88:91], v[60:63], a[48:63]
 ds_read_b128 v[80:83], v13 offset:36864
 v_cos_f32 v50, v34
 v_add_f32 v33, v33, v14
 v_cvt_pk_bf16_f32 v70, v48, v49
 v_cos_f32 v52, v36
 v_mfma_f32_32x32x16_bf16 a[176:191], v[88:91], v[64:67], a[176:191]
 v_cos_f32 v51, v35
 v_add_f32 v34, v34, v14
 v_cos_f32 v53, v37
 v_add_f32 v36, v36, v15
 s_waitcnt lgkmcnt(5)
 s_add_u32 m0, s76, 6144
 v_mfma_f32_32x32x16_bf16 a[64:79], v[92:95], v[60:63], a[64:79]
 ds_read_b128 v[84:87], v13 offset:40960
 v_add_f32 v35, v35, v14
 v_cvt_pk_bf16_f32 v71, v50, v51
 v_cos_f32 v54, v38
 v_add_f32 v37, v37, v15
 v_cvt_pk_bf16_f32 v72, v52, v53
 v_mfma_f32_32x32x16_bf16 a[192:207], v[92:95], v[64:67], a[192:207]
 buffer_load_dwordx4 v8, s[8:11], s84 offen  lds
 v_cos_f32 v55, v39
 v_add_f32 v38, v38, v15
 s_waitcnt lgkmcnt(5)
 v_mfma_f32_32x32x16_bf16 a[80:95], v[96:99], v[60:63], a[80:95]
 ds_read_b128 v[88:91], v13 offset:45056
 v_cos_f32 v56, v40
 v_add_f32 v39, v39, v15
 v_cvt_pk_bf16_f32 v73, v54, v55
 v_mfma_f32_32x32x16_bf16 a[208:223], v[96:99], v[64:67], a[208:223]
 v_cos_f32 v57, v41
 v_add_f32 v40, v40, v15
 s_waitcnt lgkmcnt(5)
 v_mfma_f32_32x32x16_bf16 a[96:111], v[100:103], v[60:63], a[96:111]
 ds_read_b128 v[92:95], v13 offset:49152
 v_cos_f32 v58, v42
 v_add_f32 v41, v41, v15
 v_cvt_pk_bf16_f32 v74, v56, v57
 v_mfma_f32_32x32x16_bf16 a[224:239], v[100:103], v[64:67], a[224:239]
 v_cos_f32 v59, v43
 v_add_f32 v42, v42, v15
 s_waitcnt lgkmcnt(5)
 s_add_u32 m0, s76, 7168
 v_mfma_f32_32x32x16_bf16 a[112:127], v[104:107], v[60:63], a[112:127]
 ds_read_b128 v[96:99], v13 offset:53248
 v_add_f32 v43, v43, v15
 v_cvt_pk_bf16_f32 v75, v58, v59
 v_mfma_f32_32x32x16_bf16 a[240:255], v[104:107], v[64:67], a[240:255]
 buffer_load_dwordx4 v9, s[8:11], s85 offen  lds
 s_waitcnt lgkmcnt(5)
 v_mfma_f32_32x32x16_bf16 a[0:15], v[76:79], v[68:71], a[0:15]
 ds_read_b128 v[100:103], v13 offset:57344
 v_cos_f32 v44, v28
 v_mfma_f32_32x32x16_bf16 a[128:143], v[76:79], v[72:75], a[128:143]
 v_cos_f32 v45, v29
 v_add_f32 v28, v28, v14
 v_add_u32 v8, 128, v8
 v_add_u32 v9, 128, v9
 s_add_u32 s76, s76, 32768
 s_and_b32 s76, s76, 0x1ffff
 s_waitcnt lgkmcnt(5)
 v_mfma_f32_32x32x16_bf16 a[16:31], v[80:83], v[68:71], a[16:31]
 ds_read_b128 v[104:107], v13 offset:61440
 v_xor_b32 v13, 0x10000, v13
 v_cos_f32 v46, v30
 v_add_f32 v29, v29, v14
 v_cvt_pk_bf16_f32 v60, v44, v45
 v_mfma_f32_32x32x16_bf16 a[144:159], v[80:83], v[72:75], a[144:159]
 v_cos_f32 v47, v31
 v_add_f32 v30, v30, v14
 s_waitcnt vmcnt(8)
 s_barrier
 s_waitcnt lgkmcnt(5)
 v_mfma_f32_32x32x16_bf16 a[32:47], v[84:87], v[68:71], a[32:47]
 ds_read_b128 v[76:79], v10 offset:0
 v_cos_f32 v48, v32
 v_add_f32 v31, v31, v14
 v_cvt_pk_bf16_f32 v61, v46, v47
 v_mfma_f32_32x32x16_bf16 a[160:175], v[84:87], v[72:75], a[160:175]
 v_cos_f32 v49, v33
 v_add_f32 v32, v32, v14
 s_waitcnt lgkmcnt(5)
 v_mfma_f32_32x32x16_bf16 a[48:63], v[88:91], v[68:71], a[48:63]
 ds_read_b128 v[80:83], v10 offset:4096
 v_cos_f32 v50, v34
 v_add_f32 v33, v33, v14
 v_cvt_pk_bf16_f32 v62, v48, v49
 v_cos_f32 v52, v36
 v_mfma_f32_32x32x16_bf16 a[176:191], v[88:91], v[72:75], a[176:191]
 v_cos_f32 v51, v35
 v_add_f32 v34, v34, v14
 v_cos_f32 v53, v37
 v_add_f32 v36, v36, v15
 s_waitcnt lgkmcnt(5)
 v_mfma_f32_32x32x16_bf16 a[64:79], v[92:95], v[68:71], a[64:79]
 ds_read_b128 v[84:87], v10 offset:8192
 v_add_f32 v35, v35, v14
 v_cvt_pk_bf16_f32 v63, v50, v51
 v_cos_f32 v54, v38
 v_add_f32 v37, v37, v15
 v_cvt_pk_bf16_f32 v64, v52, v53
 v_mfma_f32_32x32x16_bf16 a[192:207], v[92:95], v[72:75], a[192:207]
 v_cos_f32 v55, v39
 v_add_f32 v38, v38, v15
 s_waitcnt lgkmcnt(5)
 v_mfma_f32_32x32x16_bf16 a[80:95], v[96:99], v[68:71], a[80:95]
 ds_read_b128 v[88:91], v10 offset:12288
 v_cos_f32 v56, v40
 v_add_f32 v39, v39, v15
 v_cvt_pk_bf16_f32 v65, v54, v55
 v_mfma_f32_32x32x16_bf16 a[208:223], v[96:99], v[72:75], a[208:223]
 v_cos_f32 v57, v41
 v_add_f32 v40, v40, v15
 s_waitcnt lgkmcnt(5)
 v_mfma_f32_32x32x16_bf16 a[96:111], v[100:103], v[68:71], a[96:111]
 ds_read_b128 v[92:95], v10 offset:16384
 v_cos_f32 v58, v42
 v_add_f32 v41, v41, v15
 v_cvt_pk_bf16_f32 v66, v56, v57
 v_mfma_f32_32x32x16_bf16 a[224:239], v[100:103], v[72:75], a[224:239]
 v_cos_f32 v59, v43
 v_add_f32 v42, v42, v15
 s_waitcnt lgkmcnt(5)
 v_mfma_f32_32x32x16_bf16 a[112:127], v[104:107], v[68:71], a[112:127]
 ds_read_b128 v[96:99], v10 offset:20480
 v_add_f32 v43, v43, v15
 v_cvt_pk_bf16_f32 v67, v58, v59
 v_mfma_f32_32x32x16_bf16 a[240:255], v[104:107], v[72:75], a[240:255]
 s_sub_u32 s75, s75, 1
 s_cmp_lg_u32 s75, 0
 s_cbranch_scc1 L_f_loop_123
 s_waitcnt vmcnt(0) lgkmcnt(0)
 s_barrier
 s_nop 11
 v_and_b32 v1, 7, v0
 v_lshlrev_b32 v2, 1, v6
 v_xor_b32 v1, v1, v2
 v_lshlrev_b32 v1, 4, v1
 v_lshl_add_u32 v1, v5, 9, v1
 s_lshl_b32 s66, s62, 15
 v_add_u32 v28, s66, v1
 v_xor_b32 v29, 16, v28
 v_xor_b32 v30, 64, v28
 v_xor_b32 v31, 80, v28
 v_accvgpr_read_b32 v108, a0
 v_accvgpr_read_b32 v124, a64
 v_accvgpr_read_b32 v109, a1
 v_accvgpr_read_b32 v125, a65
 v_accvgpr_read_b32 v110, a2
 v_accvgpr_read_b32 v126, a66
 v_accvgpr_read_b32 v111, a3
 v_accvgpr_read_b32 v127, a67
 v_accvgpr_read_b32 v112, a4
 v_accvgpr_read_b32 v128, a68
 v_accvgpr_read_b32 v113, a5
 v_accvgpr_read_b32 v129, a69
 v_accvgpr_read_b32 v114, a6
 v_accvgpr_read_b32 v130, a70
 v_accvgpr_read_b32 v115, a7
 v_accvgpr_read_b32 v131, a71
 v_accvgpr_read_b32 v116, a8
 v_accvgpr_read_b32 v132, a72
 v_accvgpr_read_b32 v117, a9
 v_accvgpr_read_b32 v133, a73
 v_accvgpr_read_b32 v118, a10
 v_accvgpr_read_b32 v134, a74
 v_accvgpr_read_b32 v119, a11
 v_accvgpr_read_b32 v135, a75
 v_accvgpr_read_b32 v120, a12
 v_accvgpr_read_b32 v136, a76
 v_accvgpr_read_b32 v121, a13
 v_accvgpr_read_b32 v137, a77
 v_accvgpr_read_b32 v122, a14
 v_accvgpr_read_b32 v138, a78
 v_accvgpr_read_b32 v123, a15
 v_accvgpr_read_b32 v139, a79
 v_pk_add_f32 v[140:141], v[108:109], v[124:125]
 v_pk_add_f32 v[124:125], v[108:109], v[124:125] neg_lo:[0,1] neg_hi:[0,1]
 v_pk_add_f32 v[142:143], v[110:111], v[126:127]
 v_pk_add_f32 v[126:127], v[110:111], v[126:127] neg_lo:[0,1] neg_hi:[0,1]
 v_pk_add_f32 v[144:145], v[112:113], v[128:129]
 v_pk_add_f32 v[128:129], v[112:113], v[128:129] neg_lo:[0,1] neg_hi:[0,1]
 v_pk_add_f32 v[146:147], v[114:115], v[130:131]
 v_pk_add_f32 v[130:131], v[114:115], v[130:131] neg_lo:[0,1] neg_hi:[0,1]
 v_pk_add_f32 v[148:149], v[116:117], v[132:133]
 v_pk_add_f32 v[132:133], v[116:117], v[132:133] neg_lo:[0,1] neg_hi:[0,1]
 v_pk_add_f32 v[150:151], v[118:119], v[134:135]
 v_pk_add_f32 v[134:135], v[118:119], v[134:135] neg_lo:[0,1] neg_hi:[0,1]
 v_pk_add_f32 v[152:153], v[120:121], v[136:137]
 v_pk_add_f32 v[136:137], v[120:121], v[136:137] neg_lo:[0,1] neg_hi:[0,1]
 v_pk_add_f32 v[154:155], v[122:123], v[138:139]
 v_pk_add_f32 v[138:139], v[122:123], v[138:139] neg_lo:[0,1] neg_hi:[0,1]
 v_cvt_pk_bf16_f32 v140, v140, v141
 v_cvt_pk_bf16_f32 v141, v142, v143
 v_cvt_pk_bf16_f32 v142, v144, v145
 v_cvt_pk_bf16_f32 v143, v146, v147
 v_cvt_pk_bf16_f32 v144, v148, v149
 v_cvt_pk_bf16_f32 v145, v150, v151
 v_cvt_pk_bf16_f32 v146, v152, v153
 v_cvt_pk_bf16_f32 v147, v154, v155
 ds_write_b128 v28, v[140:143] offset:0
 ds_write_b128 v29, v[144:147] offset:0
 v_cvt_pk_bf16_f32 v124, v124, v125
 v_cvt_pk_bf16_f32 v125, v126, v127
 v_cvt_pk_bf16_f32 v126, v128, v129
 v_cvt_pk_bf16_f32 v127, v130, v131
 v_cvt_pk_bf16_f32 v128, v132, v133
 v_cvt_pk_bf16_f32 v129, v134, v135
 v_cvt_pk_bf16_f32 v130, v136, v137
 v_cvt_pk_bf16_f32 v131, v138, v139
 ds_write_b128 v28, v[124:127] offset:256
 ds_write_b128 v29, v[128:131] offset:256
 v_accvgpr_read_b32 v156, a16
 v_accvgpr_read_b32 v172, a80
 v_accvgpr_read_b32 v157, a17
 v_accvgpr_read_b32 v173, a81
 v_accvgpr_read_b32 v158, a18
 v_accvgpr_read_b32 v174, a82
 v_accvgpr_read_b32 v159, a19
 v_accvgpr_read_b32 v175, a83
 v_accvgpr_read_b32 v160, a20
 v_accvgpr_read_b32 v176, a84
 v_accvgpr_read_b32 v161, a21
 v_accvgpr_read_b32 v177, a85
 v_accvgpr_read_b32 v162, a22
 v_accvgpr_read_b32 v178, a86
 v_accvgpr_read_b32 v163, a23
 v_accvgpr_read_b32 v179, a87
 v_accvgpr_read_b32 v164, a24
 v_accvgpr_read_b32 v180, a88
 v_accvgpr_read_b32 v165, a25
 v_accvgpr_read_b32 v181, a89
 v_accvgpr_read_b32 v166, a26
 v_accvgpr_read_b32 v182, a90
 v_accvgpr_read_b32 v167, a27
 v_accvgpr_read_b32 v183, a91
 v_accvgpr_read_b32 v168, a28
 v_accvgpr_read_b32 v184, a92
 v_accvgpr_read_b32 v169, a29
 v_accvgpr_read_b32 v185, a93
 v_accvgpr_read_b32 v170, a30
 v_accvgpr_read_b32 v186, a94
 v_accvgpr_read_b32 v171, a31
 v_accvgpr_read_b32 v187, a95
 v_pk_add_f32 v[188:189], v[156:157], v[172:173]
 v_pk_add_f32 v[172:173], v[156:157], v[172:173] neg_lo:[0,1] neg_hi:[0,1]
 v_pk_add_f32 v[190:191], v[158:159], v[174:175]
 v_pk_add_f32 v[174:175], v[158:159], v[174:175] neg_lo:[0,1] neg_hi:[0,1]
 v_pk_add_f32 v[192:193], v[160:161], v[176:177]
 v_pk_add_f32 v[176:177], v[160:161], v[176:177] neg_lo:[0,1] neg_hi:[0,1]
 v_pk_add_f32 v[194:195], v[162:163], v[178:179]
 v_pk_add_f32 v[178:179], v[162:163], v[178:179] neg_lo:[0,1] neg_hi:[0,1]
 v_pk_add_f32 v[196:197], v[164:165], v[180:181]
 v_pk_add_f32 v[180:181], v[164:165], v[180:181] neg_lo:[0,1] neg_hi:[0,1]
 v_pk_add_f32 v[198:199], v[166:167], v[182:183]
 v_pk_add_f32 v[182:183], v[166:167], v[182:183] neg_lo:[0,1] neg_hi:[0,1]
 v_pk_add_f32 v[200:201], v[168:169], v[184:185]
 v_pk_add_f32 v[184:185], v[168:169], v[184:185] neg_lo:[0,1] neg_hi:[0,1]
 v_pk_add_f32 v[202:203], v[170:171], v[186:187]
 v_pk_add_f32 v[186:187], v[170:171], v[186:187] neg_lo:[0,1] neg_hi:[0,1]
 v_cvt_pk_bf16_f32 v188, v188, v189
 v_cvt_pk_bf16_f32 v189, v190, v191
 v_cvt_pk_bf16_f32 v190, v192, v193
 v_cvt_pk_bf16_f32 v191, v194, v195
 v_cvt_pk_bf16_f32 v192, v196, v197
 v_cvt_pk_bf16_f32 v193, v198, v199
 v_cvt_pk_bf16_f32 v194, v200, v201
 v_cvt_pk_bf16_f32 v195, v202, v203
 ds_write_b128 v30, v[188:191] offset:0
 ds_write_b128 v31, v[192:195] offset:0
 v_cvt_pk_bf16_f32 v172, v172, v173
 v_cvt_pk_bf16_f32 v173, v174, v175
 v_cvt_pk_bf16_f32 v174, v176, v177
 v_cvt_pk_bf16_f32 v175, v178, v179
 v_cvt_pk_bf16_f32 v176, v180, v181
 v_cvt_pk_bf16_f32 v177, v182, v183
 v_cvt_pk_bf16_f32 v178, v184, v185
 v_cvt_pk_bf16_f32 v179, v186, v187
 ds_write_b128 v30, v[172:175] offset:256
 ds_write_b128 v31, v[176:179] offset:256
 v_accvgpr_read_b32 v108, a32
 v_accvgpr_read_b32 v124, a96
 v_accvgpr_read_b32 v109, a33
 v_accvgpr_read_b32 v125, a97
 v_accvgpr_read_b32 v110, a34
 v_accvgpr_read_b32 v126, a98
 v_accvgpr_read_b32 v111, a35
 v_accvgpr_read_b32 v127, a99
 v_accvgpr_read_b32 v112, a36
 v_accvgpr_read_b32 v128, a100
 v_accvgpr_read_b32 v113, a37
 v_accvgpr_read_b32 v129, a101
 v_accvgpr_read_b32 v114, a38
 v_accvgpr_read_b32 v130, a102
 v_accvgpr_read_b32 v115, a39
 v_accvgpr_read_b32 v131, a103
 v_accvgpr_read_b32 v116, a40
 v_accvgpr_read_b32 v132, a104
 v_accvgpr_read_b32 v117, a41
 v_accvgpr_read_b32 v133, a105
 v_accvgpr_read_b32 v118, a42
 v_accvgpr_read_b32 v134, a106
 v_accvgpr_read_b32 v119, a43
 v_accvgpr_read_b32 v135, a107
 v_accvgpr_read_b32 v120, a44
 v_accvgpr_read_b32 v136, a108
 v_accvgpr_read_b32 v121, a45
 v_accvgpr_read_b32 v137, a109
 v_accvgpr_read_b32 v122, a46
 v_accvgpr_read_b32 v138, a110
 v_accvgpr_read_b32 v123, a47
 v_accvgpr_read_b32 v139, a111
 v_pk_add_f32 v[140:141], v[108:109], v[124:125]
 v_pk_add_f32 v[124:125], v[108:109], v[124:125] neg_lo:[0,1] neg_hi:[0,1]
 v_pk_add_f32 v[142:143], v[110:111], v[126:127]
 v_pk_add_f32 v[126:127], v[110:111], v[126:127] neg_lo:[0,1] neg_hi:[0,1]
 v_pk_add_f32 v[144:145], v[112:113], v[128:129]
 v_pk_add_f32 v[128:129], v[112:113], v[128:129] neg_lo:[0,1] neg_hi:[0,1]
 v_pk_add_f32 v[146:147], v[114:115], v[130:131]
 v_pk_add_f32 v[130:131], v[114:115], v[130:131] neg_lo:[0,1] neg_hi:[0,1]
 v_pk_add_f32 v[148:149], v[116:117], v[132:133]
 v_pk_add_f32 v[132:133], v[116:117], v[132:133] neg_lo:[0,1] neg_hi:[0,1]
 v_pk_add_f32 v[150:151], v[118:119], v[134:135]
 v_pk_add_f32 v[134:135], v[118:119], v[134:135] neg_lo:[0,1] neg_hi:[0,1]
 v_pk_add_f32 v[152:153], v[120:121], v[136:137]
 v_pk_add_f32 v[136:137], v[120:121], v[136:137] neg_lo:[0,1] neg_hi:[0,1]
 v_pk_add_f32 v[154:155], v[122:123], v[138:139]
 v_pk_add_f32 v[138:139], v[122:123], v[138:139] neg_lo:[0,1] neg_hi:[0,1]
 v_cvt_pk_bf16_f32 v140, v140, v141
 v_cvt_pk_bf16_f32 v141, v142, v143
 v_cvt_pk_bf16_f32 v142, v144, v145
 v_cvt_pk_bf16_f32 v143, v146, v147
 v_cvt_pk_bf16_f32 v144, v148, v149
 v_cvt_pk_bf16_f32 v145, v150, v151
 v_cvt_pk_bf16_f32 v146, v152, v153
 v_cvt_pk_bf16_f32 v147, v154, v155
 ds_write_b128 v28, v[140:143] offset:128
 ds_write_b128 v29, v[144:147] offset:128
 v_cvt_pk_bf16_f32 v124, v124, v125
 v_cvt_pk_bf16_f32 v125, v126, v127
 v_cvt_pk_bf16_f32 v126, v128, v129
 v_cvt_pk_bf16_f32 v127, v130, v131
 v_cvt_pk_bf16_f32 v128, v132, v133
 v_cvt_pk_bf16_f32 v129, v134, v135
 v_cvt_pk_bf16_f32 v130, v136, v137
 v_cvt_pk_bf16_f32 v131, v138, v139
 ds_write_b128 v28, v[124:127] offset:384
 ds_write_b128 v29, v[128:131] offset:384
 v_accvgpr_read_b32 v156, a48
 v_accvgpr_read_b32 v172, a112
 v_accvgpr_read_b32 v157, a49
 v_accvgpr_read_b32 v173, a113
 v_accvgpr_read_b32 v158, a50
 v_accvgpr_read_b32 v174, a114
 v_accvgpr_read_b32 v159, a51
 v_accvgpr_read_b32 v175, a115
 v_accvgpr_read_b32 v160, a52
 v_accvgpr_read_b32 v176, a116
 v_accvgpr_read_b32 v161, a53
 v_accvgpr_read_b32 v177, a117
 v_accvgpr_read_b32 v162, a54
 v_accvgpr_read_b32 v178, a118
 v_accvgpr_read_b32 v163, a55
 v_accvgpr_read_b32 v179, a119
 v_accvgpr_read_b32 v164, a56
 v_accvgpr_read_b32 v180, a120
 v_accvgpr_read_b32 v165, a57
 v_accvgpr_read_b32 v181, a121
 v_accvgpr_read_b32 v166, a58
 v_accvgpr_read_b32 v182, a122
 v_accvgpr_read_b32 v167, a59
 v_accvgpr_read_b32 v183, a123
 v_accvgpr_read_b32 v168, a60
 v_accvgpr_read_b32 v184, a124
 v_accvgpr_read_b32 v169, a61
 v_accvgpr_read_b32 v185, a125
 v_accvgpr_read_b32 v170, a62
 v_accvgpr_read_b32 v186, a126
 v_accvgpr_read_b32 v171, a63
 v_accvgpr_read_b32 v187, a127
 v_pk_add_f32 v[188:189], v[156:157], v[172:173]
 v_pk_add_f32 v[172:173], v[156:157], v[172:173] neg_lo:[0,1] neg_hi:[0,1]
 v_pk_add_f32 v[190:191], v[158:159], v[174:175]
 v_pk_add_f32 v[174:175], v[158:159], v[174:175] neg_lo:[0,1] neg_hi:[0,1]
 v_pk_add_f32 v[192:193], v[160:161], v[176:177]
 v_pk_add_f32 v[176:177], v[160:161], v[176:177] neg_lo:[0,1] neg_hi:[0,1]
 v_pk_add_f32 v[194:195], v[162:163], v[178:179]
 v_pk_add_f32 v[178:179], v[162:163], v[178:179] neg_lo:[0,1] neg_hi:[0,1]
 v_pk_add_f32 v[196:197], v[164:165], v[180:181]
 v_pk_add_f32 v[180:181], v[164:165], v[180:181] neg_lo:[0,1] neg_hi:[0,1]
 v_pk_add_f32 v[198:199], v[166:167], v[182:183]
 v_pk_add_f32 v[182:183], v[166:167], v[182:183] neg_lo:[0,1] neg_hi:[0,1]
 v_pk_add_f32 v[200:201], v[168:169], v[184:185]
 v_pk_add_f32 v[184:185], v[168:169], v[184:185] neg_lo:[0,1] neg_hi:[0,1]
 v_pk_add_f32 v[202:203], v[170:171], v[186:187]
 v_pk_add_f32 v[186:187], v[170:171], v[186:187] neg_lo:[0,1] neg_hi:[0,1]
 v_cvt_pk_bf16_f32 v188, v188, v189
 v_cvt_pk_bf16_f32 v189, v190, v191
 v_cvt_pk_bf16_f32 v190, v192, v193
 v_cvt_pk_bf16_f32 v191, v194, v195
 v_cvt_pk_bf16_f32 v192, v196, v197
 v_cvt_pk_bf16_f32 v193, v198, v199
 v_cvt_pk_bf16_f32 v194, v200, v201
 v_cvt_pk_bf16_f32 v195, v202, v203
 ds_write_b128 v30, v[188:191] offset:128
 ds_write_b128 v31, v[192:195] offset:128
 v_cvt_pk_bf16_f32 v172, v172, v173
 v_cvt_pk_bf16_f32 v173, v174, v175
 v_cvt_pk_bf16_f32 v174, v176, v177
 v_cvt_pk_bf16_f32 v175, v178, v179
 v_cvt_pk_bf16_f32 v176, v180, v181
 v_cvt_pk_bf16_f32 v177, v182, v183
 v_cvt_pk_bf16_f32 v178, v184, v185
 v_cvt_pk_bf16_f32 v179, v186, v187
 ds_write_b128 v30, v[172:175] offset:384
 ds_write_b128 v31, v[176:179] offset:384
 v_accvgpr_read_b32 v108, a128
 v_accvgpr_read_b32 v124, a192
 v_accvgpr_read_b32 v109, a129
 v_accvgpr_read_b32 v125, a193
 v_accvgpr_read_b32 v110, a130
 v_accvgpr_read_b32 v126, a194
 v_accvgpr_read_b32 v111, a131
 v_accvgpr_read_b32 v127, a195
 v_accvgpr_read_b32 v112, a132
 v_accvgpr_read_b32 v128, a196
 v_accvgpr_read_b32 v113, a133
 v_accvgpr_read_b32 v129, a197
 v_accvgpr_read_b32 v114, a134
 v_accvgpr_read_b32 v130, a198
 v_accvgpr_read_b32 v115, a135
 v_accvgpr_read_b32 v131, a199
 v_accvgpr_read_b32 v116, a136
 v_accvgpr_read_b32 v132, a200
 v_accvgpr_read_b32 v117, a137
 v_accvgpr_read_b32 v133, a201
 v_accvgpr_read_b32 v118, a138
 v_accvgpr_read_b32 v134, a202
 v_accvgpr_read_b32 v119, a139
 v_accvgpr_read_b32 v135, a203
 v_accvgpr_read_b32 v120, a140
 v_accvgpr_read_b32 v136, a204
 v_accvgpr_read_b32 v121, a141
 v_accvgpr_read_b32 v137, a205
 v_accvgpr_read_b32 v122, a142
 v_accvgpr_read_b32 v138, a206
 v_accvgpr_read_b32 v123, a143
 v_accvgpr_read_b32 v139, a207
 v_pk_add_f32 v[140:141], v[108:109], v[124:125]
 v_pk_add_f32 v[124:125], v[108:109], v[124:125] neg_lo:[0,1] neg_hi:[0,1]
 v_pk_add_f32 v[142:143], v[110:111], v[126:127]
 v_pk_add_f32 v[126:127], v[110:111], v[126:127] neg_lo:[0,1] neg_hi:[0,1]
 v_pk_add_f32 v[144:145], v[112:113], v[128:129]
 v_pk_add_f32 v[128:129], v[112:113], v[128:129] neg_lo:[0,1] neg_hi:[0,1]
 v_pk_add_f32 v[146:147], v[114:115], v[130:131]
 v_pk_add_f32 v[130:131], v[114:115], v[130:131] neg_lo:[0,1] neg_hi:[0,1]
 v_pk_add_f32 v[148:149], v[116:117], v[132:133]
 v_pk_add_f32 v[132:133], v[116:117], v[132:133] neg_lo:[0,1] neg_hi:[0,1]
 v_pk_add_f32 v[150:151], v[118:119], v[134:135]
 v_pk_add_f32 v[134:135], v[118:119], v[134:135] neg_lo:[0,1] neg_hi:[0,1]
 v_pk_add_f32 v[152:153], v[120:121], v[136:137]
 v_pk_add_f32 v[136:137], v[120:121], v[136:137] neg_lo:[0,1] neg_hi:[0,1]
 v_pk_add_f32 v[154:155], v[122:123], v[138:139]
 v_pk_add_f32 v[138:139], v[122:123], v[138:139] neg_lo:[0,1] neg_hi:[0,1]
 v_cvt_pk_bf16_f32 v140, v140, v141
 v_cvt_pk_bf16_f32 v141, v142, v143
 v_cvt_pk_bf16_f32 v142, v144, v145
 v_cvt_pk_bf16_f32 v143, v146, v147
 v_cvt_pk_bf16_f32 v144, v148, v149
 v_cvt_pk_bf16_f32 v145, v150, v151
 v_cvt_pk_bf16_f32 v146, v152, v153
 v_cvt_pk_bf16_f32 v147, v154, v155
 ds_write_b128 v28, v[140:143] offset:16384
 ds_write_b128 v29, v[144:147] offset:16384
 v_cvt_pk_bf16_f32 v124, v124, v125
 v_cvt_pk_bf16_f32 v125, v126, v127
 v_cvt_pk_bf16_f32 v126, v128, v129
 v_cvt_pk_bf16_f32 v127, v130, v131
 v_cvt_pk_bf16_f32 v128, v132, v133
 v_cvt_pk_bf16_f32 v129, v134, v135
 v_cvt_pk_bf16_f32 v130, v136, v137
 v_cvt_pk_bf16_f32 v131, v138, v139
 ds_write_b128 v28, v[124:127] offset:16640
 ds_write_b128 v29, v[128:131] offset:16640
 v_accvgpr_read_b32 v156, a144
 v_accvgpr_read_b32 v172, a208
 v_accvgpr_read_b32 v157, a145
 v_accvgpr_read_b32 v173, a209
 v_accvgpr_read_b32 v158, a146
 v_accvgpr_read_b32 v174, a210
 v_accvgpr_read_b32 v159, a147
 v_accvgpr_read_b32 v175, a211
 v_accvgpr_read_b32 v160, a148
 v_accvgpr_read_b32 v176, a212
 v_accvgpr_read_b32 v161, a149
 v_accvgpr_read_b32 v177, a213
 v_accvgpr_read_b32 v162, a150
 v_accvgpr_read_b32 v178, a214
 v_accvgpr_read_b32 v163, a151
 v_accvgpr_read_b32 v179, a215
 v_accvgpr_read_b32 v164, a152
 v_accvgpr_read_b32 v180, a216
 v_accvgpr_read_b32 v165, a153
 v_accvgpr_read_b32 v181, a217
 v_accvgpr_read_b32 v166, a154
 v_accvgpr_read_b32 v182, a218
 v_accvgpr_read_b32 v167, a155
 v_accvgpr_read_b32 v183, a219
 v_accvgpr_read_b32 v168, a156
 v_accvgpr_read_b32 v184, a220
 v_accvgpr_read_b32 v169, a157
 v_accvgpr_read_b32 v185, a221
 v_accvgpr_read_b32 v170, a158
 v_accvgpr_read_b32 v186, a222
 v_accvgpr_read_b32 v171, a159
 v_accvgpr_read_b32 v187, a223
 v_pk_add_f32 v[188:189], v[156:157], v[172:173]
 v_pk_add_f32 v[172:173], v[156:157], v[172:173] neg_lo:[0,1] neg_hi:[0,1]
 v_pk_add_f32 v[190:191], v[158:159], v[174:175]
 v_pk_add_f32 v[174:175], v[158:159], v[174:175] neg_lo:[0,1] neg_hi:[0,1]
 v_pk_add_f32 v[192:193], v[160:161], v[176:177]
 v_pk_add_f32 v[176:177], v[160:161], v[176:177] neg_lo:[0,1] neg_hi:[0,1]
 v_pk_add_f32 v[194:195], v[162:163], v[178:179]
 v_pk_add_f32 v[178:179], v[162:163], v[178:179] neg_lo:[0,1] neg_hi:[0,1]
 v_pk_add_f32 v[196:197], v[164:165], v[180:181]
 v_pk_add_f32 v[180:181], v[164:165], v[180:181] neg_lo:[0,1] neg_hi:[0,1]
 v_pk_add_f32 v[198:199], v[166:167], v[182:183]
 v_pk_add_f32 v[182:183], v[166:167], v[182:183] neg_lo:[0,1] neg_hi:[0,1]
 v_pk_add_f32 v[200:201], v[168:169], v[184:185]
 v_pk_add_f32 v[184:185], v[168:169], v[184:185] neg_lo:[0,1] neg_hi:[0,1]
 v_pk_add_f32 v[202:203], v[170:171], v[186:187]
 v_pk_add_f32 v[186:187], v[170:171], v[186:187] neg_lo:[0,1] neg_hi:[0,1]
 v_cvt_pk_bf16_f32 v188, v188, v189
 v_cvt_pk_bf16_f32 v189, v190, v191
 v_cvt_pk_bf16_f32 v190, v192, v193
 v_cvt_pk_bf16_f32 v191, v194, v195
 v_cvt_pk_bf16_f32 v192, v196, v197
 v_cvt_pk_bf16_f32 v193, v198, v199
 v_cvt_pk_bf16_f32 v194, v200, v201
 v_cvt_pk_bf16_f32 v195, v202, v203
 ds_write_b128 v30, v[188:191] offset:16384
 ds_write_b128 v31, v[192:195] offset:16384
 v_cvt_pk_bf16_f32 v172, v172, v173
 v_cvt_pk_bf16_f32 v173, v174, v175
 v_cvt_pk_bf16_f32 v174, v176, v177
 v_cvt_pk_bf16_f32 v175, v178, v179
 v_cvt_pk_bf16_f32 v176, v180, v181
 v_cvt_pk_bf16_f32 v177, v182, v183
 v_cvt_pk_bf16_f32 v178, v184, v185
 v_cvt_pk_bf16_f32 v179, v186, v187
 ds_write_b128 v30, v[172:175] offset:16640
 ds_write_b128 v31, v[176:179] offset:16640
 v_accvgpr_read_b32 v108, a160
 v_accvgpr_read_b32 v124, a224
 v_accvgpr_read_b32 v109, a161
 v_accvgpr_read_b32 v125, a225
 v_accvgpr_read_b32 v110, a162
 v_accvgpr_read_b32 v126, a226
 v_accvgpr_read_b32 v111, a163
 v_accvgpr_read_b32 v127, a227
 v_accvgpr_read_b32 v112, a164
 v_accvgpr_read_b32 v128, a228
 v_accvgpr_read_b32 v113, a165
 v_accvgpr_read_b32 v129, a229
 v_accvgpr_read_b32 v114, a166
 v_accvgpr_read_b32 v130, a230
 v_accvgpr_read_b32 v115, a167
 v_accvgpr_read_b32 v131, a231
 v_accvgpr_read_b32 v116, a168
 v_accvgpr_read_b32 v132, a232
 v_accvgpr_read_b32 v117, a169
 v_accvgpr_read_b32 v133, a233
 v_accvgpr_read_b32 v118, a170
 v_accvgpr_read_b32 v134, a234
 v_accvgpr_read_b32 v119, a171
 v_accvgpr_read_b32 v135, a235
 v_accvgpr_read_b32 v120, a172
 v_accvgpr_read_b32 v136, a236
 v_accvgpr_read_b32 v121, a173
 v_accvgpr_read_b32 v137, a237
 v_accvgpr_read_b32 v122, a174
 v_accvgpr_read_b32 v138, a238
 v_accvgpr_read_b32 v123, a175
 v_accvgpr_read_b32 v139, a239
 v_pk_add_f32 v[140:141], v[108:109], v[124:125]
 v_pk_add_f32 v[124:125], v[108:109], v[124:125] neg_lo:[0,1] neg_hi:[0,1]
 v_pk_add_f32 v[142:143], v[110:111], v[126:127]
 v_pk_add_f32 v[126:127], v[110:111], v[126:127] neg_lo:[0,1] neg_hi:[0,1]
 v_pk_add_f32 v[144:145], v[112:113], v[128:129]
 v_pk_add_f32 v[128:129], v[112:113], v[128:129] neg_lo:[0,1] neg_hi:[0,1]
 v_pk_add_f32 v[146:147], v[114:115], v[130:131]
 v_pk_add_f32 v[130:131], v[114:115], v[130:131] neg_lo:[0,1] neg_hi:[0,1]
 v_pk_add_f32 v[148:149], v[116:117], v[132:133]
 v_pk_add_f32 v[132:133], v[116:117], v[132:133] neg_lo:[0,1] neg_hi:[0,1]
 v_pk_add_f32 v[150:151], v[118:119], v[134:135]
 v_pk_add_f32 v[134:135], v[118:119], v[134:135] neg_lo:[0,1] neg_hi:[0,1]
 v_pk_add_f32 v[152:153], v[120:121], v[136:137]
 v_pk_add_f32 v[136:137], v[120:121], v[136:137] neg_lo:[0,1] neg_hi:[0,1]
 v_pk_add_f32 v[154:155], v[122:123], v[138:139]
 v_pk_add_f32 v[138:139], v[122:123], v[138:139] neg_lo:[0,1] neg_hi:[0,1]
 v_cvt_pk_bf16_f32 v140, v140, v141
 v_cvt_pk_bf16_f32 v141, v142, v143
 v_cvt_pk_bf16_f32 v142, v144, v145
 v_cvt_pk_bf16_f32 v143, v146, v147
 v_cvt_pk_bf16_f32 v144, v148, v149
 v_cvt_pk_bf16_f32 v145, v150, v151
 v_cvt_pk_bf16_f32 v146, v152, v153
 v_cvt_pk_bf16_f32 v147, v154, v155
 ds_write_b128 v28, v[140:143] offset:16512
 ds_write_b128 v29, v[144:147] offset:16512
 v_cvt_pk_bf16_f32 v124, v124, v125
 v_cvt_pk_bf16_f32 v125, v126, v127
 v_cvt_pk_bf16_f32 v126, v128, v129
 v_cvt_pk_bf16_f32 v127, v130, v131
 v_cvt_pk_bf16_f32 v128, v132, v133
 v_cvt_pk_bf16_f32 v129, v134, v135
 v_cvt_pk_bf16_f32 v130, v136, v137
 v_cvt_pk_bf16_f32 v131, v138, v139
 ds_write_b128 v28, v[124:127] offset:16768
 ds_write_b128 v29, v[128:131] offset:16768
 v_accvgpr_read_b32 v156, a176
 v_accvgpr_read_b32 v172, a240
 v_accvgpr_read_b32 v157, a177
 v_accvgpr_read_b32 v173, a241
 v_accvgpr_read_b32 v158, a178
 v_accvgpr_read_b32 v174, a242
 v_accvgpr_read_b32 v159, a179
 v_accvgpr_read_b32 v175, a243
 v_accvgpr_read_b32 v160, a180
 v_accvgpr_read_b32 v176, a244
 v_accvgpr_read_b32 v161, a181
 v_accvgpr_read_b32 v177, a245
 v_accvgpr_read_b32 v162, a182
 v_accvgpr_read_b32 v178, a246
 v_accvgpr_read_b32 v163, a183
 v_accvgpr_read_b32 v179, a247
 v_accvgpr_read_b32 v164, a184
 v_accvgpr_read_b32 v180, a248
 v_accvgpr_read_b32 v165, a185
 v_accvgpr_read_b32 v181, a249
 v_accvgpr_read_b32 v166, a186
 v_accvgpr_read_b32 v182, a250
 v_accvgpr_read_b32 v167, a187
 v_accvgpr_read_b32 v183, a251
 v_accvgpr_read_b32 v168, a188
 v_accvgpr_read_b32 v184, a252
 v_accvgpr_read_b32 v169, a189
 v_accvgpr_read_b32 v185, a253
 v_accvgpr_read_b32 v170, a190
 v_accvgpr_read_b32 v186, a254
 v_accvgpr_read_b32 v171, a191
 v_accvgpr_read_b32 v187, a255
 v_pk_add_f32 v[188:189], v[156:157], v[172:173]
 v_pk_add_f32 v[172:173], v[156:157], v[172:173] neg_lo:[0,1] neg_hi:[0,1]
 v_pk_add_f32 v[190:191], v[158:159], v[174:175]
 v_pk_add_f32 v[174:175], v[158:159], v[174:175] neg_lo:[0,1] neg_hi:[0,1]
 v_pk_add_f32 v[192:193], v[160:161], v[176:177]
 v_pk_add_f32 v[176:177], v[160:161], v[176:177] neg_lo:[0,1] neg_hi:[0,1]
 v_pk_add_f32 v[194:195], v[162:163], v[178:179]
 v_pk_add_f32 v[178:179], v[162:163], v[178:179] neg_lo:[0,1] neg_hi:[0,1]
 v_pk_add_f32 v[196:197], v[164:165], v[180:181]
 v_pk_add_f32 v[180:181], v[164:165], v[180:181] neg_lo:[0,1] neg_hi:[0,1]
 v_pk_add_f32 v[198:199], v[166:167], v[182:183]
 v_pk_add_f32 v[182:183], v[166:167], v[182:183] neg_lo:[0,1] neg_hi:[0,1]
 v_pk_add_f32 v[200:201], v[168:169], v[184:185]
 v_pk_add_f32 v[184:185], v[168:169], v[184:185] neg_lo:[0,1] neg_hi:[0,1]
 v_pk_add_f32 v[202:203], v[170:171], v[186:187]
 v_pk_add_f32 v[186:187], v[170:171], v[186:187] neg_lo:[0,1] neg_hi:[0,1]
 v_cvt_pk_bf16_f32 v188, v188, v189
 v_cvt_pk_bf16_f32 v189, v190, v191
 v_cvt_pk_bf16_f32 v190, v192, v193
 v_cvt_pk_bf16_f32 v191, v194, v195
 v_cvt_pk_bf16_f32 v192, v196, v197
 v_cvt_pk_bf16_f32 v193, v198, v199
 v_cvt_pk_bf16_f32 v194, v200, v201
 v_cvt_pk_bf16_f32 v195, v202, v203
 ds_write_b128 v30, v[188:191] offset:16512
 ds_write_b128 v31, v[192:195] offset:16512
 v_cvt_pk_bf16_f32 v172, v172, v173
 v_cvt_pk_bf16_f32 v173, v174, v175
 v_cvt_pk_bf16_f32 v174, v176, v177
 v_cvt_pk_bf16_f32 v175, v178, v179
 v_cvt_pk_bf16_f32 v176, v180, v181
 v_cvt_pk_bf16_f32 v177, v182, v183
 v_cvt_pk_bf16_f32 v178, v184, v185
 v_cvt_pk_bf16_f32 v179, v186, v187
 ds_write_b128 v30, v[172:175] offset:16768
 ds_write_b128 v31, v[176:179] offset:16768
 s_lshl_b32 s86, s72, 20
 s_lshl_b32 s66, s60, 8
 s_add_u32 s86, s86, s66
 s_add_u32 s86, s86, 0x5400000
 s_waitcnt lgkmcnt(0)
 s_barrier
 v_lshrrev_b32 v1, 4, v5
 v_mul_u32_u24 v1, 2048, v1
 v_and_b32 v2, 15, v0
 v_lshl_add_u32 v1, v2, 4, v1
 v_mul_u32_u24 v2, 4096, v6
 v_add_u32 v16, v1, v2
 s_mul_i32 s65, s62, 262144
 s_add_u32 s65, s65, s86
 s_lshl_b32 s66, s62, 15
 v_xor_b32 v1, v5, v6
 v_lshlrev_b32 v1, 4, v1
 v_lshl_add_u32 v1, v6, 9, v1
 v_add_u32 v18, s66, v1
 v_xor_b32 v28, 0, v18
 v_xor_b32 v29, 32, v18
 v_xor_b32 v30, 64, v18
 v_xor_b32 v31, 96, v18
 ds_read_b128 v[108:111], v28 offset:0
 ds_read_b128 v[112:115], v29 offset:1024
 ds_read_b128 v[116:119], v30 offset:2048
 ds_read_b128 v[120:123], v31 offset:3072
 ds_read_b128 v[124:127], v28 offset:4096
 ds_read_b128 v[128:131], v29 offset:5120
 ds_read_b128 v[132:135], v30 offset:6144
 ds_read_b128 v[136:139], v31 offset:7168
 ds_read_b128 v[140:143], v28 offset:8192
 ds_read_b128 v[144:147], v29 offset:9216
 ds_read_b128 v[148:151], v30 offset:10240
 ds_read_b128 v[152:155], v31 offset:11264
 ds_read_b128 v[156:159], v28 offset:12288
 ds_read_b128 v[160:163], v29 offset:13312
 ds_read_b128 v[164:167], v30 offset:14336
 ds_read_b128 v[168:171], v31 offset:15360
 ds_read_b128 v[172:175], v28 offset:16384
 ds_read_b128 v[176:179], v29 offset:17408
 ds_read_b128 v[180:183], v30 offset:18432
 ds_read_b128 v[184:187], v31 offset:19456
 ds_read_b128 v[188:191], v28 offset:20480
 ds_read_b128 v[192:195], v29 offset:21504
 ds_read_b128 v[196:199], v30 offset:22528
 ds_read_b128 v[200:203], v31 offset:23552
 ds_read_b128 v[204:207], v28 offset:24576
 ds_read_b128 v[208:211], v29 offset:25600
 ds_read_b128 v[212:215], v30 offset:26624
 ds_read_b128 v[216:219], v31 offset:27648
 ds_read_b128 v[220:223], v28 offset:28672
 ds_read_b128 v[224:227], v29 offset:29696
 ds_read_b128 v[228:231], v30 offset:30720
 ds_read_b128 v[232:235], v31 offset:31744
 s_waitcnt lgkmcnt(15)
 buffer_store_dwordx4 v[108:111], v16, s[4:7], s65 offen sc1
 s_add_u32 s65, s65, 8192
 s_sleep 4
 buffer_store_dwordx4 v[112:115], v16, s[4:7], s65 offen sc1
 s_add_u32 s65, s65, 8192
 s_sleep 4
 buffer_store_dwordx4 v[116:119], v16, s[4:7], s65 offen sc1
 s_add_u32 s65, s65, 8192
 s_sleep 4
 buffer_store_dwordx4 v[120:123], v16, s[4:7], s65 offen sc1
 s_add_u32 s65, s65, 8192
 s_sleep 4
 buffer_store_dwordx4 v[124:127], v16, s[4:7], s65 offen sc1
 s_add_u32 s65, s65, 8192
 s_sleep 4
 buffer_store_dwordx4 v[128:131], v16, s[4:7], s65 offen sc1
 s_add_u32 s65, s65, 8192
 s_sleep 4
 buffer_store_dwordx4 v[132:135], v16, s[4:7], s65 offen sc1
 s_add_u32 s65, s65, 8192
 s_sleep 4
 buffer_store_dwordx4 v[136:139], v16, s[4:7], s65 offen sc1
 s_add_u32 s65, s65, 8192
 s_sleep 4
 buffer_store_dwordx4 v[140:143], v16, s[4:7], s65 offen sc1
 s_add_u32 s65, s65, 8192
 s_sleep 4
 buffer_store_dwordx4 v[144:147], v16, s[4:7], s65 offen sc1
 s_add_u32 s65, s65, 8192
 s_sleep 4
 buffer_store_dwordx4 v[148:151], v16, s[4:7], s65 offen sc1
 s_add_u32 s65, s65, 8192
 s_sleep 4
 buffer_store_dwordx4 v[152:155], v16, s[4:7], s65 offen sc1
 s_add_u32 s65, s65, 8192
 s_sleep 4
 buffer_store_dwordx4 v[156:159], v16, s[4:7], s65 offen sc1
 s_add_u32 s65, s65, 8192
 s_sleep 4
 buffer_store_dwordx4 v[160:163], v16, s[4:7], s65 offen sc1
 s_add_u32 s65, s65, 8192
 s_sleep 4
 buffer_store_dwordx4 v[164:167], v16, s[4:7], s65 offen sc1
 s_add_u32 s65, s65, 8192
 s_sleep 4
 buffer_store_dwordx4 v[168:171], v16, s[4:7], s65 offen sc1
 s_add_u32 s65, s65, 8192
 s_sleep 4
 buffer_store_dwordx4 v[172:175], v16, s[4:7], s65 offen sc1
 s_add_u32 s65, s65, 8192
 s_sleep 4
 s_waitcnt lgkmcnt(14)
 buffer_store_dwordx4 v[176:179], v16, s[4:7], s65 offen sc1
 s_add_u32 s65, s65, 8192
 s_sleep 4
 s_waitcnt lgkmcnt(13)
 buffer_store_dwordx4 v[180:183], v16, s[4:7], s65 offen sc1
 s_add_u32 s65, s65, 8192
 s_sleep 4
 s_waitcnt lgkmcnt(12)
 buffer_store_dwordx4 v[184:187], v16, s[4:7], s65 offen sc1
 s_add_u32 s65, s65, 8192
 s_sleep 4
 s_waitcnt lgkmcnt(11)
 buffer_store_dwordx4 v[188:191], v16, s[4:7], s65 offen sc1
 s_add_u32 s65, s65, 8192
 s_sleep 4
 s_waitcnt lgkmcnt(10)
 buffer_store_dwordx4 v[192:195], v16, s[4:7], s65 offen sc1
 s_add_u32 s65, s65, 8192
 s_sleep 4
 s_waitcnt lgkmcnt(9)
 buffer_store_dwordx4 v[196:199], v16, s[4:7], s65 offen sc1
 s_add_u32 s65, s65, 8192
 s_sleep 4
 s_waitcnt lgkmcnt(8)
 buffer_store_dwordx4 v[200:203], v16, s[4:7], s65 offen sc1
 s_add_u32 s65, s65, 8192
 s_sleep 4
 s_waitcnt lgkmcnt(7)
 buffer_store_dwordx4 v[204:207], v16, s[4:7], s65 offen sc1
 s_add_u32 s65, s65, 8192
 s_sleep 4
 s_waitcnt lgkmcnt(6)
 buffer_store_dwordx4 v[208:211], v16, s[4:7], s65 offen sc1
 s_add_u32 s65, s65, 8192
 s_sleep 4
 s_waitcnt lgkmcnt(5)
 buffer_store_dwordx4 v[212:215], v16, s[4:7], s65 offen sc1
 s_add_u32 s65, s65, 8192
 s_sleep 4
 s_waitcnt lgkmcnt(4)
 buffer_store_dwordx4 v[216:219], v16, s[4:7], s65 offen sc1
 s_add_u32 s65, s65, 8192
 s_sleep 4
 s_waitcnt lgkmcnt(3)
 buffer_store_dwordx4 v[220:223], v16, s[4:7], s65 offen sc1
 s_add_u32 s65, s65, 8192
 s_sleep 4
 s_waitcnt lgkmcnt(2)
 buffer_store_dwordx4 v[224:227], v16, s[4:7], s65 offen sc1
 s_add_u32 s65, s65, 8192
 s_sleep 4
 s_waitcnt lgkmcnt(1)
 buffer_store_dwordx4 v[228:231], v16, s[4:7], s65 offen sc1
 s_add_u32 s65, s65, 8192
 s_sleep 4
 s_waitcnt lgkmcnt(0)
 buffer_store_dwordx4 v[232:235], v16, s[4:7], s65 offen sc1
 s_add_u32 s65, s65, 8192
 s_sleep 4
 s_waitcnt vmcnt(0)
 s_barrier
 s_cmp_eq_u32 s62, 0
 s_cbranch_scc0 L_nosig_124
 s_add_u32 s65, s101, 8
 s_mov_b32 s66, 0x1
 s_atomic_add s66, s[56:57], s65
 s_waitcnt lgkmcnt(0)
L_nosig_124:
 s_and_b32 s73, s60, 1
 s_lshr_b32 s74, s60, 1
 s_lshl_b32 s65, s72, 2
 s_add_u32 s65, s65, s62
 s_lshl_b32 s65, s65, 6
 s_add_u32 s65, s65, s73
 v_lshl_add_u32 v1, v6, 4, s65
 s_and_b32 s66, s74, 1
 s_lshl_b32 s66, s66, 9
 s_and_b32 s67, s74, 2
 s_add_u32 s66, s66, s67
 v_lshl_add_u32 v17, v5, 4, s66
 v_mul_u32_u24 v19, 1026, v1
 v_sub_u32 v3, 2002, v1
 v_mul_u32_u24 v20, 1026, v3
 v_sub_u32 v3, 2048, v1
 v_cmp_eq_u32 s[90:91], 0, v1
 v_mov_b32 v4, 1024
 s_nop 0
 v_cndmask_b32 v3, v3, v4, s[90:91]
 v_mul_u32_u24 v21, 1026, v3
 v_cmp_eq_u32 s[92:93], 0, v17
 v_add_u32 v19, v19, v17
 v_and_b32 v19, -4, v19
 v_add_u32 v20, v20, v17
 v_and_b32 v20, -4, v20
 v_add_u32 v21, v21, v17
 v_and_b32 v21, -4, v21
 s_lshr_b32 s66, s74, 1
 s_cmp_eq_u32 s66, s73
 s_mov_b32 s87, 0x07060302
 s_cselect_b32 s87, 0x05040100, s87
 v_and_b32 v2, 8, v0
 v_and_b32 v3, 7, v0
 v_lshl_add_u32 v2, v2, 1, v3
 v_lshl_add_u32 v2, v2, 1, v1
 v_sub_u32 v3, 2048, v2
 v_cmp_eq_u32 vcc, 0, v2
 v_mul_u32_u24 v2, 1026, v2
 s_nop 0
 v_cndmask_b32 v3, v3, v4, vcc
 v_mul_u32_u24 v3, 1026, v3
 buffer_load_ushort v22, v2, s[24:27], 0 offen offset:1024
 buffer_load_ushort v23, v2, s[28:31], 0 offen offset:1024
 buffer_load_ushort v24, v3, s[24:27], 0 offen offset:1024
 buffer_load_ushort v25, v3, s[28:31], 0 offen offset:1024
 s_mov_b32 s67, 0
 s_mov_b32 s68, 0
 buffer_load_dwordx4 v[28:31], v19, s[24:27], s67 offen
 buffer_load_dwordx4 v[32:35], v19, s[28:31], s67 offen
 buffer_load_dwordx4 v[36:39], v21, s[24:27], s68 offen
 buffer_load_dwordx4 v[40:43], v21, s[28:31], s68 offen
 s_mov_b32 s67, 2052
 s_mov_b32 s68, 45144
 buffer_load_dwordx4 v[44:47], v19, s[24:27], s67 offen
 buffer_load_dwordx4 v[48:51], v19, s[28:31], s67 offen
 buffer_load_dwordx4 v[52:55], v20, s[24:27], s68 offen
 buffer_load_dwordx4 v[56:59], v20, s[28:31], s68 offen
 s_mov_b32 s67, 4104
 s_mov_b32 s68, 43092
 buffer_load_dwordx4 v[60:63], v19, s[24:27], s67 offen
 buffer_load_dwordx4 v[64:67], v19, s[28:31], s67 offen
 buffer_load_dwordx4 v[68:71], v20, s[24:27], s68 offen
 buffer_load_dwordx4 v[72:75], v20, s[28:31], s68 offen
 s_mov_b32 s67, 6156
 s_mov_b32 s68, 41040
 buffer_load_dwordx4 v[76:79], v19, s[24:27], s67 offen
 buffer_load_dwordx4 v[80:83], v19, s[28:31], s67 offen
 buffer_load_dwordx4 v[84:87], v20, s[24:27], s68 offen
 buffer_load_dwordx4 v[88:91], v20, s[28:31], s68 offen
 s_mov_b32 s67, 8208
 s_mov_b32 s68, 38988
 buffer_load_dwordx4 v[92:95], v19, s[24:27], s67 offen
 buffer_load_dwordx4 v[96:99], v19, s[28:31], s67 offen
 buffer_load_dwordx4 v[100:103], v20, s[24:27], s68 offen
 buffer_load_dwordx4 v[104:107], v20, s[28:31], s68 offen
 s_waitcnt vmcnt(16)
 v_perm_b32 v108, v32, v28, s87
 v_perm_b32 v109, v40, v36, s87
 v_perm_b32 v124, v33, v29, s87
 v_perm_b32 v125, v41, v37, s87
 v_perm_b32 v140, v34, v30, s87
 v_perm_b32 v141, v42, v38, s87
 v_perm_b32 v156, v35, v31, s87
 v_perm_b32 v157, v43, v39, s87
 s_mov_b32 s67, 10260
 s_mov_b32 s68, 36936
 buffer_load_dwordx4 v[28:31], v19, s[24:27], s67 offen
 buffer_load_dwordx4 v[32:35], v19, s[28:31], s67 offen
 buffer_load_dwordx4 v[36:39], v20, s[24:27], s68 offen
 buffer_load_dwordx4 v[40:43], v20, s[28:31], s68 offen
 s_waitcnt vmcnt(16)
 v_perm_b32 v110, v48, v44, s87
 v_perm_b32 v111, v56, v52, s87
 v_perm_b32 v126, v49, v45, s87
 v_perm_b32 v127, v57, v53, s87
 v_perm_b32 v142, v50, v46, s87
 v_perm_b32 v143, v58, v54, s87
 v_perm_b32 v158, v51, v47, s87
 v_perm_b32 v159, v59, v55, s87
 s_mov_b32 s67, 12312
 s_mov_b32 s68, 34884
 buffer_load_dwordx4 v[44:47], v19, s[24:27], s67 offen
 buffer_load_dwordx4 v[48:51], v19, s[28:31], s67 offen
 buffer_load_dwordx4 v[52:55], v20, s[24:27], s68 offen
 buffer_load_dwordx4 v[56:59], v20, s[28:31], s68 offen
 s_waitcnt vmcnt(16)
 v_perm_b32 v112, v64, v60, s87
 v_perm_b32 v113, v72, v68, s87
 v_perm_b32 v128, v65, v61, s87
 v_perm_b32 v129, v73, v69, s87
 v_perm_b32 v144, v66, v62, s87
 v_perm_b32 v145, v74, v70, s87
 v_perm_b32 v160, v67, v63, s87
 v_perm_b32 v161, v75, v71, s87
 s_mov_b32 s67, 14364
 s_mov_b32 s68, 32832
 buffer_load_dwordx4 v[60:63], v19, s[24:27], s67 offen
 buffer_load_dwordx4 v[64:67], v19, s[28:31], s67 offen
 buffer_load_dwordx4 v[68:71], v20, s[24:27], s68 offen
 buffer_load_dwordx4 v[72:75], v20, s[28:31], s68 offen
 s_waitcnt vmcnt(16)
 v_perm_b32 v114, v80, v76, s87
 v_perm_b32 v115, v88, v84, s87
 v_perm_b32 v130, v81, v77, s87
 v_perm_b32 v131, v89, v85, s87
 v_perm_b32 v146, v82, v78, s87
 v_perm_b32 v147, v90, v86, s87
 v_perm_b32 v162, v83, v79, s87
 v_perm_b32 v163, v91, v87, s87
 s_mov_b32 s67, 32832
 s_mov_b32 s68, 14364
 buffer_load_dwordx4 v[76:79], v19, s[24:27], s67 offen
 buffer_load_dwordx4 v[80:83], v19, s[28:31], s67 offen
 buffer_load_dwordx4 v[84:87], v20, s[24:27], s68 offen
 buffer_load_dwordx4 v[88:91], v20, s[28:31], s68 offen
 s_waitcnt vmcnt(16)
 v_perm_b32 v116, v96, v92, s87
 v_perm_b32 v117, v104, v100, s87
 v_perm_b32 v132, v97, v93, s87
 v_perm_b32 v133, v105, v101, s87
 v_perm_b32 v148, v98, v94, s87
 v_perm_b32 v149, v106, v102, s87
 v_perm_b32 v164, v99, v95, s87
 v_perm_b32 v165, v107, v103, s87
 s_mov_b32 s67, 34884
 s_mov_b32 s68, 12312
 buffer_load_dwordx4 v[92:95], v19, s[24:27], s67 offen
 buffer_load_dwordx4 v[96:99], v19, s[28:31], s67 offen
 buffer_load_dwordx4 v[100:103], v20, s[24:27], s68 offen
 buffer_load_dwordx4 v[104:107], v20, s[28:31], s68 offen
 s_waitcnt vmcnt(16)
 v_perm_b32 v118, v32, v28, s87
 v_perm_b32 v119, v40, v36, s87
 v_perm_b32 v134, v33, v29, s87
 v_perm_b32 v135, v41, v37, s87
 v_perm_b32 v150, v34, v30, s87
 v_perm_b32 v151, v42, v38, s87
 v_perm_b32 v166, v35, v31, s87
 v_perm_b32 v167, v43, v39, s87
 s_mov_b32 s67, 36936
 s_mov_b32 s68, 10260
 buffer_load_dwordx4 v[28:31], v19, s[24:27], s67 offen
 buffer_load_dwordx4 v[32:35], v19, s[28:31], s67 offen
 buffer_load_dwordx4 v[36:39], v20, s[24:27], s68 offen
 buffer_load_dwordx4 v[40:43], v20, s[28:31], s68 offen
 s_waitcnt vmcnt(16)
 v_perm_b32 v120, v48, v44, s87
 v_perm_b32 v121, v56, v52, s87
 v_perm_b32 v136, v49, v45, s87
 v_perm_b32 v137, v57, v53, s87
 v_perm_b32 v152, v50, v46, s87
 v_perm_b32 v153, v58, v54, s87
 v_perm_b32 v168, v51, v47, s87
 v_perm_b32 v169, v59, v55, s87
 s_mov_b32 s67, 38988
 s_mov_b32 s68, 8208
 buffer_load_dwordx4 v[44:47], v19, s[24:27], s67 offen
 buffer_load_dwordx4 v[48:51], v19, s[28:31], s67 offen
 buffer_load_dwordx4 v[52:55], v20, s[24:27], s68 offen
 buffer_load_dwordx4 v[56:59], v20, s[28:31], s68 offen
 s_waitcnt vmcnt(16)
 v_perm_b32 v122, v64, v60, s87
 v_perm_b32 v123, v72, v68, s87
 v_perm_b32 v138, v65, v61, s87
 v_perm_b32 v139, v73, v69, s87
 v_perm_b32 v154, v66, v62, s87
 v_perm_b32 v155, v74, v70, s87
 v_perm_b32 v170, v67, v63, s87
 v_perm_b32 v171, v75, v71, s87
 s_mov_b32 s67, 41040
 s_mov_b32 s68, 6156
 buffer_load_dwordx4 v[60:63], v19, s[24:27], s67 offen
 buffer_load_dwordx4 v[64:67], v19, s[28:31], s67 offen
 buffer_load_dwordx4 v[68:71], v20, s[24:27], s68 offen
 buffer_load_dwordx4 v[72:75], v20, s[28:31], s68 offen
 s_waitcnt vmcnt(16)
 v_perm_b32 v172, v80, v76, s87
 v_perm_b32 v173, v88, v84, s87
 v_perm_b32 v188, v81, v77, s87
 v_perm_b32 v189, v89, v85, s87
 v_perm_b32 v204, v82, v78, s87
 v_perm_b32 v205, v90, v86, s87
 v_perm_b32 v220, v83, v79, s87
 v_perm_b32 v221, v91, v87, s87
 s_mov_b32 s67, 43092
 s_mov_b32 s68, 4104
 buffer_load_dwordx4 v[76:79], v19, s[24:27], s67 offen
 buffer_load_dwordx4 v[80:83], v19, s[28:31], s67 offen
 buffer_load_dwordx4 v[84:87], v20, s[24:27], s68 offen
 buffer_load_dwordx4 v[88:91], v20, s[28:31], s68 offen
 s_waitcnt vmcnt(16)
 v_perm_b32 v174, v96, v92, s87
 v_perm_b32 v175, v104, v100, s87
 v_perm_b32 v190, v97, v93, s87
 v_perm_b32 v191, v105, v101, s87
 v_perm_b32 v206, v98, v94, s87
 v_perm_b32 v207, v106, v102, s87
 v_perm_b32 v222, v99, v95, s87
 v_perm_b32 v223, v107, v103, s87
 s_mov_b32 s67, 45144
 s_mov_b32 s68, 2052
 buffer_load_dwordx4 v[92:95], v19, s[24:27], s67 offen
 buffer_load_dwordx4 v[96:99], v19, s[28:31], s67 offen
 buffer_load_dwordx4 v[100:103], v20, s[24:27], s68 offen
 buffer_load_dwordx4 v[104:107], v20, s[28:31], s68 offen
 s_waitcnt vmcnt(16)
 v_perm_b32 v176, v32, v28, s87
 v_perm_b32 v177, v40, v36, s87
 v_perm_b32 v192, v33, v29, s87
 v_perm_b32 v193, v41, v37, s87
 v_perm_b32 v208, v34, v30, s87
 v_perm_b32 v209, v42, v38, s87
 v_perm_b32 v224, v35, v31, s87
 v_perm_b32 v225, v43, v39, s87
 s_mov_b32 s67, 47196
 s_mov_b32 s68, 0
 buffer_load_dwordx4 v[28:31], v19, s[24:27], s67 offen
 buffer_load_dwordx4 v[32:35], v19, s[28:31], s67 offen
 buffer_load_dwordx4 v[36:39], v20, s[24:27], s68 offen
 buffer_load_dwordx4 v[40:43], v20, s[28:31], s68 offen
 s_waitcnt vmcnt(16)
 v_perm_b32 v178, v48, v44, s87
 v_perm_b32 v179, v56, v52, s87
 v_perm_b32 v194, v49, v45, s87
 v_perm_b32 v195, v57, v53, s87
 v_perm_b32 v210, v50, v46, s87
 v_perm_b32 v211, v58, v54, s87
 v_perm_b32 v226, v51, v47, s87
 v_perm_b32 v227, v59, v55, s87
 s_waitcnt vmcnt(12)
 v_perm_b32 v180, v64, v60, s87
 v_perm_b32 v181, v72, v68, s87
 v_perm_b32 v196, v65, v61, s87
 v_perm_b32 v197, v73, v69, s87
 v_perm_b32 v212, v66, v62, s87
 v_perm_b32 v213, v74, v70, s87
 v_perm_b32 v228, v67, v63, s87
 v_perm_b32 v229, v75, v71, s87
 s_waitcnt vmcnt(8)
 v_perm_b32 v182, v80, v76, s87
 v_perm_b32 v183, v88, v84, s87
 v_perm_b32 v198, v81, v77, s87
 v_perm_b32 v199, v89, v85, s87
 v_perm_b32 v214, v82, v78, s87
 v_perm_b32 v215, v90, v86, s87
 v_perm_b32 v230, v83, v79, s87
 v_perm_b32 v231, v91, v87, s87
 s_waitcnt vmcnt(4)
 v_perm_b32 v184, v96, v92, s87
 v_perm_b32 v185, v104, v100, s87
 v_perm_b32 v200, v97, v93, s87
 v_perm_b32 v201, v105, v101, s87
 v_perm_b32 v216, v98, v94, s87
 v_perm_b32 v217, v106, v102, s87
 v_perm_b32 v232, v99, v95, s87
 v_perm_b32 v233, v107, v103, s87
 s_waitcnt vmcnt(0)
 v_perm_b32 v186, v32, v28, s87
 v_perm_b32 v187, v40, v36, s87
 v_perm_b32 v202, v33, v29, s87
 v_perm_b32 v203, v41, v37, s87
 v_perm_b32 v218, v34, v30, s87
 v_perm_b32 v219, v42, v38, s87
 v_perm_b32 v234, v35, v31, s87
 v_perm_b32 v235, v43, v39, s87
 v_lshlrev_b32 v22, 16, v22
 v_lshlrev_b32 v23, 16, v23
 v_lshlrev_b32 v24, 16, v24
 v_lshlrev_b32 v25, 16, v25
 s_cmp_eq_u32 s62, 0
 s_cbranch_scc0 L_fb_skip_125
 v_mov_b32 v1, 8
L_wc_126:
 buffer_load_dword v2, v1, s[16:19], s101 offen sc1
 s_waitcnt vmcnt(0)
 v_readfirstlane_b32 s65, v2
 s_nop 3
 s_cmp_ge_u32 s65, 32
 s_cbranch_scc1 L_wcok_127
 s_sleep 10
 s_sub_u32 s63, s63, 1
 s_cbranch_scc0 L_wc_126
 s_endpgm
L_wcok_127:
L_fb_skip_125:
 s_barrier
 s_and_b32 s73, s60, 1
 s_lshr_b32 s74, s60, 1
 s_lshl_b32 s65, s74, 7
 s_add_u32 s65, s65, s62
 s_mul_i32 s65, s65, 8192
 s_lshl_b32 s66, s73, 11
 s_add_u32 s65, s65, s66
 v_lshrrev_b32 v1, 3, v0
 v_lshlrev_b32 v2, 3, v1
 v_mul_u32_u24 v2, 4096, v2
 v_lshrrev_b32 v1, 1, v1
 v_and_b32 v3, 7, v0
 v_xor_b32 v1, v1, v3
 v_lshl_add_u32 v8, v1, 4, v2
 v_xor_b32 v9, 64, v8
 s_add_u32 s78, s65, 0x5400000
 s_add_u32 s79, s65, 0x5440000
 s_add_u32 s80, s65, 0x5480000
 s_add_u32 s81, s65, 0x54c0000
 s_add_u32 s82, s65, 0x5401000
 s_add_u32 s83, s65, 0x5441000
 s_add_u32 s84, s65, 0x5481000
 s_add_u32 s85, s65, 0x54c1000
 s_lshl_b32 s76, s62, 13
 s_add_u32 m0, s76, 0
 s_nop 0
 buffer_load_dwordx4 v8, s[4:7], s78 offen sc1 lds
 s_add_u32 m0, s76, 1024
 s_nop 0
 buffer_load_dwordx4 v9, s[4:7], s79 offen sc1 lds
 s_add_u32 m0, s76, 2048
 s_nop 0
 buffer_load_dwordx4 v8, s[4:7], s80 offen sc1 lds
 s_add_u32 m0, s76, 3072
 s_nop 0
 buffer_load_dwordx4 v9, s[4:7], s81 offen sc1 lds
 s_add_u32 m0, s76, 4096
 s_nop 0
 buffer_load_dwordx4 v8, s[4:7], s82 offen sc1 lds
 s_add_u32 m0, s76, 5120
 s_nop 0
 buffer_load_dwordx4 v9, s[4:7], s83 offen sc1 lds
 s_add_u32 m0, s76, 6144
 s_nop 0
 buffer_load_dwordx4 v8, s[4:7], s84 offen sc1 lds
 s_add_u32 m0, s76, 7168
 s_nop 0
 buffer_load_dwordx4 v9, s[4:7], s85 offen sc1 lds
 v_add_u32 v8, 128, v8
 v_add_u32 v9, 128, v9
 s_add_u32 s76, s76, 32768
 s_and_b32 s76, s76, 0x1ffff
 s_add_u32 m0, s76, 0
 s_nop 0
 buffer_load_dwordx4 v8, s[4:7], s78 offen sc1 lds
 s_add_u32 m0, s76, 1024
 s_nop 0
 buffer_load_dwordx4 v9, s[4:7], s79 offen sc1 lds
 s_add_u32 m0, s76, 2048
 s_nop 0
 buffer_load_dwordx4 v8, s[4:7], s80 offen sc1 lds
 s_add_u32 m0, s76, 3072
 s_nop 0
 buffer_load_dwordx4 v9, s[4:7], s81 offen sc1 lds
 s_add_u32 m0, s76, 4096
 s_nop 0
 buffer_load_dwordx4 v8, s[4:7], s82 offen sc1 lds
 s_add_u32 m0, s76, 5120
 s_nop 0
 buffer_load_dwordx4 v9, s[4:7], s83 offen sc1 lds
 s_add_u32 m0, s76, 6144
 s_nop 0
 buffer_load_dwordx4 v8, s[4:7], s84 offen sc1 lds
 s_add_u32 m0, s76, 7168
 s_nop 0
 buffer_load_dwordx4 v9, s[4:7], s85 offen sc1 lds
 v_add_u32 v8, 128, v8
 v_add_u32 v9, 128, v9
 s_add_u32 s76, s76, 32768
 s_and_b32 s76, s76, 0x1ffff
 v_bfe_u32 v1, v0, 1, 3
 v_xor_b32 v1, v1, v6
 v_lshlrev_b32 v1, 4, v1
 v_lshl_add_u32 v10, v5, 7, v1
 v_xor_b32 v11, 32, v10
 v_xor_b32 v12, 64, v10
 v_xor_b32 v13, 96, v10
 s_mov_b32 s66, 0x3a000000
 s_mov_b32 s65, s72
 s_lshl_b32 s65, s65, 2
 s_add_u32 s65, s65, s62
 s_lshl_b32 s65, s65, 6
 s_add_u32 s65, s65, 0
 v_add_u32 v1, s65, v7
 v_and_b32 v2, -2, v1
 v_add_u32 v2, s73, v2
 v_and_b32 v3, 1, v1
 v_lshl_add_u32 v4, v2, 1, v3
 v_cmp_eq_u32 vcc, 1, v4
 v_cvt_f32_u32 v3, v3
 v_mul_f32 v3, 0xbe800000, v3
 v_mov_b32 v4, 1024
 v_cndmask_b32 v2, v2, v4, vcc
 v_cndmask_b32 v3, v3, 0, vcc
 v_lshl_add_u32 v4, v6, 3, 0
 v_mul_u32_u24 v4, v4, v2
 v_and_b32 v4, 2047, v4
 v_cvt_f32_u32 v4, v4
 v_fma_f32 v28, v4, s66, v3
 v_lshl_add_u32 v4, v6, 3, 1
 v_mul_u32_u24 v4, v4, v2
 v_and_b32 v4, 2047, v4
 v_cvt_f32_u32 v4, v4
 v_fma_f32 v29, v4, s66, v3
 v_lshl_add_u32 v4, v6, 3, 2
 v_mul_u32_u24 v4, v4, v2
 v_and_b32 v4, 2047, v4
 v_cvt_f32_u32 v4, v4
 v_fma_f32 v30, v4, s66, v3
 v_lshl_add_u32 v4, v6, 3, 3
 v_mul_u32_u24 v4, v4, v2
 v_and_b32 v4, 2047, v4
 v_cvt_f32_u32 v4, v4
 v_fma_f32 v31, v4, s66, v3
 v_lshl_add_u32 v4, v6, 3, 4
 v_mul_u32_u24 v4, v4, v2
 v_and_b32 v4, 2047, v4
 v_cvt_f32_u32 v4, v4
 v_fma_f32 v32, v4, s66, v3
 v_lshl_add_u32 v4, v6, 3, 5
 v_mul_u32_u24 v4, v4, v2
 v_and_b32 v4, 2047, v4
 v_cvt_f32_u32 v4, v4
 v_fma_f32 v33, v4, s66, v3
 v_lshl_add_u32 v4, v6, 3, 6
 v_mul_u32_u24 v4, v4, v2
 v_and_b32 v4, 2047, v4
 v_cvt_f32_u32 v4, v4
 v_fma_f32 v34, v4, s66, v3
 v_lshl_add_u32 v4, v6, 3, 7
 v_mul_u32_u24 v4, v4, v2
 v_and_b32 v4, 2047, v4
 v_cvt_f32_u32 v4, v4
 v_fma_f32 v35, v4, s66, v3
 v_lshlrev_b32 v4, 4, v2
 v_and_b32 v4, 2047, v4
 v_cvt_f32_u32 v4, v4
 v_mul_f32 v14, s66, v4
 v_cos_f32 v44, v28
 v_cos_f32 v45, v29
 v_cos_f32 v46, v30
 v_cos_f32 v47, v31
 v_cos_f32 v48, v32
 v_cos_f32 v49, v33
 v_cos_f32 v50, v34
 v_cos_f32 v51, v35
 v_add_f32 v28, v28, v14
 v_add_f32 v29, v29, v14
 v_add_f32 v30, v30, v14
 v_add_f32 v31, v31, v14
 v_add_f32 v32, v32, v14
 v_add_f32 v33, v33, v14
 v_add_f32 v34, v34, v14
 v_add_f32 v35, v35, v14
 v_cvt_pk_bf16_f32 v60, v44, v45
 v_cvt_pk_bf16_f32 v61, v46, v47
 v_cvt_pk_bf16_f32 v62, v48, v49
 v_cvt_pk_bf16_f32 v63, v50, v51
 s_mov_b32 s65, s72
 s_lshl_b32 s65, s65, 2
 s_add_u32 s65, s65, s62
 s_lshl_b32 s65, s65, 6
 s_add_u32 s65, s65, 32
 v_add_u32 v1, s65, v7
 v_and_b32 v2, -2, v1
 v_add_u32 v2, s73, v2
 v_and_b32 v3, 1, v1
 v_lshl_add_u32 v4, v2, 1, v3
 v_cmp_eq_u32 vcc, 1, v4
 v_cvt_f32_u32 v3, v3
 v_mul_f32 v3, 0xbe800000, v3
 v_mov_b32 v4, 1024
 v_cndmask_b32 v2, v2, v4, vcc
 v_cndmask_b32 v3, v3, 0, vcc
 v_lshl_add_u32 v4, v6, 3, 0
 v_mul_u32_u24 v4, v4, v2
 v_and_b32 v4, 2047, v4
 v_cvt_f32_u32 v4, v4
 v_fma_f32 v36, v4, s66, v3
 v_lshl_add_u32 v4, v6, 3, 1
 v_mul_u32_u24 v4, v4, v2
 v_and_b32 v4, 2047, v4
 v_cvt_f32_u32 v4, v4
 v_fma_f32 v37, v4, s66, v3
 v_lshl_add_u32 v4, v6, 3, 2
 v_mul_u32_u24 v4, v4, v2
 v_and_b32 v4, 2047, v4
 v_cvt_f32_u32 v4, v4
 v_fma_f32 v38, v4, s66, v3
 v_lshl_add_u32 v4, v6, 3, 3
 v_mul_u32_u24 v4, v4, v2
 v_and_b32 v4, 2047, v4
 v_cvt_f32_u32 v4, v4
 v_fma_f32 v39, v4, s66, v3
 v_lshl_add_u32 v4, v6, 3, 4
 v_mul_u32_u24 v4, v4, v2
 v_and_b32 v4, 2047, v4
 v_cvt_f32_u32 v4, v4
 v_fma_f32 v40, v4, s66, v3
 v_lshl_add_u32 v4, v6, 3, 5
 v_mul_u32_u24 v4, v4, v2
 v_and_b32 v4, 2047, v4
 v_cvt_f32_u32 v4, v4
 v_fma_f32 v41, v4, s66, v3
 v_lshl_add_u32 v4, v6, 3, 6
 v_mul_u32_u24 v4, v4, v2
 v_and_b32 v4, 2047, v4
 v_cvt_f32_u32 v4, v4
 v_fma_f32 v42, v4, s66, v3
 v_lshl_add_u32 v4, v6, 3, 7
 v_mul_u32_u24 v4, v4, v2
 v_and_b32 v4, 2047, v4
 v_cvt_f32_u32 v4, v4
 v_fma_f32 v43, v4, s66, v3
 v_lshlrev_b32 v4, 4, v2
 v_and_b32 v4, 2047, v4
 v_cvt_f32_u32 v4, v4
 v_mul_f32 v15, s66, v4
 v_cos_f32 v52, v36
 v_cos_f32 v53, v37
 v_cos_f32 v54, v38
 v_cos_f32 v55, v39
 v_cos_f32 v56, v40
 v_cos_f32 v57, v41
 v_cos_f32 v58, v42
 v_cos_f32 v59, v43
 v_add_f32 v36, v36, v15
 v_add_f32 v37, v37, v15
 v_add_f32 v38, v38, v15
 v_add_f32 v39, v39, v15
 v_add_f32 v40, v40, v15
 v_add_f32 v41, v41, v15
 v_add_f32 v42, v42, v15
 v_add_f32 v43, v43, v15
 v_cvt_pk_bf16_f32 v64, v52, v53
 v_cvt_pk_bf16_f32 v65, v54, v55
 v_cvt_pk_bf16_f32 v66, v56, v57
 v_cvt_pk_bf16_f32 v67, v58, v59
 v_mov_b32 v104, 0
 v_mov_b32 v105, 0
 v_mov_b32 v106, 0
 v_mov_b32 v107, 0
 s_nop 1
 v_mfma_f32_32x32x16_bf16 a[0:15], v[104:107], v[104:107], 0
 v_mfma_f32_32x32x16_bf16 a[16:31], v[104:107], v[104:107], 0
 v_mfma_f32_32x32x16_bf16 a[32:47], v[104:107], v[104:107], 0
 v_mfma_f32_32x32x16_bf16 a[48:63], v[104:107], v[104:107], 0
 v_mfma_f32_32x32x16_bf16 a[64:79], v[104:107], v[104:107], 0
 v_mfma_f32_32x32x16_bf16 a[80:95], v[104:107], v[104:107], 0
 v_mfma_f32_32x32x16_bf16 a[96:111], v[104:107], v[104:107], 0
 v_mfma_f32_32x32x16_bf16 a[112:127], v[104:107], v[104:107], 0
 v_mfma_f32_32x32x16_bf16 a[128:143], v[104:107], v[104:107], 0
 v_mfma_f32_32x32x16_bf16 a[144:159], v[104:107], v[104:107], 0
 v_mfma_f32_32x32x16_bf16 a[160:175], v[104:107], v[104:107], 0
 v_mfma_f32_32x32x16_bf16 a[176:191], v[104:107], v[104:107], 0
 v_mfma_f32_32x32x16_bf16 a[192:207], v[104:107], v[104:107], 0
 v_mfma_f32_32x32x16_bf16 a[208:223], v[104:107], v[104:107], 0
 v_mfma_f32_32x32x16_bf16 a[224:239], v[104:107], v[104:107], 0
 v_mfma_f32_32x32x16_bf16 a[240:255], v[104:107], v[104:107], 0
 s_waitcnt vmcnt(8)
 s_barrier
 ds_read_b128 v[76:79], v10 offset:0
 ds_read_b128 v[80:83], v10 offset:4096
 ds_read_b128 v[84:87], v10 offset:8192
 ds_read_b128 v[88:91], v10 offset:12288
 ds_read_b128 v[92:95], v10 offset:16384
 ds_read_b128 v[96:99], v10 offset:20480
 s_mov_b32 s75, 8
L_f_loop_128:
 s_waitcnt lgkmcnt(5)
 v_mfma_f32_32x32x16_bf16 a[0:15], v[60:63], v[76:79], a[0:15]
 ds_read_b128 v[100:103], v10 offset:24576
 v_cos_f32 v44, v28
 v_mfma_f32_32x32x16_bf16 a[128:143], v[64:67], v[76:79], a[128:143]
 v_cos_f32 v45, v29
 v_add_f32 v28, v28, v14
 s_waitcnt lgkmcnt(5)
 v_mfma_f32_32x32x16_bf16 a[16:31], v[60:63], v[80:83], a[16:31]
 ds_read_b128 v[104:107], v10 offset:28672
 v_cos_f32 v46, v30
 v_add_f32 v29, v29, v14
 v_cvt_pk_bf16_f32 v68, v44, v45
 v_mfma_f32_32x32x16_bf16 a[144:159], v[64:67], v[80:83], a[144:159]
 v_cos_f32 v47, v31
 v_add_f32 v30, v30, v14
 s_waitcnt lgkmcnt(5)
 s_add_u32 m0, s76, 0
 v_mfma_f32_32x32x16_bf16 a[32:47], v[60:63], v[84:87], a[32:47]
 ds_read_b128 v[76:79], v11 offset:0
 v_cos_f32 v48, v32
 v_add_f32 v31, v31, v14
 v_cvt_pk_bf16_f32 v69, v46, v47
 v_mfma_f32_32x32x16_bf16 a[160:175], v[64:67], v[84:87], a[160:175]
 buffer_load_dwordx4 v8, s[4:7], s78 offen sc1 lds
 v_cos_f32 v49, v33
 v_add_f32 v32, v32, v14
 s_waitcnt lgkmcnt(5)
 v_mfma_f32_32x32x16_bf16 a[48:63], v[60:63], v[88:91], a[48:63]
 ds_read_b128 v[80:83], v11 offset:4096
 v_cos_f32 v50, v34
 v_add_f32 v33, v33, v14
 v_cvt_pk_bf16_f32 v70, v48, v49
 v_cos_f32 v52, v36
 v_mfma_f32_32x32x16_bf16 a[176:191], v[64:67], v[88:91], a[176:191]
 v_cos_f32 v51, v35
 v_add_f32 v34, v34, v14
 v_cos_f32 v53, v37
 v_add_f32 v36, v36, v15
 s_waitcnt lgkmcnt(5)
 v_mfma_f32_32x32x16_bf16 a[64:79], v[60:63], v[92:95], a[64:79]
 ds_read_b128 v[84:87], v11 offset:8192
 v_add_f32 v35, v35, v14
 v_cvt_pk_bf16_f32 v71, v50, v51
 v_cos_f32 v54, v38
 v_add_f32 v37, v37, v15
 v_cvt_pk_bf16_f32 v72, v52, v53
 v_mfma_f32_32x32x16_bf16 a[192:207], v[64:67], v[92:95], a[192:207]
 v_cos_f32 v55, v39
 v_add_f32 v38, v38, v15
 s_waitcnt lgkmcnt(5)
 s_add_u32 m0, s76, 1024
 v_mfma_f32_32x32x16_bf16 a[80:95], v[60:63], v[96:99], a[80:95]
 ds_read_b128 v[88:91], v11 offset:12288
 v_cos_f32 v56, v40
 v_add_f32 v39, v39, v15
 v_cvt_pk_bf16_f32 v73, v54, v55
 v_mfma_f32_32x32x16_bf16 a[208:223], v[64:67], v[96:99], a[208:223]
 buffer_load_dwordx4 v9, s[4:7], s79 offen sc1 lds
 v_cos_f32 v57, v41
 v_add_f32 v40, v40, v15
 s_waitcnt lgkmcnt(5)
 v_mfma_f32_32x32x16_bf16 a[96:111], v[60:63], v[100:103], a[96:111]
 ds_read_b128 v[92:95], v11 offset:16384
 v_cos_f32 v58, v42
 v_add_f32 v41, v41, v15
 v_cvt_pk_bf16_f32 v74, v56, v57
 v_mfma_f32_32x32x16_bf16 a[224:239], v[64:67], v[100:103], a[224:239]
 v_cos_f32 v59, v43
 v_add_f32 v42, v42, v15
 s_waitcnt lgkmcnt(5)
 v_mfma_f32_32x32x16_bf16 a[112:127], v[60:63], v[104:107], a[112:127]
 ds_read_b128 v[96:99], v11 offset:20480
 v_add_f32 v43, v43, v15
 v_cvt_pk_bf16_f32 v75, v58, v59
 v_mfma_f32_32x32x16_bf16 a[240:255], v[64:67], v[104:107], a[240:255]
 s_waitcnt lgkmcnt(5)
 s_add_u32 m0, s76, 2048
 v_mfma_f32_32x32x16_bf16 a[0:15], v[68:71], v[76:79], a[0:15]
 ds_read_b128 v[100:103], v11 offset:24576
 v_cos_f32 v44, v28
 v_mfma_f32_32x32x16_bf16 a[128:143], v[72:75], v[76:79], a[128:143]
 buffer_load_dwordx4 v8, s[4:7], s80 offen sc1 lds
 v_cos_f32 v45, v29
 v_add_f32 v28, v28, v14
 s_waitcnt lgkmcnt(5)
 v_mfma_f32_32x32x16_bf16 a[16:31], v[68:71], v[80:83], a[16:31]
 ds_read_b128 v[104:107], v11 offset:28672
 v_cos_f32 v46, v30
 v_add_f32 v29, v29, v14
 v_cvt_pk_bf16_f32 v60, v44, v45
 v_mfma_f32_32x32x16_bf16 a[144:159], v[72:75], v[80:83], a[144:159]
 v_cos_f32 v47, v31
 v_add_f32 v30, v30, v14
 s_waitcnt lgkmcnt(5)
 v_mfma_f32_32x32x16_bf16 a[32:47], v[68:71], v[84:87], a[32:47]
 ds_read_b128 v[76:79], v12 offset:0
 v_cos_f32 v48, v32
 v_add_f32 v31, v31, v14
 v_cvt_pk_bf16_f32 v61, v46, v47
 v_mfma_f32_32x32x16_bf16 a[160:175], v[72:75], v[84:87], a[160:175]
 v_cos_f32 v49, v33
 v_add_f32 v32, v32, v14
 s_waitcnt lgkmcnt(5)
 s_add_u32 m0, s76, 3072
 v_mfma_f32_32x32x16_bf16 a[48:63], v[68:71], v[88:91], a[48:63]
 ds_read_b128 v[80:83], v12 offset:4096
 v_cos_f32 v50, v34
 v_add_f32 v33, v33, v14
 v_cvt_pk_bf16_f32 v62, v48, v49
 v_cos_f32 v52, v36
 v_mfma_f32_32x32x16_bf16 a[176:191], v[72:75], v[88:91], a[176:191]
 buffer_load_dwordx4 v9, s[4:7], s81 offen sc1 lds
 v_cos_f32 v51, v35
 v_add_f32 v34, v34, v14
 v_cos_f32 v53, v37
 v_add_f32 v36, v36, v15
 s_waitcnt lgkmcnt(5)
 v_mfma_f32_32x32x16_bf16 a[64:79], v[68:71], v[92:95], a[64:79]
 ds_read_b128 v[84:87], v12 offset:8192
 v_add_f32 v35, v35, v14
 v_cvt_pk_bf16_f32 v63, v50, v51
 v_cos_f32 v54, v38
 v_add_f32 v37, v37, v15
 v_cvt_pk_bf16_f32 v64, v52, v53
 v_mfma_f32_32x32x16_bf16 a[192:207], v[72:75], v[92:95], a[192:207]
 v_cos_f32 v55, v39
 v_add_f32 v38, v38, v15
 s_waitcnt lgkmcnt(5)
 v_mfma_f32_32x32x16_bf16 a[80:95], v[68:71], v[96:99], a[80:95]
 ds_read_b128 v[88:91], v12 offset:12288
 v_cos_f32 v56, v40
 v_add_f32 v39, v39, v15
 v_cvt_pk_bf16_f32 v65, v54, v55
 v_mfma_f32_32x32x16_bf16 a[208:223], v[72:75], v[96:99], a[208:223]
 v_cos_f32 v57, v41
 v_add_f32 v40, v40, v15
 s_waitcnt lgkmcnt(5)
 s_add_u32 m0, s76, 4096
 v_mfma_f32_32x32x16_bf16 a[96:111], v[68:71], v[100:103], a[96:111]
 ds_read_b128 v[92:95], v12 offset:16384
 v_cos_f32 v58, v42
 v_add_f32 v41, v41, v15
 v_cvt_pk_bf16_f32 v66, v56, v57
 v_mfma_f32_32x32x16_bf16 a[224:239], v[72:75], v[100:103], a[224:239]
 buffer_load_dwordx4 v8, s[4:7], s82 offen sc1 lds
 v_cos_f32 v59, v43
 v_add_f32 v42, v42, v15
 s_waitcnt lgkmcnt(5)
 v_mfma_f32_32x32x16_bf16 a[112:127], v[68:71], v[104:107], a[112:127]
 ds_read_b128 v[96:99], v12 offset:20480
 v_add_f32 v43, v43, v15
 v_cvt_pk_bf16_f32 v67, v58, v59
 v_mfma_f32_32x32x16_bf16 a[240:255], v[72:75], v[104:107], a[240:255]
 s_waitcnt lgkmcnt(5)
 v_mfma_f32_32x32x16_bf16 a[0:15], v[60:63], v[76:79], a[0:15]
 ds_read_b128 v[100:103], v12 offset:24576
 v_cos_f32 v44, v28
 v_mfma_f32_32x32x16_bf16 a[128:143], v[64:67], v[76:79], a[128:143]
 v_cos_f32 v45, v29
 v_add_f32 v28, v28, v14
 s_waitcnt lgkmcnt(5)
 s_add_u32 m0, s76, 5120
 v_mfma_f32_32x32x16_bf16 a[16:31], v[60:63], v[80:83], a[16:31]
 ds_read_b128 v[104:107], v12 offset:28672
 v_cos_f32 v46, v30
 v_add_f32 v29, v29, v14
 v_cvt_pk_bf16_f32 v68, v44, v45
 v_mfma_f32_32x32x16_bf16 a[144:159], v[64:67], v[80:83], a[144:159]
 buffer_load_dwordx4 v9, s[4:7], s83 offen sc1 lds
 v_cos_f32 v47, v31
 v_add_f32 v30, v30, v14
 s_waitcnt lgkmcnt(5)
 v_mfma_f32_32x32x16_bf16 a[32:47], v[60:63], v[84:87], a[32:47]
 ds_read_b128 v[76:79], v13 offset:0
 v_cos_f32 v48, v32
 v_add_f32 v31, v31, v14
 v_cvt_pk_bf16_f32 v69, v46, v47
 v_mfma_f32_32x32x16_bf16 a[160:175], v[64:67], v[84:87], a[160:175]
 v_cos_f32 v49, v33
 v_add_f32 v32, v32, v14
 s_waitcnt lgkmcnt(5)
 v_mfma_f32_32x32x16_bf16 a[48:63], v[60:63], v[88:91], a[48:63]
 ds_read_b128 v[80:83], v13 offset:4096
 v_cos_f32 v50, v34
 v_add_f32 v33, v33, v14
 v_cvt_pk_bf16_f32 v70, v48, v49
 v_cos_f32 v52, v36
 v_mfma_f32_32x32x16_bf16 a[176:191], v[64:67], v[88:91], a[176:191]
 v_cos_f32 v51, v35
 v_add_f32 v34, v34, v14
 v_cos_f32 v53, v37
 v_add_f32 v36, v36, v15
 s_waitcnt lgkmcnt(5)
 s_add_u32 m0, s76, 6144
 v_mfma_f32_32x32x16_bf16 a[64:79], v[60:63], v[92:95], a[64:79]
 ds_read_b128 v[84:87], v13 offset:8192
 v_add_f32 v35, v35, v14
 v_cvt_pk_bf16_f32 v71, v50, v51
 v_cos_f32 v54, v38
 v_add_f32 v37, v37, v15
 v_cvt_pk_bf16_f32 v72, v52, v53
 v_mfma_f32_32x32x16_bf16 a[192:207], v[64:67], v[92:95], a[192:207]
 buffer_load_dwordx4 v8, s[4:7], s84 offen sc1 lds
 v_cos_f32 v55, v39
 v_add_f32 v38, v38, v15
 s_waitcnt lgkmcnt(5)
 v_mfma_f32_32x32x16_bf16 a[80:95], v[60:63], v[96:99], a[80:95]
 ds_read_b128 v[88:91], v13 offset:12288
 v_cos_f32 v56, v40
 v_add_f32 v39, v39, v15
 v_cvt_pk_bf16_f32 v73, v54, v55
 v_mfma_f32_32x32x16_bf16 a[208:223], v[64:67], v[96:99], a[208:223]
 v_cos_f32 v57, v41
 v_add_f32 v40, v40, v15
 s_waitcnt lgkmcnt(5)
 v_mfma_f32_32x32x16_bf16 a[96:111], v[60:63], v[100:103], a[96:111]
 ds_read_b128 v[92:95], v13 offset:16384
 v_cos_f32 v58, v42
 v_add_f32 v41, v41, v15
 v_cvt_pk_bf16_f32 v74, v56, v57
 v_mfma_f32_32x32x16_bf16 a[224:239], v[64:67], v[100:103], a[224:239]
 v_cos_f32 v59, v43
 v_add_f32 v42, v42, v15
 s_waitcnt lgkmcnt(5)
 s_add_u32 m0, s76, 7168
 v_mfma_f32_32x32x16_bf16 a[112:127], v[60:63], v[104:107], a[112:127]
 ds_read_b128 v[96:99], v13 offset:20480
 v_add_f32 v43, v43, v15
 v_cvt_pk_bf16_f32 v75, v58, v59
 v_mfma_f32_32x32x16_bf16 a[240:255], v[64:67], v[104:107], a[240:255]
 buffer_load_dwordx4 v9, s[4:7], s85 offen sc1 lds
 s_waitcnt lgkmcnt(5)
 v_mfma_f32_32x32x16_bf16 a[0:15], v[68:71], v[76:79], a[0:15]
 ds_read_b128 v[100:103], v13 offset:24576
 v_cos_f32 v44, v28
 v_mfma_f32_32x32x16_bf16 a[128:143], v[72:75], v[76:79], a[128:143]
 v_cos_f32 v45, v29
 v_add_f32 v28, v28, v14
 v_add_u32 v8, 128, v8
 v_add_u32 v9, 128, v9
 s_add_u32 s76, s76, 32768
 s_and_b32 s76, s76, 0x1ffff
 s_waitcnt lgkmcnt(5)
 v_mfma_f32_32x32x16_bf16 a[16:31], v[68:71], v[80:83], a[16:31]
 ds_read_b128 v[104:107], v13 offset:28672
 v_cos_f32 v46, v30
 v_add_f32 v29, v29, v14
 v_cvt_pk_bf16_f32 v60, v44, v45
 v_mfma_f32_32x32x16_bf16 a[144:159], v[72:75], v[80:83], a[144:159]
 v_cos_f32 v47, v31
 v_add_f32 v30, v30, v14
 s_waitcnt vmcnt(8)
 s_barrier
 s_waitcnt lgkmcnt(5)
 v_mfma_f32_32x32x16_bf16 a[32:47], v[68:71], v[84:87], a[32:47]
 ds_read_b128 v[76:79], v10 offset:32768
 v_cos_f32 v48, v32
 v_add_f32 v31, v31, v14
 v_cvt_pk_bf16_f32 v61, v46, v47
 v_mfma_f32_32x32x16_bf16 a[160:175], v[72:75], v[84:87], a[160:175]
 v_cos_f32 v49, v33
 v_add_f32 v32, v32, v14
 s_waitcnt lgkmcnt(5)
 v_mfma_f32_32x32x16_bf16 a[48:63], v[68:71], v[88:91], a[48:63]
 ds_read_b128 v[80:83], v10 offset:36864
 v_cos_f32 v50, v34
 v_add_f32 v33, v33, v14
 v_cvt_pk_bf16_f32 v62, v48, v49
 v_cos_f32 v52, v36
 v_mfma_f32_32x32x16_bf16 a[176:191], v[72:75], v[88:91], a[176:191]
 v_cos_f32 v51, v35
 v_add_f32 v34, v34, v14
 v_cos_f32 v53, v37
 v_add_f32 v36, v36, v15
 s_waitcnt lgkmcnt(5)
 v_mfma_f32_32x32x16_bf16 a[64:79], v[68:71], v[92:95], a[64:79]
 ds_read_b128 v[84:87], v10 offset:40960
 v_add_f32 v35, v35, v14
 v_cvt_pk_bf16_f32 v63, v50, v51
 v_cos_f32 v54, v38
 v_add_f32 v37, v37, v15
 v_cvt_pk_bf16_f32 v64, v52, v53
 v_mfma_f32_32x32x16_bf16 a[192:207], v[72:75], v[92:95], a[192:207]
 v_cos_f32 v55, v39
 v_add_f32 v38, v38, v15
 s_waitcnt lgkmcnt(5)
 v_mfma_f32_32x32x16_bf16 a[80:95], v[68:71], v[96:99], a[80:95]
 ds_read_b128 v[88:91], v10 offset:45056
 v_cos_f32 v56, v40
 v_add_f32 v39, v39, v15
 v_cvt_pk_bf16_f32 v65, v54, v55
 v_mfma_f32_32x32x16_bf16 a[208:223], v[72:75], v[96:99], a[208:223]
 v_cos_f32 v57, v41
 v_add_f32 v40, v40, v15
 s_waitcnt lgkmcnt(5)
 v_mfma_f32_32x32x16_bf16 a[96:111], v[68:71], v[100:103], a[96:111]
 ds_read_b128 v[92:95], v10 offset:49152
 v_cos_f32 v58, v42
 v_add_f32 v41, v41, v15
 v_cvt_pk_bf16_f32 v66, v56, v57
 v_mfma_f32_32x32x16_bf16 a[224:239], v[72:75], v[100:103], a[224:239]
 v_cos_f32 v59, v43
 v_add_f32 v42, v42, v15
 s_waitcnt lgkmcnt(5)
 v_mfma_f32_32x32x16_bf16 a[112:127], v[68:71], v[104:107], a[112:127]
 ds_read_b128 v[96:99], v10 offset:53248
 v_add_f32 v43, v43, v15
 v_cvt_pk_bf16_f32 v67, v58, v59
 v_mfma_f32_32x32x16_bf16 a[240:255], v[72:75], v[104:107], a[240:255]
 s_waitcnt lgkmcnt(5)
 v_mfma_f32_32x32x16_bf16 a[0:15], v[60:63], v[76:79], a[0:15]
 ds_read_b128 v[100:103], v10 offset:57344
 v_cos_f32 v44, v28
 v_mfma_f32_32x32x16_bf16 a[128:143], v[64:67], v[76:79], a[128:143]
 v_cos_f32 v45, v29
 v_add_f32 v28, v28, v14
 s_waitcnt lgkmcnt(5)
 v_mfma_f32_32x32x16_bf16 a[16:31], v[60:63], v[80:83], a[16:31]
 ds_read_b128 v[104:107], v10 offset:61440
 v_xor_b32 v10, 0x10000, v10
 v_cos_f32 v46, v30
 v_add_f32 v29, v29, v14
 v_cvt_pk_bf16_f32 v68, v44, v45
 v_mfma_f32_32x32x16_bf16 a[144:159], v[64:67], v[80:83], a[144:159]
 v_cos_f32 v47, v31
 v_add_f32 v30, v30, v14
 s_waitcnt lgkmcnt(5)
 s_add_u32 m0, s76, 0
 v_mfma_f32_32x32x16_bf16 a[32:47], v[60:63], v[84:87], a[32:47]
 ds_read_b128 v[76:79], v11 offset:32768
 v_cos_f32 v48, v32
 v_add_f32 v31, v31, v14
 v_cvt_pk_bf16_f32 v69, v46, v47
 v_mfma_f32_32x32x16_bf16 a[160:175], v[64:67], v[84:87], a[160:175]
 buffer_load_dwordx4 v8, s[4:7], s78 offen sc1 lds
 v_cos_f32 v49, v33
 v_add_f32 v32, v32, v14
 s_waitcnt lgkmcnt(5)
 v_mfma_f32_32x32x16_bf16 a[48:63], v[60:63], v[88:91], a[48:63]
 ds_read_b128 v[80:83], v11 offset:36864
 v_cos_f32 v50, v34
 v_add_f32 v33, v33, v14
 v_cvt_pk_bf16_f32 v70, v48, v49
 v_cos_f32 v52, v36
 v_mfma_f32_32x32x16_bf16 a[176:191], v[64:67], v[88:91], a[176:191]
 v_cos_f32 v51, v35
 v_add_f32 v34, v34, v14
 v_cos_f32 v53, v37
 v_add_f32 v36, v36, v15
 s_waitcnt lgkmcnt(5)
 v_mfma_f32_32x32x16_bf16 a[64:79], v[60:63], v[92:95], a[64:79]
 ds_read_b128 v[84:87], v11 offset:40960
 v_add_f32 v35, v35, v14
 v_cvt_pk_bf16_f32 v71, v50, v51
 v_cos_f32 v54, v38
 v_add_f32 v37, v37, v15
 v_cvt_pk_bf16_f32 v72, v52, v53
 v_mfma_f32_32x32x16_bf16 a[192:207], v[64:67], v[92:95], a[192:207]
 v_cos_f32 v55, v39
 v_add_f32 v38, v38, v15
 s_waitcnt lgkmcnt(5)
 s_add_u32 m0, s76, 1024
 v_mfma_f32_32x32x16_bf16 a[80:95], v[60:63], v[96:99], a[80:95]
 ds_read_b128 v[88:91], v11 offset:45056
 v_cos_f32 v56, v40
 v_add_f32 v39, v39, v15
 v_cvt_pk_bf16_f32 v73, v54, v55
 v_mfma_f32_32x32x16_bf16 a[208:223], v[64:67], v[96:99], a[208:223]
 buffer_load_dwordx4 v9, s[4:7], s79 offen sc1 lds
 v_cos_f32 v57, v41
 v_add_f32 v40, v40, v15
 s_waitcnt lgkmcnt(5)
 v_mfma_f32_32x32x16_bf16 a[96:111], v[60:63], v[100:103], a[96:111]
 ds_read_b128 v[92:95], v11 offset:49152
 v_cos_f32 v58, v42
 v_add_f32 v41, v41, v15
 v_cvt_pk_bf16_f32 v74, v56, v57
 v_mfma_f32_32x32x16_bf16 a[224:239], v[64:67], v[100:103], a[224:239]
 v_cos_f32 v59, v43
 v_add_f32 v42, v42, v15
 s_waitcnt lgkmcnt(5)
 v_mfma_f32_32x32x16_bf16 a[112:127], v[60:63], v[104:107], a[112:127]
 ds_read_b128 v[96:99], v11 offset:53248
 v_add_f32 v43, v43, v15
 v_cvt_pk_bf16_f32 v75, v58, v59
 v_mfma_f32_32x32x16_bf16 a[240:255], v[64:67], v[104:107], a[240:255]
 s_waitcnt lgkmcnt(5)
 s_add_u32 m0, s76, 2048
 v_mfma_f32_32x32x16_bf16 a[0:15], v[68:71], v[76:79], a[0:15]
 ds_read_b128 v[100:103], v11 offset:57344
 v_cos_f32 v44, v28
 v_mfma_f32_32x32x16_bf16 a[128:143], v[72:75], v[76:79], a[128:143]
 buffer_load_dwordx4 v8, s[4:7], s80 offen sc1 lds
 v_cos_f32 v45, v29
 v_add_f32 v28, v28, v14
 s_waitcnt lgkmcnt(5)
 v_mfma_f32_32x32x16_bf16 a[16:31], v[68:71], v[80:83], a[16:31]
 ds_read_b128 v[104:107], v11 offset:61440
 v_xor_b32 v11, 0x10000, v11
 v_cos_f32 v46, v30
 v_add_f32 v29, v29, v14
 v_cvt_pk_bf16_f32 v60, v44, v45
 v_mfma_f32_32x32x16_bf16 a[144:159], v[72:75], v[80:83], a[144:159]
 v_cos_f32 v47, v31
 v_add_f32 v30, v30, v14
 s_waitcnt lgkmcnt(5)
 v_mfma_f32_32x32x16_bf16 a[32:47], v[68:71], v[84:87], a[32:47]
 ds_read_b128 v[76:79], v12 offset:32768
 v_cos_f32 v48, v32
 v_add_f32 v31, v31, v14
 v_cvt_pk_bf16_f32 v61, v46, v47
 v_mfma_f32_32x32x16_bf16 a[160:175], v[72:75], v[84:87], a[160:175]
 v_cos_f32 v49, v33
 v_add_f32 v32, v32, v14
 s_waitcnt lgkmcnt(5)
 s_add_u32 m0, s76, 3072
 v_mfma_f32_32x32x16_bf16 a[48:63], v[68:71], v[88:91], a[48:63]
 ds_read_b128 v[80:83], v12 offset:36864
 v_cos_f32 v50, v34
 v_add_f32 v33, v33, v14
 v_cvt_pk_bf16_f32 v62, v48, v49
 v_cos_f32 v52, v36
 v_mfma_f32_32x32x16_bf16 a[176:191], v[72:75], v[88:91], a[176:191]
 buffer_load_dwordx4 v9, s[4:7], s81 offen sc1 lds
 v_cos_f32 v51, v35
 v_add_f32 v34, v34, v14
 v_cos_f32 v53, v37
 v_add_f32 v36, v36, v15
 s_waitcnt lgkmcnt(5)
 v_mfma_f32_32x32x16_bf16 a[64:79], v[68:71], v[92:95], a[64:79]
 ds_read_b128 v[84:87], v12 offset:40960
 v_add_f32 v35, v35, v14
 v_cvt_pk_bf16_f32 v63, v50, v51
 v_cos_f32 v54, v38
 v_add_f32 v37, v37, v15
 v_cvt_pk_bf16_f32 v64, v52, v53
 v_mfma_f32_32x32x16_bf16 a[192:207], v[72:75], v[92:95], a[192:207]
 v_cos_f32 v55, v39
 v_add_f32 v38, v38, v15
 s_waitcnt lgkmcnt(5)
 v_mfma_f32_32x32x16_bf16 a[80:95], v[68:71], v[96:99], a[80:95]
 ds_read_b128 v[88:91], v12 offset:45056
 v_cos_f32 v56, v40
 v_add_f32 v39, v39, v15
 v_cvt_pk_bf16_f32 v65, v54, v55
 v_mfma_f32_32x32x16_bf16 a[208:223], v[72:75], v[96:99], a[208:223]
 v_cos_f32 v57, v41
 v_add_f32 v40, v40, v15
 s_waitcnt lgkmcnt(5)
 s_add_u32 m0, s76, 4096
 v_mfma_f32_32x32x16_bf16 a[96:111], v[68:71], v[100:103], a[96:111]
 ds_read_b128 v[92:95], v12 offset:49152
 v_cos_f32 v58, v42
 v_add_f32 v41, v41, v15
 v_cvt_pk_bf16_f32 v66, v56, v57
 v_mfma_f32_32x32x16_bf16 a[224:239], v[72:75], v[100:103], a[224:239]
 buffer_load_dwordx4 v8, s[4:7], s82 offen sc1 lds
 v_cos_f32 v59, v43
 v_add_f32 v42, v42, v15
 s_waitcnt lgkmcnt(5)
 v_mfma_f32_32x32x16_bf16 a[112:127], v[68:71], v[104:107], a[112:127]
 ds_read_b128 v[96:99], v12 offset:53248
 v_add_f32 v43, v43, v15
 v_cvt_pk_bf16_f32 v67, v58, v59
 v_mfma_f32_32x32x16_bf16 a[240:255], v[72:75], v[104:107], a[240:255]
 s_waitcnt lgkmcnt(5)
 v_mfma_f32_32x32x16_bf16 a[0:15], v[60:63], v[76:79], a[0:15]
 ds_read_b128 v[100:103], v12 offset:57344
 v_cos_f32 v44, v28
 v_mfma_f32_32x32x16_bf16 a[128:143], v[64:67], v[76:79], a[128:143]
 v_cos_f32 v45, v29
 v_add_f32 v28, v28, v14
 s_waitcnt lgkmcnt(5)
 s_add_u32 m0, s76, 5120
 v_mfma_f32_32x32x16_bf16 a[16:31], v[60:63], v[80:83], a[16:31]
 ds_read_b128 v[104:107], v12 offset:61440
 v_xor_b32 v12, 0x10000, v12
 v_cos_f32 v46, v30
 v_add_f32 v29, v29, v14
 v_cvt_pk_bf16_f32 v68, v44, v45
 v_mfma_f32_32x32x16_bf16 a[144:159], v[64:67], v[80:83], a[144:159]
 buffer_load_dwordx4 v9, s[4:7], s83 offen sc1 lds
 v_cos_f32 v47, v31
 v_add_f32 v30, v30, v14
 s_waitcnt lgkmcnt(5)
 v_mfma_f32_32x32x16_bf16 a[32:47], v[60:63], v[84:87], a[32:47]
 ds_read_b128 v[76:79], v13 offset:32768
 v_cos_f32 v48, v32
 v_add_f32 v31, v31, v14
 v_cvt_pk_bf16_f32 v69, v46, v47
 v_mfma_f32_32x32x16_bf16 a[160:175], v[64:67], v[84:87], a[160:175]
 v_cos_f32 v49, v33
 v_add_f32 v32, v32, v14
 s_waitcnt lgkmcnt(5)
 v_mfma_f32_32x32x16_bf16 a[48:63], v[60:63], v[88:91], a[48:63]
 ds_read_b128 v[80:83], v13 offset:36864
 v_cos_f32 v50, v34
 v_add_f32 v33, v33, v14
 v_cvt_pk_bf16_f32 v70, v48, v49
 v_cos_f32 v52, v36
 v_mfma_f32_32x32x16_bf16 a[176:191], v[64:67], v[88:91], a[176:191]
 v_cos_f32 v51, v35
 v_add_f32 v34, v34, v14
 v_cos_f32 v53, v37
 v_add_f32 v36, v36, v15
 s_waitcnt lgkmcnt(5)
 s_add_u32 m0, s76, 6144
 v_mfma_f32_32x32x16_bf16 a[64:79], v[60:63], v[92:95], a[64:79]
 ds_read_b128 v[84:87], v13 offset:40960
 v_add_f32 v35, v35, v14
 v_cvt_pk_bf16_f32 v71, v50, v51
 v_cos_f32 v54, v38
 v_add_f32 v37, v37, v15
 v_cvt_pk_bf16_f32 v72, v52, v53
 v_mfma_f32_32x32x16_bf16 a[192:207], v[64:67], v[92:95], a[192:207]
 buffer_load_dwordx4 v8, s[4:7], s84 offen sc1 lds
 v_cos_f32 v55, v39
 v_add_f32 v38, v38, v15
 s_waitcnt lgkmcnt(5)
 v_mfma_f32_32x32x16_bf16 a[80:95], v[60:63], v[96:99], a[80:95]
 ds_read_b128 v[88:91], v13 offset:45056
 v_cos_f32 v56, v40
 v_add_f32 v39, v39, v15
 v_cvt_pk_bf16_f32 v73, v54, v55
 v_mfma_f32_32x32x16_bf16 a[208:223], v[64:67], v[96:99], a[208:223]
 v_cos_f32 v57, v41
 v_add_f32 v40, v40, v15
 s_waitcnt lgkmcnt(5)
 v_mfma_f32_32x32x16_bf16 a[96:111], v[60:63], v[100:103], a[96:111]
 ds_read_b128 v[92:95], v13 offset:49152
 v_cos_f32 v58, v42
 v_add_f32 v41, v41, v15
 v_cvt_pk_bf16_f32 v74, v56, v57
 v_mfma_f32_32x32x16_bf16 a[224:239], v[64:67], v[100:103], a[224:239]
 v_cos_f32 v59, v43
 v_add_f32 v42, v42, v15
 s_waitcnt lgkmcnt(5)
 s_add_u32 m0, s76, 7168
 v_mfma_f32_32x32x16_bf16 a[112:127], v[60:63], v[104:107], a[112:127]
 ds_read_b128 v[96:99], v13 offset:53248
 v_add_f32 v43, v43, v15
 v_cvt_pk_bf16_f32 v75, v58, v59
 v_mfma_f32_32x32x16_bf16 a[240:255], v[64:67], v[104:107], a[240:255]
 buffer_load_dwordx4 v9, s[4:7], s85 offen sc1 lds
 s_waitcnt lgkmcnt(5)
 v_mfma_f32_32x32x16_bf16 a[0:15], v[68:71], v[76:79], a[0:15]
 ds_read_b128 v[100:103], v13 offset:57344
 v_cos_f32 v44, v28
 v_mfma_f32_32x32x16_bf16 a[128:143], v[72:75], v[76:79], a[128:143]
 v_cos_f32 v45, v29
 v_add_f32 v28, v28, v14
 v_add_u32 v8, 128, v8
 v_add_u32 v9, 128, v9
 s_add_u32 s76, s76, 32768
 s_and_b32 s76, s76, 0x1ffff
 s_waitcnt lgkmcnt(5)
 v_mfma_f32_32x32x16_bf16 a[16:31], v[68:71], v[80:83], a[16:31]
 ds_read_b128 v[104:107], v13 offset:61440
 v_xor_b32 v13, 0x10000, v13
 v_cos_f32 v46, v30
 v_add_f32 v29, v29, v14
 v_cvt_pk_bf16_f32 v60, v44, v45
 v_mfma_f32_32x32x16_bf16 a[144:159], v[72:75], v[80:83], a[144:159]
 v_cos_f32 v47, v31
 v_add_f32 v30, v30, v14
 s_waitcnt vmcnt(8)
 s_barrier
 s_waitcnt lgkmcnt(5)
 v_mfma_f32_32x32x16_bf16 a[32:47], v[68:71], v[84:87], a[32:47]
 ds_read_b128 v[76:79], v10 offset:0
 v_cos_f32 v48, v32
 v_add_f32 v31, v31, v14
 v_cvt_pk_bf16_f32 v61, v46, v47
 v_mfma_f32_32x32x16_bf16 a[160:175], v[72:75], v[84:87], a[160:175]
 v_cos_f32 v49, v33
 v_add_f32 v32, v32, v14
 s_waitcnt lgkmcnt(5)
 v_mfma_f32_32x32x16_bf16 a[48:63], v[68:71], v[88:91], a[48:63]
 ds_read_b128 v[80:83], v10 offset:4096
 v_cos_f32 v50, v34
 v_add_f32 v33, v33, v14
 v_cvt_pk_bf16_f32 v62, v48, v49
 v_cos_f32 v52, v36
 v_mfma_f32_32x32x16_bf16 a[176:191], v[72:75], v[88:91], a[176:191]
 v_cos_f32 v51, v35
 v_add_f32 v34, v34, v14
 v_cos_f32 v53, v37
 v_add_f32 v36, v36, v15
 s_waitcnt lgkmcnt(5)
 v_mfma_f32_32x32x16_bf16 a[64:79], v[68:71], v[92:95], a[64:79]
 ds_read_b128 v[84:87], v10 offset:8192
 v_add_f32 v35, v35, v14
 v_cvt_pk_bf16_f32 v63, v50, v51
 v_cos_f32 v54, v38
 v_add_f32 v37, v37, v15
 v_cvt_pk_bf16_f32 v64, v52, v53
 v_mfma_f32_32x32x16_bf16 a[192:207], v[72:75], v[92:95], a[192:207]
 v_cos_f32 v55, v39
 v_add_f32 v38, v38, v15
 s_waitcnt lgkmcnt(5)
 v_mfma_f32_32x32x16_bf16 a[80:95], v[68:71], v[96:99], a[80:95]
 ds_read_b128 v[88:91], v10 offset:12288
 v_cos_f32 v56, v40
 v_add_f32 v39, v39, v15
 v_cvt_pk_bf16_f32 v65, v54, v55
 v_mfma_f32_32x32x16_bf16 a[208:223], v[72:75], v[96:99], a[208:223]
 v_cos_f32 v57, v41
 v_add_f32 v40, v40, v15
 s_waitcnt lgkmcnt(5)
 v_mfma_f32_32x32x16_bf16 a[96:111], v[68:71], v[100:103], a[96:111]
 ds_read_b128 v[92:95], v10 offset:16384
 v_cos_f32 v58, v42
 v_add_f32 v41, v41, v15
 v_cvt_pk_bf16_f32 v66, v56, v57
 v_mfma_f32_32x32x16_bf16 a[224:239], v[72:75], v[100:103], a[224:239]
 v_cos_f32 v59, v43
 v_add_f32 v42, v42, v15
 s_waitcnt lgkmcnt(5)
 v_mfma_f32_32x32x16_bf16 a[112:127], v[68:71], v[104:107], a[112:127]
 ds_read_b128 v[96:99], v10 offset:20480
 v_add_f32 v43, v43, v15
 v_cvt_pk_bf16_f32 v67, v58, v59
 v_mfma_f32_32x32x16_bf16 a[240:255], v[72:75], v[104:107], a[240:255]
 s_sub_u32 s75, s75, 1
 s_cmp_lg_u32 s75, 0
 s_cbranch_scc1 L_f_loop_128
 s_waitcnt vmcnt(0) lgkmcnt(0)
 s_barrier
 s_nop 11
 s_mov_b32 s86, 0x35800000
 v_and_b32 v1, 7, v0
 v_lshlrev_b32 v2, 1, v6
 v_xor_b32 v1, v1, v2
 v_lshlrev_b32 v1, 4, v1
 v_lshl_add_u32 v1, v5, 12, v1
 s_lshl_b32 s66, s62, 7
 v_add_u32 v60, s66, v1
 v_xor_b32 v61, 16, v60
 v_xor_b32 v62, 64, v60
 v_xor_b32 v63, 80, v60
 v_accvgpr_read_b32 v76, a0
 v_accvgpr_read_b32 v77, a1
 v_accvgpr_read_b32 v78, a16
 v_accvgpr_read_b32 v79, a17
 v_lshlrev_b32 v88, 16, v108
 v_and_b32 v89, 0xffff0000, v108
 v_lshlrev_b32 v90, 16, v109
 v_and_b32 v91, 0xffff0000, v109
 v_add_f32 v80, v88, v90
 v_sub_f32 v81, v88, v90
 v_add_f32 v82, v89, v91
 v_sub_f32 v83, v89, v91
 v_pk_mul_f32 v[84:85], v[76:77], v[80:81] op_sel_hi:[1,0]
 v_pk_mul_f32 v[86:87], v[78:79], v[80:81] op_sel_hi:[1,0]
 v_pk_fma_f32 v[84:85], v[76:77], v[82:83], v[84:85] op_sel:[1,1,0] op_sel_hi:[0,1,1] neg_hi:[1,0,0]
 v_pk_fma_f32 v[86:87], v[78:79], v[82:83], v[86:87] op_sel:[1,1,0] op_sel_hi:[0,1,1] neg_hi:[1,0,0]
 v_mul_f32 v68, 0.5, v84
 v_mul_f32 v69, 0.5, v85
 v_pk_fma_f32 v[84:85], v[78:79], v[80:81], v[84:85] op_sel:[1,1,0] op_sel_hi:[0,1,1] neg_lo:[1,0,0]
 v_pk_fma_f32 v[86:87], v[76:77], v[80:81], v[86:87] op_sel:[1,1,0] op_sel_hi:[0,1,1] neg_hi:[1,0,0]
 v_pk_fma_f32 v[84:85], v[78:79], v[82:83], v[84:85] op_sel_hi:[1,0,1]
 v_pk_fma_f32 v[86:87], v[76:77], v[82:83], v[86:87] op_sel_hi:[1,0,1] neg_lo:[1,0,0] neg_hi:[1,0,0]
 s_mov_b64 exec, s[90:91]
 v_mul_f32 v84, v76, v88
 v_mul_f32 v85, v77, v90
 v_mul_f32 v68, 0.5, v84
 v_mul_f32 v69, 0.5, v85
 v_fma_f32 v84, v78, v89, v84
 v_fma_f32 v85, v79, v91, v85
 v_mul_f32 v86, v78, v88
 v_fma_f32 v86, -v76, v89, v86
 v_mul_f32 v87, v79, v90
 v_fma_f32 v87, -v77, v91, v87
 s_mov_b64 exec, -1
 v_mov_b32 v88, v22
 v_mov_b32 v89, v23
 v_mov_b32 v90, v24
 v_mov_b32 v91, v25
 s_mov_b64 exec, s[92:93]
 v_mov_b32 v84, v68
 v_mov_b32 v85, v69
 v_add_f32 v80, v88, v90
 v_sub_f32 v83, v89, v91
 v_mul_f32 v86, v78, v80
 v_mul_f32 v87, v79, v80
 v_fma_f32 v86, v79, v83, v86
 v_fma_f32 v87, -v78, v83, v87
 s_and_b64 exec, s[92:93], s[90:91]
 v_mul_f32 v86, v78, v88
 v_mul_f32 v87, v79, v90
 s_mov_b64 exec, s[92:93]
 v_mul_f32 v86, 0.5, v86
 v_mul_f32 v87, 0.5, v87
 s_mov_b64 exec, -1
 v_mul_f32 v84, s86, v84
 v_mul_f32 v85, s86, v85
 v_mul_f32 v86, s86, v86
 v_mul_f32 v87, s86, v87
 v_cvt_pk_bf16_f32 v92, v84, v85
 v_cvt_pk_bf16_f32 v100, v86, v87
 v_accvgpr_read_b32 v76, a2
 v_accvgpr_read_b32 v77, a3
 v_accvgpr_read_b32 v78, a18
 v_accvgpr_read_b32 v79, a19
 v_lshlrev_b32 v88, 16, v110
 v_and_b32 v89, 0xffff0000, v110
 v_lshlrev_b32 v90, 16, v111
 v_and_b32 v91, 0xffff0000, v111
 v_add_f32 v80, v88, v90
 v_sub_f32 v81, v88, v90
 v_add_f32 v82, v89, v91
 v_sub_f32 v83, v89, v91
 v_pk_mul_f32 v[84:85], v[76:77], v[80:81] op_sel_hi:[1,0]
 v_pk_mul_f32 v[86:87], v[78:79], v[80:81] op_sel_hi:[1,0]
 v_pk_fma_f32 v[84:85], v[76:77], v[82:83], v[84:85] op_sel:[1,1,0] op_sel_hi:[0,1,1] neg_hi:[1,0,0]
 v_pk_fma_f32 v[86:87], v[78:79], v[82:83], v[86:87] op_sel:[1,1,0] op_sel_hi:[0,1,1] neg_hi:[1,0,0]
 v_mul_f32 v68, 0.5, v84
 v_mul_f32 v69, 0.5, v85
 v_pk_fma_f32 v[84:85], v[78:79], v[80:81], v[84:85] op_sel:[1,1,0] op_sel_hi:[0,1,1] neg_lo:[1,0,0]
 v_pk_fma_f32 v[86:87], v[76:77], v[80:81], v[86:87] op_sel:[1,1,0] op_sel_hi:[0,1,1] neg_hi:[1,0,0]
 v_pk_fma_f32 v[84:85], v[78:79], v[82:83], v[84:85] op_sel_hi:[1,0,1]
 v_pk_fma_f32 v[86:87], v[76:77], v[82:83], v[86:87] op_sel_hi:[1,0,1] neg_lo:[1,0,0] neg_hi:[1,0,0]
 v_mov_b32_dpp v88, v22 row_shl:1 row_mask:0xf bank_mask:0xf
 v_mov_b32_dpp v89, v23 row_shl:1 row_mask:0xf bank_mask:0xf
 v_mov_b32_dpp v90, v24 row_shl:1 row_mask:0xf bank_mask:0xf
 v_mov_b32_dpp v91, v25 row_shl:1 row_mask:0xf bank_mask:0xf
 s_mov_b64 exec, s[92:93]
 v_mov_b32 v84, v68
 v_mov_b32 v85, v69
 v_add_f32 v80, v88, v90
 v_sub_f32 v83, v89, v91
 v_mul_f32 v86, v78, v80
 v_mul_f32 v87, v79, v80
 v_fma_f32 v86, v79, v83, v86
 v_fma_f32 v87, -v78, v83, v87
 v_mul_f32 v86, 0.5, v86
 v_mul_f32 v87, 0.5, v87
 s_mov_b64 exec, -1
 v_mul_f32 v84, s86, v84
 v_mul_f32 v85, s86, v85
 v_mul_f32 v86, s86, v86
 v_mul_f32 v87, s86, v87
 v_cvt_pk_bf16_f32 v93, v84, v85
 v_cvt_pk_bf16_f32 v101, v86, v87
 v_accvgpr_read_b32 v76, a4
 v_accvgpr_read_b32 v77, a5
 v_accvgpr_read_b32 v78, a20
 v_accvgpr_read_b32 v79, a21
 v_lshlrev_b32 v88, 16, v112
 v_and_b32 v89, 0xffff0000, v112
 v_lshlrev_b32 v90, 16, v113
 v_and_b32 v91, 0xffff0000, v113
 v_add_f32 v80, v88, v90
 v_sub_f32 v81, v88, v90
 v_add_f32 v82, v89, v91
 v_sub_f32 v83, v89, v91
 v_pk_mul_f32 v[84:85], v[76:77], v[80:81] op_sel_hi:[1,0]
 v_pk_mul_f32 v[86:87], v[78:79], v[80:81] op_sel_hi:[1,0]
 v_pk_fma_f32 v[84:85], v[76:77], v[82:83], v[84:85] op_sel:[1,1,0] op_sel_hi:[0,1,1] neg_hi:[1,0,0]
 v_pk_fma_f32 v[86:87], v[78:79], v[82:83], v[86:87] op_sel:[1,1,0] op_sel_hi:[0,1,1] neg_hi:[1,0,0]
 v_mul_f32 v68, 0.5, v84
 v_mul_f32 v69, 0.5, v85
 v_pk_fma_f32 v[84:85], v[78:79], v[80:81], v[84:85] op_sel:[1,1,0] op_sel_hi:[0,1,1] neg_lo:[1,0,0]
 v_pk_fma_f32 v[86:87], v[76:77], v[80:81], v[86:87] op_sel:[1,1,0] op_sel_hi:[0,1,1] neg_hi:[1,0,0]
 v_pk_fma_f32 v[84:85], v[78:79], v[82:83], v[84:85] op_sel_hi:[1,0,1]
 v_pk_fma_f32 v[86:87], v[76:77], v[82:83], v[86:87] op_sel_hi:[1,0,1] neg_lo:[1,0,0] neg_hi:[1,0,0]
 v_mov_b32_dpp v88, v22 row_shl:2 row_mask:0xf bank_mask:0xf
 v_mov_b32_dpp v89, v23 row_shl:2 row_mask:0xf bank_mask:0xf
 v_mov_b32_dpp v90, v24 row_shl:2 row_mask:0xf bank_mask:0xf
 v_mov_b32_dpp v91, v25 row_shl:2 row_mask:0xf bank_mask:0xf
 s_mov_b64 exec, s[92:93]
 v_mov_b32 v84, v68
 v_mov_b32 v85, v69
 v_add_f32 v80, v88, v90
 v_sub_f32 v83, v89, v91
 v_mul_f32 v86, v78, v80
 v_mul_f32 v87, v79, v80
 v_fma_f32 v86, v79, v83, v86
 v_fma_f32 v87, -v78, v83, v87
 v_mul_f32 v86, 0.5, v86
 v_mul_f32 v87, 0.5, v87
 s_mov_b64 exec, -1
 v_mul_f32 v84, s86, v84
 v_mul_f32 v85, s86, v85
 v_mul_f32 v86, s86, v86
 v_mul_f32 v87, s86, v87
 v_cvt_pk_bf16_f32 v94, v84, v85
 v_cvt_pk_bf16_f32 v102, v86, v87
 v_accvgpr_read_b32 v76, a6
 v_accvgpr_read_b32 v77, a7
 v_accvgpr_read_b32 v78, a22
 v_accvgpr_read_b32 v79, a23
 v_lshlrev_b32 v88, 16, v114
 v_and_b32 v89, 0xffff0000, v114
 v_lshlrev_b32 v90, 16, v115
 v_and_b32 v91, 0xffff0000, v115
 v_add_f32 v80, v88, v90
 v_sub_f32 v81, v88, v90
 v_add_f32 v82, v89, v91
 v_sub_f32 v83, v89, v91
 v_pk_mul_f32 v[84:85], v[76:77], v[80:81] op_sel_hi:[1,0]
 v_pk_mul_f32 v[86:87], v[78:79], v[80:81] op_sel_hi:[1,0]
 v_pk_fma_f32 v[84:85], v[76:77], v[82:83], v[84:85] op_sel:[1,1,0] op_sel_hi:[0,1,1] neg_hi:[1,0,0]
 v_pk_fma_f32 v[86:87], v[78:79], v[82:83], v[86:87] op_sel:[1,1,0] op_sel_hi:[0,1,1] neg_hi:[1,0,0]
 v_mul_f32 v68, 0.5, v84
 v_mul_f32 v69, 0.5, v85
 v_pk_fma_f32 v[84:85], v[78:79], v[80:81], v[84:85] op_sel:[1,1,0] op_sel_hi:[0,1,1] neg_lo:[1,0,0]
 v_pk_fma_f32 v[86:87], v[76:77], v[80:81], v[86:87] op_sel:[1,1,0] op_sel_hi:[0,1,1] neg_hi:[1,0,0]
 v_pk_fma_f32 v[84:85], v[78:79], v[82:83], v[84:85] op_sel_hi:[1,0,1]
 v_pk_fma_f32 v[86:87], v[76:77], v[82:83], v[86:87] op_sel_hi:[1,0,1] neg_lo:[1,0,0] neg_hi:[1,0,0]
 v_mov_b32_dpp v88, v22 row_shl:3 row_mask:0xf bank_mask:0xf
 v_mov_b32_dpp v89, v23 row_shl:3 row_mask:0xf bank_mask:0xf
 v_mov_b32_dpp v90, v24 row_shl:3 row_mask:0xf bank_mask:0xf
 v_mov_b32_dpp v91, v25 row_shl:3 row_mask:0xf bank_mask:0xf
 s_mov_b64 exec, s[92:93]
 v_mov_b32 v84, v68
 v_mov_b32 v85, v69
 v_add_f32 v80, v88, v90
 v_sub_f32 v83, v89, v91
 v_mul_f32 v86, v78, v80
 v_mul_f32 v87, v79, v80
 v_fma_f32 v86, v79, v83, v86
 v_fma_f32 v87, -v78, v83, v87
 v_mul_f32 v86, 0.5, v86
 v_mul_f32 v87, 0.5, v87
 s_mov_b64 exec, -1
 v_mul_f32 v84, s86, v84
 v_mul_f32 v85, s86, v85
 v_mul_f32 v86, s86, v86
 v_mul_f32 v87, s86, v87
 v_cvt_pk_bf16_f32 v95, v84, v85
 v_cvt_pk_bf16_f32 v103, v86, v87
 v_accvgpr_read_b32 v76, a8
 v_accvgpr_read_b32 v77, a9
 v_accvgpr_read_b32 v78, a24
 v_accvgpr_read_b32 v79, a25
 v_lshlrev_b32 v88, 16, v116
 v_and_b32 v89, 0xffff0000, v116
 v_lshlrev_b32 v90, 16, v117
 v_and_b32 v91, 0xffff0000, v117
 v_add_f32 v80, v88, v90
 v_sub_f32 v81, v88, v90
 v_add_f32 v82, v89, v91
 v_sub_f32 v83, v89, v91
 v_pk_mul_f32 v[84:85], v[76:77], v[80:81] op_sel_hi:[1,0]
 v_pk_mul_f32 v[86:87], v[78:79], v[80:81] op_sel_hi:[1,0]
 v_pk_fma_f32 v[84:85], v[76:77], v[82:83], v[84:85] op_sel:[1,1,0] op_sel_hi:[0,1,1] neg_hi:[1,0,0]
 v_pk_fma_f32 v[86:87], v[78:79], v[82:83], v[86:87] op_sel:[1,1,0] op_sel_hi:[0,1,1] neg_hi:[1,0,0]
 v_mul_f32 v68, 0.5, v84
 v_mul_f32 v69, 0.5, v85
 v_pk_fma_f32 v[84:85], v[78:79], v[80:81], v[84:85] op_sel:[1,1,0] op_sel_hi:[0,1,1] neg_lo:[1,0,0]
 v_pk_fma_f32 v[86:87], v[76:77], v[80:81], v[86:87] op_sel:[1,1,0] op_sel_hi:[0,1,1] neg_hi:[1,0,0]
 v_pk_fma_f32 v[84:85], v[78:79], v[82:83], v[84:85] op_sel_hi:[1,0,1]
 v_pk_fma_f32 v[86:87], v[76:77], v[82:83], v[86:87] op_sel_hi:[1,0,1] neg_lo:[1,0,0] neg_hi:[1,0,0]
 v_mov_b32_dpp v88, v22 row_shl:4 row_mask:0xf bank_mask:0xf
 v_mov_b32_dpp v89, v23 row_shl:4 row_mask:0xf bank_mask:0xf
 v_mov_b32_dpp v90, v24 row_shl:4 row_mask:0xf bank_mask:0xf
 v_mov_b32_dpp v91, v25 row_shl:4 row_mask:0xf bank_mask:0xf
 s_mov_b64 exec, s[92:93]
 v_mov_b32 v84, v68
 v_mov_b32 v85, v69
 v_add_f32 v80, v88, v90
 v_sub_f32 v83, v89, v91
 v_mul_f32 v86, v78, v80
 v_mul_f32 v87, v79, v80
 v_fma_f32 v86, v79, v83, v86
 v_fma_f32 v87, -v78, v83, v87
 v_mul_f32 v86, 0.5, v86
 v_mul_f32 v87, 0.5, v87
 s_mov_b64 exec, -1
 v_mul_f32 v84, s86, v84
 v_mul_f32 v85, s86, v85
 v_mul_f32 v86, s86, v86
 v_mul_f32 v87, s86, v87
 v_cvt_pk_bf16_f32 v96, v84, v85
 v_cvt_pk_bf16_f32 v104, v86, v87
 v_accvgpr_read_b32 v76, a10
 v_accvgpr_read_b32 v77, a11
 v_accvgpr_read_b32 v78, a26
 v_accvgpr_read_b32 v79, a27
 v_lshlrev_b32 v88, 16, v118
 v_and_b32 v89, 0xffff0000, v118
 v_lshlrev_b32 v90, 16, v119
 v_and_b32 v91, 0xffff0000, v119
 v_add_f32 v80, v88, v90
 v_sub_f32 v81, v88, v90
 v_add_f32 v82, v89, v91
 v_sub_f32 v83, v89, v91
 v_pk_mul_f32 v[84:85], v[76:77], v[80:81] op_sel_hi:[1,0]
 v_pk_mul_f32 v[86:87], v[78:79], v[80:81] op_sel_hi:[1,0]
 v_pk_fma_f32 v[84:85], v[76:77], v[82:83], v[84:85] op_sel:[1,1,0] op_sel_hi:[0,1,1] neg_hi:[1,0,0]
 v_pk_fma_f32 v[86:87], v[78:79], v[82:83], v[86:87] op_sel:[1,1,0] op_sel_hi:[0,1,1] neg_hi:[1,0,0]
 v_mul_f32 v68, 0.5, v84
 v_mul_f32 v69, 0.5, v85
 v_pk_fma_f32 v[84:85], v[78:79], v[80:81], v[84:85] op_sel:[1,1,0] op_sel_hi:[0,1,1] neg_lo:[1,0,0]
 v_pk_fma_f32 v[86:87], v[76:77], v[80:81], v[86:87] op_sel:[1,1,0] op_sel_hi:[0,1,1] neg_hi:[1,0,0]
 v_pk_fma_f32 v[84:85], v[78:79], v[82:83], v[84:85] op_sel_hi:[1,0,1]
 v_pk_fma_f32 v[86:87], v[76:77], v[82:83], v[86:87] op_sel_hi:[1,0,1] neg_lo:[1,0,0] neg_hi:[1,0,0]
 v_mov_b32_dpp v88, v22 row_shl:5 row_mask:0xf bank_mask:0xf
 v_mov_b32_dpp v89, v23 row_shl:5 row_mask:0xf bank_mask:0xf
 v_mov_b32_dpp v90, v24 row_shl:5 row_mask:0xf bank_mask:0xf
 v_mov_b32_dpp v91, v25 row_shl:5 row_mask:0xf bank_mask:0xf
 s_mov_b64 exec, s[92:93]
 v_mov_b32 v84, v68
 v_mov_b32 v85, v69
 v_add_f32 v80, v88, v90
 v_sub_f32 v83, v89, v91
 v_mul_f32 v86, v78, v80
 v_mul_f32 v87, v79, v80
 v_fma_f32 v86, v79, v83, v86
 v_fma_f32 v87, -v78, v83, v87
 v_mul_f32 v86, 0.5, v86
 v_mul_f32 v87, 0.5, v87
 s_mov_b64 exec, -1
 v_mul_f32 v84, s86, v84
 v_mul_f32 v85, s86, v85
 v_mul_f32 v86, s86, v86
 v_mul_f32 v87, s86, v87
 v_cvt_pk_bf16_f32 v97, v84, v85
 v_cvt_pk_bf16_f32 v105, v86, v87
 v_accvgpr_read_b32 v76, a12
 v_accvgpr_read_b32 v77, a13
 v_accvgpr_read_b32 v78, a28
 v_accvgpr_read_b32 v79, a29
 v_lshlrev_b32 v88, 16, v120
 v_and_b32 v89, 0xffff0000, v120
 v_lshlrev_b32 v90, 16, v121
 v_and_b32 v91, 0xffff0000, v121
 v_add_f32 v80, v88, v90
 v_sub_f32 v81, v88, v90
 v_add_f32 v82, v89, v91
 v_sub_f32 v83, v89, v91
 v_pk_mul_f32 v[84:85], v[76:77], v[80:81] op_sel_hi:[1,0]
 v_pk_mul_f32 v[86:87], v[78:79], v[80:81] op_sel_hi:[1,0]
 v_pk_fma_f32 v[84:85], v[76:77], v[82:83], v[84:85] op_sel:[1,1,0] op_sel_hi:[0,1,1] neg_hi:[1,0,0]
 v_pk_fma_f32 v[86:87], v[78:79], v[82:83], v[86:87] op_sel:[1,1,0] op_sel_hi:[0,1,1] neg_hi:[1,0,0]
 v_mul_f32 v68, 0.5, v84
 v_mul_f32 v69, 0.5, v85
 v_pk_fma_f32 v[84:85], v[78:79], v[80:81], v[84:85] op_sel:[1,1,0] op_sel_hi:[0,1,1] neg_lo:[1,0,0]
 v_pk_fma_f32 v[86:87], v[76:77], v[80:81], v[86:87] op_sel:[1,1,0] op_sel_hi:[0,1,1] neg_hi:[1,0,0]
 v_pk_fma_f32 v[84:85], v[78:79], v[82:83], v[84:85] op_sel_hi:[1,0,1]
 v_pk_fma_f32 v[86:87], v[76:77], v[82:83], v[86:87] op_sel_hi:[1,0,1] neg_lo:[1,0,0] neg_hi:[1,0,0]
 v_mov_b32_dpp v88, v22 row_shl:6 row_mask:0xf bank_mask:0xf
 v_mov_b32_dpp v89, v23 row_shl:6 row_mask:0xf bank_mask:0xf
 v_mov_b32_dpp v90, v24 row_shl:6 row_mask:0xf bank_mask:0xf
 v_mov_b32_dpp v91, v25 row_shl:6 row_mask:0xf bank_mask:0xf
 s_mov_b64 exec, s[92:93]
 v_mov_b32 v84, v68
 v_mov_b32 v85, v69
 v_add_f32 v80, v88, v90
 v_sub_f32 v83, v89, v91
 v_mul_f32 v86, v78, v80
 v_mul_f32 v87, v79, v80
 v_fma_f32 v86, v79, v83, v86
 v_fma_f32 v87, -v78, v83, v87
 v_mul_f32 v86, 0.5, v86
 v_mul_f32 v87, 0.5, v87
 s_mov_b64 exec, -1
 v_mul_f32 v84, s86, v84
 v_mul_f32 v85, s86, v85
 v_mul_f32 v86, s86, v86
 v_mul_f32 v87, s86, v87
 v_cvt_pk_bf16_f32 v98, v84, v85
 v_cvt_pk_bf16_f32 v106, v86, v87
 v_accvgpr_read_b32 v76, a14
 v_accvgpr_read_b32 v77, a15
 v_accvgpr_read_b32 v78, a30
 v_accvgpr_read_b32 v79, a31
 v_lshlrev_b32 v88, 16, v122
 v_and_b32 v89, 0xffff0000, v122
 v_lshlrev_b32 v90, 16, v123
 v_and_b32 v91, 0xffff0000, v123
 v_add_f32 v80, v88, v90
 v_sub_f32 v81, v88, v90
 v_add_f32 v82, v89, v91
 v_sub_f32 v83, v89, v91
 v_pk_mul_f32 v[84:85], v[76:77], v[80:81] op_sel_hi:[1,0]
 v_pk_mul_f32 v[86:87], v[78:79], v[80:81] op_sel_hi:[1,0]
 v_pk_fma_f32 v[84:85], v[76:77], v[82:83], v[84:85] op_sel:[1,1,0] op_sel_hi:[0,1,1] neg_hi:[1,0,0]
 v_pk_fma_f32 v[86:87], v[78:79], v[82:83], v[86:87] op_sel:[1,1,0] op_sel_hi:[0,1,1] neg_hi:[1,0,0]
 v_mul_f32 v68, 0.5, v84
 v_mul_f32 v69, 0.5, v85
 v_pk_fma_f32 v[84:85], v[78:79], v[80:81], v[84:85] op_sel:[1,1,0] op_sel_hi:[0,1,1] neg_lo:[1,0,0]
 v_pk_fma_f32 v[86:87], v[76:77], v[80:81], v[86:87] op_sel:[1,1,0] op_sel_hi:[0,1,1] neg_hi:[1,0,0]
 v_pk_fma_f32 v[84:85], v[78:79], v[82:83], v[84:85] op_sel_hi:[1,0,1]
 v_pk_fma_f32 v[86:87], v[76:77], v[82:83], v[86:87] op_sel_hi:[1,0,1] neg_lo:[1,0,0] neg_hi:[1,0,0]
 v_mov_b32_dpp v88, v22 row_shl:7 row_mask:0xf bank_mask:0xf
 v_mov_b32_dpp v89, v23 row_shl:7 row_mask:0xf bank_mask:0xf
 v_mov_b32_dpp v90, v24 row_shl:7 row_mask:0xf bank_mask:0xf
 v_mov_b32_dpp v91, v25 row_shl:7 row_mask:0xf bank_mask:0xf
 s_mov_b64 exec, s[92:93]
 v_mov_b32 v84, v68
 v_mov_b32 v85, v69
 v_add_f32 v80, v88, v90
 v_sub_f32 v83, v89, v91
 v_mul_f32 v86, v78, v80
 v_mul_f32 v87, v79, v80
 v_fma_f32 v86, v79, v83, v86
 v_fma_f32 v87, -v78, v83, v87
 v_mul_f32 v86, 0.5, v86
 v_mul_f32 v87, 0.5, v87
 s_mov_b64 exec, -1
 v_mul_f32 v84, s86, v84
 v_mul_f32 v85, s86, v85
 v_mul_f32 v86, s86, v86
 v_mul_f32 v87, s86, v87
 v_cvt_pk_bf16_f32 v99, v84, v85
 v_cvt_pk_bf16_f32 v107, v86, v87
 ds_write_b128 v60, v[92:95] offset:0
 ds_write_b128 v60, v[100:103] offset:512
 ds_write_b128 v61, v[96:99] offset:0
 ds_write_b128 v61, v[104:107] offset:512
 v_accvgpr_read_b32 v76, a128
 v_accvgpr_read_b32 v77, a129
 v_accvgpr_read_b32 v78, a144
 v_accvgpr_read_b32 v79, a145
 v_lshlrev_b32 v88, 16, v172
 v_and_b32 v89, 0xffff0000, v172
 v_lshlrev_b32 v90, 16, v173
 v_and_b32 v91, 0xffff0000, v173
 v_add_f32 v80, v88, v90
 v_sub_f32 v81, v88, v90
 v_add_f32 v82, v89, v91
 v_sub_f32 v83, v89, v91
 v_pk_mul_f32 v[84:85], v[76:77], v[80:81] op_sel_hi:[1,0]
 v_pk_mul_f32 v[86:87], v[78:79], v[80:81] op_sel_hi:[1,0]
 v_pk_fma_f32 v[84:85], v[76:77], v[82:83], v[84:85] op_sel:[1,1,0] op_sel_hi:[0,1,1] neg_hi:[1,0,0]
 v_pk_fma_f32 v[86:87], v[78:79], v[82:83], v[86:87] op_sel:[1,1,0] op_sel_hi:[0,1,1] neg_hi:[1,0,0]
 v_mul_f32 v68, 0.5, v84
 v_mul_f32 v69, 0.5, v85
 v_pk_fma_f32 v[84:85], v[78:79], v[80:81], v[84:85] op_sel:[1,1,0] op_sel_hi:[0,1,1] neg_lo:[1,0,0]
 v_pk_fma_f32 v[86:87], v[76:77], v[80:81], v[86:87] op_sel:[1,1,0] op_sel_hi:[0,1,1] neg_hi:[1,0,0]
 v_pk_fma_f32 v[84:85], v[78:79], v[82:83], v[84:85] op_sel_hi:[1,0,1]
 v_pk_fma_f32 v[86:87], v[76:77], v[82:83], v[86:87] op_sel_hi:[1,0,1] neg_lo:[1,0,0] neg_hi:[1,0,0]
 v_mov_b32_dpp v88, v22 row_shl:8 row_mask:0xf bank_mask:0xf
 v_mov_b32_dpp v89, v23 row_shl:8 row_mask:0xf bank_mask:0xf
 v_mov_b32_dpp v90, v24 row_shl:8 row_mask:0xf bank_mask:0xf
 v_mov_b32_dpp v91, v25 row_shl:8 row_mask:0xf bank_mask:0xf
 s_mov_b64 exec, s[92:93]
 v_mov_b32 v84, v68
 v_mov_b32 v85, v69
 v_add_f32 v80, v88, v90
 v_sub_f32 v83, v89, v91
 v_mul_f32 v86, v78, v80
 v_mul_f32 v87, v79, v80
 v_fma_f32 v86, v79, v83, v86
 v_fma_f32 v87, -v78, v83, v87
 v_mul_f32 v86, 0.5, v86
 v_mul_f32 v87, 0.5, v87
 s_mov_b64 exec, -1
 v_mul_f32 v84, s86, v84
 v_mul_f32 v85, s86, v85
 v_mul_f32 v86, s86, v86
 v_mul_f32 v87, s86, v87
 v_cvt_pk_bf16_f32 v92, v84, v85
 v_cvt_pk_bf16_f32 v100, v86, v87
 v_accvgpr_read_b32 v76, a130
 v_accvgpr_read_b32 v77, a131
 v_accvgpr_read_b32 v78, a146
 v_accvgpr_read_b32 v79, a147
 v_lshlrev_b32 v88, 16, v174
 v_and_b32 v89, 0xffff0000, v174
 v_lshlrev_b32 v90, 16, v175
 v_and_b32 v91, 0xffff0000, v175
 v_add_f32 v80, v88, v90
 v_sub_f32 v81, v88, v90
 v_add_f32 v82, v89, v91
 v_sub_f32 v83, v89, v91
 v_pk_mul_f32 v[84:85], v[76:77], v[80:81] op_sel_hi:[1,0]
 v_pk_mul_f32 v[86:87], v[78:79], v[80:81] op_sel_hi:[1,0]
 v_pk_fma_f32 v[84:85], v[76:77], v[82:83], v[84:85] op_sel:[1,1,0] op_sel_hi:[0,1,1] neg_hi:[1,0,0]
 v_pk_fma_f32 v[86:87], v[78:79], v[82:83], v[86:87] op_sel:[1,1,0] op_sel_hi:[0,1,1] neg_hi:[1,0,0]
 v_mul_f32 v68, 0.5, v84
 v_mul_f32 v69, 0.5, v85
 v_pk_fma_f32 v[84:85], v[78:79], v[80:81], v[84:85] op_sel:[1,1,0] op_sel_hi:[0,1,1] neg_lo:[1,0,0]
 v_pk_fma_f32 v[86:87], v[76:77], v[80:81], v[86:87] op_sel:[1,1,0] op_sel_hi:[0,1,1] neg_hi:[1,0,0]
 v_pk_fma_f32 v[84:85], v[78:79], v[82:83], v[84:85] op_sel_hi:[1,0,1]
 v_pk_fma_f32 v[86:87], v[76:77], v[82:83], v[86:87] op_sel_hi:[1,0,1] neg_lo:[1,0,0] neg_hi:[1,0,0]
 v_mov_b32_dpp v88, v22 row_shl:9 row_mask:0xf bank_mask:0xf
 v_mov_b32_dpp v89, v23 row_shl:9 row_mask:0xf bank_mask:0xf
 v_mov_b32_dpp v90, v24 row_shl:9 row_mask:0xf bank_mask:0xf
 v_mov_b32_dpp v91, v25 row_shl:9 row_mask:0xf bank_mask:0xf
 s_mov_b64 exec, s[92:93]
 v_mov_b32 v84, v68
 v_mov_b32 v85, v69
 v_add_f32 v80, v88, v90
 v_sub_f32 v83, v89, v91
 v_mul_f32 v86, v78, v80
 v_mul_f32 v87, v79, v80
 v_fma_f32 v86, v79, v83, v86
 v_fma_f32 v87, -v78, v83, v87
 v_mul_f32 v86, 0.5, v86
 v_mul_f32 v87, 0.5, v87
 s_mov_b64 exec, -1
 v_mul_f32 v84, s86, v84
 v_mul_f32 v85, s86, v85
 v_mul_f32 v86, s86, v86
 v_mul_f32 v87, s86, v87
 v_cvt_pk_bf16_f32 v93, v84, v85
 v_cvt_pk_bf16_f32 v101, v86, v87
 v_accvgpr_read_b32 v76, a132
 v_accvgpr_read_b32 v77, a133
 v_accvgpr_read_b32 v78, a148
 v_accvgpr_read_b32 v79, a149
 v_lshlrev_b32 v88, 16, v176
 v_and_b32 v89, 0xffff0000, v176
 v_lshlrev_b32 v90, 16, v177
 v_and_b32 v91, 0xffff0000, v177
 v_add_f32 v80, v88, v90
 v_sub_f32 v81, v88, v90
 v_add_f32 v82, v89, v91
 v_sub_f32 v83, v89, v91
 v_pk_mul_f32 v[84:85], v[76:77], v[80:81] op_sel_hi:[1,0]
 v_pk_mul_f32 v[86:87], v[78:79], v[80:81] op_sel_hi:[1,0]
 v_pk_fma_f32 v[84:85], v[76:77], v[82:83], v[84:85] op_sel:[1,1,0] op_sel_hi:[0,1,1] neg_hi:[1,0,0]
 v_pk_fma_f32 v[86:87], v[78:79], v[82:83], v[86:87] op_sel:[1,1,0] op_sel_hi:[0,1,1] neg_hi:[1,0,0]
 v_mul_f32 v68, 0.5, v84
 v_mul_f32 v69, 0.5, v85
 v_pk_fma_f32 v[84:85], v[78:79], v[80:81], v[84:85] op_sel:[1,1,0] op_sel_hi:[0,1,1] neg_lo:[1,0,0]
 v_pk_fma_f32 v[86:87], v[76:77], v[80:81], v[86:87] op_sel:[1,1,0] op_sel_hi:[0,1,1] neg_hi:[1,0,0]
 v_pk_fma_f32 v[84:85], v[78:79], v[82:83], v[84:85] op_sel_hi:[1,0,1]
 v_pk_fma_f32 v[86:87], v[76:77], v[82:83], v[86:87] op_sel_hi:[1,0,1] neg_lo:[1,0,0] neg_hi:[1,0,0]
 v_mov_b32_dpp v88, v22 row_shl:10 row_mask:0xf bank_mask:0xf
 v_mov_b32_dpp v89, v23 row_shl:10 row_mask:0xf bank_mask:0xf
 v_mov_b32_dpp v90, v24 row_shl:10 row_mask:0xf bank_mask:0xf
 v_mov_b32_dpp v91, v25 row_shl:10 row_mask:0xf bank_mask:0xf
 s_mov_b64 exec, s[92:93]
 v_mov_b32 v84, v68
 v_mov_b32 v85, v69
 v_add_f32 v80, v88, v90
 v_sub_f32 v83, v89, v91
 v_mul_f32 v86, v78, v80
 v_mul_f32 v87, v79, v80
 v_fma_f32 v86, v79, v83, v86
 v_fma_f32 v87, -v78, v83, v87
 v_mul_f32 v86, 0.5, v86
 v_mul_f32 v87, 0.5, v87
 s_mov_b64 exec, -1
 v_mul_f32 v84, s86, v84
 v_mul_f32 v85, s86, v85
 v_mul_f32 v86, s86, v86
 v_mul_f32 v87, s86, v87
 v_cvt_pk_bf16_f32 v94, v84, v85
 v_cvt_pk_bf16_f32 v102, v86, v87
 v_accvgpr_read_b32 v76, a134
 v_accvgpr_read_b32 v77, a135
 v_accvgpr_read_b32 v78, a150
 v_accvgpr_read_b32 v79, a151
 v_lshlrev_b32 v88, 16, v178
 v_and_b32 v89, 0xffff0000, v178
 v_lshlrev_b32 v90, 16, v179
 v_and_b32 v91, 0xffff0000, v179
 v_add_f32 v80, v88, v90
 v_sub_f32 v81, v88, v90
 v_add_f32 v82, v89, v91
 v_sub_f32 v83, v89, v91
 v_pk_mul_f32 v[84:85], v[76:77], v[80:81] op_sel_hi:[1,0]
 v_pk_mul_f32 v[86:87], v[78:79], v[80:81] op_sel_hi:[1,0]
 v_pk_fma_f32 v[84:85], v[76:77], v[82:83], v[84:85] op_sel:[1,1,0] op_sel_hi:[0,1,1] neg_hi:[1,0,0]
 v_pk_fma_f32 v[86:87], v[78:79], v[82:83], v[86:87] op_sel:[1,1,0] op_sel_hi:[0,1,1] neg_hi:[1,0,0]
 v_mul_f32 v68, 0.5, v84
 v_mul_f32 v69, 0.5, v85
 v_pk_fma_f32 v[84:85], v[78:79], v[80:81], v[84:85] op_sel:[1,1,0] op_sel_hi:[0,1,1] neg_lo:[1,0,0]
 v_pk_fma_f32 v[86:87], v[76:77], v[80:81], v[86:87] op_sel:[1,1,0] op_sel_hi:[0,1,1] neg_hi:[1,0,0]
 v_pk_fma_f32 v[84:85], v[78:79], v[82:83], v[84:85] op_sel_hi:[1,0,1]
 v_pk_fma_f32 v[86:87], v[76:77], v[82:83], v[86:87] op_sel_hi:[1,0,1] neg_lo:[1,0,0] neg_hi:[1,0,0]
 v_mov_b32_dpp v88, v22 row_shl:11 row_mask:0xf bank_mask:0xf
 v_mov_b32_dpp v89, v23 row_shl:11 row_mask:0xf bank_mask:0xf
 v_mov_b32_dpp v90, v24 row_shl:11 row_mask:0xf bank_mask:0xf
 v_mov_b32_dpp v91, v25 row_shl:11 row_mask:0xf bank_mask:0xf
 s_mov_b64 exec, s[92:93]
 v_mov_b32 v84, v68
 v_mov_b32 v85, v69
 v_add_f32 v80, v88, v90
 v_sub_f32 v83, v89, v91
 v_mul_f32 v86, v78, v80
 v_mul_f32 v87, v79, v80
 v_fma_f32 v86, v79, v83, v86
 v_fma_f32 v87, -v78, v83, v87
 v_mul_f32 v86, 0.5, v86
 v_mul_f32 v87, 0.5, v87
 s_mov_b64 exec, -1
 v_mul_f32 v84, s86, v84
 v_mul_f32 v85, s86, v85
 v_mul_f32 v86, s86, v86
 v_mul_f32 v87, s86, v87
 v_cvt_pk_bf16_f32 v95, v84, v85
 v_cvt_pk_bf16_f32 v103, v86, v87
 v_accvgpr_read_b32 v76, a136
 v_accvgpr_read_b32 v77, a137
 v_accvgpr_read_b32 v78, a152
 v_accvgpr_read_b32 v79, a153
 v_lshlrev_b32 v88, 16, v180
 v_and_b32 v89, 0xffff0000, v180
 v_lshlrev_b32 v90, 16, v181
 v_and_b32 v91, 0xffff0000, v181
 v_add_f32 v80, v88, v90
 v_sub_f32 v81, v88, v90
 v_add_f32 v82, v89, v91
 v_sub_f32 v83, v89, v91
 v_pk_mul_f32 v[84:85], v[76:77], v[80:81] op_sel_hi:[1,0]
 v_pk_mul_f32 v[86:87], v[78:79], v[80:81] op_sel_hi:[1,0]
 v_pk_fma_f32 v[84:85], v[76:77], v[82:83], v[84:85] op_sel:[1,1,0] op_sel_hi:[0,1,1] neg_hi:[1,0,0]
 v_pk_fma_f32 v[86:87], v[78:79], v[82:83], v[86:87] op_sel:[1,1,0] op_sel_hi:[0,1,1] neg_hi:[1,0,0]
 v_mul_f32 v68, 0.5, v84
 v_mul_f32 v69, 0.5, v85
 v_pk_fma_f32 v[84:85], v[78:79], v[80:81], v[84:85] op_sel:[1,1,0] op_sel_hi:[0,1,1] neg_lo:[1,0,0]
 v_pk_fma_f32 v[86:87], v[76:77], v[80:81], v[86:87] op_sel:[1,1,0] op_sel_hi:[0,1,1] neg_hi:[1,0,0]
 v_pk_fma_f32 v[84:85], v[78:79], v[82:83], v[84:85] op_sel_hi:[1,0,1]
 v_pk_fma_f32 v[86:87], v[76:77], v[82:83], v[86:87] op_sel_hi:[1,0,1] neg_lo:[1,0,0] neg_hi:[1,0,0]
 v_mov_b32_dpp v88, v22 row_shl:12 row_mask:0xf bank_mask:0xf
 v_mov_b32_dpp v89, v23 row_shl:12 row_mask:0xf bank_mask:0xf
 v_mov_b32_dpp v90, v24 row_shl:12 row_mask:0xf bank_mask:0xf
 v_mov_b32_dpp v91, v25 row_shl:12 row_mask:0xf bank_mask:0xf
 s_mov_b64 exec, s[92:93]
 v_mov_b32 v84, v68
 v_mov_b32 v85, v69
 v_add_f32 v80, v88, v90
 v_sub_f32 v83, v89, v91
 v_mul_f32 v86, v78, v80
 v_mul_f32 v87, v79, v80
 v_fma_f32 v86, v79, v83, v86
 v_fma_f32 v87, -v78, v83, v87
 v_mul_f32 v86, 0.5, v86
 v_mul_f32 v87, 0.5, v87
 s_mov_b64 exec, -1
 v_mul_f32 v84, s86, v84
 v_mul_f32 v85, s86, v85
 v_mul_f32 v86, s86, v86
 v_mul_f32 v87, s86, v87
 v_cvt_pk_bf16_f32 v96, v84, v85
 v_cvt_pk_bf16_f32 v104, v86, v87
 v_accvgpr_read_b32 v76, a138
 v_accvgpr_read_b32 v77, a139
 v_accvgpr_read_b32 v78, a154
 v_accvgpr_read_b32 v79, a155
 v_lshlrev_b32 v88, 16, v182
 v_and_b32 v89, 0xffff0000, v182
 v_lshlrev_b32 v90, 16, v183
 v_and_b32 v91, 0xffff0000, v183
 v_add_f32 v80, v88, v90
 v_sub_f32 v81, v88, v90
 v_add_f32 v82, v89, v91
 v_sub_f32 v83, v89, v91
 v_pk_mul_f32 v[84:85], v[76:77], v[80:81] op_sel_hi:[1,0]
 v_pk_mul_f32 v[86:87], v[78:79], v[80:81] op_sel_hi:[1,0]
 v_pk_fma_f32 v[84:85], v[76:77], v[82:83], v[84:85] op_sel:[1,1,0] op_sel_hi:[0,1,1] neg_hi:[1,0,0]
 v_pk_fma_f32 v[86:87], v[78:79], v[82:83], v[86:87] op_sel:[1,1,0] op_sel_hi:[0,1,1] neg_hi:[1,0,0]
 v_mul_f32 v68, 0.5, v84
 v_mul_f32 v69, 0.5, v85
 v_pk_fma_f32 v[84:85], v[78:79], v[80:81], v[84:85] op_sel:[1,1,0] op_sel_hi:[0,1,1] neg_lo:[1,0,0]
 v_pk_fma_f32 v[86:87], v[76:77], v[80:81], v[86:87] op_sel:[1,1,0] op_sel_hi:[0,1,1] neg_hi:[1,0,0]
 v_pk_fma_f32 v[84:85], v[78:79], v[82:83], v[84:85] op_sel_hi:[1,0,1]
 v_pk_fma_f32 v[86:87], v[76:77], v[82:83], v[86:87] op_sel_hi:[1,0,1] neg_lo:[1,0,0] neg_hi:[1,0,0]
 v_mov_b32_dpp v88, v22 row_shl:13 row_mask:0xf bank_mask:0xf
 v_mov_b32_dpp v89, v23 row_shl:13 row_mask:0xf bank_mask:0xf
 v_mov_b32_dpp v90, v24 row_shl:13 row_mask:0xf bank_mask:0xf
 v_mov_b32_dpp v91, v25 row_shl:13 row_mask:0xf bank_mask:0xf
 s_mov_b64 exec, s[92:93]
 v_mov_b32 v84, v68
 v_mov_b32 v85, v69
 v_add_f32 v80, v88, v90
 v_sub_f32 v83, v89, v91
 v_mul_f32 v86, v78, v80
 v_mul_f32 v87, v79, v80
 v_fma_f32 v86, v79, v83, v86
 v_fma_f32 v87, -v78, v83, v87
 v_mul_f32 v86, 0.5, v86
 v_mul_f32 v87, 0.5, v87
 s_mov_b64 exec, -1
 v_mul_f32 v84, s86, v84
 v_mul_f32 v85, s86, v85
 v_mul_f32 v86, s86, v86
 v_mul_f32 v87, s86, v87
 v_cvt_pk_bf16_f32 v97, v84, v85
 v_cvt_pk_bf16_f32 v105, v86, v87
 v_accvgpr_read_b32 v76, a140
 v_accvgpr_read_b32 v77, a141
 v_accvgpr_read_b32 v78, a156
 v_accvgpr_read_b32 v79, a157
 v_lshlrev_b32 v88, 16, v184
 v_and_b32 v89, 0xffff0000, v184
 v_lshlrev_b32 v90, 16, v185
 v_and_b32 v91, 0xffff0000, v185
 v_add_f32 v80, v88, v90
 v_sub_f32 v81, v88, v90
 v_add_f32 v82, v89, v91
 v_sub_f32 v83, v89, v91
 v_pk_mul_f32 v[84:85], v[76:77], v[80:81] op_sel_hi:[1,0]
 v_pk_mul_f32 v[86:87], v[78:79], v[80:81] op_sel_hi:[1,0]
 v_pk_fma_f32 v[84:85], v[76:77], v[82:83], v[84:85] op_sel:[1,1,0] op_sel_hi:[0,1,1] neg_hi:[1,0,0]
 v_pk_fma_f32 v[86:87], v[78:79], v[82:83], v[86:87] op_sel:[1,1,0] op_sel_hi:[0,1,1] neg_hi:[1,0,0]
 v_mul_f32 v68, 0.5, v84
 v_mul_f32 v69, 0.5, v85
 v_pk_fma_f32 v[84:85], v[78:79], v[80:81], v[84:85] op_sel:[1,1,0] op_sel_hi:[0,1,1] neg_lo:[1,0,0]
 v_pk_fma_f32 v[86:87], v[76:77], v[80:81], v[86:87] op_sel:[1,1,0] op_sel_hi:[0,1,1] neg_hi:[1,0,0]
 v_pk_fma_f32 v[84:85], v[78:79], v[82:83], v[84:85] op_sel_hi:[1,0,1]
 v_pk_fma_f32 v[86:87], v[76:77], v[82:83], v[86:87] op_sel_hi:[1,0,1] neg_lo:[1,0,0] neg_hi:[1,0,0]
 v_mov_b32_dpp v88, v22 row_shl:14 row_mask:0xf bank_mask:0xf
 v_mov_b32_dpp v89, v23 row_shl:14 row_mask:0xf bank_mask:0xf
 v_mov_b32_dpp v90, v24 row_shl:14 row_mask:0xf bank_mask:0xf
 v_mov_b32_dpp v91, v25 row_shl:14 row_mask:0xf bank_mask:0xf
 s_mov_b64 exec, s[92:93]
 v_mov_b32 v84, v68
 v_mov_b32 v85, v69
 v_add_f32 v80, v88, v90
 v_sub_f32 v83, v89, v91
 v_mul_f32 v86, v78, v80
 v_mul_f32 v87, v79, v80
 v_fma_f32 v86, v79, v83, v86
 v_fma_f32 v87, -v78, v83, v87
 v_mul_f32 v86, 0.5, v86
 v_mul_f32 v87, 0.5, v87
 s_mov_b64 exec, -1
 v_mul_f32 v84, s86, v84
 v_mul_f32 v85, s86, v85
 v_mul_f32 v86, s86, v86
 v_mul_f32 v87, s86, v87
 v_cvt_pk_bf16_f32 v98, v84, v85
 v_cvt_pk_bf16_f32 v106, v86, v87
 v_accvgpr_read_b32 v76, a142
 v_accvgpr_read_b32 v77, a143
 v_accvgpr_read_b32 v78, a158
 v_accvgpr_read_b32 v79, a159
 v_lshlrev_b32 v88, 16, v186
 v_and_b32 v89, 0xffff0000, v186
 v_lshlrev_b32 v90, 16, v187
 v_and_b32 v91, 0xffff0000, v187
 v_add_f32 v80, v88, v90
 v_sub_f32 v81, v88, v90
 v_add_f32 v82, v89, v91
 v_sub_f32 v83, v89, v91
 v_pk_mul_f32 v[84:85], v[76:77], v[80:81] op_sel_hi:[1,0]
 v_pk_mul_f32 v[86:87], v[78:79], v[80:81] op_sel_hi:[1,0]
 v_pk_fma_f32 v[84:85], v[76:77], v[82:83], v[84:85] op_sel:[1,1,0] op_sel_hi:[0,1,1] neg_hi:[1,0,0]
 v_pk_fma_f32 v[86:87], v[78:79], v[82:83], v[86:87] op_sel:[1,1,0] op_sel_hi:[0,1,1] neg_hi:[1,0,0]
 v_mul_f32 v68, 0.5, v84
 v_mul_f32 v69, 0.5, v85
 v_pk_fma_f32 v[84:85], v[78:79], v[80:81], v[84:85] op_sel:[1,1,0] op_sel_hi:[0,1,1] neg_lo:[1,0,0]
 v_pk_fma_f32 v[86:87], v[76:77], v[80:81], v[86:87] op_sel:[1,1,0] op_sel_hi:[0,1,1] neg_hi:[1,0,0]
 v_pk_fma_f32 v[84:85], v[78:79], v[82:83], v[84:85] op_sel_hi:[1,0,1]
 v_pk_fma_f32 v[86:87], v[76:77], v[82:83], v[86:87] op_sel_hi:[1,0,1] neg_lo:[1,0,0] neg_hi:[1,0,0]
 v_mov_b32_dpp v88, v22 row_shl:15 row_mask:0xf bank_mask:0xf
 v_mov_b32_dpp v89, v23 row_shl:15 row_mask:0xf bank_mask:0xf
 v_mov_b32_dpp v90, v24 row_shl:15 row_mask:0xf bank_mask:0xf
 v_mov_b32_dpp v91, v25 row_shl:15 row_mask:0xf bank_mask:0xf
 s_mov_b64 exec, s[92:93]
 v_mov_b32 v84, v68
 v_mov_b32 v85, v69
 v_add_f32 v80, v88, v90
 v_sub_f32 v83, v89, v91
 v_mul_f32 v86, v78, v80
 v_mul_f32 v87, v79, v80
 v_fma_f32 v86, v79, v83, v86
 v_fma_f32 v87, -v78, v83, v87
 v_mul_f32 v86, 0.5, v86
 v_mul_f32 v87, 0.5, v87
 s_mov_b64 exec, -1
 v_mul_f32 v84, s86, v84
 v_mul_f32 v85, s86, v85
 v_mul_f32 v86, s86, v86
 v_mul_f32 v87, s86, v87
 v_cvt_pk_bf16_f32 v99, v84, v85
 v_cvt_pk_bf16_f32 v107, v86, v87
 ds_write_b128 v62, v[92:95] offset:0
 ds_write_b128 v62, v[100:103] offset:512
 ds_write_b128 v63, v[96:99] offset:0
 ds_write_b128 v63, v[104:107] offset:512
 v_accvgpr_read_b32 v76, a32
 v_accvgpr_read_b32 v77, a33
 v_accvgpr_read_b32 v78, a48
 v_accvgpr_read_b32 v79, a49
 v_lshlrev_b32 v88, 16, v124
 v_and_b32 v89, 0xffff0000, v124
 v_lshlrev_b32 v90, 16, v125
 v_and_b32 v91, 0xffff0000, v125
 v_add_f32 v80, v88, v90
 v_sub_f32 v81, v88, v90
 v_add_f32 v82, v89, v91
 v_sub_f32 v83, v89, v91
 v_pk_mul_f32 v[84:85], v[76:77], v[80:81] op_sel_hi:[1,0]
 v_pk_mul_f32 v[86:87], v[78:79], v[80:81] op_sel_hi:[1,0]
 v_pk_fma_f32 v[84:85], v[76:77], v[82:83], v[84:85] op_sel:[1,1,0] op_sel_hi:[0,1,1] neg_hi:[1,0,0]
 v_pk_fma_f32 v[86:87], v[78:79], v[82:83], v[86:87] op_sel:[1,1,0] op_sel_hi:[0,1,1] neg_hi:[1,0,0]
 v_pk_fma_f32 v[84:85], v[78:79], v[80:81], v[84:85] op_sel:[1,1,0] op_sel_hi:[0,1,1] neg_lo:[1,0,0]
 v_pk_fma_f32 v[86:87], v[76:77], v[80:81], v[86:87] op_sel:[1,1,0] op_sel_hi:[0,1,1] neg_hi:[1,0,0]
 v_pk_fma_f32 v[84:85], v[78:79], v[82:83], v[84:85] op_sel_hi:[1,0,1]
 v_pk_fma_f32 v[86:87], v[76:77], v[82:83], v[86:87] op_sel_hi:[1,0,1] neg_lo:[1,0,0] neg_hi:[1,0,0]
 s_mov_b64 exec, s[90:91]
 v_mul_f32 v84, v76, v88
 v_mul_f32 v85, v77, v90
 v_fma_f32 v84, v78, v89, v84
 v_fma_f32 v85, v79, v91, v85
 v_mul_f32 v86, v78, v88
 v_fma_f32 v86, -v76, v89, v86
 v_mul_f32 v87, v79, v90
 v_fma_f32 v87, -v77, v91, v87
 s_mov_b64 exec, -1
 v_mul_f32 v84, s86, v84
 v_mul_f32 v85, s86, v85
 v_mul_f32 v86, s86, v86
 v_mul_f32 v87, s86, v87
 v_cvt_pk_bf16_f32 v92, v84, v85
 v_cvt_pk_bf16_f32 v100, v86, v87
 v_accvgpr_read_b32 v76, a34
 v_accvgpr_read_b32 v77, a35
 v_accvgpr_read_b32 v78, a50
 v_accvgpr_read_b32 v79, a51
 v_lshlrev_b32 v88, 16, v126
 v_and_b32 v89, 0xffff0000, v126
 v_lshlrev_b32 v90, 16, v127
 v_and_b32 v91, 0xffff0000, v127
 v_add_f32 v80, v88, v90
 v_sub_f32 v81, v88, v90
 v_add_f32 v82, v89, v91
 v_sub_f32 v83, v89, v91
 v_pk_mul_f32 v[84:85], v[76:77], v[80:81] op_sel_hi:[1,0]
 v_pk_mul_f32 v[86:87], v[78:79], v[80:81] op_sel_hi:[1,0]
 v_pk_fma_f32 v[84:85], v[76:77], v[82:83], v[84:85] op_sel:[1,1,0] op_sel_hi:[0,1,1] neg_hi:[1,0,0]
 v_pk_fma_f32 v[86:87], v[78:79], v[82:83], v[86:87] op_sel:[1,1,0] op_sel_hi:[0,1,1] neg_hi:[1,0,0]
 v_pk_fma_f32 v[84:85], v[78:79], v[80:81], v[84:85] op_sel:[1,1,0] op_sel_hi:[0,1,1] neg_lo:[1,0,0]
 v_pk_fma_f32 v[86:87], v[76:77], v[80:81], v[86:87] op_sel:[1,1,0] op_sel_hi:[0,1,1] neg_hi:[1,0,0]
 v_pk_fma_f32 v[84:85], v[78:79], v[82:83], v[84:85] op_sel_hi:[1,0,1]
 v_pk_fma_f32 v[86:87], v[76:77], v[82:83], v[86:87] op_sel_hi:[1,0,1] neg_lo:[1,0,0] neg_hi:[1,0,0]
 v_mul_f32 v84, s86, v84
 v_mul_f32 v85, s86, v85
 v_mul_f32 v86, s86, v86
 v_mul_f32 v87, s86, v87
 v_cvt_pk_bf16_f32 v93, v84, v85
 v_cvt_pk_bf16_f32 v101, v86, v87
 v_accvgpr_read_b32 v76, a36
 v_accvgpr_read_b32 v77, a37
 v_accvgpr_read_b32 v78, a52
 v_accvgpr_read_b32 v79, a53
 v_lshlrev_b32 v88, 16, v128
 v_and_b32 v89, 0xffff0000, v128
 v_lshlrev_b32 v90, 16, v129
 v_and_b32 v91, 0xffff0000, v129
 v_add_f32 v80, v88, v90
 v_sub_f32 v81, v88, v90
 v_add_f32 v82, v89, v91
 v_sub_f32 v83, v89, v91
 v_pk_mul_f32 v[84:85], v[76:77], v[80:81] op_sel_hi:[1,0]
 v_pk_mul_f32 v[86:87], v[78:79], v[80:81] op_sel_hi:[1,0]
 v_pk_fma_f32 v[84:85], v[76:77], v[82:83], v[84:85] op_sel:[1,1,0] op_sel_hi:[0,1,1] neg_hi:[1,0,0]
 v_pk_fma_f32 v[86:87], v[78:79], v[82:83], v[86:87] op_sel:[1,1,0] op_sel_hi:[0,1,1] neg_hi:[1,0,0]
 v_pk_fma_f32 v[84:85], v[78:79], v[80:81], v[84:85] op_sel:[1,1,0] op_sel_hi:[0,1,1] neg_lo:[1,0,0]
 v_pk_fma_f32 v[86:87], v[76:77], v[80:81], v[86:87] op_sel:[1,1,0] op_sel_hi:[0,1,1] neg_hi:[1,0,0]
 v_pk_fma_f32 v[84:85], v[78:79], v[82:83], v[84:85] op_sel_hi:[1,0,1]
 v_pk_fma_f32 v[86:87], v[76:77], v[82:83], v[86:87] op_sel_hi:[1,0,1] neg_lo:[1,0,0] neg_hi:[1,0,0]
 v_mul_f32 v84, s86, v84
 v_mul_f32 v85, s86, v85
 v_mul_f32 v86, s86, v86
 v_mul_f32 v87, s86, v87
 v_cvt_pk_bf16_f32 v94, v84, v85
 v_cvt_pk_bf16_f32 v102, v86, v87
 v_accvgpr_read_b32 v76, a38
 v_accvgpr_read_b32 v77, a39
 v_accvgpr_read_b32 v78, a54
 v_accvgpr_read_b32 v79, a55
 v_lshlrev_b32 v88, 16, v130
 v_and_b32 v89, 0xffff0000, v130
 v_lshlrev_b32 v90, 16, v131
 v_and_b32 v91, 0xffff0000, v131
 v_add_f32 v80, v88, v90
 v_sub_f32 v81, v88, v90
 v_add_f32 v82, v89, v91
 v_sub_f32 v83, v89, v91
 v_pk_mul_f32 v[84:85], v[76:77], v[80:81] op_sel_hi:[1,0]
 v_pk_mul_f32 v[86:87], v[78:79], v[80:81] op_sel_hi:[1,0]
 v_pk_fma_f32 v[84:85], v[76:77], v[82:83], v[84:85] op_sel:[1,1,0] op_sel_hi:[0,1,1] neg_hi:[1,0,0]
 v_pk_fma_f32 v[86:87], v[78:79], v[82:83], v[86:87] op_sel:[1,1,0] op_sel_hi:[0,1,1] neg_hi:[1,0,0]
 v_pk_fma_f32 v[84:85], v[78:79], v[80:81], v[84:85] op_sel:[1,1,0] op_sel_hi:[0,1,1] neg_lo:[1,0,0]
 v_pk_fma_f32 v[86:87], v[76:77], v[80:81], v[86:87] op_sel:[1,1,0] op_sel_hi:[0,1,1] neg_hi:[1,0,0]
 v_pk_fma_f32 v[84:85], v[78:79], v[82:83], v[84:85] op_sel_hi:[1,0,1]
 v_pk_fma_f32 v[86:87], v[76:77], v[82:83], v[86:87] op_sel_hi:[1,0,1] neg_lo:[1,0,0] neg_hi:[1,0,0]
 v_mul_f32 v84, s86, v84
 v_mul_f32 v85, s86, v85
 v_mul_f32 v86, s86, v86
 v_mul_f32 v87, s86, v87
 v_cvt_pk_bf16_f32 v95, v84, v85
 v_cvt_pk_bf16_f32 v103, v86, v87
 v_accvgpr_read_b32 v76, a40
 v_accvgpr_read_b32 v77, a41
 v_accvgpr_read_b32 v78, a56
 v_accvgpr_read_b32 v79, a57
 v_lshlrev_b32 v88, 16, v132
 v_and_b32 v89, 0xffff0000, v132
 v_lshlrev_b32 v90, 16, v133
 v_and_b32 v91, 0xffff0000, v133
 v_add_f32 v80, v88, v90
 v_sub_f32 v81, v88, v90
 v_add_f32 v82, v89, v91
 v_sub_f32 v83, v89, v91
 v_pk_mul_f32 v[84:85], v[76:77], v[80:81] op_sel_hi:[1,0]
 v_pk_mul_f32 v[86:87], v[78:79], v[80:81] op_sel_hi:[1,0]
 v_pk_fma_f32 v[84:85], v[76:77], v[82:83], v[84:85] op_sel:[1,1,0] op_sel_hi:[0,1,1] neg_hi:[1,0,0]
 v_pk_fma_f32 v[86:87], v[78:79], v[82:83], v[86:87] op_sel:[1,1,0] op_sel_hi:[0,1,1] neg_hi:[1,0,0]
 v_pk_fma_f32 v[84:85], v[78:79], v[80:81], v[84:85] op_sel:[1,1,0] op_sel_hi:[0,1,1] neg_lo:[1,0,0]
 v_pk_fma_f32 v[86:87], v[76:77], v[80:81], v[86:87] op_sel:[1,1,0] op_sel_hi:[0,1,1] neg_hi:[1,0,0]
 v_pk_fma_f32 v[84:85], v[78:79], v[82:83], v[84:85] op_sel_hi:[1,0,1]
 v_pk_fma_f32 v[86:87], v[76:77], v[82:83], v[86:87] op_sel_hi:[1,0,1] neg_lo:[1,0,0] neg_hi:[1,0,0]
 v_mul_f32 v84, s86, v84
 v_mul_f32 v85, s86, v85
 v_mul_f32 v86, s86, v86
 v_mul_f32 v87, s86, v87
 v_cvt_pk_bf16_f32 v96, v84, v85
 v_cvt_pk_bf16_f32 v104, v86, v87
 v_accvgpr_read_b32 v76, a42
 v_accvgpr_read_b32 v77, a43
 v_accvgpr_read_b32 v78, a58
 v_accvgpr_read_b32 v79, a59
 v_lshlrev_b32 v88, 16, v134
 v_and_b32 v89, 0xffff0000, v134
 v_lshlrev_b32 v90, 16, v135
 v_and_b32 v91, 0xffff0000, v135
 v_add_f32 v80, v88, v90
 v_sub_f32 v81, v88, v90
 v_add_f32 v82, v89, v91
 v_sub_f32 v83, v89, v91
 v_pk_mul_f32 v[84:85], v[76:77], v[80:81] op_sel_hi:[1,0]
 v_pk_mul_f32 v[86:87], v[78:79], v[80:81] op_sel_hi:[1,0]
 v_pk_fma_f32 v[84:85], v[76:77], v[82:83], v[84:85] op_sel:[1,1,0] op_sel_hi:[0,1,1] neg_hi:[1,0,0]
 v_pk_fma_f32 v[86:87], v[78:79], v[82:83], v[86:87] op_sel:[1,1,0] op_sel_hi:[0,1,1] neg_hi:[1,0,0]
 v_pk_fma_f32 v[84:85], v[78:79], v[80:81], v[84:85] op_sel:[1,1,0] op_sel_hi:[0,1,1] neg_lo:[1,0,0]
 v_pk_fma_f32 v[86:87], v[76:77], v[80:81], v[86:87] op_sel:[1,1,0] op_sel_hi:[0,1,1] neg_hi:[1,0,0]
 v_pk_fma_f32 v[84:85], v[78:79], v[82:83], v[84:85] op_sel_hi:[1,0,1]
 v_pk_fma_f32 v[86:87], v[76:77], v[82:83], v[86:87] op_sel_hi:[1,0,1] neg_lo:[1,0,0] neg_hi:[1,0,0]
 v_mul_f32 v84, s86, v84
 v_mul_f32 v85, s86, v85
 v_mul_f32 v86, s86, v86
 v_mul_f32 v87, s86, v87
 v_cvt_pk_bf16_f32 v97, v84, v85
 v_cvt_pk_bf16_f32 v105, v86, v87
 v_accvgpr_read_b32 v76, a44
 v_accvgpr_read_b32 v77, a45
 v_accvgpr_read_b32 v78, a60
 v_accvgpr_read_b32 v79, a61
 v_lshlrev_b32 v88, 16, v136
 v_and_b32 v89, 0xffff0000, v136
 v_lshlrev_b32 v90, 16, v137
 v_and_b32 v91, 0xffff0000, v137
 v_add_f32 v80, v88, v90
 v_sub_f32 v81, v88, v90
 v_add_f32 v82, v89, v91
 v_sub_f32 v83, v89, v91
 v_pk_mul_f32 v[84:85], v[76:77], v[80:81] op_sel_hi:[1,0]
 v_pk_mul_f32 v[86:87], v[78:79], v[80:81] op_sel_hi:[1,0]
 v_pk_fma_f32 v[84:85], v[76:77], v[82:83], v[84:85] op_sel:[1,1,0] op_sel_hi:[0,1,1] neg_hi:[1,0,0]
 v_pk_fma_f32 v[86:87], v[78:79], v[82:83], v[86:87] op_sel:[1,1,0] op_sel_hi:[0,1,1] neg_hi:[1,0,0]
 v_pk_fma_f32 v[84:85], v[78:79], v[80:81], v[84:85] op_sel:[1,1,0] op_sel_hi:[0,1,1] neg_lo:[1,0,0]
 v_pk_fma_f32 v[86:87], v[76:77], v[80:81], v[86:87] op_sel:[1,1,0] op_sel_hi:[0,1,1] neg_hi:[1,0,0]
 v_pk_fma_f32 v[84:85], v[78:79], v[82:83], v[84:85] op_sel_hi:[1,0,1]
 v_pk_fma_f32 v[86:87], v[76:77], v[82:83], v[86:87] op_sel_hi:[1,0,1] neg_lo:[1,0,0] neg_hi:[1,0,0]
 v_mul_f32 v84, s86, v84
 v_mul_f32 v85, s86, v85
 v_mul_f32 v86, s86, v86
 v_mul_f32 v87, s86, v87
 v_cvt_pk_bf16_f32 v98, v84, v85
 v_cvt_pk_bf16_f32 v106, v86, v87
 v_accvgpr_read_b32 v76, a46
 v_accvgpr_read_b32 v77, a47
 v_accvgpr_read_b32 v78, a62
 v_accvgpr_read_b32 v79, a63
 v_lshlrev_b32 v88, 16, v138
 v_and_b32 v89, 0xffff0000, v138
 v_lshlrev_b32 v90, 16, v139
 v_and_b32 v91, 0xffff0000, v139
 v_add_f32 v80, v88, v90
 v_sub_f32 v81, v88, v90
 v_add_f32 v82, v89, v91
 v_sub_f32 v83, v89, v91
 v_pk_mul_f32 v[84:85], v[76:77], v[80:81] op_sel_hi:[1,0]
 v_pk_mul_f32 v[86:87], v[78:79], v[80:81] op_sel_hi:[1,0]
 v_pk_fma_f32 v[84:85], v[76:77], v[82:83], v[84:85] op_sel:[1,1,0] op_sel_hi:[0,1,1] neg_hi:[1,0,0]
 v_pk_fma_f32 v[86:87], v[78:79], v[82:83], v[86:87] op_sel:[1,1,0] op_sel_hi:[0,1,1] neg_hi:[1,0,0]
 v_pk_fma_f32 v[84:85], v[78:79], v[80:81], v[84:85] op_sel:[1,1,0] op_sel_hi:[0,1,1] neg_lo:[1,0,0]
 v_pk_fma_f32 v[86:87], v[76:77], v[80:81], v[86:87] op_sel:[1,1,0] op_sel_hi:[0,1,1] neg_hi:[1,0,0]
 v_pk_fma_f32 v[84:85], v[78:79], v[82:83], v[84:85] op_sel_hi:[1,0,1]
 v_pk_fma_f32 v[86:87], v[76:77], v[82:83], v[86:87] op_sel_hi:[1,0,1] neg_lo:[1,0,0] neg_hi:[1,0,0]
 v_mul_f32 v84, s86, v84
 v_mul_f32 v85, s86, v85
 v_mul_f32 v86, s86, v86
 v_mul_f32 v87, s86, v87
 v_cvt_pk_bf16_f32 v99, v84, v85
 v_cvt_pk_bf16_f32 v107, v86, v87
 ds_write_b128 v60, v[92:95] offset:1024
 ds_write_b128 v60, v[100:103] offset:1536
 ds_write_b128 v61, v[96:99] offset:1024
 ds_write_b128 v61, v[104:107] offset:1536
 v_accvgpr_read_b32 v76, a160
 v_accvgpr_read_b32 v77, a161
 v_accvgpr_read_b32 v78, a176
 v_accvgpr_read_b32 v79, a177
 v_lshlrev_b32 v88, 16, v188
 v_and_b32 v89, 0xffff0000, v188
 v_lshlrev_b32 v90, 16, v189
 v_and_b32 v91, 0xffff0000, v189
 v_add_f32 v80, v88, v90
 v_sub_f32 v81, v88, v90
 v_add_f32 v82, v89, v91
 v_sub_f32 v83, v89, v91
 v_pk_mul_f32 v[84:85], v[76:77], v[80:81] op_sel_hi:[1,0]
 v_pk_mul_f32 v[86:87], v[78:79], v[80:81] op_sel_hi:[1,0]
 v_pk_fma_f32 v[84:85], v[76:77], v[82:83], v[84:85] op_sel:[1,1,0] op_sel_hi:[0,1,1] neg_hi:[1,0,0]
 v_pk_fma_f32 v[86:87], v[78:79], v[82:83], v[86:87] op_sel:[1,1,0] op_sel_hi:[0,1,1] neg_hi:[1,0,0]
 v_pk_fma_f32 v[84:85], v[78:79], v[80:81], v[84:85] op_sel:[1,1,0] op_sel_hi:[0,1,1] neg_lo:[1,0,0]
 v_pk_fma_f32 v[86:87], v[76:77], v[80:81], v[86:87] op_sel:[1,1,0] op_sel_hi:[0,1,1] neg_hi:[1,0,0]
 v_pk_fma_f32 v[84:85], v[78:79], v[82:83], v[84:85] op_sel_hi:[1,0,1]
 v_pk_fma_f32 v[86:87], v[76:77], v[82:83], v[86:87] op_sel_hi:[1,0,1] neg_lo:[1,0,0] neg_hi:[1,0,0]
 v_mul_f32 v84, s86, v84
 v_mul_f32 v85, s86, v85
 v_mul_f32 v86, s86, v86
 v_mul_f32 v87, s86, v87
 v_cvt_pk_bf16_f32 v92, v84, v85
 v_cvt_pk_bf16_f32 v100, v86, v87
 v_accvgpr_read_b32 v76, a162
 v_accvgpr_read_b32 v77, a163
 v_accvgpr_read_b32 v78, a178
 v_accvgpr_read_b32 v79, a179
 v_lshlrev_b32 v88, 16, v190
 v_and_b32 v89, 0xffff0000, v190
 v_lshlrev_b32 v90, 16, v191
 v_and_b32 v91, 0xffff0000, v191
 v_add_f32 v80, v88, v90
 v_sub_f32 v81, v88, v90
 v_add_f32 v82, v89, v91
 v_sub_f32 v83, v89, v91
 v_pk_mul_f32 v[84:85], v[76:77], v[80:81] op_sel_hi:[1,0]
 v_pk_mul_f32 v[86:87], v[78:79], v[80:81] op_sel_hi:[1,0]
 v_pk_fma_f32 v[84:85], v[76:77], v[82:83], v[84:85] op_sel:[1,1,0] op_sel_hi:[0,1,1] neg_hi:[1,0,0]
 v_pk_fma_f32 v[86:87], v[78:79], v[82:83], v[86:87] op_sel:[1,1,0] op_sel_hi:[0,1,1] neg_hi:[1,0,0]
 v_pk_fma_f32 v[84:85], v[78:79], v[80:81], v[84:85] op_sel:[1,1,0] op_sel_hi:[0,1,1] neg_lo:[1,0,0]
 v_pk_fma_f32 v[86:87], v[76:77], v[80:81], v[86:87] op_sel:[1,1,0] op_sel_hi:[0,1,1] neg_hi:[1,0,0]
 v_pk_fma_f32 v[84:85], v[78:79], v[82:83], v[84:85] op_sel_hi:[1,0,1]
 v_pk_fma_f32 v[86:87], v[76:77], v[82:83], v[86:87] op_sel_hi:[1,0,1] neg_lo:[1,0,0] neg_hi:[1,0,0]
 v_mul_f32 v84, s86, v84
 v_mul_f32 v85, s86, v85
 v_mul_f32 v86, s86, v86
 v_mul_f32 v87, s86, v87
 v_cvt_pk_bf16_f32 v93, v84, v85
 v_cvt_pk_bf16_f32 v101, v86, v87
 v_accvgpr_read_b32 v76, a164
 v_accvgpr_read_b32 v77, a165
 v_accvgpr_read_b32 v78, a180
 v_accvgpr_read_b32 v79, a181
 v_lshlrev_b32 v88, 16, v192
 v_and_b32 v89, 0xffff0000, v192
 v_lshlrev_b32 v90, 16, v193
 v_and_b32 v91, 0xffff0000, v193
 v_add_f32 v80, v88, v90
 v_sub_f32 v81, v88, v90
 v_add_f32 v82, v89, v91
 v_sub_f32 v83, v89, v91
 v_pk_mul_f32 v[84:85], v[76:77], v[80:81] op_sel_hi:[1,0]
 v_pk_mul_f32 v[86:87], v[78:79], v[80:81] op_sel_hi:[1,0]
 v_pk_fma_f32 v[84:85], v[76:77], v[82:83], v[84:85] op_sel:[1,1,0] op_sel_hi:[0,1,1] neg_hi:[1,0,0]
 v_pk_fma_f32 v[86:87], v[78:79], v[82:83], v[86:87] op_sel:[1,1,0] op_sel_hi:[0,1,1] neg_hi:[1,0,0]
 v_pk_fma_f32 v[84:85], v[78:79], v[80:81], v[84:85] op_sel:[1,1,0] op_sel_hi:[0,1,1] neg_lo:[1,0,0]
 v_pk_fma_f32 v[86:87], v[76:77], v[80:81], v[86:87] op_sel:[1,1,0] op_sel_hi:[0,1,1] neg_hi:[1,0,0]
 v_pk_fma_f32 v[84:85], v[78:79], v[82:83], v[84:85] op_sel_hi:[1,0,1]
 v_pk_fma_f32 v[86:87], v[76:77], v[82:83], v[86:87] op_sel_hi:[1,0,1] neg_lo:[1,0,0] neg_hi:[1,0,0]
 v_mul_f32 v84, s86, v84
 v_mul_f32 v85, s86, v85
 v_mul_f32 v86, s86, v86
 v_mul_f32 v87, s86, v87
 v_cvt_pk_bf16_f32 v94, v84, v85
 v_cvt_pk_bf16_f32 v102, v86, v87
 v_accvgpr_read_b32 v76, a166
 v_accvgpr_read_b32 v77, a167
 v_accvgpr_read_b32 v78, a182
 v_accvgpr_read_b32 v79, a183
 v_lshlrev_b32 v88, 16, v194
 v_and_b32 v89, 0xffff0000, v194
 v_lshlrev_b32 v90, 16, v195
 v_and_b32 v91, 0xffff0000, v195
 v_add_f32 v80, v88, v90
 v_sub_f32 v81, v88, v90
 v_add_f32 v82, v89, v91
 v_sub_f32 v83, v89, v91
 v_pk_mul_f32 v[84:85], v[76:77], v[80:81] op_sel_hi:[1,0]
 v_pk_mul_f32 v[86:87], v[78:79], v[80:81] op_sel_hi:[1,0]
 v_pk_fma_f32 v[84:85], v[76:77], v[82:83], v[84:85] op_sel:[1,1,0] op_sel_hi:[0,1,1] neg_hi:[1,0,0]
 v_pk_fma_f32 v[86:87], v[78:79], v[82:83], v[86:87] op_sel:[1,1,0] op_sel_hi:[0,1,1] neg_hi:[1,0,0]
 v_pk_fma_f32 v[84:85], v[78:79], v[80:81], v[84:85] op_sel:[1,1,0] op_sel_hi:[0,1,1] neg_lo:[1,0,0]
 v_pk_fma_f32 v[86:87], v[76:77], v[80:81], v[86:87] op_sel:[1,1,0] op_sel_hi:[0,1,1] neg_hi:[1,0,0]
 v_pk_fma_f32 v[84:85], v[78:79], v[82:83], v[84:85] op_sel_hi:[1,0,1]
 v_pk_fma_f32 v[86:87], v[76:77], v[82:83], v[86:87] op_sel_hi:[1,0,1] neg_lo:[1,0,0] neg_hi:[1,0,0]
 v_mul_f32 v84, s86, v84
 v_mul_f32 v85, s86, v85
 v_mul_f32 v86, s86, v86
 v_mul_f32 v87, s86, v87
 v_cvt_pk_bf16_f32 v95, v84, v85
 v_cvt_pk_bf16_f32 v103, v86, v87
 v_accvgpr_read_b32 v76, a168
 v_accvgpr_read_b32 v77, a169
 v_accvgpr_read_b32 v78, a184
 v_accvgpr_read_b32 v79, a185
 v_lshlrev_b32 v88, 16, v196
 v_and_b32 v89, 0xffff0000, v196
 v_lshlrev_b32 v90, 16, v197
 v_and_b32 v91, 0xffff0000, v197
 v_add_f32 v80, v88, v90
 v_sub_f32 v81, v88, v90
 v_add_f32 v82, v89, v91
 v_sub_f32 v83, v89, v91
 v_pk_mul_f32 v[84:85], v[76:77], v[80:81] op_sel_hi:[1,0]
 v_pk_mul_f32 v[86:87], v[78:79], v[80:81] op_sel_hi:[1,0]
 v_pk_fma_f32 v[84:85], v[76:77], v[82:83], v[84:85] op_sel:[1,1,0] op_sel_hi:[0,1,1] neg_hi:[1,0,0]
 v_pk_fma_f32 v[86:87], v[78:79], v[82:83], v[86:87] op_sel:[1,1,0] op_sel_hi:[0,1,1] neg_hi:[1,0,0]
 v_pk_fma_f32 v[84:85], v[78:79], v[80:81], v[84:85] op_sel:[1,1,0] op_sel_hi:[0,1,1] neg_lo:[1,0,0]
 v_pk_fma_f32 v[86:87], v[76:77], v[80:81], v[86:87] op_sel:[1,1,0] op_sel_hi:[0,1,1] neg_hi:[1,0,0]
 v_pk_fma_f32 v[84:85], v[78:79], v[82:83], v[84:85] op_sel_hi:[1,0,1]
 v_pk_fma_f32 v[86:87], v[76:77], v[82:83], v[86:87] op_sel_hi:[1,0,1] neg_lo:[1,0,0] neg_hi:[1,0,0]
 v_mul_f32 v84, s86, v84
 v_mul_f32 v85, s86, v85
 v_mul_f32 v86, s86, v86
 v_mul_f32 v87, s86, v87
 v_cvt_pk_bf16_f32 v96, v84, v85
 v_cvt_pk_bf16_f32 v104, v86, v87
 v_accvgpr_read_b32 v76, a170
 v_accvgpr_read_b32 v77, a171
 v_accvgpr_read_b32 v78, a186
 v_accvgpr_read_b32 v79, a187
 v_lshlrev_b32 v88, 16, v198
 v_and_b32 v89, 0xffff0000, v198
 v_lshlrev_b32 v90, 16, v199
 v_and_b32 v91, 0xffff0000, v199
 v_add_f32 v80, v88, v90
 v_sub_f32 v81, v88, v90
 v_add_f32 v82, v89, v91
 v_sub_f32 v83, v89, v91
 v_pk_mul_f32 v[84:85], v[76:77], v[80:81] op_sel_hi:[1,0]
 v_pk_mul_f32 v[86:87], v[78:79], v[80:81] op_sel_hi:[1,0]
 v_pk_fma_f32 v[84:85], v[76:77], v[82:83], v[84:85] op_sel:[1,1,0] op_sel_hi:[0,1,1] neg_hi:[1,0,0]
 v_pk_fma_f32 v[86:87], v[78:79], v[82:83], v[86:87] op_sel:[1,1,0] op_sel_hi:[0,1,1] neg_hi:[1,0,0]
 v_pk_fma_f32 v[84:85], v[78:79], v[80:81], v[84:85] op_sel:[1,1,0] op_sel_hi:[0,1,1] neg_lo:[1,0,0]
 v_pk_fma_f32 v[86:87], v[76:77], v[80:81], v[86:87] op_sel:[1,1,0] op_sel_hi:[0,1,1] neg_hi:[1,0,0]
 v_pk_fma_f32 v[84:85], v[78:79], v[82:83], v[84:85] op_sel_hi:[1,0,1]
 v_pk_fma_f32 v[86:87], v[76:77], v[82:83], v[86:87] op_sel_hi:[1,0,1] neg_lo:[1,0,0] neg_hi:[1,0,0]
 v_mul_f32 v84, s86, v84
 v_mul_f32 v85, s86, v85
 v_mul_f32 v86, s86, v86
 v_mul_f32 v87, s86, v87
 v_cvt_pk_bf16_f32 v97, v84, v85
 v_cvt_pk_bf16_f32 v105, v86, v87
 v_accvgpr_read_b32 v76, a172
 v_accvgpr_read_b32 v77, a173
 v_accvgpr_read_b32 v78, a188
 v_accvgpr_read_b32 v79, a189
 v_lshlrev_b32 v88, 16, v200
 v_and_b32 v89, 0xffff0000, v200
 v_lshlrev_b32 v90, 16, v201
 v_and_b32 v91, 0xffff0000, v201
 v_add_f32 v80, v88, v90
 v_sub_f32 v81, v88, v90
 v_add_f32 v82, v89, v91
 v_sub_f32 v83, v89, v91
 v_pk_mul_f32 v[84:85], v[76:77], v[80:81] op_sel_hi:[1,0]
 v_pk_mul_f32 v[86:87], v[78:79], v[80:81] op_sel_hi:[1,0]
 v_pk_fma_f32 v[84:85], v[76:77], v[82:83], v[84:85] op_sel:[1,1,0] op_sel_hi:[0,1,1] neg_hi:[1,0,0]
 v_pk_fma_f32 v[86:87], v[78:79], v[82:83], v[86:87] op_sel:[1,1,0] op_sel_hi:[0,1,1] neg_hi:[1,0,0]
 v_pk_fma_f32 v[84:85], v[78:79], v[80:81], v[84:85] op_sel:[1,1,0] op_sel_hi:[0,1,1] neg_lo:[1,0,0]
 v_pk_fma_f32 v[86:87], v[76:77], v[80:81], v[86:87] op_sel:[1,1,0] op_sel_hi:[0,1,1] neg_hi:[1,0,0]
 v_pk_fma_f32 v[84:85], v[78:79], v[82:83], v[84:85] op_sel_hi:[1,0,1]
 v_pk_fma_f32 v[86:87], v[76:77], v[82:83], v[86:87] op_sel_hi:[1,0,1] neg_lo:[1,0,0] neg_hi:[1,0,0]
 v_mul_f32 v84, s86, v84
 v_mul_f32 v85, s86, v85
 v_mul_f32 v86, s86, v86
 v_mul_f32 v87, s86, v87
 v_cvt_pk_bf16_f32 v98, v84, v85
 v_cvt_pk_bf16_f32 v106, v86, v87
 v_accvgpr_read_b32 v76, a174
 v_accvgpr_read_b32 v77, a175
 v_accvgpr_read_b32 v78, a190
 v_accvgpr_read_b32 v79, a191
 v_lshlrev_b32 v88, 16, v202
 v_and_b32 v89, 0xffff0000, v202
 v_lshlrev_b32 v90, 16, v203
 v_and_b32 v91, 0xffff0000, v203
 v_add_f32 v80, v88, v90
 v_sub_f32 v81, v88, v90
 v_add_f32 v82, v89, v91
 v_sub_f32 v83, v89, v91
 v_pk_mul_f32 v[84:85], v[76:77], v[80:81] op_sel_hi:[1,0]
 v_pk_mul_f32 v[86:87], v[78:79], v[80:81] op_sel_hi:[1,0]
 v_pk_fma_f32 v[84:85], v[76:77], v[82:83], v[84:85] op_sel:[1,1,0] op_sel_hi:[0,1,1] neg_hi:[1,0,0]
 v_pk_fma_f32 v[86:87], v[78:79], v[82:83], v[86:87] op_sel:[1,1,0] op_sel_hi:[0,1,1] neg_hi:[1,0,0]
 v_pk_fma_f32 v[84:85], v[78:79], v[80:81], v[84:85] op_sel:[1,1,0] op_sel_hi:[0,1,1] neg_lo:[1,0,0]
 v_pk_fma_f32 v[86:87], v[76:77], v[80:81], v[86:87] op_sel:[1,1,0] op_sel_hi:[0,1,1] neg_hi:[1,0,0]
 v_pk_fma_f32 v[84:85], v[78:79], v[82:83], v[84:85] op_sel_hi:[1,0,1]
 v_pk_fma_f32 v[86:87], v[76:77], v[82:83], v[86:87] op_sel_hi:[1,0,1] neg_lo:[1,0,0] neg_hi:[1,0,0]
 v_mul_f32 v84, s86, v84
 v_mul_f32 v85, s86, v85
 v_mul_f32 v86, s86, v86
 v_mul_f32 v87, s86, v87
 v_cvt_pk_bf16_f32 v99, v84, v85
 v_cvt_pk_bf16_f32 v107, v86, v87
 ds_write_b128 v62, v[92:95] offset:1024
 ds_write_b128 v62, v[100:103] offset:1536
 ds_write_b128 v63, v[96:99] offset:1024
 ds_write_b128 v63, v[104:107] offset:1536
 v_accvgpr_read_b32 v76, a64
 v_accvgpr_read_b32 v77, a65
 v_accvgpr_read_b32 v78, a80
 v_accvgpr_read_b32 v79, a81
 v_lshlrev_b32 v88, 16, v140
 v_and_b32 v89, 0xffff0000, v140
 v_lshlrev_b32 v90, 16, v141
 v_and_b32 v91, 0xffff0000, v141
 v_add_f32 v80, v88, v90
 v_sub_f32 v81, v88, v90
 v_add_f32 v82, v89, v91
 v_sub_f32 v83, v89, v91
 v_pk_mul_f32 v[84:85], v[76:77], v[80:81] op_sel_hi:[1,0]
 v_pk_mul_f32 v[86:87], v[78:79], v[80:81] op_sel_hi:[1,0]
 v_pk_fma_f32 v[84:85], v[76:77], v[82:83], v[84:85] op_sel:[1,1,0] op_sel_hi:[0,1,1] neg_hi:[1,0,0]
 v_pk_fma_f32 v[86:87], v[78:79], v[82:83], v[86:87] op_sel:[1,1,0] op_sel_hi:[0,1,1] neg_hi:[1,0,0]
 v_pk_fma_f32 v[84:85], v[78:79], v[80:81], v[84:85] op_sel:[1,1,0] op_sel_hi:[0,1,1] neg_lo:[1,0,0]
 v_pk_fma_f32 v[86:87], v[76:77], v[80:81], v[86:87] op_sel:[1,1,0] op_sel_hi:[0,1,1] neg_hi:[1,0,0]
 v_pk_fma_f32 v[84:85], v[78:79], v[82:83], v[84:85] op_sel_hi:[1,0,1]
 v_pk_fma_f32 v[86:87], v[76:77], v[82:83], v[86:87] op_sel_hi:[1,0,1] neg_lo:[1,0,0] neg_hi:[1,0,0]
 s_mov_b64 exec, s[90:91]
 v_mul_f32 v84, v76, v88
 v_mul_f32 v85, v77, v90
 v_fma_f32 v84, v78, v89, v84
 v_fma_f32 v85, v79, v91, v85
 v_mul_f32 v86, v78, v88
 v_fma_f32 v86, -v76, v89, v86
 v_mul_f32 v87, v79, v90
 v_fma_f32 v87, -v77, v91, v87
 s_mov_b64 exec, -1
 v_mul_f32 v84, s86, v84
 v_mul_f32 v85, s86, v85
 v_mul_f32 v86, s86, v86
 v_mul_f32 v87, s86, v87
 v_cvt_pk_bf16_f32 v92, v84, v85
 v_cvt_pk_bf16_f32 v100, v86, v87
 v_accvgpr_read_b32 v76, a66
 v_accvgpr_read_b32 v77, a67
 v_accvgpr_read_b32 v78, a82
 v_accvgpr_read_b32 v79, a83
 v_lshlrev_b32 v88, 16, v142
 v_and_b32 v89, 0xffff0000, v142
 v_lshlrev_b32 v90, 16, v143
 v_and_b32 v91, 0xffff0000, v143
 v_add_f32 v80, v88, v90
 v_sub_f32 v81, v88, v90
 v_add_f32 v82, v89, v91
 v_sub_f32 v83, v89, v91
 v_pk_mul_f32 v[84:85], v[76:77], v[80:81] op_sel_hi:[1,0]
 v_pk_mul_f32 v[86:87], v[78:79], v[80:81] op_sel_hi:[1,0]
 v_pk_fma_f32 v[84:85], v[76:77], v[82:83], v[84:85] op_sel:[1,1,0] op_sel_hi:[0,1,1] neg_hi:[1,0,0]
 v_pk_fma_f32 v[86:87], v[78:79], v[82:83], v[86:87] op_sel:[1,1,0] op_sel_hi:[0,1,1] neg_hi:[1,0,0]
 v_pk_fma_f32 v[84:85], v[78:79], v[80:81], v[84:85] op_sel:[1,1,0] op_sel_hi:[0,1,1] neg_lo:[1,0,0]
 v_pk_fma_f32 v[86:87], v[76:77], v[80:81], v[86:87] op_sel:[1,1,0] op_sel_hi:[0,1,1] neg_hi:[1,0,0]
 v_pk_fma_f32 v[84:85], v[78:79], v[82:83], v[84:85] op_sel_hi:[1,0,1]
 v_pk_fma_f32 v[86:87], v[76:77], v[82:83], v[86:87] op_sel_hi:[1,0,1] neg_lo:[1,0,0] neg_hi:[1,0,0]
 v_mul_f32 v84, s86, v84
 v_mul_f32 v85, s86, v85
 v_mul_f32 v86, s86, v86
 v_mul_f32 v87, s86, v87
 v_cvt_pk_bf16_f32 v93, v84, v85
 v_cvt_pk_bf16_f32 v101, v86, v87
 v_accvgpr_read_b32 v76, a68
 v_accvgpr_read_b32 v77, a69
 v_accvgpr_read_b32 v78, a84
 v_accvgpr_read_b32 v79, a85
 v_lshlrev_b32 v88, 16, v144
 v_and_b32 v89, 0xffff0000, v144
 v_lshlrev_b32 v90, 16, v145
 v_and_b32 v91, 0xffff0000, v145
 v_add_f32 v80, v88, v90
 v_sub_f32 v81, v88, v90
 v_add_f32 v82, v89, v91
 v_sub_f32 v83, v89, v91
 v_pk_mul_f32 v[84:85], v[76:77], v[80:81] op_sel_hi:[1,0]
 v_pk_mul_f32 v[86:87], v[78:79], v[80:81] op_sel_hi:[1,0]
 v_pk_fma_f32 v[84:85], v[76:77], v[82:83], v[84:85] op_sel:[1,1,0] op_sel_hi:[0,1,1] neg_hi:[1,0,0]
 v_pk_fma_f32 v[86:87], v[78:79], v[82:83], v[86:87] op_sel:[1,1,0] op_sel_hi:[0,1,1] neg_hi:[1,0,0]
 v_pk_fma_f32 v[84:85], v[78:79], v[80:81], v[84:85] op_sel:[1,1,0] op_sel_hi:[0,1,1] neg_lo:[1,0,0]
 v_pk_fma_f32 v[86:87], v[76:77], v[80:81], v[86:87] op_sel:[1,1,0] op_sel_hi:[0,1,1] neg_hi:[1,0,0]
 v_pk_fma_f32 v[84:85], v[78:79], v[82:83], v[84:85] op_sel_hi:[1,0,1]
 v_pk_fma_f32 v[86:87], v[76:77], v[82:83], v[86:87] op_sel_hi:[1,0,1] neg_lo:[1,0,0] neg_hi:[1,0,0]
 v_mul_f32 v84, s86, v84
 v_mul_f32 v85, s86, v85
 v_mul_f32 v86, s86, v86
 v_mul_f32 v87, s86, v87
 v_cvt_pk_bf16_f32 v94, v84, v85
 v_cvt_pk_bf16_f32 v102, v86, v87
 v_accvgpr_read_b32 v76, a70
 v_accvgpr_read_b32 v77, a71
 v_accvgpr_read_b32 v78, a86
 v_accvgpr_read_b32 v79, a87
 v_lshlrev_b32 v88, 16, v146
 v_and_b32 v89, 0xffff0000, v146
 v_lshlrev_b32 v90, 16, v147
 v_and_b32 v91, 0xffff0000, v147
 v_add_f32 v80, v88, v90
 v_sub_f32 v81, v88, v90
 v_add_f32 v82, v89, v91
 v_sub_f32 v83, v89, v91
 v_pk_mul_f32 v[84:85], v[76:77], v[80:81] op_sel_hi:[1,0]
 v_pk_mul_f32 v[86:87], v[78:79], v[80:81] op_sel_hi:[1,0]
 v_pk_fma_f32 v[84:85], v[76:77], v[82:83], v[84:85] op_sel:[1,1,0] op_sel_hi:[0,1,1] neg_hi:[1,0,0]
 v_pk_fma_f32 v[86:87], v[78:79], v[82:83], v[86:87] op_sel:[1,1,0] op_sel_hi:[0,1,1] neg_hi:[1,0,0]
 v_pk_fma_f32 v[84:85], v[78:79], v[80:81], v[84:85] op_sel:[1,1,0] op_sel_hi:[0,1,1] neg_lo:[1,0,0]
 v_pk_fma_f32 v[86:87], v[76:77], v[80:81], v[86:87] op_sel:[1,1,0] op_sel_hi:[0,1,1] neg_hi:[1,0,0]
 v_pk_fma_f32 v[84:85], v[78:79], v[82:83], v[84:85] op_sel_hi:[1,0,1]
 v_pk_fma_f32 v[86:87], v[76:77], v[82:83], v[86:87] op_sel_hi:[1,0,1] neg_lo:[1,0,0] neg_hi:[1,0,0]
 v_mul_f32 v84, s86, v84
 v_mul_f32 v85, s86, v85
 v_mul_f32 v86, s86, v86
 v_mul_f32 v87, s86, v87
 v_cvt_pk_bf16_f32 v95, v84, v85
 v_cvt_pk_bf16_f32 v103, v86, v87
 v_accvgpr_read_b32 v76, a72
 v_accvgpr_read_b32 v77, a73
 v_accvgpr_read_b32 v78, a88
 v_accvgpr_read_b32 v79, a89
 v_lshlrev_b32 v88, 16, v148
 v_and_b32 v89, 0xffff0000, v148
 v_lshlrev_b32 v90, 16, v149
 v_and_b32 v91, 0xffff0000, v149
 v_add_f32 v80, v88, v90
 v_sub_f32 v81, v88, v90
 v_add_f32 v82, v89, v91
 v_sub_f32 v83, v89, v91
 v_pk_mul_f32 v[84:85], v[76:77], v[80:81] op_sel_hi:[1,0]
 v_pk_mul_f32 v[86:87], v[78:79], v[80:81] op_sel_hi:[1,0]
 v_pk_fma_f32 v[84:85], v[76:77], v[82:83], v[84:85] op_sel:[1,1,0] op_sel_hi:[0,1,1] neg_hi:[1,0,0]
 v_pk_fma_f32 v[86:87], v[78:79], v[82:83], v[86:87] op_sel:[1,1,0] op_sel_hi:[0,1,1] neg_hi:[1,0,0]
 v_pk_fma_f32 v[84:85], v[78:79], v[80:81], v[84:85] op_sel:[1,1,0] op_sel_hi:[0,1,1] neg_lo:[1,0,0]
 v_pk_fma_f32 v[86:87], v[76:77], v[80:81], v[86:87] op_sel:[1,1,0] op_sel_hi:[0,1,1] neg_hi:[1,0,0]
 v_pk_fma_f32 v[84:85], v[78:79], v[82:83], v[84:85] op_sel_hi:[1,0,1]
 v_pk_fma_f32 v[86:87], v[76:77], v[82:83], v[86:87] op_sel_hi:[1,0,1] neg_lo:[1,0,0] neg_hi:[1,0,0]
 v_mul_f32 v84, s86, v84
 v_mul_f32 v85, s86, v85
 v_mul_f32 v86, s86, v86
 v_mul_f32 v87, s86, v87
 v_cvt_pk_bf16_f32 v96, v84, v85
 v_cvt_pk_bf16_f32 v104, v86, v87
 v_accvgpr_read_b32 v76, a74
 v_accvgpr_read_b32 v77, a75
 v_accvgpr_read_b32 v78, a90
 v_accvgpr_read_b32 v79, a91
 v_lshlrev_b32 v88, 16, v150
 v_and_b32 v89, 0xffff0000, v150
 v_lshlrev_b32 v90, 16, v151
 v_and_b32 v91, 0xffff0000, v151
 v_add_f32 v80, v88, v90
 v_sub_f32 v81, v88, v90
 v_add_f32 v82, v89, v91
 v_sub_f32 v83, v89, v91
 v_pk_mul_f32 v[84:85], v[76:77], v[80:81] op_sel_hi:[1,0]
 v_pk_mul_f32 v[86:87], v[78:79], v[80:81] op_sel_hi:[1,0]
 v_pk_fma_f32 v[84:85], v[76:77], v[82:83], v[84:85] op_sel:[1,1,0] op_sel_hi:[0,1,1] neg_hi:[1,0,0]
 v_pk_fma_f32 v[86:87], v[78:79], v[82:83], v[86:87] op_sel:[1,1,0] op_sel_hi:[0,1,1] neg_hi:[1,0,0]
 v_pk_fma_f32 v[84:85], v[78:79], v[80:81], v[84:85] op_sel:[1,1,0] op_sel_hi:[0,1,1] neg_lo:[1,0,0]
 v_pk_fma_f32 v[86:87], v[76:77], v[80:81], v[86:87] op_sel:[1,1,0] op_sel_hi:[0,1,1] neg_hi:[1,0,0]
 v_pk_fma_f32 v[84:85], v[78:79], v[82:83], v[84:85] op_sel_hi:[1,0,1]
 v_pk_fma_f32 v[86:87], v[76:77], v[82:83], v[86:87] op_sel_hi:[1,0,1] neg_lo:[1,0,0] neg_hi:[1,0,0]
 v_mul_f32 v84, s86, v84
 v_mul_f32 v85, s86, v85
 v_mul_f32 v86, s86, v86
 v_mul_f32 v87, s86, v87
 v_cvt_pk_bf16_f32 v97, v84, v85
 v_cvt_pk_bf16_f32 v105, v86, v87
 v_accvgpr_read_b32 v76, a76
 v_accvgpr_read_b32 v77, a77
 v_accvgpr_read_b32 v78, a92
 v_accvgpr_read_b32 v79, a93
 v_lshlrev_b32 v88, 16, v152
 v_and_b32 v89, 0xffff0000, v152
 v_lshlrev_b32 v90, 16, v153
 v_and_b32 v91, 0xffff0000, v153
 v_add_f32 v80, v88, v90
 v_sub_f32 v81, v88, v90
 v_add_f32 v82, v89, v91
 v_sub_f32 v83, v89, v91
 v_pk_mul_f32 v[84:85], v[76:77], v[80:81] op_sel_hi:[1,0]
 v_pk_mul_f32 v[86:87], v[78:79], v[80:81] op_sel_hi:[1,0]
 v_pk_fma_f32 v[84:85], v[76:77], v[82:83], v[84:85] op_sel:[1,1,0] op_sel_hi:[0,1,1] neg_hi:[1,0,0]
 v_pk_fma_f32 v[86:87], v[78:79], v[82:83], v[86:87] op_sel:[1,1,0] op_sel_hi:[0,1,1] neg_hi:[1,0,0]
 v_pk_fma_f32 v[84:85], v[78:79], v[80:81], v[84:85] op_sel:[1,1,0] op_sel_hi:[0,1,1] neg_lo:[1,0,0]
 v_pk_fma_f32 v[86:87], v[76:77], v[80:81], v[86:87] op_sel:[1,1,0] op_sel_hi:[0,1,1] neg_hi:[1,0,0]
 v_pk_fma_f32 v[84:85], v[78:79], v[82:83], v[84:85] op_sel_hi:[1,0,1]
 v_pk_fma_f32 v[86:87], v[76:77], v[82:83], v[86:87] op_sel_hi:[1,0,1] neg_lo:[1,0,0] neg_hi:[1,0,0]
 v_mul_f32 v84, s86, v84
 v_mul_f32 v85, s86, v85
 v_mul_f32 v86, s86, v86
 v_mul_f32 v87, s86, v87
 v_cvt_pk_bf16_f32 v98, v84, v85
 v_cvt_pk_bf16_f32 v106, v86, v87
 v_accvgpr_read_b32 v76, a78
 v_accvgpr_read_b32 v77, a79
 v_accvgpr_read_b32 v78, a94
 v_accvgpr_read_b32 v79, a95
 v_lshlrev_b32 v88, 16, v154
 v_and_b32 v89, 0xffff0000, v154
 v_lshlrev_b32 v90, 16, v155
 v_and_b32 v91, 0xffff0000, v155
 v_add_f32 v80, v88, v90
 v_sub_f32 v81, v88, v90
 v_add_f32 v82, v89, v91
 v_sub_f32 v83, v89, v91
 v_pk_mul_f32 v[84:85], v[76:77], v[80:81] op_sel_hi:[1,0]
 v_pk_mul_f32 v[86:87], v[78:79], v[80:81] op_sel_hi:[1,0]
 v_pk_fma_f32 v[84:85], v[76:77], v[82:83], v[84:85] op_sel:[1,1,0] op_sel_hi:[0,1,1] neg_hi:[1,0,0]
 v_pk_fma_f32 v[86:87], v[78:79], v[82:83], v[86:87] op_sel:[1,1,0] op_sel_hi:[0,1,1] neg_hi:[1,0,0]
 v_pk_fma_f32 v[84:85], v[78:79], v[80:81], v[84:85] op_sel:[1,1,0] op_sel_hi:[0,1,1] neg_lo:[1,0,0]
 v_pk_fma_f32 v[86:87], v[76:77], v[80:81], v[86:87] op_sel:[1,1,0] op_sel_hi:[0,1,1] neg_hi:[1,0,0]
 v_pk_fma_f32 v[84:85], v[78:79], v[82:83], v[84:85] op_sel_hi:[1,0,1]
 v_pk_fma_f32 v[86:87], v[76:77], v[82:83], v[86:87] op_sel_hi:[1,0,1] neg_lo:[1,0,0] neg_hi:[1,0,0]
 v_mul_f32 v84, s86, v84
 v_mul_f32 v85, s86, v85
 v_mul_f32 v86, s86, v86
 v_mul_f32 v87, s86, v87
 v_cvt_pk_bf16_f32 v99, v84, v85
 v_cvt_pk_bf16_f32 v107, v86, v87
 ds_write_b128 v60, v[92:95] offset:2048
 ds_write_b128 v60, v[100:103] offset:2560
 ds_write_b128 v61, v[96:99] offset:2048
 ds_write_b128 v61, v[104:107] offset:2560
 v_accvgpr_read_b32 v76, a192
 v_accvgpr_read_b32 v77, a193
 v_accvgpr_read_b32 v78, a208
 v_accvgpr_read_b32 v79, a209
 v_lshlrev_b32 v88, 16, v204
 v_and_b32 v89, 0xffff0000, v204
 v_lshlrev_b32 v90, 16, v205
 v_and_b32 v91, 0xffff0000, v205
 v_add_f32 v80, v88, v90
 v_sub_f32 v81, v88, v90
 v_add_f32 v82, v89, v91
 v_sub_f32 v83, v89, v91
 v_pk_mul_f32 v[84:85], v[76:77], v[80:81] op_sel_hi:[1,0]
 v_pk_mul_f32 v[86:87], v[78:79], v[80:81] op_sel_hi:[1,0]
 v_pk_fma_f32 v[84:85], v[76:77], v[82:83], v[84:85] op_sel:[1,1,0] op_sel_hi:[0,1,1] neg_hi:[1,0,0]
 v_pk_fma_f32 v[86:87], v[78:79], v[82:83], v[86:87] op_sel:[1,1,0] op_sel_hi:[0,1,1] neg_hi:[1,0,0]
 v_pk_fma_f32 v[84:85], v[78:79], v[80:81], v[84:85] op_sel:[1,1,0] op_sel_hi:[0,1,1] neg_lo:[1,0,0]
 v_pk_fma_f32 v[86:87], v[76:77], v[80:81], v[86:87] op_sel:[1,1,0] op_sel_hi:[0,1,1] neg_hi:[1,0,0]
 v_pk_fma_f32 v[84:85], v[78:79], v[82:83], v[84:85] op_sel_hi:[1,0,1]
 v_pk_fma_f32 v[86:87], v[76:77], v[82:83], v[86:87] op_sel_hi:[1,0,1] neg_lo:[1,0,0] neg_hi:[1,0,0]
 v_mul_f32 v84, s86, v84
 v_mul_f32 v85, s86, v85
 v_mul_f32 v86, s86, v86
 v_mul_f32 v87, s86, v87
 v_cvt_pk_bf16_f32 v92, v84, v85
 v_cvt_pk_bf16_f32 v100, v86, v87
 v_accvgpr_read_b32 v76, a194
 v_accvgpr_read_b32 v77, a195
 v_accvgpr_read_b32 v78, a210
 v_accvgpr_read_b32 v79, a211
 v_lshlrev_b32 v88, 16, v206
 v_and_b32 v89, 0xffff0000, v206
 v_lshlrev_b32 v90, 16, v207
 v_and_b32 v91, 0xffff0000, v207
 v_add_f32 v80, v88, v90
 v_sub_f32 v81, v88, v90
 v_add_f32 v82, v89, v91
 v_sub_f32 v83, v89, v91
 v_pk_mul_f32 v[84:85], v[76:77], v[80:81] op_sel_hi:[1,0]
 v_pk_mul_f32 v[86:87], v[78:79], v[80:81] op_sel_hi:[1,0]
 v_pk_fma_f32 v[84:85], v[76:77], v[82:83], v[84:85] op_sel:[1,1,0] op_sel_hi:[0,1,1] neg_hi:[1,0,0]
 v_pk_fma_f32 v[86:87], v[78:79], v[82:83], v[86:87] op_sel:[1,1,0] op_sel_hi:[0,1,1] neg_hi:[1,0,0]
 v_pk_fma_f32 v[84:85], v[78:79], v[80:81], v[84:85] op_sel:[1,1,0] op_sel_hi:[0,1,1] neg_lo:[1,0,0]
 v_pk_fma_f32 v[86:87], v[76:77], v[80:81], v[86:87] op_sel:[1,1,0] op_sel_hi:[0,1,1] neg_hi:[1,0,0]
 v_pk_fma_f32 v[84:85], v[78:79], v[82:83], v[84:85] op_sel_hi:[1,0,1]
 v_pk_fma_f32 v[86:87], v[76:77], v[82:83], v[86:87] op_sel_hi:[1,0,1] neg_lo:[1,0,0] neg_hi:[1,0,0]
 v_mul_f32 v84, s86, v84
 v_mul_f32 v85, s86, v85
 v_mul_f32 v86, s86, v86
 v_mul_f32 v87, s86, v87
 v_cvt_pk_bf16_f32 v93, v84, v85
 v_cvt_pk_bf16_f32 v101, v86, v87
 v_accvgpr_read_b32 v76, a196
 v_accvgpr_read_b32 v77, a197
 v_accvgpr_read_b32 v78, a212
 v_accvgpr_read_b32 v79, a213
 v_lshlrev_b32 v88, 16, v208
 v_and_b32 v89, 0xffff0000, v208
 v_lshlrev_b32 v90, 16, v209
 v_and_b32 v91, 0xffff0000, v209
 v_add_f32 v80, v88, v90
 v_sub_f32 v81, v88, v90
 v_add_f32 v82, v89, v91
 v_sub_f32 v83, v89, v91
 v_pk_mul_f32 v[84:85], v[76:77], v[80:81] op_sel_hi:[1,0]
 v_pk_mul_f32 v[86:87], v[78:79], v[80:81] op_sel_hi:[1,0]
 v_pk_fma_f32 v[84:85], v[76:77], v[82:83], v[84:85] op_sel:[1,1,0] op_sel_hi:[0,1,1] neg_hi:[1,0,0]
 v_pk_fma_f32 v[86:87], v[78:79], v[82:83], v[86:87] op_sel:[1,1,0] op_sel_hi:[0,1,1] neg_hi:[1,0,0]
 v_pk_fma_f32 v[84:85], v[78:79], v[80:81], v[84:85] op_sel:[1,1,0] op_sel_hi:[0,1,1] neg_lo:[1,0,0]
 v_pk_fma_f32 v[86:87], v[76:77], v[80:81], v[86:87] op_sel:[1,1,0] op_sel_hi:[0,1,1] neg_hi:[1,0,0]
 v_pk_fma_f32 v[84:85], v[78:79], v[82:83], v[84:85] op_sel_hi:[1,0,1]
 v_pk_fma_f32 v[86:87], v[76:77], v[82:83], v[86:87] op_sel_hi:[1,0,1] neg_lo:[1,0,0] neg_hi:[1,0,0]
 v_mul_f32 v84, s86, v84
 v_mul_f32 v85, s86, v85
 v_mul_f32 v86, s86, v86
 v_mul_f32 v87, s86, v87
 v_cvt_pk_bf16_f32 v94, v84, v85
 v_cvt_pk_bf16_f32 v102, v86, v87
 v_accvgpr_read_b32 v76, a198
 v_accvgpr_read_b32 v77, a199
 v_accvgpr_read_b32 v78, a214
 v_accvgpr_read_b32 v79, a215
 v_lshlrev_b32 v88, 16, v210
 v_and_b32 v89, 0xffff0000, v210
 v_lshlrev_b32 v90, 16, v211
 v_and_b32 v91, 0xffff0000, v211
 v_add_f32 v80, v88, v90
 v_sub_f32 v81, v88, v90
 v_add_f32 v82, v89, v91
 v_sub_f32 v83, v89, v91
 v_pk_mul_f32 v[84:85], v[76:77], v[80:81] op_sel_hi:[1,0]
 v_pk_mul_f32 v[86:87], v[78:79], v[80:81] op_sel_hi:[1,0]
 v_pk_fma_f32 v[84:85], v[76:77], v[82:83], v[84:85] op_sel:[1,1,0] op_sel_hi:[0,1,1] neg_hi:[1,0,0]
 v_pk_fma_f32 v[86:87], v[78:79], v[82:83], v[86:87] op_sel:[1,1,0] op_sel_hi:[0,1,1] neg_hi:[1,0,0]
 v_pk_fma_f32 v[84:85], v[78:79], v[80:81], v[84:85] op_sel:[1,1,0] op_sel_hi:[0,1,1] neg_lo:[1,0,0]
 v_pk_fma_f32 v[86:87], v[76:77], v[80:81], v[86:87] op_sel:[1,1,0] op_sel_hi:[0,1,1] neg_hi:[1,0,0]
 v_pk_fma_f32 v[84:85], v[78:79], v[82:83], v[84:85] op_sel_hi:[1,0,1]
 v_pk_fma_f32 v[86:87], v[76:77], v[82:83], v[86:87] op_sel_hi:[1,0,1] neg_lo:[1,0,0] neg_hi:[1,0,0]
 v_mul_f32 v84, s86, v84
 v_mul_f32 v85, s86, v85
 v_mul_f32 v86, s86, v86
 v_mul_f32 v87, s86, v87
 v_cvt_pk_bf16_f32 v95, v84, v85
 v_cvt_pk_bf16_f32 v103, v86, v87
 v_accvgpr_read_b32 v76, a200
 v_accvgpr_read_b32 v77, a201
 v_accvgpr_read_b32 v78, a216
 v_accvgpr_read_b32 v79, a217
 v_lshlrev_b32 v88, 16, v212
 v_and_b32 v89, 0xffff0000, v212
 v_lshlrev_b32 v90, 16, v213
 v_and_b32 v91, 0xffff0000, v213
 v_add_f32 v80, v88, v90
 v_sub_f32 v81, v88, v90
 v_add_f32 v82, v89, v91
 v_sub_f32 v83, v89, v91
 v_pk_mul_f32 v[84:85], v[76:77], v[80:81] op_sel_hi:[1,0]
 v_pk_mul_f32 v[86:87], v[78:79], v[80:81] op_sel_hi:[1,0]
 v_pk_fma_f32 v[84:85], v[76:77], v[82:83], v[84:85] op_sel:[1,1,0] op_sel_hi:[0,1,1] neg_hi:[1,0,0]
 v_pk_fma_f32 v[86:87], v[78:79], v[82:83], v[86:87] op_sel:[1,1,0] op_sel_hi:[0,1,1] neg_hi:[1,0,0]
 v_pk_fma_f32 v[84:85], v[78:79], v[80:81], v[84:85] op_sel:[1,1,0] op_sel_hi:[0,1,1] neg_lo:[1,0,0]
 v_pk_fma_f32 v[86:87], v[76:77], v[80:81], v[86:87] op_sel:[1,1,0] op_sel_hi:[0,1,1] neg_hi:[1,0,0]
 v_pk_fma_f32 v[84:85], v[78:79], v[82:83], v[84:85] op_sel_hi:[1,0,1]
 v_pk_fma_f32 v[86:87], v[76:77], v[82:83], v[86:87] op_sel_hi:[1,0,1] neg_lo:[1,0,0] neg_hi:[1,0,0]
 v_mul_f32 v84, s86, v84
 v_mul_f32 v85, s86, v85
 v_mul_f32 v86, s86, v86
 v_mul_f32 v87, s86, v87
 v_cvt_pk_bf16_f32 v96, v84, v85
 v_cvt_pk_bf16_f32 v104, v86, v87
 v_accvgpr_read_b32 v76, a202
 v_accvgpr_read_b32 v77, a203
 v_accvgpr_read_b32 v78, a218
 v_accvgpr_read_b32 v79, a219
 v_lshlrev_b32 v88, 16, v214
 v_and_b32 v89, 0xffff0000, v214
 v_lshlrev_b32 v90, 16, v215
 v_and_b32 v91, 0xffff0000, v215
 v_add_f32 v80, v88, v90
 v_sub_f32 v81, v88, v90
 v_add_f32 v82, v89, v91
 v_sub_f32 v83, v89, v91
 v_pk_mul_f32 v[84:85], v[76:77], v[80:81] op_sel_hi:[1,0]
 v_pk_mul_f32 v[86:87], v[78:79], v[80:81] op_sel_hi:[1,0]
 v_pk_fma_f32 v[84:85], v[76:77], v[82:83], v[84:85] op_sel:[1,1,0] op_sel_hi:[0,1,1] neg_hi:[1,0,0]
 v_pk_fma_f32 v[86:87], v[78:79], v[82:83], v[86:87] op_sel:[1,1,0] op_sel_hi:[0,1,1] neg_hi:[1,0,0]
 v_pk_fma_f32 v[84:85], v[78:79], v[80:81], v[84:85] op_sel:[1,1,0] op_sel_hi:[0,1,1] neg_lo:[1,0,0]
 v_pk_fma_f32 v[86:87], v[76:77], v[80:81], v[86:87] op_sel:[1,1,0] op_sel_hi:[0,1,1] neg_hi:[1,0,0]
 v_pk_fma_f32 v[84:85], v[78:79], v[82:83], v[84:85] op_sel_hi:[1,0,1]
 v_pk_fma_f32 v[86:87], v[76:77], v[82:83], v[86:87] op_sel_hi:[1,0,1] neg_lo:[1,0,0] neg_hi:[1,0,0]
 v_mul_f32 v84, s86, v84
 v_mul_f32 v85, s86, v85
 v_mul_f32 v86, s86, v86
 v_mul_f32 v87, s86, v87
 v_cvt_pk_bf16_f32 v97, v84, v85
 v_cvt_pk_bf16_f32 v105, v86, v87
 v_accvgpr_read_b32 v76, a204
 v_accvgpr_read_b32 v77, a205
 v_accvgpr_read_b32 v78, a220
 v_accvgpr_read_b32 v79, a221
 v_lshlrev_b32 v88, 16, v216
 v_and_b32 v89, 0xffff0000, v216
 v_lshlrev_b32 v90, 16, v217
 v_and_b32 v91, 0xffff0000, v217
 v_add_f32 v80, v88, v90
 v_sub_f32 v81, v88, v90
 v_add_f32 v82, v89, v91
 v_sub_f32 v83, v89, v91
 v_pk_mul_f32 v[84:85], v[76:77], v[80:81] op_sel_hi:[1,0]
 v_pk_mul_f32 v[86:87], v[78:79], v[80:81] op_sel_hi:[1,0]
 v_pk_fma_f32 v[84:85], v[76:77], v[82:83], v[84:85] op_sel:[1,1,0] op_sel_hi:[0,1,1] neg_hi:[1,0,0]
 v_pk_fma_f32 v[86:87], v[78:79], v[82:83], v[86:87] op_sel:[1,1,0] op_sel_hi:[0,1,1] neg_hi:[1,0,0]
 v_pk_fma_f32 v[84:85], v[78:79], v[80:81], v[84:85] op_sel:[1,1,0] op_sel_hi:[0,1,1] neg_lo:[1,0,0]
 v_pk_fma_f32 v[86:87], v[76:77], v[80:81], v[86:87] op_sel:[1,1,0] op_sel_hi:[0,1,1] neg_hi:[1,0,0]
 v_pk_fma_f32 v[84:85], v[78:79], v[82:83], v[84:85] op_sel_hi:[1,0,1]
 v_pk_fma_f32 v[86:87], v[76:77], v[82:83], v[86:87] op_sel_hi:[1,0,1] neg_lo:[1,0,0] neg_hi:[1,0,0]
 v_mul_f32 v84, s86, v84
 v_mul_f32 v85, s86, v85
 v_mul_f32 v86, s86, v86
 v_mul_f32 v87, s86, v87
 v_cvt_pk_bf16_f32 v98, v84, v85
 v_cvt_pk_bf16_f32 v106, v86, v87
 v_accvgpr_read_b32 v76, a206
 v_accvgpr_read_b32 v77, a207
 v_accvgpr_read_b32 v78, a222
 v_accvgpr_read_b32 v79, a223
 v_lshlrev_b32 v88, 16, v218
 v_and_b32 v89, 0xffff0000, v218
 v_lshlrev_b32 v90, 16, v219
 v_and_b32 v91, 0xffff0000, v219
 v_add_f32 v80, v88, v90
 v_sub_f32 v81, v88, v90
 v_add_f32 v82, v89, v91
 v_sub_f32 v83, v89, v91
 v_pk_mul_f32 v[84:85], v[76:77], v[80:81] op_sel_hi:[1,0]
 v_pk_mul_f32 v[86:87], v[78:79], v[80:81] op_sel_hi:[1,0]
 v_pk_fma_f32 v[84:85], v[76:77], v[82:83], v[84:85] op_sel:[1,1,0] op_sel_hi:[0,1,1] neg_hi:[1,0,0]
 v_pk_fma_f32 v[86:87], v[78:79], v[82:83], v[86:87] op_sel:[1,1,0] op_sel_hi:[0,1,1] neg_hi:[1,0,0]
 v_pk_fma_f32 v[84:85], v[78:79], v[80:81], v[84:85] op_sel:[1,1,0] op_sel_hi:[0,1,1] neg_lo:[1,0,0]
 v_pk_fma_f32 v[86:87], v[76:77], v[80:81], v[86:87] op_sel:[1,1,0] op_sel_hi:[0,1,1] neg_hi:[1,0,0]
 v_pk_fma_f32 v[84:85], v[78:79], v[82:83], v[84:85] op_sel_hi:[1,0,1]
 v_pk_fma_f32 v[86:87], v[76:77], v[82:83], v[86:87] op_sel_hi:[1,0,1] neg_lo:[1,0,0] neg_hi:[1,0,0]
 v_mul_f32 v84, s86, v84
 v_mul_f32 v85, s86, v85
 v_mul_f32 v86, s86, v86
 v_mul_f32 v87, s86, v87
 v_cvt_pk_bf16_f32 v99, v84, v85
 v_cvt_pk_bf16_f32 v107, v86, v87
 ds_write_b128 v62, v[92:95] offset:2048
 ds_write_b128 v62, v[100:103] offset:2560
 ds_write_b128 v63, v[96:99] offset:2048
 ds_write_b128 v63, v[104:107] offset:2560
 v_accvgpr_read_b32 v76, a96
 v_accvgpr_read_b32 v77, a97
 v_accvgpr_read_b32 v78, a112
 v_accvgpr_read_b32 v79, a113
 v_lshlrev_b32 v88, 16, v156
 v_and_b32 v89, 0xffff0000, v156
 v_lshlrev_b32 v90, 16, v157
 v_and_b32 v91, 0xffff0000, v157
 v_add_f32 v80, v88, v90
 v_sub_f32 v81, v88, v90
 v_add_f32 v82, v89, v91
 v_sub_f32 v83, v89, v91
 v_pk_mul_f32 v[84:85], v[76:77], v[80:81] op_sel_hi:[1,0]
 v_pk_mul_f32 v[86:87], v[78:79], v[80:81] op_sel_hi:[1,0]
 v_pk_fma_f32 v[84:85], v[76:77], v[82:83], v[84:85] op_sel:[1,1,0] op_sel_hi:[0,1,1] neg_hi:[1,0,0]
 v_pk_fma_f32 v[86:87], v[78:79], v[82:83], v[86:87] op_sel:[1,1,0] op_sel_hi:[0,1,1] neg_hi:[1,0,0]
 v_pk_fma_f32 v[84:85], v[78:79], v[80:81], v[84:85] op_sel:[1,1,0] op_sel_hi:[0,1,1] neg_lo:[1,0,0]
 v_pk_fma_f32 v[86:87], v[76:77], v[80:81], v[86:87] op_sel:[1,1,0] op_sel_hi:[0,1,1] neg_hi:[1,0,0]
 v_pk_fma_f32 v[84:85], v[78:79], v[82:83], v[84:85] op_sel_hi:[1,0,1]
 v_pk_fma_f32 v[86:87], v[76:77], v[82:83], v[86:87] op_sel_hi:[1,0,1] neg_lo:[1,0,0] neg_hi:[1,0,0]
 s_mov_b64 exec, s[90:91]
 v_mul_f32 v84, v76, v88
 v_mul_f32 v85, v77, v90
 v_fma_f32 v84, v78, v89, v84
 v_fma_f32 v85, v79, v91, v85
 v_mul_f32 v86, v78, v88
 v_fma_f32 v86, -v76, v89, v86
 v_mul_f32 v87, v79, v90
 v_fma_f32 v87, -v77, v91, v87
 s_mov_b64 exec, -1
 v_mul_f32 v84, s86, v84
 v_mul_f32 v85, s86, v85
 v_mul_f32 v86, s86, v86
 v_mul_f32 v87, s86, v87
 v_cvt_pk_bf16_f32 v92, v84, v85
 v_cvt_pk_bf16_f32 v100, v86, v87
 v_accvgpr_read_b32 v76, a98
 v_accvgpr_read_b32 v77, a99
 v_accvgpr_read_b32 v78, a114
 v_accvgpr_read_b32 v79, a115
 v_lshlrev_b32 v88, 16, v158
 v_and_b32 v89, 0xffff0000, v158
 v_lshlrev_b32 v90, 16, v159
 v_and_b32 v91, 0xffff0000, v159
 v_add_f32 v80, v88, v90
 v_sub_f32 v81, v88, v90
 v_add_f32 v82, v89, v91
 v_sub_f32 v83, v89, v91
 v_pk_mul_f32 v[84:85], v[76:77], v[80:81] op_sel_hi:[1,0]
 v_pk_mul_f32 v[86:87], v[78:79], v[80:81] op_sel_hi:[1,0]
 v_pk_fma_f32 v[84:85], v[76:77], v[82:83], v[84:85] op_sel:[1,1,0] op_sel_hi:[0,1,1] neg_hi:[1,0,0]
 v_pk_fma_f32 v[86:87], v[78:79], v[82:83], v[86:87] op_sel:[1,1,0] op_sel_hi:[0,1,1] neg_hi:[1,0,0]
 v_pk_fma_f32 v[84:85], v[78:79], v[80:81], v[84:85] op_sel:[1,1,0] op_sel_hi:[0,1,1] neg_lo:[1,0,0]
 v_pk_fma_f32 v[86:87], v[76:77], v[80:81], v[86:87] op_sel:[1,1,0] op_sel_hi:[0,1,1] neg_hi:[1,0,0]
 v_pk_fma_f32 v[84:85], v[78:79], v[82:83], v[84:85] op_sel_hi:[1,0,1]
 v_pk_fma_f32 v[86:87], v[76:77], v[82:83], v[86:87] op_sel_hi:[1,0,1] neg_lo:[1,0,0] neg_hi:[1,0,0]
 v_mul_f32 v84, s86, v84
 v_mul_f32 v85, s86, v85
 v_mul_f32 v86, s86, v86
 v_mul_f32 v87, s86, v87
 v_cvt_pk_bf16_f32 v93, v84, v85
 v_cvt_pk_bf16_f32 v101, v86, v87
 v_accvgpr_read_b32 v76, a100
 v_accvgpr_read_b32 v77, a101
 v_accvgpr_read_b32 v78, a116
 v_accvgpr_read_b32 v79, a117
 v_lshlrev_b32 v88, 16, v160
 v_and_b32 v89, 0xffff0000, v160
 v_lshlrev_b32 v90, 16, v161
 v_and_b32 v91, 0xffff0000, v161
 v_add_f32 v80, v88, v90
 v_sub_f32 v81, v88, v90
 v_add_f32 v82, v89, v91
 v_sub_f32 v83, v89, v91
 v_pk_mul_f32 v[84:85], v[76:77], v[80:81] op_sel_hi:[1,0]
 v_pk_mul_f32 v[86:87], v[78:79], v[80:81] op_sel_hi:[1,0]
 v_pk_fma_f32 v[84:85], v[76:77], v[82:83], v[84:85] op_sel:[1,1,0] op_sel_hi:[0,1,1] neg_hi:[1,0,0]
 v_pk_fma_f32 v[86:87], v[78:79], v[82:83], v[86:87] op_sel:[1,1,0] op_sel_hi:[0,1,1] neg_hi:[1,0,0]
 v_pk_fma_f32 v[84:85], v[78:79], v[80:81], v[84:85] op_sel:[1,1,0] op_sel_hi:[0,1,1] neg_lo:[1,0,0]
 v_pk_fma_f32 v[86:87], v[76:77], v[80:81], v[86:87] op_sel:[1,1,0] op_sel_hi:[0,1,1] neg_hi:[1,0,0]
 v_pk_fma_f32 v[84:85], v[78:79], v[82:83], v[84:85] op_sel_hi:[1,0,1]
 v_pk_fma_f32 v[86:87], v[76:77], v[82:83], v[86:87] op_sel_hi:[1,0,1] neg_lo:[1,0,0] neg_hi:[1,0,0]
 v_mul_f32 v84, s86, v84
 v_mul_f32 v85, s86, v85
 v_mul_f32 v86, s86, v86
 v_mul_f32 v87, s86, v87
 v_cvt_pk_bf16_f32 v94, v84, v85
 v_cvt_pk_bf16_f32 v102, v86, v87
 v_accvgpr_read_b32 v76, a102
 v_accvgpr_read_b32 v77, a103
 v_accvgpr_read_b32 v78, a118
 v_accvgpr_read_b32 v79, a119
 v_lshlrev_b32 v88, 16, v162
 v_and_b32 v89, 0xffff0000, v162
 v_lshlrev_b32 v90, 16, v163
 v_and_b32 v91, 0xffff0000, v163
 v_add_f32 v80, v88, v90
 v_sub_f32 v81, v88, v90
 v_add_f32 v82, v89, v91
 v_sub_f32 v83, v89, v91
 v_pk_mul_f32 v[84:85], v[76:77], v[80:81] op_sel_hi:[1,0]
 v_pk_mul_f32 v[86:87], v[78:79], v[80:81] op_sel_hi:[1,0]
 v_pk_fma_f32 v[84:85], v[76:77], v[82:83], v[84:85] op_sel:[1,1,0] op_sel_hi:[0,1,1] neg_hi:[1,0,0]
 v_pk_fma_f32 v[86:87], v[78:79], v[82:83], v[86:87] op_sel:[1,1,0] op_sel_hi:[0,1,1] neg_hi:[1,0,0]
 v_pk_fma_f32 v[84:85], v[78:79], v[80:81], v[84:85] op_sel:[1,1,0] op_sel_hi:[0,1,1] neg_lo:[1,0,0]
 v_pk_fma_f32 v[86:87], v[76:77], v[80:81], v[86:87] op_sel:[1,1,0] op_sel_hi:[0,1,1] neg_hi:[1,0,0]
 v_pk_fma_f32 v[84:85], v[78:79], v[82:83], v[84:85] op_sel_hi:[1,0,1]
 v_pk_fma_f32 v[86:87], v[76:77], v[82:83], v[86:87] op_sel_hi:[1,0,1] neg_lo:[1,0,0] neg_hi:[1,0,0]
 v_mul_f32 v84, s86, v84
 v_mul_f32 v85, s86, v85
 v_mul_f32 v86, s86, v86
 v_mul_f32 v87, s86, v87
 v_cvt_pk_bf16_f32 v95, v84, v85
 v_cvt_pk_bf16_f32 v103, v86, v87
 v_accvgpr_read_b32 v76, a104
 v_accvgpr_read_b32 v77, a105
 v_accvgpr_read_b32 v78, a120
 v_accvgpr_read_b32 v79, a121
 v_lshlrev_b32 v88, 16, v164
 v_and_b32 v89, 0xffff0000, v164
 v_lshlrev_b32 v90, 16, v165
 v_and_b32 v91, 0xffff0000, v165
 v_add_f32 v80, v88, v90
 v_sub_f32 v81, v88, v90
 v_add_f32 v82, v89, v91
 v_sub_f32 v83, v89, v91
 v_pk_mul_f32 v[84:85], v[76:77], v[80:81] op_sel_hi:[1,0]
 v_pk_mul_f32 v[86:87], v[78:79], v[80:81] op_sel_hi:[1,0]
 v_pk_fma_f32 v[84:85], v[76:77], v[82:83], v[84:85] op_sel:[1,1,0] op_sel_hi:[0,1,1] neg_hi:[1,0,0]
 v_pk_fma_f32 v[86:87], v[78:79], v[82:83], v[86:87] op_sel:[1,1,0] op_sel_hi:[0,1,1] neg_hi:[1,0,0]
 v_pk_fma_f32 v[84:85], v[78:79], v[80:81], v[84:85] op_sel:[1,1,0] op_sel_hi:[0,1,1] neg_lo:[1,0,0]
 v_pk_fma_f32 v[86:87], v[76:77], v[80:81], v[86:87] op_sel:[1,1,0] op_sel_hi:[0,1,1] neg_hi:[1,0,0]
 v_pk_fma_f32 v[84:85], v[78:79], v[82:83], v[84:85] op_sel_hi:[1,0,1]
 v_pk_fma_f32 v[86:87], v[76:77], v[82:83], v[86:87] op_sel_hi:[1,0,1] neg_lo:[1,0,0] neg_hi:[1,0,0]
 v_mul_f32 v84, s86, v84
 v_mul_f32 v85, s86, v85
 v_mul_f32 v86, s86, v86
 v_mul_f32 v87, s86, v87
 v_cvt_pk_bf16_f32 v96, v84, v85
 v_cvt_pk_bf16_f32 v104, v86, v87
 v_accvgpr_read_b32 v76, a106
 v_accvgpr_read_b32 v77, a107
 v_accvgpr_read_b32 v78, a122
 v_accvgpr_read_b32 v79, a123
 v_lshlrev_b32 v88, 16, v166
 v_and_b32 v89, 0xffff0000, v166
 v_lshlrev_b32 v90, 16, v167
 v_and_b32 v91, 0xffff0000, v167
 v_add_f32 v80, v88, v90
 v_sub_f32 v81, v88, v90
 v_add_f32 v82, v89, v91
 v_sub_f32 v83, v89, v91
 v_pk_mul_f32 v[84:85], v[76:77], v[80:81] op_sel_hi:[1,0]
 v_pk_mul_f32 v[86:87], v[78:79], v[80:81] op_sel_hi:[1,0]
 v_pk_fma_f32 v[84:85], v[76:77], v[82:83], v[84:85] op_sel:[1,1,0] op_sel_hi:[0,1,1] neg_hi:[1,0,0]
 v_pk_fma_f32 v[86:87], v[78:79], v[82:83], v[86:87] op_sel:[1,1,0] op_sel_hi:[0,1,1] neg_hi:[1,0,0]
 v_pk_fma_f32 v[84:85], v[78:79], v[80:81], v[84:85] op_sel:[1,1,0] op_sel_hi:[0,1,1] neg_lo:[1,0,0]
 v_pk_fma_f32 v[86:87], v[76:77], v[80:81], v[86:87] op_sel:[1,1,0] op_sel_hi:[0,1,1] neg_hi:[1,0,0]
 v_pk_fma_f32 v[84:85], v[78:79], v[82:83], v[84:85] op_sel_hi:[1,0,1]
 v_pk_fma_f32 v[86:87], v[76:77], v[82:83], v[86:87] op_sel_hi:[1,0,1] neg_lo:[1,0,0] neg_hi:[1,0,0]
 v_mul_f32 v84, s86, v84
 v_mul_f32 v85, s86, v85
 v_mul_f32 v86, s86, v86
 v_mul_f32 v87, s86, v87
 v_cvt_pk_bf16_f32 v97, v84, v85
 v_cvt_pk_bf16_f32 v105, v86, v87
 v_accvgpr_read_b32 v76, a108
 v_accvgpr_read_b32 v77, a109
 v_accvgpr_read_b32 v78, a124
 v_accvgpr_read_b32 v79, a125
 v_lshlrev_b32 v88, 16, v168
 v_and_b32 v89, 0xffff0000, v168
 v_lshlrev_b32 v90, 16, v169
 v_and_b32 v91, 0xffff0000, v169
 v_add_f32 v80, v88, v90
 v_sub_f32 v81, v88, v90
 v_add_f32 v82, v89, v91
 v_sub_f32 v83, v89, v91
 v_pk_mul_f32 v[84:85], v[76:77], v[80:81] op_sel_hi:[1,0]
 v_pk_mul_f32 v[86:87], v[78:79], v[80:81] op_sel_hi:[1,0]
 v_pk_fma_f32 v[84:85], v[76:77], v[82:83], v[84:85] op_sel:[1,1,0] op_sel_hi:[0,1,1] neg_hi:[1,0,0]
 v_pk_fma_f32 v[86:87], v[78:79], v[82:83], v[86:87] op_sel:[1,1,0] op_sel_hi:[0,1,1] neg_hi:[1,0,0]
 v_pk_fma_f32 v[84:85], v[78:79], v[80:81], v[84:85] op_sel:[1,1,0] op_sel_hi:[0,1,1] neg_lo:[1,0,0]
 v_pk_fma_f32 v[86:87], v[76:77], v[80:81], v[86:87] op_sel:[1,1,0] op_sel_hi:[0,1,1] neg_hi:[1,0,0]
 v_pk_fma_f32 v[84:85], v[78:79], v[82:83], v[84:85] op_sel_hi:[1,0,1]
 v_pk_fma_f32 v[86:87], v[76:77], v[82:83], v[86:87] op_sel_hi:[1,0,1] neg_lo:[1,0,0] neg_hi:[1,0,0]
 v_mul_f32 v84, s86, v84
 v_mul_f32 v85, s86, v85
 v_mul_f32 v86, s86, v86
 v_mul_f32 v87, s86, v87
 v_cvt_pk_bf16_f32 v98, v84, v85
 v_cvt_pk_bf16_f32 v106, v86, v87
 v_accvgpr_read_b32 v76, a110
 v_accvgpr_read_b32 v77, a111
 v_accvgpr_read_b32 v78, a126
 v_accvgpr_read_b32 v79, a127
 v_lshlrev_b32 v88, 16, v170
 v_and_b32 v89, 0xffff0000, v170
 v_lshlrev_b32 v90, 16, v171
 v_and_b32 v91, 0xffff0000, v171
 v_add_f32 v80, v88, v90
 v_sub_f32 v81, v88, v90
 v_add_f32 v82, v89, v91
 v_sub_f32 v83, v89, v91
 v_pk_mul_f32 v[84:85], v[76:77], v[80:81] op_sel_hi:[1,0]
 v_pk_mul_f32 v[86:87], v[78:79], v[80:81] op_sel_hi:[1,0]
 v_pk_fma_f32 v[84:85], v[76:77], v[82:83], v[84:85] op_sel:[1,1,0] op_sel_hi:[0,1,1] neg_hi:[1,0,0]
 v_pk_fma_f32 v[86:87], v[78:79], v[82:83], v[86:87] op_sel:[1,1,0] op_sel_hi:[0,1,1] neg_hi:[1,0,0]
 v_pk_fma_f32 v[84:85], v[78:79], v[80:81], v[84:85] op_sel:[1,1,0] op_sel_hi:[0,1,1] neg_lo:[1,0,0]
 v_pk_fma_f32 v[86:87], v[76:77], v[80:81], v[86:87] op_sel:[1,1,0] op_sel_hi:[0,1,1] neg_hi:[1,0,0]
 v_pk_fma_f32 v[84:85], v[78:79], v[82:83], v[84:85] op_sel_hi:[1,0,1]
 v_pk_fma_f32 v[86:87], v[76:77], v[82:83], v[86:87] op_sel_hi:[1,0,1] neg_lo:[1,0,0] neg_hi:[1,0,0]
 v_mul_f32 v84, s86, v84
 v_mul_f32 v85, s86, v85
 v_mul_f32 v86, s86, v86
 v_mul_f32 v87, s86, v87
 v_cvt_pk_bf16_f32 v99, v84, v85
 v_cvt_pk_bf16_f32 v107, v86, v87
 ds_write_b128 v60, v[92:95] offset:3072
 ds_write_b128 v60, v[100:103] offset:3584
 ds_write_b128 v61, v[96:99] offset:3072
 ds_write_b128 v61, v[104:107] offset:3584
 v_accvgpr_read_b32 v76, a224
 v_accvgpr_read_b32 v77, a225
 v_accvgpr_read_b32 v78, a240
 v_accvgpr_read_b32 v79, a241
 v_lshlrev_b32 v88, 16, v220
 v_and_b32 v89, 0xffff0000, v220
 v_lshlrev_b32 v90, 16, v221
 v_and_b32 v91, 0xffff0000, v221
 v_add_f32 v80, v88, v90
 v_sub_f32 v81, v88, v90
 v_add_f32 v82, v89, v91
 v_sub_f32 v83, v89, v91
 v_pk_mul_f32 v[84:85], v[76:77], v[80:81] op_sel_hi:[1,0]
 v_pk_mul_f32 v[86:87], v[78:79], v[80:81] op_sel_hi:[1,0]
 v_pk_fma_f32 v[84:85], v[76:77], v[82:83], v[84:85] op_sel:[1,1,0] op_sel_hi:[0,1,1] neg_hi:[1,0,0]
 v_pk_fma_f32 v[86:87], v[78:79], v[82:83], v[86:87] op_sel:[1,1,0] op_sel_hi:[0,1,1] neg_hi:[1,0,0]
 v_pk_fma_f32 v[84:85], v[78:79], v[80:81], v[84:85] op_sel:[1,1,0] op_sel_hi:[0,1,1] neg_lo:[1,0,0]
 v_pk_fma_f32 v[86:87], v[76:77], v[80:81], v[86:87] op_sel:[1,1,0] op_sel_hi:[0,1,1] neg_hi:[1,0,0]
 v_pk_fma_f32 v[84:85], v[78:79], v[82:83], v[84:85] op_sel_hi:[1,0,1]
 v_pk_fma_f32 v[86:87], v[76:77], v[82:83], v[86:87] op_sel_hi:[1,0,1] neg_lo:[1,0,0] neg_hi:[1,0,0]
 v_mul_f32 v84, s86, v84
 v_mul_f32 v85, s86, v85
 v_mul_f32 v86, s86, v86
 v_mul_f32 v87, s86, v87
 v_cvt_pk_bf16_f32 v92, v84, v85
 v_cvt_pk_bf16_f32 v100, v86, v87
 v_accvgpr_read_b32 v76, a226
 v_accvgpr_read_b32 v77, a227
 v_accvgpr_read_b32 v78, a242
 v_accvgpr_read_b32 v79, a243
 v_lshlrev_b32 v88, 16, v222
 v_and_b32 v89, 0xffff0000, v222
 v_lshlrev_b32 v90, 16, v223
 v_and_b32 v91, 0xffff0000, v223
 v_add_f32 v80, v88, v90
 v_sub_f32 v81, v88, v90
 v_add_f32 v82, v89, v91
 v_sub_f32 v83, v89, v91
 v_pk_mul_f32 v[84:85], v[76:77], v[80:81] op_sel_hi:[1,0]
 v_pk_mul_f32 v[86:87], v[78:79], v[80:81] op_sel_hi:[1,0]
 v_pk_fma_f32 v[84:85], v[76:77], v[82:83], v[84:85] op_sel:[1,1,0] op_sel_hi:[0,1,1] neg_hi:[1,0,0]
 v_pk_fma_f32 v[86:87], v[78:79], v[82:83], v[86:87] op_sel:[1,1,0] op_sel_hi:[0,1,1] neg_hi:[1,0,0]
 v_pk_fma_f32 v[84:85], v[78:79], v[80:81], v[84:85] op_sel:[1,1,0] op_sel_hi:[0,1,1] neg_lo:[1,0,0]
 v_pk_fma_f32 v[86:87], v[76:77], v[80:81], v[86:87] op_sel:[1,1,0] op_sel_hi:[0,1,1] neg_hi:[1,0,0]
 v_pk_fma_f32 v[84:85], v[78:79], v[82:83], v[84:85] op_sel_hi:[1,0,1]
 v_pk_fma_f32 v[86:87], v[76:77], v[82:83], v[86:87] op_sel_hi:[1,0,1] neg_lo:[1,0,0] neg_hi:[1,0,0]
 v_mul_f32 v84, s86, v84
 v_mul_f32 v85, s86, v85
 v_mul_f32 v86, s86, v86
 v_mul_f32 v87, s86, v87
 v_cvt_pk_bf16_f32 v93, v84, v85
 v_cvt_pk_bf16_f32 v101, v86, v87
 v_accvgpr_read_b32 v76, a228
 v_accvgpr_read_b32 v77, a229
 v_accvgpr_read_b32 v78, a244
 v_accvgpr_read_b32 v79, a245
 v_lshlrev_b32 v88, 16, v224
 v_and_b32 v89, 0xffff0000, v224
 v_lshlrev_b32 v90, 16, v225
 v_and_b32 v91, 0xffff0000, v225
 v_add_f32 v80, v88, v90
 v_sub_f32 v81, v88, v90
 v_add_f32 v82, v89, v91
 v_sub_f32 v83, v89, v91
 v_pk_mul_f32 v[84:85], v[76:77], v[80:81] op_sel_hi:[1,0]
 v_pk_mul_f32 v[86:87], v[78:79], v[80:81] op_sel_hi:[1,0]
 v_pk_fma_f32 v[84:85], v[76:77], v[82:83], v[84:85] op_sel:[1,1,0] op_sel_hi:[0,1,1] neg_hi:[1,0,0]
 v_pk_fma_f32 v[86:87], v[78:79], v[82:83], v[86:87] op_sel:[1,1,0] op_sel_hi:[0,1,1] neg_hi:[1,0,0]
 v_pk_fma_f32 v[84:85], v[78:79], v[80:81], v[84:85] op_sel:[1,1,0] op_sel_hi:[0,1,1] neg_lo:[1,0,0]
 v_pk_fma_f32 v[86:87], v[76:77], v[80:81], v[86:87] op_sel:[1,1,0] op_sel_hi:[0,1,1] neg_hi:[1,0,0]
 v_pk_fma_f32 v[84:85], v[78:79], v[82:83], v[84:85] op_sel_hi:[1,0,1]
 v_pk_fma_f32 v[86:87], v[76:77], v[82:83], v[86:87] op_sel_hi:[1,0,1] neg_lo:[1,0,0] neg_hi:[1,0,0]
 v_mul_f32 v84, s86, v84
 v_mul_f32 v85, s86, v85
 v_mul_f32 v86, s86, v86
 v_mul_f32 v87, s86, v87
 v_cvt_pk_bf16_f32 v94, v84, v85
 v_cvt_pk_bf16_f32 v102, v86, v87
 v_accvgpr_read_b32 v76, a230
 v_accvgpr_read_b32 v77, a231
 v_accvgpr_read_b32 v78, a246
 v_accvgpr_read_b32 v79, a247
 v_lshlrev_b32 v88, 16, v226
 v_and_b32 v89, 0xffff0000, v226
 v_lshlrev_b32 v90, 16, v227
 v_and_b32 v91, 0xffff0000, v227
 v_add_f32 v80, v88, v90
 v_sub_f32 v81, v88, v90
 v_add_f32 v82, v89, v91
 v_sub_f32 v83, v89, v91
 v_pk_mul_f32 v[84:85], v[76:77], v[80:81] op_sel_hi:[1,0]
 v_pk_mul_f32 v[86:87], v[78:79], v[80:81] op_sel_hi:[1,0]
 v_pk_fma_f32 v[84:85], v[76:77], v[82:83], v[84:85] op_sel:[1,1,0] op_sel_hi:[0,1,1] neg_hi:[1,0,0]
 v_pk_fma_f32 v[86:87], v[78:79], v[82:83], v[86:87] op_sel:[1,1,0] op_sel_hi:[0,1,1] neg_hi:[1,0,0]
 v_pk_fma_f32 v[84:85], v[78:79], v[80:81], v[84:85] op_sel:[1,1,0] op_sel_hi:[0,1,1] neg_lo:[1,0,0]
 v_pk_fma_f32 v[86:87], v[76:77], v[80:81], v[86:87] op_sel:[1,1,0] op_sel_hi:[0,1,1] neg_hi:[1,0,0]
 v_pk_fma_f32 v[84:85], v[78:79], v[82:83], v[84:85] op_sel_hi:[1,0,1]
 v_pk_fma_f32 v[86:87], v[76:77], v[82:83], v[86:87] op_sel_hi:[1,0,1] neg_lo:[1,0,0] neg_hi:[1,0,0]
 v_mul_f32 v84, s86, v84
 v_mul_f32 v85, s86, v85
 v_mul_f32 v86, s86, v86
 v_mul_f32 v87, s86, v87
 v_cvt_pk_bf16_f32 v95, v84, v85
 v_cvt_pk_bf16_f32 v103, v86, v87
 v_accvgpr_read_b32 v76, a232
 v_accvgpr_read_b32 v77, a233
 v_accvgpr_read_b32 v78, a248
 v_accvgpr_read_b32 v79, a249
 v_lshlrev_b32 v88, 16, v228
 v_and_b32 v89, 0xffff0000, v228
 v_lshlrev_b32 v90, 16, v229
 v_and_b32 v91, 0xffff0000, v229
 v_add_f32 v80, v88, v90
 v_sub_f32 v81, v88, v90
 v_add_f32 v82, v89, v91
 v_sub_f32 v83, v89, v91
 v_pk_mul_f32 v[84:85], v[76:77], v[80:81] op_sel_hi:[1,0]
 v_pk_mul_f32 v[86:87], v[78:79], v[80:81] op_sel_hi:[1,0]
 v_pk_fma_f32 v[84:85], v[76:77], v[82:83], v[84:85] op_sel:[1,1,0] op_sel_hi:[0,1,1] neg_hi:[1,0,0]
 v_pk_fma_f32 v[86:87], v[78:79], v[82:83], v[86:87] op_sel:[1,1,0] op_sel_hi:[0,1,1] neg_hi:[1,0,0]
 v_pk_fma_f32 v[84:85], v[78:79], v[80:81], v[84:85] op_sel:[1,1,0] op_sel_hi:[0,1,1] neg_lo:[1,0,0]
 v_pk_fma_f32 v[86:87], v[76:77], v[80:81], v[86:87] op_sel:[1,1,0] op_sel_hi:[0,1,1] neg_hi:[1,0,0]
 v_pk_fma_f32 v[84:85], v[78:79], v[82:83], v[84:85] op_sel_hi:[1,0,1]
 v_pk_fma_f32 v[86:87], v[76:77], v[82:83], v[86:87] op_sel_hi:[1,0,1] neg_lo:[1,0,0] neg_hi:[1,0,0]
 v_mul_f32 v84, s86, v84
 v_mul_f32 v85, s86, v85
 v_mul_f32 v86, s86, v86
 v_mul_f32 v87, s86, v87
 v_cvt_pk_bf16_f32 v96, v84, v85
 v_cvt_pk_bf16_f32 v104, v86, v87
 v_accvgpr_read_b32 v76, a234
 v_accvgpr_read_b32 v77, a235
 v_accvgpr_read_b32 v78, a250
 v_accvgpr_read_b32 v79, a251
 v_lshlrev_b32 v88, 16, v230
 v_and_b32 v89, 0xffff0000, v230
 v_lshlrev_b32 v90, 16, v231
 v_and_b32 v91, 0xffff0000, v231
 v_add_f32 v80, v88, v90
 v_sub_f32 v81, v88, v90
 v_add_f32 v82, v89, v91
 v_sub_f32 v83, v89, v91
 v_pk_mul_f32 v[84:85], v[76:77], v[80:81] op_sel_hi:[1,0]
 v_pk_mul_f32 v[86:87], v[78:79], v[80:81] op_sel_hi:[1,0]
 v_pk_fma_f32 v[84:85], v[76:77], v[82:83], v[84:85] op_sel:[1,1,0] op_sel_hi:[0,1,1] neg_hi:[1,0,0]
 v_pk_fma_f32 v[86:87], v[78:79], v[82:83], v[86:87] op_sel:[1,1,0] op_sel_hi:[0,1,1] neg_hi:[1,0,0]
 v_pk_fma_f32 v[84:85], v[78:79], v[80:81], v[84:85] op_sel:[1,1,0] op_sel_hi:[0,1,1] neg_lo:[1,0,0]
 v_pk_fma_f32 v[86:87], v[76:77], v[80:81], v[86:87] op_sel:[1,1,0] op_sel_hi:[0,1,1] neg_hi:[1,0,0]
 v_pk_fma_f32 v[84:85], v[78:79], v[82:83], v[84:85] op_sel_hi:[1,0,1]
 v_pk_fma_f32 v[86:87], v[76:77], v[82:83], v[86:87] op_sel_hi:[1,0,1] neg_lo:[1,0,0] neg_hi:[1,0,0]
 v_mul_f32 v84, s86, v84
 v_mul_f32 v85, s86, v85
 v_mul_f32 v86, s86, v86
 v_mul_f32 v87, s86, v87
 v_cvt_pk_bf16_f32 v97, v84, v85
 v_cvt_pk_bf16_f32 v105, v86, v87
 v_accvgpr_read_b32 v76, a236
 v_accvgpr_read_b32 v77, a237
 v_accvgpr_read_b32 v78, a252
 v_accvgpr_read_b32 v79, a253
 v_lshlrev_b32 v88, 16, v232
 v_and_b32 v89, 0xffff0000, v232
 v_lshlrev_b32 v90, 16, v233
 v_and_b32 v91, 0xffff0000, v233
 v_add_f32 v80, v88, v90
 v_sub_f32 v81, v88, v90
 v_add_f32 v82, v89, v91
 v_sub_f32 v83, v89, v91
 v_pk_mul_f32 v[84:85], v[76:77], v[80:81] op_sel_hi:[1,0]
 v_pk_mul_f32 v[86:87], v[78:79], v[80:81] op_sel_hi:[1,0]
 v_pk_fma_f32 v[84:85], v[76:77], v[82:83], v[84:85] op_sel:[1,1,0] op_sel_hi:[0,1,1] neg_hi:[1,0,0]
 v_pk_fma_f32 v[86:87], v[78:79], v[82:83], v[86:87] op_sel:[1,1,0] op_sel_hi:[0,1,1] neg_hi:[1,0,0]
 v_pk_fma_f32 v[84:85], v[78:79], v[80:81], v[84:85] op_sel:[1,1,0] op_sel_hi:[0,1,1] neg_lo:[1,0,0]
 v_pk_fma_f32 v[86:87], v[76:77], v[80:81], v[86:87] op_sel:[1,1,0] op_sel_hi:[0,1,1] neg_hi:[1,0,0]
 v_pk_fma_f32 v[84:85], v[78:79], v[82:83], v[84:85] op_sel_hi:[1,0,1]
 v_pk_fma_f32 v[86:87], v[76:77], v[82:83], v[86:87] op_sel_hi:[1,0,1] neg_lo:[1,0,0] neg_hi:[1,0,0]
 v_mul_f32 v84, s86, v84
 v_mul_f32 v85, s86, v85
 v_mul_f32 v86, s86, v86
 v_mul_f32 v87, s86, v87
 v_cvt_pk_bf16_f32 v98, v84, v85
 v_cvt_pk_bf16_f32 v106, v86, v87
 v_accvgpr_read_b32 v76, a238
 v_accvgpr_read_b32 v77, a239
 v_accvgpr_read_b32 v78, a254
 v_accvgpr_read_b32 v79, a255
 v_lshlrev_b32 v88, 16, v234
 v_and_b32 v89, 0xffff0000, v234
 v_lshlrev_b32 v90, 16, v235
 v_and_b32 v91, 0xffff0000, v235
 v_add_f32 v80, v88, v90
 v_sub_f32 v81, v88, v90
 v_add_f32 v82, v89, v91
 v_sub_f32 v83, v89, v91
 v_pk_mul_f32 v[84:85], v[76:77], v[80:81] op_sel_hi:[1,0]
 v_pk_mul_f32 v[86:87], v[78:79], v[80:81] op_sel_hi:[1,0]
 v_pk_fma_f32 v[84:85], v[76:77], v[82:83], v[84:85] op_sel:[1,1,0] op_sel_hi:[0,1,1] neg_hi:[1,0,0]
 v_pk_fma_f32 v[86:87], v[78:79], v[82:83], v[86:87] op_sel:[1,1,0] op_sel_hi:[0,1,1] neg_hi:[1,0,0]
 v_pk_fma_f32 v[84:85], v[78:79], v[80:81], v[84:85] op_sel:[1,1,0] op_sel_hi:[0,1,1] neg_lo:[1,0,0]
 v_pk_fma_f32 v[86:87], v[76:77], v[80:81], v[86:87] op_sel:[1,1,0] op_sel_hi:[0,1,1] neg_hi:[1,0,0]
 v_pk_fma_f32 v[84:85], v[78:79], v[82:83], v[84:85] op_sel_hi:[1,0,1]
 v_pk_fma_f32 v[86:87], v[76:77], v[82:83], v[86:87] op_sel_hi:[1,0,1] neg_lo:[1,0,0] neg_hi:[1,0,0]
 v_mul_f32 v84, s86, v84
 v_mul_f32 v85, s86, v85
 v_mul_f32 v86, s86, v86
 v_mul_f32 v87, s86, v87
 v_cvt_pk_bf16_f32 v99, v84, v85
 v_cvt_pk_bf16_f32 v107, v86, v87
 ds_write_b128 v62, v[92:95] offset:3072
 ds_write_b128 v62, v[100:103] offset:3584
 ds_write_b128 v63, v[96:99] offset:3072
 ds_write_b128 v63, v[104:107] offset:3584
 s_lshl_b32 s86, s74, 20
 s_lshl_b32 s66, s73, 2
 s_add_u32 s66, s66, s72
 s_lshl_b32 s66, s66, 9
 s_add_u32 s86, s86, s66
 s_add_u32 s86, s86, 0x5800000
 s_waitcnt lgkmcnt(0)
 s_barrier
 v_lshrrev_b32 v1, 4, v5
 v_mul_u32_u24 v1, 256, v1
 v_and_b32 v2, 15, v0
 v_lshl_add_u32 v1, v2, 4, v1
 v_mul_u32_u24 v2, 4096, v6
 v_add_u32 v16, v1, v2
 s_mul_i32 s65, s62, 262144
 s_add_u32 s65, s65, s86
 s_lshl_b32 s66, s62, 15
 v_mov_b32 v1, v5
 v_lshlrev_b32 v1, 4, v1
 v_lshl_add_u32 v1, v6, 9, v1
 v_add_u32 v18, s66, v1
 v_xor_b32 v28, 0, v18
 v_xor_b32 v29, 16, v18
 v_xor_b32 v30, 32, v18
 v_xor_b32 v31, 48, v18
 v_xor_b32 v32, 64, v18
 v_xor_b32 v33, 80, v18
 v_xor_b32 v34, 96, v18
 v_xor_b32 v35, 112, v18
 ds_read_b128 v[108:111], v28 offset:0
 ds_read_b128 v[112:115], v28 offset:1024
 ds_read_b128 v[116:119], v28 offset:2048
 ds_read_b128 v[120:123], v28 offset:3072
 ds_read_b128 v[124:127], v29 offset:4096
 ds_read_b128 v[128:131], v29 offset:5120
 ds_read_b128 v[132:135], v29 offset:6144
 ds_read_b128 v[136:139], v29 offset:7168
 ds_read_b128 v[140:143], v30 offset:8192
 ds_read_b128 v[144:147], v30 offset:9216
 ds_read_b128 v[148:151], v30 offset:10240
 ds_read_b128 v[152:155], v30 offset:11264
 ds_read_b128 v[156:159], v31 offset:12288
 ds_read_b128 v[160:163], v31 offset:13312
 ds_read_b128 v[164:167], v31 offset:14336
 ds_read_b128 v[168:171], v31 offset:15360
 ds_read_b128 v[172:175], v32 offset:16384
 ds_read_b128 v[176:179], v32 offset:17408
 ds_read_b128 v[180:183], v32 offset:18432
 ds_read_b128 v[184:187], v32 offset:19456
 ds_read_b128 v[188:191], v33 offset:20480
 ds_read_b128 v[192:195], v33 offset:21504
 ds_read_b128 v[196:199], v33 offset:22528
 ds_read_b128 v[200:203], v33 offset:23552
 ds_read_b128 v[204:207], v34 offset:24576
 ds_read_b128 v[208:211], v34 offset:25600
 ds_read_b128 v[212:215], v34 offset:26624
 ds_read_b128 v[216:219], v34 offset:27648
 ds_read_b128 v[220:223], v35 offset:28672
 ds_read_b128 v[224:227], v35 offset:29696
 ds_read_b128 v[228:231], v35 offset:30720
 ds_read_b128 v[232:235], v35 offset:31744
 s_waitcnt lgkmcnt(15)
 buffer_store_dwordx4 v[108:111], v16, s[4:7], s65 offen sc1
 s_add_u32 s65, s65, 8192
 s_sleep 4
 buffer_store_dwordx4 v[112:115], v16, s[4:7], s65 offen sc1
 s_add_u32 s65, s65, 8192
 s_sleep 4
 buffer_store_dwordx4 v[116:119], v16, s[4:7], s65 offen sc1
 s_add_u32 s65, s65, 8192
 s_sleep 4
 buffer_store_dwordx4 v[120:123], v16, s[4:7], s65 offen sc1
 s_add_u32 s65, s65, 8192
 s_sleep 4
 buffer_store_dwordx4 v[124:127], v16, s[4:7], s65 offen sc1
 s_add_u32 s65, s65, 8192
 s_sleep 4
 buffer_store_dwordx4 v[128:131], v16, s[4:7], s65 offen sc1
 s_add_u32 s65, s65, 8192
 s_sleep 4
 buffer_store_dwordx4 v[132:135], v16, s[4:7], s65 offen sc1
 s_add_u32 s65, s65, 8192
 s_sleep 4
 buffer_store_dwordx4 v[136:139], v16, s[4:7], s65 offen sc1
 s_add_u32 s65, s65, 8192
 s_sleep 4
 buffer_store_dwordx4 v[140:143], v16, s[4:7], s65 offen sc1
 s_add_u32 s65, s65, 8192
 s_sleep 4
 buffer_store_dwordx4 v[144:147], v16, s[4:7], s65 offen sc1
 s_add_u32 s65, s65, 8192
 s_sleep 4
 buffer_store_dwordx4 v[148:151], v16, s[4:7], s65 offen sc1
 s_add_u32 s65, s65, 8192
 s_sleep 4
 buffer_store_dwordx4 v[152:155], v16, s[4:7], s65 offen sc1
 s_add_u32 s65, s65, 8192
 s_sleep 4
 buffer_store_dwordx4 v[156:159], v16, s[4:7], s65 offen sc1
 s_add_u32 s65, s65, 8192
 s_sleep 4
 buffer_store_dwordx4 v[160:163], v16, s[4:7], s65 offen sc1
 s_add_u32 s65, s65, 8192
 s_sleep 4
 buffer_store_dwordx4 v[164:167], v16, s[4:7], s65 offen sc1
 s_add_u32 s65, s65, 8192
 s_sleep 4
 buffer_store_dwordx4 v[168:171], v16, s[4:7], s65 offen sc1
 s_add_u32 s65, s65, 8192
 s_sleep 4
 buffer_store_dwordx4 v[172:175], v16, s[4:7], s65 offen sc1
 s_add_u32 s65, s65, 8192
 s_sleep 4
 s_waitcnt lgkmcnt(14)
 buffer_store_dwordx4 v[176:179], v16, s[4:7], s65 offen sc1
 s_add_u32 s65, s65, 8192
 s_sleep 4
 s_waitcnt lgkmcnt(13)
 buffer_store_dwordx4 v[180:183], v16, s[4:7], s65 offen sc1
 s_add_u32 s65, s65, 8192
 s_sleep 4
 s_waitcnt lgkmcnt(12)
 buffer_store_dwordx4 v[184:187], v16, s[4:7], s65 offen sc1
 s_add_u32 s65, s65, 8192
 s_sleep 4
 s_waitcnt lgkmcnt(11)
 buffer_store_dwordx4 v[188:191], v16, s[4:7], s65 offen sc1
 s_add_u32 s65, s65, 8192
 s_sleep 4
 s_waitcnt lgkmcnt(10)
 buffer_store_dwordx4 v[192:195], v16, s[4:7], s65 offen sc1
 s_add_u32 s65, s65, 8192
 s_sleep 4
 s_waitcnt lgkmcnt(9)
 buffer_store_dwordx4 v[196:199], v16, s[4:7], s65 offen sc1
 s_add_u32 s65, s65, 8192
 s_sleep 4
 s_waitcnt lgkmcnt(8)
 buffer_store_dwordx4 v[200:203], v16, s[4:7], s65 offen sc1
 s_add_u32 s65, s65, 8192
 s_sleep 4
 s_waitcnt lgkmcnt(7)
 buffer_store_dwordx4 v[204:207], v16, s[4:7], s65 offen sc1
 s_add_u32 s65, s65, 8192
 s_sleep 4
 s_waitcnt lgkmcnt(6)
 buffer_store_dwordx4 v[208:211], v16, s[4:7], s65 offen sc1
 s_add_u32 s65, s65, 8192
 s_sleep 4
 s_waitcnt lgkmcnt(5)
 buffer_store_dwordx4 v[212:215], v16, s[4:7], s65 offen sc1
 s_add_u32 s65, s65, 8192
 s_sleep 4
 s_waitcnt lgkmcnt(4)
 buffer_store_dwordx4 v[216:219], v16, s[4:7], s65 offen sc1
 s_add_u32 s65, s65, 8192
 s_sleep 4
 s_waitcnt lgkmcnt(3)
 buffer_store_dwordx4 v[220:223], v16, s[4:7], s65 offen sc1
 s_add_u32 s65, s65, 8192
 s_sleep 4
 s_waitcnt lgkmcnt(2)
 buffer_store_dwordx4 v[224:227], v16, s[4:7], s65 offen sc1
 s_add_u32 s65, s65, 8192
 s_sleep 4
 s_waitcnt lgkmcnt(1)
 buffer_store_dwordx4 v[228:231], v16, s[4:7], s65 offen sc1
 s_add_u32 s65, s65, 8192
 s_sleep 4
 s_waitcnt lgkmcnt(0)
 buffer_store_dwordx4 v[232:235], v16, s[4:7], s65 offen sc1
 s_add_u32 s65, s65, 8192
 s_sleep 4
 s_waitcnt vmcnt(0)
 s_barrier
 s_cmp_eq_u32 s62, 0
 s_cbranch_scc0 L_nosig_129
 s_add_u32 s65, s101, 12
 s_mov_b32 s66, 0x1
 s_atomic_add s66, s[56:57], s65
 s_waitcnt lgkmcnt(0)
L_nosig_129:
 s_cmp_eq_u32 s62, 0
 s_cbranch_scc0 L_fb_skip_130
 v_mov_b32 v1, 12
L_wc_131:
 buffer_load_dword v2, v1, s[16:19], s101 offen sc1
 s_waitcnt vmcnt(0)
 v_readfirstlane_b32 s65, v2
 s_nop 3
 s_cmp_ge_u32 s65, 32
 s_cbranch_scc1 L_wcok_132
 s_sleep 10
 s_sub_u32 s63, s63, 1
 s_cbranch_scc0 L_wc_131
 s_endpgm
L_wcok_132:
L_fb_skip_130:
 s_barrier
 s_and_b32 s73, s60, 1
 s_lshr_b32 s74, s60, 1
 s_lshl_b32 s65, s74, 2
 s_add_u32 s65, s65, s62
 s_mul_i32 s65, s65, 262144
 s_lshl_b32 s66, s73, 11
 s_add_u32 s65, s65, s66
 v_lshrrev_b32 v1, 3, v0
 v_lshrrev_b32 v2, 2, v1
 v_and_b32 v3, 3, v1
 v_lshl_add_u32 v2, v2, 4, v3
 v_mul_u32_u24 v2, 4096, v2
 v_lshrrev_b32 v1, 1, v1
 v_and_b32 v3, 7, v0
 v_xor_b32 v1, v1, v3
 v_lshl_add_u32 v8, v1, 4, v2
 v_xor_b32 v9, 64, v8
 s_add_u32 s78, s65, 0x5800000
 s_add_u32 s79, s65, 0x5804000
 s_add_u32 s80, s65, 0x5808000
 s_add_u32 s81, s65, 0x580c000
 s_add_u32 s82, s65, 0x5820000
 s_add_u32 s83, s65, 0x5824000
 s_add_u32 s84, s65, 0x5828000
 s_add_u32 s85, s65, 0x582c000
 s_lshl_b32 s76, s62, 13
 s_add_u32 m0, s76, 0
 s_nop 0
 buffer_load_dwordx4 v8, s[4:7], s78 offen sc1 lds
 s_add_u32 m0, s76, 1024
 s_nop 0
 buffer_load_dwordx4 v9, s[4:7], s79 offen sc1 lds
 s_add_u32 m0, s76, 2048
 s_nop 0
 buffer_load_dwordx4 v8, s[4:7], s80 offen sc1 lds
 s_add_u32 m0, s76, 3072
 s_nop 0
 buffer_load_dwordx4 v9, s[4:7], s81 offen sc1 lds
 s_add_u32 m0, s76, 4096
 s_nop 0
 buffer_load_dwordx4 v8, s[4:7], s82 offen sc1 lds
 s_add_u32 m0, s76, 5120
 s_nop 0
 buffer_load_dwordx4 v9, s[4:7], s83 offen sc1 lds
 s_add_u32 m0, s76, 6144
 s_nop 0
 buffer_load_dwordx4 v8, s[4:7], s84 offen sc1 lds
 s_add_u32 m0, s76, 7168
 s_nop 0
 buffer_load_dwordx4 v9, s[4:7], s85 offen sc1 lds
 v_add_u32 v8, 128, v8
 v_add_u32 v9, 128, v9
 s_add_u32 s76, s76, 32768
 s_and_b32 s76, s76, 0x1ffff
 s_add_u32 m0, s76, 0
 s_nop 0
 buffer_load_dwordx4 v8, s[4:7], s78 offen sc1 lds
 s_add_u32 m0, s76, 1024
 s_nop 0
 buffer_load_dwordx4 v9, s[4:7], s79 offen sc1 lds
 s_add_u32 m0, s76, 2048
 s_nop 0
 buffer_load_dwordx4 v8, s[4:7], s80 offen sc1 lds
 s_add_u32 m0, s76, 3072
 s_nop 0
 buffer_load_dwordx4 v9, s[4:7], s81 offen sc1 lds
 s_add_u32 m0, s76, 4096
 s_nop 0
 buffer_load_dwordx4 v8, s[4:7], s82 offen sc1 lds
 s_add_u32 m0, s76, 5120
 s_nop 0
 buffer_load_dwordx4 v9, s[4:7], s83 offen sc1 lds
 s_add_u32 m0, s76, 6144
 s_nop 0
 buffer_load_dwordx4 v8, s[4:7], s84 offen sc1 lds
 s_add_u32 m0, s76, 7168
 s_nop 0
 buffer_load_dwordx4 v9, s[4:7], s85 offen sc1 lds
 v_add_u32 v8, 128, v8
 v_add_u32 v9, 128, v9
 s_add_u32 s76, s76, 32768
 s_and_b32 s76, s76, 0x1ffff
 v_bfe_u32 v1, v0, 1, 3
 v_xor_b32 v1, v1, v6
 v_lshlrev_b32 v1, 4, v1
 v_lshl_add_u32 v10, v5, 7, v1
 v_xor_b32 v11, 32, v10
 v_xor_b32 v12, 64, v10
 v_xor_b32 v13, 96, v10
 s_mov_b32 s66, 0x3a000000
 s_mov_b32 s65, s72
 s_lshl_b32 s65, s65, 2
 s_add_u32 s65, s65, s62
 s_lshl_b32 s65, s65, 6
 s_add_u32 s65, s65, 0
 v_add_u32 v1, s65, v5
 v_lshl_add_u32 v4, v6, 3, 0
 v_add_u32 v4, s73, v4
 v_mul_u32_u24 v4, v4, v1
 v_and_b32 v4, 2047, v4
 v_cvt_f32_u32 v4, v4
 v_mul_f32 v28, s66, v4
 v_add_f32 v29, 0xbe800000, v28
 v_lshl_add_u32 v4, v6, 3, 2
 v_add_u32 v4, s73, v4
 v_mul_u32_u24 v4, v4, v1
 v_and_b32 v4, 2047, v4
 v_cvt_f32_u32 v4, v4
 v_mul_f32 v30, s66, v4
 v_add_f32 v31, 0xbe800000, v30
 v_lshl_add_u32 v4, v6, 3, 4
 v_add_u32 v4, s73, v4
 v_mul_u32_u24 v4, v4, v1
 v_and_b32 v4, 2047, v4
 v_cvt_f32_u32 v4, v4
 v_mul_f32 v32, s66, v4
 v_add_f32 v33, 0xbe800000, v32
 v_lshl_add_u32 v4, v6, 3, 6
 v_add_u32 v4, s73, v4
 v_mul_u32_u24 v4, v4, v1
 v_and_b32 v4, 2047, v4
 v_cvt_f32_u32 v4, v4
 v_mul_f32 v34, s66, v4
 v_add_f32 v35, 0xbe800000, v34
 v_lshlrev_b32 v4, 4, v1
 v_and_b32 v4, 2047, v4
 v_cvt_f32_u32 v4, v4
 v_mul_f32 v14, s66, v4
 v_cos_f32 v44, v28
 v_cos_f32 v45, v29
 v_cos_f32 v46, v30
 v_cos_f32 v47, v31
 v_cos_f32 v48, v32
 v_cos_f32 v49, v33
 v_cos_f32 v50, v34
 v_cos_f32 v51, v35
 v_and_b32 v2, 1, v1
 v_cvt_f32_u32 v2, v2
 v_fma_f32 v2, v2, -2.0, 1.0
 v_add_u32 v3, s73, v6
 v_cmp_eq_u32 vcc, 0, v3
 s_nop 1
 v_cndmask_b32 v45, v45, v2, vcc
 v_add_f32 v28, v28, v14
 v_add_f32 v29, v29, v14
 v_add_f32 v30, v30, v14
 v_add_f32 v31, v31, v14
 v_add_f32 v32, v32, v14
 v_add_f32 v33, v33, v14
 v_add_f32 v34, v34, v14
 v_add_f32 v35, v35, v14
 v_cvt_pk_bf16_f32 v60, v44, v45
 v_cvt_pk_bf16_f32 v61, v46, v47
 v_cvt_pk_bf16_f32 v62, v48, v49
 v_cvt_pk_bf16_f32 v63, v50, v51
 s_mov_b32 s65, s72
 s_lshl_b32 s65, s65, 2
 s_add_u32 s65, s65, s62
 s_lshl_b32 s65, s65, 6
 s_add_u32 s65, s65, 32
 v_add_u32 v1, s65, v5
 v_lshl_add_u32 v4, v6, 3, 0
 v_add_u32 v4, s73, v4
 v_mul_u32_u24 v4, v4, v1
 v_and_b32 v4, 2047, v4
 v_cvt_f32_u32 v4, v4
 v_mul_f32 v36, s66, v4
 v_add_f32 v37, 0xbe800000, v36
 v_lshl_add_u32 v4, v6, 3, 2
 v_add_u32 v4, s73, v4
 v_mul_u32_u24 v4, v4, v1
 v_and_b32 v4, 2047, v4
 v_cvt_f32_u32 v4, v4
 v_mul_f32 v38, s66, v4
 v_add_f32 v39, 0xbe800000, v38
 v_lshl_add_u32 v4, v6, 3, 4
 v_add_u32 v4, s73, v4
 v_mul_u32_u24 v4, v4, v1
 v_and_b32 v4, 2047, v4
 v_cvt_f32_u32 v4, v4
 v_mul_f32 v40, s66, v4
 v_add_f32 v41, 0xbe800000, v40
 v_lshl_add_u32 v4, v6, 3, 6
 v_add_u32 v4, s73, v4
 v_mul_u32_u24 v4, v4, v1
 v_and_b32 v4, 2047, v4
 v_cvt_f32_u32 v4, v4
 v_mul_f32 v42, s66, v4
 v_add_f32 v43, 0xbe800000, v42
 v_lshlrev_b32 v4, 4, v1
 v_and_b32 v4, 2047, v4
 v_cvt_f32_u32 v4, v4
 v_mul_f32 v15, s66, v4
 v_cos_f32 v52, v36
 v_cos_f32 v53, v37
 v_cos_f32 v54, v38
 v_cos_f32 v55, v39
 v_cos_f32 v56, v40
 v_cos_f32 v57, v41
 v_cos_f32 v58, v42
 v_cos_f32 v59, v43
 v_and_b32 v2, 1, v1
 v_cvt_f32_u32 v2, v2
 v_fma_f32 v2, v2, -2.0, 1.0
 v_add_u32 v3, s73, v6
 v_cmp_eq_u32 vcc, 0, v3
 s_nop 1
 v_cndmask_b32 v53, v53, v2, vcc
 v_add_f32 v36, v36, v15
 v_add_f32 v37, v37, v15
 v_add_f32 v38, v38, v15
 v_add_f32 v39, v39, v15
 v_add_f32 v40, v40, v15
 v_add_f32 v41, v41, v15
 v_add_f32 v42, v42, v15
 v_add_f32 v43, v43, v15
 v_cvt_pk_bf16_f32 v64, v52, v53
 v_cvt_pk_bf16_f32 v65, v54, v55
 v_cvt_pk_bf16_f32 v66, v56, v57
 v_cvt_pk_bf16_f32 v67, v58, v59
 v_mov_b32 v104, 0
 v_mov_b32 v105, 0
 v_mov_b32 v106, 0
 v_mov_b32 v107, 0
 s_nop 1
 v_mfma_f32_32x32x16_bf16 a[0:15], v[104:107], v[104:107], 0
 v_mfma_f32_32x32x16_bf16 a[16:31], v[104:107], v[104:107], 0
 v_mfma_f32_32x32x16_bf16 a[32:47], v[104:107], v[104:107], 0
 v_mfma_f32_32x32x16_bf16 a[48:63], v[104:107], v[104:107], 0
 v_mfma_f32_32x32x16_bf16 a[64:79], v[104:107], v[104:107], 0
 v_mfma_f32_32x32x16_bf16 a[80:95], v[104:107], v[104:107], 0
 v_mfma_f32_32x32x16_bf16 a[96:111], v[104:107], v[104:107], 0
 v_mfma_f32_32x32x16_bf16 a[112:127], v[104:107], v[104:107], 0
 v_mfma_f32_32x32x16_bf16 a[128:143], v[104:107], v[104:107], 0
 v_mfma_f32_32x32x16_bf16 a[144:159], v[104:107], v[104:107], 0
 v_mfma_f32_32x32x16_bf16 a[160:175], v[104:107], v[104:107], 0
 v_mfma_f32_32x32x16_bf16 a[176:191], v[104:107], v[104:107], 0
 v_mfma_f32_32x32x16_bf16 a[192:207], v[104:107], v[104:107], 0
 v_mfma_f32_32x32x16_bf16 a[208:223], v[104:107], v[104:107], 0
 v_mfma_f32_32x32x16_bf16 a[224:239], v[104:107], v[104:107], 0
 v_mfma_f32_32x32x16_bf16 a[240:255], v[104:107], v[104:107], 0
 s_waitcnt vmcnt(8)
 s_barrier
 ds_read_b128 v[76:79], v10 offset:0
 ds_read_b128 v[80:83], v10 offset:4096
 ds_read_b128 v[84:87], v10 offset:8192
 ds_read_b128 v[88:91], v10 offset:12288
 ds_read_b128 v[92:95], v10 offset:16384
 ds_read_b128 v[96:99], v10 offset:20480
 s_mov_b32 s75, 8
L_f_loop_133:
 s_waitcnt lgkmcnt(5)
 v_mfma_f32_32x32x16_bf16 a[0:15], v[76:79], v[60:63], a[0:15]
 ds_read_b128 v[100:103], v10 offset:24576
 v_cos_f32 v44, v28
 v_mfma_f32_32x32x16_bf16 a[128:143], v[76:79], v[64:67], a[128:143]
 v_cos_f32 v45, v29
 v_add_f32 v28, v28, v14
 s_waitcnt lgkmcnt(5)
 v_mfma_f32_32x32x16_bf16 a[16:31], v[80:83], v[60:63], a[16:31]
 ds_read_b128 v[104:107], v10 offset:28672
 v_cos_f32 v46, v30
 v_add_f32 v29, v29, v14
 v_cvt_pk_bf16_f32 v68, v44, v45
 v_mfma_f32_32x32x16_bf16 a[144:159], v[80:83], v[64:67], a[144:159]
 v_cos_f32 v47, v31
 v_add_f32 v30, v30, v14
 s_waitcnt lgkmcnt(5)
 s_add_u32 m0, s76, 0
 v_mfma_f32_32x32x16_bf16 a[32:47], v[84:87], v[60:63], a[32:47]
 ds_read_b128 v[76:79], v11 offset:0
 v_cos_f32 v48, v32
 v_add_f32 v31, v31, v14
 v_cvt_pk_bf16_f32 v69, v46, v47
 v_mfma_f32_32x32x16_bf16 a[160:175], v[84:87], v[64:67], a[160:175]
 buffer_load_dwordx4 v8, s[4:7], s78 offen sc1 lds
 v_cos_f32 v49, v33
 v_add_f32 v32, v32, v14
 s_waitcnt lgkmcnt(5)
 v_mfma_f32_32x32x16_bf16 a[48:63], v[88:91], v[60:63], a[48:63]
 ds_read_b128 v[80:83], v11 offset:4096
 v_cos_f32 v50, v34
 v_add_f32 v33, v33, v14
 v_cvt_pk_bf16_f32 v70, v48, v49
 v_cos_f32 v52, v36
 v_mfma_f32_32x32x16_bf16 a[176:191], v[88:91], v[64:67], a[176:191]
 v_cos_f32 v51, v35
 v_add_f32 v34, v34, v14
 v_cos_f32 v53, v37
 v_add_f32 v36, v36, v15
 s_waitcnt lgkmcnt(5)
 v_mfma_f32_32x32x16_bf16 a[64:79], v[92:95], v[60:63], a[64:79]
 ds_read_b128 v[84:87], v11 offset:8192
 v_add_f32 v35, v35, v14
 v_cvt_pk_bf16_f32 v71, v50, v51
 v_cos_f32 v54, v38
 v_add_f32 v37, v37, v15
 v_cvt_pk_bf16_f32 v72, v52, v53
 v_mfma_f32_32x32x16_bf16 a[192:207], v[92:95], v[64:67], a[192:207]
 v_cos_f32 v55, v39
 v_add_f32 v38, v38, v15
 s_waitcnt lgkmcnt(5)
 s_add_u32 m0, s76, 1024
 v_mfma_f32_32x32x16_bf16 a[80:95], v[96:99], v[60:63], a[80:95]
 ds_read_b128 v[88:91], v11 offset:12288
 v_cos_f32 v56, v40
 v_add_f32 v39, v39, v15
 v_cvt_pk_bf16_f32 v73, v54, v55
 v_mfma_f32_32x32x16_bf16 a[208:223], v[96:99], v[64:67], a[208:223]
 buffer_load_dwordx4 v9, s[4:7], s79 offen sc1 lds
 v_cos_f32 v57, v41
 v_add_f32 v40, v40, v15
 s_waitcnt lgkmcnt(5)
 v_mfma_f32_32x32x16_bf16 a[96:111], v[100:103], v[60:63], a[96:111]
 ds_read_b128 v[92:95], v11 offset:16384
 v_cos_f32 v58, v42
 v_add_f32 v41, v41, v15
 v_cvt_pk_bf16_f32 v74, v56, v57
 v_mfma_f32_32x32x16_bf16 a[224:239], v[100:103], v[64:67], a[224:239]
 v_cos_f32 v59, v43
 v_add_f32 v42, v42, v15
 s_waitcnt lgkmcnt(5)
 v_mfma_f32_32x32x16_bf16 a[112:127], v[104:107], v[60:63], a[112:127]
 ds_read_b128 v[96:99], v11 offset:20480
 v_add_f32 v43, v43, v15
 v_cvt_pk_bf16_f32 v75, v58, v59
 v_mfma_f32_32x32x16_bf16 a[240:255], v[104:107], v[64:67], a[240:255]
 s_waitcnt lgkmcnt(5)
 s_add_u32 m0, s76, 2048
 v_mfma_f32_32x32x16_bf16 a[0:15], v[76:79], v[68:71], a[0:15]
 ds_read_b128 v[100:103], v11 offset:24576
 v_cos_f32 v44, v28
 v_mfma_f32_32x32x16_bf16 a[128:143], v[76:79], v[72:75], a[128:143]
 buffer_load_dwordx4 v8, s[4:7], s80 offen sc1 lds
 v_cos_f32 v45, v29
 v_add_f32 v28, v28, v14
 s_waitcnt lgkmcnt(5)
 v_mfma_f32_32x32x16_bf16 a[16:31], v[80:83], v[68:71], a[16:31]
 ds_read_b128 v[104:107], v11 offset:28672
 v_cos_f32 v46, v30
 v_add_f32 v29, v29, v14
 v_cvt_pk_bf16_f32 v60, v44, v45
 v_mfma_f32_32x32x16_bf16 a[144:159], v[80:83], v[72:75], a[144:159]
 v_cos_f32 v47, v31
 v_add_f32 v30, v30, v14
 s_waitcnt lgkmcnt(5)
 v_mfma_f32_32x32x16_bf16 a[32:47], v[84:87], v[68:71], a[32:47]
 ds_read_b128 v[76:79], v12 offset:0
 v_cos_f32 v48, v32
 v_add_f32 v31, v31, v14
 v_cvt_pk_bf16_f32 v61, v46, v47
 v_mfma_f32_32x32x16_bf16 a[160:175], v[84:87], v[72:75], a[160:175]
 v_cos_f32 v49, v33
 v_add_f32 v32, v32, v14
 s_waitcnt lgkmcnt(5)
 s_add_u32 m0, s76, 3072
 v_mfma_f32_32x32x16_bf16 a[48:63], v[88:91], v[68:71], a[48:63]
 ds_read_b128 v[80:83], v12 offset:4096
 v_cos_f32 v50, v34
 v_add_f32 v33, v33, v14
 v_cvt_pk_bf16_f32 v62, v48, v49
 v_cos_f32 v52, v36
 v_mfma_f32_32x32x16_bf16 a[176:191], v[88:91], v[72:75], a[176:191]
 buffer_load_dwordx4 v9, s[4:7], s81 offen sc1 lds
 v_cos_f32 v51, v35
 v_add_f32 v34, v34, v14
 v_cos_f32 v53, v37
 v_add_f32 v36, v36, v15
 s_waitcnt lgkmcnt(5)
 v_mfma_f32_32x32x16_bf16 a[64:79], v[92:95], v[68:71], a[64:79]
 ds_read_b128 v[84:87], v12 offset:8192
 v_add_f32 v35, v35, v14
 v_cvt_pk_bf16_f32 v63, v50, v51
 v_cos_f32 v54, v38
 v_add_f32 v37, v37, v15
 v_cvt_pk_bf16_f32 v64, v52, v53
 v_mfma_f32_32x32x16_bf16 a[192:207], v[92:95], v[72:75], a[192:207]
 v_cos_f32 v55, v39
 v_add_f32 v38, v38, v15
 s_waitcnt lgkmcnt(5)
 v_mfma_f32_32x32x16_bf16 a[80:95], v[96:99], v[68:71], a[80:95]
 ds_read_b128 v[88:91], v12 offset:12288
 v_cos_f32 v56, v40
 v_add_f32 v39, v39, v15
 v_cvt_pk_bf16_f32 v65, v54, v55
 v_mfma_f32_32x32x16_bf16 a[208:223], v[96:99], v[72:75], a[208:223]
 v_cos_f32 v57, v41
 v_add_f32 v40, v40, v15
 s_waitcnt lgkmcnt(5)
 s_add_u32 m0, s76, 4096
 v_mfma_f32_32x32x16_bf16 a[96:111], v[100:103], v[68:71], a[96:111]
 ds_read_b128 v[92:95], v12 offset:16384
 v_cos_f32 v58, v42
 v_add_f32 v41, v41, v15
 v_cvt_pk_bf16_f32 v66, v56, v57
 v_mfma_f32_32x32x16_bf16 a[224:239], v[100:103], v[72:75], a[224:239]
 buffer_load_dwordx4 v8, s[4:7], s82 offen sc1 lds
 v_cos_f32 v59, v43
 v_add_f32 v42, v42, v15
 s_waitcnt lgkmcnt(5)
 v_mfma_f32_32x32x16_bf16 a[112:127], v[104:107], v[68:71], a[112:127]
 ds_read_b128 v[96:99], v12 offset:20480
 v_add_f32 v43, v43, v15
 v_cvt_pk_bf16_f32 v67, v58, v59
 v_mfma_f32_32x32x16_bf16 a[240:255], v[104:107], v[72:75], a[240:255]
 s_waitcnt lgkmcnt(5)
 v_mfma_f32_32x32x16_bf16 a[0:15], v[76:79], v[60:63], a[0:15]
 ds_read_b128 v[100:103], v12 offset:24576
 v_cos_f32 v44, v28
 v_mfma_f32_32x32x16_bf16 a[128:143], v[76:79], v[64:67], a[128:143]
 v_cos_f32 v45, v29
 v_add_f32 v28, v28, v14
 s_waitcnt lgkmcnt(5)
 s_add_u32 m0, s76, 5120
 v_mfma_f32_32x32x16_bf16 a[16:31], v[80:83], v[60:63], a[16:31]
 ds_read_b128 v[104:107], v12 offset:28672
 v_cos_f32 v46, v30
 v_add_f32 v29, v29, v14
 v_cvt_pk_bf16_f32 v68, v44, v45
 v_mfma_f32_32x32x16_bf16 a[144:159], v[80:83], v[64:67], a[144:159]
 buffer_load_dwordx4 v9, s[4:7], s83 offen sc1 lds
 v_cos_f32 v47, v31
 v_add_f32 v30, v30, v14
 s_waitcnt lgkmcnt(5)
 v_mfma_f32_32x32x16_bf16 a[32:47], v[84:87], v[60:63], a[32:47]
 ds_read_b128 v[76:79], v13 offset:0
 v_cos_f32 v48, v32
 v_add_f32 v31, v31, v14
 v_cvt_pk_bf16_f32 v69, v46, v47
 v_mfma_f32_32x32x16_bf16 a[160:175], v[84:87], v[64:67], a[160:175]
 v_cos_f32 v49, v33
 v_add_f32 v32, v32, v14
 s_waitcnt lgkmcnt(5)
 v_mfma_f32_32x32x16_bf16 a[48:63], v[88:91], v[60:63], a[48:63]
 ds_read_b128 v[80:83], v13 offset:4096
 v_cos_f32 v50, v34
 v_add_f32 v33, v33, v14
 v_cvt_pk_bf16_f32 v70, v48, v49
 v_cos_f32 v52, v36
 v_mfma_f32_32x32x16_bf16 a[176:191], v[88:91], v[64:67], a[176:191]
 v_cos_f32 v51, v35
 v_add_f32 v34, v34, v14
 v_cos_f32 v53, v37
 v_add_f32 v36, v36, v15
 s_waitcnt lgkmcnt(5)
 s_add_u32 m0, s76, 6144
 v_mfma_f32_32x32x16_bf16 a[64:79], v[92:95], v[60:63], a[64:79]
 ds_read_b128 v[84:87], v13 offset:8192
 v_add_f32 v35, v35, v14
 v_cvt_pk_bf16_f32 v71, v50, v51
 v_cos_f32 v54, v38
 v_add_f32 v37, v37, v15
 v_cvt_pk_bf16_f32 v72, v52, v53
 v_mfma_f32_32x32x16_bf16 a[192:207], v[92:95], v[64:67], a[192:207]
 buffer_load_dwordx4 v8, s[4:7], s84 offen sc1 lds
 v_cos_f32 v55, v39
 v_add_f32 v38, v38, v15
 s_waitcnt lgkmcnt(5)
 v_mfma_f32_32x32x16_bf16 a[80:95], v[96:99], v[60:63], a[80:95]
 ds_read_b128 v[88:91], v13 offset:12288
 v_cos_f32 v56, v40
 v_add_f32 v39, v39, v15
 v_cvt_pk_bf16_f32 v73, v54, v55
 v_mfma_f32_32x32x16_bf16 a[208:223], v[96:99], v[64:67], a[208:223]
 v_cos_f32 v57, v41
 v_add_f32 v40, v40, v15
 s_waitcnt lgkmcnt(5)
 v_mfma_f32_32x32x16_bf16 a[96:111], v[100:103], v[60:63], a[96:111]
 ds_read_b128 v[92:95], v13 offset:16384
 v_cos_f32 v58, v42
 v_add_f32 v41, v41, v15
 v_cvt_pk_bf16_f32 v74, v56, v57
 v_mfma_f32_32x32x16_bf16 a[224:239], v[100:103], v[64:67], a[224:239]
 v_cos_f32 v59, v43
 v_add_f32 v42, v42, v15
 s_waitcnt lgkmcnt(5)
 s_add_u32 m0, s76, 7168
 v_mfma_f32_32x32x16_bf16 a[112:127], v[104:107], v[60:63], a[112:127]
 ds_read_b128 v[96:99], v13 offset:20480
 v_add_f32 v43, v43, v15
 v_cvt_pk_bf16_f32 v75, v58, v59
 v_mfma_f32_32x32x16_bf16 a[240:255], v[104:107], v[64:67], a[240:255]
 buffer_load_dwordx4 v9, s[4:7], s85 offen sc1 lds
 s_waitcnt lgkmcnt(5)
 v_mfma_f32_32x32x16_bf16 a[0:15], v[76:79], v[68:71], a[0:15]
 ds_read_b128 v[100:103], v13 offset:24576
 v_cos_f32 v44, v28
 v_mfma_f32_32x32x16_bf16 a[128:143], v[76:79], v[72:75], a[128:143]
 v_cos_f32 v45, v29
 v_add_f32 v28, v28, v14
 v_add_u32 v8, 128, v8
 v_add_u32 v9, 128, v9
 s_add_u32 s76, s76, 32768
 s_and_b32 s76, s76, 0x1ffff
 s_waitcnt lgkmcnt(5)
 v_mfma_f32_32x32x16_bf16 a[16:31], v[80:83], v[68:71], a[16:31]
 ds_read_b128 v[104:107], v13 offset:28672
 v_cos_f32 v46, v30
 v_add_f32 v29, v29, v14
 v_cvt_pk_bf16_f32 v60, v44, v45
 v_mfma_f32_32x32x16_bf16 a[144:159], v[80:83], v[72:75], a[144:159]
 v_cos_f32 v47, v31
 v_add_f32 v30, v30, v14
 s_waitcnt vmcnt(8)
 s_barrier
 s_waitcnt lgkmcnt(5)
 v_mfma_f32_32x32x16_bf16 a[32:47], v[84:87], v[68:71], a[32:47]
 ds_read_b128 v[76:79], v10 offset:32768
 v_cos_f32 v48, v32
 v_add_f32 v31, v31, v14
 v_cvt_pk_bf16_f32 v61, v46, v47
 v_mfma_f32_32x32x16_bf16 a[160:175], v[84:87], v[72:75], a[160:175]
 v_cos_f32 v49, v33
 v_add_f32 v32, v32, v14
 s_waitcnt lgkmcnt(5)
 v_mfma_f32_32x32x16_bf16 a[48:63], v[88:91], v[68:71], a[48:63]
 ds_read_b128 v[80:83], v10 offset:36864
 v_cos_f32 v50, v34
 v_add_f32 v33, v33, v14
 v_cvt_pk_bf16_f32 v62, v48, v49
 v_cos_f32 v52, v36
 v_mfma_f32_32x32x16_bf16 a[176:191], v[88:91], v[72:75], a[176:191]
 v_cos_f32 v51, v35
 v_add_f32 v34, v34, v14
 v_cos_f32 v53, v37
 v_add_f32 v36, v36, v15
 s_waitcnt lgkmcnt(5)
 v_mfma_f32_32x32x16_bf16 a[64:79], v[92:95], v[68:71], a[64:79]
 ds_read_b128 v[84:87], v10 offset:40960
 v_add_f32 v35, v35, v14
 v_cvt_pk_bf16_f32 v63, v50, v51
 v_cos_f32 v54, v38
 v_add_f32 v37, v37, v15
 v_cvt_pk_bf16_f32 v64, v52, v53
 v_mfma_f32_32x32x16_bf16 a[192:207], v[92:95], v[72:75], a[192:207]
 v_cos_f32 v55, v39
 v_add_f32 v38, v38, v15
 s_waitcnt lgkmcnt(5)
 v_mfma_f32_32x32x16_bf16 a[80:95], v[96:99], v[68:71], a[80:95]
 ds_read_b128 v[88:91], v10 offset:45056
 v_cos_f32 v56, v40
 v_add_f32 v39, v39, v15
 v_cvt_pk_bf16_f32 v65, v54, v55
 v_mfma_f32_32x32x16_bf16 a[208:223], v[96:99], v[72:75], a[208:223]
 v_cos_f32 v57, v41
 v_add_f32 v40, v40, v15
 s_waitcnt lgkmcnt(5)
 v_mfma_f32_32x32x16_bf16 a[96:111], v[100:103], v[68:71], a[96:111]
 ds_read_b128 v[92:95], v10 offset:49152
 v_cos_f32 v58, v42
 v_add_f32 v41, v41, v15
 v_cvt_pk_bf16_f32 v66, v56, v57
 v_mfma_f32_32x32x16_bf16 a[224:239], v[100:103], v[72:75], a[224:239]
 v_cos_f32 v59, v43
 v_add_f32 v42, v42, v15
 s_waitcnt lgkmcnt(5)
 v_mfma_f32_32x32x16_bf16 a[112:127], v[104:107], v[68:71], a[112:127]
 ds_read_b128 v[96:99], v10 offset:53248
 v_add_f32 v43, v43, v15
 v_cvt_pk_bf16_f32 v67, v58, v59
 v_mfma_f32_32x32x16_bf16 a[240:255], v[104:107], v[72:75], a[240:255]
 s_waitcnt lgkmcnt(5)
 v_mfma_f32_32x32x16_bf16 a[0:15], v[76:79], v[60:63], a[0:15]
 ds_read_b128 v[100:103], v10 offset:57344
 v_cos_f32 v44, v28
 v_mfma_f32_32x32x16_bf16 a[128:143], v[76:79], v[64:67], a[128:143]
 v_cos_f32 v45, v29
 v_add_f32 v28, v28, v14
 s_waitcnt lgkmcnt(5)
 v_mfma_f32_32x32x16_bf16 a[16:31], v[80:83], v[60:63], a[16:31]
 ds_read_b128 v[104:107], v10 offset:61440
 v_xor_b32 v10, 0x10000, v10
 v_cos_f32 v46, v30
 v_add_f32 v29, v29, v14
 v_cvt_pk_bf16_f32 v68, v44, v45
 v_mfma_f32_32x32x16_bf16 a[144:159], v[80:83], v[64:67], a[144:159]
 v_cos_f32 v47, v31
 v_add_f32 v30, v30, v14
 s_waitcnt lgkmcnt(5)
 s_add_u32 m0, s76, 0
 v_mfma_f32_32x32x16_bf16 a[32:47], v[84:87], v[60:63], a[32:47]
 ds_read_b128 v[76:79], v11 offset:32768
 v_cos_f32 v48, v32
 v_add_f32 v31, v31, v14
 v_cvt_pk_bf16_f32 v69, v46, v47
 v_mfma_f32_32x32x16_bf16 a[160:175], v[84:87], v[64:67], a[160:175]
 buffer_load_dwordx4 v8, s[4:7], s78 offen sc1 lds
 v_cos_f32 v49, v33
 v_add_f32 v32, v32, v14
 s_waitcnt lgkmcnt(5)
 v_mfma_f32_32x32x16_bf16 a[48:63], v[88:91], v[60:63], a[48:63]
 ds_read_b128 v[80:83], v11 offset:36864
 v_cos_f32 v50, v34
 v_add_f32 v33, v33, v14
 v_cvt_pk_bf16_f32 v70, v48, v49
 v_cos_f32 v52, v36
 v_mfma_f32_32x32x16_bf16 a[176:191], v[88:91], v[64:67], a[176:191]
 v_cos_f32 v51, v35
 v_add_f32 v34, v34, v14
 v_cos_f32 v53, v37
 v_add_f32 v36, v36, v15
 s_waitcnt lgkmcnt(5)
 v_mfma_f32_32x32x16_bf16 a[64:79], v[92:95], v[60:63], a[64:79]
 ds_read_b128 v[84:87], v11 offset:40960
 v_add_f32 v35, v35, v14
 v_cvt_pk_bf16_f32 v71, v50, v51
 v_cos_f32 v54, v38
 v_add_f32 v37, v37, v15
 v_cvt_pk_bf16_f32 v72, v52, v53
 v_mfma_f32_32x32x16_bf16 a[192:207], v[92:95], v[64:67], a[192:207]
 v_cos_f32 v55, v39
 v_add_f32 v38, v38, v15
 s_waitcnt lgkmcnt(5)
 s_add_u32 m0, s76, 1024
 v_mfma_f32_32x32x16_bf16 a[80:95], v[96:99], v[60:63], a[80:95]
 ds_read_b128 v[88:91], v11 offset:45056
 v_cos_f32 v56, v40
 v_add_f32 v39, v39, v15
 v_cvt_pk_bf16_f32 v73, v54, v55
 v_mfma_f32_32x32x16_bf16 a[208:223], v[96:99], v[64:67], a[208:223]
 buffer_load_dwordx4 v9, s[4:7], s79 offen sc1 lds
 v_cos_f32 v57, v41
 v_add_f32 v40, v40, v15
 s_waitcnt lgkmcnt(5)
 v_mfma_f32_32x32x16_bf16 a[96:111], v[100:103], v[60:63], a[96:111]
 ds_read_b128 v[92:95], v11 offset:49152
 v_cos_f32 v58, v42
 v_add_f32 v41, v41, v15
 v_cvt_pk_bf16_f32 v74, v56, v57
 v_mfma_f32_32x32x16_bf16 a[224:239], v[100:103], v[64:67], a[224:239]
 v_cos_f32 v59, v43
 v_add_f32 v42, v42, v15
 s_waitcnt lgkmcnt(5)
 v_mfma_f32_32x32x16_bf16 a[112:127], v[104:107], v[60:63], a[112:127]
 ds_read_b128 v[96:99], v11 offset:53248
 v_add_f32 v43, v43, v15
 v_cvt_pk_bf16_f32 v75, v58, v59
 v_mfma_f32_32x32x16_bf16 a[240:255], v[104:107], v[64:67], a[240:255]
 s_waitcnt lgkmcnt(5)
 s_add_u32 m0, s76, 2048
 v_mfma_f32_32x32x16_bf16 a[0:15], v[76:79], v[68:71], a[0:15]
 ds_read_b128 v[100:103], v11 offset:57344
 v_cos_f32 v44, v28
 v_mfma_f32_32x32x16_bf16 a[128:143], v[76:79], v[72:75], a[128:143]
 buffer_load_dwordx4 v8, s[4:7], s80 offen sc1 lds
 v_cos_f32 v45, v29
 v_add_f32 v28, v28, v14
 s_waitcnt lgkmcnt(5)
 v_mfma_f32_32x32x16_bf16 a[16:31], v[80:83], v[68:71], a[16:31]
 ds_read_b128 v[104:107], v11 offset:61440
 v_xor_b32 v11, 0x10000, v11
 v_cos_f32 v46, v30
 v_add_f32 v29, v29, v14
 v_cvt_pk_bf16_f32 v60, v44, v45
 v_mfma_f32_32x32x16_bf16 a[144:159], v[80:83], v[72:75], a[144:159]
 v_cos_f32 v47, v31
 v_add_f32 v30, v30, v14
 s_waitcnt lgkmcnt(5)
 v_mfma_f32_32x32x16_bf16 a[32:47], v[84:87], v[68:71], a[32:47]
 ds_read_b128 v[76:79], v12 offset:32768
 v_cos_f32 v48, v32
 v_add_f32 v31, v31, v14
 v_cvt_pk_bf16_f32 v61, v46, v47
 v_mfma_f32_32x32x16_bf16 a[160:175], v[84:87], v[72:75], a[160:175]
 v_cos_f32 v49, v33
 v_add_f32 v32, v32, v14
 s_waitcnt lgkmcnt(5)
 s_add_u32 m0, s76, 3072
 v_mfma_f32_32x32x16_bf16 a[48:63], v[88:91], v[68:71], a[48:63]
 ds_read_b128 v[80:83], v12 offset:36864
 v_cos_f32 v50, v34
 v_add_f32 v33, v33, v14
 v_cvt_pk_bf16_f32 v62, v48, v49
 v_cos_f32 v52, v36
 v_mfma_f32_32x32x16_bf16 a[176:191], v[88:91], v[72:75], a[176:191]
 buffer_load_dwordx4 v9, s[4:7], s81 offen sc1 lds
 v_cos_f32 v51, v35
 v_add_f32 v34, v34, v14
 v_cos_f32 v53, v37
 v_add_f32 v36, v36, v15
 s_waitcnt lgkmcnt(5)
 v_mfma_f32_32x32x16_bf16 a[64:79], v[92:95], v[68:71], a[64:79]
 ds_read_b128 v[84:87], v12 offset:40960
 v_add_f32 v35, v35, v14
 v_cvt_pk_bf16_f32 v63, v50, v51
 v_cos_f32 v54, v38
 v_add_f32 v37, v37, v15
 v_cvt_pk_bf16_f32 v64, v52, v53
 v_mfma_f32_32x32x16_bf16 a[192:207], v[92:95], v[72:75], a[192:207]
 v_cos_f32 v55, v39
 v_add_f32 v38, v38, v15
 s_waitcnt lgkmcnt(5)
 v_mfma_f32_32x32x16_bf16 a[80:95], v[96:99], v[68:71], a[80:95]
 ds_read_b128 v[88:91], v12 offset:45056
 v_cos_f32 v56, v40
 v_add_f32 v39, v39, v15
 v_cvt_pk_bf16_f32 v65, v54, v55
 v_mfma_f32_32x32x16_bf16 a[208:223], v[96:99], v[72:75], a[208:223]
 v_cos_f32 v57, v41
 v_add_f32 v40, v40, v15
 s_waitcnt lgkmcnt(5)
 s_add_u32 m0, s76, 4096
 v_mfma_f32_32x32x16_bf16 a[96:111], v[100:103], v[68:71], a[96:111]
 ds_read_b128 v[92:95], v12 offset:49152
 v_cos_f32 v58, v42
 v_add_f32 v41, v41, v15
 v_cvt_pk_bf16_f32 v66, v56, v57
 v_mfma_f32_32x32x16_bf16 a[224:239], v[100:103], v[72:75], a[224:239]
 buffer_load_dwordx4 v8, s[4:7], s82 offen sc1 lds
 v_cos_f32 v59, v43
 v_add_f32 v42, v42, v15
 s_waitcnt lgkmcnt(5)
 v_mfma_f32_32x32x16_bf16 a[112:127], v[104:107], v[68:71], a[112:127]
 ds_read_b128 v[96:99], v12 offset:53248
 v_add_f32 v43, v43, v15
 v_cvt_pk_bf16_f32 v67, v58, v59
 v_mfma_f32_32x32x16_bf16 a[240:255], v[104:107], v[72:75], a[240:255]
 s_waitcnt lgkmcnt(5)
 v_mfma_f32_32x32x16_bf16 a[0:15], v[76:79], v[60:63], a[0:15]
 ds_read_b128 v[100:103], v12 offset:57344
 v_cos_f32 v44, v28
 v_mfma_f32_32x32x16_bf16 a[128:143], v[76:79], v[64:67], a[128:143]
 v_cos_f32 v45, v29
 v_add_f32 v28, v28, v14
 s_waitcnt lgkmcnt(5)
 s_add_u32 m0, s76, 5120
 v_mfma_f32_32x32x16_bf16 a[16:31], v[80:83], v[60:63], a[16:31]
 ds_read_b128 v[104:107], v12 offset:61440
 v_xor_b32 v12, 0x10000, v12
 v_cos_f32 v46, v30
 v_add_f32 v29, v29, v14
 v_cvt_pk_bf16_f32 v68, v44, v45
 v_mfma_f32_32x32x16_bf16 a[144:159], v[80:83], v[64:67], a[144:159]
 buffer_load_dwordx4 v9, s[4:7], s83 offen sc1 lds
 v_cos_f32 v47, v31
 v_add_f32 v30, v30, v14
 s_waitcnt lgkmcnt(5)
 v_mfma_f32_32x32x16_bf16 a[32:47], v[84:87], v[60:63], a[32:47]
 ds_read_b128 v[76:79], v13 offset:32768
 v_cos_f32 v48, v32
 v_add_f32 v31, v31, v14
 v_cvt_pk_bf16_f32 v69, v46, v47
 v_mfma_f32_32x32x16_bf16 a[160:175], v[84:87], v[64:67], a[160:175]
 v_cos_f32 v49, v33
 v_add_f32 v32, v32, v14
 s_waitcnt lgkmcnt(5)
 v_mfma_f32_32x32x16_bf16 a[48:63], v[88:91], v[60:63], a[48:63]
 ds_read_b128 v[80:83], v13 offset:36864
 v_cos_f32 v50, v34
 v_add_f32 v33, v33, v14
 v_cvt_pk_bf16_f32 v70, v48, v49
 v_cos_f32 v52, v36
 v_mfma_f32_32x32x16_bf16 a[176:191], v[88:91], v[64:67], a[176:191]
 v_cos_f32 v51, v35
 v_add_f32 v34, v34, v14
 v_cos_f32 v53, v37
 v_add_f32 v36, v36, v15
 s_waitcnt lgkmcnt(5)
 s_add_u32 m0, s76, 6144
 v_mfma_f32_32x32x16_bf16 a[64:79], v[92:95], v[60:63], a[64:79]
 ds_read_b128 v[84:87], v13 offset:40960
 v_add_f32 v35, v35, v14
 v_cvt_pk_bf16_f32 v71, v50, v51
 v_cos_f32 v54, v38
 v_add_f32 v37, v37, v15
 v_cvt_pk_bf16_f32 v72, v52, v53
 v_mfma_f32_32x32x16_bf16 a[192:207], v[92:95], v[64:67], a[192:207]
 buffer_load_dwordx4 v8, s[4:7], s84 offen sc1 lds
 v_cos_f32 v55, v39
 v_add_f32 v38, v38, v15
 s_waitcnt lgkmcnt(5)
 v_mfma_f32_32x32x16_bf16 a[80:95], v[96:99], v[60:63], a[80:95]
 ds_read_b128 v[88:91], v13 offset:45056
 v_cos_f32 v56, v40
 v_add_f32 v39, v39, v15
 v_cvt_pk_bf16_f32 v73, v54, v55
 v_mfma_f32_32x32x16_bf16 a[208:223], v[96:99], v[64:67], a[208:223]
 v_cos_f32 v57, v41
 v_add_f32 v40, v40, v15
 s_waitcnt lgkmcnt(5)
 v_mfma_f32_32x32x16_bf16 a[96:111], v[100:103], v[60:63], a[96:111]
 ds_read_b128 v[92:95], v13 offset:49152
 v_cos_f32 v58, v42
 v_add_f32 v41, v41, v15
 v_cvt_pk_bf16_f32 v74, v56, v57
 v_mfma_f32_32x32x16_bf16 a[224:239], v[100:103], v[64:67], a[224:239]
 v_cos_f32 v59, v43
 v_add_f32 v42, v42, v15
 s_waitcnt lgkmcnt(5)
 s_add_u32 m0, s76, 7168
 v_mfma_f32_32x32x16_bf16 a[112:127], v[104:107], v[60:63], a[112:127]
 ds_read_b128 v[96:99], v13 offset:53248
 v_add_f32 v43, v43, v15
 v_cvt_pk_bf16_f32 v75, v58, v59
 v_mfma_f32_32x32x16_bf16 a[240:255], v[104:107], v[64:67], a[240:255]
 buffer_load_dwordx4 v9, s[4:7], s85 offen sc1 lds
 s_waitcnt lgkmcnt(5)
 v_mfma_f32_32x32x16_bf16 a[0:15], v[76:79], v[68:71], a[0:15]
 ds_read_b128 v[100:103], v13 offset:57344
 v_cos_f32 v44, v28
 v_mfma_f32_32x32x16_bf16 a[128:143], v[76:79], v[72:75], a[128:143]
 v_cos_f32 v45, v29
 v_add_f32 v28, v28, v14
 v_add_u32 v8, 128, v8
 v_add_u32 v9, 128, v9
 s_add_u32 s76, s76, 32768
 s_and_b32 s76, s76, 0x1ffff
 s_waitcnt lgkmcnt(5)
 v_mfma_f32_32x32x16_bf16 a[16:31], v[80:83], v[68:71], a[16:31]
 ds_read_b128 v[104:107], v13 offset:61440
 v_xor_b32 v13, 0x10000, v13
 v_cos_f32 v46, v30
 v_add_f32 v29, v29, v14
 v_cvt_pk_bf16_f32 v60, v44, v45
 v_mfma_f32_32x32x16_bf16 a[144:159], v[80:83], v[72:75], a[144:159]
 v_cos_f32 v47, v31
 v_add_f32 v30, v30, v14
 s_waitcnt vmcnt(8)
 s_barrier
 s_waitcnt lgkmcnt(5)
 v_mfma_f32_32x32x16_bf16 a[32:47], v[84:87], v[68:71], a[32:47]
 ds_read_b128 v[76:79], v10 offset:0
 v_cos_f32 v48, v32
 v_add_f32 v31, v31, v14
 v_cvt_pk_bf16_f32 v61, v46, v47
 v_mfma_f32_32x32x16_bf16 a[160:175], v[84:87], v[72:75], a[160:175]
 v_cos_f32 v49, v33
 v_add_f32 v32, v32, v14
 s_waitcnt lgkmcnt(5)
 v_mfma_f32_32x32x16_bf16 a[48:63], v[88:91], v[68:71], a[48:63]
 ds_read_b128 v[80:83], v10 offset:4096
 v_cos_f32 v50, v34
 v_add_f32 v33, v33, v14
 v_cvt_pk_bf16_f32 v62, v48, v49
 v_cos_f32 v52, v36
 v_mfma_f32_32x32x16_bf16 a[176:191], v[88:91], v[72:75], a[176:191]
 v_cos_f32 v51, v35
 v_add_f32 v34, v34, v14
 v_cos_f32 v53, v37
 v_add_f32 v36, v36, v15
 s_waitcnt lgkmcnt(5)
 v_mfma_f32_32x32x16_bf16 a[64:79], v[92:95], v[68:71], a[64:79]
 ds_read_b128 v[84:87], v10 offset:8192
 v_add_f32 v35, v35, v14
 v_cvt_pk_bf16_f32 v63, v50, v51
 v_cos_f32 v54, v38
 v_add_f32 v37, v37, v15
 v_cvt_pk_bf16_f32 v64, v52, v53
 v_mfma_f32_32x32x16_bf16 a[192:207], v[92:95], v[72:75], a[192:207]
 v_cos_f32 v55, v39
 v_add_f32 v38, v38, v15
 s_waitcnt lgkmcnt(5)
 v_mfma_f32_32x32x16_bf16 a[80:95], v[96:99], v[68:71], a[80:95]
 ds_read_b128 v[88:91], v10 offset:12288
 v_cos_f32 v56, v40
 v_add_f32 v39, v39, v15
 v_cvt_pk_bf16_f32 v65, v54, v55
 v_mfma_f32_32x32x16_bf16 a[208:223], v[96:99], v[72:75], a[208:223]
 v_cos_f32 v57, v41
 v_add_f32 v40, v40, v15
 s_waitcnt lgkmcnt(5)
 v_mfma_f32_32x32x16_bf16 a[96:111], v[100:103], v[68:71], a[96:111]
 ds_read_b128 v[92:95], v10 offset:16384
 v_cos_f32 v58, v42
 v_add_f32 v41, v41, v15
 v_cvt_pk_bf16_f32 v66, v56, v57
 v_mfma_f32_32x32x16_bf16 a[224:239], v[100:103], v[72:75], a[224:239]
 v_cos_f32 v59, v43
 v_add_f32 v42, v42, v15
 s_waitcnt lgkmcnt(5)
 v_mfma_f32_32x32x16_bf16 a[112:127], v[104:107], v[68:71], a[112:127]
 ds_read_b128 v[96:99], v10 offset:20480
 v_add_f32 v43, v43, v15
 v_cvt_pk_bf16_f32 v67, v58, v59
 v_mfma_f32_32x32x16_bf16 a[240:255], v[104:107], v[72:75], a[240:255]
 s_sub_u32 s75, s75, 1
 s_cmp_lg_u32 s75, 0
 s_cbranch_scc1 L_f_loop_133
 s_waitcnt vmcnt(0) lgkmcnt(0)
 s_barrier
 s_nop 11
 v_and_b32 v1, 7, v0
 v_lshlrev_b32 v2, 1, v6
 v_xor_b32 v1, v1, v2
 v_lshlrev_b32 v1, 4, v1
 v_lshl_add_u32 v1, v5, 9, v1
 s_lshl_b32 s66, s62, 15
 v_add_u32 v28, s66, v1
 v_xor_b32 v29, 16, v28
 v_xor_b32 v30, 64, v28
 v_xor_b32 v31, 80, v28
 v_accvgpr_read_b32 v108, a0
 v_accvgpr_read_b32 v124, a16
 v_accvgpr_read_b32 v109, a1
 v_accvgpr_read_b32 v125, a17
 v_accvgpr_read_b32 v110, a2
 v_accvgpr_read_b32 v126, a18
 v_accvgpr_read_b32 v111, a3
 v_accvgpr_read_b32 v127, a19
 v_accvgpr_read_b32 v112, a4
 v_accvgpr_read_b32 v128, a20
 v_accvgpr_read_b32 v113, a5
 v_accvgpr_read_b32 v129, a21
 v_accvgpr_read_b32 v114, a6
 v_accvgpr_read_b32 v130, a22
 v_accvgpr_read_b32 v115, a7
 v_accvgpr_read_b32 v131, a23
 v_accvgpr_read_b32 v116, a8
 v_accvgpr_read_b32 v132, a24
 v_accvgpr_read_b32 v117, a9
 v_accvgpr_read_b32 v133, a25
 v_accvgpr_read_b32 v118, a10
 v_accvgpr_read_b32 v134, a26
 v_accvgpr_read_b32 v119, a11
 v_accvgpr_read_b32 v135, a27
 v_accvgpr_read_b32 v120, a12
 v_accvgpr_read_b32 v136, a28
 v_accvgpr_read_b32 v121, a13
 v_accvgpr_read_b32 v137, a29
 v_accvgpr_read_b32 v122, a14
 v_accvgpr_read_b32 v138, a30
 v_accvgpr_read_b32 v123, a15
 v_accvgpr_read_b32 v139, a31
 v_cvt_pk_bf16_f32 v108, v108, v109
 v_cvt_pk_bf16_f32 v109, v110, v111
 v_cvt_pk_bf16_f32 v110, v112, v113
 v_cvt_pk_bf16_f32 v111, v114, v115
 v_cvt_pk_bf16_f32 v112, v116, v117
 v_cvt_pk_bf16_f32 v113, v118, v119
 v_cvt_pk_bf16_f32 v114, v120, v121
 v_cvt_pk_bf16_f32 v115, v122, v123
 ds_write_b128 v28, v[108:111] offset:0
 ds_write_b128 v29, v[112:115] offset:0
 v_cvt_pk_bf16_f32 v124, v124, v125
 v_cvt_pk_bf16_f32 v125, v126, v127
 v_cvt_pk_bf16_f32 v126, v128, v129
 v_cvt_pk_bf16_f32 v127, v130, v131
 v_cvt_pk_bf16_f32 v128, v132, v133
 v_cvt_pk_bf16_f32 v129, v134, v135
 v_cvt_pk_bf16_f32 v130, v136, v137
 v_cvt_pk_bf16_f32 v131, v138, v139
 ds_write_b128 v30, v[124:127] offset:0
 ds_write_b128 v31, v[128:131] offset:0
 v_accvgpr_read_b32 v156, a32
 v_accvgpr_read_b32 v172, a48
 v_accvgpr_read_b32 v157, a33
 v_accvgpr_read_b32 v173, a49
 v_accvgpr_read_b32 v158, a34
 v_accvgpr_read_b32 v174, a50
 v_accvgpr_read_b32 v159, a35
 v_accvgpr_read_b32 v175, a51
 v_accvgpr_read_b32 v160, a36
 v_accvgpr_read_b32 v176, a52
 v_accvgpr_read_b32 v161, a37
 v_accvgpr_read_b32 v177, a53
 v_accvgpr_read_b32 v162, a38
 v_accvgpr_read_b32 v178, a54
 v_accvgpr_read_b32 v163, a39
 v_accvgpr_read_b32 v179, a55
 v_accvgpr_read_b32 v164, a40
 v_accvgpr_read_b32 v180, a56
 v_accvgpr_read_b32 v165, a41
 v_accvgpr_read_b32 v181, a57
 v_accvgpr_read_b32 v166, a42
 v_accvgpr_read_b32 v182, a58
 v_accvgpr_read_b32 v167, a43
 v_accvgpr_read_b32 v183, a59
 v_accvgpr_read_b32 v168, a44
 v_accvgpr_read_b32 v184, a60
 v_accvgpr_read_b32 v169, a45
 v_accvgpr_read_b32 v185, a61
 v_accvgpr_read_b32 v170, a46
 v_accvgpr_read_b32 v186, a62
 v_accvgpr_read_b32 v171, a47
 v_accvgpr_read_b32 v187, a63
 v_cvt_pk_bf16_f32 v156, v156, v157
 v_cvt_pk_bf16_f32 v157, v158, v159
 v_cvt_pk_bf16_f32 v158, v160, v161
 v_cvt_pk_bf16_f32 v159, v162, v163
 v_cvt_pk_bf16_f32 v160, v164, v165
 v_cvt_pk_bf16_f32 v161, v166, v167
 v_cvt_pk_bf16_f32 v162, v168, v169
 v_cvt_pk_bf16_f32 v163, v170, v171
 ds_write_b128 v28, v[156:159] offset:128
 ds_write_b128 v29, v[160:163] offset:128
 v_cvt_pk_bf16_f32 v172, v172, v173
 v_cvt_pk_bf16_f32 v173, v174, v175
 v_cvt_pk_bf16_f32 v174, v176, v177
 v_cvt_pk_bf16_f32 v175, v178, v179
 v_cvt_pk_bf16_f32 v176, v180, v181
 v_cvt_pk_bf16_f32 v177, v182, v183
 v_cvt_pk_bf16_f32 v178, v184, v185
 v_cvt_pk_bf16_f32 v179, v186, v187
 ds_write_b128 v30, v[172:175] offset:128
 ds_write_b128 v31, v[176:179] offset:128
 v_accvgpr_read_b32 v108, a64
 v_accvgpr_read_b32 v124, a80
 v_accvgpr_read_b32 v109, a65
 v_accvgpr_read_b32 v125, a81
 v_accvgpr_read_b32 v110, a66
 v_accvgpr_read_b32 v126, a82
 v_accvgpr_read_b32 v111, a67
 v_accvgpr_read_b32 v127, a83
 v_accvgpr_read_b32 v112, a68
 v_accvgpr_read_b32 v128, a84
 v_accvgpr_read_b32 v113, a69
 v_accvgpr_read_b32 v129, a85
 v_accvgpr_read_b32 v114, a70
 v_accvgpr_read_b32 v130, a86
 v_accvgpr_read_b32 v115, a71
 v_accvgpr_read_b32 v131, a87
 v_accvgpr_read_b32 v116, a72
 v_accvgpr_read_b32 v132, a88
 v_accvgpr_read_b32 v117, a73
 v_accvgpr_read_b32 v133, a89
 v_accvgpr_read_b32 v118, a74
 v_accvgpr_read_b32 v134, a90
 v_accvgpr_read_b32 v119, a75
 v_accvgpr_read_b32 v135, a91
 v_accvgpr_read_b32 v120, a76
 v_accvgpr_read_b32 v136, a92
 v_accvgpr_read_b32 v121, a77
 v_accvgpr_read_b32 v137, a93
 v_accvgpr_read_b32 v122, a78
 v_accvgpr_read_b32 v138, a94
 v_accvgpr_read_b32 v123, a79
 v_accvgpr_read_b32 v139, a95
 v_cvt_pk_bf16_f32 v108, v108, v109
 v_cvt_pk_bf16_f32 v109, v110, v111
 v_cvt_pk_bf16_f32 v110, v112, v113
 v_cvt_pk_bf16_f32 v111, v114, v115
 v_cvt_pk_bf16_f32 v112, v116, v117
 v_cvt_pk_bf16_f32 v113, v118, v119
 v_cvt_pk_bf16_f32 v114, v120, v121
 v_cvt_pk_bf16_f32 v115, v122, v123
 ds_write_b128 v28, v[108:111] offset:256
 ds_write_b128 v29, v[112:115] offset:256
 v_cvt_pk_bf16_f32 v124, v124, v125
 v_cvt_pk_bf16_f32 v125, v126, v127
 v_cvt_pk_bf16_f32 v126, v128, v129
 v_cvt_pk_bf16_f32 v127, v130, v131
 v_cvt_pk_bf16_f32 v128, v132, v133
 v_cvt_pk_bf16_f32 v129, v134, v135
 v_cvt_pk_bf16_f32 v130, v136, v137
 v_cvt_pk_bf16_f32 v131, v138, v139
 ds_write_b128 v30, v[124:127] offset:256
 ds_write_b128 v31, v[128:131] offset:256
 v_accvgpr_read_b32 v156, a96
 v_accvgpr_read_b32 v172, a112
 v_accvgpr_read_b32 v157, a97
 v_accvgpr_read_b32 v173, a113
 v_accvgpr_read_b32 v158, a98
 v_accvgpr_read_b32 v174, a114
 v_accvgpr_read_b32 v159, a99
 v_accvgpr_read_b32 v175, a115
 v_accvgpr_read_b32 v160, a100
 v_accvgpr_read_b32 v176, a116
 v_accvgpr_read_b32 v161, a101
 v_accvgpr_read_b32 v177, a117
 v_accvgpr_read_b32 v162, a102
 v_accvgpr_read_b32 v178, a118
 v_accvgpr_read_b32 v163, a103
 v_accvgpr_read_b32 v179, a119
 v_accvgpr_read_b32 v164, a104
 v_accvgpr_read_b32 v180, a120
 v_accvgpr_read_b32 v165, a105
 v_accvgpr_read_b32 v181, a121
 v_accvgpr_read_b32 v166, a106
 v_accvgpr_read_b32 v182, a122
 v_accvgpr_read_b32 v167, a107
 v_accvgpr_read_b32 v183, a123
 v_accvgpr_read_b32 v168, a108
 v_accvgpr_read_b32 v184, a124
 v_accvgpr_read_b32 v169, a109
 v_accvgpr_read_b32 v185, a125
 v_accvgpr_read_b32 v170, a110
 v_accvgpr_read_b32 v186, a126
 v_accvgpr_read_b32 v171, a111
 v_accvgpr_read_b32 v187, a127
 v_cvt_pk_bf16_f32 v156, v156, v157
 v_cvt_pk_bf16_f32 v157, v158, v159
 v_cvt_pk_bf16_f32 v158, v160, v161
 v_cvt_pk_bf16_f32 v159, v162, v163
 v_cvt_pk_bf16_f32 v160, v164, v165
 v_cvt_pk_bf16_f32 v161, v166, v167
 v_cvt_pk_bf16_f32 v162, v168, v169
 v_cvt_pk_bf16_f32 v163, v170, v171
 ds_write_b128 v28, v[156:159] offset:384
 ds_write_b128 v29, v[160:163] offset:384
 v_cvt_pk_bf16_f32 v172, v172, v173
 v_cvt_pk_bf16_f32 v173, v174, v175
 v_cvt_pk_bf16_f32 v174, v176, v177
 v_cvt_pk_bf16_f32 v175, v178, v179
 v_cvt_pk_bf16_f32 v176, v180, v181
 v_cvt_pk_bf16_f32 v177, v182, v183
 v_cvt_pk_bf16_f32 v178, v184, v185
 v_cvt_pk_bf16_f32 v179, v186, v187
 ds_write_b128 v30, v[172:175] offset:384
 ds_write_b128 v31, v[176:179] offset:384
 v_accvgpr_read_b32 v108, a128
 v_accvgpr_read_b32 v124, a144
 v_accvgpr_read_b32 v109, a129
 v_accvgpr_read_b32 v125, a145
 v_accvgpr_read_b32 v110, a130
 v_accvgpr_read_b32 v126, a146
 v_accvgpr_read_b32 v111, a131
 v_accvgpr_read_b32 v127, a147
 v_accvgpr_read_b32 v112, a132
 v_accvgpr_read_b32 v128, a148
 v_accvgpr_read_b32 v113, a133
 v_accvgpr_read_b32 v129, a149
 v_accvgpr_read_b32 v114, a134
 v_accvgpr_read_b32 v130, a150
 v_accvgpr_read_b32 v115, a135
 v_accvgpr_read_b32 v131, a151
 v_accvgpr_read_b32 v116, a136
 v_accvgpr_read_b32 v132, a152
 v_accvgpr_read_b32 v117, a137
 v_accvgpr_read_b32 v133, a153
 v_accvgpr_read_b32 v118, a138
 v_accvgpr_read_b32 v134, a154
 v_accvgpr_read_b32 v119, a139
 v_accvgpr_read_b32 v135, a155
 v_accvgpr_read_b32 v120, a140
 v_accvgpr_read_b32 v136, a156
 v_accvgpr_read_b32 v121, a141
 v_accvgpr_read_b32 v137, a157
 v_accvgpr_read_b32 v122, a142
 v_accvgpr_read_b32 v138, a158
 v_accvgpr_read_b32 v123, a143
 v_accvgpr_read_b32 v139, a159
 v_cvt_pk_bf16_f32 v108, v108, v109
 v_cvt_pk_bf16_f32 v109, v110, v111
 v_cvt_pk_bf16_f32 v110, v112, v113
 v_cvt_pk_bf16_f32 v111, v114, v115
 v_cvt_pk_bf16_f32 v112, v116, v117
 v_cvt_pk_bf16_f32 v113, v118, v119
 v_cvt_pk_bf16_f32 v114, v120, v121
 v_cvt_pk_bf16_f32 v115, v122, v123
 ds_write_b128 v28, v[108:111] offset:16384
 ds_write_b128 v29, v[112:115] offset:16384
 v_cvt_pk_bf16_f32 v124, v124, v125
 v_cvt_pk_bf16_f32 v125, v126, v127
 v_cvt_pk_bf16_f32 v126, v128, v129
 v_cvt_pk_bf16_f32 v127, v130, v131
 v_cvt_pk_bf16_f32 v128, v132, v133
 v_cvt_pk_bf16_f32 v129, v134, v135
 v_cvt_pk_bf16_f32 v130, v136, v137
 v_cvt_pk_bf16_f32 v131, v138, v139
 ds_write_b128 v30, v[124:127] offset:16384
 ds_write_b128 v31, v[128:131] offset:16384
 v_accvgpr_read_b32 v156, a160
 v_accvgpr_read_b32 v172, a176
 v_accvgpr_read_b32 v157, a161
 v_accvgpr_read_b32 v173, a177
 v_accvgpr_read_b32 v158, a162
 v_accvgpr_read_b32 v174, a178
 v_accvgpr_read_b32 v159, a163
 v_accvgpr_read_b32 v175, a179
 v_accvgpr_read_b32 v160, a164
 v_accvgpr_read_b32 v176, a180
 v_accvgpr_read_b32 v161, a165
 v_accvgpr_read_b32 v177, a181
 v_accvgpr_read_b32 v162, a166
 v_accvgpr_read_b32 v178, a182
 v_accvgpr_read_b32 v163, a167
 v_accvgpr_read_b32 v179, a183
 v_accvgpr_read_b32 v164, a168
 v_accvgpr_read_b32 v180, a184
 v_accvgpr_read_b32 v165, a169
 v_accvgpr_read_b32 v181, a185
 v_accvgpr_read_b32 v166, a170
 v_accvgpr_read_b32 v182, a186
 v_accvgpr_read_b32 v167, a171
 v_accvgpr_read_b32 v183, a187
 v_accvgpr_read_b32 v168, a172
 v_accvgpr_read_b32 v184, a188
 v_accvgpr_read_b32 v169, a173
 v_accvgpr_read_b32 v185, a189
 v_accvgpr_read_b32 v170, a174
 v_accvgpr_read_b32 v186, a190
 v_accvgpr_read_b32 v171, a175
 v_accvgpr_read_b32 v187, a191
 v_cvt_pk_bf16_f32 v156, v156, v157
 v_cvt_pk_bf16_f32 v157, v158, v159
 v_cvt_pk_bf16_f32 v158, v160, v161
 v_cvt_pk_bf16_f32 v159, v162, v163
 v_cvt_pk_bf16_f32 v160, v164, v165
 v_cvt_pk_bf16_f32 v161, v166, v167
 v_cvt_pk_bf16_f32 v162, v168, v169
 v_cvt_pk_bf16_f32 v163, v170, v171
 ds_write_b128 v28, v[156:159] offset:16512
 ds_write_b128 v29, v[160:163] offset:16512
 v_cvt_pk_bf16_f32 v172, v172, v173
 v_cvt_pk_bf16_f32 v173, v174, v175
 v_cvt_pk_bf16_f32 v174, v176, v177
 v_cvt_pk_bf16_f32 v175, v178, v179
 v_cvt_pk_bf16_f32 v176, v180, v181
 v_cvt_pk_bf16_f32 v177, v182, v183
 v_cvt_pk_bf16_f32 v178, v184, v185
 v_cvt_pk_bf16_f32 v179, v186, v187
 ds_write_b128 v30, v[172:175] offset:16512
 ds_write_b128 v31, v[176:179] offset:16512
 v_accvgpr_read_b32 v108, a192
 v_accvgpr_read_b32 v124, a208
 v_accvgpr_read_b32 v109, a193
 v_accvgpr_read_b32 v125, a209
 v_accvgpr_read_b32 v110, a194
 v_accvgpr_read_b32 v126, a210
 v_accvgpr_read_b32 v111, a195
 v_accvgpr_read_b32 v127, a211
 v_accvgpr_read_b32 v112, a196
 v_accvgpr_read_b32 v128, a212
 v_accvgpr_read_b32 v113, a197
 v_accvgpr_read_b32 v129, a213
 v_accvgpr_read_b32 v114, a198
 v_accvgpr_read_b32 v130, a214
 v_accvgpr_read_b32 v115, a199
 v_accvgpr_read_b32 v131, a215
 v_accvgpr_read_b32 v116, a200
 v_accvgpr_read_b32 v132, a216
 v_accvgpr_read_b32 v117, a201
 v_accvgpr_read_b32 v133, a217
 v_accvgpr_read_b32 v118, a202
 v_accvgpr_read_b32 v134, a218
 v_accvgpr_read_b32 v119, a203
 v_accvgpr_read_b32 v135, a219
 v_accvgpr_read_b32 v120, a204
 v_accvgpr_read_b32 v136, a220
 v_accvgpr_read_b32 v121, a205
 v_accvgpr_read_b32 v137, a221
 v_accvgpr_read_b32 v122, a206
 v_accvgpr_read_b32 v138, a222
 v_accvgpr_read_b32 v123, a207
 v_accvgpr_read_b32 v139, a223
 v_cvt_pk_bf16_f32 v108, v108, v109
 v_cvt_pk_bf16_f32 v109, v110, v111
 v_cvt_pk_bf16_f32 v110, v112, v113
 v_cvt_pk_bf16_f32 v111, v114, v115
 v_cvt_pk_bf16_f32 v112, v116, v117
 v_cvt_pk_bf16_f32 v113, v118, v119
 v_cvt_pk_bf16_f32 v114, v120, v121
 v_cvt_pk_bf16_f32 v115, v122, v123
 ds_write_b128 v28, v[108:111] offset:16640
 ds_write_b128 v29, v[112:115] offset:16640
 v_cvt_pk_bf16_f32 v124, v124, v125
 v_cvt_pk_bf16_f32 v125, v126, v127
 v_cvt_pk_bf16_f32 v126, v128, v129
 v_cvt_pk_bf16_f32 v127, v130, v131
 v_cvt_pk_bf16_f32 v128, v132, v133
 v_cvt_pk_bf16_f32 v129, v134, v135
 v_cvt_pk_bf16_f32 v130, v136, v137
 v_cvt_pk_bf16_f32 v131, v138, v139
 ds_write_b128 v30, v[124:127] offset:16640
 ds_write_b128 v31, v[128:131] offset:16640
 v_accvgpr_read_b32 v156, a224
 v_accvgpr_read_b32 v172, a240
 v_accvgpr_read_b32 v157, a225
 v_accvgpr_read_b32 v173, a241
 v_accvgpr_read_b32 v158, a226
 v_accvgpr_read_b32 v174, a242
 v_accvgpr_read_b32 v159, a227
 v_accvgpr_read_b32 v175, a243
 v_accvgpr_read_b32 v160, a228
 v_accvgpr_read_b32 v176, a244
 v_accvgpr_read_b32 v161, a229
 v_accvgpr_read_b32 v177, a245
 v_accvgpr_read_b32 v162, a230
 v_accvgpr_read_b32 v178, a246
 v_accvgpr_read_b32 v163, a231
 v_accvgpr_read_b32 v179, a247
 v_accvgpr_read_b32 v164, a232
 v_accvgpr_read_b32 v180, a248
 v_accvgpr_read_b32 v165, a233
 v_accvgpr_read_b32 v181, a249
 v_accvgpr_read_b32 v166, a234
 v_accvgpr_read_b32 v182, a250
 v_accvgpr_read_b32 v167, a235
 v_accvgpr_read_b32 v183, a251
 v_accvgpr_read_b32 v168, a236
 v_accvgpr_read_b32 v184, a252
 v_accvgpr_read_b32 v169, a237
 v_accvgpr_read_b32 v185, a253
 v_accvgpr_read_b32 v170, a238
 v_accvgpr_read_b32 v186, a254
 v_accvgpr_read_b32 v171, a239
 v_accvgpr_read_b32 v187, a255
 v_cvt_pk_bf16_f32 v156, v156, v157
 v_cvt_pk_bf16_f32 v157, v158, v159
 v_cvt_pk_bf16_f32 v158, v160, v161
 v_cvt_pk_bf16_f32 v159, v162, v163
 v_cvt_pk_bf16_f32 v160, v164, v165
 v_cvt_pk_bf16_f32 v161, v166, v167
 v_cvt_pk_bf16_f32 v162, v168, v169
 v_cvt_pk_bf16_f32 v163, v170, v171
 ds_write_b128 v28, v[156:159] offset:16768
 ds_write_b128 v29, v[160:163] offset:16768
 v_cvt_pk_bf16_f32 v172, v172, v173
 v_cvt_pk_bf16_f32 v173, v174, v175
 v_cvt_pk_bf16_f32 v174, v176, v177
 v_cvt_pk_bf16_f32 v175, v178, v179
 v_cvt_pk_bf16_f32 v176, v180, v181
 v_cvt_pk_bf16_f32 v177, v182, v183
 v_cvt_pk_bf16_f32 v178, v184, v185
 v_cvt_pk_bf16_f32 v179, v186, v187
 ds_write_b128 v30, v[172:175] offset:16768
 ds_write_b128 v31, v[176:179] offset:16768
 s_lshl_b32 s66, s73, 2
 s_add_u32 s66, s66, s72
 s_lshl_b32 s86, s66, 19
 s_lshl_b32 s66, s74, 9
 s_add_u32 s86, s86, s66
 s_add_u32 s86, s86, 0x5c00000
 s_waitcnt lgkmcnt(0)
 s_barrier
 v_lshrrev_b32 v1, 4, v5
 v_mul_u32_u24 v1, 256, v1
 v_and_b32 v2, 15, v0
 v_lshl_add_u32 v1, v2, 4, v1
 v_mul_u32_u24 v2, 2048, v6
 v_add_u32 v16, v1, v2
 s_mul_i32 s65, s62, 131072
 s_add_u32 s65, s65, s86
 s_lshl_b32 s66, s62, 15
 v_xor_b32 v1, v5, v6
 v_lshlrev_b32 v1, 4, v1
 v_lshl_add_u32 v1, v6, 9, v1
 v_add_u32 v18, s66, v1
 v_xor_b32 v28, 0, v18
 v_xor_b32 v29, 32, v18
 v_xor_b32 v30, 64, v18
 v_xor_b32 v31, 96, v18
 ds_read_b128 v[108:111], v28 offset:0
 ds_read_b128 v[112:115], v29 offset:1024
 ds_read_b128 v[116:119], v30 offset:2048
 ds_read_b128 v[120:123], v31 offset:3072
 ds_read_b128 v[124:127], v28 offset:4096
 ds_read_b128 v[128:131], v29 offset:5120
 ds_read_b128 v[132:135], v30 offset:6144
 ds_read_b128 v[136:139], v31 offset:7168
 ds_read_b128 v[140:143], v28 offset:8192
 ds_read_b128 v[144:147], v29 offset:9216
 ds_read_b128 v[148:151], v30 offset:10240
 ds_read_b128 v[152:155], v31 offset:11264
 ds_read_b128 v[156:159], v28 offset:12288
 ds_read_b128 v[160:163], v29 offset:13312
 ds_read_b128 v[164:167], v30 offset:14336
 ds_read_b128 v[168:171], v31 offset:15360
 ds_read_b128 v[172:175], v28 offset:16384
 ds_read_b128 v[176:179], v29 offset:17408
 ds_read_b128 v[180:183], v30 offset:18432
 ds_read_b128 v[184:187], v31 offset:19456
 ds_read_b128 v[188:191], v28 offset:20480
 ds_read_b128 v[192:195], v29 offset:21504
 ds_read_b128 v[196:199], v30 offset:22528
 ds_read_b128 v[200:203], v31 offset:23552
 ds_read_b128 v[204:207], v28 offset:24576
 ds_read_b128 v[208:211], v29 offset:25600
 ds_read_b128 v[212:215], v30 offset:26624
 ds_read_b128 v[216:219], v31 offset:27648
 ds_read_b128 v[220:223], v28 offset:28672
 ds_read_b128 v[224:227], v29 offset:29696
 ds_read_b128 v[228:231], v30 offset:30720
 ds_read_b128 v[232:235], v31 offset:31744
 s_waitcnt lgkmcnt(15)
 buffer_store_dwordx4 v[108:111], v16, s[4:7], s65 offen sc1
 s_add_u32 s65, s65, 4096
 s_sleep 4
 buffer_store_dwordx4 v[112:115], v16, s[4:7], s65 offen sc1
 s_add_u32 s65, s65, 4096
 s_sleep 4
 buffer_store_dwordx4 v[116:119], v16, s[4:7], s65 offen sc1
 s_add_u32 s65, s65, 4096
 s_sleep 4
 buffer_store_dwordx4 v[120:123], v16, s[4:7], s65 offen sc1
 s_add_u32 s65, s65, 4096
 s_sleep 4
 buffer_store_dwordx4 v[124:127], v16, s[4:7], s65 offen sc1
 s_add_u32 s65, s65, 4096
 s_sleep 4
 buffer_store_dwordx4 v[128:131], v16, s[4:7], s65 offen sc1
 s_add_u32 s65, s65, 4096
 s_sleep 4
 buffer_store_dwordx4 v[132:135], v16, s[4:7], s65 offen sc1
 s_add_u32 s65, s65, 4096
 s_sleep 4
 buffer_store_dwordx4 v[136:139], v16, s[4:7], s65 offen sc1
 s_add_u32 s65, s65, 4096
 s_sleep 4
 buffer_store_dwordx4 v[140:143], v16, s[4:7], s65 offen sc1
 s_add_u32 s65, s65, 4096
 s_sleep 4
 buffer_store_dwordx4 v[144:147], v16, s[4:7], s65 offen sc1
 s_add_u32 s65, s65, 4096
 s_sleep 4
 buffer_store_dwordx4 v[148:151], v16, s[4:7], s65 offen sc1
 s_add_u32 s65, s65, 4096
 s_sleep 4
 buffer_store_dwordx4 v[152:155], v16, s[4:7], s65 offen sc1
 s_add_u32 s65, s65, 4096
 s_sleep 4
 buffer_store_dwordx4 v[156:159], v16, s[4:7], s65 offen sc1
 s_add_u32 s65, s65, 4096
 s_sleep 4
 buffer_store_dwordx4 v[160:163], v16, s[4:7], s65 offen sc1
 s_add_u32 s65, s65, 4096
 s_sleep 4
 buffer_store_dwordx4 v[164:167], v16, s[4:7], s65 offen sc1
 s_add_u32 s65, s65, 4096
 s_sleep 4
 buffer_store_dwordx4 v[168:171], v16, s[4:7], s65 offen sc1
 s_add_u32 s65, s65, 4096
 s_sleep 4
 buffer_store_dwordx4 v[172:175], v16, s[4:7], s65 offen sc1
 s_add_u32 s65, s65, 4096
 s_sleep 4
 s_waitcnt lgkmcnt(14)
 buffer_store_dwordx4 v[176:179], v16, s[4:7], s65 offen sc1
 s_add_u32 s65, s65, 4096
 s_sleep 4
 s_waitcnt lgkmcnt(13)
 buffer_store_dwordx4 v[180:183], v16, s[4:7], s65 offen sc1
 s_add_u32 s65, s65, 4096
 s_sleep 4
 s_waitcnt lgkmcnt(12)
 buffer_store_dwordx4 v[184:187], v16, s[4:7], s65 offen sc1
 s_add_u32 s65, s65, 4096
 s_sleep 4
 s_waitcnt lgkmcnt(11)
 buffer_store_dwordx4 v[188:191], v16, s[4:7], s65 offen sc1
 s_add_u32 s65, s65, 4096
 s_sleep 4
 s_waitcnt lgkmcnt(10)
 buffer_store_dwordx4 v[192:195], v16, s[4:7], s65 offen sc1
 s_add_u32 s65, s65, 4096
 s_sleep 4
 s_waitcnt lgkmcnt(9)
 buffer_store_dwordx4 v[196:199], v16, s[4:7], s65 offen sc1
 s_add_u32 s65, s65, 4096
 s_sleep 4
 s_waitcnt lgkmcnt(8)
 buffer_store_dwordx4 v[200:203], v16, s[4:7], s65 offen sc1
 s_add_u32 s65, s65, 4096
 s_sleep 4
 s_waitcnt lgkmcnt(7)
 buffer_store_dwordx4 v[204:207], v16, s[4:7], s65 offen sc1
 s_add_u32 s65, s65, 4096
 s_sleep 4
 s_waitcnt lgkmcnt(6)
 buffer_store_dwordx4 v[208:211], v16, s[4:7], s65 offen sc1
 s_add_u32 s65, s65, 4096
 s_sleep 4
 s_waitcnt lgkmcnt(5)
 buffer_store_dwordx4 v[212:215], v16, s[4:7], s65 offen sc1
 s_add_u32 s65, s65, 4096
 s_sleep 4
 s_waitcnt lgkmcnt(4)
 buffer_store_dwordx4 v[216:219], v16, s[4:7], s65 offen sc1
 s_add_u32 s65, s65, 4096
 s_sleep 4
 s_waitcnt lgkmcnt(3)
 buffer_store_dwordx4 v[220:223], v16, s[4:7], s65 offen sc1
 s_add_u32 s65, s65, 4096
 s_sleep 4
 s_waitcnt lgkmcnt(2)
 buffer_store_dwordx4 v[224:227], v16, s[4:7], s65 offen sc1
 s_add_u32 s65, s65, 4096
 s_sleep 4
 s_waitcnt lgkmcnt(1)
 buffer_store_dwordx4 v[228:231], v16, s[4:7], s65 offen sc1
 s_add_u32 s65, s65, 4096
 s_sleep 4
 s_waitcnt lgkmcnt(0)
 buffer_store_dwordx4 v[232:235], v16, s[4:7], s65 offen sc1
 s_add_u32 s65, s65, 4096
 s_sleep 4
 s_waitcnt vmcnt(0)
 s_barrier
 s_cmp_eq_u32 s62, 0
 s_cbranch_scc0 L_nosig_134
 s_add_u32 s65, s101, 16
 s_mov_b32 s66, 0x1
 s_atomic_add s66, s[56:57], s65
 s_waitcnt lgkmcnt(0)
L_nosig_134:
 s_cmp_eq_u32 s62, 0
 s_cbranch_scc0 L_fb_skip_135
 v_mov_b32 v1, 16
L_wc_136:
 buffer_load_dword v2, v1, s[16:19], s101 offen sc1
 s_waitcnt vmcnt(0)
 v_readfirstlane_b32 s65, v2
 s_nop 3
 s_cmp_ge_u32 s65, 32
 s_cbranch_scc1 L_wcok_137
 s_sleep 10
 s_sub_u32 s63, s63, 1
 s_cbranch_scc0 L_wc_136
 s_endpgm
L_wcok_137:
L_fb_skip_135:
 s_barrier
 s_mov_b32 s73, 0
 s_lshl_b32 s65, s62, 7
 s_add_u32 s65, s65, s60
 s_mul_i32 s65, s65, 8192
 v_lshrrev_b32 v1, 3, v0
 v_lshrrev_b32 v2, 2, v1
 v_and_b32 v3, 3, v1
 v_lshl_add_u32 v2, v2, 5, v3
 v_mul_u32_u24 v2, 2048, v2
 v_lshrrev_b32 v1, 1, v1
 v_and_b32 v3, 7, v0
 v_xor_b32 v1, v1, v3
 v_lshl_add_u32 v8, v1, 4, v2
 v_xor_b32 v9, 64, v8
 s_add_u32 s78, s65, 0x5c00000
 s_add_u32 s79, s65, 0x5c20000
 s_add_u32 s80, s65, 0x5c40000
 s_add_u32 s81, s65, 0x5c60000
 s_add_u32 s82, s65, 0x5c80000
 s_add_u32 s83, s65, 0x5ca0000
 s_add_u32 s84, s65, 0x5cc0000
 s_add_u32 s85, s65, 0x5ce0000
 s_lshl_b32 s76, s62, 13
 s_add_u32 m0, s76, 0
 s_nop 0
 buffer_load_dwordx4 v8, s[4:7], s78 offen sc1 lds
 s_add_u32 m0, s76, 1024
 s_nop 0
 buffer_load_dwordx4 v9, s[4:7], s79 offen sc1 lds
 s_add_u32 m0, s76, 2048
 s_nop 0
 buffer_load_dwordx4 v8, s[4:7], s80 offen sc1 lds
 s_add_u32 m0, s76, 3072
 s_nop 0
 buffer_load_dwordx4 v9, s[4:7], s81 offen sc1 lds
 s_add_u32 m0, s76, 4096
 s_nop 0
 buffer_load_dwordx4 v8, s[4:7], s82 offen sc1 lds
 s_add_u32 m0, s76, 5120
 s_nop 0
 buffer_load_dwordx4 v9, s[4:7], s83 offen sc1 lds
 s_add_u32 m0, s76, 6144
 s_nop 0
 buffer_load_dwordx4 v8, s[4:7], s84 offen sc1 lds
 s_add_u32 m0, s76, 7168
 s_nop 0
 buffer_load_dwordx4 v9, s[4:7], s85 offen sc1 lds
 v_add_u32 v8, 128, v8
 v_add_u32 v9, 128, v9
 s_add_u32 s76, s76, 32768
 s_and_b32 s76, s76, 0x1ffff
 s_add_u32 m0, s76, 0
 s_nop 0
 buffer_load_dwordx4 v8, s[4:7], s78 offen sc1 lds
 s_add_u32 m0, s76, 1024
 s_nop 0
 buffer_load_dwordx4 v9, s[4:7], s79 offen sc1 lds
 s_add_u32 m0, s76, 2048
 s_nop 0
 buffer_load_dwordx4 v8, s[4:7], s80 offen sc1 lds
 s_add_u32 m0, s76, 3072
 s_nop 0
 buffer_load_dwordx4 v9, s[4:7], s81 offen sc1 lds
 s_add_u32 m0, s76, 4096
 s_nop 0
 buffer_load_dwordx4 v8, s[4:7], s82 offen sc1 lds
 s_add_u32 m0, s76, 5120
 s_nop 0
 buffer_load_dwordx4 v9, s[4:7], s83 offen sc1 lds
 s_add_u32 m0, s76, 6144
 s_nop 0
 buffer_load_dwordx4 v8, s[4:7], s84 offen sc1 lds
 s_add_u32 m0, s76, 7168
 s_nop 0
 buffer_load_dwordx4 v9, s[4:7], s85 offen sc1 lds
 v_add_u32 v8, 128, v8
 v_add_u32 v9, 128, v9
 s_add_u32 s76, s76, 32768
 s_and_b32 s76, s76, 0x1ffff
 v_bfe_u32 v1, v0, 1, 3
 v_xor_b32 v1, v1, v6
 v_lshlrev_b32 v1, 4, v1
 v_lshl_add_u32 v10, v5, 7, v1
 v_xor_b32 v11, 32, v10
 v_xor_b32 v12, 64, v10
 v_xor_b32 v13, 96, v10
 s_mov_b32 s66, 0x3a800000
 s_mov_b32 s65, s72
 s_lshl_b32 s65, s65, 2
 s_add_u32 s65, s65, s62
 s_lshl_b32 s65, s65, 5
 s_add_u32 s65, s65, 0
 v_add_u32 v1, s65, v7
 v_lshl_add_u32 v4, v6, 3, 0
 v_add_u32 v4, s73, v4
 v_mul_u32_u24 v4, v4, v1
 v_and_b32 v4, 1023, v4
 v_cvt_f32_u32 v4, v4
 v_mul_f32 v28, s66, v4
 v_add_f32 v29, 0xbe800000, v28
 v_lshl_add_u32 v4, v6, 3, 2
 v_add_u32 v4, s73, v4
 v_mul_u32_u24 v4, v4, v1
 v_and_b32 v4, 1023, v4
 v_cvt_f32_u32 v4, v4
 v_mul_f32 v30, s66, v4
 v_add_f32 v31, 0xbe800000, v30
 v_lshl_add_u32 v4, v6, 3, 4
 v_add_u32 v4, s73, v4
 v_mul_u32_u24 v4, v4, v1
 v_and_b32 v4, 1023, v4
 v_cvt_f32_u32 v4, v4
 v_mul_f32 v32, s66, v4
 v_add_f32 v33, 0xbe800000, v32
 v_lshl_add_u32 v4, v6, 3, 6
 v_add_u32 v4, s73, v4
 v_mul_u32_u24 v4, v4, v1
 v_and_b32 v4, 1023, v4
 v_cvt_f32_u32 v4, v4
 v_mul_f32 v34, s66, v4
 v_add_f32 v35, 0xbe800000, v34
 v_lshlrev_b32 v4, 4, v1
 v_and_b32 v4, 1023, v4
 v_cvt_f32_u32 v4, v4
 v_mul_f32 v14, s66, v4
 v_cos_f32 v44, v28
 v_cos_f32 v45, v29
 v_cos_f32 v46, v30
 v_cos_f32 v47, v31
 v_cos_f32 v48, v32
 v_cos_f32 v49, v33
 v_cos_f32 v50, v34
 v_cos_f32 v51, v35
 v_and_b32 v2, 1, v1
 v_cvt_f32_u32 v2, v2
 v_fma_f32 v2, v2, -2.0, 1.0
 v_add_u32 v3, s73, v6
 v_cmp_eq_u32 vcc, 0, v3
 s_nop 1
 v_cndmask_b32 v45, v45, v2, vcc
 v_add_f32 v28, v28, v14
 v_add_f32 v29, v29, v14
 v_add_f32 v30, v30, v14
 v_add_f32 v31, v31, v14
 v_add_f32 v32, v32, v14
 v_add_f32 v33, v33, v14
 v_add_f32 v34, v34, v14
 v_add_f32 v35, v35, v14
 v_cvt_pk_bf16_f32 v60, v44, v45
 v_cvt_pk_bf16_f32 v61, v46, v47
 v_cvt_pk_bf16_f32 v62, v48, v49
 v_cvt_pk_bf16_f32 v63, v50, v51
 v_mov_b32 v104, 0
 v_mov_b32 v105, 0
 v_mov_b32 v106, 0
 v_mov_b32 v107, 0
 s_nop 1
 v_mfma_f32_32x32x16_bf16 a[0:15], v[104:107], v[104:107], 0
 v_mfma_f32_32x32x16_bf16 a[16:31], v[104:107], v[104:107], 0
 v_mfma_f32_32x32x16_bf16 a[32:47], v[104:107], v[104:107], 0
 v_mfma_f32_32x32x16_bf16 a[48:63], v[104:107], v[104:107], 0
 v_mfma_f32_32x32x16_bf16 a[64:79], v[104:107], v[104:107], 0
 v_mfma_f32_32x32x16_bf16 a[80:95], v[104:107], v[104:107], 0
 v_mfma_f32_32x32x16_bf16 a[96:111], v[104:107], v[104:107], 0
 v_mfma_f32_32x32x16_bf16 a[112:127], v[104:107], v[104:107], 0
 s_waitcnt vmcnt(8)
 s_barrier
 ds_read_b128 v[76:79], v10 offset:0
 ds_read_b128 v[80:83], v10 offset:4096
 ds_read_b128 v[84:87], v10 offset:8192
 ds_read_b128 v[88:91], v10 offset:12288
 ds_read_b128 v[92:95], v10 offset:16384
 ds_read_b128 v[96:99], v10 offset:20480
 s_mov_b32 s75, 4
L_f_loop_138:
 s_waitcnt lgkmcnt(5)
 v_mfma_f32_32x32x16_bf16 a[0:15], v[60:63], v[76:79], a[0:15]
 ds_read_b128 v[100:103], v10 offset:24576
 v_cos_f32 v44, v28
 v_cos_f32 v45, v29
 s_waitcnt lgkmcnt(5)
 v_mfma_f32_32x32x16_bf16 a[16:31], v[60:63], v[80:83], a[16:31]
 ds_read_b128 v[104:107], v10 offset:28672
 v_cos_f32 v46, v30
 v_cos_f32 v47, v31
 s_waitcnt lgkmcnt(5)
 s_add_u32 m0, s76, 0
 v_mfma_f32_32x32x16_bf16 a[32:47], v[60:63], v[84:87], a[32:47]
 ds_read_b128 v[76:79], v11 offset:0
 buffer_load_dwordx4 v8, s[4:7], s78 offen sc1 lds
 v_cos_f32 v48, v32
 v_cos_f32 v49, v33
 s_waitcnt lgkmcnt(5)
 v_mfma_f32_32x32x16_bf16 a[48:63], v[60:63], v[88:91], a[48:63]
 ds_read_b128 v[80:83], v11 offset:4096
 v_cos_f32 v50, v34
 v_cos_f32 v51, v35
 s_waitcnt lgkmcnt(5)
 v_mfma_f32_32x32x16_bf16 a[64:79], v[60:63], v[92:95], a[64:79]
 ds_read_b128 v[84:87], v11 offset:8192
 v_add_f32 v28, v28, v14
 v_add_f32 v29, v29, v14
 v_cvt_pk_bf16_f32 v68, v44, v45
 v_cvt_pk_bf16_f32 v69, v46, v47
 s_waitcnt lgkmcnt(5)
 s_add_u32 m0, s76, 1024
 v_mfma_f32_32x32x16_bf16 a[80:95], v[60:63], v[96:99], a[80:95]
 ds_read_b128 v[88:91], v11 offset:12288
 buffer_load_dwordx4 v9, s[4:7], s79 offen sc1 lds
 v_add_f32 v30, v30, v14
 v_add_f32 v31, v31, v14
 v_cvt_pk_bf16_f32 v70, v48, v49
 v_cvt_pk_bf16_f32 v71, v50, v51
 s_waitcnt lgkmcnt(5)
 v_mfma_f32_32x32x16_bf16 a[96:111], v[60:63], v[100:103], a[96:111]
 ds_read_b128 v[92:95], v11 offset:16384
 v_add_f32 v32, v32, v14
 v_add_f32 v33, v33, v14
 s_waitcnt lgkmcnt(5)
 v_mfma_f32_32x32x16_bf16 a[112:127], v[60:63], v[104:107], a[112:127]
 ds_read_b128 v[96:99], v11 offset:20480
 v_add_f32 v34, v34, v14
 v_add_f32 v35, v35, v14
 s_waitcnt lgkmcnt(5)
 s_add_u32 m0, s76, 2048
 v_mfma_f32_32x32x16_bf16 a[0:15], v[68:71], v[76:79], a[0:15]
 ds_read_b128 v[100:103], v11 offset:24576
 buffer_load_dwordx4 v8, s[4:7], s80 offen sc1 lds
 v_cos_f32 v44, v28
 v_cos_f32 v45, v29
 s_waitcnt lgkmcnt(5)
 v_mfma_f32_32x32x16_bf16 a[16:31], v[68:71], v[80:83], a[16:31]
 ds_read_b128 v[104:107], v11 offset:28672
 v_cos_f32 v46, v30
 v_cos_f32 v47, v31
 s_waitcnt lgkmcnt(5)
 v_mfma_f32_32x32x16_bf16 a[32:47], v[68:71], v[84:87], a[32:47]
 ds_read_b128 v[76:79], v12 offset:0
 v_cos_f32 v48, v32
 v_cos_f32 v49, v33
 s_waitcnt lgkmcnt(5)
 s_add_u32 m0, s76, 3072
 v_mfma_f32_32x32x16_bf16 a[48:63], v[68:71], v[88:91], a[48:63]
 ds_read_b128 v[80:83], v12 offset:4096
 buffer_load_dwordx4 v9, s[4:7], s81 offen sc1 lds
 v_cos_f32 v50, v34
 v_cos_f32 v51, v35
 s_waitcnt lgkmcnt(5)
 v_mfma_f32_32x32x16_bf16 a[64:79], v[68:71], v[92:95], a[64:79]
 ds_read_b128 v[84:87], v12 offset:8192
 v_add_f32 v28, v28, v14
 v_add_f32 v29, v29, v14
 v_cvt_pk_bf16_f32 v60, v44, v45
 v_cvt_pk_bf16_f32 v61, v46, v47
 s_waitcnt lgkmcnt(5)
 v_mfma_f32_32x32x16_bf16 a[80:95], v[68:71], v[96:99], a[80:95]
 ds_read_b128 v[88:91], v12 offset:12288
 v_add_f32 v30, v30, v14
 v_add_f32 v31, v31, v14
 v_cvt_pk_bf16_f32 v62, v48, v49
 v_cvt_pk_bf16_f32 v63, v50, v51
 s_waitcnt lgkmcnt(5)
 s_add_u32 m0, s76, 4096
 v_mfma_f32_32x32x16_bf16 a[96:111], v[68:71], v[100:103], a[96:111]
 ds_read_b128 v[92:95], v12 offset:16384
 buffer_load_dwordx4 v8, s[4:7], s82 offen sc1 lds
 v_add_f32 v32, v32, v14
 v_add_f32 v33, v33, v14
 s_waitcnt lgkmcnt(5)
 v_mfma_f32_32x32x16_bf16 a[112:127], v[68:71], v[104:107], a[112:127]
 ds_read_b128 v[96:99], v12 offset:20480
 v_add_f32 v34, v34, v14
 v_add_f32 v35, v35, v14
 s_waitcnt lgkmcnt(5)
 v_mfma_f32_32x32x16_bf16 a[0:15], v[60:63], v[76:79], a[0:15]
 ds_read_b128 v[100:103], v12 offset:24576
 v_cos_f32 v44, v28
 v_cos_f32 v45, v29
 s_waitcnt lgkmcnt(5)
 s_add_u32 m0, s76, 5120
 v_mfma_f32_32x32x16_bf16 a[16:31], v[60:63], v[80:83], a[16:31]
 ds_read_b128 v[104:107], v12 offset:28672
 buffer_load_dwordx4 v9, s[4:7], s83 offen sc1 lds
 v_cos_f32 v46, v30
 v_cos_f32 v47, v31
 s_waitcnt lgkmcnt(5)
 v_mfma_f32_32x32x16_bf16 a[32:47], v[60:63], v[84:87], a[32:47]
 ds_read_b128 v[76:79], v13 offset:0
 v_cos_f32 v48, v32
 v_cos_f32 v49, v33
 s_waitcnt lgkmcnt(5)
 v_mfma_f32_32x32x16_bf16 a[48:63], v[60:63], v[88:91], a[48:63]
 ds_read_b128 v[80:83], v13 offset:4096
 v_cos_f32 v50, v34
 v_cos_f32 v51, v35
 s_waitcnt lgkmcnt(5)
 s_add_u32 m0, s76, 6144
 v_mfma_f32_32x32x16_bf16 a[64:79], v[60:63], v[92:95], a[64:79]
 ds_read_b128 v[84:87], v13 offset:8192
 buffer_load_dwordx4 v8, s[4:7], s84 offen sc1 lds
 v_add_f32 v28, v28, v14
 v_add_f32 v29, v29, v14
 v_cvt_pk_bf16_f32 v68, v44, v45
 v_cvt_pk_bf16_f32 v69, v46, v47
 s_waitcnt lgkmcnt(5)
 v_mfma_f32_32x32x16_bf16 a[80:95], v[60:63], v[96:99], a[80:95]
 ds_read_b128 v[88:91], v13 offset:12288
 v_add_f32 v30, v30, v14
 v_add_f32 v31, v31, v14
 v_cvt_pk_bf16_f32 v70, v48, v49
 v_cvt_pk_bf16_f32 v71, v50, v51
 s_waitcnt lgkmcnt(5)
 v_mfma_f32_32x32x16_bf16 a[96:111], v[60:63], v[100:103], a[96:111]
 ds_read_b128 v[92:95], v13 offset:16384
 v_add_f32 v32, v32, v14
 v_add_f32 v33, v33, v14
 s_waitcnt lgkmcnt(5)
 s_add_u32 m0, s76, 7168
 v_mfma_f32_32x32x16_bf16 a[112:127], v[60:63], v[104:107], a[112:127]
 ds_read_b128 v[96:99], v13 offset:20480
 buffer_load_dwordx4 v9, s[4:7], s85 offen sc1 lds
 v_add_f32 v34, v34, v14
 v_add_f32 v35, v35, v14
 s_waitcnt lgkmcnt(5)
 v_mfma_f32_32x32x16_bf16 a[0:15], v[68:71], v[76:79], a[0:15]
 ds_read_b128 v[100:103], v13 offset:24576
 v_cos_f32 v44, v28
 v_cos_f32 v45, v29
 v_add_u32 v8, 128, v8
 v_add_u32 v9, 128, v9
 s_add_u32 s76, s76, 32768
 s_and_b32 s76, s76, 0x1ffff
 s_waitcnt lgkmcnt(5)
 v_mfma_f32_32x32x16_bf16 a[16:31], v[68:71], v[80:83], a[16:31]
 ds_read_b128 v[104:107], v13 offset:28672
 v_cos_f32 v46, v30
 v_cos_f32 v47, v31
 s_waitcnt vmcnt(8)
 s_barrier
 s_waitcnt lgkmcnt(5)
 v_mfma_f32_32x32x16_bf16 a[32:47], v[68:71], v[84:87], a[32:47]
 ds_read_b128 v[76:79], v10 offset:32768
 v_cos_f32 v48, v32
 v_cos_f32 v49, v33
 s_waitcnt lgkmcnt(5)
 v_mfma_f32_32x32x16_bf16 a[48:63], v[68:71], v[88:91], a[48:63]
 ds_read_b128 v[80:83], v10 offset:36864
 v_cos_f32 v50, v34
 v_cos_f32 v51, v35
 s_waitcnt lgkmcnt(5)
 v_mfma_f32_32x32x16_bf16 a[64:79], v[68:71], v[92:95], a[64:79]
 ds_read_b128 v[84:87], v10 offset:40960
 v_add_f32 v28, v28, v14
 v_add_f32 v29, v29, v14
 v_cvt_pk_bf16_f32 v60, v44, v45
 v_cvt_pk_bf16_f32 v61, v46, v47
 s_waitcnt lgkmcnt(5)
 v_mfma_f32_32x32x16_bf16 a[80:95], v[68:71], v[96:99], a[80:95]
 ds_read_b128 v[88:91], v10 offset:45056
 v_add_f32 v30, v30, v14
 v_add_f32 v31, v31, v14
 v_cvt_pk_bf16_f32 v62, v48, v49
 v_cvt_pk_bf16_f32 v63, v50, v51
 s_waitcnt lgkmcnt(5)
 v_mfma_f32_32x32x16_bf16 a[96:111], v[68:71], v[100:103], a[96:111]
 ds_read_b128 v[92:95], v10 offset:49152
 v_add_f32 v32, v32, v14
 v_add_f32 v33, v33, v14
 s_waitcnt lgkmcnt(5)
 v_mfma_f32_32x32x16_bf16 a[112:127], v[68:71], v[104:107], a[112:127]
 ds_read_b128 v[96:99], v10 offset:53248
 v_add_f32 v34, v34, v14
 v_add_f32 v35, v35, v14
 s_waitcnt lgkmcnt(5)
 v_mfma_f32_32x32x16_bf16 a[0:15], v[60:63], v[76:79], a[0:15]
 ds_read_b128 v[100:103], v10 offset:57344
 v_cos_f32 v44, v28
 v_cos_f32 v45, v29
 s_waitcnt lgkmcnt(5)
 v_mfma_f32_32x32x16_bf16 a[16:31], v[60:63], v[80:83], a[16:31]
 ds_read_b128 v[104:107], v10 offset:61440
 v_xor_b32 v10, 0x10000, v10
 v_cos_f32 v46, v30
 v_cos_f32 v47, v31
 s_waitcnt lgkmcnt(5)
 s_add_u32 m0, s76, 0
 v_mfma_f32_32x32x16_bf16 a[32:47], v[60:63], v[84:87], a[32:47]
 ds_read_b128 v[76:79], v11 offset:32768
 buffer_load_dwordx4 v8, s[4:7], s78 offen sc1 lds
 v_cos_f32 v48, v32
 v_cos_f32 v49, v33
 s_waitcnt lgkmcnt(5)
 v_mfma_f32_32x32x16_bf16 a[48:63], v[60:63], v[88:91], a[48:63]
 ds_read_b128 v[80:83], v11 offset:36864
 v_cos_f32 v50, v34
 v_cos_f32 v51, v35
 s_waitcnt lgkmcnt(5)
 v_mfma_f32_32x32x16_bf16 a[64:79], v[60:63], v[92:95], a[64:79]
 ds_read_b128 v[84:87], v11 offset:40960
 v_add_f32 v28, v28, v14
 v_add_f32 v29, v29, v14
 v_cvt_pk_bf16_f32 v68, v44, v45
 v_cvt_pk_bf16_f32 v69, v46, v47
 s_waitcnt lgkmcnt(5)
 s_add_u32 m0, s76, 1024
 v_mfma_f32_32x32x16_bf16 a[80:95], v[60:63], v[96:99], a[80:95]
 ds_read_b128 v[88:91], v11 offset:45056
 buffer_load_dwordx4 v9, s[4:7], s79 offen sc1 lds
 v_add_f32 v30, v30, v14
 v_add_f32 v31, v31, v14
 v_cvt_pk_bf16_f32 v70, v48, v49
 v_cvt_pk_bf16_f32 v71, v50, v51
 s_waitcnt lgkmcnt(5)
 v_mfma_f32_32x32x16_bf16 a[96:111], v[60:63], v[100:103], a[96:111]
 ds_read_b128 v[92:95], v11 offset:49152
 v_add_f32 v32, v32, v14
 v_add_f32 v33, v33, v14
 s_waitcnt lgkmcnt(5)
 v_mfma_f32_32x32x16_bf16 a[112:127], v[60:63], v[104:107], a[112:127]
 ds_read_b128 v[96:99], v11 offset:53248
 v_add_f32 v34, v34, v14
 v_add_f32 v35, v35, v14
 s_waitcnt lgkmcnt(5)
 s_add_u32 m0, s76, 2048
 v_mfma_f32_32x32x16_bf16 a[0:15], v[68:71], v[76:79], a[0:15]
 ds_read_b128 v[100:103], v11 offset:57344
 buffer_load_dwordx4 v8, s[4:7], s80 offen sc1 lds
 v_cos_f32 v44, v28
 v_cos_f32 v45, v29
 s_waitcnt lgkmcnt(5)
 v_mfma_f32_32x32x16_bf16 a[16:31], v[68:71], v[80:83], a[16:31]
 ds_read_b128 v[104:107], v11 offset:61440
 v_xor_b32 v11, 0x10000, v11
 v_cos_f32 v46, v30
 v_cos_f32 v47, v31
 s_waitcnt lgkmcnt(5)
 v_mfma_f32_32x32x16_bf16 a[32:47], v[68:71], v[84:87], a[32:47]
 ds_read_b128 v[76:79], v12 offset:32768
 v_cos_f32 v48, v32
 v_cos_f32 v49, v33
 s_waitcnt lgkmcnt(5)
 s_add_u32 m0, s76, 3072
 v_mfma_f32_32x32x16_bf16 a[48:63], v[68:71], v[88:91], a[48:63]
 ds_read_b128 v[80:83], v12 offset:36864
 buffer_load_dwordx4 v9, s[4:7], s81 offen sc1 lds
 v_cos_f32 v50, v34
 v_cos_f32 v51, v35
 s_waitcnt lgkmcnt(5)
 v_mfma_f32_32x32x16_bf16 a[64:79], v[68:71], v[92:95], a[64:79]
 ds_read_b128 v[84:87], v12 offset:40960
 v_add_f32 v28, v28, v14
 v_add_f32 v29, v29, v14
 v_cvt_pk_bf16_f32 v60, v44, v45
 v_cvt_pk_bf16_f32 v61, v46, v47
 s_waitcnt lgkmcnt(5)
 v_mfma_f32_32x32x16_bf16 a[80:95], v[68:71], v[96:99], a[80:95]
 ds_read_b128 v[88:91], v12 offset:45056
 v_add_f32 v30, v30, v14
 v_add_f32 v31, v31, v14
 v_cvt_pk_bf16_f32 v62, v48, v49
 v_cvt_pk_bf16_f32 v63, v50, v51
 s_waitcnt lgkmcnt(5)
 s_add_u32 m0, s76, 4096
 v_mfma_f32_32x32x16_bf16 a[96:111], v[68:71], v[100:103], a[96:111]
 ds_read_b128 v[92:95], v12 offset:49152
 buffer_load_dwordx4 v8, s[4:7], s82 offen sc1 lds
 v_add_f32 v32, v32, v14
 v_add_f32 v33, v33, v14
 s_waitcnt lgkmcnt(5)
 v_mfma_f32_32x32x16_bf16 a[112:127], v[68:71], v[104:107], a[112:127]
 ds_read_b128 v[96:99], v12 offset:53248
 v_add_f32 v34, v34, v14
 v_add_f32 v35, v35, v14
 s_waitcnt lgkmcnt(5)
 v_mfma_f32_32x32x16_bf16 a[0:15], v[60:63], v[76:79], a[0:15]
 ds_read_b128 v[100:103], v12 offset:57344
 v_cos_f32 v44, v28
 v_cos_f32 v45, v29
 s_waitcnt lgkmcnt(5)
 s_add_u32 m0, s76, 5120
 v_mfma_f32_32x32x16_bf16 a[16:31], v[60:63], v[80:83], a[16:31]
 ds_read_b128 v[104:107], v12 offset:61440
 v_xor_b32 v12, 0x10000, v12
 buffer_load_dwordx4 v9, s[4:7], s83 offen sc1 lds
 v_cos_f32 v46, v30
 v_cos_f32 v47, v31
 s_waitcnt lgkmcnt(5)
 v_mfma_f32_32x32x16_bf16 a[32:47], v[60:63], v[84:87], a[32:47]
 ds_read_b128 v[76:79], v13 offset:32768
 v_cos_f32 v48, v32
 v_cos_f32 v49, v33
 s_waitcnt lgkmcnt(5)
 v_mfma_f32_32x32x16_bf16 a[48:63], v[60:63], v[88:91], a[48:63]
 ds_read_b128 v[80:83], v13 offset:36864
 v_cos_f32 v50, v34
 v_cos_f32 v51, v35
 s_waitcnt lgkmcnt(5)
 s_add_u32 m0, s76, 6144
 v_mfma_f32_32x32x16_bf16 a[64:79], v[60:63], v[92:95], a[64:79]
 ds_read_b128 v[84:87], v13 offset:40960
 buffer_load_dwordx4 v8, s[4:7], s84 offen sc1 lds
 v_add_f32 v28, v28, v14
 v_add_f32 v29, v29, v14
 v_cvt_pk_bf16_f32 v68, v44, v45
 v_cvt_pk_bf16_f32 v69, v46, v47
 s_waitcnt lgkmcnt(5)
 v_mfma_f32_32x32x16_bf16 a[80:95], v[60:63], v[96:99], a[80:95]
 ds_read_b128 v[88:91], v13 offset:45056
 v_add_f32 v30, v30, v14
 v_add_f32 v31, v31, v14
 v_cvt_pk_bf16_f32 v70, v48, v49
 v_cvt_pk_bf16_f32 v71, v50, v51
 s_waitcnt lgkmcnt(5)
 v_mfma_f32_32x32x16_bf16 a[96:111], v[60:63], v[100:103], a[96:111]
 ds_read_b128 v[92:95], v13 offset:49152
 v_add_f32 v32, v32, v14
 v_add_f32 v33, v33, v14
 s_waitcnt lgkmcnt(5)
 s_add_u32 m0, s76, 7168
 v_mfma_f32_32x32x16_bf16 a[112:127], v[60:63], v[104:107], a[112:127]
 ds_read_b128 v[96:99], v13 offset:53248
 buffer_load_dwordx4 v9, s[4:7], s85 offen sc1 lds
 v_add_f32 v34, v34, v14
 v_add_f32 v35, v35, v14
 s_waitcnt lgkmcnt(5)
 v_mfma_f32_32x32x16_bf16 a[0:15], v[68:71], v[76:79], a[0:15]
 ds_read_b128 v[100:103], v13 offset:57344
 v_cos_f32 v44, v28
 v_cos_f32 v45, v29
 v_add_u32 v8, 128, v8
 v_add_u32 v9, 128, v9
 s_add_u32 s76, s76, 32768
 s_and_b32 s76, s76, 0x1ffff
 s_waitcnt lgkmcnt(5)
 v_mfma_f32_32x32x16_bf16 a[16:31], v[68:71], v[80:83], a[16:31]
 ds_read_b128 v[104:107], v13 offset:61440
 v_xor_b32 v13, 0x10000, v13
 v_cos_f32 v46, v30
 v_cos_f32 v47, v31
 s_waitcnt vmcnt(8)
 s_barrier
 s_waitcnt lgkmcnt(5)
 v_mfma_f32_32x32x16_bf16 a[32:47], v[68:71], v[84:87], a[32:47]
 ds_read_b128 v[76:79], v10 offset:0
 v_cos_f32 v48, v32
 v_cos_f32 v49, v33
 s_waitcnt lgkmcnt(5)
 v_mfma_f32_32x32x16_bf16 a[48:63], v[68:71], v[88:91], a[48:63]
 ds_read_b128 v[80:83], v10 offset:4096
 v_cos_f32 v50, v34
 v_cos_f32 v51, v35
 s_waitcnt lgkmcnt(5)
 v_mfma_f32_32x32x16_bf16 a[64:79], v[68:71], v[92:95], a[64:79]
 ds_read_b128 v[84:87], v10 offset:8192
 v_add_f32 v28, v28, v14
 v_add_f32 v29, v29, v14
 v_cvt_pk_bf16_f32 v60, v44, v45
 v_cvt_pk_bf16_f32 v61, v46, v47
 s_waitcnt lgkmcnt(5)
 v_mfma_f32_32x32x16_bf16 a[80:95], v[68:71], v[96:99], a[80:95]
 ds_read_b128 v[88:91], v10 offset:12288
 v_add_f32 v30, v30, v14
 v_add_f32 v31, v31, v14
 v_cvt_pk_bf16_f32 v62, v48, v49
 v_cvt_pk_bf16_f32 v63, v50, v51
 s_waitcnt lgkmcnt(5)
 v_mfma_f32_32x32x16_bf16 a[96:111], v[68:71], v[100:103], a[96:111]
 ds_read_b128 v[92:95], v10 offset:16384
 v_add_f32 v32, v32, v14
 v_add_f32 v33, v33, v14
 s_waitcnt lgkmcnt(5)
 v_mfma_f32_32x32x16_bf16 a[112:127], v[68:71], v[104:107], a[112:127]
 ds_read_b128 v[96:99], v10 offset:20480
 v_add_f32 v34, v34, v14
 v_add_f32 v35, v35, v14
 s_sub_u32 s75, s75, 1
 s_cmp_lg_u32 s75, 0
 s_cbranch_scc1 L_f_loop_138
 s_waitcnt vmcnt(0) lgkmcnt(0)
 s_barrier
 s_nop 11
 s_mov_b32 s73, 1
 s_lshl_b32 s65, s62, 7
 s_add_u32 s65, s65, s60
 s_mul_i32 s65, s65, 8192
 v_lshrrev_b32 v1, 3, v0
 v_lshrrev_b32 v2, 2, v1
 v_and_b32 v3, 3, v1
 v_lshl_add_u32 v2, v2, 5, v3
 v_mul_u32_u24 v2, 2048, v2
 v_lshrrev_b32 v1, 1, v1
 v_and_b32 v3, 7, v0
 v_xor_b32 v1, v1, v3
 v_lshl_add_u32 v8, v1, 4, v2
 v_xor_b32 v9, 64, v8
 s_add_u32 s78, s65, 0x5c00400
 s_add_u32 s79, s65, 0x5c20400
 s_add_u32 s80, s65, 0x5c40400
 s_add_u32 s81, s65, 0x5c60400
 s_add_u32 s82, s65, 0x5c80400
 s_add_u32 s83, s65, 0x5ca0400
 s_add_u32 s84, s65, 0x5cc0400
 s_add_u32 s85, s65, 0x5ce0400
 s_lshl_b32 s76, s62, 13
 s_add_u32 m0, s76, 0
 s_nop 0
 buffer_load_dwordx4 v8, s[4:7], s78 offen sc1 lds
 s_add_u32 m0, s76, 1024
 s_nop 0
 buffer_load_dwordx4 v9, s[4:7], s79 offen sc1 lds
 s_add_u32 m0, s76, 2048
 s_nop 0
 buffer_load_dwordx4 v8, s[4:7], s80 offen sc1 lds
 s_add_u32 m0, s76, 3072
 s_nop 0
 buffer_load_dwordx4 v9, s[4:7], s81 offen sc1 lds
 s_add_u32 m0, s76, 4096
 s_nop 0
 buffer_load_dwordx4 v8, s[4:7], s82 offen sc1 lds
 s_add_u32 m0, s76, 5120
 s_nop 0
 buffer_load_dwordx4 v9, s[4:7], s83 offen sc1 lds
 s_add_u32 m0, s76, 6144
 s_nop 0
 buffer_load_dwordx4 v8, s[4:7], s84 offen sc1 lds
 s_add_u32 m0, s76, 7168
 s_nop 0
 buffer_load_dwordx4 v9, s[4:7], s85 offen sc1 lds
 v_add_u32 v8, 128, v8
 v_add_u32 v9, 128, v9
 s_add_u32 s76, s76, 32768
 s_and_b32 s76, s76, 0x1ffff
 s_add_u32 m0, s76, 0
 s_nop 0
 buffer_load_dwordx4 v8, s[4:7], s78 offen sc1 lds
 s_add_u32 m0, s76, 1024
 s_nop 0
 buffer_load_dwordx4 v9, s[4:7], s79 offen sc1 lds
 s_add_u32 m0, s76, 2048
 s_nop 0
 buffer_load_dwordx4 v8, s[4:7], s80 offen sc1 lds
 s_add_u32 m0, s76, 3072
 s_nop 0
 buffer_load_dwordx4 v9, s[4:7], s81 offen sc1 lds
 s_add_u32 m0, s76, 4096
 s_nop 0
 buffer_load_dwordx4 v8, s[4:7], s82 offen sc1 lds
 s_add_u32 m0, s76, 5120
 s_nop 0
 buffer_load_dwordx4 v9, s[4:7], s83 offen sc1 lds
 s_add_u32 m0, s76, 6144
 s_nop 0
 buffer_load_dwordx4 v8, s[4:7], s84 offen sc1 lds
 s_add_u32 m0, s76, 7168
 s_nop 0
 buffer_load_dwordx4 v9, s[4:7], s85 offen sc1 lds
 v_add_u32 v8, 128, v8
 v_add_u32 v9, 128, v9
 s_add_u32 s76, s76, 32768
 s_and_b32 s76, s76, 0x1ffff
 v_bfe_u32 v1, v0, 1, 3
 v_xor_b32 v1, v1, v6
 v_lshlrev_b32 v1, 4, v1
 v_lshl_add_u32 v10, v5, 7, v1
 v_xor_b32 v11, 32, v10
 v_xor_b32 v12, 64, v10
 v_xor_b32 v13, 96, v10
 s_mov_b32 s66, 0x3a800000
 s_mov_b32 s65, s72
 s_lshl_b32 s65, s65, 2
 s_add_u32 s65, s65, s62
 s_lshl_b32 s65, s65, 5
 s_add_u32 s65, s65, 0
 v_add_u32 v1, s65, v7
 v_lshl_add_u32 v4, v6, 3, 0
 v_add_u32 v4, s73, v4
 v_mul_u32_u24 v4, v4, v1
 v_and_b32 v4, 1023, v4
 v_cvt_f32_u32 v4, v4
 v_mul_f32 v28, s66, v4
 v_add_f32 v29, 0xbe800000, v28
 v_lshl_add_u32 v4, v6, 3, 2
 v_add_u32 v4, s73, v4
 v_mul_u32_u24 v4, v4, v1
 v_and_b32 v4, 1023, v4
 v_cvt_f32_u32 v4, v4
 v_mul_f32 v30, s66, v4
 v_add_f32 v31, 0xbe800000, v30
 v_lshl_add_u32 v4, v6, 3, 4
 v_add_u32 v4, s73, v4
 v_mul_u32_u24 v4, v4, v1
 v_and_b32 v4, 1023, v4
 v_cvt_f32_u32 v4, v4
 v_mul_f32 v32, s66, v4
 v_add_f32 v33, 0xbe800000, v32
 v_lshl_add_u32 v4, v6, 3, 6
 v_add_u32 v4, s73, v4
 v_mul_u32_u24 v4, v4, v1
 v_and_b32 v4, 1023, v4
 v_cvt_f32_u32 v4, v4
 v_mul_f32 v34, s66, v4
 v_add_f32 v35, 0xbe800000, v34
 v_lshlrev_b32 v4, 4, v1
 v_and_b32 v4, 1023, v4
 v_cvt_f32_u32 v4, v4
 v_mul_f32 v14, s66, v4
 v_cos_f32 v44, v28
 v_cos_f32 v45, v29
 v_cos_f32 v46, v30
 v_cos_f32 v47, v31
 v_cos_f32 v48, v32
 v_cos_f32 v49, v33
 v_cos_f32 v50, v34
 v_cos_f32 v51, v35
 v_and_b32 v2, 1, v1
 v_cvt_f32_u32 v2, v2
 v_fma_f32 v2, v2, -2.0, 1.0
 v_add_u32 v3, s73, v6
 v_cmp_eq_u32 vcc, 0, v3
 s_nop 1
 v_cndmask_b32 v45, v45, v2, vcc
 v_add_f32 v28, v28, v14
 v_add_f32 v29, v29, v14
 v_add_f32 v30, v30, v14
 v_add_f32 v31, v31, v14
 v_add_f32 v32, v32, v14
 v_add_f32 v33, v33, v14
 v_add_f32 v34, v34, v14
 v_add_f32 v35, v35, v14
 v_cvt_pk_bf16_f32 v60, v44, v45
 v_cvt_pk_bf16_f32 v61, v46, v47
 v_cvt_pk_bf16_f32 v62, v48, v49
 v_cvt_pk_bf16_f32 v63, v50, v51
 v_mov_b32 v104, 0
 v_mov_b32 v105, 0
 v_mov_b32 v106, 0
 v_mov_b32 v107, 0
 s_nop 1
 v_mfma_f32_32x32x16_bf16 a[128:143], v[104:107], v[104:107], 0
 v_mfma_f32_32x32x16_bf16 a[144:159], v[104:107], v[104:107], 0
 v_mfma_f32_32x32x16_bf16 a[160:175], v[104:107], v[104:107], 0
 v_mfma_f32_32x32x16_bf16 a[176:191], v[104:107], v[104:107], 0
 v_mfma_f32_32x32x16_bf16 a[192:207], v[104:107], v[104:107], 0
 v_mfma_f32_32x32x16_bf16 a[208:223], v[104:107], v[104:107], 0
 v_mfma_f32_32x32x16_bf16 a[224:239], v[104:107], v[104:107], 0
 v_mfma_f32_32x32x16_bf16 a[240:255], v[104:107], v[104:107], 0
 s_waitcnt vmcnt(8)
 s_barrier
 ds_read_b128 v[76:79], v10 offset:0
 ds_read_b128 v[80:83], v10 offset:4096
 ds_read_b128 v[84:87], v10 offset:8192
 ds_read_b128 v[88:91], v10 offset:12288
 ds_read_b128 v[92:95], v10 offset:16384
 ds_read_b128 v[96:99], v10 offset:20480
 s_mov_b32 s75, 4
L_f_loop_139:
 s_waitcnt lgkmcnt(5)
 v_mfma_f32_32x32x16_bf16 a[128:143], v[60:63], v[76:79], a[128:143]
 ds_read_b128 v[100:103], v10 offset:24576
 v_cos_f32 v44, v28
 v_cos_f32 v45, v29
 s_waitcnt lgkmcnt(5)
 v_mfma_f32_32x32x16_bf16 a[144:159], v[60:63], v[80:83], a[144:159]
 ds_read_b128 v[104:107], v10 offset:28672
 v_cos_f32 v46, v30
 v_cos_f32 v47, v31
 s_waitcnt lgkmcnt(5)
 s_add_u32 m0, s76, 0
 v_mfma_f32_32x32x16_bf16 a[160:175], v[60:63], v[84:87], a[160:175]
 ds_read_b128 v[76:79], v11 offset:0
 buffer_load_dwordx4 v8, s[4:7], s78 offen sc1 lds
 v_cos_f32 v48, v32
 v_cos_f32 v49, v33
 s_waitcnt lgkmcnt(5)
 v_mfma_f32_32x32x16_bf16 a[176:191], v[60:63], v[88:91], a[176:191]
 ds_read_b128 v[80:83], v11 offset:4096
 v_cos_f32 v50, v34
 v_cos_f32 v51, v35
 s_waitcnt lgkmcnt(5)
 v_mfma_f32_32x32x16_bf16 a[192:207], v[60:63], v[92:95], a[192:207]
 ds_read_b128 v[84:87], v11 offset:8192
 v_add_f32 v28, v28, v14
 v_add_f32 v29, v29, v14
 v_cvt_pk_bf16_f32 v68, v44, v45
 v_cvt_pk_bf16_f32 v69, v46, v47
 s_waitcnt lgkmcnt(5)
 s_add_u32 m0, s76, 1024
 v_mfma_f32_32x32x16_bf16 a[208:223], v[60:63], v[96:99], a[208:223]
 ds_read_b128 v[88:91], v11 offset:12288
 buffer_load_dwordx4 v9, s[4:7], s79 offen sc1 lds
 v_add_f32 v30, v30, v14
 v_add_f32 v31, v31, v14
 v_cvt_pk_bf16_f32 v70, v48, v49
 v_cvt_pk_bf16_f32 v71, v50, v51
 s_waitcnt lgkmcnt(5)
 v_mfma_f32_32x32x16_bf16 a[224:239], v[60:63], v[100:103], a[224:239]
 ds_read_b128 v[92:95], v11 offset:16384
 v_add_f32 v32, v32, v14
 v_add_f32 v33, v33, v14
 s_waitcnt lgkmcnt(5)
 v_mfma_f32_32x32x16_bf16 a[240:255], v[60:63], v[104:107], a[240:255]
 ds_read_b128 v[96:99], v11 offset:20480
 v_add_f32 v34, v34, v14
 v_add_f32 v35, v35, v14
 s_waitcnt lgkmcnt(5)
 s_add_u32 m0, s76, 2048
 v_mfma_f32_32x32x16_bf16 a[128:143], v[68:71], v[76:79], a[128:143]
 ds_read_b128 v[100:103], v11 offset:24576
 buffer_load_dwordx4 v8, s[4:7], s80 offen sc1 lds
 v_cos_f32 v44, v28
 v_cos_f32 v45, v29
 s_waitcnt lgkmcnt(5)
 v_mfma_f32_32x32x16_bf16 a[144:159], v[68:71], v[80:83], a[144:159]
 ds_read_b128 v[104:107], v11 offset:28672
 v_cos_f32 v46, v30
 v_cos_f32 v47, v31
 s_waitcnt lgkmcnt(5)
 v_mfma_f32_32x32x16_bf16 a[160:175], v[68:71], v[84:87], a[160:175]
 ds_read_b128 v[76:79], v12 offset:0
 v_cos_f32 v48, v32
 v_cos_f32 v49, v33
 s_waitcnt lgkmcnt(5)
 s_add_u32 m0, s76, 3072
 v_mfma_f32_32x32x16_bf16 a[176:191], v[68:71], v[88:91], a[176:191]
 ds_read_b128 v[80:83], v12 offset:4096
 buffer_load_dwordx4 v9, s[4:7], s81 offen sc1 lds
 v_cos_f32 v50, v34
 v_cos_f32 v51, v35
 s_waitcnt lgkmcnt(5)
 v_mfma_f32_32x32x16_bf16 a[192:207], v[68:71], v[92:95], a[192:207]
 ds_read_b128 v[84:87], v12 offset:8192
 v_add_f32 v28, v28, v14
 v_add_f32 v29, v29, v14
 v_cvt_pk_bf16_f32 v60, v44, v45
 v_cvt_pk_bf16_f32 v61, v46, v47
 s_waitcnt lgkmcnt(5)
 v_mfma_f32_32x32x16_bf16 a[208:223], v[68:71], v[96:99], a[208:223]
 ds_read_b128 v[88:91], v12 offset:12288
 v_add_f32 v30, v30, v14
 v_add_f32 v31, v31, v14
 v_cvt_pk_bf16_f32 v62, v48, v49
 v_cvt_pk_bf16_f32 v63, v50, v51
 s_waitcnt lgkmcnt(5)
 s_add_u32 m0, s76, 4096
 v_mfma_f32_32x32x16_bf16 a[224:239], v[68:71], v[100:103], a[224:239]
 ds_read_b128 v[92:95], v12 offset:16384
 buffer_load_dwordx4 v8, s[4:7], s82 offen sc1 lds
 v_add_f32 v32, v32, v14
 v_add_f32 v33, v33, v14
 s_waitcnt lgkmcnt(5)
 v_mfma_f32_32x32x16_bf16 a[240:255], v[68:71], v[104:107], a[240:255]
 ds_read_b128 v[96:99], v12 offset:20480
 v_add_f32 v34, v34, v14
 v_add_f32 v35, v35, v14
 s_waitcnt lgkmcnt(5)
 v_mfma_f32_32x32x16_bf16 a[128:143], v[60:63], v[76:79], a[128:143]
 ds_read_b128 v[100:103], v12 offset:24576
 v_cos_f32 v44, v28
 v_cos_f32 v45, v29
 s_waitcnt lgkmcnt(5)
 s_add_u32 m0, s76, 5120
 v_mfma_f32_32x32x16_bf16 a[144:159], v[60:63], v[80:83], a[144:159]
 ds_read_b128 v[104:107], v12 offset:28672
 buffer_load_dwordx4 v9, s[4:7], s83 offen sc1 lds
 v_cos_f32 v46, v30
 v_cos_f32 v47, v31
 s_waitcnt lgkmcnt(5)
 v_mfma_f32_32x32x16_bf16 a[160:175], v[60:63], v[84:87], a[160:175]
 ds_read_b128 v[76:79], v13 offset:0
 v_cos_f32 v48, v32
 v_cos_f32 v49, v33
 s_waitcnt lgkmcnt(5)
 v_mfma_f32_32x32x16_bf16 a[176:191], v[60:63], v[88:91], a[176:191]
 ds_read_b128 v[80:83], v13 offset:4096
 v_cos_f32 v50, v34
 v_cos_f32 v51, v35
 s_waitcnt lgkmcnt(5)
 s_add_u32 m0, s76, 6144
 v_mfma_f32_32x32x16_bf16 a[192:207], v[60:63], v[92:95], a[192:207]
 ds_read_b128 v[84:87], v13 offset:8192
 buffer_load_dwordx4 v8, s[4:7], s84 offen sc1 lds
 v_add_f32 v28, v28, v14
 v_add_f32 v29, v29, v14
 v_cvt_pk_bf16_f32 v68, v44, v45
 v_cvt_pk_bf16_f32 v69, v46, v47
 s_waitcnt lgkmcnt(5)
 v_mfma_f32_32x32x16_bf16 a[208:223], v[60:63], v[96:99], a[208:223]
 ds_read_b128 v[88:91], v13 offset:12288
 v_add_f32 v30, v30, v14
 v_add_f32 v31, v31, v14
 v_cvt_pk_bf16_f32 v70, v48, v49
 v_cvt_pk_bf16_f32 v71, v50, v51
 s_waitcnt lgkmcnt(5)
 v_mfma_f32_32x32x16_bf16 a[224:239], v[60:63], v[100:103], a[224:239]
 ds_read_b128 v[92:95], v13 offset:16384
 v_add_f32 v32, v32, v14
 v_add_f32 v33, v33, v14
 s_waitcnt lgkmcnt(5)
 s_add_u32 m0, s76, 7168
 v_mfma_f32_32x32x16_bf16 a[240:255], v[60:63], v[104:107], a[240:255]
 ds_read_b128 v[96:99], v13 offset:20480
 buffer_load_dwordx4 v9, s[4:7], s85 offen sc1 lds
 v_add_f32 v34, v34, v14
 v_add_f32 v35, v35, v14
 s_waitcnt lgkmcnt(5)
 v_mfma_f32_32x32x16_bf16 a[128:143], v[68:71], v[76:79], a[128:143]
 ds_read_b128 v[100:103], v13 offset:24576
 v_cos_f32 v44, v28
 v_cos_f32 v45, v29
 v_add_u32 v8, 128, v8
 v_add_u32 v9, 128, v9
 s_add_u32 s76, s76, 32768
 s_and_b32 s76, s76, 0x1ffff
 s_waitcnt lgkmcnt(5)
 v_mfma_f32_32x32x16_bf16 a[144:159], v[68:71], v[80:83], a[144:159]
 ds_read_b128 v[104:107], v13 offset:28672
 v_cos_f32 v46, v30
 v_cos_f32 v47, v31
 s_waitcnt vmcnt(8)
 s_barrier
 s_waitcnt lgkmcnt(5)
 v_mfma_f32_32x32x16_bf16 a[160:175], v[68:71], v[84:87], a[160:175]
 ds_read_b128 v[76:79], v10 offset:32768
 v_cos_f32 v48, v32
 v_cos_f32 v49, v33
 s_waitcnt lgkmcnt(5)
 v_mfma_f32_32x32x16_bf16 a[176:191], v[68:71], v[88:91], a[176:191]
 ds_read_b128 v[80:83], v10 offset:36864
 v_cos_f32 v50, v34
 v_cos_f32 v51, v35
 s_waitcnt lgkmcnt(5)
 v_mfma_f32_32x32x16_bf16 a[192:207], v[68:71], v[92:95], a[192:207]
 ds_read_b128 v[84:87], v10 offset:40960
 v_add_f32 v28, v28, v14
 v_add_f32 v29, v29, v14
 v_cvt_pk_bf16_f32 v60, v44, v45
 v_cvt_pk_bf16_f32 v61, v46, v47
 s_waitcnt lgkmcnt(5)
 v_mfma_f32_32x32x16_bf16 a[208:223], v[68:71], v[96:99], a[208:223]
 ds_read_b128 v[88:91], v10 offset:45056
 v_add_f32 v30, v30, v14
 v_add_f32 v31, v31, v14
 v_cvt_pk_bf16_f32 v62, v48, v49
 v_cvt_pk_bf16_f32 v63, v50, v51
 s_waitcnt lgkmcnt(5)
 v_mfma_f32_32x32x16_bf16 a[224:239], v[68:71], v[100:103], a[224:239]
 ds_read_b128 v[92:95], v10 offset:49152
 v_add_f32 v32, v32, v14
 v_add_f32 v33, v33, v14
 s_waitcnt lgkmcnt(5)
 v_mfma_f32_32x32x16_bf16 a[240:255], v[68:71], v[104:107], a[240:255]
 ds_read_b128 v[96:99], v10 offset:53248
 v_add_f32 v34, v34, v14
 v_add_f32 v35, v35, v14
 s_waitcnt lgkmcnt(5)
 v_mfma_f32_32x32x16_bf16 a[128:143], v[60:63], v[76:79], a[128:143]
 ds_read_b128 v[100:103], v10 offset:57344
 v_cos_f32 v44, v28
 v_cos_f32 v45, v29
 s_waitcnt lgkmcnt(5)
 v_mfma_f32_32x32x16_bf16 a[144:159], v[60:63], v[80:83], a[144:159]
 ds_read_b128 v[104:107], v10 offset:61440
 v_xor_b32 v10, 0x10000, v10
 v_cos_f32 v46, v30
 v_cos_f32 v47, v31
 s_waitcnt lgkmcnt(5)
 s_add_u32 m0, s76, 0
 v_mfma_f32_32x32x16_bf16 a[160:175], v[60:63], v[84:87], a[160:175]
 ds_read_b128 v[76:79], v11 offset:32768
 buffer_load_dwordx4 v8, s[4:7], s78 offen sc1 lds
 v_cos_f32 v48, v32
 v_cos_f32 v49, v33
 s_waitcnt lgkmcnt(5)
 v_mfma_f32_32x32x16_bf16 a[176:191], v[60:63], v[88:91], a[176:191]
 ds_read_b128 v[80:83], v11 offset:36864
 v_cos_f32 v50, v34
 v_cos_f32 v51, v35
 s_waitcnt lgkmcnt(5)
 v_mfma_f32_32x32x16_bf16 a[192:207], v[60:63], v[92:95], a[192:207]
 ds_read_b128 v[84:87], v11 offset:40960
 v_add_f32 v28, v28, v14
 v_add_f32 v29, v29, v14
 v_cvt_pk_bf16_f32 v68, v44, v45
 v_cvt_pk_bf16_f32 v69, v46, v47
 s_waitcnt lgkmcnt(5)
 s_add_u32 m0, s76, 1024
 v_mfma_f32_32x32x16_bf16 a[208:223], v[60:63], v[96:99], a[208:223]
 ds_read_b128 v[88:91], v11 offset:45056
 buffer_load_dwordx4 v9, s[4:7], s79 offen sc1 lds
 v_add_f32 v30, v30, v14
 v_add_f32 v31, v31, v14
 v_cvt_pk_bf16_f32 v70, v48, v49
 v_cvt_pk_bf16_f32 v71, v50, v51
 s_waitcnt lgkmcnt(5)
 v_mfma_f32_32x32x16_bf16 a[224:239], v[60:63], v[100:103], a[224:239]
 ds_read_b128 v[92:95], v11 offset:49152
 v_add_f32 v32, v32, v14
 v_add_f32 v33, v33, v14
 s_waitcnt lgkmcnt(5)
 v_mfma_f32_32x32x16_bf16 a[240:255], v[60:63], v[104:107], a[240:255]
 ds_read_b128 v[96:99], v11 offset:53248
 v_add_f32 v34, v34, v14
 v_add_f32 v35, v35, v14
 s_waitcnt lgkmcnt(5)
 s_add_u32 m0, s76, 2048
 v_mfma_f32_32x32x16_bf16 a[128:143], v[68:71], v[76:79], a[128:143]
 ds_read_b128 v[100:103], v11 offset:57344
 buffer_load_dwordx4 v8, s[4:7], s80 offen sc1 lds
 v_cos_f32 v44, v28
 v_cos_f32 v45, v29
 s_waitcnt lgkmcnt(5)
 v_mfma_f32_32x32x16_bf16 a[144:159], v[68:71], v[80:83], a[144:159]
 ds_read_b128 v[104:107], v11 offset:61440
 v_xor_b32 v11, 0x10000, v11
 v_cos_f32 v46, v30
 v_cos_f32 v47, v31
 s_waitcnt lgkmcnt(5)
 v_mfma_f32_32x32x16_bf16 a[160:175], v[68:71], v[84:87], a[160:175]
 ds_read_b128 v[76:79], v12 offset:32768
 v_cos_f32 v48, v32
 v_cos_f32 v49, v33
 s_waitcnt lgkmcnt(5)
 s_add_u32 m0, s76, 3072
 v_mfma_f32_32x32x16_bf16 a[176:191], v[68:71], v[88:91], a[176:191]
 ds_read_b128 v[80:83], v12 offset:36864
 buffer_load_dwordx4 v9, s[4:7], s81 offen sc1 lds
 v_cos_f32 v50, v34
 v_cos_f32 v51, v35
 s_waitcnt lgkmcnt(5)
 v_mfma_f32_32x32x16_bf16 a[192:207], v[68:71], v[92:95], a[192:207]
 ds_read_b128 v[84:87], v12 offset:40960
 v_add_f32 v28, v28, v14
 v_add_f32 v29, v29, v14
 v_cvt_pk_bf16_f32 v60, v44, v45
 v_cvt_pk_bf16_f32 v61, v46, v47
 s_waitcnt lgkmcnt(5)
 v_mfma_f32_32x32x16_bf16 a[208:223], v[68:71], v[96:99], a[208:223]
 ds_read_b128 v[88:91], v12 offset:45056
 v_add_f32 v30, v30, v14
 v_add_f32 v31, v31, v14
 v_cvt_pk_bf16_f32 v62, v48, v49
 v_cvt_pk_bf16_f32 v63, v50, v51
 s_waitcnt lgkmcnt(5)
 s_add_u32 m0, s76, 4096
 v_mfma_f32_32x32x16_bf16 a[224:239], v[68:71], v[100:103], a[224:239]
 ds_read_b128 v[92:95], v12 offset:49152
 buffer_load_dwordx4 v8, s[4:7], s82 offen sc1 lds
 v_add_f32 v32, v32, v14
 v_add_f32 v33, v33, v14
 s_waitcnt lgkmcnt(5)
 v_mfma_f32_32x32x16_bf16 a[240:255], v[68:71], v[104:107], a[240:255]
 ds_read_b128 v[96:99], v12 offset:53248
 v_add_f32 v34, v34, v14
 v_add_f32 v35, v35, v14
 s_waitcnt lgkmcnt(5)
 v_mfma_f32_32x32x16_bf16 a[128:143], v[60:63], v[76:79], a[128:143]
 ds_read_b128 v[100:103], v12 offset:57344
 v_cos_f32 v44, v28
 v_cos_f32 v45, v29
 s_waitcnt lgkmcnt(5)
 s_add_u32 m0, s76, 5120
 v_mfma_f32_32x32x16_bf16 a[144:159], v[60:63], v[80:83], a[144:159]
 ds_read_b128 v[104:107], v12 offset:61440
 v_xor_b32 v12, 0x10000, v12
 buffer_load_dwordx4 v9, s[4:7], s83 offen sc1 lds
 v_cos_f32 v46, v30
 v_cos_f32 v47, v31
 s_waitcnt lgkmcnt(5)
 v_mfma_f32_32x32x16_bf16 a[160:175], v[60:63], v[84:87], a[160:175]
 ds_read_b128 v[76:79], v13 offset:32768
 v_cos_f32 v48, v32
 v_cos_f32 v49, v33
 s_waitcnt lgkmcnt(5)
 v_mfma_f32_32x32x16_bf16 a[176:191], v[60:63], v[88:91], a[176:191]
 ds_read_b128 v[80:83], v13 offset:36864
 v_cos_f32 v50, v34
 v_cos_f32 v51, v35
 s_waitcnt lgkmcnt(5)
 s_add_u32 m0, s76, 6144
 v_mfma_f32_32x32x16_bf16 a[192:207], v[60:63], v[92:95], a[192:207]
 ds_read_b128 v[84:87], v13 offset:40960
 buffer_load_dwordx4 v8, s[4:7], s84 offen sc1 lds
 v_add_f32 v28, v28, v14
 v_add_f32 v29, v29, v14
 v_cvt_pk_bf16_f32 v68, v44, v45
 v_cvt_pk_bf16_f32 v69, v46, v47
 s_waitcnt lgkmcnt(5)
 v_mfma_f32_32x32x16_bf16 a[208:223], v[60:63], v[96:99], a[208:223]
 ds_read_b128 v[88:91], v13 offset:45056
 v_add_f32 v30, v30, v14
 v_add_f32 v31, v31, v14
 v_cvt_pk_bf16_f32 v70, v48, v49
 v_cvt_pk_bf16_f32 v71, v50, v51
 s_waitcnt lgkmcnt(5)
 v_mfma_f32_32x32x16_bf16 a[224:239], v[60:63], v[100:103], a[224:239]
 ds_read_b128 v[92:95], v13 offset:49152
 v_add_f32 v32, v32, v14
 v_add_f32 v33, v33, v14
 s_waitcnt lgkmcnt(5)
 s_add_u32 m0, s76, 7168
 v_mfma_f32_32x32x16_bf16 a[240:255], v[60:63], v[104:107], a[240:255]
 ds_read_b128 v[96:99], v13 offset:53248
 buffer_load_dwordx4 v9, s[4:7], s85 offen sc1 lds
 v_add_f32 v34, v34, v14
 v_add_f32 v35, v35, v14
 s_waitcnt lgkmcnt(5)
 v_mfma_f32_32x32x16_bf16 a[128:143], v[68:71], v[76:79], a[128:143]
 ds_read_b128 v[100:103], v13 offset:57344
 v_cos_f32 v44, v28
 v_cos_f32 v45, v29
 v_add_u32 v8, 128, v8
 v_add_u32 v9, 128, v9
 s_add_u32 s76, s76, 32768
 s_and_b32 s76, s76, 0x1ffff
 s_waitcnt lgkmcnt(5)
 v_mfma_f32_32x32x16_bf16 a[144:159], v[68:71], v[80:83], a[144:159]
 ds_read_b128 v[104:107], v13 offset:61440
 v_xor_b32 v13, 0x10000, v13
 v_cos_f32 v46, v30
 v_cos_f32 v47, v31
 s_waitcnt vmcnt(8)
 s_barrier
 s_waitcnt lgkmcnt(5)
 v_mfma_f32_32x32x16_bf16 a[160:175], v[68:71], v[84:87], a[160:175]
 ds_read_b128 v[76:79], v10 offset:0
 v_cos_f32 v48, v32
 v_cos_f32 v49, v33
 s_waitcnt lgkmcnt(5)
 v_mfma_f32_32x32x16_bf16 a[176:191], v[68:71], v[88:91], a[176:191]
 ds_read_b128 v[80:83], v10 offset:4096
 v_cos_f32 v50, v34
 v_cos_f32 v51, v35
 s_waitcnt lgkmcnt(5)
 v_mfma_f32_32x32x16_bf16 a[192:207], v[68:71], v[92:95], a[192:207]
 ds_read_b128 v[84:87], v10 offset:8192
 v_add_f32 v28, v28, v14
 v_add_f32 v29, v29, v14
 v_cvt_pk_bf16_f32 v60, v44, v45
 v_cvt_pk_bf16_f32 v61, v46, v47
 s_waitcnt lgkmcnt(5)
 v_mfma_f32_32x32x16_bf16 a[208:223], v[68:71], v[96:99], a[208:223]
 ds_read_b128 v[88:91], v10 offset:12288
 v_add_f32 v30, v30, v14
 v_add_f32 v31, v31, v14
 v_cvt_pk_bf16_f32 v62, v48, v49
 v_cvt_pk_bf16_f32 v63, v50, v51
 s_waitcnt lgkmcnt(5)
 v_mfma_f32_32x32x16_bf16 a[224:239], v[68:71], v[100:103], a[224:239]
 ds_read_b128 v[92:95], v10 offset:16384
 v_add_f32 v32, v32, v14
 v_add_f32 v33, v33, v14
 s_waitcnt lgkmcnt(5)
 v_mfma_f32_32x32x16_bf16 a[240:255], v[68:71], v[104:107], a[240:255]
 ds_read_b128 v[96:99], v10 offset:20480
 v_add_f32 v34, v34, v14
 v_add_f32 v35, v35, v14
 s_sub_u32 s75, s75, 1
 s_cmp_lg_u32 s75, 0
 s_cbranch_scc1 L_f_loop_139
 s_waitcnt vmcnt(0) lgkmcnt(0)
 s_barrier
 s_nop 11
 s_lshl_b32 s66, s62, 15
 v_lshlrev_b32 v1, 4, v0
 v_add_u32 v18, s66, v1
 v_accvgpr_read_b32 v108, a0
 v_accvgpr_read_b32 v124, a64
 v_accvgpr_read_b32 v140, a128
 v_accvgpr_read_b32 v156, a192
 v_accvgpr_read_b32 v109, a1
 v_accvgpr_read_b32 v125, a65
 v_accvgpr_read_b32 v141, a129
 v_accvgpr_read_b32 v157, a193
 v_accvgpr_read_b32 v110, a2
 v_accvgpr_read_b32 v126, a66
 v_accvgpr_read_b32 v142, a130
 v_accvgpr_read_b32 v158, a194
 v_accvgpr_read_b32 v111, a3
 v_accvgpr_read_b32 v127, a67
 v_accvgpr_read_b32 v143, a131
 v_accvgpr_read_b32 v159, a195
 v_accvgpr_read_b32 v112, a4
 v_accvgpr_read_b32 v128, a68
 v_accvgpr_read_b32 v144, a132
 v_accvgpr_read_b32 v160, a196
 v_accvgpr_read_b32 v113, a5
 v_accvgpr_read_b32 v129, a69
 v_accvgpr_read_b32 v145, a133
 v_accvgpr_read_b32 v161, a197
 v_accvgpr_read_b32 v114, a6
 v_accvgpr_read_b32 v130, a70
 v_accvgpr_read_b32 v146, a134
 v_accvgpr_read_b32 v162, a198
 v_accvgpr_read_b32 v115, a7
 v_accvgpr_read_b32 v131, a71
 v_accvgpr_read_b32 v147, a135
 v_accvgpr_read_b32 v163, a199
 v_accvgpr_read_b32 v116, a8
 v_accvgpr_read_b32 v132, a72
 v_accvgpr_read_b32 v148, a136
 v_accvgpr_read_b32 v164, a200
 v_accvgpr_read_b32 v117, a9
 v_accvgpr_read_b32 v133, a73
 v_accvgpr_read_b32 v149, a137
 v_accvgpr_read_b32 v165, a201
 v_accvgpr_read_b32 v118, a10
 v_accvgpr_read_b32 v134, a74
 v_accvgpr_read_b32 v150, a138
 v_accvgpr_read_b32 v166, a202
 v_accvgpr_read_b32 v119, a11
 v_accvgpr_read_b32 v135, a75
 v_accvgpr_read_b32 v151, a139
 v_accvgpr_read_b32 v167, a203
 v_accvgpr_read_b32 v120, a12
 v_accvgpr_read_b32 v136, a76
 v_accvgpr_read_b32 v152, a140
 v_accvgpr_read_b32 v168, a204
 v_accvgpr_read_b32 v121, a13
 v_accvgpr_read_b32 v137, a77
 v_accvgpr_read_b32 v153, a141
 v_accvgpr_read_b32 v169, a205
 v_accvgpr_read_b32 v122, a14
 v_accvgpr_read_b32 v138, a78
 v_accvgpr_read_b32 v154, a142
 v_accvgpr_read_b32 v170, a206
 v_accvgpr_read_b32 v123, a15
 v_accvgpr_read_b32 v139, a79
 v_accvgpr_read_b32 v155, a143
 v_accvgpr_read_b32 v171, a207
 v_pk_add_f32 v[172:173], v[108:109], v[124:125]
 v_pk_add_f32 v[108:109], v[108:109], v[124:125] neg_lo:[0,1] neg_hi:[0,1]
 v_pk_add_f32 v[188:189], v[140:141], v[156:157]
 v_pk_add_f32 v[140:141], v[140:141], v[156:157] neg_lo:[0,1] neg_hi:[0,1]
 v_pk_add_f32 v[174:175], v[110:111], v[126:127]
 v_pk_add_f32 v[110:111], v[110:111], v[126:127] neg_lo:[0,1] neg_hi:[0,1]
 v_pk_add_f32 v[190:191], v[142:143], v[158:159]
 v_pk_add_f32 v[142:143], v[142:143], v[158:159] neg_lo:[0,1] neg_hi:[0,1]
 v_pk_add_f32 v[176:177], v[112:113], v[128:129]
 v_pk_add_f32 v[112:113], v[112:113], v[128:129] neg_lo:[0,1] neg_hi:[0,1]
 v_pk_add_f32 v[192:193], v[144:145], v[160:161]
 v_pk_add_f32 v[144:145], v[144:145], v[160:161] neg_lo:[0,1] neg_hi:[0,1]
 v_pk_add_f32 v[178:179], v[114:115], v[130:131]
 v_pk_add_f32 v[114:115], v[114:115], v[130:131] neg_lo:[0,1] neg_hi:[0,1]
 v_pk_add_f32 v[194:195], v[146:147], v[162:163]
 v_pk_add_f32 v[146:147], v[146:147], v[162:163] neg_lo:[0,1] neg_hi:[0,1]
 v_pk_add_f32 v[180:181], v[116:117], v[132:133]
 v_pk_add_f32 v[116:117], v[116:117], v[132:133] neg_lo:[0,1] neg_hi:[0,1]
 v_pk_add_f32 v[196:197], v[148:149], v[164:165]
 v_pk_add_f32 v[148:149], v[148:149], v[164:165] neg_lo:[0,1] neg_hi:[0,1]
 v_pk_add_f32 v[182:183], v[118:119], v[134:135]
 v_pk_add_f32 v[118:119], v[118:119], v[134:135] neg_lo:[0,1] neg_hi:[0,1]
 v_pk_add_f32 v[198:199], v[150:151], v[166:167]
 v_pk_add_f32 v[150:151], v[150:151], v[166:167] neg_lo:[0,1] neg_hi:[0,1]
 v_pk_add_f32 v[184:185], v[120:121], v[136:137]
 v_pk_add_f32 v[120:121], v[120:121], v[136:137] neg_lo:[0,1] neg_hi:[0,1]
 v_pk_add_f32 v[200:201], v[152:153], v[168:169]
 v_pk_add_f32 v[152:153], v[152:153], v[168:169] neg_lo:[0,1] neg_hi:[0,1]
 v_pk_add_f32 v[186:187], v[122:123], v[138:139]
 v_pk_add_f32 v[122:123], v[122:123], v[138:139] neg_lo:[0,1] neg_hi:[0,1]
 v_pk_add_f32 v[202:203], v[154:155], v[170:171]
 v_pk_add_f32 v[154:155], v[154:155], v[170:171] neg_lo:[0,1] neg_hi:[0,1]
 v_pk_add_f32 v[124:125], v[172:173], v[188:189]
 v_cvt_pk_bf16_f32 v76, v124, v125
 v_pk_add_f32 v[124:125], v[174:175], v[190:191]
 v_cvt_pk_bf16_f32 v77, v124, v125
 v_pk_add_f32 v[124:125], v[176:177], v[192:193]
 v_cvt_pk_bf16_f32 v78, v124, v125
 v_pk_add_f32 v[124:125], v[178:179], v[194:195]
 v_cvt_pk_bf16_f32 v79, v124, v125
 v_pk_add_f32 v[124:125], v[180:181], v[196:197]
 v_cvt_pk_bf16_f32 v80, v124, v125
 v_pk_add_f32 v[124:125], v[182:183], v[198:199]
 v_cvt_pk_bf16_f32 v81, v124, v125
 v_pk_add_f32 v[124:125], v[184:185], v[200:201]
 v_cvt_pk_bf16_f32 v82, v124, v125
 v_pk_add_f32 v[124:125], v[186:187], v[202:203]
 v_cvt_pk_bf16_f32 v83, v124, v125
 ds_write_b128 v18, v[76:79] offset:0
 ds_write_b128 v18, v[80:83] offset:1024
 v_pk_add_f32 v[124:125], v[172:173], v[188:189] neg_lo:[0,1] neg_hi:[0,1]
 v_cvt_pk_bf16_f32 v84, v124, v125
 v_pk_add_f32 v[124:125], v[174:175], v[190:191] neg_lo:[0,1] neg_hi:[0,1]
 v_cvt_pk_bf16_f32 v85, v124, v125
 v_pk_add_f32 v[124:125], v[176:177], v[192:193] neg_lo:[0,1] neg_hi:[0,1]
 v_cvt_pk_bf16_f32 v86, v124, v125
 v_pk_add_f32 v[124:125], v[178:179], v[194:195] neg_lo:[0,1] neg_hi:[0,1]
 v_cvt_pk_bf16_f32 v87, v124, v125
 v_pk_add_f32 v[124:125], v[180:181], v[196:197] neg_lo:[0,1] neg_hi:[0,1]
 v_cvt_pk_bf16_f32 v88, v124, v125
 v_pk_add_f32 v[124:125], v[182:183], v[198:199] neg_lo:[0,1] neg_hi:[0,1]
 v_cvt_pk_bf16_f32 v89, v124, v125
 v_pk_add_f32 v[124:125], v[184:185], v[200:201] neg_lo:[0,1] neg_hi:[0,1]
 v_cvt_pk_bf16_f32 v90, v124, v125
 v_pk_add_f32 v[124:125], v[186:187], v[202:203] neg_lo:[0,1] neg_hi:[0,1]
 v_cvt_pk_bf16_f32 v91, v124, v125
 ds_write_b128 v18, v[84:87] offset:2048
 ds_write_b128 v18, v[88:91] offset:3072
 v_pk_add_f32 v[124:125], v[108:109], v[140:141]
 v_cvt_pk_bf16_f32 v92, v124, v125
 v_pk_add_f32 v[124:125], v[110:111], v[142:143]
 v_cvt_pk_bf16_f32 v93, v124, v125
 v_pk_add_f32 v[124:125], v[112:113], v[144:145]
 v_cvt_pk_bf16_f32 v94, v124, v125
 v_pk_add_f32 v[124:125], v[114:115], v[146:147]
 v_cvt_pk_bf16_f32 v95, v124, v125
 v_pk_add_f32 v[124:125], v[116:117], v[148:149]
 v_cvt_pk_bf16_f32 v96, v124, v125
 v_pk_add_f32 v[124:125], v[118:119], v[150:151]
 v_cvt_pk_bf16_f32 v97, v124, v125
 v_pk_add_f32 v[124:125], v[120:121], v[152:153]
 v_cvt_pk_bf16_f32 v98, v124, v125
 v_pk_add_f32 v[124:125], v[122:123], v[154:155]
 v_cvt_pk_bf16_f32 v99, v124, v125
 ds_write_b128 v18, v[92:95] offset:16384
 ds_write_b128 v18, v[96:99] offset:17408
 v_pk_add_f32 v[124:125], v[108:109], v[140:141] neg_lo:[0,1] neg_hi:[0,1]
 v_cvt_pk_bf16_f32 v100, v124, v125
 v_pk_add_f32 v[124:125], v[110:111], v[142:143] neg_lo:[0,1] neg_hi:[0,1]
 v_cvt_pk_bf16_f32 v101, v124, v125
 v_pk_add_f32 v[124:125], v[112:113], v[144:145] neg_lo:[0,1] neg_hi:[0,1]
 v_cvt_pk_bf16_f32 v102, v124, v125
 v_pk_add_f32 v[124:125], v[114:115], v[146:147] neg_lo:[0,1] neg_hi:[0,1]
 v_cvt_pk_bf16_f32 v103, v124, v125
 v_pk_add_f32 v[124:125], v[116:117], v[148:149] neg_lo:[0,1] neg_hi:[0,1]
 v_cvt_pk_bf16_f32 v104, v124, v125
 v_pk_add_f32 v[124:125], v[118:119], v[150:151] neg_lo:[0,1] neg_hi:[0,1]
 v_cvt_pk_bf16_f32 v105, v124, v125
 v_pk_add_f32 v[124:125], v[120:121], v[152:153] neg_lo:[0,1] neg_hi:[0,1]
 v_cvt_pk_bf16_f32 v106, v124, v125
 v_pk_add_f32 v[124:125], v[122:123], v[154:155] neg_lo:[0,1] neg_hi:[0,1]
 v_cvt_pk_bf16_f32 v107, v124, v125
 ds_write_b128 v18, v[100:103] offset:18432
 ds_write_b128 v18, v[104:107] offset:19456
 v_accvgpr_read_b32 v108, a16
 v_accvgpr_read_b32 v124, a80
 v_accvgpr_read_b32 v140, a144
 v_accvgpr_read_b32 v156, a208
 v_accvgpr_read_b32 v109, a17
 v_accvgpr_read_b32 v125, a81
 v_accvgpr_read_b32 v141, a145
 v_accvgpr_read_b32 v157, a209
 v_accvgpr_read_b32 v110, a18
 v_accvgpr_read_b32 v126, a82
 v_accvgpr_read_b32 v142, a146
 v_accvgpr_read_b32 v158, a210
 v_accvgpr_read_b32 v111, a19
 v_accvgpr_read_b32 v127, a83
 v_accvgpr_read_b32 v143, a147
 v_accvgpr_read_b32 v159, a211
 v_accvgpr_read_b32 v112, a20
 v_accvgpr_read_b32 v128, a84
 v_accvgpr_read_b32 v144, a148
 v_accvgpr_read_b32 v160, a212
 v_accvgpr_read_b32 v113, a21
 v_accvgpr_read_b32 v129, a85
 v_accvgpr_read_b32 v145, a149
 v_accvgpr_read_b32 v161, a213
 v_accvgpr_read_b32 v114, a22
 v_accvgpr_read_b32 v130, a86
 v_accvgpr_read_b32 v146, a150
 v_accvgpr_read_b32 v162, a214
 v_accvgpr_read_b32 v115, a23
 v_accvgpr_read_b32 v131, a87
 v_accvgpr_read_b32 v147, a151
 v_accvgpr_read_b32 v163, a215
 v_accvgpr_read_b32 v116, a24
 v_accvgpr_read_b32 v132, a88
 v_accvgpr_read_b32 v148, a152
 v_accvgpr_read_b32 v164, a216
 v_accvgpr_read_b32 v117, a25
 v_accvgpr_read_b32 v133, a89
 v_accvgpr_read_b32 v149, a153
 v_accvgpr_read_b32 v165, a217
 v_accvgpr_read_b32 v118, a26
 v_accvgpr_read_b32 v134, a90
 v_accvgpr_read_b32 v150, a154
 v_accvgpr_read_b32 v166, a218
 v_accvgpr_read_b32 v119, a27
 v_accvgpr_read_b32 v135, a91
 v_accvgpr_read_b32 v151, a155
 v_accvgpr_read_b32 v167, a219
 v_accvgpr_read_b32 v120, a28
 v_accvgpr_read_b32 v136, a92
 v_accvgpr_read_b32 v152, a156
 v_accvgpr_read_b32 v168, a220
 v_accvgpr_read_b32 v121, a29
 v_accvgpr_read_b32 v137, a93
 v_accvgpr_read_b32 v153, a157
 v_accvgpr_read_b32 v169, a221
 v_accvgpr_read_b32 v122, a30
 v_accvgpr_read_b32 v138, a94
 v_accvgpr_read_b32 v154, a158
 v_accvgpr_read_b32 v170, a222
 v_accvgpr_read_b32 v123, a31
 v_accvgpr_read_b32 v139, a95
 v_accvgpr_read_b32 v155, a159
 v_accvgpr_read_b32 v171, a223
 v_pk_add_f32 v[172:173], v[108:109], v[124:125]
 v_pk_add_f32 v[108:109], v[108:109], v[124:125] neg_lo:[0,1] neg_hi:[0,1]
 v_pk_add_f32 v[188:189], v[140:141], v[156:157]
 v_pk_add_f32 v[140:141], v[140:141], v[156:157] neg_lo:[0,1] neg_hi:[0,1]
 v_pk_add_f32 v[174:175], v[110:111], v[126:127]
 v_pk_add_f32 v[110:111], v[110:111], v[126:127] neg_lo:[0,1] neg_hi:[0,1]
 v_pk_add_f32 v[190:191], v[142:143], v[158:159]
 v_pk_add_f32 v[142:143], v[142:143], v[158:159] neg_lo:[0,1] neg_hi:[0,1]
 v_pk_add_f32 v[176:177], v[112:113], v[128:129]
 v_pk_add_f32 v[112:113], v[112:113], v[128:129] neg_lo:[0,1] neg_hi:[0,1]
 v_pk_add_f32 v[192:193], v[144:145], v[160:161]
 v_pk_add_f32 v[144:145], v[144:145], v[160:161] neg_lo:[0,1] neg_hi:[0,1]
 v_pk_add_f32 v[178:179], v[114:115], v[130:131]
 v_pk_add_f32 v[114:115], v[114:115], v[130:131] neg_lo:[0,1] neg_hi:[0,1]
 v_pk_add_f32 v[194:195], v[146:147], v[162:163]
 v_pk_add_f32 v[146:147], v[146:147], v[162:163] neg_lo:[0,1] neg_hi:[0,1]
 v_pk_add_f32 v[180:181], v[116:117], v[132:133]
 v_pk_add_f32 v[116:117], v[116:117], v[132:133] neg_lo:[0,1] neg_hi:[0,1]
 v_pk_add_f32 v[196:197], v[148:149], v[164:165]
 v_pk_add_f32 v[148:149], v[148:149], v[164:165] neg_lo:[0,1] neg_hi:[0,1]
 v_pk_add_f32 v[182:183], v[118:119], v[134:135]
 v_pk_add_f32 v[118:119], v[118:119], v[134:135] neg_lo:[0,1] neg_hi:[0,1]
 v_pk_add_f32 v[198:199], v[150:151], v[166:167]
 v_pk_add_f32 v[150:151], v[150:151], v[166:167] neg_lo:[0,1] neg_hi:[0,1]
 v_pk_add_f32 v[184:185], v[120:121], v[136:137]
 v_pk_add_f32 v[120:121], v[120:121], v[136:137] neg_lo:[0,1] neg_hi:[0,1]
 v_pk_add_f32 v[200:201], v[152:153], v[168:169]
 v_pk_add_f32 v[152:153], v[152:153], v[168:169] neg_lo:[0,1] neg_hi:[0,1]
 v_pk_add_f32 v[186:187], v[122:123], v[138:139]
 v_pk_add_f32 v[122:123], v[122:123], v[138:139] neg_lo:[0,1] neg_hi:[0,1]
 v_pk_add_f32 v[202:203], v[154:155], v[170:171]
 v_pk_add_f32 v[154:155], v[154:155], v[170:171] neg_lo:[0,1] neg_hi:[0,1]
 v_pk_add_f32 v[124:125], v[172:173], v[188:189]
 v_cvt_pk_bf16_f32 v76, v124, v125
 v_pk_add_f32 v[124:125], v[174:175], v[190:191]
 v_cvt_pk_bf16_f32 v77, v124, v125
 v_pk_add_f32 v[124:125], v[176:177], v[192:193]
 v_cvt_pk_bf16_f32 v78, v124, v125
 v_pk_add_f32 v[124:125], v[178:179], v[194:195]
 v_cvt_pk_bf16_f32 v79, v124, v125
 v_pk_add_f32 v[124:125], v[180:181], v[196:197]
 v_cvt_pk_bf16_f32 v80, v124, v125
 v_pk_add_f32 v[124:125], v[182:183], v[198:199]
 v_cvt_pk_bf16_f32 v81, v124, v125
 v_pk_add_f32 v[124:125], v[184:185], v[200:201]
 v_cvt_pk_bf16_f32 v82, v124, v125
 v_pk_add_f32 v[124:125], v[186:187], v[202:203]
 v_cvt_pk_bf16_f32 v83, v124, v125
 ds_write_b128 v18, v[76:79] offset:4096
 ds_write_b128 v18, v[80:83] offset:5120
 v_pk_add_f32 v[124:125], v[172:173], v[188:189] neg_lo:[0,1] neg_hi:[0,1]
 v_cvt_pk_bf16_f32 v84, v124, v125
 v_pk_add_f32 v[124:125], v[174:175], v[190:191] neg_lo:[0,1] neg_hi:[0,1]
 v_cvt_pk_bf16_f32 v85, v124, v125
 v_pk_add_f32 v[124:125], v[176:177], v[192:193] neg_lo:[0,1] neg_hi:[0,1]
 v_cvt_pk_bf16_f32 v86, v124, v125
 v_pk_add_f32 v[124:125], v[178:179], v[194:195] neg_lo:[0,1] neg_hi:[0,1]
 v_cvt_pk_bf16_f32 v87, v124, v125
 v_pk_add_f32 v[124:125], v[180:181], v[196:197] neg_lo:[0,1] neg_hi:[0,1]
 v_cvt_pk_bf16_f32 v88, v124, v125
 v_pk_add_f32 v[124:125], v[182:183], v[198:199] neg_lo:[0,1] neg_hi:[0,1]
 v_cvt_pk_bf16_f32 v89, v124, v125
 v_pk_add_f32 v[124:125], v[184:185], v[200:201] neg_lo:[0,1] neg_hi:[0,1]
 v_cvt_pk_bf16_f32 v90, v124, v125
 v_pk_add_f32 v[124:125], v[186:187], v[202:203] neg_lo:[0,1] neg_hi:[0,1]
 v_cvt_pk_bf16_f32 v91, v124, v125
 ds_write_b128 v18, v[84:87] offset:6144
 ds_write_b128 v18, v[88:91] offset:7168
 v_pk_add_f32 v[124:125], v[108:109], v[140:141]
 v_cvt_pk_bf16_f32 v92, v124, v125
 v_pk_add_f32 v[124:125], v[110:111], v[142:143]
 v_cvt_pk_bf16_f32 v93, v124, v125
 v_pk_add_f32 v[124:125], v[112:113], v[144:145]
 v_cvt_pk_bf16_f32 v94, v124, v125
 v_pk_add_f32 v[124:125], v[114:115], v[146:147]
 v_cvt_pk_bf16_f32 v95, v124, v125
 v_pk_add_f32 v[124:125], v[116:117], v[148:149]
 v_cvt_pk_bf16_f32 v96, v124, v125
 v_pk_add_f32 v[124:125], v[118:119], v[150:151]
 v_cvt_pk_bf16_f32 v97, v124, v125
 v_pk_add_f32 v[124:125], v[120:121], v[152:153]
 v_cvt_pk_bf16_f32 v98, v124, v125
 v_pk_add_f32 v[124:125], v[122:123], v[154:155]
 v_cvt_pk_bf16_f32 v99, v124, v125
 ds_write_b128 v18, v[92:95] offset:20480
 ds_write_b128 v18, v[96:99] offset:21504
 v_pk_add_f32 v[124:125], v[108:109], v[140:141] neg_lo:[0,1] neg_hi:[0,1]
 v_cvt_pk_bf16_f32 v100, v124, v125
 v_pk_add_f32 v[124:125], v[110:111], v[142:143] neg_lo:[0,1] neg_hi:[0,1]
 v_cvt_pk_bf16_f32 v101, v124, v125
 v_pk_add_f32 v[124:125], v[112:113], v[144:145] neg_lo:[0,1] neg_hi:[0,1]
 v_cvt_pk_bf16_f32 v102, v124, v125
 v_pk_add_f32 v[124:125], v[114:115], v[146:147] neg_lo:[0,1] neg_hi:[0,1]
 v_cvt_pk_bf16_f32 v103, v124, v125
 v_pk_add_f32 v[124:125], v[116:117], v[148:149] neg_lo:[0,1] neg_hi:[0,1]
 v_cvt_pk_bf16_f32 v104, v124, v125
 v_pk_add_f32 v[124:125], v[118:119], v[150:151] neg_lo:[0,1] neg_hi:[0,1]
 v_cvt_pk_bf16_f32 v105, v124, v125
 v_pk_add_f32 v[124:125], v[120:121], v[152:153] neg_lo:[0,1] neg_hi:[0,1]
 v_cvt_pk_bf16_f32 v106, v124, v125
 v_pk_add_f32 v[124:125], v[122:123], v[154:155] neg_lo:[0,1] neg_hi:[0,1]
 v_cvt_pk_bf16_f32 v107, v124, v125
 ds_write_b128 v18, v[100:103] offset:22528
 ds_write_b128 v18, v[104:107] offset:23552
 v_accvgpr_read_b32 v108, a32
 v_accvgpr_read_b32 v124, a96
 v_accvgpr_read_b32 v140, a160
 v_accvgpr_read_b32 v156, a224
 v_accvgpr_read_b32 v109, a33
 v_accvgpr_read_b32 v125, a97
 v_accvgpr_read_b32 v141, a161
 v_accvgpr_read_b32 v157, a225
 v_accvgpr_read_b32 v110, a34
 v_accvgpr_read_b32 v126, a98
 v_accvgpr_read_b32 v142, a162
 v_accvgpr_read_b32 v158, a226
 v_accvgpr_read_b32 v111, a35
 v_accvgpr_read_b32 v127, a99
 v_accvgpr_read_b32 v143, a163
 v_accvgpr_read_b32 v159, a227
 v_accvgpr_read_b32 v112, a36
 v_accvgpr_read_b32 v128, a100
 v_accvgpr_read_b32 v144, a164
 v_accvgpr_read_b32 v160, a228
 v_accvgpr_read_b32 v113, a37
 v_accvgpr_read_b32 v129, a101
 v_accvgpr_read_b32 v145, a165
 v_accvgpr_read_b32 v161, a229
 v_accvgpr_read_b32 v114, a38
 v_accvgpr_read_b32 v130, a102
 v_accvgpr_read_b32 v146, a166
 v_accvgpr_read_b32 v162, a230
 v_accvgpr_read_b32 v115, a39
 v_accvgpr_read_b32 v131, a103
 v_accvgpr_read_b32 v147, a167
 v_accvgpr_read_b32 v163, a231
 v_accvgpr_read_b32 v116, a40
 v_accvgpr_read_b32 v132, a104
 v_accvgpr_read_b32 v148, a168
 v_accvgpr_read_b32 v164, a232
 v_accvgpr_read_b32 v117, a41
 v_accvgpr_read_b32 v133, a105
 v_accvgpr_read_b32 v149, a169
 v_accvgpr_read_b32 v165, a233
 v_accvgpr_read_b32 v118, a42
 v_accvgpr_read_b32 v134, a106
 v_accvgpr_read_b32 v150, a170
 v_accvgpr_read_b32 v166, a234
 v_accvgpr_read_b32 v119, a43
 v_accvgpr_read_b32 v135, a107
 v_accvgpr_read_b32 v151, a171
 v_accvgpr_read_b32 v167, a235
 v_accvgpr_read_b32 v120, a44
 v_accvgpr_read_b32 v136, a108
 v_accvgpr_read_b32 v152, a172
 v_accvgpr_read_b32 v168, a236
 v_accvgpr_read_b32 v121, a45
 v_accvgpr_read_b32 v137, a109
 v_accvgpr_read_b32 v153, a173
 v_accvgpr_read_b32 v169, a237
 v_accvgpr_read_b32 v122, a46
 v_accvgpr_read_b32 v138, a110
 v_accvgpr_read_b32 v154, a174
 v_accvgpr_read_b32 v170, a238
 v_accvgpr_read_b32 v123, a47
 v_accvgpr_read_b32 v139, a111
 v_accvgpr_read_b32 v155, a175
 v_accvgpr_read_b32 v171, a239
 v_pk_add_f32 v[172:173], v[108:109], v[124:125]
 v_pk_add_f32 v[108:109], v[108:109], v[124:125] neg_lo:[0,1] neg_hi:[0,1]
 v_pk_add_f32 v[188:189], v[140:141], v[156:157]
 v_pk_add_f32 v[140:141], v[140:141], v[156:157] neg_lo:[0,1] neg_hi:[0,1]
 v_pk_add_f32 v[174:175], v[110:111], v[126:127]
 v_pk_add_f32 v[110:111], v[110:111], v[126:127] neg_lo:[0,1] neg_hi:[0,1]
 v_pk_add_f32 v[190:191], v[142:143], v[158:159]
 v_pk_add_f32 v[142:143], v[142:143], v[158:159] neg_lo:[0,1] neg_hi:[0,1]
 v_pk_add_f32 v[176:177], v[112:113], v[128:129]
 v_pk_add_f32 v[112:113], v[112:113], v[128:129] neg_lo:[0,1] neg_hi:[0,1]
 v_pk_add_f32 v[192:193], v[144:145], v[160:161]
 v_pk_add_f32 v[144:145], v[144:145], v[160:161] neg_lo:[0,1] neg_hi:[0,1]
 v_pk_add_f32 v[178:179], v[114:115], v[130:131]
 v_pk_add_f32 v[114:115], v[114:115], v[130:131] neg_lo:[0,1] neg_hi:[0,1]
 v_pk_add_f32 v[194:195], v[146:147], v[162:163]
 v_pk_add_f32 v[146:147], v[146:147], v[162:163] neg_lo:[0,1] neg_hi:[0,1]
 v_pk_add_f32 v[180:181], v[116:117], v[132:133]
 v_pk_add_f32 v[116:117], v[116:117], v[132:133] neg_lo:[0,1] neg_hi:[0,1]
 v_pk_add_f32 v[196:197], v[148:149], v[164:165]
 v_pk_add_f32 v[148:149], v[148:149], v[164:165] neg_lo:[0,1] neg_hi:[0,1]
 v_pk_add_f32 v[182:183], v[118:119], v[134:135]
 v_pk_add_f32 v[118:119], v[118:119], v[134:135] neg_lo:[0,1] neg_hi:[0,1]
 v_pk_add_f32 v[198:199], v[150:151], v[166:167]
 v_pk_add_f32 v[150:151], v[150:151], v[166:167] neg_lo:[0,1] neg_hi:[0,1]
 v_pk_add_f32 v[184:185], v[120:121], v[136:137]
 v_pk_add_f32 v[120:121], v[120:121], v[136:137] neg_lo:[0,1] neg_hi:[0,1]
 v_pk_add_f32 v[200:201], v[152:153], v[168:169]
 v_pk_add_f32 v[152:153], v[152:153], v[168:169] neg_lo:[0,1] neg_hi:[0,1]
 v_pk_add_f32 v[186:187], v[122:123], v[138:139]
 v_pk_add_f32 v[122:123], v[122:123], v[138:139] neg_lo:[0,1] neg_hi:[0,1]
 v_pk_add_f32 v[202:203], v[154:155], v[170:171]
 v_pk_add_f32 v[154:155], v[154:155], v[170:171] neg_lo:[0,1] neg_hi:[0,1]
 v_pk_add_f32 v[124:125], v[172:173], v[188:189]
 v_cvt_pk_bf16_f32 v76, v124, v125
 v_pk_add_f32 v[124:125], v[174:175], v[190:191]
 v_cvt_pk_bf16_f32 v77, v124, v125
 v_pk_add_f32 v[124:125], v[176:177], v[192:193]
 v_cvt_pk_bf16_f32 v78, v124, v125
 v_pk_add_f32 v[124:125], v[178:179], v[194:195]
 v_cvt_pk_bf16_f32 v79, v124, v125
 v_pk_add_f32 v[124:125], v[180:181], v[196:197]
 v_cvt_pk_bf16_f32 v80, v124, v125
 v_pk_add_f32 v[124:125], v[182:183], v[198:199]
 v_cvt_pk_bf16_f32 v81, v124, v125
 v_pk_add_f32 v[124:125], v[184:185], v[200:201]
 v_cvt_pk_bf16_f32 v82, v124, v125
 v_pk_add_f32 v[124:125], v[186:187], v[202:203]
 v_cvt_pk_bf16_f32 v83, v124, v125
 ds_write_b128 v18, v[76:79] offset:8192
 ds_write_b128 v18, v[80:83] offset:9216
 v_pk_add_f32 v[124:125], v[172:173], v[188:189] neg_lo:[0,1] neg_hi:[0,1]
 v_cvt_pk_bf16_f32 v84, v124, v125
 v_pk_add_f32 v[124:125], v[174:175], v[190:191] neg_lo:[0,1] neg_hi:[0,1]
 v_cvt_pk_bf16_f32 v85, v124, v125
 v_pk_add_f32 v[124:125], v[176:177], v[192:193] neg_lo:[0,1] neg_hi:[0,1]
 v_cvt_pk_bf16_f32 v86, v124, v125
 v_pk_add_f32 v[124:125], v[178:179], v[194:195] neg_lo:[0,1] neg_hi:[0,1]
 v_cvt_pk_bf16_f32 v87, v124, v125
 v_pk_add_f32 v[124:125], v[180:181], v[196:197] neg_lo:[0,1] neg_hi:[0,1]
 v_cvt_pk_bf16_f32 v88, v124, v125
 v_pk_add_f32 v[124:125], v[182:183], v[198:199] neg_lo:[0,1] neg_hi:[0,1]
 v_cvt_pk_bf16_f32 v89, v124, v125
 v_pk_add_f32 v[124:125], v[184:185], v[200:201] neg_lo:[0,1] neg_hi:[0,1]
 v_cvt_pk_bf16_f32 v90, v124, v125
 v_pk_add_f32 v[124:125], v[186:187], v[202:203] neg_lo:[0,1] neg_hi:[0,1]
 v_cvt_pk_bf16_f32 v91, v124, v125
 ds_write_b128 v18, v[84:87] offset:10240
 ds_write_b128 v18, v[88:91] offset:11264
 v_pk_add_f32 v[124:125], v[108:109], v[140:141]
 v_cvt_pk_bf16_f32 v92, v124, v125
 v_pk_add_f32 v[124:125], v[110:111], v[142:143]
 v_cvt_pk_bf16_f32 v93, v124, v125
 v_pk_add_f32 v[124:125], v[112:113], v[144:145]
 v_cvt_pk_bf16_f32 v94, v124, v125
 v_pk_add_f32 v[124:125], v[114:115], v[146:147]
 v_cvt_pk_bf16_f32 v95, v124, v125
 v_pk_add_f32 v[124:125], v[116:117], v[148:149]
 v_cvt_pk_bf16_f32 v96, v124, v125
 v_pk_add_f32 v[124:125], v[118:119], v[150:151]
 v_cvt_pk_bf16_f32 v97, v124, v125
 v_pk_add_f32 v[124:125], v[120:121], v[152:153]
 v_cvt_pk_bf16_f32 v98, v124, v125
 v_pk_add_f32 v[124:125], v[122:123], v[154:155]
 v_cvt_pk_bf16_f32 v99, v124, v125
 ds_write_b128 v18, v[92:95] offset:24576
 ds_write_b128 v18, v[96:99] offset:25600
 v_pk_add_f32 v[124:125], v[108:109], v[140:141] neg_lo:[0,1] neg_hi:[0,1]
 v_cvt_pk_bf16_f32 v100, v124, v125
 v_pk_add_f32 v[124:125], v[110:111], v[142:143] neg_lo:[0,1] neg_hi:[0,1]
 v_cvt_pk_bf16_f32 v101, v124, v125
 v_pk_add_f32 v[124:125], v[112:113], v[144:145] neg_lo:[0,1] neg_hi:[0,1]
 v_cvt_pk_bf16_f32 v102, v124, v125
 v_pk_add_f32 v[124:125], v[114:115], v[146:147] neg_lo:[0,1] neg_hi:[0,1]
 v_cvt_pk_bf16_f32 v103, v124, v125
 v_pk_add_f32 v[124:125], v[116:117], v[148:149] neg_lo:[0,1] neg_hi:[0,1]
 v_cvt_pk_bf16_f32 v104, v124, v125
 v_pk_add_f32 v[124:125], v[118:119], v[150:151] neg_lo:[0,1] neg_hi:[0,1]
 v_cvt_pk_bf16_f32 v105, v124, v125
 v_pk_add_f32 v[124:125], v[120:121], v[152:153] neg_lo:[0,1] neg_hi:[0,1]
 v_cvt_pk_bf16_f32 v106, v124, v125
 v_pk_add_f32 v[124:125], v[122:123], v[154:155] neg_lo:[0,1] neg_hi:[0,1]
 v_cvt_pk_bf16_f32 v107, v124, v125
 ds_write_b128 v18, v[100:103] offset:26624
 ds_write_b128 v18, v[104:107] offset:27648
 v_accvgpr_read_b32 v108, a48
 v_accvgpr_read_b32 v124, a112
 v_accvgpr_read_b32 v140, a176
 v_accvgpr_read_b32 v156, a240
 v_accvgpr_read_b32 v109, a49
 v_accvgpr_read_b32 v125, a113
 v_accvgpr_read_b32 v141, a177
 v_accvgpr_read_b32 v157, a241
 v_accvgpr_read_b32 v110, a50
 v_accvgpr_read_b32 v126, a114
 v_accvgpr_read_b32 v142, a178
 v_accvgpr_read_b32 v158, a242
 v_accvgpr_read_b32 v111, a51
 v_accvgpr_read_b32 v127, a115
 v_accvgpr_read_b32 v143, a179
 v_accvgpr_read_b32 v159, a243
 v_accvgpr_read_b32 v112, a52
 v_accvgpr_read_b32 v128, a116
 v_accvgpr_read_b32 v144, a180
 v_accvgpr_read_b32 v160, a244
 v_accvgpr_read_b32 v113, a53
 v_accvgpr_read_b32 v129, a117
 v_accvgpr_read_b32 v145, a181
 v_accvgpr_read_b32 v161, a245
 v_accvgpr_read_b32 v114, a54
 v_accvgpr_read_b32 v130, a118
 v_accvgpr_read_b32 v146, a182
 v_accvgpr_read_b32 v162, a246
 v_accvgpr_read_b32 v115, a55
 v_accvgpr_read_b32 v131, a119
 v_accvgpr_read_b32 v147, a183
 v_accvgpr_read_b32 v163, a247
 v_accvgpr_read_b32 v116, a56
 v_accvgpr_read_b32 v132, a120
 v_accvgpr_read_b32 v148, a184
 v_accvgpr_read_b32 v164, a248
 v_accvgpr_read_b32 v117, a57
 v_accvgpr_read_b32 v133, a121
 v_accvgpr_read_b32 v149, a185
 v_accvgpr_read_b32 v165, a249
 v_accvgpr_read_b32 v118, a58
 v_accvgpr_read_b32 v134, a122
 v_accvgpr_read_b32 v150, a186
 v_accvgpr_read_b32 v166, a250
 v_accvgpr_read_b32 v119, a59
 v_accvgpr_read_b32 v135, a123
 v_accvgpr_read_b32 v151, a187
 v_accvgpr_read_b32 v167, a251
 v_accvgpr_read_b32 v120, a60
 v_accvgpr_read_b32 v136, a124
 v_accvgpr_read_b32 v152, a188
 v_accvgpr_read_b32 v168, a252
 v_accvgpr_read_b32 v121, a61
 v_accvgpr_read_b32 v137, a125
 v_accvgpr_read_b32 v153, a189
 v_accvgpr_read_b32 v169, a253
 v_accvgpr_read_b32 v122, a62
 v_accvgpr_read_b32 v138, a126
 v_accvgpr_read_b32 v154, a190
 v_accvgpr_read_b32 v170, a254
 v_accvgpr_read_b32 v123, a63
 v_accvgpr_read_b32 v139, a127
 v_accvgpr_read_b32 v155, a191
 v_accvgpr_read_b32 v171, a255
 v_pk_add_f32 v[172:173], v[108:109], v[124:125]
 v_pk_add_f32 v[108:109], v[108:109], v[124:125] neg_lo:[0,1] neg_hi:[0,1]
 v_pk_add_f32 v[188:189], v[140:141], v[156:157]
 v_pk_add_f32 v[140:141], v[140:141], v[156:157] neg_lo:[0,1] neg_hi:[0,1]
 v_pk_add_f32 v[174:175], v[110:111], v[126:127]
 v_pk_add_f32 v[110:111], v[110:111], v[126:127] neg_lo:[0,1] neg_hi:[0,1]
 v_pk_add_f32 v[190:191], v[142:143], v[158:159]
 v_pk_add_f32 v[142:143], v[142:143], v[158:159] neg_lo:[0,1] neg_hi:[0,1]
 v_pk_add_f32 v[176:177], v[112:113], v[128:129]
 v_pk_add_f32 v[112:113], v[112:113], v[128:129] neg_lo:[0,1] neg_hi:[0,1]
 v_pk_add_f32 v[192:193], v[144:145], v[160:161]
 v_pk_add_f32 v[144:145], v[144:145], v[160:161] neg_lo:[0,1] neg_hi:[0,1]
 v_pk_add_f32 v[178:179], v[114:115], v[130:131]
 v_pk_add_f32 v[114:115], v[114:115], v[130:131] neg_lo:[0,1] neg_hi:[0,1]
 v_pk_add_f32 v[194:195], v[146:147], v[162:163]
 v_pk_add_f32 v[146:147], v[146:147], v[162:163] neg_lo:[0,1] neg_hi:[0,1]
 v_pk_add_f32 v[180:181], v[116:117], v[132:133]
 v_pk_add_f32 v[116:117], v[116:117], v[132:133] neg_lo:[0,1] neg_hi:[0,1]
 v_pk_add_f32 v[196:197], v[148:149], v[164:165]
 v_pk_add_f32 v[148:149], v[148:149], v[164:165] neg_lo:[0,1] neg_hi:[0,1]
 v_pk_add_f32 v[182:183], v[118:119], v[134:135]
 v_pk_add_f32 v[118:119], v[118:119], v[134:135] neg_lo:[0,1] neg_hi:[0,1]
 v_pk_add_f32 v[198:199], v[150:151], v[166:167]
 v_pk_add_f32 v[150:151], v[150:151], v[166:167] neg_lo:[0,1] neg_hi:[0,1]
 v_pk_add_f32 v[184:185], v[120:121], v[136:137]
 v_pk_add_f32 v[120:121], v[120:121], v[136:137] neg_lo:[0,1] neg_hi:[0,1]
 v_pk_add_f32 v[200:201], v[152:153], v[168:169]
 v_pk_add_f32 v[152:153], v[152:153], v[168:169] neg_lo:[0,1] neg_hi:[0,1]
 v_pk_add_f32 v[186:187], v[122:123], v[138:139]
 v_pk_add_f32 v[122:123], v[122:123], v[138:139] neg_lo:[0,1] neg_hi:[0,1]
 v_pk_add_f32 v[202:203], v[154:155], v[170:171]
 v_pk_add_f32 v[154:155], v[154:155], v[170:171] neg_lo:[0,1] neg_hi:[0,1]
 v_pk_add_f32 v[124:125], v[172:173], v[188:189]
 v_cvt_pk_bf16_f32 v76, v124, v125
 v_pk_add_f32 v[124:125], v[174:175], v[190:191]
 v_cvt_pk_bf16_f32 v77, v124, v125
 v_pk_add_f32 v[124:125], v[176:177], v[192:193]
 v_cvt_pk_bf16_f32 v78, v124, v125
 v_pk_add_f32 v[124:125], v[178:179], v[194:195]
 v_cvt_pk_bf16_f32 v79, v124, v125
 v_pk_add_f32 v[124:125], v[180:181], v[196:197]
 v_cvt_pk_bf16_f32 v80, v124, v125
 v_pk_add_f32 v[124:125], v[182:183], v[198:199]
 v_cvt_pk_bf16_f32 v81, v124, v125
 v_pk_add_f32 v[124:125], v[184:185], v[200:201]
 v_cvt_pk_bf16_f32 v82, v124, v125
 v_pk_add_f32 v[124:125], v[186:187], v[202:203]
 v_cvt_pk_bf16_f32 v83, v124, v125
 ds_write_b128 v18, v[76:79] offset:12288
 ds_write_b128 v18, v[80:83] offset:13312
 v_pk_add_f32 v[124:125], v[172:173], v[188:189] neg_lo:[0,1] neg_hi:[0,1]
 v_cvt_pk_bf16_f32 v84, v124, v125
 v_pk_add_f32 v[124:125], v[174:175], v[190:191] neg_lo:[0,1] neg_hi:[0,1]
 v_cvt_pk_bf16_f32 v85, v124, v125
 v_pk_add_f32 v[124:125], v[176:177], v[192:193] neg_lo:[0,1] neg_hi:[0,1]
 v_cvt_pk_bf16_f32 v86, v124, v125
 v_pk_add_f32 v[124:125], v[178:179], v[194:195] neg_lo:[0,1] neg_hi:[0,1]
 v_cvt_pk_bf16_f32 v87, v124, v125
 v_pk_add_f32 v[124:125], v[180:181], v[196:197] neg_lo:[0,1] neg_hi:[0,1]
 v_cvt_pk_bf16_f32 v88, v124, v125
 v_pk_add_f32 v[124:125], v[182:183], v[198:199] neg_lo:[0,1] neg_hi:[0,1]
 v_cvt_pk_bf16_f32 v89, v124, v125
 v_pk_add_f32 v[124:125], v[184:185], v[200:201] neg_lo:[0,1] neg_hi:[0,1]
 v_cvt_pk_bf16_f32 v90, v124, v125
 v_pk_add_f32 v[124:125], v[186:187], v[202:203] neg_lo:[0,1] neg_hi:[0,1]
 v_cvt_pk_bf16_f32 v91, v124, v125
 ds_write_b128 v18, v[84:87] offset:14336
 ds_write_b128 v18, v[88:91] offset:15360
 v_pk_add_f32 v[124:125], v[108:109], v[140:141]
 v_cvt_pk_bf16_f32 v92, v124, v125
 v_pk_add_f32 v[124:125], v[110:111], v[142:143]
 v_cvt_pk_bf16_f32 v93, v124, v125
 v_pk_add_f32 v[124:125], v[112:113], v[144:145]
 v_cvt_pk_bf16_f32 v94, v124, v125
 v_pk_add_f32 v[124:125], v[114:115], v[146:147]
 v_cvt_pk_bf16_f32 v95, v124, v125
 v_pk_add_f32 v[124:125], v[116:117], v[148:149]
 v_cvt_pk_bf16_f32 v96, v124, v125
 v_pk_add_f32 v[124:125], v[118:119], v[150:151]
 v_cvt_pk_bf16_f32 v97, v124, v125
 v_pk_add_f32 v[124:125], v[120:121], v[152:153]
 v_cvt_pk_bf16_f32 v98, v124, v125
 v_pk_add_f32 v[124:125], v[122:123], v[154:155]
 v_cvt_pk_bf16_f32 v99, v124, v125
 ds_write_b128 v18, v[92:95] offset:28672
 ds_write_b128 v18, v[96:99] offset:29696
 v_pk_add_f32 v[124:125], v[108:109], v[140:141] neg_lo:[0,1] neg_hi:[0,1]
 v_cvt_pk_bf16_f32 v100, v124, v125
 v_pk_add_f32 v[124:125], v[110:111], v[142:143] neg_lo:[0,1] neg_hi:[0,1]
 v_cvt_pk_bf16_f32 v101, v124, v125
 v_pk_add_f32 v[124:125], v[112:113], v[144:145] neg_lo:[0,1] neg_hi:[0,1]
 v_cvt_pk_bf16_f32 v102, v124, v125
 v_pk_add_f32 v[124:125], v[114:115], v[146:147] neg_lo:[0,1] neg_hi:[0,1]
 v_cvt_pk_bf16_f32 v103, v124, v125
 v_pk_add_f32 v[124:125], v[116:117], v[148:149] neg_lo:[0,1] neg_hi:[0,1]
 v_cvt_pk_bf16_f32 v104, v124, v125
 v_pk_add_f32 v[124:125], v[118:119], v[150:151] neg_lo:[0,1] neg_hi:[0,1]
 v_cvt_pk_bf16_f32 v105, v124, v125
 v_pk_add_f32 v[124:125], v[120:121], v[152:153] neg_lo:[0,1] neg_hi:[0,1]
 v_cvt_pk_bf16_f32 v106, v124, v125
 v_pk_add_f32 v[124:125], v[122:123], v[154:155] neg_lo:[0,1] neg_hi:[0,1]
 v_cvt_pk_bf16_f32 v107, v124, v125
 ds_write_b128 v18, v[100:103] offset:30720
 ds_write_b128 v18, v[104:107] offset:31744
 v_bfe_u32 v1, v0, 3, 2
 v_bfe_u32 v2, v0, 1, 2
 v_and_b32 v3, 1, v0
 v_lshlrev_b32 v19, 3, v5
 v_lshl_add_u32 v19, v6, 21, v19
 v_and_b32 v4, 7, v0
 v_bfe_u32 v17, v0, 3, 1
 v_lshlrev_b32 v17, 10, v17
 v_lshl_add_u32 v17, v4, 3, v17
 v_bfe_u32 v4, v0, 4, 1
 v_lshl_add_u32 v17, v4, 9, v17
 v_lshl_add_u32 v17, v6, 11, v17
 s_lshl_b32 s66, s62, 15
 v_add_u32 v17, s66, v17
 v_lshlrev_b32 v21, 2, v2
 v_lshlrev_b32 v16, 11, v2
 v_lshl_add_u32 v16, v6, 10, v16
 v_lshl_add_u32 v16, v1, 4, v16
 v_lshl_add_u32 v16, v3, 3, v16
 v_mov_b32 v20, 0
 s_lshl_b32 s89, s72, 2
 s_add_u32 s89, s89, s62
 s_lshl_b32 s86, s89, 17
 s_lshl_b32 s65, s60, 8
 s_add_u32 s86, s86, s65
 s_add_u32 s86, s86, 0x3000000
 s_lshl_b32 s87, s60, 7
 s_add_u32 s87, s87, 0x5000000
 s_lshl_b32 s88, s89, 6
 s_lshl_b32 s65, s60, 13
 s_add_u32 s88, s88, s65
 s_lshl_b32 s76, s60, 4
 s_add_u32 s76, s76, 0x6000000
 s_mov_b32 s75, 0
 v_mov_b32 v3, 0
L_f_mix_140:
 s_getpc_b64 s[94:95]
L_f_pc_141:
 s_sub_u32 s94, s94, L_f_pc_141-L_role_p_0
 s_subb_u32 s95, s95, 0
 s_lshl_b32 s65, s72, 2
 s_add_u32 s65, s65, s62
 s_mul_i32 s65, s65, 2304
 v_min_u32 v1, 17, v0
 v_lshlrev_b32 v1, 7, v1
 v_add_u32 v1, s65, v1
 global_load_dword v255, v1, s[94:95]
 s_getpc_b64 s[94:95]
L_f_pc_142:
 s_lshl_b32 s65, s72, 2
 s_add_u32 s65, s65, s62
 s_mul_i32 s65, s65, 384
 v_min_u32 v1, 2, v0
 v_lshlrev_b32 v1, 7, v1
 v_add_u32 v1, s65, v1
 global_load_dword v255, v1, s[94:95]
 s_lshr_b32 s65, s75, 3
 s_lshl_b32 s65, s65, 12
 s_and_b32 s66, s75, 7
 s_lshl_b32 s66, s66, 6
 s_add_u32 s65, s65, s66
 v_add_u32 v1, s65, v17
 buffer_load_dword v28, v21, s[4:7], s76 offen offset:0 sc1
 ds_read_b64 v[36:37], v1 offset:0
 buffer_load_dword v30, v21, s[4:7], s76 offen offset:128 sc1
 ds_read_b64 v[38:39], v1 offset:64
 buffer_load_dword v32, v21, s[4:7], s76 offen offset:256 sc1
 ds_read_b64 v[40:41], v1 offset:128
 buffer_load_dword v34, v21, s[4:7], s76 offen offset:384 sc1
 ds_read_b64 v[42:43], v1 offset:192
 s_add_u32 s67, s75, 6
 s_min_u32 s67, s67, 63
 v_cmp_gt_u32 vcc, s67, v3
 s_cbranch_vccz L_f_known_145
 s_branch L_f_w1_144
L_f_w_143:
 s_sleep 20
 s_sub_u32 s63, s63, 1
 s_cbranch_scc1 L_role_f_abort
L_f_w1_144:
 buffer_load_dword v3, v20, s[4:7], s87 offen sc1
 s_waitcnt vmcnt(0)
 v_cmp_gt_u32 vcc, s67, v3
 s_cbranch_vccnz L_f_w_143
L_f_known_145:
 s_add_u32 s65, s86, 0
 buffer_load_dwordx2 v[108:109], v19, s[4:7], s65 offen sc1
 s_add_u32 s65, s65, 0x400000
 buffer_load_dwordx2 v[110:111], v19, s[4:7], s65 offen sc1
 s_add_u32 s65, s65, 0x400000
 buffer_load_dwordx2 v[112:113], v19, s[4:7], s65 offen sc1
 s_add_u32 s65, s65, 0x400000
 buffer_load_dwordx2 v[114:115], v19, s[4:7], s65 offen sc1
 s_add_u32 s65, s65, 0x400000
 buffer_load_dwordx2 v[116:117], v19, s[4:7], s65 offen sc1
 s_add_u32 s65, s65, 0x400000
 buffer_load_dwordx2 v[118:119], v19, s[4:7], s65 offen sc1
 s_add_u32 s65, s65, 0x400000
 buffer_load_dwordx2 v[120:121], v19, s[4:7], s65 offen sc1
 s_add_u32 s65, s65, 0x400000
 buffer_load_dwordx2 v[122:123], v19, s[4:7], s65 offen sc1
 s_add_u32 s65, s86, 2048
 buffer_load_dwordx2 v[124:125], v19, s[4:7], s65 offen sc1
 s_add_u32 s65, s65, 0x400000
 buffer_load_dwordx2 v[126:127], v19, s[4:7], s65 offen sc1
 s_add_u32 s65, s65, 0x400000
 buffer_load_dwordx2 v[128:129], v19, s[4:7], s65 offen sc1
 s_add_u32 s65, s65, 0x400000
 buffer_load_dwordx2 v[130:131], v19, s[4:7], s65 offen sc1
 s_add_u32 s65, s65, 0x400000
 buffer_load_dwordx2 v[132:133], v19, s[4:7], s65 offen sc1
 s_add_u32 s65, s65, 0x400000
 buffer_load_dwordx2 v[134:135], v19, s[4:7], s65 offen sc1
 s_add_u32 s65, s65, 0x400000
 buffer_load_dwordx2 v[136:137], v19, s[4:7], s65 offen sc1
 s_add_u32 s65, s65, 0x400000
 buffer_load_dwordx2 v[138:139], v19, s[4:7], s65 offen sc1
 s_add_u32 s65, s86, 4096
 buffer_load_dwordx2 v[140:141], v19, s[4:7], s65 offen sc1
 s_add_u32 s65, s65, 0x400000
 buffer_load_dwordx2 v[142:143], v19, s[4:7], s65 offen sc1
 s_add_u32 s65, s65, 0x400000
 buffer_load_dwordx2 v[144:145], v19, s[4:7], s65 offen sc1
 s_add_u32 s65, s65, 0x400000
 buffer_load_dwordx2 v[146:147], v19, s[4:7], s65 offen sc1
 s_add_u32 s65, s65, 0x400000
 buffer_load_dwordx2 v[148:149], v19, s[4:7], s65 offen sc1
 s_add_u32 s65, s65, 0x400000
 buffer_load_dwordx2 v[150:151], v19, s[4:7], s65 offen sc1
 s_add_u32 s65, s65, 0x400000
 buffer_load_dwordx2 v[152:153], v19, s[4:7], s65 offen sc1
 s_add_u32 s65, s65, 0x400000
 buffer_load_dwordx2 v[154:155], v19, s[4:7], s65 offen sc1
 s_add_u32 s65, s86, 6144
 buffer_load_dwordx2 v[156:157], v19, s[4:7], s65 offen sc1
 s_add_u32 s65, s65, 0x400000
 buffer_load_dwordx2 v[158:159], v19, s[4:7], s65 offen sc1
 s_add_u32 s65, s65, 0x400000
 buffer_load_dwordx2 v[160:161], v19, s[4:7], s65 offen sc1
 s_add_u32 s65, s65, 0x400000
 buffer_load_dwordx2 v[162:163], v19, s[4:7], s65 offen sc1
 s_add_u32 s65, s65, 0x400000
 buffer_load_dwordx2 v[164:165], v19, s[4:7], s65 offen sc1
 s_add_u32 s65, s65, 0x400000
 buffer_load_dwordx2 v[166:167], v19, s[4:7], s65 offen sc1
 s_add_u32 s65, s65, 0x400000
 buffer_load_dwordx2 v[168:169], v19, s[4:7], s65 offen sc1
 s_add_u32 s65, s65, 0x400000
 buffer_load_dwordx2 v[170:171], v19, s[4:7], s65 offen sc1
 s_waitcnt lgkmcnt(0)
 v_lshlrev_b32 v80, 16, v36
 v_and_b32 v81, 0xffff0000, v36
 v_lshlrev_b32 v82, 16, v37
 v_and_b32 v83, 0xffff0000, v37
 s_waitcnt vmcnt(31)
 v_lshlrev_b32 v76, 16, v108
 v_and_b32 v77, 0xffff0000, v108
 v_lshlrev_b32 v78, 16, v109
 v_and_b32 v79, 0xffff0000, v109
 s_waitcnt vmcnt(30)
 v_lshlrev_b32 v84, 16, v110
 v_and_b32 v85, 0xffff0000, v110
 v_lshlrev_b32 v86, 16, v111
 v_and_b32 v87, 0xffff0000, v111
 v_pk_add_f32 v[76:77], v[76:77], v[84:85]
 v_pk_add_f32 v[78:79], v[78:79], v[86:87]
 s_waitcnt vmcnt(29)
 v_lshlrev_b32 v84, 16, v112
 v_and_b32 v85, 0xffff0000, v112
 v_lshlrev_b32 v86, 16, v113
 v_and_b32 v87, 0xffff0000, v113
 v_pk_add_f32 v[76:77], v[76:77], v[84:85]
 v_pk_add_f32 v[78:79], v[78:79], v[86:87]
 s_waitcnt vmcnt(28)
 v_lshlrev_b32 v84, 16, v114
 v_and_b32 v85, 0xffff0000, v114
 v_lshlrev_b32 v86, 16, v115
 v_and_b32 v87, 0xffff0000, v115
 v_pk_add_f32 v[76:77], v[76:77], v[84:85]
 v_pk_add_f32 v[78:79], v[78:79], v[86:87]
 s_waitcnt vmcnt(27)
 v_lshlrev_b32 v84, 16, v116
 v_and_b32 v85, 0xffff0000, v116
 v_lshlrev_b32 v86, 16, v117
 v_and_b32 v87, 0xffff0000, v117
 v_pk_add_f32 v[76:77], v[76:77], v[84:85]
 v_pk_add_f32 v[78:79], v[78:79], v[86:87]
 s_waitcnt vmcnt(26)
 v_lshlrev_b32 v84, 16, v118
 v_and_b32 v85, 0xffff0000, v118
 v_lshlrev_b32 v86, 16, v119
 v_and_b32 v87, 0xffff0000, v119
 v_pk_add_f32 v[76:77], v[76:77], v[84:85]
 v_pk_add_f32 v[78:79], v[78:79], v[86:87]
 s_waitcnt vmcnt(25)
 v_lshlrev_b32 v84, 16, v120
 v_and_b32 v85, 0xffff0000, v120
 v_lshlrev_b32 v86, 16, v121
 v_and_b32 v87, 0xffff0000, v121
 v_pk_add_f32 v[76:77], v[76:77], v[84:85]
 v_pk_add_f32 v[78:79], v[78:79], v[86:87]
 s_waitcnt vmcnt(24)
 v_lshlrev_b32 v84, 16, v122
 v_and_b32 v85, 0xffff0000, v122
 v_lshlrev_b32 v86, 16, v123
 v_and_b32 v87, 0xffff0000, v123
 v_pk_add_f32 v[76:77], v[76:77], v[84:85]
 v_pk_add_f32 v[78:79], v[78:79], v[86:87]
 v_pk_add_f32 v[76:77], v[76:77], v[80:81] neg_lo:[0,1] neg_hi:[0,1]
 v_pk_fma_f32 v[76:77], v[76:77], v[28:29], v[80:81] op_sel_hi:[1,0,1]
 v_cvt_pk_bf16_f32 v44, v76, v77
 v_pk_add_f32 v[78:79], v[78:79], v[82:83] neg_lo:[0,1] neg_hi:[0,1]
 v_pk_fma_f32 v[78:79], v[78:79], v[28:29], v[82:83] op_sel_hi:[1,0,1]
 v_cvt_pk_bf16_f32 v45, v78, v79
 buffer_store_dwordx2 v[44:45], v16, s[20:23], s88 offen sc1
 s_add_u32 s88, s88, 65536
 v_lshlrev_b32 v80, 16, v38
 v_and_b32 v81, 0xffff0000, v38
 v_lshlrev_b32 v82, 16, v39
 v_and_b32 v83, 0xffff0000, v39
 s_waitcnt vmcnt(24)
 v_lshlrev_b32 v76, 16, v124
 v_and_b32 v77, 0xffff0000, v124
 v_lshlrev_b32 v78, 16, v125
 v_and_b32 v79, 0xffff0000, v125
 s_waitcnt vmcnt(23)
 v_lshlrev_b32 v84, 16, v126
 v_and_b32 v85, 0xffff0000, v126
 v_lshlrev_b32 v86, 16, v127
 v_and_b32 v87, 0xffff0000, v127
 v_pk_add_f32 v[76:77], v[76:77], v[84:85]
 v_pk_add_f32 v[78:79], v[78:79], v[86:87]
 s_waitcnt vmcnt(22)
 v_lshlrev_b32 v84, 16, v128
 v_and_b32 v85, 0xffff0000, v128
 v_lshlrev_b32 v86, 16, v129
 v_and_b32 v87, 0xffff0000, v129
 v_pk_add_f32 v[76:77], v[76:77], v[84:85]
 v_pk_add_f32 v[78:79], v[78:79], v[86:87]
 s_waitcnt vmcnt(21)
 v_lshlrev_b32 v84, 16, v130
 v_and_b32 v85, 0xffff0000, v130
 v_lshlrev_b32 v86, 16, v131
 v_and_b32 v87, 0xffff0000, v131
 v_pk_add_f32 v[76:77], v[76:77], v[84:85]
 v_pk_add_f32 v[78:79], v[78:79], v[86:87]
 s_waitcnt vmcnt(20)
 v_lshlrev_b32 v84, 16, v132
 v_and_b32 v85, 0xffff0000, v132
 v_lshlrev_b32 v86, 16, v133
 v_and_b32 v87, 0xffff0000, v133
 v_pk_add_f32 v[76:77], v[76:77], v[84:85]
 v_pk_add_f32 v[78:79], v[78:79], v[86:87]
 s_waitcnt vmcnt(19)
 v_lshlrev_b32 v84, 16, v134
 v_and_b32 v85, 0xffff0000, v134
 v_lshlrev_b32 v86, 16, v135
 v_and_b32 v87, 0xffff0000, v135
 v_pk_add_f32 v[76:77], v[76:77], v[84:85]
 v_pk_add_f32 v[78:79], v[78:79], v[86:87]
 s_waitcnt vmcnt(18)
 v_lshlrev_b32 v84, 16, v136
 v_and_b32 v85, 0xffff0000, v136
 v_lshlrev_b32 v86, 16, v137
 v_and_b32 v87, 0xffff0000, v137
 v_pk_add_f32 v[76:77], v[76:77], v[84:85]
 v_pk_add_f32 v[78:79], v[78:79], v[86:87]
 s_waitcnt vmcnt(17)
 v_lshlrev_b32 v84, 16, v138
 v_and_b32 v85, 0xffff0000, v138
 v_lshlrev_b32 v86, 16, v139
 v_and_b32 v87, 0xffff0000, v139
 v_pk_add_f32 v[76:77], v[76:77], v[84:85]
 v_pk_add_f32 v[78:79], v[78:79], v[86:87]
 v_pk_add_f32 v[76:77], v[76:77], v[80:81] neg_lo:[0,1] neg_hi:[0,1]
 v_pk_fma_f32 v[76:77], v[76:77], v[30:31], v[80:81] op_sel_hi:[1,0,1]
 v_cvt_pk_bf16_f32 v46, v76, v77
 v_pk_add_f32 v[78:79], v[78:79], v[82:83] neg_lo:[0,1] neg_hi:[0,1]
 v_pk_fma_f32 v[78:79], v[78:79], v[30:31], v[82:83] op_sel_hi:[1,0,1]
 v_cvt_pk_bf16_f32 v47, v78, v79
 buffer_store_dwordx2 v[46:47], v16, s[20:23], s88 offen sc1
 s_add_u32 s88, s88, 65536
 v_lshlrev_b32 v80, 16, v40
 v_and_b32 v81, 0xffff0000, v40
 v_lshlrev_b32 v82, 16, v41
 v_and_b32 v83, 0xffff0000, v41
 s_waitcnt vmcnt(17)
 v_lshlrev_b32 v76, 16, v140
 v_and_b32 v77, 0xffff0000, v140
 v_lshlrev_b32 v78, 16, v141
 v_and_b32 v79, 0xffff0000, v141
 s_waitcnt vmcnt(16)
 v_lshlrev_b32 v84, 16, v142
 v_and_b32 v85, 0xffff0000, v142
 v_lshlrev_b32 v86, 16, v143
 v_and_b32 v87, 0xffff0000, v143
 v_pk_add_f32 v[76:77], v[76:77], v[84:85]
 v_pk_add_f32 v[78:79], v[78:79], v[86:87]
 s_waitcnt vmcnt(15)
 v_lshlrev_b32 v84, 16, v144
 v_and_b32 v85, 0xffff0000, v144
 v_lshlrev_b32 v86, 16, v145
 v_and_b32 v87, 0xffff0000, v145
 v_pk_add_f32 v[76:77], v[76:77], v[84:85]
 v_pk_add_f32 v[78:79], v[78:79], v[86:87]
 s_waitcnt vmcnt(14)
 v_lshlrev_b32 v84, 16, v146
 v_and_b32 v85, 0xffff0000, v146
 v_lshlrev_b32 v86, 16, v147
 v_and_b32 v87, 0xffff0000, v147
 v_pk_add_f32 v[76:77], v[76:77], v[84:85]
 v_pk_add_f32 v[78:79], v[78:79], v[86:87]
 s_waitcnt vmcnt(13)
 v_lshlrev_b32 v84, 16, v148
 v_and_b32 v85, 0xffff0000, v148
 v_lshlrev_b32 v86, 16, v149
 v_and_b32 v87, 0xffff0000, v149
 v_pk_add_f32 v[76:77], v[76:77], v[84:85]
 v_pk_add_f32 v[78:79], v[78:79], v[86:87]
 s_waitcnt vmcnt(12)
 v_lshlrev_b32 v84, 16, v150
 v_and_b32 v85, 0xffff0000, v150
 v_lshlrev_b32 v86, 16, v151
 v_and_b32 v87, 0xffff0000, v151
 v_pk_add_f32 v[76:77], v[76:77], v[84:85]
 v_pk_add_f32 v[78:79], v[78:79], v[86:87]
 s_waitcnt vmcnt(11)
 v_lshlrev_b32 v84, 16, v152
 v_and_b32 v85, 0xffff0000, v152
 v_lshlrev_b32 v86, 16, v153
 v_and_b32 v87, 0xffff0000, v153
 v_pk_add_f32 v[76:77], v[76:77], v[84:85]
 v_pk_add_f32 v[78:79], v[78:79], v[86:87]
 s_waitcnt vmcnt(10)
 v_lshlrev_b32 v84, 16, v154
 v_and_b32 v85, 0xffff0000, v154
 v_lshlrev_b32 v86, 16, v155
 v_and_b32 v87, 0xffff0000, v155
 v_pk_add_f32 v[76:77], v[76:77], v[84:85]
 v_pk_add_f32 v[78:79], v[78:79], v[86:87]
 v_pk_add_f32 v[76:77], v[76:77], v[80:81] neg_lo:[0,1] neg_hi:[0,1]
 v_pk_fma_f32 v[76:77], v[76:77], v[32:33], v[80:81] op_sel_hi:[1,0,1]
 v_cvt_pk_bf16_f32 v48, v76, v77
 v_pk_add_f32 v[78:79], v[78:79], v[82:83] neg_lo:[0,1] neg_hi:[0,1]
 v_pk_fma_f32 v[78:79], v[78:79], v[32:33], v[82:83] op_sel_hi:[1,0,1]
 v_cvt_pk_bf16_f32 v49, v78, v79
 buffer_store_dwordx2 v[48:49], v16, s[20:23], s88 offen sc1
 s_add_u32 s88, s88, 65536
 v_lshlrev_b32 v80, 16, v42
 v_and_b32 v81, 0xffff0000, v42
 v_lshlrev_b32 v82, 16, v43
 v_and_b32 v83, 0xffff0000, v43
 s_waitcnt vmcnt(10)
 v_lshlrev_b32 v76, 16, v156
 v_and_b32 v77, 0xffff0000, v156
 v_lshlrev_b32 v78, 16, v157
 v_and_b32 v79, 0xffff0000, v157
 s_waitcnt vmcnt(9)
 v_lshlrev_b32 v84, 16, v158
 v_and_b32 v85, 0xffff0000, v158
 v_lshlrev_b32 v86, 16, v159
 v_and_b32 v87, 0xffff0000, v159
 v_pk_add_f32 v[76:77], v[76:77], v[84:85]
 v_pk_add_f32 v[78:79], v[78:79], v[86:87]
 s_waitcnt vmcnt(8)
 v_lshlrev_b32 v84, 16, v160
 v_and_b32 v85, 0xffff0000, v160
 v_lshlrev_b32 v86, 16, v161
 v_and_b32 v87, 0xffff0000, v161
 v_pk_add_f32 v[76:77], v[76:77], v[84:85]
 v_pk_add_f32 v[78:79], v[78:79], v[86:87]
 s_waitcnt vmcnt(7)
 v_lshlrev_b32 v84, 16, v162
 v_and_b32 v85, 0xffff0000, v162
 v_lshlrev_b32 v86, 16, v163
 v_and_b32 v87, 0xffff0000, v163
 v_pk_add_f32 v[76:77], v[76:77], v[84:85]
 v_pk_add_f32 v[78:79], v[78:79], v[86:87]
 s_waitcnt vmcnt(6)
 v_lshlrev_b32 v84, 16, v164
 v_and_b32 v85, 0xffff0000, v164
 v_lshlrev_b32 v86, 16, v165
 v_and_b32 v87, 0xffff0000, v165
 v_pk_add_f32 v[76:77], v[76:77], v[84:85]
 v_pk_add_f32 v[78:79], v[78:79], v[86:87]
 s_waitcnt vmcnt(5)
 v_lshlrev_b32 v84, 16, v166
 v_and_b32 v85, 0xffff0000, v166
 v_lshlrev_b32 v86, 16, v167
 v_and_b32 v87, 0xffff0000, v167
 v_pk_add_f32 v[76:77], v[76:77], v[84:85]
 v_pk_add_f32 v[78:79], v[78:79], v[86:87]
 s_waitcnt vmcnt(4)
 v_lshlrev_b32 v84, 16, v168
 v_and_b32 v85, 0xffff0000, v168
 v_lshlrev_b32 v86, 16, v169
 v_and_b32 v87, 0xffff0000, v169
 v_pk_add_f32 v[76:77], v[76:77], v[84:85]
 v_pk_add_f32 v[78:79], v[78:79], v[86:87]
 s_waitcnt vmcnt(3)
 v_lshlrev_b32 v84, 16, v170
 v_and_b32 v85, 0xffff0000, v170
 v_lshlrev_b32 v86, 16, v171
 v_and_b32 v87, 0xffff0000, v171
 v_pk_add_f32 v[76:77], v[76:77], v[84:85]
 v_pk_add_f32 v[78:79], v[78:79], v[86:87]
 v_pk_add_f32 v[76:77], v[76:77], v[80:81] neg_lo:[0,1] neg_hi:[0,1]
 v_pk_fma_f32 v[76:77], v[76:77], v[34:35], v[80:81] op_sel_hi:[1,0,1]
 v_cvt_pk_bf16_f32 v50, v76, v77
 v_pk_add_f32 v[78:79], v[78:79], v[82:83] neg_lo:[0,1] neg_hi:[0,1]
 v_pk_fma_f32 v[78:79], v[78:79], v[34:35], v[82:83] op_sel_hi:[1,0,1]
 v_cvt_pk_bf16_f32 v51, v78, v79
 buffer_store_dwordx2 v[50:51], v16, s[20:23], s88 offen sc1
 s_add_u32 s88, s88, 65536
 s_add_u32 s86, s86, 8192
 s_add_u32 s76, s76, 512
 s_cmp_eq_u32 s75, 36
 s_cbranch_scc0 L_f_mk_146
L_f_mk_146:
 s_add_u32 s75, s75, 4
 s_cmp_lt_u32 s75, 56
 s_cbranch_scc1 L_f_mix_140
L_f_mix_147:
 s_lshr_b32 s65, s75, 3
 s_lshl_b32 s65, s65, 12
 s_and_b32 s66, s75, 7
 s_lshl_b32 s66, s66, 6
 s_add_u32 s65, s65, s66
 v_add_u32 v1, s65, v17
 buffer_load_dword v28, v21, s[4:7], s76 offen offset:0 sc1
 ds_read_b64 v[36:37], v1 offset:0
 s_cmp_eq_u32 s75, 63
 s_cbranch_scc0 L_f_notw_151
 s_lshl_b32 s67, s60, 12
 s_add_u32 s67, s67, 0x6500c00
 v_and_b32 v2, 7, v0
 v_lshlrev_b32 v2, 7, v2
 s_branch L_pfirst_153
L_poll_152:
 s_sub_u32 s63, s63, 1
 s_cbranch_scc1 L_role_f_abort
L_pfirst_153:
 buffer_load_dword v3, v2, s[4:7], s67 offen sc1
 s_waitcnt vmcnt(0)
 v_mov_b32 v4, v3
 v_cmp_eq_u32 vcc, -1, v4
 s_cbranch_vccnz L_poll_152
 s_nop 15
 s_nop 15
 s_nop 7
 s_branch L_f_known_150
L_f_notw_151:
 s_add_u32 s67, s75, 3
 s_cmp_ge_u32 s75, 60
 s_cselect_b32 s68, 2, 0
 s_sub_u32 s67, s67, s68
 s_min_u32 s67, s67, 63
 v_cmp_gt_u32 vcc, s67, v3
 s_cbranch_vccz L_f_known_150
 s_branch L_f_w1_149
L_f_w_148:
 s_sleep 3
 s_sub_u32 s63, s63, 1
 s_cbranch_scc1 L_role_f_abort
L_f_w1_149:
 buffer_load_dword v3, v20, s[4:7], s87 offen sc1
 s_waitcnt vmcnt(0)
 v_cmp_gt_u32 vcc, s67, v3
 s_cbranch_vccnz L_f_w_148
 s_and_b32 s68, s75, 62
 s_cmp_eq_u32 s68, 60
 s_cbranch_scc0 L_f_known_150
 s_sleep 48
L_f_known_150:
L_f_d_154:
 s_add_u32 s65, s86, 0
 buffer_load_dwordx2 v[108:109], v19, s[4:7], s65 offen sc1
 s_add_u32 s65, s65, 0x400000
 buffer_load_dwordx2 v[110:111], v19, s[4:7], s65 offen sc1
 s_add_u32 s65, s65, 0x400000
 buffer_load_dwordx2 v[112:113], v19, s[4:7], s65 offen sc1
 s_add_u32 s65, s65, 0x400000
 buffer_load_dwordx2 v[114:115], v19, s[4:7], s65 offen sc1
 s_add_u32 s65, s65, 0x400000
 buffer_load_dwordx2 v[116:117], v19, s[4:7], s65 offen sc1
 s_add_u32 s65, s65, 0x400000
 buffer_load_dwordx2 v[118:119], v19, s[4:7], s65 offen sc1
 s_add_u32 s65, s65, 0x400000
 buffer_load_dwordx2 v[120:121], v19, s[4:7], s65 offen sc1
 s_add_u32 s65, s65, 0x400000
 buffer_load_dwordx2 v[122:123], v19, s[4:7], s65 offen sc1
 s_sub_u32 s63, s63, 1
 s_cbranch_scc1 L_role_f_abort
 s_waitcnt vmcnt(0)
 v_max3_u32 v4, v108, v110, v112
 v_max3_u32 v4, v4, v114, v116
 v_max3_u32 v4, v4, v118, v120
 v_max_u32 v4, v4, v122
 v_cmp_eq_u32 vcc, -1, v4
 s_cbranch_vccnz L_f_d_154
 s_waitcnt lgkmcnt(0)
 v_lshlrev_b32 v80, 16, v36
 v_and_b32 v81, 0xffff0000, v36
 v_lshlrev_b32 v82, 16, v37
 v_and_b32 v83, 0xffff0000, v37
 s_waitcnt vmcnt(7)
 v_lshlrev_b32 v76, 16, v108
 v_and_b32 v77, 0xffff0000, v108
 v_lshlrev_b32 v78, 16, v109
 v_and_b32 v79, 0xffff0000, v109
 s_waitcnt vmcnt(6)
 v_lshlrev_b32 v84, 16, v110
 v_and_b32 v85, 0xffff0000, v110
 v_lshlrev_b32 v86, 16, v111
 v_and_b32 v87, 0xffff0000, v111
 v_pk_add_f32 v[76:77], v[76:77], v[84:85]
 v_pk_add_f32 v[78:79], v[78:79], v[86:87]
 s_waitcnt vmcnt(5)
 v_lshlrev_b32 v84, 16, v112
 v_and_b32 v85, 0xffff0000, v112
 v_lshlrev_b32 v86, 16, v113
 v_and_b32 v87, 0xffff0000, v113
 v_pk_add_f32 v[76:77], v[76:77], v[84:85]
 v_pk_add_f32 v[78:79], v[78:79], v[86:87]
 s_waitcnt vmcnt(4)
 v_lshlrev_b32 v84, 16, v114
 v_and_b32 v85, 0xffff0000, v114
 v_lshlrev_b32 v86, 16, v115
 v_and_b32 v87, 0xffff0000, v115
 v_pk_add_f32 v[76:77], v[76:77], v[84:85]
 v_pk_add_f32 v[78:79], v[78:79], v[86:87]
 s_waitcnt vmcnt(3)
 v_lshlrev_b32 v84, 16, v116
 v_and_b32 v85, 0xffff0000, v116
 v_lshlrev_b32 v86, 16, v117
 v_and_b32 v87, 0xffff0000, v117
 v_pk_add_f32 v[76:77], v[76:77], v[84:85]
 v_pk_add_f32 v[78:79], v[78:79], v[86:87]
 s_waitcnt vmcnt(2)
 v_lshlrev_b32 v84, 16, v118
 v_and_b32 v85, 0xffff0000, v118
 v_lshlrev_b32 v86, 16, v119
 v_and_b32 v87, 0xffff0000, v119
 v_pk_add_f32 v[76:77], v[76:77], v[84:85]
 v_pk_add_f32 v[78:79], v[78:79], v[86:87]
 s_waitcnt vmcnt(1)
 v_lshlrev_b32 v84, 16, v120
 v_and_b32 v85, 0xffff0000, v120
 v_lshlrev_b32 v86, 16, v121
 v_and_b32 v87, 0xffff0000, v121
 v_pk_add_f32 v[76:77], v[76:77], v[84:85]
 v_pk_add_f32 v[78:79], v[78:79], v[86:87]
 s_waitcnt vmcnt(0)
 v_lshlrev_b32 v84, 16, v122
 v_and_b32 v85, 0xffff0000, v122
 v_lshlrev_b32 v86, 16, v123
 v_and_b32 v87, 0xffff0000, v123
 v_pk_add_f32 v[76:77], v[76:77], v[84:85]
 v_pk_add_f32 v[78:79], v[78:79], v[86:87]
 v_pk_add_f32 v[76:77], v[76:77], v[80:81] neg_lo:[0,1] neg_hi:[0,1]
 v_pk_fma_f32 v[76:77], v[76:77], v[28:29], v[80:81] op_sel_hi:[1,0,1]
 v_cvt_pk_bf16_f32 v44, v76, v77
 v_pk_add_f32 v[78:79], v[78:79], v[82:83] neg_lo:[0,1] neg_hi:[0,1]
 v_pk_fma_f32 v[78:79], v[78:79], v[28:29], v[82:83] op_sel_hi:[1,0,1]
 v_cvt_pk_bf16_f32 v45, v78, v79
 buffer_store_dwordx2 v[44:45], v16, s[20:23], s88 offen
 s_add_u32 s88, s88, 65536
 s_add_u32 s86, s86, 2048
 s_add_u32 s76, s76, 128
 s_add_u32 s75, s75, 1
 s_cmp_lt_u32 s75, 64
 s_cbranch_scc1 L_f_mix_147
 s_endpgm
L_role_p_1_abort:
 s_endpgm
.p2align 6
L_role_p_1:
 s_and_b32 s66, s61, 3
 s_lshr_b32 s24, s61, 2
 s_lshl_b32 s67, s60, 2
 s_add_u32 s66, s66, s67
 s_cmp_eq_u32 s24, 0
 s_cselect_b64 s[12:13], s[40:41], s[42:43]
 s_cmp_eq_u32 s24, 2
 s_cselect_b64 s[12:13], s[44:45], s[12:13]
 s_lshl_b32 s67, s66, 8
 s_add_u32 s12, s12, s67
 s_addc_u32 s13, s13, 0
 s_sub_u32 s14, 0x800000, s67
 s_mov_b32 s15, 0x00020000
 s_lshl_b32 s27, s24, 5
 s_add_u32 s27, s27, s66
 s_lshl_b32 s22, s27, 13
 s_add_u32 s22, s22, 0x6200000
 s_lshl_b32 s23, s60, 16
 s_lshl_b32 s68, s62, 12
 s_add_u32 s23, s23, s68
 s_add_u32 s23, s23, 0x6100000
 v_lshrrev_b32 v6, 4, v0
 v_lshlrev_b32 v7, 2, v6
 v_and_b32 v1, 15, v0
 v_xor_b32 v1, v1, v7
 v_lshlrev_b32 v1, 4, v1
 v_mul_u32_u24 v6, 8192, v6
 v_add_u32 v1, v1, v6
 v_bfe_u32 v6, v0, 2, 2
 v_and_b32 v7, 3, v0
 s_lshl_b32 s65, s62, 2
 v_add_u32 v7, s65, v7
 v_and_b32 v2, 3, v6
 v_lshlrev_b32 v2, 2, v2
 v_xor_b32 v7, v7, v2
 v_lshlrev_b32 v7, 4, v7
 v_lshrrev_b32 v2, 4, v0
 v_lshlrev_b32 v2, 3, v2
 v_add_u32 v2, v2, v6
 v_lshlrev_b32 v2, 8, v2
 v_add_u32 v2, v2, v7
 v_add_u32 v3, 1024, v2
 v_add_u32 v4, 0x10000, v2
 v_add_u32 v5, 0x10000, v3
 s_mul_i32 s20, s62, 524288
 s_lshl_b32 s21, s62, 14
 s_add_u32 m0, s21, 0
 s_add_u32 s65, s20, 0
 buffer_load_dwordx4 v1, s[12:15], s65 offen nt lds
 s_add_u32 m0, s21, 1024
 s_add_u32 s65, s20, 32768
 buffer_load_dwordx4 v1, s[12:15], s65 offen nt lds
 s_add_u32 m0, s21, 2048
 s_add_u32 s65, s20, 65536
 buffer_load_dwordx4 v1, s[12:15], s65 offen nt lds
 s_add_u32 m0, s21, 3072
 s_add_u32 s65, s20, 98304
 buffer_load_dwordx4 v1, s[12:15], s65 offen nt lds
 s_add_u32 m0, s21, 4096
 s_add_u32 s65, s20, 131072
 buffer_load_dwordx4 v1, s[12:15], s65 offen nt lds
 s_add_u32 m0, s21, 5120
 s_add_u32 s65, s20, 163840
 buffer_load_dwordx4 v1, s[12:15], s65 offen nt lds
 s_add_u32 m0, s21, 6144
 s_add_u32 s65, s20, 196608
 buffer_load_dwordx4 v1, s[12:15], s65 offen nt lds
 s_add_u32 m0, s21, 7168
 s_add_u32 s65, s20, 229376
 buffer_load_dwordx4 v1, s[12:15], s65 offen nt lds
 s_add_u32 m0, s21, 8192
 s_add_u32 s65, s20, 262144
 buffer_load_dwordx4 v1, s[12:15], s65 offen nt lds
 s_add_u32 m0, s21, 9216
 s_add_u32 s65, s20, 294912
 buffer_load_dwordx4 v1, s[12:15], s65 offen nt lds
 s_add_u32 m0, s21, 10240
 s_add_u32 s65, s20, 327680
 buffer_load_dwordx4 v1, s[12:15], s65 offen nt lds
 s_add_u32 m0, s21, 11264
 s_add_u32 s65, s20, 360448
 buffer_load_dwordx4 v1, s[12:15], s65 offen nt lds
 s_add_u32 m0, s21, 12288
 s_add_u32 s65, s20, 393216
 buffer_load_dwordx4 v1, s[12:15], s65 offen nt lds
 s_add_u32 m0, s21, 13312
 s_add_u32 s65, s20, 425984
 buffer_load_dwordx4 v1, s[12:15], s65 offen nt lds
 s_add_u32 m0, s21, 14336
 s_add_u32 s65, s20, 458752
 buffer_load_dwordx4 v1, s[12:15], s65 offen nt lds
 s_add_u32 m0, s21, 15360
 s_add_u32 s65, s20, 491520
 buffer_load_dwordx4 v1, s[12:15], s65 offen nt lds
 s_add_u32 m0, s21, 65536
 s_add_u32 s65, s20, 2097152
 buffer_load_dwordx4 v1, s[12:15], s65 offen nt lds
 s_add_u32 m0, s21, 66560
 s_add_u32 s65, s20, 2129920
 buffer_load_dwordx4 v1, s[12:15], s65 offen nt lds
 s_add_u32 m0, s21, 67584
 s_add_u32 s65, s20, 2162688
 buffer_load_dwordx4 v1, s[12:15], s65 offen nt lds
 s_add_u32 m0, s21, 68608
 s_add_u32 s65, s20, 2195456
 buffer_load_dwordx4 v1, s[12:15], s65 offen nt lds
 s_add_u32 m0, s21, 69632
 s_add_u32 s65, s20, 2228224
 buffer_load_dwordx4 v1, s[12:15], s65 offen nt lds
 s_add_u32 m0, s21, 70656
 s_add_u32 s65, s20, 2260992
 buffer_load_dwordx4 v1, s[12:15], s65 offen nt lds
 s_add_u32 m0, s21, 71680
 s_add_u32 s65, s20, 2293760
 buffer_load_dwordx4 v1, s[12:15], s65 offen nt lds
 s_add_u32 m0, s21, 72704
 s_add_u32 s65, s20, 2326528
 buffer_load_dwordx4 v1, s[12:15], s65 offen nt lds
 s_add_u32 m0, s21, 73728
 s_add_u32 s65, s20, 2359296
 buffer_load_dwordx4 v1, s[12:15], s65 offen nt lds
 s_add_u32 m0, s21, 74752
 s_add_u32 s65, s20, 2392064
 buffer_load_dwordx4 v1, s[12:15], s65 offen nt lds
 s_add_u32 m0, s21, 75776
 s_add_u32 s65, s20, 2424832
 buffer_load_dwordx4 v1, s[12:15], s65 offen nt lds
 s_add_u32 m0, s21, 76800
 s_add_u32 s65, s20, 2457600
 buffer_load_dwordx4 v1, s[12:15], s65 offen nt lds
 s_add_u32 m0, s21, 77824
 s_add_u32 s65, s20, 2490368
 buffer_load_dwordx4 v1, s[12:15], s65 offen nt lds
 s_add_u32 m0, s21, 78848
 s_add_u32 s65, s20, 2523136
 buffer_load_dwordx4 v1, s[12:15], s65 offen nt lds
 s_add_u32 m0, s21, 79872
 s_add_u32 s65, s20, 2555904
 buffer_load_dwordx4 v1, s[12:15], s65 offen nt lds
 s_add_u32 m0, s21, 80896
 s_add_u32 s65, s20, 2588672
 buffer_load_dwordx4 v1, s[12:15], s65 offen nt lds
 v_lshlrev_b32 v10, 4, v0
 s_cmp_eq_u32 s24, 2
 s_cselect_b64 vcc, -1, 0
 v_and_b32 v6, 15, v0
 v_lshrrev_b32 v7, 5, v0
 v_lshl_add_u32 v6, v7, 4, v6
 v_lshlrev_b32 v6, 4, v6
 v_bfe_u32 v7, v0, 4, 1
 v_lshl_add_u32 v8, v7, 3, v6
 v_lshrrev_b32 v6, 4, v0
 v_lshlrev_b32 v6, 7, v6
 v_and_b32 v7, 7, v0
 v_lshl_add_u32 v6, v7, 4, v6
 v_bfe_u32 v7, v0, 3, 1
 v_lshl_add_u32 v9, v7, 3, v6
 v_cndmask_b32 v8, v9, v8, vcc
 s_lshl_b32 s68, s62, 9
 v_add_u32 v11, s68, v8
 v_cndmask_b32 v7, v7, 0, vcc
 v_lshl_add_u32 v12, v7, 28, v11
 v_mov_b32 v16, -1
 v_mov_b32 v17, -1
 v_mov_b32 v18, -1
 v_mov_b32 v19, -1
 s_add_u32 s68, s62, 0
 s_and_b32 s68, s68, 3
 s_lshl_b32 s69, s68, 12
 s_add_u32 s69, s69, 131072
 v_add_u32 v20, s69, v10
 s_add_u32 s68, s62, 1
 s_and_b32 s68, s68, 3
 s_lshl_b32 s69, s68, 12
 s_add_u32 s69, s69, 131072
 v_add_u32 v21, s69, v10
 s_add_u32 s68, s62, 2
 s_and_b32 s68, s68, 3
 s_lshl_b32 s69, s68, 12
 s_add_u32 s69, s69, 131072
 v_add_u32 v22, s69, v10
 s_add_u32 s68, s62, 3
 s_and_b32 s68, s68, 3
 s_lshl_b32 s69, s68, 12
 s_add_u32 s69, s69, 131072
 v_add_u32 v23, s69, v10
 v_and_b32 v6, 8, v0
 v_cmp_ne_u32 vcc, 0, v6
 v_mov_b32 v24, 0x44444444
 v_mov_b32 v6, 0xeeeeeeee
 s_nop 1
 v_cndmask_b32 v24, v24, v6, vcc
 v_and_b32 v7, 1, v0
 v_lshlrev_b32 v7, 4, v7
 v_mov_b32 v8, 0x3f80
 v_lshlrev_b32 v7, v7, v8
 v_bfe_u32 v6, v0, 3, 1
 v_bfe_u32 v8, v0, 1, 1
 v_lshl_add_u32 v6, v6, 1, v8
 v_bfe_u32 v8, v0, 4, 1
 v_bfe_u32 v9, v0, 2, 1
 v_xor_b32 v8, v8, v9
 v_lshl_add_u32 v6, v8, 2, v6
 v_cmp_eq_u32 vcc, 0, v6
 s_nop 1
 v_cndmask_b32 v28, 0, v7, vcc
 v_cmp_eq_u32 vcc, 1, v6
 s_nop 1
 v_cndmask_b32 v29, 0, v7, vcc
 v_cmp_eq_u32 vcc, 2, v6
 s_nop 1
 v_cndmask_b32 v30, 0, v7, vcc
 v_cmp_eq_u32 vcc, 3, v6
 s_nop 1
 v_cndmask_b32 v31, 0, v7, vcc
 v_mov_b32 v48, 0
 v_mov_b32 v49, 0
 v_mov_b32 v50, 0
 v_mov_b32 v51, 0
 s_lshl_b32 s76, s27, 15
 s_lshl_b32 s68, s62, 10
 s_add_u32 s76, s76, s68
 v_lshrrev_b32 v6, 3, v0
 v_lshrrev_b32 v7, 4, v0
 s_and_b32 s68, s62, 1
 s_lshl_b32 s68, s68, 2
 v_add_u32 v7, s68, v7
 v_and_b32 v8, 7, v0
 v_xor_b32 v7, v7, v8
 v_lshlrev_b32 v7, 4, v7
 s_lshl_b32 s68, s62, 3
 v_add_u32 v6, s68, v6
 v_lshl_add_u32 v55, v6, 11, v7
 v_bfe_u32 v6, v0, 3, 1
 v_lshlrev_b32 v6, 10, v6
 v_and_b32 v7, 7, v0
 v_lshl_add_u32 v6, v7, 7, v6
 v_bfe_u32 v7, v0, 1, 3
 v_lshrrev_b32 v8, 4, v0
 v_xor_b32 v7, v7, v8
 v_lshl_add_u32 v6, v7, 4, v6
 s_add_u32 s68, s62, 0
 s_and_b32 s68, s68, 3
 s_lshl_b32 s69, s68, 14
 v_add_u32 v56, s69, v6
 v_xor_b32 v57, 64, v56
 s_add_u32 s68, s62, 1
 s_and_b32 s68, s68, 3
 s_lshl_b32 s69, s68, 14
 v_add_u32 v58, s69, v6
 v_xor_b32 v59, 64, v58
 s_add_u32 s68, s62, 2
 s_and_b32 s68, s68, 3
 s_lshl_b32 s69, s68, 14
 v_add_u32 v60, s69, v6
 v_xor_b32 v61, 64, v60
 s_add_u32 s68, s62, 3
 s_and_b32 s68, s68, 3
 s_lshl_b32 s69, s68, 14
 v_add_u32 v62, s69, v6
 v_xor_b32 v63, 64, v62
 v_lshrrev_b32 v6, 4, v0
 s_lshr_b32 s65, s61, 3
 v_or_b32 v6, s65, v6
 v_min_u32 v6, 1, v6
 v_lshlrev_b32 v6, 28, v6
 v_lshl_add_u32 v6, v0, 7, v6
 s_lshl_b32 s65, s61, 2
 s_add_u32 s65, s65, s62
 s_lshl_b32 s65, s65, 11
 v_add_u32 v64, s65, v6
 s_cmp_eq_u32 s24, 2
 s_cselect_b32 s65, 0, 1
 v_or_b32 v6, s65, v0
 v_min_u32 v6, 1, v6
 v_lshlrev_b32 v66, 28, v6
 s_and_b32 s83, s27, 31
 s_lshl_b32 s83, s83, 5
 s_add_u32 s83, s83, s62
 s_lshl_b32 s83, s83, 2
 s_add_u32 s83, s83, 0x5010000
 s_or_b32 s65, s61, s62
 v_or_b32 v6, s65, v0
 v_min_u32 v6, 1, v6
 v_lshlrev_b32 v68, 28, v6
 s_xor_b32 s88, s61, 1
 s_or_b32 s88, s88, s62
 v_lshrrev_b32 v6, 3, v0
 v_or_b32 v6, s88, v6
 v_min_u32 v6, 1, v6
 v_lshlrev_b32 v6, 28, v6
 v_lshl_add_u32 v70, v0, 7, v6
 v_mov_b32 v69, 0
 s_mov_b32 s85, 0x6742000
 s_mov_b32 s86, 0x6742000
 s_lshl_b32 s87, s60, 7
 s_add_u32 s87, s87, 0x5001000
 s_or_b32 s65, s62, s101
 s_cbranch_scc1 L_clm_155
 s_waitcnt lgkmcnt(0)
 s_bitcmp1_b32 s3, s61
 s_cbranch_scc0 L_clm_155
 s_mov_b32 s66, 1
 s_atomic_or s66, s[56:57], 36
 s_waitcnt lgkmcnt(0)
L_clm_155:
 s_waitcnt vmcnt(16)
 s_barrier
 s_sub_u32 s68, 4, s62
 s_and_b32 s68, s68, 3
 s_cmp_eq_u32 s68, 0
 s_cbranch_scc0 L_wl_next_157
 ds_read_b64_tr_b16 a[0:1], v2 offset:0
 ds_read_b64_tr_b16 a[2:3], v3 offset:0
 ds_read_b64_tr_b16 a[8:9], v2 offset:8
 ds_read_b64_tr_b16 a[10:11], v3 offset:8
 ds_read_b64_tr_b16 a[4:5], v2 offset:8192
 ds_read_b64_tr_b16 a[6:7], v3 offset:8192
 ds_read_b64_tr_b16 a[12:13], v2 offset:8200
 ds_read_b64_tr_b16 a[14:15], v3 offset:8200
 ds_read_b64_tr_b16 a[16:17], v2 offset:16384
 ds_read_b64_tr_b16 a[18:19], v3 offset:16384
 ds_read_b64_tr_b16 a[24:25], v2 offset:16392
 ds_read_b64_tr_b16 a[26:27], v3 offset:16392
 ds_read_b64_tr_b16 a[20:21], v2 offset:24576
 ds_read_b64_tr_b16 a[22:23], v3 offset:24576
 ds_read_b64_tr_b16 a[28:29], v2 offset:24584
 ds_read_b64_tr_b16 a[30:31], v3 offset:24584
 ds_read_b64_tr_b16 a[32:33], v2 offset:32768
 ds_read_b64_tr_b16 a[34:35], v3 offset:32768
 ds_read_b64_tr_b16 a[40:41], v2 offset:32776
 ds_read_b64_tr_b16 a[42:43], v3 offset:32776
 ds_read_b64_tr_b16 a[36:37], v2 offset:40960
 ds_read_b64_tr_b16 a[38:39], v3 offset:40960
 ds_read_b64_tr_b16 a[44:45], v2 offset:40968
 ds_read_b64_tr_b16 a[46:47], v3 offset:40968
 ds_read_b64_tr_b16 a[48:49], v2 offset:49152
 ds_read_b64_tr_b16 a[50:51], v3 offset:49152
 ds_read_b64_tr_b16 a[56:57], v2 offset:49160
 ds_read_b64_tr_b16 a[58:59], v3 offset:49160
 ds_read_b64_tr_b16 a[52:53], v2 offset:57344
 ds_read_b64_tr_b16 a[54:55], v3 offset:57344
 ds_read_b64_tr_b16 a[60:61], v2 offset:57352
 ds_read_b64_tr_b16 a[62:63], v3 offset:57352
 s_waitcnt lgkmcnt(0)
 s_branch L_wl_done_156
L_wl_next_157:
 s_cmp_eq_u32 s68, 1
 s_cbranch_scc0 L_wl_next_158
 ds_read_b64_tr_b16 a[64:65], v2 offset:0
 ds_read_b64_tr_b16 a[66:67], v3 offset:0
 ds_read_b64_tr_b16 a[72:73], v2 offset:8
 ds_read_b64_tr_b16 a[74:75], v3 offset:8
 ds_read_b64_tr_b16 a[68:69], v2 offset:8192
 ds_read_b64_tr_b16 a[70:71], v3 offset:8192
 ds_read_b64_tr_b16 a[76:77], v2 offset:8200
 ds_read_b64_tr_b16 a[78:79], v3 offset:8200
 ds_read_b64_tr_b16 a[80:81], v2 offset:16384
 ds_read_b64_tr_b16 a[82:83], v3 offset:16384
 ds_read_b64_tr_b16 a[88:89], v2 offset:16392
 ds_read_b64_tr_b16 a[90:91], v3 offset:16392
 ds_read_b64_tr_b16 a[84:85], v2 offset:24576
 ds_read_b64_tr_b16 a[86:87], v3 offset:24576
 ds_read_b64_tr_b16 a[92:93], v2 offset:24584
 ds_read_b64_tr_b16 a[94:95], v3 offset:24584
 ds_read_b64_tr_b16 a[96:97], v2 offset:32768
 ds_read_b64_tr_b16 a[98:99], v3 offset:32768
 ds_read_b64_tr_b16 a[104:105], v2 offset:32776
 ds_read_b64_tr_b16 a[106:107], v3 offset:32776
 ds_read_b64_tr_b16 a[100:101], v2 offset:40960
 ds_read_b64_tr_b16 a[102:103], v3 offset:40960
 ds_read_b64_tr_b16 a[108:109], v2 offset:40968
 ds_read_b64_tr_b16 a[110:111], v3 offset:40968
 ds_read_b64_tr_b16 a[112:113], v2 offset:49152
 ds_read_b64_tr_b16 a[114:115], v3 offset:49152
 ds_read_b64_tr_b16 a[120:121], v2 offset:49160
 ds_read_b64_tr_b16 a[122:123], v3 offset:49160
 ds_read_b64_tr_b16 a[116:117], v2 offset:57344
 ds_read_b64_tr_b16 a[118:119], v3 offset:57344
 ds_read_b64_tr_b16 a[124:125], v2 offset:57352
 ds_read_b64_tr_b16 a[126:127], v3 offset:57352
 s_waitcnt lgkmcnt(0)
 s_branch L_wl_done_156
L_wl_next_158:
 s_cmp_eq_u32 s68, 2
 s_cbranch_scc0 L_wl_next_159
 ds_read_b64_tr_b16 a[128:129], v2 offset:0
 ds_read_b64_tr_b16 a[130:131], v3 offset:0
 ds_read_b64_tr_b16 a[136:137], v2 offset:8
 ds_read_b64_tr_b16 a[138:139], v3 offset:8
 ds_read_b64_tr_b16 a[132:133], v2 offset:8192
 ds_read_b64_tr_b16 a[134:135], v3 offset:8192
 ds_read_b64_tr_b16 a[140:141], v2 offset:8200
 ds_read_b64_tr_b16 a[142:143], v3 offset:8200
 ds_read_b64_tr_b16 a[144:145], v2 offset:16384
 ds_read_b64_tr_b16 a[146:147], v3 offset:16384
 ds_read_b64_tr_b16 a[152:153], v2 offset:16392
 ds_read_b64_tr_b16 a[154:155], v3 offset:16392
 ds_read_b64_tr_b16 a[148:149], v2 offset:24576
 ds_read_b64_tr_b16 a[150:151], v3 offset:24576
 ds_read_b64_tr_b16 a[156:157], v2 offset:24584
 ds_read_b64_tr_b16 a[158:159], v3 offset:24584
 ds_read_b64_tr_b16 a[160:161], v2 offset:32768
 ds_read_b64_tr_b16 a[162:163], v3 offset:32768
 ds_read_b64_tr_b16 a[168:169], v2 offset:32776
 ds_read_b64_tr_b16 a[170:171], v3 offset:32776
 ds_read_b64_tr_b16 a[164:165], v2 offset:40960
 ds_read_b64_tr_b16 a[166:167], v3 offset:40960
 ds_read_b64_tr_b16 a[172:173], v2 offset:40968
 ds_read_b64_tr_b16 a[174:175], v3 offset:40968
 ds_read_b64_tr_b16 a[176:177], v2 offset:49152
 ds_read_b64_tr_b16 a[178:179], v3 offset:49152
 ds_read_b64_tr_b16 a[184:185], v2 offset:49160
 ds_read_b64_tr_b16 a[186:187], v3 offset:49160
 ds_read_b64_tr_b16 a[180:181], v2 offset:57344
 ds_read_b64_tr_b16 a[182:183], v3 offset:57344
 ds_read_b64_tr_b16 a[188:189], v2 offset:57352
 ds_read_b64_tr_b16 a[190:191], v3 offset:57352
 s_waitcnt lgkmcnt(0)
 s_branch L_wl_done_156
L_wl_next_159:
 ds_read_b64_tr_b16 a[192:193], v2 offset:0
 ds_read_b64_tr_b16 a[194:195], v3 offset:0
 ds_read_b64_tr_b16 a[200:201], v2 offset:8
 ds_read_b64_tr_b16 a[202:203], v3 offset:8
 ds_read_b64_tr_b16 a[196:197], v2 offset:8192
 ds_read_b64_tr_b16 a[198:199], v3 offset:8192
 ds_read_b64_tr_b16 a[204:205], v2 offset:8200
 ds_read_b64_tr_b16 a[206:207], v3 offset:8200
 ds_read_b64_tr_b16 a[208:209], v2 offset:16384
 ds_read_b64_tr_b16 a[210:211], v3 offset:16384
 ds_read_b64_tr_b16 a[216:217], v2 offset:16392
 ds_read_b64_tr_b16 a[218:219], v3 offset:16392
 ds_read_b64_tr_b16 a[212:213], v2 offset:24576
 ds_read_b64_tr_b16 a[214:215], v3 offset:24576
 ds_read_b64_tr_b16 a[220:221], v2 offset:24584
 ds_read_b64_tr_b16 a[222:223], v3 offset:24584
 ds_read_b64_tr_b16 a[224:225], v2 offset:32768
 ds_read_b64_tr_b16 a[226:227], v3 offset:32768
 ds_read_b64_tr_b16 a[232:233], v2 offset:32776
 ds_read_b64_tr_b16 a[234:235], v3 offset:32776
 ds_read_b64_tr_b16 a[228:229], v2 offset:40960
 ds_read_b64_tr_b16 a[230:231], v3 offset:40960
 ds_read_b64_tr_b16 a[236:237], v2 offset:40968
 ds_read_b64_tr_b16 a[238:239], v3 offset:40968
 ds_read_b64_tr_b16 a[240:241], v2 offset:49152
 ds_read_b64_tr_b16 a[242:243], v3 offset:49152
 ds_read_b64_tr_b16 a[248:249], v2 offset:49160
 ds_read_b64_tr_b16 a[250:251], v3 offset:49160
 ds_read_b64_tr_b16 a[244:245], v2 offset:57344
 ds_read_b64_tr_b16 a[246:247], v3 offset:57344
 ds_read_b64_tr_b16 a[252:253], v2 offset:57352
 ds_read_b64_tr_b16 a[254:255], v3 offset:57352
 s_waitcnt lgkmcnt(0)
L_wl_done_156:
 s_barrier
 s_add_u32 m0, s21, 0
 s_add_u32 s65, s20, 4194304
 buffer_load_dwordx4 v1, s[12:15], s65 offen nt lds
 s_add_u32 m0, s21, 1024
 s_add_u32 s65, s20, 4227072
 buffer_load_dwordx4 v1, s[12:15], s65 offen nt lds
 s_add_u32 m0, s21, 2048
 s_add_u32 s65, s20, 4259840
 buffer_load_dwordx4 v1, s[12:15], s65 offen nt lds
 s_add_u32 m0, s21, 3072
 s_add_u32 s65, s20, 4292608
 buffer_load_dwordx4 v1, s[12:15], s65 offen nt lds
 s_add_u32 m0, s21, 4096
 s_add_u32 s65, s20, 4325376
 buffer_load_dwordx4 v1, s[12:15], s65 offen nt lds
 s_add_u32 m0, s21, 5120
 s_add_u32 s65, s20, 4358144
 buffer_load_dwordx4 v1, s[12:15], s65 offen nt lds
 s_add_u32 m0, s21, 6144
 s_add_u32 s65, s20, 4390912
 buffer_load_dwordx4 v1, s[12:15], s65 offen nt lds
 s_add_u32 m0, s21, 7168
 s_add_u32 s65, s20, 4423680
 buffer_load_dwordx4 v1, s[12:15], s65 offen nt lds
 s_add_u32 m0, s21, 8192
 s_add_u32 s65, s20, 4456448
 buffer_load_dwordx4 v1, s[12:15], s65 offen nt lds
 s_add_u32 m0, s21, 9216
 s_add_u32 s65, s20, 4489216
 buffer_load_dwordx4 v1, s[12:15], s65 offen nt lds
 s_add_u32 m0, s21, 10240
 s_add_u32 s65, s20, 4521984
 buffer_load_dwordx4 v1, s[12:15], s65 offen nt lds
 s_add_u32 m0, s21, 11264
 s_add_u32 s65, s20, 4554752
 buffer_load_dwordx4 v1, s[12:15], s65 offen nt lds
 s_add_u32 m0, s21, 12288
 s_add_u32 s65, s20, 4587520
 buffer_load_dwordx4 v1, s[12:15], s65 offen nt lds
 s_add_u32 m0, s21, 13312
 s_add_u32 s65, s20, 4620288
 buffer_load_dwordx4 v1, s[12:15], s65 offen nt lds
 s_add_u32 m0, s21, 14336
 s_add_u32 s65, s20, 4653056
 buffer_load_dwordx4 v1, s[12:15], s65 offen nt lds
 s_add_u32 m0, s21, 15360
 s_add_u32 s65, s20, 4685824
 buffer_load_dwordx4 v1, s[12:15], s65 offen nt lds
 s_waitcnt vmcnt(16)
 s_barrier
 s_sub_u32 s68, 5, s62
 s_and_b32 s68, s68, 3
 s_cmp_eq_u32 s68, 0
 s_cbranch_scc0 L_wl_next_162
 ds_read_b64_tr_b16 a[0:1], v4 offset:0
 ds_read_b64_tr_b16 a[2:3], v5 offset:0
 ds_read_b64_tr_b16 a[8:9], v4 offset:8
 ds_read_b64_tr_b16 a[10:11], v5 offset:8
 ds_read_b64_tr_b16 a[4:5], v4 offset:8192
 ds_read_b64_tr_b16 a[6:7], v5 offset:8192
 ds_read_b64_tr_b16 a[12:13], v4 offset:8200
 ds_read_b64_tr_b16 a[14:15], v5 offset:8200
 ds_read_b64_tr_b16 a[16:17], v4 offset:16384
 ds_read_b64_tr_b16 a[18:19], v5 offset:16384
 ds_read_b64_tr_b16 a[24:25], v4 offset:16392
 ds_read_b64_tr_b16 a[26:27], v5 offset:16392
 ds_read_b64_tr_b16 a[20:21], v4 offset:24576
 ds_read_b64_tr_b16 a[22:23], v5 offset:24576
 ds_read_b64_tr_b16 a[28:29], v4 offset:24584
 ds_read_b64_tr_b16 a[30:31], v5 offset:24584
 ds_read_b64_tr_b16 a[32:33], v4 offset:32768
 ds_read_b64_tr_b16 a[34:35], v5 offset:32768
 ds_read_b64_tr_b16 a[40:41], v4 offset:32776
 ds_read_b64_tr_b16 a[42:43], v5 offset:32776
 ds_read_b64_tr_b16 a[36:37], v4 offset:40960
 ds_read_b64_tr_b16 a[38:39], v5 offset:40960
 ds_read_b64_tr_b16 a[44:45], v4 offset:40968
 ds_read_b64_tr_b16 a[46:47], v5 offset:40968
 ds_read_b64_tr_b16 a[48:49], v4 offset:49152
 ds_read_b64_tr_b16 a[50:51], v5 offset:49152
 ds_read_b64_tr_b16 a[56:57], v4 offset:49160
 ds_read_b64_tr_b16 a[58:59], v5 offset:49160
 ds_read_b64_tr_b16 a[52:53], v4 offset:57344
 ds_read_b64_tr_b16 a[54:55], v5 offset:57344
 ds_read_b64_tr_b16 a[60:61], v4 offset:57352
 ds_read_b64_tr_b16 a[62:63], v5 offset:57352
 s_waitcnt lgkmcnt(0)
 s_branch L_wl_done_161
L_wl_next_162:
 s_cmp_eq_u32 s68, 1
 s_cbranch_scc0 L_wl_next_163
 ds_read_b64_tr_b16 a[64:65], v4 offset:0
 ds_read_b64_tr_b16 a[66:67], v5 offset:0
 ds_read_b64_tr_b16 a[72:73], v4 offset:8
 ds_read_b64_tr_b16 a[74:75], v5 offset:8
 ds_read_b64_tr_b16 a[68:69], v4 offset:8192
 ds_read_b64_tr_b16 a[70:71], v5 offset:8192
 ds_read_b64_tr_b16 a[76:77], v4 offset:8200
 ds_read_b64_tr_b16 a[78:79], v5 offset:8200
 ds_read_b64_tr_b16 a[80:81], v4 offset:16384
 ds_read_b64_tr_b16 a[82:83], v5 offset:16384
 ds_read_b64_tr_b16 a[88:89], v4 offset:16392
 ds_read_b64_tr_b16 a[90:91], v5 offset:16392
 ds_read_b64_tr_b16 a[84:85], v4 offset:24576
 ds_read_b64_tr_b16 a[86:87], v5 offset:24576
 ds_read_b64_tr_b16 a[92:93], v4 offset:24584
 ds_read_b64_tr_b16 a[94:95], v5 offset:24584
 ds_read_b64_tr_b16 a[96:97], v4 offset:32768
 ds_read_b64_tr_b16 a[98:99], v5 offset:32768
 ds_read_b64_tr_b16 a[104:105], v4 offset:32776
 ds_read_b64_tr_b16 a[106:107], v5 offset:32776
 ds_read_b64_tr_b16 a[100:101], v4 offset:40960
 ds_read_b64_tr_b16 a[102:103], v5 offset:40960
 ds_read_b64_tr_b16 a[108:109], v4 offset:40968
 ds_read_b64_tr_b16 a[110:111], v5 offset:40968
 ds_read_b64_tr_b16 a[112:113], v4 offset:49152
 ds_read_b64_tr_b16 a[114:115], v5 offset:49152
 ds_read_b64_tr_b16 a[120:121], v4 offset:49160
 ds_read_b64_tr_b16 a[122:123], v5 offset:49160
 ds_read_b64_tr_b16 a[116:117], v4 offset:57344
 ds_read_b64_tr_b16 a[118:119], v5 offset:57344
 ds_read_b64_tr_b16 a[124:125], v4 offset:57352
 ds_read_b64_tr_b16 a[126:127], v5 offset:57352
 s_waitcnt lgkmcnt(0)
 s_branch L_wl_done_161
L_wl_next_163:
 s_cmp_eq_u32 s68, 2
 s_cbranch_scc0 L_wl_next_164
 ds_read_b64_tr_b16 a[128:129], v4 offset:0
 ds_read_b64_tr_b16 a[130:131], v5 offset:0
 ds_read_b64_tr_b16 a[136:137], v4 offset:8
 ds_read_b64_tr_b16 a[138:139], v5 offset:8
 ds_read_b64_tr_b16 a[132:133], v4 offset:8192
 ds_read_b64_tr_b16 a[134:135], v5 offset:8192
 ds_read_b64_tr_b16 a[140:141], v4 offset:8200
 ds_read_b64_tr_b16 a[142:143], v5 offset:8200
 ds_read_b64_tr_b16 a[144:145], v4 offset:16384
 ds_read_b64_tr_b16 a[146:147], v5 offset:16384
 ds_read_b64_tr_b16 a[152:153], v4 offset:16392
 ds_read_b64_tr_b16 a[154:155], v5 offset:16392
 ds_read_b64_tr_b16 a[148:149], v4 offset:24576
 ds_read_b64_tr_b16 a[150:151], v5 offset:24576
 ds_read_b64_tr_b16 a[156:157], v4 offset:24584
 ds_read_b64_tr_b16 a[158:159], v5 offset:24584
 ds_read_b64_tr_b16 a[160:161], v4 offset:32768
 ds_read_b64_tr_b16 a[162:163], v5 offset:32768
 ds_read_b64_tr_b16 a[168:169], v4 offset:32776
 ds_read_b64_tr_b16 a[170:171], v5 offset:32776
 ds_read_b64_tr_b16 a[164:165], v4 offset:40960
 ds_read_b64_tr_b16 a[166:167], v5 offset:40960
 ds_read_b64_tr_b16 a[172:173], v4 offset:40968
 ds_read_b64_tr_b16 a[174:175], v5 offset:40968
 ds_read_b64_tr_b16 a[176:177], v4 offset:49152
 ds_read_b64_tr_b16 a[178:179], v5 offset:49152
 ds_read_b64_tr_b16 a[184:185], v4 offset:49160
 ds_read_b64_tr_b16 a[186:187], v5 offset:49160
 ds_read_b64_tr_b16 a[180:181], v4 offset:57344
 ds_read_b64_tr_b16 a[182:183], v5 offset:57344
 ds_read_b64_tr_b16 a[188:189], v4 offset:57352
 ds_read_b64_tr_b16 a[190:191], v5 offset:57352
 s_waitcnt lgkmcnt(0)
 s_branch L_wl_done_161
L_wl_next_164:
 ds_read_b64_tr_b16 a[192:193], v4 offset:0
 ds_read_b64_tr_b16 a[194:195], v5 offset:0
 ds_read_b64_tr_b16 a[200:201], v4 offset:8
 ds_read_b64_tr_b16 a[202:203], v5 offset:8
 ds_read_b64_tr_b16 a[196:197], v4 offset:8192
 ds_read_b64_tr_b16 a[198:199], v5 offset:8192
 ds_read_b64_tr_b16 a[204:205], v4 offset:8200
 ds_read_b64_tr_b16 a[206:207], v5 offset:8200
 ds_read_b64_tr_b16 a[208:209], v4 offset:16384
 ds_read_b64_tr_b16 a[210:211], v5 offset:16384
 ds_read_b64_tr_b16 a[216:217], v4 offset:16392
 ds_read_b64_tr_b16 a[218:219], v5 offset:16392
 ds_read_b64_tr_b16 a[212:213], v4 offset:24576
 ds_read_b64_tr_b16 a[214:215], v5 offset:24576
 ds_read_b64_tr_b16 a[220:221], v4 offset:24584
 ds_read_b64_tr_b16 a[222:223], v5 offset:24584
 ds_read_b64_tr_b16 a[224:225], v4 offset:32768
 ds_read_b64_tr_b16 a[226:227], v5 offset:32768
 ds_read_b64_tr_b16 a[232:233], v4 offset:32776
 ds_read_b64_tr_b16 a[234:235], v5 offset:32776
 ds_read_b64_tr_b16 a[228:229], v4 offset:40960
 ds_read_b64_tr_b16 a[230:231], v5 offset:40960
 ds_read_b64_tr_b16 a[236:237], v4 offset:40968
 ds_read_b64_tr_b16 a[238:239], v5 offset:40968
 ds_read_b64_tr_b16 a[240:241], v4 offset:49152
 ds_read_b64_tr_b16 a[242:243], v5 offset:49152
 ds_read_b64_tr_b16 a[248:249], v4 offset:49160
 ds_read_b64_tr_b16 a[250:251], v5 offset:49160
 ds_read_b64_tr_b16 a[244:245], v4 offset:57344
 ds_read_b64_tr_b16 a[246:247], v5 offset:57344
 ds_read_b64_tr_b16 a[252:253], v4 offset:57352
 ds_read_b64_tr_b16 a[254:255], v5 offset:57352
 s_waitcnt lgkmcnt(0)
L_wl_done_161:
 s_barrier
 s_add_u32 m0, s21, 65536
 s_add_u32 s65, s20, 6291456
 buffer_load_dwordx4 v1, s[12:15], s65 offen nt lds
 s_add_u32 m0, s21, 66560
 s_add_u32 s65, s20, 6324224
 buffer_load_dwordx4 v1, s[12:15], s65 offen nt lds
 s_add_u32 m0, s21, 67584
 s_add_u32 s65, s20, 6356992
 buffer_load_dwordx4 v1, s[12:15], s65 offen nt lds
 s_add_u32 m0, s21, 68608
 s_add_u32 s65, s20, 6389760
 buffer_load_dwordx4 v1, s[12:15], s65 offen nt lds
 s_add_u32 m0, s21, 69632
 s_add_u32 s65, s20, 6422528
 buffer_load_dwordx4 v1, s[12:15], s65 offen nt lds
 s_add_u32 m0, s21, 70656
 s_add_u32 s65, s20, 6455296
 buffer_load_dwordx4 v1, s[12:15], s65 offen nt lds
 s_add_u32 m0, s21, 71680
 s_add_u32 s65, s20, 6488064
 buffer_load_dwordx4 v1, s[12:15], s65 offen nt lds
 s_add_u32 m0, s21, 72704
 s_add_u32 s65, s20, 6520832
 buffer_load_dwordx4 v1, s[12:15], s65 offen nt lds
 s_add_u32 m0, s21, 73728
 s_add_u32 s65, s20, 6553600
 buffer_load_dwordx4 v1, s[12:15], s65 offen nt lds
 s_add_u32 m0, s21, 74752
 s_add_u32 s65, s20, 6586368
 buffer_load_dwordx4 v1, s[12:15], s65 offen nt lds
 s_add_u32 m0, s21, 75776
 s_add_u32 s65, s20, 6619136
 buffer_load_dwordx4 v1, s[12:15], s65 offen nt lds
 s_add_u32 m0, s21, 76800
 s_add_u32 s65, s20, 6651904
 buffer_load_dwordx4 v1, s[12:15], s65 offen nt lds
 s_add_u32 m0, s21, 77824
 s_add_u32 s65, s20, 6684672
 buffer_load_dwordx4 v1, s[12:15], s65 offen nt lds
 s_add_u32 m0, s21, 78848
 s_add_u32 s65, s20, 6717440
 buffer_load_dwordx4 v1, s[12:15], s65 offen nt lds
 s_add_u32 m0, s21, 79872
 s_add_u32 s65, s20, 6750208
 buffer_load_dwordx4 v1, s[12:15], s65 offen nt lds
 s_add_u32 m0, s21, 80896
 s_add_u32 s65, s20, 6782976
 buffer_load_dwordx4 v1, s[12:15], s65 offen nt lds
 s_waitcnt vmcnt(16)
 s_barrier
 s_sub_u32 s68, 6, s62
 s_and_b32 s68, s68, 3
 s_cmp_eq_u32 s68, 0
 s_cbranch_scc0 L_wl_next_167
 ds_read_b64_tr_b16 a[0:1], v2 offset:0
 ds_read_b64_tr_b16 a[2:3], v3 offset:0
 ds_read_b64_tr_b16 a[8:9], v2 offset:8
 ds_read_b64_tr_b16 a[10:11], v3 offset:8
 ds_read_b64_tr_b16 a[4:5], v2 offset:8192
 ds_read_b64_tr_b16 a[6:7], v3 offset:8192
 ds_read_b64_tr_b16 a[12:13], v2 offset:8200
 ds_read_b64_tr_b16 a[14:15], v3 offset:8200
 ds_read_b64_tr_b16 a[16:17], v2 offset:16384
 ds_read_b64_tr_b16 a[18:19], v3 offset:16384
 ds_read_b64_tr_b16 a[24:25], v2 offset:16392
 ds_read_b64_tr_b16 a[26:27], v3 offset:16392
 ds_read_b64_tr_b16 a[20:21], v2 offset:24576
 ds_read_b64_tr_b16 a[22:23], v3 offset:24576
 ds_read_b64_tr_b16 a[28:29], v2 offset:24584
 ds_read_b64_tr_b16 a[30:31], v3 offset:24584
 ds_read_b64_tr_b16 a[32:33], v2 offset:32768
 ds_read_b64_tr_b16 a[34:35], v3 offset:32768
 ds_read_b64_tr_b16 a[40:41], v2 offset:32776
 ds_read_b64_tr_b16 a[42:43], v3 offset:32776
 ds_read_b64_tr_b16 a[36:37], v2 offset:40960
 ds_read_b64_tr_b16 a[38:39], v3 offset:40960
 ds_read_b64_tr_b16 a[44:45], v2 offset:40968
 ds_read_b64_tr_b16 a[46:47], v3 offset:40968
 ds_read_b64_tr_b16 a[48:49], v2 offset:49152
 ds_read_b64_tr_b16 a[50:51], v3 offset:49152
 ds_read_b64_tr_b16 a[56:57], v2 offset:49160
 ds_read_b64_tr_b16 a[58:59], v3 offset:49160
 ds_read_b64_tr_b16 a[52:53], v2 offset:57344
 ds_read_b64_tr_b16 a[54:55], v3 offset:57344
 ds_read_b64_tr_b16 a[60:61], v2 offset:57352
 ds_read_b64_tr_b16 a[62:63], v3 offset:57352
 s_waitcnt lgkmcnt(0)
 s_branch L_wl_done_166
L_wl_next_167:
 s_cmp_eq_u32 s68, 1
 s_cbranch_scc0 L_wl_next_168
 ds_read_b64_tr_b16 a[64:65], v2 offset:0
 ds_read_b64_tr_b16 a[66:67], v3 offset:0
 ds_read_b64_tr_b16 a[72:73], v2 offset:8
 ds_read_b64_tr_b16 a[74:75], v3 offset:8
 ds_read_b64_tr_b16 a[68:69], v2 offset:8192
 ds_read_b64_tr_b16 a[70:71], v3 offset:8192
 ds_read_b64_tr_b16 a[76:77], v2 offset:8200
 ds_read_b64_tr_b16 a[78:79], v3 offset:8200
 ds_read_b64_tr_b16 a[80:81], v2 offset:16384
 ds_read_b64_tr_b16 a[82:83], v3 offset:16384
 ds_read_b64_tr_b16 a[88:89], v2 offset:16392
 ds_read_b64_tr_b16 a[90:91], v3 offset:16392
 ds_read_b64_tr_b16 a[84:85], v2 offset:24576
 ds_read_b64_tr_b16 a[86:87], v3 offset:24576
 ds_read_b64_tr_b16 a[92:93], v2 offset:24584
 ds_read_b64_tr_b16 a[94:95], v3 offset:24584
 ds_read_b64_tr_b16 a[96:97], v2 offset:32768
 ds_read_b64_tr_b16 a[98:99], v3 offset:32768
 ds_read_b64_tr_b16 a[104:105], v2 offset:32776
 ds_read_b64_tr_b16 a[106:107], v3 offset:32776
 ds_read_b64_tr_b16 a[100:101], v2 offset:40960
 ds_read_b64_tr_b16 a[102:103], v3 offset:40960
 ds_read_b64_tr_b16 a[108:109], v2 offset:40968
 ds_read_b64_tr_b16 a[110:111], v3 offset:40968
 ds_read_b64_tr_b16 a[112:113], v2 offset:49152
 ds_read_b64_tr_b16 a[114:115], v3 offset:49152
 ds_read_b64_tr_b16 a[120:121], v2 offset:49160
 ds_read_b64_tr_b16 a[122:123], v3 offset:49160
 ds_read_b64_tr_b16 a[116:117], v2 offset:57344
 ds_read_b64_tr_b16 a[118:119], v3 offset:57344
 ds_read_b64_tr_b16 a[124:125], v2 offset:57352
 ds_read_b64_tr_b16 a[126:127], v3 offset:57352
 s_waitcnt lgkmcnt(0)
 s_branch L_wl_done_166
L_wl_next_168:
 s_cmp_eq_u32 s68, 2
 s_cbranch_scc0 L_wl_next_169
 ds_read_b64_tr_b16 a[128:129], v2 offset:0
 ds_read_b64_tr_b16 a[130:131], v3 offset:0
 ds_read_b64_tr_b16 a[136:137], v2 offset:8
 ds_read_b64_tr_b16 a[138:139], v3 offset:8
 ds_read_b64_tr_b16 a[132:133], v2 offset:8192
 ds_read_b64_tr_b16 a[134:135], v3 offset:8192
 ds_read_b64_tr_b16 a[140:141], v2 offset:8200
 ds_read_b64_tr_b16 a[142:143], v3 offset:8200
 ds_read_b64_tr_b16 a[144:145], v2 offset:16384
 ds_read_b64_tr_b16 a[146:147], v3 offset:16384
 ds_read_b64_tr_b16 a[152:153], v2 offset:16392
 ds_read_b64_tr_b16 a[154:155], v3 offset:16392
 ds_read_b64_tr_b16 a[148:149], v2 offset:24576
 ds_read_b64_tr_b16 a[150:151], v3 offset:24576
 ds_read_b64_tr_b16 a[156:157], v2 offset:24584
 ds_read_b64_tr_b16 a[158:159], v3 offset:24584
 ds_read_b64_tr_b16 a[160:161], v2 offset:32768
 ds_read_b64_tr_b16 a[162:163], v3 offset:32768
 ds_read_b64_tr_b16 a[168:169], v2 offset:32776
 ds_read_b64_tr_b16 a[170:171], v3 offset:32776
 ds_read_b64_tr_b16 a[164:165], v2 offset:40960
 ds_read_b64_tr_b16 a[166:167], v3 offset:40960
 ds_read_b64_tr_b16 a[172:173], v2 offset:40968
 ds_read_b64_tr_b16 a[174:175], v3 offset:40968
 ds_read_b64_tr_b16 a[176:177], v2 offset:49152
 ds_read_b64_tr_b16 a[178:179], v3 offset:49152
 ds_read_b64_tr_b16 a[184:185], v2 offset:49160
 ds_read_b64_tr_b16 a[186:187], v3 offset:49160
 ds_read_b64_tr_b16 a[180:181], v2 offset:57344
 ds_read_b64_tr_b16 a[182:183], v3 offset:57344
 ds_read_b64_tr_b16 a[188:189], v2 offset:57352
 ds_read_b64_tr_b16 a[190:191], v3 offset:57352
 s_waitcnt lgkmcnt(0)
 s_branch L_wl_done_166
L_wl_next_169:
 ds_read_b64_tr_b16 a[192:193], v2 offset:0
 ds_read_b64_tr_b16 a[194:195], v3 offset:0
 ds_read_b64_tr_b16 a[200:201], v2 offset:8
 ds_read_b64_tr_b16 a[202:203], v3 offset:8
 ds_read_b64_tr_b16 a[196:197], v2 offset:8192
 ds_read_b64_tr_b16 a[198:199], v3 offset:8192
 ds_read_b64_tr_b16 a[204:205], v2 offset:8200
 ds_read_b64_tr_b16 a[206:207], v3 offset:8200
 ds_read_b64_tr_b16 a[208:209], v2 offset:16384
 ds_read_b64_tr_b16 a[210:211], v3 offset:16384
 ds_read_b64_tr_b16 a[216:217], v2 offset:16392
 ds_read_b64_tr_b16 a[218:219], v3 offset:16392
 ds_read_b64_tr_b16 a[212:213], v2 offset:24576
 ds_read_b64_tr_b16 a[214:215], v3 offset:24576
 ds_read_b64_tr_b16 a[220:221], v2 offset:24584
 ds_read_b64_tr_b16 a[222:223], v3 offset:24584
 ds_read_b64_tr_b16 a[224:225], v2 offset:32768
 ds_read_b64_tr_b16 a[226:227], v3 offset:32768
 ds_read_b64_tr_b16 a[232:233], v2 offset:32776
 ds_read_b64_tr_b16 a[234:235], v3 offset:32776
 ds_read_b64_tr_b16 a[228:229], v2 offset:40960
 ds_read_b64_tr_b16 a[230:231], v3 offset:40960
 ds_read_b64_tr_b16 a[236:237], v2 offset:40968
 ds_read_b64_tr_b16 a[238:239], v3 offset:40968
 ds_read_b64_tr_b16 a[240:241], v2 offset:49152
 ds_read_b64_tr_b16 a[242:243], v3 offset:49152
 ds_read_b64_tr_b16 a[248:249], v2 offset:49160
 ds_read_b64_tr_b16 a[250:251], v3 offset:49160
 ds_read_b64_tr_b16 a[244:245], v2 offset:57344
 ds_read_b64_tr_b16 a[246:247], v3 offset:57344
 ds_read_b64_tr_b16 a[252:253], v2 offset:57352
 ds_read_b64_tr_b16 a[254:255], v3 offset:57352
 s_waitcnt lgkmcnt(0)
L_wl_done_166:
 s_barrier
 s_lshl_b32 s80, s62, 10
 s_mov_b32 s81, 0
 s_add_u32 m0, s80, 0
 s_nop 0
 buffer_load_dwordx4 v55, s[8:11], s81 offen offset:0 lds
 s_add_u32 m0, s80, 3968
 s_nop 0
 buffer_load_dwordx4 v55, s[8:11], s81 offen offset:128 lds
 s_add_u32 m0, s80, 7936
 s_nop 0
 buffer_load_dwordx4 v55, s[8:11], s81 offen offset:256 lds
 s_add_u32 m0, s80, 11904
 s_nop 0
 buffer_load_dwordx4 v55, s[8:11], s81 offen offset:384 lds
 s_add_u32 m0, s80, 15872
 s_nop 0
 buffer_load_dwordx4 v55, s[8:11], s81 offen offset:512 lds
 s_add_u32 m0, s80, 19840
 s_nop 0
 buffer_load_dwordx4 v55, s[8:11], s81 offen offset:640 lds
 s_add_u32 m0, s80, 23808
 s_nop 0
 buffer_load_dwordx4 v55, s[8:11], s81 offen offset:768 lds
 s_add_u32 m0, s80, 27776
 s_nop 0
 buffer_load_dwordx4 v55, s[8:11], s81 offen offset:896 lds
 s_add_u32 m0, s80, 31744
 s_nop 0
 buffer_load_dwordx4 v55, s[8:11], s81 offen offset:1024 lds
 s_add_u32 m0, s80, 35712
 s_nop 0
 buffer_load_dwordx4 v55, s[8:11], s81 offen offset:1152 lds
 s_add_u32 m0, s80, 39680
 s_nop 0
 buffer_load_dwordx4 v55, s[8:11], s81 offen offset:1280 lds
 s_add_u32 m0, s80, 43648
 s_nop 0
 buffer_load_dwordx4 v55, s[8:11], s81 offen offset:1408 lds
 s_add_u32 m0, s80, 47616
 s_nop 0
 buffer_load_dwordx4 v55, s[8:11], s81 offen offset:1536 lds
 s_add_u32 m0, s80, 51584
 s_nop 0
 buffer_load_dwordx4 v55, s[8:11], s81 offen offset:1664 lds
 s_add_u32 m0, s80, 55552
 s_nop 0
 buffer_load_dwordx4 v55, s[8:11], s81 offen offset:1792 lds
 s_add_u32 m0, s80, 59520
 s_nop 0
 buffer_load_dwordx4 v55, s[8:11], s81 offen offset:1920 lds
 s_waitcnt vmcnt(16)
 s_barrier
 s_sub_u32 s68, 7, s62
 s_and_b32 s68, s68, 3
 s_cmp_eq_u32 s68, 0
 s_cbranch_scc0 L_wl_next_172
 ds_read_b64_tr_b16 a[0:1], v4 offset:0
 ds_read_b64_tr_b16 a[2:3], v5 offset:0
 ds_read_b64_tr_b16 a[8:9], v4 offset:8
 ds_read_b64_tr_b16 a[10:11], v5 offset:8
 ds_read_b64_tr_b16 a[4:5], v4 offset:8192
 ds_read_b64_tr_b16 a[6:7], v5 offset:8192
 ds_read_b64_tr_b16 a[12:13], v4 offset:8200
 ds_read_b64_tr_b16 a[14:15], v5 offset:8200
 ds_read_b64_tr_b16 a[16:17], v4 offset:16384
 ds_read_b64_tr_b16 a[18:19], v5 offset:16384
 ds_read_b64_tr_b16 a[24:25], v4 offset:16392
 ds_read_b64_tr_b16 a[26:27], v5 offset:16392
 ds_read_b64_tr_b16 a[20:21], v4 offset:24576
 ds_read_b64_tr_b16 a[22:23], v5 offset:24576
 ds_read_b64_tr_b16 a[28:29], v4 offset:24584
 ds_read_b64_tr_b16 a[30:31], v5 offset:24584
 ds_read_b64_tr_b16 a[32:33], v4 offset:32768
 ds_read_b64_tr_b16 a[34:35], v5 offset:32768
 ds_read_b64_tr_b16 a[40:41], v4 offset:32776
 ds_read_b64_tr_b16 a[42:43], v5 offset:32776
 ds_read_b64_tr_b16 a[36:37], v4 offset:40960
 ds_read_b64_tr_b16 a[38:39], v5 offset:40960
 ds_read_b64_tr_b16 a[44:45], v4 offset:40968
 ds_read_b64_tr_b16 a[46:47], v5 offset:40968
 ds_read_b64_tr_b16 a[48:49], v4 offset:49152
 ds_read_b64_tr_b16 a[50:51], v5 offset:49152
 ds_read_b64_tr_b16 a[56:57], v4 offset:49160
 ds_read_b64_tr_b16 a[58:59], v5 offset:49160
 ds_read_b64_tr_b16 a[52:53], v4 offset:57344
 ds_read_b64_tr_b16 a[54:55], v5 offset:57344
 ds_read_b64_tr_b16 a[60:61], v4 offset:57352
 ds_read_b64_tr_b16 a[62:63], v5 offset:57352
 s_waitcnt lgkmcnt(0)
 s_branch L_wl_done_171
L_wl_next_172:
 s_cmp_eq_u32 s68, 1
 s_cbranch_scc0 L_wl_next_173
 ds_read_b64_tr_b16 a[64:65], v4 offset:0
 ds_read_b64_tr_b16 a[66:67], v5 offset:0
 ds_read_b64_tr_b16 a[72:73], v4 offset:8
 ds_read_b64_tr_b16 a[74:75], v5 offset:8
 ds_read_b64_tr_b16 a[68:69], v4 offset:8192
 ds_read_b64_tr_b16 a[70:71], v5 offset:8192
 ds_read_b64_tr_b16 a[76:77], v4 offset:8200
 ds_read_b64_tr_b16 a[78:79], v5 offset:8200
 ds_read_b64_tr_b16 a[80:81], v4 offset:16384
 ds_read_b64_tr_b16 a[82:83], v5 offset:16384
 ds_read_b64_tr_b16 a[88:89], v4 offset:16392
 ds_read_b64_tr_b16 a[90:91], v5 offset:16392
 ds_read_b64_tr_b16 a[84:85], v4 offset:24576
 ds_read_b64_tr_b16 a[86:87], v5 offset:24576
 ds_read_b64_tr_b16 a[92:93], v4 offset:24584
 ds_read_b64_tr_b16 a[94:95], v5 offset:24584
 ds_read_b64_tr_b16 a[96:97], v4 offset:32768
 ds_read_b64_tr_b16 a[98:99], v5 offset:32768
 ds_read_b64_tr_b16 a[104:105], v4 offset:32776
 ds_read_b64_tr_b16 a[106:107], v5 offset:32776
 ds_read_b64_tr_b16 a[100:101], v4 offset:40960
 ds_read_b64_tr_b16 a[102:103], v5 offset:40960
 ds_read_b64_tr_b16 a[108:109], v4 offset:40968
 ds_read_b64_tr_b16 a[110:111], v5 offset:40968
 ds_read_b64_tr_b16 a[112:113], v4 offset:49152
 ds_read_b64_tr_b16 a[114:115], v5 offset:49152
 ds_read_b64_tr_b16 a[120:121], v4 offset:49160
 ds_read_b64_tr_b16 a[122:123], v5 offset:49160
 ds_read_b64_tr_b16 a[116:117], v4 offset:57344
 ds_read_b64_tr_b16 a[118:119], v5 offset:57344
 ds_read_b64_tr_b16 a[124:125], v4 offset:57352
 ds_read_b64_tr_b16 a[126:127], v5 offset:57352
 s_waitcnt lgkmcnt(0)
 s_branch L_wl_done_171
L_wl_next_173:
 s_cmp_eq_u32 s68, 2
 s_cbranch_scc0 L_wl_next_174
 ds_read_b64_tr_b16 a[128:129], v4 offset:0
 ds_read_b64_tr_b16 a[130:131], v5 offset:0
 ds_read_b64_tr_b16 a[136:137], v4 offset:8
 ds_read_b64_tr_b16 a[138:139], v5 offset:8
 ds_read_b64_tr_b16 a[132:133], v4 offset:8192
 ds_read_b64_tr_b16 a[134:135], v5 offset:8192
 ds_read_b64_tr_b16 a[140:141], v4 offset:8200
 ds_read_b64_tr_b16 a[142:143], v5 offset:8200
 ds_read_b64_tr_b16 a[144:145], v4 offset:16384
 ds_read_b64_tr_b16 a[146:147], v5 offset:16384
 ds_read_b64_tr_b16 a[152:153], v4 offset:16392
 ds_read_b64_tr_b16 a[154:155], v5 offset:16392
 ds_read_b64_tr_b16 a[148:149], v4 offset:24576
 ds_read_b64_tr_b16 a[150:151], v5 offset:24576
 ds_read_b64_tr_b16 a[156:157], v4 offset:24584
 ds_read_b64_tr_b16 a[158:159], v5 offset:24584
 ds_read_b64_tr_b16 a[160:161], v4 offset:32768
 ds_read_b64_tr_b16 a[162:163], v5 offset:32768
 ds_read_b64_tr_b16 a[168:169], v4 offset:32776
 ds_read_b64_tr_b16 a[170:171], v5 offset:32776
 ds_read_b64_tr_b16 a[164:165], v4 offset:40960
 ds_read_b64_tr_b16 a[166:167], v5 offset:40960
 ds_read_b64_tr_b16 a[172:173], v4 offset:40968
 ds_read_b64_tr_b16 a[174:175], v5 offset:40968
 ds_read_b64_tr_b16 a[176:177], v4 offset:49152
 ds_read_b64_tr_b16 a[178:179], v5 offset:49152
 ds_read_b64_tr_b16 a[184:185], v4 offset:49160
 ds_read_b64_tr_b16 a[186:187], v5 offset:49160
 ds_read_b64_tr_b16 a[180:181], v4 offset:57344
 ds_read_b64_tr_b16 a[182:183], v5 offset:57344
 ds_read_b64_tr_b16 a[188:189], v4 offset:57352
 ds_read_b64_tr_b16 a[190:191], v5 offset:57352
 s_waitcnt lgkmcnt(0)
 s_branch L_wl_done_171
L_wl_next_174:
 ds_read_b64_tr_b16 a[192:193], v4 offset:0
 ds_read_b64_tr_b16 a[194:195], v5 offset:0
 ds_read_b64_tr_b16 a[200:201], v4 offset:8
 ds_read_b64_tr_b16 a[202:203], v5 offset:8
 ds_read_b64_tr_b16 a[196:197], v4 offset:8192
 ds_read_b64_tr_b16 a[198:199], v5 offset:8192
 ds_read_b64_tr_b16 a[204:205], v4 offset:8200
 ds_read_b64_tr_b16 a[206:207], v5 offset:8200
 ds_read_b64_tr_b16 a[208:209], v4 offset:16384
 ds_read_b64_tr_b16 a[210:211], v5 offset:16384
 ds_read_b64_tr_b16 a[216:217], v4 offset:16392
 ds_read_b64_tr_b16 a[218:219], v5 offset:16392
 ds_read_b64_tr_b16 a[212:213], v4 offset:24576
 ds_read_b64_tr_b16 a[214:215], v5 offset:24576
 ds_read_b64_tr_b16 a[220:221], v4 offset:24584
 ds_read_b64_tr_b16 a[222:223], v5 offset:24584
 ds_read_b64_tr_b16 a[224:225], v4 offset:32768
 ds_read_b64_tr_b16 a[226:227], v5 offset:32768
 ds_read_b64_tr_b16 a[232:233], v4 offset:32776
 ds_read_b64_tr_b16 a[234:235], v5 offset:32776
 ds_read_b64_tr_b16 a[228:229], v4 offset:40960
 ds_read_b64_tr_b16 a[230:231], v5 offset:40960
 ds_read_b64_tr_b16 a[236:237], v4 offset:40968
 ds_read_b64_tr_b16 a[238:239], v5 offset:40968
 ds_read_b64_tr_b16 a[240:241], v4 offset:49152
 ds_read_b64_tr_b16 a[242:243], v5 offset:49152
 ds_read_b64_tr_b16 a[248:249], v4 offset:49160
 ds_read_b64_tr_b16 a[250:251], v5 offset:49160
 ds_read_b64_tr_b16 a[244:245], v4 offset:57344
 ds_read_b64_tr_b16 a[246:247], v5 offset:57344
 ds_read_b64_tr_b16 a[252:253], v4 offset:57352
 ds_read_b64_tr_b16 a[254:255], v5 offset:57352
 s_waitcnt lgkmcnt(0)
L_wl_done_171:
 s_barrier
 v_lshlrev_b32 v6, 2, v0
 s_lshr_b32 s66, s101, 2
 s_add_u32 s66, s66, 1
 s_branch L_hs1_177
L_hs_176:
 s_sleep 8
 s_sub_u32 s63, s63, 1
 s_cbranch_scc1 L_role_p_1_abort
L_hs1_177:
 buffer_load_dword v7, v6, s[16:19], 0 offen sc1
 s_waitcnt vmcnt(0)
 v_readlane_b32 s65, v7, s66
 s_cmp_eq_u32 s101, 128
 s_cbranch_scc1 L_hs2_178
 s_cmp_eq_u32 s101, 64
 s_cbranch_scc1 L_hs3_179
 v_readlane_b32 s67, v7, 9
 v_cmp_eq_u32 s[96:97], -1, v7
 s_mov_b32 vcc_lo, 0x20202020
 s_mov_b32 vcc_hi, 0x20202020
 s_nop 1
 s_cmp_lg_u32 s67, 0
 s_cbranch_scc1 L_retry
 s_andn2_b64 s[96:97], vcc, s[96:97]
 s_cbranch_scc1 L_hs_176
 s_branch L_hs2_178
L_hs3_179:
 v_readlane_b32 s67, v7, 10
 v_cmp_eq_u32 s[96:97], 32, v7
 s_mov_b32 vcc_lo, 0x01010101
 s_mov_b32 vcc_hi, 0x01010101
 s_nop 1
 s_cmp_lg_u32 s67, 0
 s_cbranch_scc1 L_fallback
 s_andn2_b64 s[96:97], vcc, s[96:97]
 s_cbranch_scc1 L_hs_176
L_hs2_178:
 s_cmp_ge_u32 s65, 64
 s_cbranch_scc0 L_hs_176
 s_mov_b32 s64, -2
 s_add_u32 s25, s22, 4096
L_proj_loop_180:
 s_cmp_ge_i32 s64, 0
 s_cbranch_scc1 L_proj_crit_181
 s_waitcnt vmcnt(0)
 s_barrier
 s_cmp_eq_i32 s64, -2
 s_cbranch_scc1 L_proj_x_182
 s_add_u32 s65, s22, 6144
 buffer_store_dwordx2 v[48:49], v11, s[4:7], s65 offen sc1
 v_mov_b32 v67, 1
 buffer_store_dword v67, v66, s[4:7], s83 offen sc1
 s_branch L_proj_x_182
L_proj_half_184:
 s_cmp_eq_u32 s64, 0
 s_cbranch_scc1 L_proj_noidle_186
 s_sleep 4
L_proj_noidle_186:
 buffer_load_dwordx4 v[32:35], v10, s[4:7], s20 offen offset:0 sc1
 buffer_load_dwordx4 v[36:39], v10, s[4:7], s20 offen offset:1024 sc1
 buffer_load_dwordx4 v[40:43], v10, s[4:7], s20 offen offset:2048 sc1
 buffer_load_dwordx4 v[44:47], v10, s[4:7], s20 offen offset:3072 sc1
 s_add_u32 s25, s64, 0
 s_and_b32 s25, s25, 3
 s_lshl_b32 s26, s25, 11
 s_xor_b32 s25, s26, 4096
 s_add_u32 s26, s26, s22
 s_add_u32 s25, s25, s22
 v_mov_b64 v[120:121], 0
 v_mov_b64 v[122:123], 0
 v_mov_b64 v[124:125], 0
 v_mov_b64 v[126:127], 0
 s_branch L_pq_187_0123
L_pq_187_0123f:
 buffer_load_dwordx4 v[32:35], v10, s[4:7], s20 offen offset:0 sc1
 s_sub_u32 s63, s63, 1
 s_cbranch_scc1 L_role_p_1_abort
L_pq_187_1230:
 s_waitcnt vmcnt(3)
 v_max_u32 v54, v36, v38
 v_cmp_eq_u32 vcc, -1, v54
 ds_write_b128 v20, v[36:39] offset:1024
 s_cbranch_vccnz L_pq_187_1230f
L_pq_187_230:
 s_waitcnt vmcnt(2)
 v_max_u32 v54, v40, v42
 v_cmp_eq_u32 vcc, -1, v54
 ds_write_b128 v20, v[40:43] offset:2048
 s_cbranch_vccnz L_pq_187_230f
L_pq_187_30:
 s_waitcnt vmcnt(1)
 v_max_u32 v54, v44, v46
 v_cmp_eq_u32 vcc, -1, v54
 ds_write_b128 v20, v[44:47] offset:3072
 s_cbranch_vccnz L_pq_187_30f
L_pq_187_0:
 buffer_load_dwordx4 v[32:35], v10, s[4:7], s20 offen offset:0 sc1
 s_sub_u32 s63, s63, 1
 s_cbranch_scc1 L_role_p_1_abort
 s_waitcnt vmcnt(1)
 v_max_u32 v54, v32, v34
 v_cmp_eq_u32 vcc, -1, v54
 ds_write_b128 v20, v[32:35] offset:0
 s_cbranch_vccnz L_pq_187_0
 s_branch L_pq_187_done
L_pq_187_1230f:
 buffer_load_dwordx4 v[36:39], v10, s[4:7], s20 offen offset:1024 sc1
L_pq_187_2301:
 s_waitcnt vmcnt(3)
 v_max_u32 v54, v40, v42
 v_cmp_eq_u32 vcc, -1, v54
 ds_write_b128 v20, v[40:43] offset:2048
 s_cbranch_vccnz L_pq_187_2301f
L_pq_187_301:
 s_waitcnt vmcnt(2)
 v_max_u32 v54, v44, v46
 v_cmp_eq_u32 vcc, -1, v54
 ds_write_b128 v20, v[44:47] offset:3072
 s_cbranch_vccnz L_pq_187_301f
L_pq_187_01:
 s_waitcnt vmcnt(1)
 v_max_u32 v54, v32, v34
 v_cmp_eq_u32 vcc, -1, v54
 ds_write_b128 v20, v[32:35] offset:0
 s_cbranch_vccnz L_pq_187_01f
L_pq_187_1:
 buffer_load_dwordx4 v[36:39], v10, s[4:7], s20 offen offset:1024 sc1
 s_sub_u32 s63, s63, 1
 s_cbranch_scc1 L_role_p_1_abort
 s_waitcnt vmcnt(1)
 v_max_u32 v54, v36, v38
 v_cmp_eq_u32 vcc, -1, v54
 ds_write_b128 v20, v[36:39] offset:1024
 s_cbranch_vccnz L_pq_187_1
 s_branch L_pq_187_done
L_pq_187_2301f:
 buffer_load_dwordx4 v[40:43], v10, s[4:7], s20 offen offset:2048 sc1
L_pq_187_3012:
 s_waitcnt vmcnt(3)
 v_max_u32 v54, v44, v46
 v_cmp_eq_u32 vcc, -1, v54
 ds_write_b128 v20, v[44:47] offset:3072
 s_cbranch_vccnz L_pq_187_3012f
L_pq_187_012:
 s_waitcnt vmcnt(2)
 v_max_u32 v54, v32, v34
 v_cmp_eq_u32 vcc, -1, v54
 ds_write_b128 v20, v[32:35] offset:0
 s_cbranch_vccnz L_pq_187_012f
L_pq_187_12:
 s_waitcnt vmcnt(1)
 v_max_u32 v54, v36, v38
 v_cmp_eq_u32 vcc, -1, v54
 ds_write_b128 v20, v[36:39] offset:1024
 s_cbranch_vccnz L_pq_187_12f
L_pq_187_2:
 buffer_load_dwordx4 v[40:43], v10, s[4:7], s20 offen offset:2048 sc1
 s_sub_u32 s63, s63, 1
 s_cbranch_scc1 L_role_p_1_abort
 s_waitcnt vmcnt(1)
 v_max_u32 v54, v40, v42
 v_cmp_eq_u32 vcc, -1, v54
 ds_write_b128 v20, v[40:43] offset:2048
 s_cbranch_vccnz L_pq_187_2
 s_branch L_pq_187_done
L_pq_187_3012f:
 buffer_load_dwordx4 v[44:47], v10, s[4:7], s20 offen offset:3072 sc1
 s_branch L_pq_187_0123
L_pq_187_012f:
 buffer_load_dwordx4 v[32:35], v10, s[4:7], s20 offen offset:0 sc1
 s_sub_u32 s63, s63, 1
 s_cbranch_scc1 L_role_p_1_abort
L_pq_187_120:
 s_waitcnt vmcnt(2)
 v_max_u32 v54, v36, v38
 v_cmp_eq_u32 vcc, -1, v54
 ds_write_b128 v20, v[36:39] offset:1024
 s_cbranch_vccnz L_pq_187_120f
L_pq_187_20:
 s_waitcnt vmcnt(1)
 v_max_u32 v54, v40, v42
 v_cmp_eq_u32 vcc, -1, v54
 ds_write_b128 v20, v[40:43] offset:2048
 s_cbranch_vccnz L_pq_187_20f
 s_branch L_pq_187_0
L_pq_187_120f:
 buffer_load_dwordx4 v[36:39], v10, s[4:7], s20 offen offset:1024 sc1
L_pq_187_201:
 s_waitcnt vmcnt(2)
 v_max_u32 v54, v40, v42
 v_cmp_eq_u32 vcc, -1, v54
 ds_write_b128 v20, v[40:43] offset:2048
 s_cbranch_vccnz L_pq_187_201f
 s_branch L_pq_187_01
L_pq_187_201f:
 buffer_load_dwordx4 v[40:43], v10, s[4:7], s20 offen offset:2048 sc1
 s_branch L_pq_187_012
L_pq_187_013f:
 buffer_load_dwordx4 v[32:35], v10, s[4:7], s20 offen offset:0 sc1
 s_sub_u32 s63, s63, 1
 s_cbranch_scc1 L_role_p_1_abort
L_pq_187_130:
 s_waitcnt vmcnt(2)
 v_max_u32 v54, v36, v38
 v_cmp_eq_u32 vcc, -1, v54
 ds_write_b128 v20, v[36:39] offset:1024
 s_cbranch_vccnz L_pq_187_130f
 s_branch L_pq_187_30
L_pq_187_130f:
 buffer_load_dwordx4 v[36:39], v10, s[4:7], s20 offen offset:1024 sc1
 s_branch L_pq_187_301
L_pq_187_301f:
 buffer_load_dwordx4 v[44:47], v10, s[4:7], s20 offen offset:3072 sc1
L_pq_187_013:
 s_waitcnt vmcnt(2)
 v_max_u32 v54, v32, v34
 v_cmp_eq_u32 vcc, -1, v54
 ds_write_b128 v20, v[32:35] offset:0
 s_cbranch_vccnz L_pq_187_013f
L_pq_187_13:
 s_waitcnt vmcnt(1)
 v_max_u32 v54, v36, v38
 v_cmp_eq_u32 vcc, -1, v54
 ds_write_b128 v20, v[36:39] offset:1024
 s_cbranch_vccnz L_pq_187_13f
 s_branch L_pq_187_3
L_pq_187_023f:
 buffer_load_dwordx4 v[32:35], v10, s[4:7], s20 offen offset:0 sc1
 s_sub_u32 s63, s63, 1
 s_cbranch_scc1 L_role_p_1_abort
 s_branch L_pq_187_230
L_pq_187_230f:
 buffer_load_dwordx4 v[40:43], v10, s[4:7], s20 offen offset:2048 sc1
L_pq_187_302:
 s_waitcnt vmcnt(2)
 v_max_u32 v54, v44, v46
 v_cmp_eq_u32 vcc, -1, v54
 ds_write_b128 v20, v[44:47] offset:3072
 s_cbranch_vccnz L_pq_187_302f
L_pq_187_02:
 s_waitcnt vmcnt(1)
 v_max_u32 v54, v32, v34
 v_cmp_eq_u32 vcc, -1, v54
 ds_write_b128 v20, v[32:35] offset:0
 s_cbranch_vccnz L_pq_187_02f
 s_branch L_pq_187_2
L_pq_187_302f:
 buffer_load_dwordx4 v[44:47], v10, s[4:7], s20 offen offset:3072 sc1
L_pq_187_023:
 s_waitcnt vmcnt(2)
 v_max_u32 v54, v32, v34
 v_cmp_eq_u32 vcc, -1, v54
 ds_write_b128 v20, v[32:35] offset:0
 s_cbranch_vccnz L_pq_187_023f
 s_branch L_pq_187_23
L_pq_187_123f:
 buffer_load_dwordx4 v[36:39], v10, s[4:7], s20 offen offset:1024 sc1
 s_sub_u32 s63, s63, 1
 s_cbranch_scc1 L_role_p_1_abort
L_pq_187_231:
 s_waitcnt vmcnt(2)
 v_max_u32 v54, v40, v42
 v_cmp_eq_u32 vcc, -1, v54
 ds_write_b128 v20, v[40:43] offset:2048
 s_cbranch_vccnz L_pq_187_231f
L_pq_187_31:
 s_waitcnt vmcnt(1)
 v_max_u32 v54, v44, v46
 v_cmp_eq_u32 vcc, -1, v54
 ds_write_b128 v20, v[44:47] offset:3072
 s_cbranch_vccnz L_pq_187_31f
 s_branch L_pq_187_1
L_pq_187_231f:
 buffer_load_dwordx4 v[40:43], v10, s[4:7], s20 offen offset:2048 sc1
L_pq_187_312:
 s_waitcnt vmcnt(2)
 v_max_u32 v54, v44, v46
 v_cmp_eq_u32 vcc, -1, v54
 ds_write_b128 v20, v[44:47] offset:3072
 s_cbranch_vccnz L_pq_187_312f
 s_branch L_pq_187_12
L_pq_187_312f:
 buffer_load_dwordx4 v[44:47], v10, s[4:7], s20 offen offset:3072 sc1
 s_branch L_pq_187_123
L_pq_187_01f:
 buffer_load_dwordx4 v[32:35], v10, s[4:7], s20 offen offset:0 sc1
 s_sub_u32 s63, s63, 1
 s_cbranch_scc1 L_role_p_1_abort
L_pq_187_10:
 s_waitcnt vmcnt(1)
 v_max_u32 v54, v36, v38
 v_cmp_eq_u32 vcc, -1, v54
 ds_write_b128 v20, v[36:39] offset:1024
 s_cbranch_vccnz L_pq_187_10f
 s_branch L_pq_187_0
L_pq_187_10f:
 buffer_load_dwordx4 v[36:39], v10, s[4:7], s20 offen offset:1024 sc1
 s_branch L_pq_187_01
L_pq_187_02f:
 buffer_load_dwordx4 v[32:35], v10, s[4:7], s20 offen offset:0 sc1
 s_sub_u32 s63, s63, 1
 s_cbranch_scc1 L_role_p_1_abort
 s_branch L_pq_187_20
L_pq_187_20f:
 buffer_load_dwordx4 v[40:43], v10, s[4:7], s20 offen offset:2048 sc1
 s_branch L_pq_187_02
L_pq_187_03f:
 buffer_load_dwordx4 v[32:35], v10, s[4:7], s20 offen offset:0 sc1
 s_sub_u32 s63, s63, 1
 s_cbranch_scc1 L_role_p_1_abort
 s_branch L_pq_187_30
L_pq_187_30f:
 buffer_load_dwordx4 v[44:47], v10, s[4:7], s20 offen offset:3072 sc1
L_pq_187_03:
 s_waitcnt vmcnt(1)
 v_max_u32 v54, v32, v34
 v_cmp_eq_u32 vcc, -1, v54
 ds_write_b128 v20, v[32:35] offset:0
 s_cbranch_vccnz L_pq_187_03f
 s_branch L_pq_187_3
L_pq_187_12f:
 buffer_load_dwordx4 v[36:39], v10, s[4:7], s20 offen offset:1024 sc1
 s_sub_u32 s63, s63, 1
 s_cbranch_scc1 L_role_p_1_abort
L_pq_187_21:
 s_waitcnt vmcnt(1)
 v_max_u32 v54, v40, v42
 v_cmp_eq_u32 vcc, -1, v54
 ds_write_b128 v20, v[40:43] offset:2048
 s_cbranch_vccnz L_pq_187_21f
 s_branch L_pq_187_1
L_pq_187_21f:
 buffer_load_dwordx4 v[40:43], v10, s[4:7], s20 offen offset:2048 sc1
 s_branch L_pq_187_12
L_pq_187_13f:
 buffer_load_dwordx4 v[36:39], v10, s[4:7], s20 offen offset:1024 sc1
 s_sub_u32 s63, s63, 1
 s_cbranch_scc1 L_role_p_1_abort
 s_branch L_pq_187_31
L_pq_187_31f:
 buffer_load_dwordx4 v[44:47], v10, s[4:7], s20 offen offset:3072 sc1
 s_branch L_pq_187_13
L_pq_187_23f:
 buffer_load_dwordx4 v[40:43], v10, s[4:7], s20 offen offset:2048 sc1
 s_sub_u32 s63, s63, 1
 s_cbranch_scc1 L_role_p_1_abort
L_pq_187_32:
 s_waitcnt vmcnt(1)
 v_max_u32 v54, v44, v46
 v_cmp_eq_u32 vcc, -1, v54
 ds_write_b128 v20, v[44:47] offset:3072
 s_cbranch_vccnz L_pq_187_32f
 s_branch L_pq_187_2
L_pq_187_32f:
 buffer_load_dwordx4 v[44:47], v10, s[4:7], s20 offen offset:3072 sc1
 s_branch L_pq_187_23
.p2align 6
L_pq_187_0123:
 s_waitcnt vmcnt(3)
 v_max_u32 v54, v32, v34
 v_cmp_eq_u32 vcc, -1, v54
 ds_write_b128 v20, v[32:35] offset:0
 s_cbranch_vccnz L_pq_187_0123f
L_pq_187_123:
 s_waitcnt vmcnt(2)
 v_max_u32 v54, v36, v38
 v_cmp_eq_u32 vcc, -1, v54
 ds_write_b128 v20, v[36:39] offset:1024
 s_cbranch_vccnz L_pq_187_123f
L_pq_187_23:
 s_waitcnt vmcnt(1)
 v_max_u32 v54, v40, v42
 v_cmp_eq_u32 vcc, -1, v54
 ds_write_b128 v20, v[40:43] offset:2048
 s_cbranch_vccnz L_pq_187_23f
L_pq_187_3:
 buffer_load_dwordx4 v[44:47], v10, s[4:7], s20 offen offset:3072 sc1
 s_sub_u32 s63, s63, 1
 s_cbranch_scc1 L_role_p_1_abort
 s_waitcnt vmcnt(1)
 v_max_u32 v54, v44, v46
 v_cmp_eq_u32 vcc, -1, v54
 ds_write_b128 v20, v[44:47] offset:3072
 s_cbranch_vccnz L_pq_187_3
L_pq_187_done:
 v_smfmac_f32_16x16x64_bf16 v[120:123], v[32:35], a[0:7], v24
 v_smfmac_f32_16x16x64_bf16 v[120:123], v[36:39], a[16:23], v24
 s_waitcnt lgkmcnt(0)
 s_barrier
 ds_read_b128 v[72:75], v21 offset:0
 ds_read_b128 v[76:79], v21 offset:1024
 ds_read_b128 v[80:83], v21 offset:2048
 ds_read_b128 v[84:87], v21 offset:3072
 v_smfmac_f32_16x16x64_bf16 v[120:123], v[40:43], a[32:39], v24
 ds_read_b128 v[88:91], v22 offset:0
 ds_read_b128 v[92:95], v22 offset:1024
 ds_read_b128 v[96:99], v22 offset:2048
 ds_read_b128 v[100:103], v22 offset:3072
 v_smfmac_f32_16x16x64_bf16 v[120:123], v[44:47], a[48:55], v24
 ds_read_b128 v[104:107], v23 offset:0
 ds_read_b128 v[108:111], v23 offset:1024
 ds_read_b128 v[112:115], v23 offset:2048
 ds_read_b128 v[116:119], v23 offset:3072
 s_waitcnt lgkmcnt(11)
 v_smfmac_f32_16x16x64_bf16 v[120:123], v[72:75], a[64:71], v24
 s_waitcnt lgkmcnt(10)
 v_smfmac_f32_16x16x64_bf16 v[120:123], v[76:79], a[80:87], v24
 s_waitcnt lgkmcnt(9)
 v_smfmac_f32_16x16x64_bf16 v[120:123], v[80:83], a[96:103], v24
 s_waitcnt lgkmcnt(8)
 v_smfmac_f32_16x16x64_bf16 v[120:123], v[84:87], a[112:119], v24
 s_waitcnt lgkmcnt(7)
 v_smfmac_f32_16x16x64_bf16 v[120:123], v[88:91], a[128:135], v24
 s_waitcnt lgkmcnt(6)
 v_smfmac_f32_16x16x64_bf16 v[120:123], v[92:95], a[144:151], v24
 s_waitcnt lgkmcnt(5)
 v_smfmac_f32_16x16x64_bf16 v[120:123], v[96:99], a[160:167], v24
 s_waitcnt lgkmcnt(4)
 v_smfmac_f32_16x16x64_bf16 v[120:123], v[100:103], a[176:183], v24
 s_waitcnt lgkmcnt(3)
 v_smfmac_f32_16x16x64_bf16 v[120:123], v[104:107], a[192:199], v24
 s_waitcnt lgkmcnt(2)
 v_smfmac_f32_16x16x64_bf16 v[120:123], v[108:111], a[208:215], v24
 s_waitcnt lgkmcnt(1)
 v_smfmac_f32_16x16x64_bf16 v[120:123], v[112:115], a[224:231], v24
 s_waitcnt lgkmcnt(0)
 v_smfmac_f32_16x16x64_bf16 v[120:123], v[116:119], a[240:247], v24
 s_nop 7
 v_cvt_pk_bf16_f32 v48, v120, v121
 v_cvt_pk_bf16_f32 v49, v122, v123
 s_nop 1
 v_mfma_f32_16x16x32_bf16 v[128:131], v[48:51], v[28:31], 0
 s_nop 7
 v_cvt_pk_bf16_f32 v52, v128, v129
 v_cvt_pk_bf16_f32 v53, v130, v131
 v_min_u32 v52, -2, v52
 buffer_store_dwordx2 v[52:53], v12, s[4:7], s26 offen sc1
 s_branch L_proj_pub_185
L_proj_crit_181:
 s_add_u32 s20, s64, 0
 s_and_b32 s20, s20, 3
 s_lshl_b32 s20, s20, 14
 s_add_u32 s20, s20, s23
 s_cmp_eq_u32 s24, 2
 s_cbranch_scc0 L_proj_half_184
 buffer_load_dwordx4 v[32:35], v10, s[4:7], s20 offen offset:0 sc1
 buffer_load_dwordx4 v[36:39], v10, s[4:7], s20 offen offset:1024 sc1
 buffer_load_dwordx4 v[40:43], v10, s[4:7], s20 offen offset:2048 sc1
 buffer_load_dwordx4 v[44:47], v10, s[4:7], s20 offen offset:3072 sc1
 s_add_u32 s65, s64, 2
 v_mov_b32 v67, s65
 s_waitcnt vmcnt(4)
 buffer_store_dword v67, v66, s[4:7], s83 offen sc1
 s_add_u32 s25, s64, 0
 s_and_b32 s25, s25, 3
 s_lshl_b32 s26, s25, 11
 s_xor_b32 s25, s26, 4096
 s_add_u32 s26, s26, s22
 s_add_u32 s25, s25, s22
 v_mov_b64 v[120:121], 0
 v_mov_b64 v[122:123], 0
 v_mov_b64 v[124:125], 0
 v_mov_b64 v[126:127], 0
 s_branch L_pq_188_0123
L_pq_188_0123f:
 buffer_load_dwordx4 v[32:35], v10, s[4:7], s20 offen offset:0 sc1
 s_sub_u32 s63, s63, 1
 s_cbranch_scc1 L_role_p_1_abort
L_pq_188_1230:
 s_waitcnt vmcnt(3)
 v_max_u32 v54, v36, v38
 v_cmp_eq_u32 vcc, -1, v54
 ds_write_b128 v20, v[36:39] offset:1024
 s_cbranch_vccnz L_pq_188_1230f
L_pq_188_230:
 s_waitcnt vmcnt(2)
 v_max_u32 v54, v40, v42
 v_cmp_eq_u32 vcc, -1, v54
 ds_write_b128 v20, v[40:43] offset:2048
 s_cbranch_vccnz L_pq_188_230f
L_pq_188_30:
 s_waitcnt vmcnt(1)
 v_max_u32 v54, v44, v46
 v_cmp_eq_u32 vcc, -1, v54
 ds_write_b128 v20, v[44:47] offset:3072
 s_cbranch_vccnz L_pq_188_30f
L_pq_188_0:
 buffer_load_dwordx4 v[32:35], v10, s[4:7], s20 offen offset:0 sc1
 s_sub_u32 s63, s63, 1
 s_cbranch_scc1 L_role_p_1_abort
 s_waitcnt vmcnt(1)
 v_max_u32 v54, v32, v34
 v_cmp_eq_u32 vcc, -1, v54
 ds_write_b128 v20, v[32:35] offset:0
 s_cbranch_vccnz L_pq_188_0
 s_branch L_pq_188_done
L_pq_188_1230f:
 buffer_load_dwordx4 v[36:39], v10, s[4:7], s20 offen offset:1024 sc1
L_pq_188_2301:
 s_waitcnt vmcnt(3)
 v_max_u32 v54, v40, v42
 v_cmp_eq_u32 vcc, -1, v54
 ds_write_b128 v20, v[40:43] offset:2048
 s_cbranch_vccnz L_pq_188_2301f
L_pq_188_301:
 s_waitcnt vmcnt(2)
 v_max_u32 v54, v44, v46
 v_cmp_eq_u32 vcc, -1, v54
 ds_write_b128 v20, v[44:47] offset:3072
 s_cbranch_vccnz L_pq_188_301f
L_pq_188_01:
 s_waitcnt vmcnt(1)
 v_max_u32 v54, v32, v34
 v_cmp_eq_u32 vcc, -1, v54
 ds_write_b128 v20, v[32:35] offset:0
 s_cbranch_vccnz L_pq_188_01f
L_pq_188_1:
 buffer_load_dwordx4 v[36:39], v10, s[4:7], s20 offen offset:1024 sc1
 s_sub_u32 s63, s63, 1
 s_cbranch_scc1 L_role_p_1_abort
 s_waitcnt vmcnt(1)
 v_max_u32 v54, v36, v38
 v_cmp_eq_u32 vcc, -1, v54
 ds_write_b128 v20, v[36:39] offset:1024
 s_cbranch_vccnz L_pq_188_1
 s_branch L_pq_188_done
L_pq_188_2301f:
 buffer_load_dwordx4 v[40:43], v10, s[4:7], s20 offen offset:2048 sc1
L_pq_188_3012:
 s_waitcnt vmcnt(3)
 v_max_u32 v54, v44, v46
 v_cmp_eq_u32 vcc, -1, v54
 ds_write_b128 v20, v[44:47] offset:3072
 s_cbranch_vccnz L_pq_188_3012f
L_pq_188_012:
 s_waitcnt vmcnt(2)
 v_max_u32 v54, v32, v34
 v_cmp_eq_u32 vcc, -1, v54
 ds_write_b128 v20, v[32:35] offset:0
 s_cbranch_vccnz L_pq_188_012f
L_pq_188_12:
 s_waitcnt vmcnt(1)
 v_max_u32 v54, v36, v38
 v_cmp_eq_u32 vcc, -1, v54
 ds_write_b128 v20, v[36:39] offset:1024
 s_cbranch_vccnz L_pq_188_12f
L_pq_188_2:
 buffer_load_dwordx4 v[40:43], v10, s[4:7], s20 offen offset:2048 sc1
 s_sub_u32 s63, s63, 1
 s_cbranch_scc1 L_role_p_1_abort
 s_waitcnt vmcnt(1)
 v_max_u32 v54, v40, v42
 v_cmp_eq_u32 vcc, -1, v54
 ds_write_b128 v20, v[40:43] offset:2048
 s_cbranch_vccnz L_pq_188_2
 s_branch L_pq_188_done
L_pq_188_3012f:
 buffer_load_dwordx4 v[44:47], v10, s[4:7], s20 offen offset:3072 sc1
 s_branch L_pq_188_0123
L_pq_188_012f:
 buffer_load_dwordx4 v[32:35], v10, s[4:7], s20 offen offset:0 sc1
 s_sub_u32 s63, s63, 1
 s_cbranch_scc1 L_role_p_1_abort
L_pq_188_120:
 s_waitcnt vmcnt(2)
 v_max_u32 v54, v36, v38
 v_cmp_eq_u32 vcc, -1, v54
 ds_write_b128 v20, v[36:39] offset:1024
 s_cbranch_vccnz L_pq_188_120f
L_pq_188_20:
 s_waitcnt vmcnt(1)
 v_max_u32 v54, v40, v42
 v_cmp_eq_u32 vcc, -1, v54
 ds_write_b128 v20, v[40:43] offset:2048
 s_cbranch_vccnz L_pq_188_20f
 s_branch L_pq_188_0
L_pq_188_120f:
 buffer_load_dwordx4 v[36:39], v10, s[4:7], s20 offen offset:1024 sc1
L_pq_188_201:
 s_waitcnt vmcnt(2)
 v_max_u32 v54, v40, v42
 v_cmp_eq_u32 vcc, -1, v54
 ds_write_b128 v20, v[40:43] offset:2048
 s_cbranch_vccnz L_pq_188_201f
 s_branch L_pq_188_01
L_pq_188_201f:
 buffer_load_dwordx4 v[40:43], v10, s[4:7], s20 offen offset:2048 sc1
 s_branch L_pq_188_012
L_pq_188_013f:
 buffer_load_dwordx4 v[32:35], v10, s[4:7], s20 offen offset:0 sc1
 s_sub_u32 s63, s63, 1
 s_cbranch_scc1 L_role_p_1_abort
L_pq_188_130:
 s_waitcnt vmcnt(2)
 v_max_u32 v54, v36, v38
 v_cmp_eq_u32 vcc, -1, v54
 ds_write_b128 v20, v[36:39] offset:1024
 s_cbranch_vccnz L_pq_188_130f
 s_branch L_pq_188_30
L_pq_188_130f:
 buffer_load_dwordx4 v[36:39], v10, s[4:7], s20 offen offset:1024 sc1
 s_branch L_pq_188_301
L_pq_188_301f:
 buffer_load_dwordx4 v[44:47], v10, s[4:7], s20 offen offset:3072 sc1
L_pq_188_013:
 s_waitcnt vmcnt(2)
 v_max_u32 v54, v32, v34
 v_cmp_eq_u32 vcc, -1, v54
 ds_write_b128 v20, v[32:35] offset:0
 s_cbranch_vccnz L_pq_188_013f
L_pq_188_13:
 s_waitcnt vmcnt(1)
 v_max_u32 v54, v36, v38
 v_cmp_eq_u32 vcc, -1, v54
 ds_write_b128 v20, v[36:39] offset:1024
 s_cbranch_vccnz L_pq_188_13f
 s_branch L_pq_188_3
L_pq_188_023f:
 buffer_load_dwordx4 v[32:35], v10, s[4:7], s20 offen offset:0 sc1
 s_sub_u32 s63, s63, 1
 s_cbranch_scc1 L_role_p_1_abort
 s_branch L_pq_188_230
L_pq_188_230f:
 buffer_load_dwordx4 v[40:43], v10, s[4:7], s20 offen offset:2048 sc1
L_pq_188_302:
 s_waitcnt vmcnt(2)
 v_max_u32 v54, v44, v46
 v_cmp_eq_u32 vcc, -1, v54
 ds_write_b128 v20, v[44:47] offset:3072
 s_cbranch_vccnz L_pq_188_302f
L_pq_188_02:
 s_waitcnt vmcnt(1)
 v_max_u32 v54, v32, v34
 v_cmp_eq_u32 vcc, -1, v54
 ds_write_b128 v20, v[32:35] offset:0
 s_cbranch_vccnz L_pq_188_02f
 s_branch L_pq_188_2
L_pq_188_302f:
 buffer_load_dwordx4 v[44:47], v10, s[4:7], s20 offen offset:3072 sc1
L_pq_188_023:
 s_waitcnt vmcnt(2)
 v_max_u32 v54, v32, v34
 v_cmp_eq_u32 vcc, -1, v54
 ds_write_b128 v20, v[32:35] offset:0
 s_cbranch_vccnz L_pq_188_023f
 s_branch L_pq_188_23
L_pq_188_123f:
 buffer_load_dwordx4 v[36:39], v10, s[4:7], s20 offen offset:1024 sc1
 s_sub_u32 s63, s63, 1
 s_cbranch_scc1 L_role_p_1_abort
L_pq_188_231:
 s_waitcnt vmcnt(2)
 v_max_u32 v54, v40, v42
 v_cmp_eq_u32 vcc, -1, v54
 ds_write_b128 v20, v[40:43] offset:2048
 s_cbranch_vccnz L_pq_188_231f
L_pq_188_31:
 s_waitcnt vmcnt(1)
 v_max_u32 v54, v44, v46
 v_cmp_eq_u32 vcc, -1, v54
 ds_write_b128 v20, v[44:47] offset:3072
 s_cbranch_vccnz L_pq_188_31f
 s_branch L_pq_188_1
L_pq_188_231f:
 buffer_load_dwordx4 v[40:43], v10, s[4:7], s20 offen offset:2048 sc1
L_pq_188_312:
 s_waitcnt vmcnt(2)
 v_max_u32 v54, v44, v46
 v_cmp_eq_u32 vcc, -1, v54
 ds_write_b128 v20, v[44:47] offset:3072
 s_cbranch_vccnz L_pq_188_312f
 s_branch L_pq_188_12
L_pq_188_312f:
 buffer_load_dwordx4 v[44:47], v10, s[4:7], s20 offen offset:3072 sc1
 s_branch L_pq_188_123
L_pq_188_01f:
 buffer_load_dwordx4 v[32:35], v10, s[4:7], s20 offen offset:0 sc1
 s_sub_u32 s63, s63, 1
 s_cbranch_scc1 L_role_p_1_abort
L_pq_188_10:
 s_waitcnt vmcnt(1)
 v_max_u32 v54, v36, v38
 v_cmp_eq_u32 vcc, -1, v54
 ds_write_b128 v20, v[36:39] offset:1024
 s_cbranch_vccnz L_pq_188_10f
 s_branch L_pq_188_0
L_pq_188_10f:
 buffer_load_dwordx4 v[36:39], v10, s[4:7], s20 offen offset:1024 sc1
 s_branch L_pq_188_01
L_pq_188_02f:
 buffer_load_dwordx4 v[32:35], v10, s[4:7], s20 offen offset:0 sc1
 s_sub_u32 s63, s63, 1
 s_cbranch_scc1 L_role_p_1_abort
 s_branch L_pq_188_20
L_pq_188_20f:
 buffer_load_dwordx4 v[40:43], v10, s[4:7], s20 offen offset:2048 sc1
 s_branch L_pq_188_02
L_pq_188_03f:
 buffer_load_dwordx4 v[32:35], v10, s[4:7], s20 offen offset:0 sc1
 s_sub_u32 s63, s63, 1
 s_cbranch_scc1 L_role_p_1_abort
 s_branch L_pq_188_30
L_pq_188_30f:
 buffer_load_dwordx4 v[44:47], v10, s[4:7], s20 offen offset:3072 sc1
L_pq_188_03:
 s_waitcnt vmcnt(1)
 v_max_u32 v54, v32, v34
 v_cmp_eq_u32 vcc, -1, v54
 ds_write_b128 v20, v[32:35] offset:0
 s_cbranch_vccnz L_pq_188_03f
 s_branch L_pq_188_3
L_pq_188_12f:
 buffer_load_dwordx4 v[36:39], v10, s[4:7], s20 offen offset:1024 sc1
 s_sub_u32 s63, s63, 1
 s_cbranch_scc1 L_role_p_1_abort
L_pq_188_21:
 s_waitcnt vmcnt(1)
 v_max_u32 v54, v40, v42
 v_cmp_eq_u32 vcc, -1, v54
 ds_write_b128 v20, v[40:43] offset:2048
 s_cbranch_vccnz L_pq_188_21f
 s_branch L_pq_188_1
L_pq_188_21f:
 buffer_load_dwordx4 v[40:43], v10, s[4:7], s20 offen offset:2048 sc1
 s_branch L_pq_188_12
L_pq_188_13f:
 buffer_load_dwordx4 v[36:39], v10, s[4:7], s20 offen offset:1024 sc1
 s_sub_u32 s63, s63, 1
 s_cbranch_scc1 L_role_p_1_abort
 s_branch L_pq_188_31
L_pq_188_31f:
 buffer_load_dwordx4 v[44:47], v10, s[4:7], s20 offen offset:3072 sc1
 s_branch L_pq_188_13
L_pq_188_23f:
 buffer_load_dwordx4 v[40:43], v10, s[4:7], s20 offen offset:2048 sc1
 s_sub_u32 s63, s63, 1
 s_cbranch_scc1 L_role_p_1_abort
L_pq_188_32:
 s_waitcnt vmcnt(1)
 v_max_u32 v54, v44, v46
 v_cmp_eq_u32 vcc, -1, v54
 ds_write_b128 v20, v[44:47] offset:3072
 s_cbranch_vccnz L_pq_188_32f
 s_branch L_pq_188_2
L_pq_188_32f:
 buffer_load_dwordx4 v[44:47], v10, s[4:7], s20 offen offset:3072 sc1
 s_branch L_pq_188_23
.p2align 6
L_pq_188_0123:
 s_waitcnt vmcnt(3)
 v_max_u32 v54, v32, v34
 v_cmp_eq_u32 vcc, -1, v54
 ds_write_b128 v20, v[32:35] offset:0
 s_cbranch_vccnz L_pq_188_0123f
L_pq_188_123:
 s_waitcnt vmcnt(2)
 v_max_u32 v54, v36, v38
 v_cmp_eq_u32 vcc, -1, v54
 ds_write_b128 v20, v[36:39] offset:1024
 s_cbranch_vccnz L_pq_188_123f
L_pq_188_23:
 s_waitcnt vmcnt(1)
 v_max_u32 v54, v40, v42
 v_cmp_eq_u32 vcc, -1, v54
 ds_write_b128 v20, v[40:43] offset:2048
 s_cbranch_vccnz L_pq_188_23f
L_pq_188_3:
 buffer_load_dwordx4 v[44:47], v10, s[4:7], s20 offen offset:3072 sc1
 s_sub_u32 s63, s63, 1
 s_cbranch_scc1 L_role_p_1_abort
 s_waitcnt vmcnt(1)
 v_max_u32 v54, v44, v46
 v_cmp_eq_u32 vcc, -1, v54
 ds_write_b128 v20, v[44:47] offset:3072
 s_cbranch_vccnz L_pq_188_3
L_pq_188_done:
 v_smfmac_f32_16x16x64_bf16 v[120:123], v[32:35], a[0:7], v24
 v_smfmac_f32_16x16x64_bf16 v[124:127], v[32:35], a[8:15], v24
 v_smfmac_f32_16x16x64_bf16 v[120:123], v[36:39], a[16:23], v24
 v_smfmac_f32_16x16x64_bf16 v[124:127], v[36:39], a[24:31], v24
 s_waitcnt lgkmcnt(0)
 s_barrier
 ds_read_b128 v[72:75], v21 offset:0
 ds_read_b128 v[76:79], v21 offset:1024
 ds_read_b128 v[80:83], v21 offset:2048
 ds_read_b128 v[84:87], v21 offset:3072
 v_smfmac_f32_16x16x64_bf16 v[120:123], v[40:43], a[32:39], v24
 v_smfmac_f32_16x16x64_bf16 v[124:127], v[40:43], a[40:47], v24
 ds_read_b128 v[88:91], v22 offset:0
 ds_read_b128 v[92:95], v22 offset:1024
 ds_read_b128 v[96:99], v22 offset:2048
 ds_read_b128 v[100:103], v22 offset:3072
 v_smfmac_f32_16x16x64_bf16 v[120:123], v[44:47], a[48:55], v24
 v_smfmac_f32_16x16x64_bf16 v[124:127], v[44:47], a[56:63], v24
 ds_read_b128 v[104:107], v23 offset:0
 ds_read_b128 v[108:111], v23 offset:1024
 ds_read_b128 v[112:115], v23 offset:2048
 ds_read_b128 v[116:119], v23 offset:3072
 s_waitcnt lgkmcnt(11)
 v_smfmac_f32_16x16x64_bf16 v[120:123], v[72:75], a[64:71], v24
 v_smfmac_f32_16x16x64_bf16 v[124:127], v[72:75], a[72:79], v24
 s_waitcnt lgkmcnt(10)
 v_smfmac_f32_16x16x64_bf16 v[120:123], v[76:79], a[80:87], v24
 v_smfmac_f32_16x16x64_bf16 v[124:127], v[76:79], a[88:95], v24
 s_waitcnt lgkmcnt(9)
 v_smfmac_f32_16x16x64_bf16 v[120:123], v[80:83], a[96:103], v24
 v_smfmac_f32_16x16x64_bf16 v[124:127], v[80:83], a[104:111], v24
 s_waitcnt lgkmcnt(8)
 v_smfmac_f32_16x16x64_bf16 v[120:123], v[84:87], a[112:119], v24
 v_smfmac_f32_16x16x64_bf16 v[124:127], v[84:87], a[120:127], v24
 s_waitcnt lgkmcnt(7)
 v_smfmac_f32_16x16x64_bf16 v[120:123], v[88:91], a[128:135], v24
 v_smfmac_f32_16x16x64_bf16 v[124:127], v[88:91], a[136:143], v24
 s_waitcnt lgkmcnt(6)
 v_smfmac_f32_16x16x64_bf16 v[120:123], v[92:95], a[144:151], v24
 v_smfmac_f32_16x16x64_bf16 v[124:127], v[92:95], a[152:159], v24
 s_waitcnt lgkmcnt(5)
 v_smfmac_f32_16x16x64_bf16 v[120:123], v[96:99], a[160:167], v24
 v_smfmac_f32_16x16x64_bf16 v[124:127], v[96:99], a[168:175], v24
 s_waitcnt lgkmcnt(4)
 v_smfmac_f32_16x16x64_bf16 v[120:123], v[100:103], a[176:183], v24
 v_smfmac_f32_16x16x64_bf16 v[124:127], v[100:103], a[184:191], v24
 s_waitcnt lgkmcnt(3)
 v_smfmac_f32_16x16x64_bf16 v[120:123], v[104:107], a[192:199], v24
 v_smfmac_f32_16x16x64_bf16 v[124:127], v[104:107], a[200:207], v24
 s_waitcnt lgkmcnt(2)
 v_smfmac_f32_16x16x64_bf16 v[120:123], v[108:111], a[208:215], v24
 v_smfmac_f32_16x16x64_bf16 v[124:127], v[108:111], a[216:223], v24
 s_waitcnt lgkmcnt(1)
 v_smfmac_f32_16x16x64_bf16 v[120:123], v[112:115], a[224:231], v24
 v_smfmac_f32_16x16x64_bf16 v[124:127], v[112:115], a[232:239], v24
 s_waitcnt lgkmcnt(0)
 v_smfmac_f32_16x16x64_bf16 v[120:123], v[116:119], a[240:247], v24
 v_smfmac_f32_16x16x64_bf16 v[124:127], v[116:119], a[248:255], v24
 s_nop 6
 v_cvt_pk_bf16_f32 v48, v120, v121
 v_cvt_pk_bf16_f32 v49, v122, v123
 v_cvt_pk_bf16_f32 v50, v124, v125
 v_cvt_pk_bf16_f32 v51, v126, v127
 s_nop 1
 v_mfma_f32_16x16x32_bf16 v[128:131], v[48:51], v[28:31], 0
 s_nop 7
 v_cvt_pk_bf16_f32 v52, v128, v129
 v_cvt_pk_bf16_f32 v53, v130, v131
 v_min_u32 v52, -2, v52
 buffer_store_dwordx2 v[52:53], v12, s[4:7], s26 offen sc1
L_proj_pub_185:
 v_xor_b32 v20, 0x4000, v20
 v_xor_b32 v21, 0x4000, v21
 v_xor_b32 v22, 0x4000, v22
 v_xor_b32 v23, 0x4000, v23
 s_cmp_ge_i32 s64, 62
 s_cbranch_scc1 L_proj_end_183
L_proj_x_182:
 s_add_u32 s65, s64, 3
 s_min_u32 s66, s65, 63
 s_lshl_b32 s81, s66, 16
 s_and_b32 s65, s65, 1
 s_lshl_b32 s65, s65, 16
 s_lshl_b32 s80, s62, 10
 s_add_u32 s80, s80, s65
 s_add_u32 s82, s64, 5
 s_min_u32 s82, s82, 63
 s_lshl_b32 s82, s82, 16
 ds_read_b128 v[136:139], v56 offset:0
 ds_read_b128 v[140:143], v56 offset:2048
 ds_read_b128 v[144:147], v57 offset:0
 ds_read_b128 v[148:151], v57 offset:2048
 ds_read_b128 v[152:155], v56 offset:4096
 ds_read_b128 v[156:159], v56 offset:6144
 s_waitcnt lgkmcnt(4)
 v_mfma_f32_16x16x32_bf16 v[120:123], a[0:3], v[136:139], 0
 ds_read_b128 v[160:163], v57 offset:4096
 v_mfma_f32_16x16x32_bf16 v[124:127], a[8:11], v[136:139], 0
 v_mfma_f32_16x16x32_bf16 v[128:131], a[0:3], v[140:143], 0
 ds_read_b128 v[164:167], v57 offset:6144
 v_mfma_f32_16x16x32_bf16 v[132:135], a[8:11], v[140:143], 0
 s_waitcnt lgkmcnt(4)
 v_mfma_f32_16x16x32_bf16 v[120:123], a[4:7], v[144:147], v[120:123]
 ds_read_b128 v[136:139], v56 offset:8192
 v_mfma_f32_16x16x32_bf16 v[124:127], a[12:15], v[144:147], v[124:127]
 buffer_load_dword v65, v64, s[8:11], s82 offen
 v_mfma_f32_16x16x32_bf16 v[128:131], a[4:7], v[148:151], v[128:131]
 ds_read_b128 v[140:143], v56 offset:10240
 v_mfma_f32_16x16x32_bf16 v[132:135], a[12:15], v[148:151], v[132:135]
 s_waitcnt lgkmcnt(4)
 v_mfma_f32_16x16x32_bf16 v[120:123], a[16:19], v[152:155], v[120:123]
 ds_read_b128 v[144:147], v57 offset:8192
 v_mfma_f32_16x16x32_bf16 v[124:127], a[24:27], v[152:155], v[124:127]
 v_mfma_f32_16x16x32_bf16 v[128:131], a[16:19], v[156:159], v[128:131]
 ds_read_b128 v[148:151], v57 offset:10240
 v_mfma_f32_16x16x32_bf16 v[132:135], a[24:27], v[156:159], v[132:135]
 s_waitcnt lgkmcnt(4)
 v_mfma_f32_16x16x32_bf16 v[120:123], a[20:23], v[160:163], v[120:123]
 ds_read_b128 v[152:155], v56 offset:12288
 v_mfma_f32_16x16x32_bf16 v[124:127], a[28:31], v[160:163], v[124:127]
 v_mfma_f32_16x16x32_bf16 v[128:131], a[20:23], v[164:167], v[128:131]
 ds_read_b128 v[156:159], v56 offset:14336
 v_mfma_f32_16x16x32_bf16 v[132:135], a[28:31], v[164:167], v[132:135]
 s_waitcnt lgkmcnt(4)
 v_mfma_f32_16x16x32_bf16 v[120:123], a[32:35], v[136:139], v[120:123]
 ds_read_b128 v[160:163], v57 offset:12288
 v_mfma_f32_16x16x32_bf16 v[124:127], a[40:43], v[136:139], v[124:127]
 buffer_store_dwordx2 v[16:17], v12, s[4:7], s25 offen sc1
 v_mfma_f32_16x16x32_bf16 v[128:131], a[32:35], v[140:143], v[128:131]
 ds_read_b128 v[164:167], v57 offset:14336
 v_mfma_f32_16x16x32_bf16 v[132:135], a[40:43], v[140:143], v[132:135]
 s_waitcnt lgkmcnt(4)
 v_mfma_f32_16x16x32_bf16 v[120:123], a[36:39], v[144:147], v[120:123]
 ds_read_b128 v[136:139], v58 offset:0
 v_mfma_f32_16x16x32_bf16 v[124:127], a[44:47], v[144:147], v[124:127]
 v_mfma_f32_16x16x32_bf16 v[128:131], a[36:39], v[148:151], v[128:131]
 ds_read_b128 v[140:143], v58 offset:2048
 v_mfma_f32_16x16x32_bf16 v[132:135], a[44:47], v[148:151], v[132:135]
 s_waitcnt lgkmcnt(4)
 v_mfma_f32_16x16x32_bf16 v[120:123], a[48:51], v[152:155], v[120:123]
 ds_read_b128 v[144:147], v59 offset:0
 v_mfma_f32_16x16x32_bf16 v[124:127], a[56:59], v[152:155], v[124:127]
 v_mfma_f32_16x16x32_bf16 v[128:131], a[48:51], v[156:159], v[128:131]
 ds_read_b128 v[148:151], v59 offset:2048
 v_mfma_f32_16x16x32_bf16 v[132:135], a[56:59], v[156:159], v[132:135]
 s_waitcnt lgkmcnt(4)
 s_xor_b32 s67, s81, 0
 v_mfma_f32_16x16x32_bf16 v[120:123], a[52:55], v[160:163], v[120:123]
 ds_read_b128 v[152:155], v58 offset:4096
 v_mfma_f32_16x16x32_bf16 v[124:127], a[60:63], v[160:163], v[124:127]
 s_xor_b32 m0, s80, 0
 v_mfma_f32_16x16x32_bf16 v[128:131], a[52:55], v[164:167], v[128:131]
 ds_read_b128 v[156:159], v58 offset:6144
 v_mfma_f32_16x16x32_bf16 v[132:135], a[60:63], v[164:167], v[132:135]
 buffer_load_dwordx4 v55, s[8:11], s67 offen lds
 s_waitcnt lgkmcnt(4)
 v_mfma_f32_16x16x32_bf16 v[120:123], a[64:67], v[136:139], v[120:123]
 ds_read_b128 v[160:163], v59 offset:4096
 v_mfma_f32_16x16x32_bf16 v[124:127], a[72:75], v[136:139], v[124:127]
 s_xor_b32 s67, s81, 128
 v_mfma_f32_16x16x32_bf16 v[128:131], a[64:67], v[140:143], v[128:131]
 ds_read_b128 v[164:167], v59 offset:6144
 v_mfma_f32_16x16x32_bf16 v[132:135], a[72:75], v[140:143], v[132:135]
 s_waitcnt lgkmcnt(4)
 s_xor_b32 m0, s80, 4096
 v_mfma_f32_16x16x32_bf16 v[120:123], a[68:71], v[144:147], v[120:123]
 ds_read_b128 v[136:139], v58 offset:8192
 v_mfma_f32_16x16x32_bf16 v[124:127], a[76:79], v[144:147], v[124:127]
 buffer_load_dwordx4 v55, s[8:11], s67 offen lds
 v_mfma_f32_16x16x32_bf16 v[128:131], a[68:71], v[148:151], v[128:131]
 ds_read_b128 v[140:143], v58 offset:10240
 v_mfma_f32_16x16x32_bf16 v[132:135], a[76:79], v[148:151], v[132:135]
 s_waitcnt lgkmcnt(4)
 s_xor_b32 s67, s81, 256
 v_mfma_f32_16x16x32_bf16 v[120:123], a[80:83], v[152:155], v[120:123]
 ds_read_b128 v[144:147], v59 offset:8192
 v_mfma_f32_16x16x32_bf16 v[124:127], a[88:91], v[152:155], v[124:127]
 s_xor_b32 m0, s80, 8192
 v_mfma_f32_16x16x32_bf16 v[128:131], a[80:83], v[156:159], v[128:131]
 ds_read_b128 v[148:151], v59 offset:10240
 v_mfma_f32_16x16x32_bf16 v[132:135], a[88:91], v[156:159], v[132:135]
 buffer_load_dwordx4 v55, s[8:11], s67 offen lds
 s_waitcnt lgkmcnt(4)
 v_mfma_f32_16x16x32_bf16 v[120:123], a[84:87], v[160:163], v[120:123]
 ds_read_b128 v[152:155], v58 offset:12288
 v_mfma_f32_16x16x32_bf16 v[124:127], a[92:95], v[160:163], v[124:127]
 s_xor_b32 s67, s81, 384
 v_mfma_f32_16x16x32_bf16 v[128:131], a[84:87], v[164:167], v[128:131]
 ds_read_b128 v[156:159], v58 offset:14336
 v_mfma_f32_16x16x32_bf16 v[132:135], a[92:95], v[164:167], v[132:135]
 s_waitcnt lgkmcnt(4)
 s_xor_b32 m0, s80, 12288
 v_mfma_f32_16x16x32_bf16 v[120:123], a[96:99], v[136:139], v[120:123]
 ds_read_b128 v[160:163], v59 offset:12288
 v_mfma_f32_16x16x32_bf16 v[124:127], a[104:107], v[136:139], v[124:127]
 buffer_load_dwordx4 v55, s[8:11], s67 offen lds
 v_mfma_f32_16x16x32_bf16 v[128:131], a[96:99], v[140:143], v[128:131]
 ds_read_b128 v[164:167], v59 offset:14336
 v_mfma_f32_16x16x32_bf16 v[132:135], a[104:107], v[140:143], v[132:135]
 s_waitcnt lgkmcnt(4)
 s_xor_b32 s67, s81, 512
 v_mfma_f32_16x16x32_bf16 v[120:123], a[100:103], v[144:147], v[120:123]
 ds_read_b128 v[136:139], v60 offset:0
 v_mfma_f32_16x16x32_bf16 v[124:127], a[108:111], v[144:147], v[124:127]
 s_xor_b32 m0, s80, 16384
 v_mfma_f32_16x16x32_bf16 v[128:131], a[100:103], v[148:151], v[128:131]
 ds_read_b128 v[140:143], v60 offset:2048
 v_mfma_f32_16x16x32_bf16 v[132:135], a[108:111], v[148:151], v[132:135]
 buffer_load_dwordx4 v55, s[8:11], s67 offen lds
 s_waitcnt lgkmcnt(4)
 v_mfma_f32_16x16x32_bf16 v[120:123], a[112:115], v[152:155], v[120:123]
 ds_read_b128 v[144:147], v61 offset:0
 v_mfma_f32_16x16x32_bf16 v[124:127], a[120:123], v[152:155], v[124:127]
 s_xor_b32 s67, s81, 640
 v_mfma_f32_16x16x32_bf16 v[128:131], a[112:115], v[156:159], v[128:131]
 ds_read_b128 v[148:151], v61 offset:2048
 v_mfma_f32_16x16x32_bf16 v[132:135], a[120:123], v[156:159], v[132:135]
 s_waitcnt lgkmcnt(4)
 s_xor_b32 m0, s80, 20480
 v_mfma_f32_16x16x32_bf16 v[120:123], a[116:119], v[160:163], v[120:123]
 ds_read_b128 v[152:155], v60 offset:4096
 v_mfma_f32_16x16x32_bf16 v[124:127], a[124:127], v[160:163], v[124:127]
 buffer_load_dwordx4 v55, s[8:11], s67 offen lds
 v_mfma_f32_16x16x32_bf16 v[128:131], a[116:119], v[164:167], v[128:131]
 ds_read_b128 v[156:159], v60 offset:6144
 v_mfma_f32_16x16x32_bf16 v[132:135], a[124:127], v[164:167], v[132:135]
 s_waitcnt lgkmcnt(4)
 s_xor_b32 s67, s81, 768
 v_mfma_f32_16x16x32_bf16 v[120:123], a[128:131], v[136:139], v[120:123]
 ds_read_b128 v[160:163], v61 offset:4096
 v_mfma_f32_16x16x32_bf16 v[124:127], a[136:139], v[136:139], v[124:127]
 s_xor_b32 m0, s80, 24576
 v_mfma_f32_16x16x32_bf16 v[128:131], a[128:131], v[140:143], v[128:131]
 ds_read_b128 v[164:167], v61 offset:6144
 v_mfma_f32_16x16x32_bf16 v[132:135], a[136:139], v[140:143], v[132:135]
 buffer_load_dwordx4 v55, s[8:11], s67 offen lds
 s_waitcnt lgkmcnt(4)
 v_mfma_f32_16x16x32_bf16 v[120:123], a[132:135], v[144:147], v[120:123]
 ds_read_b128 v[136:139], v60 offset:8192
 v_mfma_f32_16x16x32_bf16 v[124:127], a[140:143], v[144:147], v[124:127]
 s_xor_b32 s67, s81, 896
 v_mfma_f32_16x16x32_bf16 v[128:131], a[132:135], v[148:151], v[128:131]
 ds_read_b128 v[140:143], v60 offset:10240
 v_mfma_f32_16x16x32_bf16 v[132:135], a[140:143], v[148:151], v[132:135]
 s_waitcnt lgkmcnt(4)
 s_xor_b32 m0, s80, 28672
 v_mfma_f32_16x16x32_bf16 v[120:123], a[144:147], v[152:155], v[120:123]
 ds_read_b128 v[144:147], v61 offset:8192
 v_mfma_f32_16x16x32_bf16 v[124:127], a[152:155], v[152:155], v[124:127]
 buffer_load_dwordx4 v55, s[8:11], s67 offen lds
 v_mfma_f32_16x16x32_bf16 v[128:131], a[144:147], v[156:159], v[128:131]
 ds_read_b128 v[148:151], v61 offset:10240
 v_mfma_f32_16x16x32_bf16 v[132:135], a[152:155], v[156:159], v[132:135]
 s_waitcnt lgkmcnt(4)
 s_xor_b32 s67, s81, 1024
 v_mfma_f32_16x16x32_bf16 v[120:123], a[148:151], v[160:163], v[120:123]
 ds_read_b128 v[152:155], v60 offset:12288
 v_mfma_f32_16x16x32_bf16 v[124:127], a[156:159], v[160:163], v[124:127]
 s_xor_b32 m0, s80, 32768
 v_mfma_f32_16x16x32_bf16 v[128:131], a[148:151], v[164:167], v[128:131]
 ds_read_b128 v[156:159], v60 offset:14336
 v_mfma_f32_16x16x32_bf16 v[132:135], a[156:159], v[164:167], v[132:135]
 buffer_load_dwordx4 v55, s[8:11], s67 offen lds
 s_waitcnt lgkmcnt(4)
 v_mfma_f32_16x16x32_bf16 v[120:123], a[160:163], v[136:139], v[120:123]
 ds_read_b128 v[160:163], v61 offset:12288
 v_mfma_f32_16x16x32_bf16 v[124:127], a[168:171], v[136:139], v[124:127]
 s_xor_b32 s67, s81, 1152
 v_mfma_f32_16x16x32_bf16 v[128:131], a[160:163], v[140:143], v[128:131]
 ds_read_b128 v[164:167], v61 offset:14336
 v_mfma_f32_16x16x32_bf16 v[132:135], a[168:171], v[140:143], v[132:135]
 s_waitcnt lgkmcnt(4)
 s_xor_b32 m0, s80, 36864
 v_mfma_f32_16x16x32_bf16 v[120:123], a[164:167], v[144:147], v[120:123]
 ds_read_b128 v[136:139], v62 offset:0
 v_mfma_f32_16x16x32_bf16 v[124:127], a[172:175], v[144:147], v[124:127]
 buffer_load_dwordx4 v55, s[8:11], s67 offen lds
 v_mfma_f32_16x16x32_bf16 v[128:131], a[164:167], v[148:151], v[128:131]
 ds_read_b128 v[140:143], v62 offset:2048
 v_mfma_f32_16x16x32_bf16 v[132:135], a[172:175], v[148:151], v[132:135]
 s_waitcnt lgkmcnt(4)
 s_xor_b32 s67, s81, 1280
 v_mfma_f32_16x16x32_bf16 v[120:123], a[176:179], v[152:155], v[120:123]
 ds_read_b128 v[144:147], v63 offset:0
 v_mfma_f32_16x16x32_bf16 v[124:127], a[184:187], v[152:155], v[124:127]
 s_xor_b32 m0, s80, 40960
 v_mfma_f32_16x16x32_bf16 v[128:131], a[176:179], v[156:159], v[128:131]
 ds_read_b128 v[148:151], v63 offset:2048
 v_mfma_f32_16x16x32_bf16 v[132:135], a[184:187], v[156:159], v[132:135]
 buffer_load_dwordx4 v55, s[8:11], s67 offen lds
 s_waitcnt lgkmcnt(4)
 v_mfma_f32_16x16x32_bf16 v[120:123], a[180:183], v[160:163], v[120:123]
 ds_read_b128 v[152:155], v62 offset:4096
 v_mfma_f32_16x16x32_bf16 v[124:127], a[188:191], v[160:163], v[124:127]
 s_xor_b32 s67, s81, 1408
 v_mfma_f32_16x16x32_bf16 v[128:131], a[180:183], v[164:167], v[128:131]
 ds_read_b128 v[156:159], v62 offset:6144
 v_mfma_f32_16x16x32_bf16 v[132:135], a[188:191], v[164:167], v[132:135]
 s_waitcnt lgkmcnt(4)
 s_xor_b32 m0, s80, 45056
 v_mfma_f32_16x16x32_bf16 v[120:123], a[192:195], v[136:139], v[120:123]
 ds_read_b128 v[160:163], v63 offset:4096
 v_mfma_f32_16x16x32_bf16 v[124:127], a[200:203], v[136:139], v[124:127]
 buffer_load_dwordx4 v55, s[8:11], s67 offen lds
 v_mfma_f32_16x16x32_bf16 v[128:131], a[192:195], v[140:143], v[128:131]
 ds_read_b128 v[164:167], v63 offset:6144
 v_mfma_f32_16x16x32_bf16 v[132:135], a[200:203], v[140:143], v[132:135]
 s_waitcnt lgkmcnt(4)
 s_xor_b32 s67, s81, 1536
 v_mfma_f32_16x16x32_bf16 v[120:123], a[196:199], v[144:147], v[120:123]
 ds_read_b128 v[136:139], v62 offset:8192
 v_mfma_f32_16x16x32_bf16 v[124:127], a[204:207], v[144:147], v[124:127]
 s_xor_b32 m0, s80, 49152
 v_mfma_f32_16x16x32_bf16 v[128:131], a[196:199], v[148:151], v[128:131]
 ds_read_b128 v[140:143], v62 offset:10240
 v_mfma_f32_16x16x32_bf16 v[132:135], a[204:207], v[148:151], v[132:135]
 buffer_load_dwordx4 v55, s[8:11], s67 offen lds
 s_waitcnt lgkmcnt(4)
 v_mfma_f32_16x16x32_bf16 v[120:123], a[208:211], v[152:155], v[120:123]
 ds_read_b128 v[144:147], v63 offset:8192
 v_mfma_f32_16x16x32_bf16 v[124:127], a[216:219], v[152:155], v[124:127]
 s_xor_b32 s67, s81, 1664
 v_mfma_f32_16x16x32_bf16 v[128:131], a[208:211], v[156:159], v[128:131]
 ds_read_b128 v[148:151], v63 offset:10240
 v_mfma_f32_16x16x32_bf16 v[132:135], a[216:219], v[156:159], v[132:135]
 s_waitcnt lgkmcnt(4)
 s_xor_b32 m0, s80, 53248
 v_mfma_f32_16x16x32_bf16 v[120:123], a[212:215], v[160:163], v[120:123]
 ds_read_b128 v[152:155], v62 offset:12288
 v_mfma_f32_16x16x32_bf16 v[124:127], a[220:223], v[160:163], v[124:127]
 buffer_load_dwordx4 v55, s[8:11], s67 offen lds
 v_mfma_f32_16x16x32_bf16 v[128:131], a[212:215], v[164:167], v[128:131]
 ds_read_b128 v[156:159], v62 offset:14336
 v_mfma_f32_16x16x32_bf16 v[132:135], a[220:223], v[164:167], v[132:135]
 s_waitcnt lgkmcnt(4)
 s_xor_b32 s67, s81, 1792
 v_mfma_f32_16x16x32_bf16 v[120:123], a[224:227], v[136:139], v[120:123]
 ds_read_b128 v[160:163], v63 offset:12288
 v_mfma_f32_16x16x32_bf16 v[124:127], a[232:235], v[136:139], v[124:127]
 s_xor_b32 m0, s80, 57344
 v_mfma_f32_16x16x32_bf16 v[128:131], a[224:227], v[140:143], v[128:131]
 ds_read_b128 v[164:167], v63 offset:14336
 v_mfma_f32_16x16x32_bf16 v[132:135], a[232:235], v[140:143], v[132:135]
 buffer_load_dwordx4 v55, s[8:11], s67 offen lds
 s_waitcnt lgkmcnt(4)
 v_mfma_f32_16x16x32_bf16 v[120:123], a[228:231], v[144:147], v[120:123]
 v_mfma_f32_16x16x32_bf16 v[124:127], a[236:239], v[144:147], v[124:127]
 s_xor_b32 s67, s81, 1920
 v_mfma_f32_16x16x32_bf16 v[128:131], a[228:231], v[148:151], v[128:131]
 v_mfma_f32_16x16x32_bf16 v[132:135], a[236:239], v[148:151], v[132:135]
 s_waitcnt lgkmcnt(2)
 s_xor_b32 m0, s80, 61440
 v_mfma_f32_16x16x32_bf16 v[120:123], a[240:243], v[152:155], v[120:123]
 v_xor_b32 v56, 0x10000, v56
 v_xor_b32 v57, 0x10000, v57
 v_mfma_f32_16x16x32_bf16 v[124:127], a[248:251], v[152:155], v[124:127]
 buffer_load_dwordx4 v55, s[8:11], s67 offen lds
 v_mfma_f32_16x16x32_bf16 v[128:131], a[240:243], v[156:159], v[128:131]
 v_xor_b32 v58, 0x10000, v58
 v_xor_b32 v59, 0x10000, v59
 v_mfma_f32_16x16x32_bf16 v[132:135], a[248:251], v[156:159], v[132:135]
 s_waitcnt lgkmcnt(0)
 v_mfma_f32_16x16x32_bf16 v[120:123], a[244:247], v[160:163], v[120:123]
 v_xor_b32 v60, 0x10000, v60
 v_xor_b32 v61, 0x10000, v61
 v_mfma_f32_16x16x32_bf16 v[124:127], a[252:255], v[160:163], v[124:127]
 v_mfma_f32_16x16x32_bf16 v[128:131], a[244:247], v[164:167], v[128:131]
 v_xor_b32 v62, 0x10000, v62
 v_xor_b32 v63, 0x10000, v63
 v_mfma_f32_16x16x32_bf16 v[132:135], a[252:255], v[164:167], v[132:135]
 s_add_u32 s65, s64, 2
 s_and_b32 s65, s65, 3
 s_lshl_b32 s65, s65, 13
 s_add_u32 s65, s65, s76
 s_add_u32 s66, s65, 4096
 s_nop 0
 v_cvt_pk_bf16_f32 v168, v120, v121
 v_cvt_pk_bf16_f32 v169, v122, v123
 v_cvt_pk_bf16_f32 v170, v124, v125
 v_cvt_pk_bf16_f32 v171, v126, v127
 v_cvt_pk_bf16_f32 v172, v128, v129
 v_cvt_pk_bf16_f32 v173, v130, v131
 v_cvt_pk_bf16_f32 v174, v132, v133
 v_cvt_pk_bf16_f32 v175, v134, v135
 s_cmp_eq_u32 s24, 2
 s_cbranch_scc0 L_proj_noswap_189
 v_swap_b32 v169, v170
 v_swap_b32 v173, v174
L_proj_noswap_189:
 buffer_store_dwordx4 v[168:171], v10, s[4:7], s65 offen sc1
 buffer_store_dwordx4 v[172:175], v10, s[4:7], s66 offen sc1
L_proj_end_183:
 s_add_u32 s64, s64, 1
 s_cmp_lt_i32 s64, 64
 s_cbranch_scc1 L_proj_loop_180
 s_endpgm
L_role_t_1_abort:
 s_endpgm
.p2align 6
L_role_t_1:
 s_sub_u32 s84, s61, 20
 s_and_b32 s77, s84, 3
 s_lshl_b32 s84, s84, 2
 s_add_u32 s84, s84, s62
 s_lshl_b32 s67, s60, 2
 s_add_u32 s66, s77, s67
 s_lshl_b32 s72, s66, 13
 s_add_u32 s72, s72, 0x6200000
 s_add_u32 s73, s72, 262144
 s_lshl_b32 s74, s66, 15
 s_add_u32 s75, s74, 0x100000
 s_mov_b32 s82, 0x3e0293ee
 s_mov_b32 s83, 0x3e0293ee
 s_sub_u32 s69, s61, 20
 s_and_b32 s66, s69, 3
 s_lshr_b32 s24, s69, 2
 s_lshl_b32 s67, s60, 2
 s_add_u32 s66, s66, s67
 s_cmp_eq_u32 s24, 0
 s_cselect_b64 s[12:13], s[40:41], s[42:43]
 s_cmp_eq_u32 s24, 2
 s_cselect_b64 s[12:13], s[44:45], s[12:13]
 s_lshl_b32 s67, s66, 8
 s_add_u32 s12, s12, s67
 s_addc_u32 s13, s13, 0
 s_sub_u32 s14, 0x800000, s67
 s_mov_b32 s15, 0x00020000
 s_lshl_b32 s27, s24, 5
 s_add_u32 s27, s27, s66
 s_lshl_b32 s22, s27, 13
 s_add_u32 s22, s22, 0x6200000
 s_lshl_b32 s23, s60, 16
 s_lshl_b32 s68, s62, 12
 s_add_u32 s23, s23, s68
 s_add_u32 s23, s23, 0x6100000
 v_lshrrev_b32 v6, 4, v0
 v_lshlrev_b32 v7, 2, v6
 v_and_b32 v1, 15, v0
 v_xor_b32 v1, v1, v7
 v_lshlrev_b32 v1, 4, v1
 v_mul_u32_u24 v6, 8192, v6
 v_add_u32 v1, v1, v6
 v_bfe_u32 v6, v0, 2, 2
 v_and_b32 v7, 3, v0
 s_lshl_b32 s65, s62, 2
 v_add_u32 v7, s65, v7
 v_and_b32 v2, 3, v6
 v_lshlrev_b32 v2, 2, v2
 v_xor_b32 v7, v7, v2
 v_lshlrev_b32 v7, 4, v7
 v_lshrrev_b32 v2, 4, v0
 v_lshlrev_b32 v2, 3, v2
 v_add_u32 v2, v2, v6
 v_lshlrev_b32 v2, 8, v2
 v_add_u32 v2, v2, v7
 v_add_u32 v3, 1024, v2
 v_add_u32 v4, 0x10000, v2
 v_add_u32 v5, 0x10000, v3
 s_mul_i32 s20, s62, 524288
 s_lshl_b32 s21, s62, 14
 s_mov_b32 s32, s38
 s_mov_b32 s33, s39
 s_mov_b32 s34, 0x4000
 s_mov_b32 s35, 0x00020000
 s_mov_b32 s85, 0x6600000
 s_lshl_b32 s66, s84, 9
 s_lshl_b32 s67, s60, 16
 s_add_u32 s86, s66, s67
 s_add_u32 s86, s86, 0x6100000
 s_lshl_b32 s87, s60, 12
 s_add_u32 s87, s87, 0x6500000
 v_mov_b32 v78, -1
 v_mov_b32 v79, -1
 s_and_b32 s66, s84, 15
 s_lshl_b32 s66, s66, 9
 s_lshr_b32 s67, s84, 4
 s_lshl_b32 s67, s67, 14
 s_add_u32 s66, s66, s67
 s_lshl_b32 s67, s60, 15
 s_add_u32 s66, s66, s67
 v_and_b32 v56, 31, v0
 v_lshlrev_b32 v56, 4, v56
 v_add_u32 v56, s66, v56
 v_lshrrev_b32 v57, 5, v0
 v_lshlrev_b32 v57, 15, v57
 v_xor_b32 v60, v56, v57
 v_xor_b32 v61, 0x10000, v60
 v_xor_b32 v62, 0x20000, v60
 v_xor_b32 v63, 0x30000, v60
 v_and_b32 v56, 31, v0
 v_and_b32 v65, 7, v0
 v_lshlrev_b32 v65, 7, v65
 v_lshlrev_b32 v56, 4, v56
 v_lshrrev_b32 v57, 5, v0
 v_lshl_add_u32 v64, v57, 3, v56
 s_add_u32 s65, s86, 16384
 buffer_store_dwordx2 v[78:79], v64, s[4:7], s65 offen sc1
 s_add_u32 s65, s86, 32768
 buffer_store_dwordx2 v[78:79], v64, s[4:7], s65 offen sc1
 s_add_u32 s65, s86, 49152
 buffer_store_dwordx2 v[78:79], v64, s[4:7], s65 offen sc1
 v_and_b32 v56, 7, v0
 v_lshlrev_b32 v56, 11, v56
 v_bfe_u32 v57, v0, 4, 1
 v_lshl_add_u32 v56, v57, 5, v56
 v_lshrrev_b32 v57, 5, v0
 v_lshl_add_u32 v56, v57, 4, v56
 v_bfe_u32 v57, v0, 3, 1
 v_lshl_add_u32 v56, v57, 2, v56
 s_lshl_b32 s65, s84, 6
 buffer_load_dword v76, v56, s[32:35], s65 offen
 buffer_load_dword v77, v56, s[32:35], s65 offen offset:8
 v_and_b32 v57, 1, v0
 v_lshlrev_b32 v57, 4, v57
 v_mov_b32 v58, 0x3f80
 v_lshlrev_b32 v57, v57, v58
 v_bfe_u32 v56, v0, 1, 1
 v_bfe_u32 v58, v0, 4, 1
 v_xor_b32 v56, v56, v58
 v_bfe_u32 v58, v0, 2, 1
 v_lshl_add_u32 v56, v56, 1, v58
 v_bfe_u32 v58, v0, 3, 1
 v_lshl_add_u32 v56, v56, 1, v58
 v_cmp_eq_u32 vcc, 0, v56
 s_nop 1
 v_cndmask_b32 v68, 0, v57, vcc
 v_cmp_eq_u32 vcc, 1, v56
 s_nop 1
 v_cndmask_b32 v69, 0, v57, vcc
 v_cmp_eq_u32 vcc, 2, v56
 s_nop 1
 v_cndmask_b32 v70, 0, v57, vcc
 v_cmp_eq_u32 vcc, 3, v56
 s_nop 1
 v_cndmask_b32 v71, 0, v57, vcc
 v_min_u32 v66, 1, v0
 v_lshlrev_b32 v66, 28, v66
 v_mov_b32 v186, 0
 v_lshlrev_b32 v84, 4, v0
 v_lshrrev_b32 v80, 4, v0
 v_lshlrev_b32 v80, 7, v80
 v_and_b32 v81, 7, v0
 v_lshl_add_u32 v85, v81, 4, v80
 v_bfe_u32 v80, v0, 3, 1
 v_lshl_add_u32 v86, v80, 18, v85
 v_mov_b32 v92, -1
 v_mov_b32 v93, -1
 v_mov_b32 v94, -1
 v_mov_b32 v95, -1
 s_lshl_b32 s65, s60, 15
 s_lshl_b32 s66, s84, 10
 s_add_u32 s65, s65, s66
 s_add_u32 s66, s65, 0x6200000
 buffer_store_dwordx4 v[92:95], v84, s[4:7], s66 offen sc1
 s_add_u32 s66, s65, 0x6240000
 buffer_store_dwordx4 v[92:95], v84, s[4:7], s66 offen sc1
 s_add_u32 s66, s65, 0x6280000
 buffer_store_dwordx4 v[92:95], v84, s[4:7], s66 offen sc1
 s_add_u32 s66, s65, 0x6600000
 buffer_store_dwordx4 v[92:95], v84, s[4:7], s66 offen sc1
 s_add_u32 s66, s65, 0x6640000
 buffer_store_dwordx4 v[92:95], v84, s[4:7], s66 offen sc1
 s_cmp_eq_u32 s84, 18
 s_cselect_b32 s66, 0, 0x10000000
 v_or_b32 v187, s66, v66
 v_mov_b32 v188, 0
 s_lshl_b32 s30, s60, 7
 s_add_u32 s30, s30, 0x5000000
 buffer_store_dword v188, v187, s[4:7], s30 offen sc1
 s_lshr_b32 s66, s84, 2
 s_and_b32 s66, s66, 3
 s_lshl_b32 s67, s60, 2
 s_add_u32 s66, s66, s67
 s_lshl_b32 s66, s66, 5
 s_add_u32 s66, s66, s62
 s_lshl_b32 s66, s66, 2
 s_add_u32 s66, s66, 0x5010000
 buffer_store_dword v188, v66, s[4:7], s66 offen sc1
 s_lshr_b32 s65, s65, 3
 s_add_u32 s66, s65, 0x6500000
 buffer_store_dword v92, v66, s[4:7], s66 offen sc1
 s_cmp_lt_u32 s61, 24
 s_cbranch_scc0 L_t_xw_190
 v_bfe_u32 v80, v0, 1, 2
 v_lshlrev_b32 v80, 2, v80
 v_bfe_u32 v81, v0, 3, 1
 v_lshl_add_u32 v80, v81, 1, v80
 v_and_b32 v81, 1, v0
 v_add_u32 v80, v80, v81
 v_lshlrev_b32 v80, 4, v80
 v_bfe_u32 v81, v0, 4, 1
 v_lshl_add_u32 v80, v81, 3, v80
 v_lshrrev_b32 v81, 5, v0
 v_lshl_add_u32 v82, v81, 8, v80
 s_lshl_b32 s65, s77, 9
 v_add_u32 v87, s65, v82
 s_lshr_b32 s65, s77, 1
 s_lshl_b32 s65, s65, 9
 s_and_b32 s66, s77, 1
 s_lshl_b32 s66, s66, 2
 s_add_u32 s65, s65, s66
 s_add_u32 s65, s65, 2048
 v_add_u32 v88, s65, v80
 v_xor_b32 v81, 1, v81
 v_lshl_add_u32 v88, v81, 28, v88
 v_mov_b32 v80, 0xff800000
 v_cmp_gt_u32 vcc, 32, v0
 s_nop 1
 v_cndmask_b32 v176, 0, v80, vcc
 v_cndmask_b32 v177, 0, v80, vcc
 v_cndmask_b32 v178, 0, v80, vcc
 v_cndmask_b32 v179, 0, v80, vcc
 s_lshl_b32 s76, s60, 14
 s_add_u32 s76, s76, 0x6300000
 s_cmp_eq_u32 s62, 0
 s_cbranch_scc0 L_t_join_191
 s_add_u32 s65, s76, 0
 buffer_store_dwordx2 v[92:93], v87, s[4:7], s65 offen sc1
 buffer_store_dword v92, v88, s[4:7], s65 offen sc1
 buffer_store_dword v92, v88, s[4:7], s65 offen offset:256 sc1
 s_add_u32 s65, s76, 4096
 buffer_store_dwordx2 v[92:93], v87, s[4:7], s65 offen sc1
 buffer_store_dword v92, v88, s[4:7], s65 offen sc1
 buffer_store_dword v92, v88, s[4:7], s65 offen offset:256 sc1
 s_add_u32 s65, s76, 8192
 buffer_store_dwordx2 v[92:93], v87, s[4:7], s65 offen sc1
 buffer_store_dword v92, v88, s[4:7], s65 offen sc1
 buffer_store_dword v92, v88, s[4:7], s65 offen offset:256 sc1
 s_add_u32 s65, s76, 12288
 buffer_store_dwordx2 v[92:93], v87, s[4:7], s65 offen sc1
 buffer_store_dword v92, v88, s[4:7], s65 offen sc1
 buffer_store_dword v92, v88, s[4:7], s65 offen offset:256 sc1
 s_branch L_t_join_191
L_t_xw_190:
 s_and_b32 s67, s62, 1
 s_mul_i32 s68, s67, 6144
 s_lshl_b32 s65, s77, 10
 s_add_u32 s65, s65, s68
 v_add_u32 v87, s65, v84
 s_lshr_b32 s65, s77, 1
 s_lshl_b32 s65, s65, 10
 s_and_b32 s66, s77, 1
 s_lshl_b32 s66, s66, 3
 s_add_u32 s65, s65, s66
 s_add_u32 s65, s65, s68
 s_add_u32 s65, s65, 4096
 v_add_u32 v88, s65, v84
 s_lshl_b32 s65, s67, 4
 v_and_b32 v80, 15, v0
 v_add_u32 v80, s65, v80
 v_lshrrev_b32 v81, 4, v0
 v_lshlrev_b32 v81, 2, v81
 v_sub_u32 v186, v80, v81
 v_mov_b32 v185, 0xd028965f
 s_lshl_b32 s67, s67, 12
 s_add_u32 s74, s74, s67
 s_lshl_b32 s76, s60, 16
 s_add_u32 s76, s76, 0x6400000
 s_cmp_lt_u32 s62, 2
 s_cbranch_scc0 L_t_join_191
 s_add_u32 s65, s76, 0
 buffer_store_dwordx4 v[92:95], v87, s[4:7], s65 offen sc1
 buffer_store_dwordx2 v[92:93], v88, s[4:7], s65 offen sc1
 s_add_u32 s65, s76, 16384
 buffer_store_dwordx4 v[92:95], v87, s[4:7], s65 offen sc1
 buffer_store_dwordx2 v[92:93], v88, s[4:7], s65 offen sc1
 s_add_u32 s65, s76, 32768
 buffer_store_dwordx4 v[92:95], v87, s[4:7], s65 offen sc1
 buffer_store_dwordx2 v[92:93], v88, s[4:7], s65 offen sc1
 s_add_u32 s65, s76, 49152
 buffer_store_dwordx4 v[92:95], v87, s[4:7], s65 offen sc1
 buffer_store_dwordx2 v[92:93], v88, s[4:7], s65 offen sc1
L_t_join_191:
 s_waitcnt vmcnt(7)
 v_min_u32 v76, -2, v76
 buffer_store_dwordx2 v[76:77], v64, s[4:7], s86 offen sc1
 v_lshlrev_b32 v191, 4, v0
 s_cmp_eq_u32 s24, 2
 s_cselect_b64 vcc, -1, 0
 v_and_b32 v6, 15, v0
 v_lshrrev_b32 v7, 5, v0
 v_lshl_add_u32 v6, v7, 4, v6
 v_lshlrev_b32 v6, 4, v6
 v_bfe_u32 v7, v0, 4, 1
 v_lshl_add_u32 v189, v7, 3, v6
 v_lshrrev_b32 v6, 4, v0
 v_lshlrev_b32 v6, 7, v6
 v_and_b32 v7, 7, v0
 v_lshl_add_u32 v6, v7, 4, v6
 v_bfe_u32 v7, v0, 3, 1
 v_lshl_add_u32 v190, v7, 3, v6
 v_cndmask_b32 v189, v190, v189, vcc
 s_lshl_b32 s68, s62, 9
 v_add_u32 v192, s68, v189
 v_xor_b32 v7, 1, v7
 v_cndmask_b32 v7, v7, 0, vcc
 v_lshl_add_u32 v193, v7, 28, v192
 v_mov_b32 v196, -1
 v_mov_b32 v197, -1
 v_mov_b32 v198, -1
 v_mov_b32 v199, -1
 s_add_u32 s68, s62, 0
 s_and_b32 s68, s68, 3
 s_lshl_b32 s69, s68, 12
 s_add_u32 s69, s69, 131072
 v_add_u32 v200, s69, v191
 s_add_u32 s68, s62, 1
 s_and_b32 s68, s68, 3
 s_lshl_b32 s69, s68, 12
 s_add_u32 s69, s69, 131072
 v_add_u32 v201, s69, v191
 s_add_u32 s68, s62, 2
 s_and_b32 s68, s68, 3
 s_lshl_b32 s69, s68, 12
 s_add_u32 s69, s69, 131072
 v_add_u32 v202, s69, v191
 s_add_u32 s68, s62, 3
 s_and_b32 s68, s68, 3
 s_lshl_b32 s69, s68, 12
 s_add_u32 s69, s69, 131072
 v_add_u32 v203, s69, v191
 v_and_b32 v6, 8, v0
 v_cmp_ne_u32 vcc, 0, v6
 v_mov_b32 v204, 0x44444444
 v_mov_b32 v6, 0xeeeeeeee
 s_nop 1
 v_cndmask_b32 v204, v204, v6, vcc
 v_and_b32 v7, 1, v0
 v_lshlrev_b32 v7, 4, v7
 v_mov_b32 v189, 0x3f80
 v_lshlrev_b32 v7, v7, v189
 v_bfe_u32 v6, v0, 3, 1
 v_bfe_u32 v189, v0, 1, 1
 v_lshl_add_u32 v6, v6, 1, v189
 v_bfe_u32 v189, v0, 4, 1
 v_bfe_u32 v190, v0, 2, 1
 v_xor_b32 v189, v189, v190
 v_lshl_add_u32 v6, v189, 2, v6
 v_cmp_eq_u32 vcc, 0, v6
 s_nop 1
 v_cndmask_b32 v208, 0, v7, vcc
 v_cmp_eq_u32 vcc, 1, v6
 s_nop 1
 v_cndmask_b32 v209, 0, v7, vcc
 v_cmp_eq_u32 vcc, 2, v6
 s_nop 1
 v_cndmask_b32 v210, 0, v7, vcc
 v_cmp_eq_u32 vcc, 3, v6
 s_nop 1
 v_cndmask_b32 v211, 0, v7, vcc
 v_mov_b32 v228, 0
 v_mov_b32 v229, 0
 v_mov_b32 v230, 0
 v_mov_b32 v231, 0
 s_or_b32 s65, s62, s101
 s_cbranch_scc1 L_clm_192
 s_waitcnt lgkmcnt(0)
 s_bitcmp1_b32 s3, s61
 s_cbranch_scc0 L_clm_192
 s_mov_b32 s66, 1
 s_atomic_or s66, s[56:57], 36
 s_waitcnt lgkmcnt(0)
L_clm_192:
 s_waitcnt vmcnt(0)
 s_barrier
 s_add_u32 m0, s21, 0
 s_add_u32 s65, s20, 4194304
 buffer_load_dwordx4 v1, s[12:15], s65 offen nt lds
 s_add_u32 m0, s21, 1024
 s_add_u32 s65, s20, 4227072
 buffer_load_dwordx4 v1, s[12:15], s65 offen nt lds
 s_add_u32 m0, s21, 2048
 s_add_u32 s65, s20, 4259840
 buffer_load_dwordx4 v1, s[12:15], s65 offen nt lds
 s_add_u32 m0, s21, 3072
 s_add_u32 s65, s20, 4292608
 buffer_load_dwordx4 v1, s[12:15], s65 offen nt lds
 s_add_u32 m0, s21, 4096
 s_add_u32 s65, s20, 4325376
 buffer_load_dwordx4 v1, s[12:15], s65 offen nt lds
 s_add_u32 m0, s21, 5120
 s_add_u32 s65, s20, 4358144
 buffer_load_dwordx4 v1, s[12:15], s65 offen nt lds
 s_add_u32 m0, s21, 6144
 s_add_u32 s65, s20, 4390912
 buffer_load_dwordx4 v1, s[12:15], s65 offen nt lds
 s_add_u32 m0, s21, 7168
 s_add_u32 s65, s20, 4423680
 buffer_load_dwordx4 v1, s[12:15], s65 offen nt lds
 s_add_u32 m0, s21, 8192
 s_add_u32 s65, s20, 4456448
 buffer_load_dwordx4 v1, s[12:15], s65 offen nt lds
 s_add_u32 m0, s21, 9216
 s_add_u32 s65, s20, 4489216
 buffer_load_dwordx4 v1, s[12:15], s65 offen nt lds
 s_add_u32 m0, s21, 10240
 s_add_u32 s65, s20, 4521984
 buffer_load_dwordx4 v1, s[12:15], s65 offen nt lds
 s_add_u32 m0, s21, 11264
 s_add_u32 s65, s20, 4554752
 buffer_load_dwordx4 v1, s[12:15], s65 offen nt lds
 s_add_u32 m0, s21, 12288
 s_add_u32 s65, s20, 4587520
 buffer_load_dwordx4 v1, s[12:15], s65 offen nt lds
 s_add_u32 m0, s21, 13312
 s_add_u32 s65, s20, 4620288
 buffer_load_dwordx4 v1, s[12:15], s65 offen nt lds
 s_add_u32 m0, s21, 14336
 s_add_u32 s65, s20, 4653056
 buffer_load_dwordx4 v1, s[12:15], s65 offen nt lds
 s_add_u32 m0, s21, 15360
 s_add_u32 s65, s20, 4685824
 buffer_load_dwordx4 v1, s[12:15], s65 offen nt lds
 s_add_u32 m0, s21, 65536
 s_add_u32 s65, s20, 6291456
 buffer_load_dwordx4 v1, s[12:15], s65 offen nt lds
 s_add_u32 m0, s21, 66560
 s_add_u32 s65, s20, 6324224
 buffer_load_dwordx4 v1, s[12:15], s65 offen nt lds
 s_add_u32 m0, s21, 67584
 s_add_u32 s65, s20, 6356992
 buffer_load_dwordx4 v1, s[12:15], s65 offen nt lds
 s_add_u32 m0, s21, 68608
 s_add_u32 s65, s20, 6389760
 buffer_load_dwordx4 v1, s[12:15], s65 offen nt lds
 s_add_u32 m0, s21, 69632
 s_add_u32 s65, s20, 6422528
 buffer_load_dwordx4 v1, s[12:15], s65 offen nt lds
 s_add_u32 m0, s21, 70656
 s_add_u32 s65, s20, 6455296
 buffer_load_dwordx4 v1, s[12:15], s65 offen nt lds
 s_add_u32 m0, s21, 71680
 s_add_u32 s65, s20, 6488064
 buffer_load_dwordx4 v1, s[12:15], s65 offen nt lds
 s_add_u32 m0, s21, 72704
 s_add_u32 s65, s20, 6520832
 buffer_load_dwordx4 v1, s[12:15], s65 offen nt lds
 s_add_u32 m0, s21, 73728
 s_add_u32 s65, s20, 6553600
 buffer_load_dwordx4 v1, s[12:15], s65 offen nt lds
 s_add_u32 m0, s21, 74752
 s_add_u32 s65, s20, 6586368
 buffer_load_dwordx4 v1, s[12:15], s65 offen nt lds
 s_add_u32 m0, s21, 75776
 s_add_u32 s65, s20, 6619136
 buffer_load_dwordx4 v1, s[12:15], s65 offen nt lds
 s_add_u32 m0, s21, 76800
 s_add_u32 s65, s20, 6651904
 buffer_load_dwordx4 v1, s[12:15], s65 offen nt lds
 s_add_u32 m0, s21, 77824
 s_add_u32 s65, s20, 6684672
 buffer_load_dwordx4 v1, s[12:15], s65 offen nt lds
 s_add_u32 m0, s21, 78848
 s_add_u32 s65, s20, 6717440
 buffer_load_dwordx4 v1, s[12:15], s65 offen nt lds
 s_add_u32 m0, s21, 79872
 s_add_u32 s65, s20, 6750208
 buffer_load_dwordx4 v1, s[12:15], s65 offen nt lds
 s_add_u32 m0, s21, 80896
 s_add_u32 s65, s20, 6782976
 buffer_load_dwordx4 v1, s[12:15], s65 offen nt lds
 s_cmp_eq_u32 s62, 0
 s_cbranch_scc0 L_nosig_193
 s_add_u32 s65, s101, 4
 s_mov_b32 s66, 0x1
 s_atomic_add s66, s[56:57], s65
 s_waitcnt lgkmcnt(0)
L_nosig_193:
 s_waitcnt vmcnt(16)
 s_barrier
 s_sub_u32 s68, 6, s62
 s_and_b32 s68, s68, 3
 s_cmp_eq_u32 s68, 0
 s_cbranch_scc0 L_wl_next_195
 ds_read_b64_tr_b16 a[8:9], v2 offset:8
 ds_read_b64_tr_b16 a[10:11], v3 offset:8
 ds_read_b64_tr_b16 a[12:13], v2 offset:8200
 ds_read_b64_tr_b16 a[14:15], v3 offset:8200
 ds_read_b64_tr_b16 a[24:25], v2 offset:16392
 ds_read_b64_tr_b16 a[26:27], v3 offset:16392
 ds_read_b64_tr_b16 a[28:29], v2 offset:24584
 ds_read_b64_tr_b16 a[30:31], v3 offset:24584
 ds_read_b64_tr_b16 a[40:41], v2 offset:32776
 ds_read_b64_tr_b16 a[42:43], v3 offset:32776
 ds_read_b64_tr_b16 a[44:45], v2 offset:40968
 ds_read_b64_tr_b16 a[46:47], v3 offset:40968
 ds_read_b64_tr_b16 a[56:57], v2 offset:49160
 ds_read_b64_tr_b16 a[58:59], v3 offset:49160
 ds_read_b64_tr_b16 a[60:61], v2 offset:57352
 ds_read_b64_tr_b16 a[62:63], v3 offset:57352
 s_waitcnt lgkmcnt(0)
 s_branch L_wl_done_194
L_wl_next_195:
 s_cmp_eq_u32 s68, 1
 s_cbranch_scc0 L_wl_next_196
 ds_read_b64_tr_b16 a[72:73], v2 offset:8
 ds_read_b64_tr_b16 a[74:75], v3 offset:8
 ds_read_b64_tr_b16 a[76:77], v2 offset:8200
 ds_read_b64_tr_b16 a[78:79], v3 offset:8200
 ds_read_b64_tr_b16 a[88:89], v2 offset:16392
 ds_read_b64_tr_b16 a[90:91], v3 offset:16392
 ds_read_b64_tr_b16 a[92:93], v2 offset:24584
 ds_read_b64_tr_b16 a[94:95], v3 offset:24584
 ds_read_b64_tr_b16 a[104:105], v2 offset:32776
 ds_read_b64_tr_b16 a[106:107], v3 offset:32776
 ds_read_b64_tr_b16 a[108:109], v2 offset:40968
 ds_read_b64_tr_b16 a[110:111], v3 offset:40968
 ds_read_b64_tr_b16 a[120:121], v2 offset:49160
 ds_read_b64_tr_b16 a[122:123], v3 offset:49160
 ds_read_b64_tr_b16 a[124:125], v2 offset:57352
 ds_read_b64_tr_b16 a[126:127], v3 offset:57352
 s_waitcnt lgkmcnt(0)
 s_branch L_wl_done_194
L_wl_next_196:
 s_cmp_eq_u32 s68, 2
 s_cbranch_scc0 L_wl_next_197
 ds_read_b64_tr_b16 a[136:137], v2 offset:8
 ds_read_b64_tr_b16 a[138:139], v3 offset:8
 ds_read_b64_tr_b16 a[140:141], v2 offset:8200
 ds_read_b64_tr_b16 a[142:143], v3 offset:8200
 ds_read_b64_tr_b16 a[152:153], v2 offset:16392
 ds_read_b64_tr_b16 a[154:155], v3 offset:16392
 ds_read_b64_tr_b16 a[156:157], v2 offset:24584
 ds_read_b64_tr_b16 a[158:159], v3 offset:24584
 ds_read_b64_tr_b16 a[168:169], v2 offset:32776
 ds_read_b64_tr_b16 a[170:171], v3 offset:32776
 ds_read_b64_tr_b16 a[172:173], v2 offset:40968
 ds_read_b64_tr_b16 a[174:175], v3 offset:40968
 ds_read_b64_tr_b16 a[184:185], v2 offset:49160
 ds_read_b64_tr_b16 a[186:187], v3 offset:49160
 ds_read_b64_tr_b16 a[188:189], v2 offset:57352
 ds_read_b64_tr_b16 a[190:191], v3 offset:57352
 s_waitcnt lgkmcnt(0)
 s_branch L_wl_done_194
L_wl_next_197:
 ds_read_b64_tr_b16 a[200:201], v2 offset:8
 ds_read_b64_tr_b16 a[202:203], v3 offset:8
 ds_read_b64_tr_b16 a[204:205], v2 offset:8200
 ds_read_b64_tr_b16 a[206:207], v3 offset:8200
 ds_read_b64_tr_b16 a[216:217], v2 offset:16392
 ds_read_b64_tr_b16 a[218:219], v3 offset:16392
 ds_read_b64_tr_b16 a[220:221], v2 offset:24584
 ds_read_b64_tr_b16 a[222:223], v3 offset:24584
 ds_read_b64_tr_b16 a[232:233], v2 offset:32776
 ds_read_b64_tr_b16 a[234:235], v3 offset:32776
 ds_read_b64_tr_b16 a[236:237], v2 offset:40968
 ds_read_b64_tr_b16 a[238:239], v3 offset:40968
 ds_read_b64_tr_b16 a[248:249], v2 offset:49160
 ds_read_b64_tr_b16 a[250:251], v3 offset:49160
 ds_read_b64_tr_b16 a[252:253], v2 offset:57352
 ds_read_b64_tr_b16 a[254:255], v3 offset:57352
 s_waitcnt lgkmcnt(0)
L_wl_done_194:
 s_barrier
 s_add_u32 m0, s21, 0
 s_add_u32 s65, s20, 0
 buffer_load_dwordx4 v1, s[12:15], s65 offen nt lds
 s_add_u32 m0, s21, 1024
 s_add_u32 s65, s20, 32768
 buffer_load_dwordx4 v1, s[12:15], s65 offen nt lds
 s_add_u32 m0, s21, 2048
 s_add_u32 s65, s20, 65536
 buffer_load_dwordx4 v1, s[12:15], s65 offen nt lds
 s_add_u32 m0, s21, 3072
 s_add_u32 s65, s20, 98304
 buffer_load_dwordx4 v1, s[12:15], s65 offen nt lds
 s_add_u32 m0, s21, 4096
 s_add_u32 s65, s20, 131072
 buffer_load_dwordx4 v1, s[12:15], s65 offen nt lds
 s_add_u32 m0, s21, 5120
 s_add_u32 s65, s20, 163840
 buffer_load_dwordx4 v1, s[12:15], s65 offen nt lds
 s_add_u32 m0, s21, 6144
 s_add_u32 s65, s20, 196608
 buffer_load_dwordx4 v1, s[12:15], s65 offen nt lds
 s_add_u32 m0, s21, 7168
 s_add_u32 s65, s20, 229376
 buffer_load_dwordx4 v1, s[12:15], s65 offen nt lds
 s_add_u32 m0, s21, 8192
 s_add_u32 s65, s20, 262144
 buffer_load_dwordx4 v1, s[12:15], s65 offen nt lds
 s_add_u32 m0, s21, 9216
 s_add_u32 s65, s20, 294912
 buffer_load_dwordx4 v1, s[12:15], s65 offen nt lds
 s_add_u32 m0, s21, 10240
 s_add_u32 s65, s20, 327680
 buffer_load_dwordx4 v1, s[12:15], s65 offen nt lds
 s_add_u32 m0, s21, 11264
 s_add_u32 s65, s20, 360448
 buffer_load_dwordx4 v1, s[12:15], s65 offen nt lds
 s_add_u32 m0, s21, 12288
 s_add_u32 s65, s20, 393216
 buffer_load_dwordx4 v1, s[12:15], s65 offen nt lds
 s_add_u32 m0, s21, 13312
 s_add_u32 s65, s20, 425984
 buffer_load_dwordx4 v1, s[12:15], s65 offen nt lds
 s_add_u32 m0, s21, 14336
 s_add_u32 s65, s20, 458752
 buffer_load_dwordx4 v1, s[12:15], s65 offen nt lds
 s_add_u32 m0, s21, 15360
 s_add_u32 s65, s20, 491520
 buffer_load_dwordx4 v1, s[12:15], s65 offen nt lds
 s_waitcnt vmcnt(16)
 s_barrier
 s_sub_u32 s68, 7, s62
 s_and_b32 s68, s68, 3
 s_cmp_eq_u32 s68, 0
 s_cbranch_scc0 L_wl_next_200
 ds_read_b64_tr_b16 a[8:9], v4 offset:8
 ds_read_b64_tr_b16 a[10:11], v5 offset:8
 ds_read_b64_tr_b16 a[12:13], v4 offset:8200
 ds_read_b64_tr_b16 a[14:15], v5 offset:8200
 ds_read_b64_tr_b16 a[24:25], v4 offset:16392
 ds_read_b64_tr_b16 a[26:27], v5 offset:16392
 ds_read_b64_tr_b16 a[28:29], v4 offset:24584
 ds_read_b64_tr_b16 a[30:31], v5 offset:24584
 ds_read_b64_tr_b16 a[40:41], v4 offset:32776
 ds_read_b64_tr_b16 a[42:43], v5 offset:32776
 ds_read_b64_tr_b16 a[44:45], v4 offset:40968
 ds_read_b64_tr_b16 a[46:47], v5 offset:40968
 ds_read_b64_tr_b16 a[56:57], v4 offset:49160
 ds_read_b64_tr_b16 a[58:59], v5 offset:49160
 ds_read_b64_tr_b16 a[60:61], v4 offset:57352
 ds_read_b64_tr_b16 a[62:63], v5 offset:57352
 s_waitcnt lgkmcnt(0)
 s_branch L_wl_done_199
L_wl_next_200:
 s_cmp_eq_u32 s68, 1
 s_cbranch_scc0 L_wl_next_201
 ds_read_b64_tr_b16 a[72:73], v4 offset:8
 ds_read_b64_tr_b16 a[74:75], v5 offset:8
 ds_read_b64_tr_b16 a[76:77], v4 offset:8200
 ds_read_b64_tr_b16 a[78:79], v5 offset:8200
 ds_read_b64_tr_b16 a[88:89], v4 offset:16392
 ds_read_b64_tr_b16 a[90:91], v5 offset:16392
 ds_read_b64_tr_b16 a[92:93], v4 offset:24584
 ds_read_b64_tr_b16 a[94:95], v5 offset:24584
 ds_read_b64_tr_b16 a[104:105], v4 offset:32776
 ds_read_b64_tr_b16 a[106:107], v5 offset:32776
 ds_read_b64_tr_b16 a[108:109], v4 offset:40968
 ds_read_b64_tr_b16 a[110:111], v5 offset:40968
 ds_read_b64_tr_b16 a[120:121], v4 offset:49160
 ds_read_b64_tr_b16 a[122:123], v5 offset:49160
 ds_read_b64_tr_b16 a[124:125], v4 offset:57352
 ds_read_b64_tr_b16 a[126:127], v5 offset:57352
 s_waitcnt lgkmcnt(0)
 s_branch L_wl_done_199
L_wl_next_201:
 s_cmp_eq_u32 s68, 2
 s_cbranch_scc0 L_wl_next_202
 ds_read_b64_tr_b16 a[136:137], v4 offset:8
 ds_read_b64_tr_b16 a[138:139], v5 offset:8
 ds_read_b64_tr_b16 a[140:141], v4 offset:8200
 ds_read_b64_tr_b16 a[142:143], v5 offset:8200
 ds_read_b64_tr_b16 a[152:153], v4 offset:16392
 ds_read_b64_tr_b16 a[154:155], v5 offset:16392
 ds_read_b64_tr_b16 a[156:157], v4 offset:24584
 ds_read_b64_tr_b16 a[158:159], v5 offset:24584
 ds_read_b64_tr_b16 a[168:169], v4 offset:32776
 ds_read_b64_tr_b16 a[170:171], v5 offset:32776
 ds_read_b64_tr_b16 a[172:173], v4 offset:40968
 ds_read_b64_tr_b16 a[174:175], v5 offset:40968
 ds_read_b64_tr_b16 a[184:185], v4 offset:49160
 ds_read_b64_tr_b16 a[186:187], v5 offset:49160
 ds_read_b64_tr_b16 a[188:189], v4 offset:57352
 ds_read_b64_tr_b16 a[190:191], v5 offset:57352
 s_waitcnt lgkmcnt(0)
 s_branch L_wl_done_199
L_wl_next_202:
 ds_read_b64_tr_b16 a[200:201], v4 offset:8
 ds_read_b64_tr_b16 a[202:203], v5 offset:8
 ds_read_b64_tr_b16 a[204:205], v4 offset:8200
 ds_read_b64_tr_b16 a[206:207], v5 offset:8200
 ds_read_b64_tr_b16 a[216:217], v4 offset:16392
 ds_read_b64_tr_b16 a[218:219], v5 offset:16392
 ds_read_b64_tr_b16 a[220:221], v4 offset:24584
 ds_read_b64_tr_b16 a[222:223], v5 offset:24584
 ds_read_b64_tr_b16 a[232:233], v4 offset:32776
 ds_read_b64_tr_b16 a[234:235], v5 offset:32776
 ds_read_b64_tr_b16 a[236:237], v4 offset:40968
 ds_read_b64_tr_b16 a[238:239], v5 offset:40968
 ds_read_b64_tr_b16 a[248:249], v4 offset:49160
 ds_read_b64_tr_b16 a[250:251], v5 offset:49160
 ds_read_b64_tr_b16 a[252:253], v4 offset:57352
 ds_read_b64_tr_b16 a[254:255], v5 offset:57352
 s_waitcnt lgkmcnt(0)
L_wl_done_199:
 s_barrier
 s_add_u32 m0, s21, 65536
 s_add_u32 s65, s20, 2097152
 buffer_load_dwordx4 v1, s[12:15], s65 offen nt lds
 s_add_u32 m0, s21, 66560
 s_add_u32 s65, s20, 2129920
 buffer_load_dwordx4 v1, s[12:15], s65 offen nt lds
 s_add_u32 m0, s21, 67584
 s_add_u32 s65, s20, 2162688
 buffer_load_dwordx4 v1, s[12:15], s65 offen nt lds
 s_add_u32 m0, s21, 68608
 s_add_u32 s65, s20, 2195456
 buffer_load_dwordx4 v1, s[12:15], s65 offen nt lds
 s_add_u32 m0, s21, 69632
 s_add_u32 s65, s20, 2228224
 buffer_load_dwordx4 v1, s[12:15], s65 offen nt lds
 s_add_u32 m0, s21, 70656
 s_add_u32 s65, s20, 2260992
 buffer_load_dwordx4 v1, s[12:15], s65 offen nt lds
 s_add_u32 m0, s21, 71680
 s_add_u32 s65, s20, 2293760
 buffer_load_dwordx4 v1, s[12:15], s65 offen nt lds
 s_add_u32 m0, s21, 72704
 s_add_u32 s65, s20, 2326528
 buffer_load_dwordx4 v1, s[12:15], s65 offen nt lds
 s_add_u32 m0, s21, 73728
 s_add_u32 s65, s20, 2359296
 buffer_load_dwordx4 v1, s[12:15], s65 offen nt lds
 s_add_u32 m0, s21, 74752
 s_add_u32 s65, s20, 2392064
 buffer_load_dwordx4 v1, s[12:15], s65 offen nt lds
 s_add_u32 m0, s21, 75776
 s_add_u32 s65, s20, 2424832
 buffer_load_dwordx4 v1, s[12:15], s65 offen nt lds
 s_add_u32 m0, s21, 76800
 s_add_u32 s65, s20, 2457600
 buffer_load_dwordx4 v1, s[12:15], s65 offen nt lds
 s_add_u32 m0, s21, 77824
 s_add_u32 s65, s20, 2490368
 buffer_load_dwordx4 v1, s[12:15], s65 offen nt lds
 s_add_u32 m0, s21, 78848
 s_add_u32 s65, s20, 2523136
 buffer_load_dwordx4 v1, s[12:15], s65 offen nt lds
 s_add_u32 m0, s21, 79872
 s_add_u32 s65, s20, 2555904
 buffer_load_dwordx4 v1, s[12:15], s65 offen nt lds
 s_add_u32 m0, s21, 80896
 s_add_u32 s65, s20, 2588672
 buffer_load_dwordx4 v1, s[12:15], s65 offen nt lds
 s_waitcnt vmcnt(16)
 s_barrier
 s_sub_u32 s68, 4, s62
 s_and_b32 s68, s68, 3
 s_cmp_eq_u32 s68, 0
 s_cbranch_scc0 L_wl_next_205
 ds_read_b64_tr_b16 a[8:9], v2 offset:8
 ds_read_b64_tr_b16 a[10:11], v3 offset:8
 ds_read_b64_tr_b16 a[12:13], v2 offset:8200
 ds_read_b64_tr_b16 a[14:15], v3 offset:8200
 ds_read_b64_tr_b16 a[24:25], v2 offset:16392
 ds_read_b64_tr_b16 a[26:27], v3 offset:16392
 ds_read_b64_tr_b16 a[28:29], v2 offset:24584
 ds_read_b64_tr_b16 a[30:31], v3 offset:24584
 ds_read_b64_tr_b16 a[40:41], v2 offset:32776
 ds_read_b64_tr_b16 a[42:43], v3 offset:32776
 ds_read_b64_tr_b16 a[44:45], v2 offset:40968
 ds_read_b64_tr_b16 a[46:47], v3 offset:40968
 ds_read_b64_tr_b16 a[56:57], v2 offset:49160
 ds_read_b64_tr_b16 a[58:59], v3 offset:49160
 ds_read_b64_tr_b16 a[60:61], v2 offset:57352
 ds_read_b64_tr_b16 a[62:63], v3 offset:57352
 s_waitcnt lgkmcnt(0)
 s_branch L_wl_done_204
L_wl_next_205:
 s_cmp_eq_u32 s68, 1
 s_cbranch_scc0 L_wl_next_206
 ds_read_b64_tr_b16 a[72:73], v2 offset:8
 ds_read_b64_tr_b16 a[74:75], v3 offset:8
 ds_read_b64_tr_b16 a[76:77], v2 offset:8200
 ds_read_b64_tr_b16 a[78:79], v3 offset:8200
 ds_read_b64_tr_b16 a[88:89], v2 offset:16392
 ds_read_b64_tr_b16 a[90:91], v3 offset:16392
 ds_read_b64_tr_b16 a[92:93], v2 offset:24584
 ds_read_b64_tr_b16 a[94:95], v3 offset:24584
 ds_read_b64_tr_b16 a[104:105], v2 offset:32776
 ds_read_b64_tr_b16 a[106:107], v3 offset:32776
 ds_read_b64_tr_b16 a[108:109], v2 offset:40968
 ds_read_b64_tr_b16 a[110:111], v3 offset:40968
 ds_read_b64_tr_b16 a[120:121], v2 offset:49160
 ds_read_b64_tr_b16 a[122:123], v3 offset:49160
 ds_read_b64_tr_b16 a[124:125], v2 offset:57352
 ds_read_b64_tr_b16 a[126:127], v3 offset:57352
 s_waitcnt lgkmcnt(0)
 s_branch L_wl_done_204
L_wl_next_206:
 s_cmp_eq_u32 s68, 2
 s_cbranch_scc0 L_wl_next_207
 ds_read_b64_tr_b16 a[136:137], v2 offset:8
 ds_read_b64_tr_b16 a[138:139], v3 offset:8
 ds_read_b64_tr_b16 a[140:141], v2 offset:8200
 ds_read_b64_tr_b16 a[142:143], v3 offset:8200
 ds_read_b64_tr_b16 a[152:153], v2 offset:16392
 ds_read_b64_tr_b16 a[154:155], v3 offset:16392
 ds_read_b64_tr_b16 a[156:157], v2 offset:24584
 ds_read_b64_tr_b16 a[158:159], v3 offset:24584
 ds_read_b64_tr_b16 a[168:169], v2 offset:32776
 ds_read_b64_tr_b16 a[170:171], v3 offset:32776
 ds_read_b64_tr_b16 a[172:173], v2 offset:40968
 ds_read_b64_tr_b16 a[174:175], v3 offset:40968
 ds_read_b64_tr_b16 a[184:185], v2 offset:49160
 ds_read_b64_tr_b16 a[186:187], v3 offset:49160
 ds_read_b64_tr_b16 a[188:189], v2 offset:57352
 ds_read_b64_tr_b16 a[190:191], v3 offset:57352
 s_waitcnt lgkmcnt(0)
 s_branch L_wl_done_204
L_wl_next_207:
 ds_read_b64_tr_b16 a[200:201], v2 offset:8
 ds_read_b64_tr_b16 a[202:203], v3 offset:8
 ds_read_b64_tr_b16 a[204:205], v2 offset:8200
 ds_read_b64_tr_b16 a[206:207], v3 offset:8200
 ds_read_b64_tr_b16 a[216:217], v2 offset:16392
 ds_read_b64_tr_b16 a[218:219], v3 offset:16392
 ds_read_b64_tr_b16 a[220:221], v2 offset:24584
 ds_read_b64_tr_b16 a[222:223], v3 offset:24584
 ds_read_b64_tr_b16 a[232:233], v2 offset:32776
 ds_read_b64_tr_b16 a[234:235], v3 offset:32776
 ds_read_b64_tr_b16 a[236:237], v2 offset:40968
 ds_read_b64_tr_b16 a[238:239], v3 offset:40968
 ds_read_b64_tr_b16 a[248:249], v2 offset:49160
 ds_read_b64_tr_b16 a[250:251], v3 offset:49160
 ds_read_b64_tr_b16 a[252:253], v2 offset:57352
 ds_read_b64_tr_b16 a[254:255], v3 offset:57352
 s_waitcnt lgkmcnt(0)
L_wl_done_204:
 s_barrier
 s_waitcnt vmcnt(0)
 s_barrier
 s_sub_u32 s68, 5, s62
 s_and_b32 s68, s68, 3
 s_cmp_eq_u32 s68, 0
 s_cbranch_scc0 L_wl_next_210
 ds_read_b64_tr_b16 a[8:9], v4 offset:8
 ds_read_b64_tr_b16 a[10:11], v5 offset:8
 ds_read_b64_tr_b16 a[12:13], v4 offset:8200
 ds_read_b64_tr_b16 a[14:15], v5 offset:8200
 ds_read_b64_tr_b16 a[24:25], v4 offset:16392
 ds_read_b64_tr_b16 a[26:27], v5 offset:16392
 ds_read_b64_tr_b16 a[28:29], v4 offset:24584
 ds_read_b64_tr_b16 a[30:31], v5 offset:24584
 ds_read_b64_tr_b16 a[40:41], v4 offset:32776
 ds_read_b64_tr_b16 a[42:43], v5 offset:32776
 ds_read_b64_tr_b16 a[44:45], v4 offset:40968
 ds_read_b64_tr_b16 a[46:47], v5 offset:40968
 ds_read_b64_tr_b16 a[56:57], v4 offset:49160
 ds_read_b64_tr_b16 a[58:59], v5 offset:49160
 ds_read_b64_tr_b16 a[60:61], v4 offset:57352
 ds_read_b64_tr_b16 a[62:63], v5 offset:57352
 s_waitcnt lgkmcnt(0)
 s_branch L_wl_done_209
L_wl_next_210:
 s_cmp_eq_u32 s68, 1
 s_cbranch_scc0 L_wl_next_211
 ds_read_b64_tr_b16 a[72:73], v4 offset:8
 ds_read_b64_tr_b16 a[74:75], v5 offset:8
 ds_read_b64_tr_b16 a[76:77], v4 offset:8200
 ds_read_b64_tr_b16 a[78:79], v5 offset:8200
 ds_read_b64_tr_b16 a[88:89], v4 offset:16392
 ds_read_b64_tr_b16 a[90:91], v5 offset:16392
 ds_read_b64_tr_b16 a[92:93], v4 offset:24584
 ds_read_b64_tr_b16 a[94:95], v5 offset:24584
 ds_read_b64_tr_b16 a[104:105], v4 offset:32776
 ds_read_b64_tr_b16 a[106:107], v5 offset:32776
 ds_read_b64_tr_b16 a[108:109], v4 offset:40968
 ds_read_b64_tr_b16 a[110:111], v5 offset:40968
 ds_read_b64_tr_b16 a[120:121], v4 offset:49160
 ds_read_b64_tr_b16 a[122:123], v5 offset:49160
 ds_read_b64_tr_b16 a[124:125], v4 offset:57352
 ds_read_b64_tr_b16 a[126:127], v5 offset:57352
 s_waitcnt lgkmcnt(0)
 s_branch L_wl_done_209
L_wl_next_211:
 s_cmp_eq_u32 s68, 2
 s_cbranch_scc0 L_wl_next_212
 ds_read_b64_tr_b16 a[136:137], v4 offset:8
 ds_read_b64_tr_b16 a[138:139], v5 offset:8
 ds_read_b64_tr_b16 a[140:141], v4 offset:8200
 ds_read_b64_tr_b16 a[142:143], v5 offset:8200
 ds_read_b64_tr_b16 a[152:153], v4 offset:16392
 ds_read_b64_tr_b16 a[154:155], v5 offset:16392
 ds_read_b64_tr_b16 a[156:157], v4 offset:24584
 ds_read_b64_tr_b16 a[158:159], v5 offset:24584
 ds_read_b64_tr_b16 a[168:169], v4 offset:32776
 ds_read_b64_tr_b16 a[170:171], v5 offset:32776
 ds_read_b64_tr_b16 a[172:173], v4 offset:40968
 ds_read_b64_tr_b16 a[174:175], v5 offset:40968
 ds_read_b64_tr_b16 a[184:185], v4 offset:49160
 ds_read_b64_tr_b16 a[186:187], v5 offset:49160
 ds_read_b64_tr_b16 a[188:189], v4 offset:57352
 ds_read_b64_tr_b16 a[190:191], v5 offset:57352
 s_waitcnt lgkmcnt(0)
 s_branch L_wl_done_209
L_wl_next_212:
 ds_read_b64_tr_b16 a[200:201], v4 offset:8
 ds_read_b64_tr_b16 a[202:203], v5 offset:8
 ds_read_b64_tr_b16 a[204:205], v4 offset:8200
 ds_read_b64_tr_b16 a[206:207], v5 offset:8200
 ds_read_b64_tr_b16 a[216:217], v4 offset:16392
 ds_read_b64_tr_b16 a[218:219], v5 offset:16392
 ds_read_b64_tr_b16 a[220:221], v4 offset:24584
 ds_read_b64_tr_b16 a[222:223], v5 offset:24584
 ds_read_b64_tr_b16 a[232:233], v4 offset:32776
 ds_read_b64_tr_b16 a[234:235], v5 offset:32776
 ds_read_b64_tr_b16 a[236:237], v4 offset:40968
 ds_read_b64_tr_b16 a[238:239], v5 offset:40968
 ds_read_b64_tr_b16 a[248:249], v4 offset:49160
 ds_read_b64_tr_b16 a[250:251], v5 offset:49160
 ds_read_b64_tr_b16 a[252:253], v4 offset:57352
 ds_read_b64_tr_b16 a[254:255], v5 offset:57352
 s_waitcnt lgkmcnt(0)
L_wl_done_209:
 s_barrier
 s_lshl_b32 s65, s60, 15
 s_lshl_b32 s66, s84, 10
 s_add_u32 s65, s65, s66
 s_add_u32 s66, s65, 0x6200000
 buffer_load_dword v252, v84, s[4:7], s66 offen sc1
 s_add_u32 s66, s65, 0x6240000
 buffer_load_dword v253, v84, s[4:7], s66 offen sc1
 s_add_u32 s66, s65, 0x6280000
 buffer_load_dword v254, v84, s[4:7], s66 offen sc1
 s_lshl_b32 s66, s65, 1
 s_add_u32 s67, s66, 0x6100000
 buffer_load_dword v255, v84, s[4:7], s67 offen offset:0 sc1
 buffer_load_dword v255, v84, s[4:7], s67 offen offset:1024 sc1
 s_add_u32 s67, s66, 0x6400000
 buffer_load_dword v255, v84, s[4:7], s67 offen offset:0 sc1
 buffer_load_dword v255, v84, s[4:7], s67 offen offset:1024 sc1
 s_lshr_b32 s66, s65, 1
 s_and_b32 s66, s66, 0xfffffc00
 s_add_u32 s67, s66, 0x6300000
 buffer_load_dword v255, v84, s[4:7], s67 offen sc1
 v_lshlrev_b32 v80, 2, v0
 s_lshr_b32 s66, s101, 2
 s_add_u32 s66, s66, 1
 s_branch L_hs1_215
L_hs_214:
 s_sleep 8
 s_sub_u32 s63, s63, 1
 s_cbranch_scc1 L_role_t_1_abort
L_hs1_215:
 buffer_load_dword v81, v80, s[16:19], 0 offen sc1
 s_waitcnt vmcnt(0)
 v_readlane_b32 s65, v81, s66
 s_cmp_eq_u32 s101, 128
 s_cbranch_scc1 L_hs2_216
 s_cmp_eq_u32 s101, 64
 s_cbranch_scc1 L_hs3_217
 v_readlane_b32 s67, v81, 9
 v_cmp_eq_u32 s[96:97], -1, v81
 s_mov_b32 vcc_lo, 0x20202020
 s_mov_b32 vcc_hi, 0x20202020
 s_nop 1
 s_cmp_lg_u32 s67, 0
 s_cbranch_scc1 L_retry
 s_andn2_b64 s[96:97], vcc, s[96:97]
 s_cbranch_scc1 L_hs_214
 s_branch L_hs2_216
L_hs3_217:
 v_readlane_b32 s67, v81, 10
 v_cmp_eq_u32 s[96:97], 32, v81
 s_mov_b32 vcc_lo, 0x01010101
 s_mov_b32 vcc_hi, 0x01010101
 s_nop 1
 s_cmp_lg_u32 s67, 0
 s_cbranch_scc1 L_fallback
 s_andn2_b64 s[96:97], vcc, s[96:97]
 s_cbranch_scc1 L_hs_214
L_hs2_216:
 s_cmp_ge_u32 s65, 64
 s_cbranch_scc0 L_hs_214
 s_lshl_b32 s67, s60, 3
 s_add_u32 s67, s67, 6
 s_lshr_b32 s65, s101, 7
 s_add_u32 s67, s67, s65
 v_readlane_b32 s65, v81, s67
 s_nop 3
 s_cmp_eq_u32 s65, 0
 s_cbranch_scc1 L_hs_214
 s_and_b32 s65, s65, 2
 s_lshl_b32 s65, s65, 12
 s_add_u32 s85, s85, s65
 s_cmp_lt_u32 s61, 24
 s_cselect_b32 s65, 1, 2
 s_cselect_b32 s93, 0, 1
 s_cselect_b32 s28, 63, 64
 s_cselect_b32 s29, 12, 14
 s_cmp_lt_u32 s62, s65
 s_cselect_b32 s93, s93, 2
 s_cmp_eq_u32 s62, 3
 s_cselect_b32 s93, 3, s93
 v_lshrrev_b32 v82, 4, v0
 v_lshlrev_b32 v82, 9, v82
 v_cmp_le_i32 s[40:41], 0, v186
 v_cmp_le_i32 s[42:43], 1, v186
 v_cmp_le_i32 s[44:45], 2, v186
 v_cmp_le_i32 s[46:47], 3, v186
 v_cmp_le_i32 s[48:49], 16, v186
 v_cmp_le_i32 s[50:51], 17, v186
 v_cmp_le_i32 s[52:53], 18, v186
 v_cmp_le_i32 s[54:55], 19, v186
 s_mov_b32 s64, -1
 s_add_u32 s65, s64, 0
 s_and_b32 s65, s65, 3
 s_lshl_b32 s66, s65, 11
 s_add_u32 s78, s66, s72
 s_add_u32 s79, s66, s73
 s_lshl_b32 s80, s65, s29
 s_xor_b32 s65, s65, 2
 s_lshl_b32 s81, s65, s29
 s_add_u32 s80, s80, s76
 s_add_u32 s81, s81, s76
 s_cmp_ge_u32 s93, 2
 s_cbranch_scc1 L_t_go_224
 s_branch L_pfirst_227
L_poll_226:
 s_sleep 4
 s_sub_u32 s63, s63, 1
 s_cbranch_scc1 L_role_t_1_abort
L_pfirst_227:
 buffer_load_dwordx4 v[8:11], v85, s[4:7], s79 offen offset:0 sc1
 buffer_load_dwordx4 v[12:15], v85, s[4:7], s79 offen offset:512 sc1
 buffer_load_dwordx4 v[16:19], v85, s[4:7], s79 offen offset:1024 sc1
 buffer_load_dwordx4 v[20:23], v85, s[4:7], s79 offen offset:1536 sc1
 buffer_load_dword v24, v82, s[4:7], s78 offen sc1
 s_waitcnt vmcnt(0)
 v_max3_u32 v83, v8, v10, v12
 v_max3_u32 v83, v83, v14, v16
 v_max3_u32 v83, v83, v18, v20
 v_max3_u32 v83, v83, v22, v24
 v_cmp_eq_u32 vcc, -1, v83
 s_cbranch_vccnz L_poll_226
 s_cmp_eq_u32 s93, 1
 s_cbranch_scc1 L_t_px0_225
 s_add_u32 s65, s64, 1
 s_and_b32 s65, s65, 3
 s_lshl_b32 s65, s65, 13
 s_add_u32 s66, s65, s75
 s_add_u32 s67, s66, 4096
 buffer_load_dwordx4 v[96:99], v84, s[4:7], s66 offen offset:0 sc1
 buffer_load_dwordx4 v[100:103], v84, s[4:7], s66 offen offset:1024 sc1
 buffer_load_dwordx4 v[104:107], v84, s[4:7], s66 offen offset:2048 sc1
 buffer_load_dwordx4 v[108:111], v84, s[4:7], s66 offen offset:3072 sc1
 buffer_load_dwordx4 v[112:115], v84, s[4:7], s67 offen offset:0 sc1
 buffer_load_dwordx4 v[116:119], v84, s[4:7], s67 offen offset:1024 sc1
 buffer_load_dwordx4 v[120:123], v84, s[4:7], s67 offen offset:2048 sc1
 buffer_load_dwordx4 v[124:127], v84, s[4:7], s67 offen offset:3072 sc1
 s_branch L_t_go_224
L_t_px0_225:
 s_add_u32 s65, s64, 1
 s_and_b32 s65, s65, 3
 s_lshl_b32 s65, s65, 13
 s_add_u32 s66, s65, s75
 s_add_u32 s67, s66, 4096
 buffer_load_dwordx4 v[96:99], v84, s[4:7], s66 offen offset:0 sc1
 buffer_load_dwordx4 v[100:103], v84, s[4:7], s66 offen offset:1024 sc1
 buffer_load_dwordx4 v[104:107], v84, s[4:7], s66 offen offset:2048 sc1
 buffer_load_dwordx4 v[108:111], v84, s[4:7], s66 offen offset:3072 sc1
 buffer_load_dwordx4 v[112:115], v84, s[4:7], s67 offen offset:0 sc1
 buffer_load_dwordx4 v[116:119], v84, s[4:7], s67 offen offset:1024 sc1
 buffer_load_dwordx4 v[120:123], v84, s[4:7], s67 offen offset:2048 sc1
 buffer_load_dwordx4 v[124:127], v84, s[4:7], s67 offen offset:3072 sc1
 s_add_u32 s65, s65, s74
 buffer_load_dwordx4 v[128:131], v84, s[4:7], s65 offen offset:0 sc1
 buffer_load_dwordx4 v[132:135], v84, s[4:7], s65 offen offset:1024 sc1
 buffer_load_dwordx4 v[136:139], v84, s[4:7], s65 offen offset:2048 sc1
 buffer_load_dwordx4 v[140:143], v84, s[4:7], s65 offen offset:3072 sc1
 s_waitcnt vmcnt(3)
 v_mfma_f32_16x16x32_bf16 v[144:147], v[96:99], v[128:131], 0
 s_waitcnt vmcnt(2)
 v_mfma_f32_16x16x32_bf16 v[144:147], v[100:103], v[132:135], v[144:147]
 s_waitcnt vmcnt(1)
 v_mfma_f32_16x16x32_bf16 v[144:147], v[104:107], v[136:139], v[144:147]
 s_waitcnt vmcnt(0)
 v_mfma_f32_16x16x32_bf16 v[144:147], v[108:111], v[140:143], v[144:147]
 v_mfma_f32_16x16x32_bf16 v[148:151], v[112:115], v[128:131], 0
 v_mfma_f32_16x16x32_bf16 v[148:151], v[116:119], v[132:135], v[148:151]
 v_mfma_f32_16x16x32_bf16 v[148:151], v[120:123], v[136:139], v[148:151]
 v_mfma_f32_16x16x32_bf16 v[148:151], v[124:127], v[140:143], v[148:151]
 s_nop 3
 v_cndmask_b32 v144, v185, v144, s[40:41]
 v_cndmask_b32 v145, v185, v145, s[42:43]
 v_cndmask_b32 v146, v185, v146, s[44:45]
 v_cndmask_b32 v147, v185, v147, s[46:47]
 v_cndmask_b32 v148, v185, v148, s[48:49]
 v_cndmask_b32 v149, v185, v149, s[50:51]
 v_cndmask_b32 v150, v185, v150, s[52:53]
 v_cndmask_b32 v151, v185, v151, s[54:55]
L_t_go_224:
 s_mov_b32 s64, 0
 s_add_u32 s20, s64, 0
 s_and_b32 s20, s20, 3
 s_lshl_b32 s20, s20, 14
 s_add_u32 s20, s20, s23
 s_add_u32 s25, s64, 0
 s_and_b32 s25, s25, 3
 s_lshl_b32 s26, s25, 11
 s_xor_b32 s25, s26, 4096
 s_add_u32 s26, s26, s22
 s_add_u32 s25, s25, s22
 v_mov_b64 v[156:157], 0
 v_mov_b64 v[158:159], 0
 v_mov_b64 v[160:161], 0
 v_mov_b64 v[162:163], 0
 s_add_u32 s65, s64, 0
 s_and_b32 s65, s65, 3
 s_lshl_b32 s66, s65, 11
 s_add_u32 s78, s66, s72
 s_add_u32 s79, s66, s73
 s_lshl_b32 s80, s65, s29
 s_xor_b32 s65, s65, 2
 s_lshl_b32 s81, s65, s29
 s_add_u32 s80, s80, s76
 s_add_u32 s81, s81, s76
L_t_loop_218:
 s_nop 15
 s_nop 3
 buffer_load_dwordx4 v[212:215], v191, s[4:7], s20 offen offset:0 sc1
 buffer_load_dwordx4 v[216:219], v191, s[4:7], s20 offen offset:1024 sc1
 buffer_load_dwordx4 v[220:223], v191, s[4:7], s20 offen offset:2048 sc1
 buffer_load_dwordx4 v[224:227], v191, s[4:7], s20 offen offset:3072 sc1
L_t_loop2_228:
 s_branch L_pq_229_0123
L_pq_229_0123f:
 buffer_load_dwordx4 v[212:215], v191, s[4:7], s20 offen offset:0 sc1
 s_sub_u32 s63, s63, 1
 s_cbranch_scc1 L_role_t_1_abort
L_pq_229_1230:
 s_waitcnt vmcnt(3)
 v_max_u32 v234, v216, v218
 v_cmp_eq_u32 vcc, -1, v234
 ds_write_b128 v200, v[216:219] offset:1024
 s_cbranch_vccnz L_pq_229_1230f
L_pq_229_230:
 s_waitcnt vmcnt(2)
 v_max_u32 v234, v220, v222
 v_cmp_eq_u32 vcc, -1, v234
 ds_write_b128 v200, v[220:223] offset:2048
 s_cbranch_vccnz L_pq_229_230f
L_pq_229_30:
 s_waitcnt vmcnt(1)
 v_max_u32 v234, v224, v226
 v_cmp_eq_u32 vcc, -1, v234
 ds_write_b128 v200, v[224:227] offset:3072
 s_cbranch_vccnz L_pq_229_30f
L_pq_229_0:
 buffer_load_dwordx4 v[212:215], v191, s[4:7], s20 offen offset:0 sc1
 s_sub_u32 s63, s63, 1
 s_cbranch_scc1 L_role_t_1_abort
 s_waitcnt vmcnt(1)
 v_max_u32 v234, v212, v214
 v_cmp_eq_u32 vcc, -1, v234
 ds_write_b128 v200, v[212:215] offset:0
 s_cbranch_vccnz L_pq_229_0
 s_branch L_pq_229_done
L_pq_229_1230f:
 buffer_load_dwordx4 v[216:219], v191, s[4:7], s20 offen offset:1024 sc1
L_pq_229_2301:
 s_waitcnt vmcnt(3)
 v_max_u32 v234, v220, v222
 v_cmp_eq_u32 vcc, -1, v234
 ds_write_b128 v200, v[220:223] offset:2048
 s_cbranch_vccnz L_pq_229_2301f
L_pq_229_301:
 s_waitcnt vmcnt(2)
 v_max_u32 v234, v224, v226
 v_cmp_eq_u32 vcc, -1, v234
 ds_write_b128 v200, v[224:227] offset:3072
 s_cbranch_vccnz L_pq_229_301f
L_pq_229_01:
 s_waitcnt vmcnt(1)
 v_max_u32 v234, v212, v214
 v_cmp_eq_u32 vcc, -1, v234
 ds_write_b128 v200, v[212:215] offset:0
 s_cbranch_vccnz L_pq_229_01f
L_pq_229_1:
 buffer_load_dwordx4 v[216:219], v191, s[4:7], s20 offen offset:1024 sc1
 s_sub_u32 s63, s63, 1
 s_cbranch_scc1 L_role_t_1_abort
 s_waitcnt vmcnt(1)
 v_max_u32 v234, v216, v218
 v_cmp_eq_u32 vcc, -1, v234
 ds_write_b128 v200, v[216:219] offset:1024
 s_cbranch_vccnz L_pq_229_1
 s_branch L_pq_229_done
L_pq_229_2301f:
 buffer_load_dwordx4 v[220:223], v191, s[4:7], s20 offen offset:2048 sc1
L_pq_229_3012:
 s_waitcnt vmcnt(3)
 v_max_u32 v234, v224, v226
 v_cmp_eq_u32 vcc, -1, v234
 ds_write_b128 v200, v[224:227] offset:3072
 s_cbranch_vccnz L_pq_229_3012f
L_pq_229_012:
 s_waitcnt vmcnt(2)
 v_max_u32 v234, v212, v214
 v_cmp_eq_u32 vcc, -1, v234
 ds_write_b128 v200, v[212:215] offset:0
 s_cbranch_vccnz L_pq_229_012f
L_pq_229_12:
 s_waitcnt vmcnt(1)
 v_max_u32 v234, v216, v218
 v_cmp_eq_u32 vcc, -1, v234
 ds_write_b128 v200, v[216:219] offset:1024
 s_cbranch_vccnz L_pq_229_12f
L_pq_229_2:
 buffer_load_dwordx4 v[220:223], v191, s[4:7], s20 offen offset:2048 sc1
 s_sub_u32 s63, s63, 1
 s_cbranch_scc1 L_role_t_1_abort
 s_waitcnt vmcnt(1)
 v_max_u32 v234, v220, v222
 v_cmp_eq_u32 vcc, -1, v234
 ds_write_b128 v200, v[220:223] offset:2048
 s_cbranch_vccnz L_pq_229_2
 s_branch L_pq_229_done
L_pq_229_3012f:
 buffer_load_dwordx4 v[224:227], v191, s[4:7], s20 offen offset:3072 sc1
 s_branch L_pq_229_0123
L_pq_229_012f:
 buffer_load_dwordx4 v[212:215], v191, s[4:7], s20 offen offset:0 sc1
 s_sub_u32 s63, s63, 1
 s_cbranch_scc1 L_role_t_1_abort
L_pq_229_120:
 s_waitcnt vmcnt(2)
 v_max_u32 v234, v216, v218
 v_cmp_eq_u32 vcc, -1, v234
 ds_write_b128 v200, v[216:219] offset:1024
 s_cbranch_vccnz L_pq_229_120f
L_pq_229_20:
 s_waitcnt vmcnt(1)
 v_max_u32 v234, v220, v222
 v_cmp_eq_u32 vcc, -1, v234
 ds_write_b128 v200, v[220:223] offset:2048
 s_cbranch_vccnz L_pq_229_20f
 s_branch L_pq_229_0
L_pq_229_120f:
 buffer_load_dwordx4 v[216:219], v191, s[4:7], s20 offen offset:1024 sc1
L_pq_229_201:
 s_waitcnt vmcnt(2)
 v_max_u32 v234, v220, v222
 v_cmp_eq_u32 vcc, -1, v234
 ds_write_b128 v200, v[220:223] offset:2048
 s_cbranch_vccnz L_pq_229_201f
 s_branch L_pq_229_01
L_pq_229_201f:
 buffer_load_dwordx4 v[220:223], v191, s[4:7], s20 offen offset:2048 sc1
 s_branch L_pq_229_012
L_pq_229_013f:
 buffer_load_dwordx4 v[212:215], v191, s[4:7], s20 offen offset:0 sc1
 s_sub_u32 s63, s63, 1
 s_cbranch_scc1 L_role_t_1_abort
L_pq_229_130:
 s_waitcnt vmcnt(2)
 v_max_u32 v234, v216, v218
 v_cmp_eq_u32 vcc, -1, v234
 ds_write_b128 v200, v[216:219] offset:1024
 s_cbranch_vccnz L_pq_229_130f
 s_branch L_pq_229_30
L_pq_229_130f:
 buffer_load_dwordx4 v[216:219], v191, s[4:7], s20 offen offset:1024 sc1
 s_branch L_pq_229_301
L_pq_229_301f:
 buffer_load_dwordx4 v[224:227], v191, s[4:7], s20 offen offset:3072 sc1
L_pq_229_013:
 s_waitcnt vmcnt(2)
 v_max_u32 v234, v212, v214
 v_cmp_eq_u32 vcc, -1, v234
 ds_write_b128 v200, v[212:215] offset:0
 s_cbranch_vccnz L_pq_229_013f
L_pq_229_13:
 s_waitcnt vmcnt(1)
 v_max_u32 v234, v216, v218
 v_cmp_eq_u32 vcc, -1, v234
 ds_write_b128 v200, v[216:219] offset:1024
 s_cbranch_vccnz L_pq_229_13f
 s_branch L_pq_229_3
L_pq_229_023f:
 buffer_load_dwordx4 v[212:215], v191, s[4:7], s20 offen offset:0 sc1
 s_sub_u32 s63, s63, 1
 s_cbranch_scc1 L_role_t_1_abort
 s_branch L_pq_229_230
L_pq_229_230f:
 buffer_load_dwordx4 v[220:223], v191, s[4:7], s20 offen offset:2048 sc1
L_pq_229_302:
 s_waitcnt vmcnt(2)
 v_max_u32 v234, v224, v226
 v_cmp_eq_u32 vcc, -1, v234
 ds_write_b128 v200, v[224:227] offset:3072
 s_cbranch_vccnz L_pq_229_302f
L_pq_229_02:
 s_waitcnt vmcnt(1)
 v_max_u32 v234, v212, v214
 v_cmp_eq_u32 vcc, -1, v234
 ds_write_b128 v200, v[212:215] offset:0
 s_cbranch_vccnz L_pq_229_02f
 s_branch L_pq_229_2
L_pq_229_302f:
 buffer_load_dwordx4 v[224:227], v191, s[4:7], s20 offen offset:3072 sc1
L_pq_229_023:
 s_waitcnt vmcnt(2)
 v_max_u32 v234, v212, v214
 v_cmp_eq_u32 vcc, -1, v234
 ds_write_b128 v200, v[212:215] offset:0
 s_cbranch_vccnz L_pq_229_023f
 s_branch L_pq_229_23
L_pq_229_123f:
 buffer_load_dwordx4 v[216:219], v191, s[4:7], s20 offen offset:1024 sc1
 s_sub_u32 s63, s63, 1
 s_cbranch_scc1 L_role_t_1_abort
L_pq_229_231:
 s_waitcnt vmcnt(2)
 v_max_u32 v234, v220, v222
 v_cmp_eq_u32 vcc, -1, v234
 ds_write_b128 v200, v[220:223] offset:2048
 s_cbranch_vccnz L_pq_229_231f
L_pq_229_31:
 s_waitcnt vmcnt(1)
 v_max_u32 v234, v224, v226
 v_cmp_eq_u32 vcc, -1, v234
 ds_write_b128 v200, v[224:227] offset:3072
 s_cbranch_vccnz L_pq_229_31f
 s_branch L_pq_229_1
L_pq_229_231f:
 buffer_load_dwordx4 v[220:223], v191, s[4:7], s20 offen offset:2048 sc1
L_pq_229_312:
 s_waitcnt vmcnt(2)
 v_max_u32 v234, v224, v226
 v_cmp_eq_u32 vcc, -1, v234
 ds_write_b128 v200, v[224:227] offset:3072
 s_cbranch_vccnz L_pq_229_312f
 s_branch L_pq_229_12
L_pq_229_312f:
 buffer_load_dwordx4 v[224:227], v191, s[4:7], s20 offen offset:3072 sc1
 s_branch L_pq_229_123
L_pq_229_01f:
 buffer_load_dwordx4 v[212:215], v191, s[4:7], s20 offen offset:0 sc1
 s_sub_u32 s63, s63, 1
 s_cbranch_scc1 L_role_t_1_abort
L_pq_229_10:
 s_waitcnt vmcnt(1)
 v_max_u32 v234, v216, v218
 v_cmp_eq_u32 vcc, -1, v234
 ds_write_b128 v200, v[216:219] offset:1024
 s_cbranch_vccnz L_pq_229_10f
 s_branch L_pq_229_0
L_pq_229_10f:
 buffer_load_dwordx4 v[216:219], v191, s[4:7], s20 offen offset:1024 sc1
 s_branch L_pq_229_01
L_pq_229_02f:
 buffer_load_dwordx4 v[212:215], v191, s[4:7], s20 offen offset:0 sc1
 s_sub_u32 s63, s63, 1
 s_cbranch_scc1 L_role_t_1_abort
 s_branch L_pq_229_20
L_pq_229_20f:
 buffer_load_dwordx4 v[220:223], v191, s[4:7], s20 offen offset:2048 sc1
 s_branch L_pq_229_02
L_pq_229_03f:
 buffer_load_dwordx4 v[212:215], v191, s[4:7], s20 offen offset:0 sc1
 s_sub_u32 s63, s63, 1
 s_cbranch_scc1 L_role_t_1_abort
 s_branch L_pq_229_30
L_pq_229_30f:
 buffer_load_dwordx4 v[224:227], v191, s[4:7], s20 offen offset:3072 sc1
L_pq_229_03:
 s_waitcnt vmcnt(1)
 v_max_u32 v234, v212, v214
 v_cmp_eq_u32 vcc, -1, v234
 ds_write_b128 v200, v[212:215] offset:0
 s_cbranch_vccnz L_pq_229_03f
 s_branch L_pq_229_3
L_pq_229_12f:
 buffer_load_dwordx4 v[216:219], v191, s[4:7], s20 offen offset:1024 sc1
 s_sub_u32 s63, s63, 1
 s_cbranch_scc1 L_role_t_1_abort
L_pq_229_21:
 s_waitcnt vmcnt(1)
 v_max_u32 v234, v220, v222
 v_cmp_eq_u32 vcc, -1, v234
 ds_write_b128 v200, v[220:223] offset:2048
 s_cbranch_vccnz L_pq_229_21f
 s_branch L_pq_229_1
L_pq_229_21f:
 buffer_load_dwordx4 v[220:223], v191, s[4:7], s20 offen offset:2048 sc1
 s_branch L_pq_229_12
L_pq_229_13f:
 buffer_load_dwordx4 v[216:219], v191, s[4:7], s20 offen offset:1024 sc1
 s_sub_u32 s63, s63, 1
 s_cbranch_scc1 L_role_t_1_abort
 s_branch L_pq_229_31
L_pq_229_31f:
 buffer_load_dwordx4 v[224:227], v191, s[4:7], s20 offen offset:3072 sc1
 s_branch L_pq_229_13
L_pq_229_23f:
 buffer_load_dwordx4 v[220:223], v191, s[4:7], s20 offen offset:2048 sc1
 s_sub_u32 s63, s63, 1
 s_cbranch_scc1 L_role_t_1_abort
L_pq_229_32:
 s_waitcnt vmcnt(1)
 v_max_u32 v234, v224, v226
 v_cmp_eq_u32 vcc, -1, v234
 ds_write_b128 v200, v[224:227] offset:3072
 s_cbranch_vccnz L_pq_229_32f
 s_branch L_pq_229_2
L_pq_229_32f:
 buffer_load_dwordx4 v[224:227], v191, s[4:7], s20 offen offset:3072 sc1
 s_branch L_pq_229_23
.p2align 6
L_pq_229_0123:
 s_waitcnt vmcnt(3)
 v_max_u32 v234, v212, v214
 v_cmp_eq_u32 vcc, -1, v234
 ds_write_b128 v200, v[212:215] offset:0
 s_cbranch_vccnz L_pq_229_0123f
L_pq_229_123:
 s_waitcnt vmcnt(2)
 v_max_u32 v234, v216, v218
 v_cmp_eq_u32 vcc, -1, v234
 ds_write_b128 v200, v[216:219] offset:1024
 s_cbranch_vccnz L_pq_229_123f
L_pq_229_23:
 s_waitcnt vmcnt(1)
 v_max_u32 v234, v220, v222
 v_cmp_eq_u32 vcc, -1, v234
 ds_write_b128 v200, v[220:223] offset:2048
 s_cbranch_vccnz L_pq_229_23f
L_pq_229_3:
 buffer_load_dwordx4 v[224:227], v191, s[4:7], s20 offen offset:3072 sc1
 s_sub_u32 s63, s63, 1
 s_cbranch_scc1 L_role_t_1_abort
 s_waitcnt vmcnt(1)
 v_max_u32 v234, v224, v226
 v_cmp_eq_u32 vcc, -1, v234
 ds_write_b128 v200, v[224:227] offset:3072
 s_cbranch_vccnz L_pq_229_3
L_pq_229_done:
 v_smfmac_f32_16x16x64_bf16 v[160:163], v[212:215], a[8:15], v204
 v_smfmac_f32_16x16x64_bf16 v[160:163], v[216:219], a[24:31], v204
 s_waitcnt lgkmcnt(0)
 s_barrier
 ds_read_b128 v[8:11], v201 offset:0
 ds_read_b128 v[12:15], v201 offset:1024
 ds_read_b128 v[16:19], v201 offset:2048
 ds_read_b128 v[20:23], v201 offset:3072
 v_smfmac_f32_16x16x64_bf16 v[160:163], v[220:223], a[40:47], v204
 ds_read_b128 v[24:27], v202 offset:0
 ds_read_b128 v[28:31], v202 offset:1024
 ds_read_b128 v[32:35], v202 offset:2048
 ds_read_b128 v[36:39], v202 offset:3072
 v_smfmac_f32_16x16x64_bf16 v[160:163], v[224:227], a[56:63], v204
 ds_read_b128 v[40:43], v203 offset:0
 ds_read_b128 v[44:47], v203 offset:1024
 ds_read_b128 v[48:51], v203 offset:2048
 ds_read_b128 v[52:55], v203 offset:3072
 s_waitcnt lgkmcnt(11)
 v_smfmac_f32_16x16x64_bf16 v[160:163], v[8:11], a[72:79], v204
 s_waitcnt lgkmcnt(10)
 v_smfmac_f32_16x16x64_bf16 v[160:163], v[12:15], a[88:95], v204
 s_waitcnt lgkmcnt(9)
 v_smfmac_f32_16x16x64_bf16 v[160:163], v[16:19], a[104:111], v204
 s_waitcnt lgkmcnt(8)
 v_smfmac_f32_16x16x64_bf16 v[160:163], v[20:23], a[120:127], v204
 s_waitcnt lgkmcnt(7)
 v_smfmac_f32_16x16x64_bf16 v[160:163], v[24:27], a[136:143], v204
 s_waitcnt lgkmcnt(6)
 v_smfmac_f32_16x16x64_bf16 v[160:163], v[28:31], a[152:159], v204
 s_waitcnt lgkmcnt(5)
 v_smfmac_f32_16x16x64_bf16 v[160:163], v[32:35], a[168:175], v204
 s_waitcnt lgkmcnt(4)
 v_smfmac_f32_16x16x64_bf16 v[160:163], v[36:39], a[184:191], v204
 s_waitcnt lgkmcnt(3)
 v_smfmac_f32_16x16x64_bf16 v[160:163], v[40:43], a[200:207], v204
 s_waitcnt lgkmcnt(2)
 v_smfmac_f32_16x16x64_bf16 v[160:163], v[44:47], a[216:223], v204
 s_waitcnt lgkmcnt(1)
 v_smfmac_f32_16x16x64_bf16 v[160:163], v[48:51], a[232:239], v204
 s_waitcnt lgkmcnt(0)
 v_smfmac_f32_16x16x64_bf16 v[160:163], v[52:55], a[248:255], v204
 s_nop 7
 v_cvt_pk_bf16_f32 v230, v160, v161
 v_cvt_pk_bf16_f32 v231, v162, v163
 s_nop 1
 v_mfma_f32_16x16x32_bf16 v[164:167], v[228:231], v[208:211], 0
 s_nop 7
 v_cvt_pk_bf16_f32 v232, v164, v165
 v_cvt_pk_bf16_f32 v233, v166, v167
 v_min_u32 v232, -2, v232
 buffer_store_dwordx2 v[232:233], v193, s[4:7], s26 offen sc1
 s_nop 8
 s_and_b32 s65, s64, 3
 s_lshl_b32 s92, s65, 10
 s_add_u32 s92, s92, s87
 s_lshl_b32 s88, s65, 18
 s_add_u32 s88, s88, s85
 s_add_u32 s90, s64, 1
 s_and_b32 s90, s90, 3
 s_lshl_b32 s90, s90, 14
 s_xor_b32 s91, s90, 0x8000
 s_add_u32 s90, s90, s86
 s_add_u32 s91, s91, s86
 s_cmp_lg_u32 s93, 0
 s_cbranch_scc1 L_t_k1_219
 buffer_load_dwordx4 v[128:131], v86, s[4:7], s78 offen offset:0 sc1
 buffer_load_dwordx4 v[132:135], v86, s[4:7], s78 offen offset:512 sc1
 buffer_load_dwordx4 v[136:139], v86, s[4:7], s78 offen offset:1024 sc1
 buffer_load_dwordx4 v[140:143], v86, s[4:7], s78 offen offset:1536 sc1
 s_nop 15
 s_nop 3
 s_branch L_t0_rt_234
L_t0_rt_237:
 buffer_load_dwordx4 v[128:131], v86, s[4:7], s78 offen offset:0 sc1
 buffer_load_dwordx4 v[132:135], v86, s[4:7], s78 offen offset:512 sc1
 buffer_load_dwordx4 v[136:139], v86, s[4:7], s78 offen offset:1024 sc1
 buffer_load_dwordx4 v[140:143], v86, s[4:7], s78 offen offset:1536 sc1
 s_sub_u32 s63, s63, 1
 s_cbranch_scc1 L_role_t_1_abort
 s_waitcnt vmcnt(4)
 v_max_u32 v83, v140, v142
 v_cmp_eq_u32 vcc, -1, v83
 s_cbranch_vccnz L_t0_rt_237
 v_mfma_f32_16x16x32_bf16 v[144:147], v[108:111], v[140:143], v[144:147]
 v_mfma_f32_16x16x32_bf16 v[148:151], v[124:127], v[140:143], v[148:151]
 v_mfma_f32_16x16x32_bf16 v[152:155], v[140:143], v[140:143], v[152:155]
 s_branch L_t0_st_233
L_t0_rt_236:
 buffer_load_dwordx4 v[128:131], v86, s[4:7], s78 offen offset:0 sc1
 buffer_load_dwordx4 v[132:135], v86, s[4:7], s78 offen offset:512 sc1
 buffer_load_dwordx4 v[136:139], v86, s[4:7], s78 offen offset:1024 sc1
 buffer_load_dwordx4 v[140:143], v86, s[4:7], s78 offen offset:1536 sc1
 s_sub_u32 s63, s63, 1
 s_cbranch_scc1 L_role_t_1_abort
 s_waitcnt vmcnt(5)
 v_max_u32 v83, v136, v138
 v_cmp_eq_u32 vcc, -1, v83
 s_cbranch_vccnz L_t0_rt_236
 v_mfma_f32_16x16x32_bf16 v[144:147], v[104:107], v[136:139], v[144:147]
 s_waitcnt vmcnt(4)
 v_max_u32 v83, v140, v142
 v_cmp_eq_u32 vcc, -1, v83
 v_mfma_f32_16x16x32_bf16 v[148:151], v[120:123], v[136:139], v[148:151]
 v_mfma_f32_16x16x32_bf16 v[152:155], v[136:139], v[136:139], v[152:155]
 s_branch L_t0_st_232
L_t0_rt_235:
 buffer_load_dwordx4 v[128:131], v86, s[4:7], s78 offen offset:0 sc1
 buffer_load_dwordx4 v[132:135], v86, s[4:7], s78 offen offset:512 sc1
 buffer_load_dwordx4 v[136:139], v86, s[4:7], s78 offen offset:1024 sc1
 buffer_load_dwordx4 v[140:143], v86, s[4:7], s78 offen offset:1536 sc1
 s_sub_u32 s63, s63, 1
 s_cbranch_scc1 L_role_t_1_abort
 s_waitcnt vmcnt(6)
 v_max_u32 v83, v132, v134
 v_cmp_eq_u32 vcc, -1, v83
 s_cbranch_vccnz L_t0_rt_235
 v_mfma_f32_16x16x32_bf16 v[144:147], v[100:103], v[132:135], v[144:147]
 s_waitcnt vmcnt(5)
 v_max_u32 v83, v136, v138
 v_cmp_eq_u32 vcc, -1, v83
 v_mfma_f32_16x16x32_bf16 v[148:151], v[116:119], v[132:135], v[148:151]
 v_mfma_f32_16x16x32_bf16 v[152:155], v[132:135], v[132:135], v[152:155]
 s_branch L_t0_st_231
L_t0_rt_234:
 buffer_load_dwordx4 v[128:131], v86, s[4:7], s78 offen offset:0 sc1
 buffer_load_dwordx4 v[132:135], v86, s[4:7], s78 offen offset:512 sc1
 buffer_load_dwordx4 v[136:139], v86, s[4:7], s78 offen offset:1024 sc1
 buffer_load_dwordx4 v[140:143], v86, s[4:7], s78 offen offset:1536 sc1
 s_sub_u32 s63, s63, 1
 s_cbranch_scc1 L_role_t_1_abort
 s_waitcnt vmcnt(7)
 v_max_u32 v83, v128, v130
 v_cmp_eq_u32 vcc, -1, v83
 s_cbranch_vccnz L_t0_rt_234
 v_mfma_f32_16x16x32_bf16 v[144:147], v[96:99], v[128:131], 0
 s_waitcnt vmcnt(6)
 v_max_u32 v83, v132, v134
 v_cmp_eq_u32 vcc, -1, v83
 v_mfma_f32_16x16x32_bf16 v[148:151], v[112:115], v[128:131], 0
 v_mfma_f32_16x16x32_bf16 v[152:155], v[128:131], v[128:131], v[176:179]
L_t0_st_230:
 s_cbranch_vccnz L_t0_rt_235
 v_mfma_f32_16x16x32_bf16 v[144:147], v[100:103], v[132:135], v[144:147]
 s_waitcnt vmcnt(5)
 v_max_u32 v83, v136, v138
 v_cmp_eq_u32 vcc, -1, v83
 v_mfma_f32_16x16x32_bf16 v[148:151], v[116:119], v[132:135], v[148:151]
 v_mfma_f32_16x16x32_bf16 v[152:155], v[132:135], v[132:135], v[152:155]
L_t0_st_231:
 s_cbranch_vccnz L_t0_rt_236
 v_mfma_f32_16x16x32_bf16 v[144:147], v[104:107], v[136:139], v[144:147]
 s_waitcnt vmcnt(4)
 v_max_u32 v83, v140, v142
 v_cmp_eq_u32 vcc, -1, v83
 v_mfma_f32_16x16x32_bf16 v[148:151], v[120:123], v[136:139], v[148:151]
 v_mfma_f32_16x16x32_bf16 v[152:155], v[136:139], v[136:139], v[152:155]
L_t0_st_232:
 s_cbranch_vccnz L_t0_rt_237
 v_mfma_f32_16x16x32_bf16 v[144:147], v[108:111], v[140:143], v[144:147]
 v_mfma_f32_16x16x32_bf16 v[148:151], v[124:127], v[140:143], v[148:151]
 v_mfma_f32_16x16x32_bf16 v[152:155], v[140:143], v[140:143], v[152:155]
L_t0_st_233:
 s_nop 5
 v_mov_b32_dpp v144, v146 row_ror:8 row_mask:0xf bank_mask:0xc
 v_mov_b32_dpp v145, v147 row_ror:8 row_mask:0xf bank_mask:0xc
 v_mov_b32_dpp v148, v150 row_ror:8 row_mask:0xf bank_mask:0xc
 v_mov_b32_dpp v149, v151 row_ror:8 row_mask:0xf bank_mask:0xc
 v_mov_b32_dpp v152, v154 row_ror:8 row_mask:0xf bank_mask:0xc
 v_mov_b32_dpp v153, v155 row_ror:8 row_mask:0xf bank_mask:0xc
 v_max3_f32 v180, v144, v145, v148
 v_max3_f32 v180, v180, v149, v152
 v_max_f32 v180, v180, v153
 v_pk_mul_f32 v[24:25], v[144:145], s[82:83]
 v_pk_mul_f32 v[26:27], v[148:149], s[82:83]
 v_max_f32_dpp v180, v180, v180 row_ror:8 row_mask:0xf bank_mask:0xf
 v_mov_b32 v80, v180
 v_pk_mul_f32 v[28:29], v[152:153], s[82:83]
 s_nop 0
 v_permlane16_swap_b32 v180, v80
 v_max_f32 v180, v180, v80
 v_mov_b32 v80, v180
 s_nop 0
 s_nop 0
 v_permlane32_swap_b32 v180, v80
 v_max_f32 v180, v180, v80
 v_mul_f32 v180, s82, v180
 v_pk_add_f32 v[24:25], v[24:25], v[180:181] op_sel_hi:[1,0] neg_lo:[0,1] neg_hi:[0,1]
 v_pk_add_f32 v[26:27], v[26:27], v[180:181] op_sel_hi:[1,0] neg_lo:[0,1] neg_hi:[0,1]
 v_pk_add_f32 v[28:29], v[28:29], v[180:181] op_sel_hi:[1,0] neg_lo:[0,1] neg_hi:[0,1]
 v_exp_f32 v24, v24
 v_exp_f32 v25, v25
 v_exp_f32 v26, v26
 v_exp_f32 v27, v27
 v_exp_f32 v28, v28
 v_exp_f32 v29, v29
 v_pk_add_f32 v[182:183], v[24:25], v[26:27]
 v_pk_add_f32 v[182:183], v[182:183], v[28:29]
 v_add_f32 v182, v182, v183
 s_nop 1
 v_add_f32_dpp v182, v182, v182 row_ror:8 row_mask:0xf bank_mask:0xf
 v_mov_b32 v80, v182
 s_nop 1
 v_permlane16_swap_b32 v182, v80
 v_add_f32 v182, v182, v80
 v_mov_b32 v80, v182
 s_nop 1
 v_permlane32_swap_b32 v182, v80
 v_add_f32 v182, v182, v80
 v_rcp_f32 v182, v182
 s_nop 0
 v_pk_mul_f32 v[24:25], v[24:25], v[182:183] op_sel_hi:[1,0]
 v_pk_mul_f32 v[26:27], v[26:27], v[182:183] op_sel_hi:[1,0]
 v_pk_mul_f32 v[28:29], v[28:29], v[182:183] op_sel_hi:[1,0]
 v_cvt_pk_bf16_f32 v168, v24, abs(v25)
 v_cvt_pk_bf16_f32 v169, v26, abs(v27)
 v_cvt_pk_bf16_f32 v170, v28, abs(v29)
 buffer_store_dwordx2 v[168:169], v87, s[4:7], s80 offen sc1
 buffer_store_dword v170, v88, s[4:7], s80 offen sc1
 buffer_store_dword v170, v88, s[4:7], s80 offen offset:256 sc1
 s_nop 15
 s_nop 15
 s_nop 15
 s_nop 11
 buffer_store_dwordx2 v[92:93], v87, s[4:7], s81 offen sc1
 buffer_store_dword v92, v88, s[4:7], s81 offen sc1
 buffer_store_dword v92, v88, s[4:7], s81 offen offset:256 sc1
 s_add_u32 s65, s64, 1
 s_and_b32 s65, s65, 3
 s_lshl_b32 s65, s65, 13
 s_add_u32 s66, s65, s75
 s_add_u32 s67, s66, 4096
 buffer_load_dwordx4 v[96:99], v84, s[4:7], s66 offen offset:0 sc1
 buffer_load_dwordx4 v[100:103], v84, s[4:7], s66 offen offset:1024 sc1
 buffer_load_dwordx4 v[104:107], v84, s[4:7], s66 offen offset:2048 sc1
 buffer_load_dwordx4 v[108:111], v84, s[4:7], s66 offen offset:3072 sc1
 buffer_load_dwordx4 v[112:115], v84, s[4:7], s67 offen offset:0 sc1
 buffer_load_dwordx4 v[116:119], v84, s[4:7], s67 offen offset:1024 sc1
 buffer_load_dwordx4 v[120:123], v84, s[4:7], s67 offen offset:2048 sc1
 buffer_load_dwordx4 v[124:127], v84, s[4:7], s67 offen offset:3072 sc1
 s_branch L_t_jn_222
L_t_k1_219:
 s_cmp_lg_u32 s93, 1
 s_cbranch_scc1 L_t_k2_220
 s_nop 15
 s_nop 3
 s_branch L_pfirst_239
L_poll_238:
 s_sub_u32 s63, s63, 1
 s_cbranch_scc1 L_role_t_1_abort
L_pfirst_239:
 buffer_load_dwordx4 v[8:11], v85, s[4:7], s79 offen offset:0 sc1
 buffer_load_dwordx4 v[12:15], v85, s[4:7], s79 offen offset:512 sc1
 buffer_load_dwordx4 v[16:19], v85, s[4:7], s79 offen offset:1024 sc1
 buffer_load_dwordx4 v[20:23], v85, s[4:7], s79 offen offset:1536 sc1
 buffer_load_dword v24, v82, s[4:7], s78 offen sc1
 s_waitcnt vmcnt(0)
 v_max3_u32 v83, v8, v10, v12
 v_max3_u32 v83, v83, v14, v16
 v_max3_u32 v83, v83, v18, v20
 v_max3_u32 v83, v83, v22, v24
 v_cmp_eq_u32 vcc, -1, v83
 s_cbranch_vccnz L_poll_238
 v_mfma_f32_16x16x32_bf16 v[152:155], v[8:11], v[128:131], 0
 v_mfma_f32_16x16x32_bf16 v[152:155], v[12:15], v[132:135], v[152:155]
 v_mfma_f32_16x16x32_bf16 v[152:155], v[16:19], v[136:139], v[152:155]
 v_mfma_f32_16x16x32_bf16 v[152:155], v[20:23], v[140:143], v[152:155]
 s_cmp_eq_u32 s64, 63
 s_nop 2
 s_cbranch_scc1 L_t_nopf_240
 s_add_u32 s65, s64, 1
 s_and_b32 s65, s65, 3
 s_lshl_b32 s65, s65, 13
 s_add_u32 s66, s65, s75
 s_add_u32 s67, s66, 4096
 buffer_load_dwordx4 v[96:99], v84, s[4:7], s66 offen offset:0 sc1
 buffer_load_dwordx4 v[100:103], v84, s[4:7], s66 offen offset:1024 sc1
 buffer_load_dwordx4 v[104:107], v84, s[4:7], s66 offen offset:2048 sc1
 buffer_load_dwordx4 v[108:111], v84, s[4:7], s66 offen offset:3072 sc1
 buffer_load_dwordx4 v[112:115], v84, s[4:7], s67 offen offset:0 sc1
 buffer_load_dwordx4 v[116:119], v84, s[4:7], s67 offen offset:1024 sc1
 buffer_load_dwordx4 v[120:123], v84, s[4:7], s67 offen offset:2048 sc1
 buffer_load_dwordx4 v[124:127], v84, s[4:7], s67 offen offset:3072 sc1
 s_add_u32 s65, s65, s74
 buffer_load_dwordx4 v[128:131], v84, s[4:7], s65 offen offset:0 sc1
 buffer_load_dwordx4 v[132:135], v84, s[4:7], s65 offen offset:1024 sc1
 buffer_load_dwordx4 v[136:139], v84, s[4:7], s65 offen offset:2048 sc1
 buffer_load_dwordx4 v[140:143], v84, s[4:7], s65 offen offset:3072 sc1
L_t_nopf_240:
 v_max3_f32 v180, v144, v145, v146
 v_max3_f32 v180, v180, v147, v148
 v_max3_f32 v180, v180, v149, v150
 v_max3_f32 v180, v180, v151, v152
 v_max3_f32 v180, v180, v153, v154
 v_max_f32 v180, v180, v155
 v_mov_b32 v80, v180
 v_pk_mul_f32 v[24:25], v[144:145], s[82:83]
 v_pk_mul_f32 v[26:27], v[146:147], s[82:83]
 v_permlane16_swap_b32 v180, v80
 v_max_f32 v180, v180, v80
 v_mov_b32 v80, v180
 v_pk_mul_f32 v[28:29], v[148:149], s[82:83]
 v_pk_mul_f32 v[30:31], v[150:151], s[82:83]
 v_permlane32_swap_b32 v180, v80
 v_max_f32 v180, v180, v80
 v_pk_mul_f32 v[32:33], v[152:153], s[82:83]
 v_pk_mul_f32 v[34:35], v[154:155], s[82:83]
 v_mul_f32 v180, s82, v180
 v_pk_add_f32 v[24:25], v[24:25], v[180:181] op_sel_hi:[1,0] neg_lo:[0,1] neg_hi:[0,1]
 v_pk_add_f32 v[26:27], v[26:27], v[180:181] op_sel_hi:[1,0] neg_lo:[0,1] neg_hi:[0,1]
 v_pk_add_f32 v[28:29], v[28:29], v[180:181] op_sel_hi:[1,0] neg_lo:[0,1] neg_hi:[0,1]
 v_pk_add_f32 v[30:31], v[30:31], v[180:181] op_sel_hi:[1,0] neg_lo:[0,1] neg_hi:[0,1]
 v_pk_add_f32 v[32:33], v[32:33], v[180:181] op_sel_hi:[1,0] neg_lo:[0,1] neg_hi:[0,1]
 v_pk_add_f32 v[34:35], v[34:35], v[180:181] op_sel_hi:[1,0] neg_lo:[0,1] neg_hi:[0,1]
 v_exp_f32 v24, v24
 v_exp_f32 v25, v25
 v_exp_f32 v26, v26
 v_exp_f32 v27, v27
 v_exp_f32 v28, v28
 v_exp_f32 v29, v29
 v_exp_f32 v30, v30
 v_exp_f32 v31, v31
 v_exp_f32 v32, v32
 v_exp_f32 v33, v33
 v_exp_f32 v34, v34
 v_exp_f32 v35, v35
 v_add_f32 v182, v24, v25
 v_add_f32 v182, v182, v26
 v_add_f32 v182, v182, v27
 v_add_f32 v182, v182, v28
 v_add_f32 v182, v182, v29
 v_add_f32 v182, v182, v30
 v_add_f32 v182, v182, v31
 v_add_f32 v184, v32, v33
 v_add_f32 v184, v184, v34
 v_add_f32 v184, v184, v35
 v_fma_f32 v182, v184, 0.5, v182
 v_mov_b32 v80, v182
 s_nop 1
 v_permlane16_swap_b32 v182, v80
 v_add_f32 v182, v182, v80
 v_mov_b32 v80, v182
 s_nop 1
 v_permlane32_swap_b32 v182, v80
 v_add_f32 v182, v182, v80
 v_rcp_f32 v182, v182
 s_nop 0
 v_pk_mul_f32 v[24:25], v[24:25], v[182:183] op_sel_hi:[1,0]
 v_pk_mul_f32 v[26:27], v[26:27], v[182:183] op_sel_hi:[1,0]
 v_pk_mul_f32 v[28:29], v[28:29], v[182:183] op_sel_hi:[1,0]
 v_pk_mul_f32 v[30:31], v[30:31], v[182:183] op_sel_hi:[1,0]
 v_pk_mul_f32 v[32:33], v[32:33], v[182:183] op_sel_hi:[1,0]
 v_pk_mul_f32 v[34:35], v[34:35], v[182:183] op_sel_hi:[1,0]
 v_cvt_pk_bf16_f32 v168, v24, abs(v25)
 v_cvt_pk_bf16_f32 v169, v26, abs(v27)
 v_cvt_pk_bf16_f32 v170, v28, abs(v29)
 v_cvt_pk_bf16_f32 v171, v30, abs(v31)
 v_cvt_pk_bf16_f32 v172, v32, abs(v33)
 v_cvt_pk_bf16_f32 v173, v34, abs(v35)
 buffer_store_dwordx4 v[168:171], v87, s[4:7], s80 offen sc1
 buffer_store_dwordx2 v[172:173], v88, s[4:7], s80 offen sc1
 s_waitcnt vmcnt(2)
 v_mfma_f32_16x16x32_bf16 v[144:147], v[96:99], v[128:131], 0
 v_mfma_f32_16x16x32_bf16 v[144:147], v[100:103], v[132:135], v[144:147]
 v_mfma_f32_16x16x32_bf16 v[144:147], v[104:107], v[136:139], v[144:147]
 v_mfma_f32_16x16x32_bf16 v[144:147], v[108:111], v[140:143], v[144:147]
 v_mfma_f32_16x16x32_bf16 v[148:151], v[112:115], v[128:131], 0
 v_mfma_f32_16x16x32_bf16 v[148:151], v[116:119], v[132:135], v[148:151]
 v_mfma_f32_16x16x32_bf16 v[148:151], v[120:123], v[136:139], v[148:151]
 v_mfma_f32_16x16x32_bf16 v[148:151], v[124:127], v[140:143], v[148:151]
 s_nop 3
 v_cndmask_b32 v144, v185, v144, s[40:41]
 v_cndmask_b32 v145, v185, v145, s[42:43]
 v_cndmask_b32 v146, v185, v146, s[44:45]
 v_cndmask_b32 v147, v185, v147, s[46:47]
 v_cndmask_b32 v148, v185, v148, s[48:49]
 v_cndmask_b32 v149, v185, v149, s[50:51]
 v_cndmask_b32 v150, v185, v150, s[52:53]
 v_cndmask_b32 v151, v185, v151, s[54:55]
 buffer_store_dwordx4 v[92:95], v87, s[4:7], s81 offen sc1
 buffer_store_dwordx2 v[92:93], v88, s[4:7], s81 offen sc1
 s_cmp_ge_i32 s64, 63
 s_cbranch_scc1 L_t_end_223
 buffer_store_dwordx2 v[196:197], v193, s[4:7], s25 offen sc1
 v_xor_b32 v200, 0x4000, v200
 v_xor_b32 v201, 0x4000, v201
 v_xor_b32 v202, 0x4000, v202
 v_xor_b32 v203, 0x4000, v203
 s_add_u32 s20, s64, 1
 s_and_b32 s20, s20, 3
 s_lshl_b32 s20, s20, 14
 s_add_u32 s20, s20, s23
 s_add_u32 s25, s64, 1
 s_and_b32 s25, s25, 3
 s_lshl_b32 s26, s25, 11
 s_xor_b32 s25, s26, 4096
 s_add_u32 s26, s26, s22
 s_add_u32 s25, s25, s22
 v_mov_b64 v[156:157], 0
 v_mov_b64 v[158:159], 0
 v_mov_b64 v[160:161], 0
 v_mov_b64 v[162:163], 0
 s_add_u32 s65, s64, 1
 s_and_b32 s65, s65, 3
 s_lshl_b32 s66, s65, 11
 s_add_u32 s78, s66, s72
 s_add_u32 s79, s66, s73
 s_lshl_b32 s80, s65, s29
 s_xor_b32 s65, s65, 2
 s_lshl_b32 s81, s65, s29
 s_add_u32 s80, s80, s76
 s_add_u32 s81, s81, s76
 buffer_store_dwordx2 v[78:79], v64, s[4:7], s91 offen sc1
 s_branch L_t_k3_221
L_t_k2_220:
 v_mov_b32 v188, s64
 buffer_store_dword v188, v187, s[4:7], s30 offen sc1
 s_cmp_ge_i32 s64, 63
 s_cbranch_scc1 L_t_end_223
 s_sleep 14
 buffer_store_dwordx2 v[196:197], v193, s[4:7], s25 offen sc1
 v_xor_b32 v200, 0x4000, v200
 v_xor_b32 v201, 0x4000, v201
 v_xor_b32 v202, 0x4000, v202
 v_xor_b32 v203, 0x4000, v203
 s_add_u32 s20, s64, 1
 s_and_b32 s20, s20, 3
 s_lshl_b32 s20, s20, 14
 s_add_u32 s20, s20, s23
 s_add_u32 s25, s64, 1
 s_and_b32 s25, s25, 3
 s_lshl_b32 s26, s25, 11
 s_xor_b32 s25, s26, 4096
 s_add_u32 s26, s26, s22
 s_add_u32 s25, s25, s22
 v_mov_b64 v[156:157], 0
 v_mov_b64 v[158:159], 0
 v_mov_b64 v[160:161], 0
 v_mov_b64 v[162:163], 0
 s_add_u32 s65, s64, 1
 s_and_b32 s65, s65, 3
 s_lshl_b32 s66, s65, 11
 s_add_u32 s78, s66, s72
 s_add_u32 s79, s66, s73
 s_lshl_b32 s80, s65, s29
 s_xor_b32 s65, s65, 2
 s_lshl_b32 s81, s65, s29
 s_add_u32 s80, s80, s76
 s_add_u32 s81, s81, s76
 buffer_store_dwordx2 v[78:79], v64, s[4:7], s91 offen sc1
 s_cmp_eq_u32 s93, 2
 s_cbranch_scc1 L_t_k3_221
 s_waitcnt vmcnt(0)
 s_mov_b64 exec, 0xff
 buffer_load_dword v57, v65, s[4:7], s92 offen sc1
 s_nop 15
 s_nop 11
L_poll_241:
 buffer_load_dword v57, v65, s[4:7], s92 offen sc1
 s_sub_u32 s63, s63, 1
 s_cbranch_scc1 L_role_t_1_abort
 s_waitcnt vmcnt(1)
 v_cmp_eq_u32 vcc, -1, v57
 s_cbranch_vccnz L_poll_241
 s_mov_b64 exec, -1
 s_nop 15
 s_nop 7
 s_branch L_t_k3_221
L_t_jn_222:
 s_cmp_ge_i32 s64, 63
 s_cbranch_scc1 L_t_end_223
 buffer_store_dwordx2 v[196:197], v193, s[4:7], s25 offen sc1
 v_xor_b32 v200, 0x4000, v200
 v_xor_b32 v201, 0x4000, v201
 v_xor_b32 v202, 0x4000, v202
 v_xor_b32 v203, 0x4000, v203
 s_add_u32 s20, s64, 1
 s_and_b32 s20, s20, 3
 s_lshl_b32 s20, s20, 14
 s_add_u32 s20, s20, s23
 s_add_u32 s25, s64, 1
 s_and_b32 s25, s25, 3
 s_lshl_b32 s26, s25, 11
 s_xor_b32 s25, s26, 4096
 s_add_u32 s26, s26, s22
 s_add_u32 s25, s25, s22
 v_mov_b64 v[156:157], 0
 v_mov_b64 v[158:159], 0
 v_mov_b64 v[160:161], 0
 v_mov_b64 v[162:163], 0
 s_add_u32 s65, s64, 1
 s_and_b32 s65, s65, 3
 s_lshl_b32 s66, s65, 11
 s_add_u32 s78, s66, s72
 s_add_u32 s79, s66, s73
 s_lshl_b32 s80, s65, s29
 s_xor_b32 s65, s65, 2
 s_lshl_b32 s81, s65, s29
 s_add_u32 s80, s80, s76
 s_add_u32 s81, s81, s76
 buffer_store_dwordx2 v[78:79], v64, s[4:7], s91 offen sc1
L_t_k3_221:
 s_barrier
 buffer_load_dwordx4 v[40:43], v60, s[4:7], s88 offen sc1
 buffer_load_dwordx4 v[44:47], v61, s[4:7], s88 offen sc1
 s_nop 12
 buffer_load_dwordx4 v[48:51], v62, s[4:7], s88 offen sc1
 buffer_load_dwordx4 v[52:55], v63, s[4:7], s88 offen sc1
 s_waitcnt vmcnt(2)
 v_max_u32 v56, v40, v44
 v_mfma_f32_16x16x32_bf16 v[72:75], v[40:43], v[68:71], 0
 v_mfma_f32_16x16x32_bf16 v[72:75], v[44:47], v[68:71], v[72:75]
 s_waitcnt vmcnt(1)
 v_mfma_f32_16x16x32_bf16 v[72:75], v[48:51], v[68:71], v[72:75]
 s_waitcnt vmcnt(0)
 v_max3_u32 v56, v56, v48, v52
 v_mfma_f32_16x16x32_bf16 v[72:75], v[52:55], v[68:71], v[72:75]
 v_cmp_eq_u32 vcc, -1, v56
 s_cbranch_vccnz L_rpoll_242
 s_nop 5
 v_cvt_pk_bf16_f32 v76, v72, v73
 v_cvt_pk_bf16_f32 v77, v74, v75
 v_min_u32 v76, -2, v76
 buffer_store_dwordx2 v[76:77], v64, s[4:7], s90 offen sc1
 s_add_u32 s64, s64, 1
 s_cmp_lt_i32 s64, s28
 s_cbranch_scc1 L_t_loop_218
 s_branch L_t_end_223
L_rpoll_242:
 s_mov_b64 exec, vcc
 buffer_load_dwordx4 v[40:43], v60, s[4:7], s88 offen sc1
 buffer_load_dwordx4 v[44:47], v61, s[4:7], s88 offen sc1
 buffer_load_dwordx4 v[48:51], v62, s[4:7], s88 offen sc1
 buffer_load_dwordx4 v[52:55], v63, s[4:7], s88 offen sc1
 s_mov_b64 exec, -1
 s_sub_u32 s63, s63, 1
 s_cbranch_scc1 L_role_t_1_abort
 s_nop 15
 s_nop 15
 s_nop 15
 s_nop 6
 buffer_load_dwordx4 v[212:215], v191, s[4:7], s20 offen offset:0 sc1
 buffer_load_dwordx4 v[216:219], v191, s[4:7], s20 offen offset:1024 sc1
 buffer_load_dwordx4 v[220:223], v191, s[4:7], s20 offen offset:2048 sc1
 buffer_load_dwordx4 v[224:227], v191, s[4:7], s20 offen offset:3072 sc1
 s_waitcnt vmcnt(6)
 v_max_u32 v56, v40, v44
 v_mfma_f32_16x16x32_bf16 v[72:75], v[40:43], v[68:71], 0
 v_mfma_f32_16x16x32_bf16 v[72:75], v[44:47], v[68:71], v[72:75]
 s_waitcnt vmcnt(5)
 v_mfma_f32_16x16x32_bf16 v[72:75], v[48:51], v[68:71], v[72:75]
 s_waitcnt vmcnt(4)
 v_max3_u32 v56, v56, v48, v52
 v_mfma_f32_16x16x32_bf16 v[72:75], v[52:55], v[68:71], v[72:75]
 v_cmp_eq_u32 vcc, -1, v56
 s_cbranch_vccnz L_rpoll_242
 s_nop 5
 v_cvt_pk_bf16_f32 v76, v72, v73
 v_cvt_pk_bf16_f32 v77, v74, v75
 v_min_u32 v76, -2, v76
 buffer_store_dwordx2 v[76:77], v64, s[4:7], s90 offen sc1
 s_add_u32 s64, s64, 1
 s_cmp_lt_i32 s64, s28
 s_cbranch_scc1 L_t_loop2_228
 s_branch L_t_end_223
L_t_end_223:
 s_endpgm
L_role_o_1_abort:
 s_endpgm
.p2align 6
L_role_o_1:
 s_sub_u32 s74, s61, 12
 s_lshl_b32 s67, s60, 20
 s_lshl_b32 s66, s74, 8
 s_add_u32 s67, s67, s66
 s_add_u32 s12, s46, s67
 s_addc_u32 s13, s47, 0
 s_sub_u32 s14, 0x800000, s67
 s_mov_b32 s15, 0x00020000
 s_lshl_b32 s75, s60, 2
 s_add_u32 s75, s75, s62
 s_lshl_b32 s75, s75, 13
 s_add_u32 s75, s75, 0x6280000
 s_lshl_b32 s65, s60, 2
 s_add_u32 s65, s65, s62
 s_lshl_b32 s76, s65, 15
 s_add_u32 s76, s76, 0x200000
 s_lshl_b32 s71, s65, 7
 s_add_u32 s71, s71, 0x5010000
 s_lshl_b32 s77, s60, 14
 s_add_u32 s77, s77, 0x6300000
 s_min_u32 s66, s62, 2
 s_lshl_b32 s66, s66, 10
 s_add_u32 s77, s77, s66
 s_lshl_b32 s81, s60, 12
 s_lshl_b32 s66, s74, 7
 s_add_u32 s81, s81, s66
 s_add_u32 s81, s81, 0x6500000
 s_lshl_b32 s78, s60, 16
 s_mul_i32 s66, s62, 3072
 s_add_u32 s78, s78, s66
 s_add_u32 s78, s78, 0x6400000
 s_lshl_b32 s65, s74, 2
 s_add_u32 s65, s65, s62
 s_and_b32 s66, s60, 3
 s_mul_i32 s66, s66, 0
 s_lshr_b32 s67, s60, 2
 s_mul_i32 s67, s67, 0
 s_xor_b32 s66, s66, s67
 s_xor_b32 s68, s66, s65
 s_and_b32 s66, s68, 15
 s_lshl_b32 s66, s66, 9
 s_lshr_b32 s67, s68, 4
 s_lshl_b32 s67, s67, 14
 s_add_u32 s66, s66, s67
 s_lshl_b32 s67, s60, 15
 s_add_u32 s66, s66, s67
 s_add_u32 s79, s66, 0x6600000
 s_lshl_b32 s66, s65, 17
 s_add_u32 s82, s66, 0x3000000
 s_lshl_b32 s67, s60, 22
 s_add_u32 s82, s82, s67
 v_lshrrev_b32 v6, 4, v0
 v_lshlrev_b32 v7, 2, v6
 v_and_b32 v1, 15, v0
 v_xor_b32 v1, v1, v7
 v_lshlrev_b32 v1, 4, v1
 v_mul_u32_u24 v6, 2048, v6
 v_add_u32 v1, v1, v6
 v_bfe_u32 v6, v0, 3, 1
 v_bfe_u32 v7, v0, 2, 1
 v_lshl_add_u32 v6, v6, 2, v7
 v_bfe_u32 v7, v0, 1, 1
 v_and_b32 v2, 1, v0
 v_lshl_add_u32 v7, v2, 1, v7
 s_lshl_b32 s65, s62, 2
 v_add_u32 v7, s65, v7
 v_and_b32 v2, 3, v6
 v_lshlrev_b32 v2, 2, v2
 v_xor_b32 v7, v7, v2
 v_lshlrev_b32 v7, 4, v7
 v_lshrrev_b32 v2, 4, v0
 v_lshlrev_b32 v2, 3, v2
 v_add_u32 v2, v2, v6
 v_lshlrev_b32 v2, 8, v2
 v_add_u32 v2, v2, v7
 v_xor_b32 v3, 128, v2
 v_add_u32 v3, 512, v3
 v_add_u32 v4, 0x10000, v2
 v_add_u32 v5, 0x10000, v3
 s_mul_i32 s72, s62, 131072
 s_lshl_b32 s73, s62, 14
 v_lshrrev_b32 v6, 4, v0
 v_min_u32 v6, 1, v6
 v_lshlrev_b32 v6, 28, v6
 v_lshl_add_u32 v6, v0, 7, v6
 s_lshl_b32 s65, s74, 2
 s_add_u32 s65, s65, s62
 s_lshl_b32 s65, s65, 11
 v_add_u32 v8, s65, v6
 s_mov_b32 s84, 0
 buffer_load_dword v9, v8, s[8:11], s84 offen
 s_mov_b32 s84, 65536
 buffer_load_dword v9, v8, s[8:11], s84 offen
 s_mov_b32 s84, 131072
 buffer_load_dword v9, v8, s[8:11], s84 offen
 s_or_b32 s65, s62, s101
 s_cbranch_scc1 L_clm_243
 s_waitcnt lgkmcnt(0)
 s_bitcmp1_b32 s3, s61
 s_cbranch_scc0 L_clm_243
 s_mov_b32 s66, 1
 s_atomic_or s66, s[56:57], 36
 s_waitcnt lgkmcnt(0)
L_clm_243:
 s_sleep 32
 s_sleep 32
 s_sleep 32
 s_sleep 32
 s_add_u32 m0, s73, 0
 s_add_u32 s65, s72, 0
 buffer_load_dwordx4 v1, s[12:15], s65 offen nt lds
 s_add_u32 m0, s73, 1024
 s_add_u32 s65, s72, 8192
 buffer_load_dwordx4 v1, s[12:15], s65 offen nt lds
 s_add_u32 m0, s73, 2048
 s_add_u32 s65, s72, 16384
 buffer_load_dwordx4 v1, s[12:15], s65 offen nt lds
 s_add_u32 m0, s73, 3072
 s_add_u32 s65, s72, 24576
 buffer_load_dwordx4 v1, s[12:15], s65 offen nt lds
 s_add_u32 m0, s73, 4096
 s_add_u32 s65, s72, 32768
 buffer_load_dwordx4 v1, s[12:15], s65 offen nt lds
 s_add_u32 m0, s73, 5120
 s_add_u32 s65, s72, 40960
 buffer_load_dwordx4 v1, s[12:15], s65 offen nt lds
 s_add_u32 m0, s73, 6144
 s_add_u32 s65, s72, 49152
 buffer_load_dwordx4 v1, s[12:15], s65 offen nt lds
 s_add_u32 m0, s73, 7168
 s_add_u32 s65, s72, 57344
 buffer_load_dwordx4 v1, s[12:15], s65 offen nt lds
 s_add_u32 m0, s73, 8192
 s_add_u32 s65, s72, 65536
 buffer_load_dwordx4 v1, s[12:15], s65 offen nt lds
 s_add_u32 m0, s73, 9216
 s_add_u32 s65, s72, 73728
 buffer_load_dwordx4 v1, s[12:15], s65 offen nt lds
 s_add_u32 m0, s73, 10240
 s_add_u32 s65, s72, 81920
 buffer_load_dwordx4 v1, s[12:15], s65 offen nt lds
 s_add_u32 m0, s73, 11264
 s_add_u32 s65, s72, 90112
 buffer_load_dwordx4 v1, s[12:15], s65 offen nt lds
 s_add_u32 m0, s73, 12288
 s_add_u32 s65, s72, 98304
 buffer_load_dwordx4 v1, s[12:15], s65 offen nt lds
 s_add_u32 m0, s73, 13312
 s_add_u32 s65, s72, 106496
 buffer_load_dwordx4 v1, s[12:15], s65 offen nt lds
 s_add_u32 m0, s73, 14336
 s_add_u32 s65, s72, 114688
 buffer_load_dwordx4 v1, s[12:15], s65 offen nt lds
 s_add_u32 m0, s73, 15360
 s_add_u32 s65, s72, 122880
 buffer_load_dwordx4 v1, s[12:15], s65 offen nt lds
 s_add_u32 m0, s73, 65536
 s_add_u32 s65, s72, 524288
 buffer_load_dwordx4 v1, s[12:15], s65 offen nt lds
 s_add_u32 m0, s73, 66560
 s_add_u32 s65, s72, 532480
 buffer_load_dwordx4 v1, s[12:15], s65 offen nt lds
 s_add_u32 m0, s73, 67584
 s_add_u32 s65, s72, 540672
 buffer_load_dwordx4 v1, s[12:15], s65 offen nt lds
 s_add_u32 m0, s73, 68608
 s_add_u32 s65, s72, 548864
 buffer_load_dwordx4 v1, s[12:15], s65 offen nt lds
 s_add_u32 m0, s73, 69632
 s_add_u32 s65, s72, 557056
 buffer_load_dwordx4 v1, s[12:15], s65 offen nt lds
 s_add_u32 m0, s73, 70656
 s_add_u32 s65, s72, 565248
 buffer_load_dwordx4 v1, s[12:15], s65 offen nt lds
 s_add_u32 m0, s73, 71680
 s_add_u32 s65, s72, 573440
 buffer_load_dwordx4 v1, s[12:15], s65 offen nt lds
 s_add_u32 m0, s73, 72704
 s_add_u32 s65, s72, 581632
 buffer_load_dwordx4 v1, s[12:15], s65 offen nt lds
 s_add_u32 m0, s73, 73728
 s_add_u32 s65, s72, 589824
 buffer_load_dwordx4 v1, s[12:15], s65 offen nt lds
 s_add_u32 m0, s73, 74752
 s_add_u32 s65, s72, 598016
 buffer_load_dwordx4 v1, s[12:15], s65 offen nt lds
 s_add_u32 m0, s73, 75776
 s_add_u32 s65, s72, 606208
 buffer_load_dwordx4 v1, s[12:15], s65 offen nt lds
 s_add_u32 m0, s73, 76800
 s_add_u32 s65, s72, 614400
 buffer_load_dwordx4 v1, s[12:15], s65 offen nt lds
 s_add_u32 m0, s73, 77824
 s_add_u32 s65, s72, 622592
 buffer_load_dwordx4 v1, s[12:15], s65 offen nt lds
 s_add_u32 m0, s73, 78848
 s_add_u32 s65, s72, 630784
 buffer_load_dwordx4 v1, s[12:15], s65 offen nt lds
 s_add_u32 m0, s73, 79872
 s_add_u32 s65, s72, 638976
 buffer_load_dwordx4 v1, s[12:15], s65 offen nt lds
 s_add_u32 m0, s73, 80896
 s_add_u32 s65, s72, 647168
 buffer_load_dwordx4 v1, s[12:15], s65 offen nt lds
 v_lshlrev_b32 v12, 4, v0
 v_and_b32 v6, 31, v0
 v_lshlrev_b32 v6, 4, v6
 v_lshrrev_b32 v7, 5, v0
 v_lshl_add_u32 v13, v7, 13, v6
 s_lshl_b32 s65, s62, 10
 s_add_u32 s65, s65, 57344
 v_add_u32 v14, s65, v12
 s_lshl_b32 s65, s62, 11
 s_add_u32 s65, s65, 49152
 v_add_u32 v15, s65, v12
 v_mov_b32 v20, -1
 v_mov_b32 v21, -1
 v_mov_b32 v22, -1
 v_mov_b32 v23, -1
 v_mov_b32 v17, 0
 v_min_u32 v6, 1, v0
 v_lshlrev_b32 v16, 28, v6
 s_cmp_eq_u32 s62, 3
 s_cselect_b32 s65, 0, 0x10000000
 v_or_b32 v24, s65, v16
 v_bfe_u32 v6, v0, 2, 2
 v_lshlrev_b32 v32, 8, v6
 v_bfe_u32 v6, v0, 4, 1
 v_lshl_add_u32 v32, v6, 7, v32
 v_lshrrev_b32 v6, 5, v0
 v_lshl_add_u32 v32, v6, 6, v32
 v_and_b32 v6, 3, v0
 v_lshl_add_u32 v32, v6, 4, v32
 v_and_b32 v6, 8, v0
 v_cmp_ne_u32 vcc, 0, v6
 v_mov_b32 v33, 0x44444444
 v_mov_b32 v6, 0xeeeeeeee
 s_nop 1
 v_cndmask_b32 v33, v33, v6, vcc
 v_and_b32 v6, 2, v0
 v_cmp_ne_u32 vcc, 0, v6
 v_mov_b32 v34, 0x44444444
 v_mov_b32 v6, 0xeeeeeeee
 s_nop 1
 v_cndmask_b32 v34, v34, v6, vcc
 v_and_b32 v6, 2, v0
 v_cmp_eq_u32 s[92:93], 0, v6
 v_cmp_ne_u32 s[94:95], 0, v6
 s_waitcnt vmcnt(16)
 s_barrier
 ds_read_b64_tr_b16 v[36:37], v2 offset:0
 ds_read_b64_tr_b16 v[38:39], v3 offset:0
 ds_read_b64_tr_b16 v[44:45], v2 offset:8
 ds_read_b64_tr_b16 v[46:47], v3 offset:8
 ds_read_b64_tr_b16 v[40:41], v2 offset:8192
 ds_read_b64_tr_b16 v[42:43], v3 offset:8192
 ds_read_b64_tr_b16 v[48:49], v2 offset:8200
 ds_read_b64_tr_b16 v[50:51], v3 offset:8200
 ds_read_b64_tr_b16 v[52:53], v2 offset:16384
 ds_read_b64_tr_b16 v[54:55], v3 offset:16384
 ds_read_b64_tr_b16 v[60:61], v2 offset:16392
 ds_read_b64_tr_b16 v[62:63], v3 offset:16392
 ds_read_b64_tr_b16 v[56:57], v2 offset:24576
 ds_read_b64_tr_b16 v[58:59], v3 offset:24576
 ds_read_b64_tr_b16 v[64:65], v2 offset:24584
 ds_read_b64_tr_b16 v[66:67], v3 offset:24584
 ds_read_b64_tr_b16 v[68:69], v2 offset:32768
 ds_read_b64_tr_b16 v[70:71], v3 offset:32768
 ds_read_b64_tr_b16 v[76:77], v2 offset:32776
 ds_read_b64_tr_b16 v[78:79], v3 offset:32776
 ds_read_b64_tr_b16 v[72:73], v2 offset:40960
 ds_read_b64_tr_b16 v[74:75], v3 offset:40960
 ds_read_b64_tr_b16 v[80:81], v2 offset:40968
 ds_read_b64_tr_b16 v[82:83], v3 offset:40968
 ds_read_b64_tr_b16 v[84:85], v2 offset:49152
 ds_read_b64_tr_b16 v[86:87], v3 offset:49152
 ds_read_b64_tr_b16 v[92:93], v2 offset:49160
 ds_read_b64_tr_b16 v[94:95], v3 offset:49160
 ds_read_b64_tr_b16 v[88:89], v2 offset:57344
 ds_read_b64_tr_b16 v[90:91], v3 offset:57344
 ds_read_b64_tr_b16 v[96:97], v2 offset:57352
 ds_read_b64_tr_b16 v[98:99], v3 offset:57352
 s_waitcnt lgkmcnt(0)
 s_mov_b64 vcc, s[92:93]
 v_cndmask_b32_dpp v11, v44, v36, vcc quad_perm:[0,1,0,1] row_mask:0xf bank_mask:0xf
 v_accvgpr_write_b32 a0, v11
 s_nop 0
 v_cndmask_b32_dpp v11, v45, v37, vcc quad_perm:[0,1,0,1] row_mask:0xf bank_mask:0xf
 v_accvgpr_write_b32 a1, v11
 s_nop 0
 v_cndmask_b32_dpp v11, v46, v38, vcc quad_perm:[0,1,0,1] row_mask:0xf bank_mask:0xf
 v_accvgpr_write_b32 a2, v11
 s_nop 0
 v_cndmask_b32_dpp v11, v47, v39, vcc quad_perm:[0,1,0,1] row_mask:0xf bank_mask:0xf
 v_accvgpr_write_b32 a3, v11
 s_nop 0
 v_cndmask_b32_dpp v11, v48, v40, vcc quad_perm:[0,1,0,1] row_mask:0xf bank_mask:0xf
 v_accvgpr_write_b32 a4, v11
 s_nop 0
 v_cndmask_b32_dpp v11, v49, v41, vcc quad_perm:[0,1,0,1] row_mask:0xf bank_mask:0xf
 v_accvgpr_write_b32 a5, v11
 s_nop 0
 v_cndmask_b32_dpp v11, v50, v42, vcc quad_perm:[0,1,0,1] row_mask:0xf bank_mask:0xf
 v_accvgpr_write_b32 a6, v11
 s_nop 0
 v_cndmask_b32_dpp v11, v51, v43, vcc quad_perm:[0,1,0,1] row_mask:0xf bank_mask:0xf
 v_accvgpr_write_b32 a7, v11
 s_nop 0
 v_cndmask_b32_dpp v11, v60, v52, vcc quad_perm:[0,1,0,1] row_mask:0xf bank_mask:0xf
 v_accvgpr_write_b32 a16, v11
 s_nop 0
 v_cndmask_b32_dpp v11, v61, v53, vcc quad_perm:[0,1,0,1] row_mask:0xf bank_mask:0xf
 v_accvgpr_write_b32 a17, v11
 s_nop 0
 v_cndmask_b32_dpp v11, v62, v54, vcc quad_perm:[0,1,0,1] row_mask:0xf bank_mask:0xf
 v_accvgpr_write_b32 a18, v11
 s_nop 0
 v_cndmask_b32_dpp v11, v63, v55, vcc quad_perm:[0,1,0,1] row_mask:0xf bank_mask:0xf
 v_accvgpr_write_b32 a19, v11
 s_nop 0
 v_cndmask_b32_dpp v11, v64, v56, vcc quad_perm:[0,1,0,1] row_mask:0xf bank_mask:0xf
 v_accvgpr_write_b32 a20, v11
 s_nop 0
 v_cndmask_b32_dpp v11, v65, v57, vcc quad_perm:[0,1,0,1] row_mask:0xf bank_mask:0xf
 v_accvgpr_write_b32 a21, v11
 s_nop 0
 v_cndmask_b32_dpp v11, v66, v58, vcc quad_perm:[0,1,0,1] row_mask:0xf bank_mask:0xf
 v_accvgpr_write_b32 a22, v11
 s_nop 0
 v_cndmask_b32_dpp v11, v67, v59, vcc quad_perm:[0,1,0,1] row_mask:0xf bank_mask:0xf
 v_accvgpr_write_b32 a23, v11
 s_nop 0
 v_cndmask_b32_dpp v11, v76, v68, vcc quad_perm:[0,1,0,1] row_mask:0xf bank_mask:0xf
 v_accvgpr_write_b32 a32, v11
 s_nop 0
 v_cndmask_b32_dpp v11, v77, v69, vcc quad_perm:[0,1,0,1] row_mask:0xf bank_mask:0xf
 v_accvgpr_write_b32 a33, v11
 s_nop 0
 v_cndmask_b32_dpp v11, v78, v70, vcc quad_perm:[0,1,0,1] row_mask:0xf bank_mask:0xf
 v_accvgpr_write_b32 a34, v11
 s_nop 0
 v_cndmask_b32_dpp v11, v79, v71, vcc quad_perm:[0,1,0,1] row_mask:0xf bank_mask:0xf
 v_accvgpr_write_b32 a35, v11
 s_nop 0
 v_cndmask_b32_dpp v11, v80, v72, vcc quad_perm:[0,1,0,1] row_mask:0xf bank_mask:0xf
 v_accvgpr_write_b32 a36, v11
 s_nop 0
 v_cndmask_b32_dpp v11, v81, v73, vcc quad_perm:[0,1,0,1] row_mask:0xf bank_mask:0xf
 v_accvgpr_write_b32 a37, v11
 s_nop 0
 v_cndmask_b32_dpp v11, v82, v74, vcc quad_perm:[0,1,0,1] row_mask:0xf bank_mask:0xf
 v_accvgpr_write_b32 a38, v11
 s_nop 0
 v_cndmask_b32_dpp v11, v83, v75, vcc quad_perm:[0,1,0,1] row_mask:0xf bank_mask:0xf
 v_accvgpr_write_b32 a39, v11
 s_nop 0
 v_cndmask_b32_dpp v11, v92, v84, vcc quad_perm:[0,1,0,1] row_mask:0xf bank_mask:0xf
 v_accvgpr_write_b32 a48, v11
 s_nop 0
 v_cndmask_b32_dpp v11, v93, v85, vcc quad_perm:[0,1,0,1] row_mask:0xf bank_mask:0xf
 v_accvgpr_write_b32 a49, v11
 s_nop 0
 v_cndmask_b32_dpp v11, v94, v86, vcc quad_perm:[0,1,0,1] row_mask:0xf bank_mask:0xf
 v_accvgpr_write_b32 a50, v11
 s_nop 0
 v_cndmask_b32_dpp v11, v95, v87, vcc quad_perm:[0,1,0,1] row_mask:0xf bank_mask:0xf
 v_accvgpr_write_b32 a51, v11
 s_nop 0
 v_cndmask_b32_dpp v11, v96, v88, vcc quad_perm:[0,1,0,1] row_mask:0xf bank_mask:0xf
 v_accvgpr_write_b32 a52, v11
 s_nop 0
 v_cndmask_b32_dpp v11, v97, v89, vcc quad_perm:[0,1,0,1] row_mask:0xf bank_mask:0xf
 v_accvgpr_write_b32 a53, v11
 s_nop 0
 v_cndmask_b32_dpp v11, v98, v90, vcc quad_perm:[0,1,0,1] row_mask:0xf bank_mask:0xf
 v_accvgpr_write_b32 a54, v11
 s_nop 0
 v_cndmask_b32_dpp v11, v99, v91, vcc quad_perm:[0,1,0,1] row_mask:0xf bank_mask:0xf
 v_accvgpr_write_b32 a55, v11
 s_nop 0
 s_mov_b64 vcc, s[94:95]
 v_cndmask_b32_dpp v11, v36, v44, vcc quad_perm:[2,3,2,3] row_mask:0xf bank_mask:0xf
 v_accvgpr_write_b32 a8, v11
 s_nop 0
 v_cndmask_b32_dpp v11, v37, v45, vcc quad_perm:[2,3,2,3] row_mask:0xf bank_mask:0xf
 v_accvgpr_write_b32 a9, v11
 s_nop 0
 v_cndmask_b32_dpp v11, v38, v46, vcc quad_perm:[2,3,2,3] row_mask:0xf bank_mask:0xf
 v_accvgpr_write_b32 a10, v11
 s_nop 0
 v_cndmask_b32_dpp v11, v39, v47, vcc quad_perm:[2,3,2,3] row_mask:0xf bank_mask:0xf
 v_accvgpr_write_b32 a11, v11
 s_nop 0
 v_cndmask_b32_dpp v11, v40, v48, vcc quad_perm:[2,3,2,3] row_mask:0xf bank_mask:0xf
 v_accvgpr_write_b32 a12, v11
 s_nop 0
 v_cndmask_b32_dpp v11, v41, v49, vcc quad_perm:[2,3,2,3] row_mask:0xf bank_mask:0xf
 v_accvgpr_write_b32 a13, v11
 s_nop 0
 v_cndmask_b32_dpp v11, v42, v50, vcc quad_perm:[2,3,2,3] row_mask:0xf bank_mask:0xf
 v_accvgpr_write_b32 a14, v11
 s_nop 0
 v_cndmask_b32_dpp v11, v43, v51, vcc quad_perm:[2,3,2,3] row_mask:0xf bank_mask:0xf
 v_accvgpr_write_b32 a15, v11
 s_nop 0
 v_cndmask_b32_dpp v11, v52, v60, vcc quad_perm:[2,3,2,3] row_mask:0xf bank_mask:0xf
 v_accvgpr_write_b32 a24, v11
 s_nop 0
 v_cndmask_b32_dpp v11, v53, v61, vcc quad_perm:[2,3,2,3] row_mask:0xf bank_mask:0xf
 v_accvgpr_write_b32 a25, v11
 s_nop 0
 v_cndmask_b32_dpp v11, v54, v62, vcc quad_perm:[2,3,2,3] row_mask:0xf bank_mask:0xf
 v_accvgpr_write_b32 a26, v11
 s_nop 0
 v_cndmask_b32_dpp v11, v55, v63, vcc quad_perm:[2,3,2,3] row_mask:0xf bank_mask:0xf
 v_accvgpr_write_b32 a27, v11
 s_nop 0
 v_cndmask_b32_dpp v11, v56, v64, vcc quad_perm:[2,3,2,3] row_mask:0xf bank_mask:0xf
 v_accvgpr_write_b32 a28, v11
 s_nop 0
 v_cndmask_b32_dpp v11, v57, v65, vcc quad_perm:[2,3,2,3] row_mask:0xf bank_mask:0xf
 v_accvgpr_write_b32 a29, v11
 s_nop 0
 v_cndmask_b32_dpp v11, v58, v66, vcc quad_perm:[2,3,2,3] row_mask:0xf bank_mask:0xf
 v_accvgpr_write_b32 a30, v11
 s_nop 0
 v_cndmask_b32_dpp v11, v59, v67, vcc quad_perm:[2,3,2,3] row_mask:0xf bank_mask:0xf
 v_accvgpr_write_b32 a31, v11
 s_nop 0
 v_cndmask_b32_dpp v11, v68, v76, vcc quad_perm:[2,3,2,3] row_mask:0xf bank_mask:0xf
 v_accvgpr_write_b32 a40, v11
 s_nop 0
 v_cndmask_b32_dpp v11, v69, v77, vcc quad_perm:[2,3,2,3] row_mask:0xf bank_mask:0xf
 v_accvgpr_write_b32 a41, v11
 s_nop 0
 v_cndmask_b32_dpp v11, v70, v78, vcc quad_perm:[2,3,2,3] row_mask:0xf bank_mask:0xf
 v_accvgpr_write_b32 a42, v11
 s_nop 0
 v_cndmask_b32_dpp v11, v71, v79, vcc quad_perm:[2,3,2,3] row_mask:0xf bank_mask:0xf
 v_accvgpr_write_b32 a43, v11
 s_nop 0
 v_cndmask_b32_dpp v11, v72, v80, vcc quad_perm:[2,3,2,3] row_mask:0xf bank_mask:0xf
 v_accvgpr_write_b32 a44, v11
 s_nop 0
 v_cndmask_b32_dpp v11, v73, v81, vcc quad_perm:[2,3,2,3] row_mask:0xf bank_mask:0xf
 v_accvgpr_write_b32 a45, v11
 s_nop 0
 v_cndmask_b32_dpp v11, v74, v82, vcc quad_perm:[2,3,2,3] row_mask:0xf bank_mask:0xf
 v_accvgpr_write_b32 a46, v11
 s_nop 0
 v_cndmask_b32_dpp v11, v75, v83, vcc quad_perm:[2,3,2,3] row_mask:0xf bank_mask:0xf
 v_accvgpr_write_b32 a47, v11
 s_nop 0
 v_cndmask_b32_dpp v11, v84, v92, vcc quad_perm:[2,3,2,3] row_mask:0xf bank_mask:0xf
 v_accvgpr_write_b32 a56, v11
 s_nop 0
 v_cndmask_b32_dpp v11, v85, v93, vcc quad_perm:[2,3,2,3] row_mask:0xf bank_mask:0xf
 v_accvgpr_write_b32 a57, v11
 s_nop 0
 v_cndmask_b32_dpp v11, v86, v94, vcc quad_perm:[2,3,2,3] row_mask:0xf bank_mask:0xf
 v_accvgpr_write_b32 a58, v11
 s_nop 0
 v_cndmask_b32_dpp v11, v87, v95, vcc quad_perm:[2,3,2,3] row_mask:0xf bank_mask:0xf
 v_accvgpr_write_b32 a59, v11
 s_nop 0
 v_cndmask_b32_dpp v11, v88, v96, vcc quad_perm:[2,3,2,3] row_mask:0xf bank_mask:0xf
 v_accvgpr_write_b32 a60, v11
 s_nop 0
 v_cndmask_b32_dpp v11, v89, v97, vcc quad_perm:[2,3,2,3] row_mask:0xf bank_mask:0xf
 v_accvgpr_write_b32 a61, v11
 s_nop 0
 v_cndmask_b32_dpp v11, v90, v98, vcc quad_perm:[2,3,2,3] row_mask:0xf bank_mask:0xf
 v_accvgpr_write_b32 a62, v11
 s_nop 0
 v_cndmask_b32_dpp v11, v91, v99, vcc quad_perm:[2,3,2,3] row_mask:0xf bank_mask:0xf
 v_accvgpr_write_b32 a63, v11
 s_nop 0
 s_waitcnt vmcnt(0)
 s_barrier
 ds_read_b64_tr_b16 v[36:37], v4 offset:0
 ds_read_b64_tr_b16 v[38:39], v5 offset:0
 ds_read_b64_tr_b16 v[44:45], v4 offset:8
 ds_read_b64_tr_b16 v[46:47], v5 offset:8
 ds_read_b64_tr_b16 v[40:41], v4 offset:8192
 ds_read_b64_tr_b16 v[42:43], v5 offset:8192
 ds_read_b64_tr_b16 v[48:49], v4 offset:8200
 ds_read_b64_tr_b16 v[50:51], v5 offset:8200
 ds_read_b64_tr_b16 v[52:53], v4 offset:16384
 ds_read_b64_tr_b16 v[54:55], v5 offset:16384
 ds_read_b64_tr_b16 v[60:61], v4 offset:16392
 ds_read_b64_tr_b16 v[62:63], v5 offset:16392
 ds_read_b64_tr_b16 v[56:57], v4 offset:24576
 ds_read_b64_tr_b16 v[58:59], v5 offset:24576
 ds_read_b64_tr_b16 v[64:65], v4 offset:24584
 ds_read_b64_tr_b16 v[66:67], v5 offset:24584
 ds_read_b64_tr_b16 v[68:69], v4 offset:32768
 ds_read_b64_tr_b16 v[70:71], v5 offset:32768
 ds_read_b64_tr_b16 v[76:77], v4 offset:32776
 ds_read_b64_tr_b16 v[78:79], v5 offset:32776
 ds_read_b64_tr_b16 v[72:73], v4 offset:40960
 ds_read_b64_tr_b16 v[74:75], v5 offset:40960
 ds_read_b64_tr_b16 v[80:81], v4 offset:40968
 ds_read_b64_tr_b16 v[82:83], v5 offset:40968
 ds_read_b64_tr_b16 v[84:85], v4 offset:49152
 ds_read_b64_tr_b16 v[86:87], v5 offset:49152
 ds_read_b64_tr_b16 v[92:93], v4 offset:49160
 ds_read_b64_tr_b16 v[94:95], v5 offset:49160
 ds_read_b64_tr_b16 v[88:89], v4 offset:57344
 ds_read_b64_tr_b16 v[90:91], v5 offset:57344
 ds_read_b64_tr_b16 v[96:97], v4 offset:57352
 ds_read_b64_tr_b16 v[98:99], v5 offset:57352
 s_waitcnt lgkmcnt(0)
 s_mov_b64 vcc, s[92:93]
 v_cndmask_b32_dpp v11, v44, v36, vcc quad_perm:[0,1,0,1] row_mask:0xf bank_mask:0xf
 v_accvgpr_write_b32 a64, v11
 s_nop 0
 v_cndmask_b32_dpp v11, v45, v37, vcc quad_perm:[0,1,0,1] row_mask:0xf bank_mask:0xf
 v_accvgpr_write_b32 a65, v11
 s_nop 0
 v_cndmask_b32_dpp v11, v46, v38, vcc quad_perm:[0,1,0,1] row_mask:0xf bank_mask:0xf
 v_accvgpr_write_b32 a66, v11
 s_nop 0
 v_cndmask_b32_dpp v11, v47, v39, vcc quad_perm:[0,1,0,1] row_mask:0xf bank_mask:0xf
 v_accvgpr_write_b32 a67, v11
 s_nop 0
 v_cndmask_b32_dpp v11, v48, v40, vcc quad_perm:[0,1,0,1] row_mask:0xf bank_mask:0xf
 v_accvgpr_write_b32 a68, v11
 s_nop 0
 v_cndmask_b32_dpp v11, v49, v41, vcc quad_perm:[0,1,0,1] row_mask:0xf bank_mask:0xf
 v_accvgpr_write_b32 a69, v11
 s_nop 0
 v_cndmask_b32_dpp v11, v50, v42, vcc quad_perm:[0,1,0,1] row_mask:0xf bank_mask:0xf
 v_accvgpr_write_b32 a70, v11
 s_nop 0
 v_cndmask_b32_dpp v11, v51, v43, vcc quad_perm:[0,1,0,1] row_mask:0xf bank_mask:0xf
 v_accvgpr_write_b32 a71, v11
 s_nop 0
 v_cndmask_b32_dpp v11, v60, v52, vcc quad_perm:[0,1,0,1] row_mask:0xf bank_mask:0xf
 v_accvgpr_write_b32 a80, v11
 s_nop 0
 v_cndmask_b32_dpp v11, v61, v53, vcc quad_perm:[0,1,0,1] row_mask:0xf bank_mask:0xf
 v_accvgpr_write_b32 a81, v11
 s_nop 0
 v_cndmask_b32_dpp v11, v62, v54, vcc quad_perm:[0,1,0,1] row_mask:0xf bank_mask:0xf
 v_accvgpr_write_b32 a82, v11
 s_nop 0
 v_cndmask_b32_dpp v11, v63, v55, vcc quad_perm:[0,1,0,1] row_mask:0xf bank_mask:0xf
 v_accvgpr_write_b32 a83, v11
 s_nop 0
 v_cndmask_b32_dpp v11, v64, v56, vcc quad_perm:[0,1,0,1] row_mask:0xf bank_mask:0xf
 v_accvgpr_write_b32 a84, v11
 s_nop 0
 v_cndmask_b32_dpp v11, v65, v57, vcc quad_perm:[0,1,0,1] row_mask:0xf bank_mask:0xf
 v_accvgpr_write_b32 a85, v11
 s_nop 0
 v_cndmask_b32_dpp v11, v66, v58, vcc quad_perm:[0,1,0,1] row_mask:0xf bank_mask:0xf
 v_accvgpr_write_b32 a86, v11
 s_nop 0
 v_cndmask_b32_dpp v11, v67, v59, vcc quad_perm:[0,1,0,1] row_mask:0xf bank_mask:0xf
 v_accvgpr_write_b32 a87, v11
 s_nop 0
 v_cndmask_b32_dpp v11, v76, v68, vcc quad_perm:[0,1,0,1] row_mask:0xf bank_mask:0xf
 v_accvgpr_write_b32 a96, v11
 s_nop 0
 v_cndmask_b32_dpp v11, v77, v69, vcc quad_perm:[0,1,0,1] row_mask:0xf bank_mask:0xf
 v_accvgpr_write_b32 a97, v11
 s_nop 0
 v_cndmask_b32_dpp v11, v78, v70, vcc quad_perm:[0,1,0,1] row_mask:0xf bank_mask:0xf
 v_accvgpr_write_b32 a98, v11
 s_nop 0
 v_cndmask_b32_dpp v11, v79, v71, vcc quad_perm:[0,1,0,1] row_mask:0xf bank_mask:0xf
 v_accvgpr_write_b32 a99, v11
 s_nop 0
 v_cndmask_b32_dpp v11, v80, v72, vcc quad_perm:[0,1,0,1] row_mask:0xf bank_mask:0xf
 v_accvgpr_write_b32 a100, v11
 s_nop 0
 v_cndmask_b32_dpp v11, v81, v73, vcc quad_perm:[0,1,0,1] row_mask:0xf bank_mask:0xf
 v_accvgpr_write_b32 a101, v11
 s_nop 0
 v_cndmask_b32_dpp v11, v82, v74, vcc quad_perm:[0,1,0,1] row_mask:0xf bank_mask:0xf
 v_accvgpr_write_b32 a102, v11
 s_nop 0
 v_cndmask_b32_dpp v11, v83, v75, vcc quad_perm:[0,1,0,1] row_mask:0xf bank_mask:0xf
 v_accvgpr_write_b32 a103, v11
 s_nop 0
 v_cndmask_b32_dpp v11, v92, v84, vcc quad_perm:[0,1,0,1] row_mask:0xf bank_mask:0xf
 v_accvgpr_write_b32 a112, v11
 s_nop 0
 v_cndmask_b32_dpp v11, v93, v85, vcc quad_perm:[0,1,0,1] row_mask:0xf bank_mask:0xf
 v_accvgpr_write_b32 a113, v11
 s_nop 0
 v_cndmask_b32_dpp v11, v94, v86, vcc quad_perm:[0,1,0,1] row_mask:0xf bank_mask:0xf
 v_accvgpr_write_b32 a114, v11
 s_nop 0
 v_cndmask_b32_dpp v11, v95, v87, vcc quad_perm:[0,1,0,1] row_mask:0xf bank_mask:0xf
 v_accvgpr_write_b32 a115, v11
 s_nop 0
 v_cndmask_b32_dpp v11, v96, v88, vcc quad_perm:[0,1,0,1] row_mask:0xf bank_mask:0xf
 v_accvgpr_write_b32 a116, v11
 s_nop 0
 v_cndmask_b32_dpp v11, v97, v89, vcc quad_perm:[0,1,0,1] row_mask:0xf bank_mask:0xf
 v_accvgpr_write_b32 a117, v11
 s_nop 0
 v_cndmask_b32_dpp v11, v98, v90, vcc quad_perm:[0,1,0,1] row_mask:0xf bank_mask:0xf
 v_accvgpr_write_b32 a118, v11
 s_nop 0
 v_cndmask_b32_dpp v11, v99, v91, vcc quad_perm:[0,1,0,1] row_mask:0xf bank_mask:0xf
 v_accvgpr_write_b32 a119, v11
 s_nop 0
 s_mov_b64 vcc, s[94:95]
 v_cndmask_b32_dpp v11, v36, v44, vcc quad_perm:[2,3,2,3] row_mask:0xf bank_mask:0xf
 v_accvgpr_write_b32 a72, v11
 s_nop 0
 v_cndmask_b32_dpp v11, v37, v45, vcc quad_perm:[2,3,2,3] row_mask:0xf bank_mask:0xf
 v_accvgpr_write_b32 a73, v11
 s_nop 0
 v_cndmask_b32_dpp v11, v38, v46, vcc quad_perm:[2,3,2,3] row_mask:0xf bank_mask:0xf
 v_accvgpr_write_b32 a74, v11
 s_nop 0
 v_cndmask_b32_dpp v11, v39, v47, vcc quad_perm:[2,3,2,3] row_mask:0xf bank_mask:0xf
 v_accvgpr_write_b32 a75, v11
 s_nop 0
 v_cndmask_b32_dpp v11, v40, v48, vcc quad_perm:[2,3,2,3] row_mask:0xf bank_mask:0xf
 v_accvgpr_write_b32 a76, v11
 s_nop 0
 v_cndmask_b32_dpp v11, v41, v49, vcc quad_perm:[2,3,2,3] row_mask:0xf bank_mask:0xf
 v_accvgpr_write_b32 a77, v11
 s_nop 0
 v_cndmask_b32_dpp v11, v42, v50, vcc quad_perm:[2,3,2,3] row_mask:0xf bank_mask:0xf
 v_accvgpr_write_b32 a78, v11
 s_nop 0
 v_cndmask_b32_dpp v11, v43, v51, vcc quad_perm:[2,3,2,3] row_mask:0xf bank_mask:0xf
 v_accvgpr_write_b32 a79, v11
 s_nop 0
 v_cndmask_b32_dpp v11, v52, v60, vcc quad_perm:[2,3,2,3] row_mask:0xf bank_mask:0xf
 v_accvgpr_write_b32 a88, v11
 s_nop 0
 v_cndmask_b32_dpp v11, v53, v61, vcc quad_perm:[2,3,2,3] row_mask:0xf bank_mask:0xf
 v_accvgpr_write_b32 a89, v11
 s_nop 0
 v_cndmask_b32_dpp v11, v54, v62, vcc quad_perm:[2,3,2,3] row_mask:0xf bank_mask:0xf
 v_accvgpr_write_b32 a90, v11
 s_nop 0
 v_cndmask_b32_dpp v11, v55, v63, vcc quad_perm:[2,3,2,3] row_mask:0xf bank_mask:0xf
 v_accvgpr_write_b32 a91, v11
 s_nop 0
 v_cndmask_b32_dpp v11, v56, v64, vcc quad_perm:[2,3,2,3] row_mask:0xf bank_mask:0xf
 v_accvgpr_write_b32 a92, v11
 s_nop 0
 v_cndmask_b32_dpp v11, v57, v65, vcc quad_perm:[2,3,2,3] row_mask:0xf bank_mask:0xf
 v_accvgpr_write_b32 a93, v11
 s_nop 0
 v_cndmask_b32_dpp v11, v58, v66, vcc quad_perm:[2,3,2,3] row_mask:0xf bank_mask:0xf
 v_accvgpr_write_b32 a94, v11
 s_nop 0
 v_cndmask_b32_dpp v11, v59, v67, vcc quad_perm:[2,3,2,3] row_mask:0xf bank_mask:0xf
 v_accvgpr_write_b32 a95, v11
 s_nop 0
 v_cndmask_b32_dpp v11, v68, v76, vcc quad_perm:[2,3,2,3] row_mask:0xf bank_mask:0xf
 v_accvgpr_write_b32 a104, v11
 s_nop 0
 v_cndmask_b32_dpp v11, v69, v77, vcc quad_perm:[2,3,2,3] row_mask:0xf bank_mask:0xf
 v_accvgpr_write_b32 a105, v11
 s_nop 0
 v_cndmask_b32_dpp v11, v70, v78, vcc quad_perm:[2,3,2,3] row_mask:0xf bank_mask:0xf
 v_accvgpr_write_b32 a106, v11
 s_nop 0
 v_cndmask_b32_dpp v11, v71, v79, vcc quad_perm:[2,3,2,3] row_mask:0xf bank_mask:0xf
 v_accvgpr_write_b32 a107, v11
 s_nop 0
 v_cndmask_b32_dpp v11, v72, v80, vcc quad_perm:[2,3,2,3] row_mask:0xf bank_mask:0xf
 v_accvgpr_write_b32 a108, v11
 s_nop 0
 v_cndmask_b32_dpp v11, v73, v81, vcc quad_perm:[2,3,2,3] row_mask:0xf bank_mask:0xf
 v_accvgpr_write_b32 a109, v11
 s_nop 0
 v_cndmask_b32_dpp v11, v74, v82, vcc quad_perm:[2,3,2,3] row_mask:0xf bank_mask:0xf
 v_accvgpr_write_b32 a110, v11
 s_nop 0
 v_cndmask_b32_dpp v11, v75, v83, vcc quad_perm:[2,3,2,3] row_mask:0xf bank_mask:0xf
 v_accvgpr_write_b32 a111, v11
 s_nop 0
 v_cndmask_b32_dpp v11, v84, v92, vcc quad_perm:[2,3,2,3] row_mask:0xf bank_mask:0xf
 v_accvgpr_write_b32 a120, v11
 s_nop 0
 v_cndmask_b32_dpp v11, v85, v93, vcc quad_perm:[2,3,2,3] row_mask:0xf bank_mask:0xf
 v_accvgpr_write_b32 a121, v11
 s_nop 0
 v_cndmask_b32_dpp v11, v86, v94, vcc quad_perm:[2,3,2,3] row_mask:0xf bank_mask:0xf
 v_accvgpr_write_b32 a122, v11
 s_nop 0
 v_cndmask_b32_dpp v11, v87, v95, vcc quad_perm:[2,3,2,3] row_mask:0xf bank_mask:0xf
 v_accvgpr_write_b32 a123, v11
 s_nop 0
 v_cndmask_b32_dpp v11, v88, v96, vcc quad_perm:[2,3,2,3] row_mask:0xf bank_mask:0xf
 v_accvgpr_write_b32 a124, v11
 s_nop 0
 v_cndmask_b32_dpp v11, v89, v97, vcc quad_perm:[2,3,2,3] row_mask:0xf bank_mask:0xf
 v_accvgpr_write_b32 a125, v11
 s_nop 0
 v_cndmask_b32_dpp v11, v90, v98, vcc quad_perm:[2,3,2,3] row_mask:0xf bank_mask:0xf
 v_accvgpr_write_b32 a126, v11
 s_nop 0
 v_cndmask_b32_dpp v11, v91, v99, vcc quad_perm:[2,3,2,3] row_mask:0xf bank_mask:0xf
 v_accvgpr_write_b32 a127, v11
 s_nop 0
 s_barrier
 v_lshlrev_b32 v6, 2, v0
 s_lshr_b32 s66, s101, 2
 s_add_u32 s66, s66, 1
 s_branch L_hs1_245
L_hs_244:
 s_sleep 8
 s_sub_u32 s63, s63, 1
 s_cbranch_scc1 L_role_o_1_abort
L_hs1_245:
 buffer_load_dword v7, v6, s[16:19], 0 offen sc1
 s_waitcnt vmcnt(0)
 v_readlane_b32 s65, v7, s66
 s_cmp_eq_u32 s101, 128
 s_cbranch_scc1 L_hs2_246
 s_cmp_eq_u32 s101, 64
 s_cbranch_scc1 L_hs3_247
 v_readlane_b32 s67, v7, 9
 v_cmp_eq_u32 s[96:97], -1, v7
 s_mov_b32 vcc_lo, 0x20202020
 s_mov_b32 vcc_hi, 0x20202020
 s_nop 1
 s_cmp_lg_u32 s67, 0
 s_cbranch_scc1 L_retry
 s_andn2_b64 s[96:97], vcc, s[96:97]
 s_cbranch_scc1 L_hs_244
 s_branch L_hs2_246
L_hs3_247:
 v_readlane_b32 s67, v7, 10
 v_cmp_eq_u32 s[96:97], 32, v7
 s_mov_b32 vcc_lo, 0x01010101
 s_mov_b32 vcc_hi, 0x01010101
 s_nop 1
 s_cmp_lg_u32 s67, 0
 s_cbranch_scc1 L_fallback
 s_andn2_b64 s[96:97], vcc, s[96:97]
 s_cbranch_scc1 L_hs_244
L_hs2_246:
 s_cmp_ge_u32 s65, 64
 s_cbranch_scc0 L_hs_244
 s_mov_b32 s64, -1
 buffer_load_dwordx4 v[216:219], v17, s[4:7], s71 offen sc1
 s_add_u32 s65, s64, 1
 s_and_b32 s66, s65, 3
 s_lshl_b32 s66, s66, 13
 s_add_u32 s89, s66, s76
 s_add_u32 s90, s89, 4096
 s_branch L_or_xd1_249
L_or_xd_248:
 s_sleep 4
 buffer_load_dwordx4 v[216:219], v17, s[4:7], s71 offen sc1
 s_sub_u32 s63, s63, 1
 s_cbranch_scc1 L_role_o_1_abort
L_or_xd1_249:
 s_waitcnt vmcnt(0)
 v_min3_u32 v11, v216, v217, v218
 v_min_u32 v11, v11, v219
 v_cmp_ge_u32 vcc, s65, v11
 s_cbranch_vccnz L_or_xd_248
 s_lshl_b32 m0, s62, 13
 s_add_u32 m0, m0, 0
 s_nop 0
 buffer_load_dwordx4 v12, s[4:7], s89 offen offset:0 sc1 lds
 buffer_load_dwordx4 v12, s[4:7], s89 offen offset:1024 sc1 lds
 buffer_load_dwordx4 v12, s[4:7], s89 offen offset:2048 sc1 lds
 buffer_load_dwordx4 v12, s[4:7], s89 offen offset:3072 sc1 lds
 s_lshl_b32 m0, s62, 13
 s_add_u32 m0, m0, 4096
 s_nop 0
 buffer_load_dwordx4 v12, s[4:7], s90 offen offset:0 sc1 lds
 buffer_load_dwordx4 v12, s[4:7], s90 offen offset:1024 sc1 lds
 buffer_load_dwordx4 v12, s[4:7], s90 offen offset:2048 sc1 lds
 buffer_load_dwordx4 v12, s[4:7], s90 offen offset:3072 sc1 lds
 s_waitcnt vmcnt(0)
 s_barrier
 ds_read_b128 v[52:55], v12 offset:0
 ds_read_b128 v[56:59], v12 offset:1024
 ds_read_b128 v[60:63], v12 offset:2048
 ds_read_b128 v[64:67], v12 offset:3072
 ds_read_b128 v[68:71], v12 offset:8192
 ds_read_b128 v[72:75], v12 offset:9216
 s_waitcnt lgkmcnt(4)
 v_mfma_f32_16x16x32_bf16 v[84:87], v[52:55], a[0:3], 0
 ds_read_b128 v[76:79], v12 offset:10240
 v_mfma_f32_16x16x32_bf16 v[88:91], v[52:55], a[8:11], 0
 v_mfma_f32_16x16x32_bf16 v[84:87], v[56:59], a[4:7], v[84:87]
 ds_read_b128 v[80:83], v12 offset:11264
 v_mfma_f32_16x16x32_bf16 v[88:91], v[56:59], a[12:15], v[88:91]
 s_waitcnt lgkmcnt(4)
 v_mfma_f32_16x16x32_bf16 v[84:87], v[60:63], a[16:19], v[84:87]
 ds_read_b128 v[52:55], v12 offset:16384
 v_mfma_f32_16x16x32_bf16 v[88:91], v[60:63], a[24:27], v[88:91]
 v_mfma_f32_16x16x32_bf16 v[84:87], v[64:67], a[20:23], v[84:87]
 ds_read_b128 v[56:59], v12 offset:17408
 v_mfma_f32_16x16x32_bf16 v[88:91], v[64:67], a[28:31], v[88:91]
 s_waitcnt lgkmcnt(4)
 v_mfma_f32_16x16x32_bf16 v[92:95], v[68:71], a[32:35], 0
 ds_read_b128 v[60:63], v12 offset:18432
 v_mfma_f32_16x16x32_bf16 v[96:99], v[68:71], a[40:43], 0
 v_mfma_f32_16x16x32_bf16 v[92:95], v[72:75], a[36:39], v[92:95]
 ds_read_b128 v[64:67], v12 offset:19456
 v_mfma_f32_16x16x32_bf16 v[96:99], v[72:75], a[44:47], v[96:99]
 s_waitcnt lgkmcnt(4)
 v_mfma_f32_16x16x32_bf16 v[92:95], v[76:79], a[48:51], v[92:95]
 ds_read_b128 v[68:71], v12 offset:24576
 v_mfma_f32_16x16x32_bf16 v[96:99], v[76:79], a[56:59], v[96:99]
 v_mfma_f32_16x16x32_bf16 v[92:95], v[80:83], a[52:55], v[92:95]
 ds_read_b128 v[72:75], v12 offset:25600
 v_mfma_f32_16x16x32_bf16 v[96:99], v[80:83], a[60:63], v[96:99]
 s_waitcnt lgkmcnt(4)
 v_mfma_f32_16x16x32_bf16 v[100:103], v[52:55], a[64:67], 0
 ds_read_b128 v[76:79], v12 offset:26624
 v_mfma_f32_16x16x32_bf16 v[104:107], v[52:55], a[72:75], 0
 v_cvt_pk_bf16_f32 v120, v84, v85
 v_mfma_f32_16x16x32_bf16 v[100:103], v[56:59], a[68:71], v[100:103]
 ds_read_b128 v[80:83], v12 offset:27648
 v_mfma_f32_16x16x32_bf16 v[104:107], v[56:59], a[76:79], v[104:107]
 v_cvt_pk_bf16_f32 v121, v86, v87
 s_waitcnt lgkmcnt(4)
 v_mfma_f32_16x16x32_bf16 v[100:103], v[60:63], a[80:83], v[100:103]
 ds_read_b128 v[52:55], v12 offset:4096
 v_mfma_f32_16x16x32_bf16 v[104:107], v[60:63], a[88:91], v[104:107]
 v_cvt_pk_bf16_f32 v136, v88, v89
 v_mfma_f32_16x16x32_bf16 v[100:103], v[64:67], a[84:87], v[100:103]
 ds_read_b128 v[56:59], v12 offset:5120
 v_mfma_f32_16x16x32_bf16 v[104:107], v[64:67], a[92:95], v[104:107]
 v_cvt_pk_bf16_f32 v137, v90, v91
 s_waitcnt lgkmcnt(4)
 v_mfma_f32_16x16x32_bf16 v[108:111], v[68:71], a[96:99], 0
 ds_read_b128 v[60:63], v12 offset:6144
 v_mfma_f32_16x16x32_bf16 v[112:115], v[68:71], a[104:107], 0
 v_cvt_pk_bf16_f32 v124, v92, v93
 v_mfma_f32_16x16x32_bf16 v[108:111], v[72:75], a[100:103], v[108:111]
 ds_read_b128 v[64:67], v12 offset:7168
 v_mfma_f32_16x16x32_bf16 v[112:115], v[72:75], a[108:111], v[112:115]
 v_cvt_pk_bf16_f32 v125, v94, v95
 s_waitcnt lgkmcnt(4)
 v_mfma_f32_16x16x32_bf16 v[108:111], v[76:79], a[112:115], v[108:111]
 ds_read_b128 v[68:71], v12 offset:12288
 v_mfma_f32_16x16x32_bf16 v[112:115], v[76:79], a[120:123], v[112:115]
 v_cvt_pk_bf16_f32 v140, v96, v97
 v_mfma_f32_16x16x32_bf16 v[108:111], v[80:83], a[116:119], v[108:111]
 ds_read_b128 v[72:75], v12 offset:13312
 v_mfma_f32_16x16x32_bf16 v[112:115], v[80:83], a[124:127], v[112:115]
 v_cvt_pk_bf16_f32 v141, v98, v99
 s_waitcnt lgkmcnt(4)
 v_mfma_f32_16x16x32_bf16 v[84:87], v[52:55], a[0:3], 0
 ds_read_b128 v[76:79], v12 offset:14336
 v_mfma_f32_16x16x32_bf16 v[88:91], v[52:55], a[8:11], 0
 v_cvt_pk_bf16_f32 v128, v100, v101
 v_mfma_f32_16x16x32_bf16 v[84:87], v[56:59], a[4:7], v[84:87]
 ds_read_b128 v[80:83], v12 offset:15360
 v_mfma_f32_16x16x32_bf16 v[88:91], v[56:59], a[12:15], v[88:91]
 v_cvt_pk_bf16_f32 v129, v102, v103
 s_waitcnt lgkmcnt(4)
 v_mfma_f32_16x16x32_bf16 v[84:87], v[60:63], a[16:19], v[84:87]
 ds_read_b128 v[52:55], v12 offset:20480
 v_mfma_f32_16x16x32_bf16 v[88:91], v[60:63], a[24:27], v[88:91]
 v_cvt_pk_bf16_f32 v144, v104, v105
 v_mfma_f32_16x16x32_bf16 v[84:87], v[64:67], a[20:23], v[84:87]
 ds_read_b128 v[56:59], v12 offset:21504
 v_mfma_f32_16x16x32_bf16 v[88:91], v[64:67], a[28:31], v[88:91]
 v_cvt_pk_bf16_f32 v145, v106, v107
 s_waitcnt lgkmcnt(4)
 v_mfma_f32_16x16x32_bf16 v[92:95], v[68:71], a[32:35], 0
 ds_read_b128 v[60:63], v12 offset:22528
 v_mfma_f32_16x16x32_bf16 v[96:99], v[68:71], a[40:43], 0
 v_cvt_pk_bf16_f32 v132, v108, v109
 v_mfma_f32_16x16x32_bf16 v[92:95], v[72:75], a[36:39], v[92:95]
 ds_read_b128 v[64:67], v12 offset:23552
 v_mfma_f32_16x16x32_bf16 v[96:99], v[72:75], a[44:47], v[96:99]
 v_cvt_pk_bf16_f32 v133, v110, v111
 s_waitcnt lgkmcnt(4)
 v_mfma_f32_16x16x32_bf16 v[92:95], v[76:79], a[48:51], v[92:95]
 ds_read_b128 v[68:71], v12 offset:28672
 v_mfma_f32_16x16x32_bf16 v[96:99], v[76:79], a[56:59], v[96:99]
 v_cvt_pk_bf16_f32 v148, v112, v113
 v_mfma_f32_16x16x32_bf16 v[92:95], v[80:83], a[52:55], v[92:95]
 ds_read_b128 v[72:75], v12 offset:29696
 v_mfma_f32_16x16x32_bf16 v[96:99], v[80:83], a[60:63], v[96:99]
 v_cvt_pk_bf16_f32 v149, v114, v115
 s_waitcnt lgkmcnt(4)
 v_mfma_f32_16x16x32_bf16 v[100:103], v[52:55], a[64:67], 0
 ds_read_b128 v[76:79], v12 offset:30720
 v_mfma_f32_16x16x32_bf16 v[104:107], v[52:55], a[72:75], 0
 v_cvt_pk_bf16_f32 v122, v84, v85
 v_mfma_f32_16x16x32_bf16 v[100:103], v[56:59], a[68:71], v[100:103]
 ds_read_b128 v[80:83], v12 offset:31744
 v_mfma_f32_16x16x32_bf16 v[104:107], v[56:59], a[76:79], v[104:107]
 v_cvt_pk_bf16_f32 v123, v86, v87
 s_waitcnt lgkmcnt(4)
 v_mfma_f32_16x16x32_bf16 v[100:103], v[60:63], a[80:83], v[100:103]
 v_mfma_f32_16x16x32_bf16 v[104:107], v[60:63], a[88:91], v[104:107]
 v_cvt_pk_bf16_f32 v138, v88, v89
 v_mfma_f32_16x16x32_bf16 v[100:103], v[64:67], a[84:87], v[100:103]
 v_mfma_f32_16x16x32_bf16 v[104:107], v[64:67], a[92:95], v[104:107]
 v_cvt_pk_bf16_f32 v139, v90, v91
 s_waitcnt lgkmcnt(2)
 v_mfma_f32_16x16x32_bf16 v[108:111], v[68:71], a[96:99], 0
 v_mfma_f32_16x16x32_bf16 v[112:115], v[68:71], a[104:107], 0
 buffer_load_dwordx4 v[216:219], v17, s[4:7], s71 offen sc1
 v_cvt_pk_bf16_f32 v126, v92, v93
 v_mfma_f32_16x16x32_bf16 v[108:111], v[72:75], a[100:103], v[108:111]
 v_mfma_f32_16x16x32_bf16 v[112:115], v[72:75], a[108:111], v[112:115]
 v_cvt_pk_bf16_f32 v127, v94, v95
 s_waitcnt lgkmcnt(0)
 v_mfma_f32_16x16x32_bf16 v[108:111], v[76:79], a[112:115], v[108:111]
 v_mfma_f32_16x16x32_bf16 v[112:115], v[76:79], a[120:123], v[112:115]
 v_cvt_pk_bf16_f32 v142, v96, v97
 v_mfma_f32_16x16x32_bf16 v[108:111], v[80:83], a[116:119], v[108:111]
 v_mfma_f32_16x16x32_bf16 v[112:115], v[80:83], a[124:127], v[112:115]
 v_cvt_pk_bf16_f32 v143, v98, v99
 s_nop 3
 v_cvt_pk_bf16_f32 v130, v100, v101
 v_cvt_pk_bf16_f32 v131, v102, v103
 v_cvt_pk_bf16_f32 v146, v104, v105
 v_cvt_pk_bf16_f32 v147, v106, v107
 v_cvt_pk_bf16_f32 v134, v108, v109
 v_cvt_pk_bf16_f32 v135, v110, v111
 v_cvt_pk_bf16_f32 v150, v112, v113
 v_cvt_pk_bf16_f32 v151, v114, v115
 v_mov_b64 v[208:209], 0
 v_mov_b64 v[210:211], 0
 v_mov_b64 v[212:213], 0
 v_mov_b64 v[214:215], 0
 s_barrier
 s_mov_b32 s64, 0
 s_add_u32 s65, s64, 1
 s_and_b32 s66, s65, 3
 s_lshl_b32 s66, s66, 13
 s_add_u32 s89, s66, s76
 s_add_u32 s90, s89, 4096
 s_branch L_or_xd1_251
L_or_xd_250:
 buffer_load_dwordx4 v[216:219], v17, s[4:7], s71 offen sc1
 s_sub_u32 s63, s63, 1
 s_cbranch_scc1 L_role_o_1_abort
L_or_xd1_251:
 s_waitcnt vmcnt(0)
 v_min3_u32 v11, v216, v217, v218
 v_min_u32 v11, v11, v219
 v_cmp_ge_u32 vcc, s65, v11
 s_cbranch_vccnz L_or_xd_250
 s_lshl_b32 m0, s62, 13
 s_add_u32 m0, m0, 0
 s_nop 0
 buffer_load_dwordx4 v12, s[4:7], s89 offen offset:0 sc1 lds
 v_mov_b64 v[224:225], 0
 v_mov_b64 v[226:227], 0
 v_mov_b64 v[228:229], 0
 v_mov_b64 v[230:231], 0
 v_mov_b64 v[84:85], 0
 v_mov_b64 v[86:87], 0
 buffer_load_dwordx4 v12, s[4:7], s89 offen offset:1024 sc1 lds
 v_mov_b64 v[88:89], 0
 v_mov_b64 v[90:91], 0
 v_mov_b64 v[92:93], 0
 v_mov_b64 v[94:95], 0
 v_mov_b64 v[96:97], 0
 v_mov_b64 v[98:99], 0
 buffer_load_dwordx4 v12, s[4:7], s89 offen offset:2048 sc1 lds
 v_mov_b64 v[100:101], 0
 v_mov_b64 v[102:103], 0
 v_mov_b64 v[104:105], 0
 v_mov_b64 v[106:107], 0
 v_mov_b64 v[108:109], 0
 v_mov_b64 v[110:111], 0
 buffer_load_dwordx4 v12, s[4:7], s89 offen offset:3072 sc1 lds
 v_mov_b64 v[112:113], 0
 v_mov_b64 v[114:115], 0
 s_max_i32 s84, s64, 1
 s_sub_u32 s84, s84, 1
 s_lshl_b32 s84, s84, 11
 s_add_u32 s84, s84, s82
 s_lshl_b32 m0, s62, 13
 s_add_u32 m0, m0, 4096
 s_nop 0
 buffer_load_dwordx4 v12, s[4:7], s90 offen offset:0 sc1 lds
 s_and_b32 s65, s64, 3
 s_lshl_b32 s65, s65, 11
 s_add_u32 s85, s65, s75
 s_and_b32 s65, s64, 3
 s_lshl_b32 s86, s65, 12
 s_add_u32 s86, s86, s77
 buffer_load_dwordx4 v12, s[4:7], s90 offen offset:1024 sc1 lds
 s_lshl_b32 s91, s65, 14
 s_add_u32 s91, s91, s78
 s_lshl_b32 s87, s65, 18
 s_xor_b32 s88, s87, 0x80000
 s_add_u32 s87, s87, s79
 s_add_u32 s88, s88, s79
 buffer_load_dwordx4 v12, s[4:7], s90 offen offset:2048 sc1 lds
 s_lshl_b32 s69, s65, 10
 s_xor_b32 s70, s69, 2048
 s_add_u32 s69, s69, s81
 s_add_u32 s70, s70, s81
 s_cmp_lt_u32 s64, 63
 s_cselect_b32 s83, 3, 0
 buffer_load_dwordx4 v12, s[4:7], s90 offen offset:3072 sc1 lds
L_or_loop_252:
 buffer_load_dwordx4 v[200:203], v12, s[4:7], s85 offen offset:0 sc1
 buffer_load_dwordx4 v[204:207], v12, s[4:7], s85 offen offset:1024 sc1
 s_nop 15
 s_nop 11
L_poll_253:
 buffer_load_dwordx4 v[200:203], v12, s[4:7], s85 offen offset:0 sc1
 buffer_load_dwordx4 v[204:207], v12, s[4:7], s85 offen offset:1024 sc1
 s_sub_u32 s63, s63, 1
 s_cbranch_scc1 L_role_o_1_abort
 s_waitcnt vmcnt(2)
 v_max3_u32 v11, v200, v202, v204
 v_max_u32 v11, v11, v206
 v_cmp_eq_u32 vcc, -1, v11
 s_cbranch_vccnz L_poll_253
 ds_write_b128 v15, v[200:203] offset:0
 ds_write_b128 v15, v[204:207] offset:1024
 s_waitcnt lgkmcnt(0)
 s_barrier
 ds_read_b128 v[36:39], v12 offset:49152
 ds_read_b128 v[40:43], v12 offset:50176
 ds_read_b128 v[44:47], v12 offset:51200
 ds_read_b128 v[48:51], v12 offset:52224
 ds_read_b128 v[52:55], v12 offset:53248
 ds_read_b128 v[56:59], v12 offset:54272
 ds_read_b128 v[60:63], v12 offset:55296
 ds_read_b128 v[64:67], v12 offset:56320
 s_waitcnt lgkmcnt(7)
 v_smfmac_f32_16x16x64_bf16 v[84:87], v[36:39], a[0:7], v33
 v_smfmac_f32_16x16x64_bf16 v[88:91], v[36:39], a[8:15], v33
 s_waitcnt lgkmcnt(6)
 v_smfmac_f32_16x16x64_bf16 v[84:87], v[40:43], a[16:23], v33
 v_smfmac_f32_16x16x64_bf16 v[88:91], v[40:43], a[24:31], v33
 s_waitcnt lgkmcnt(5)
 v_smfmac_f32_16x16x64_bf16 v[92:95], v[44:47], a[32:39], v33
 v_smfmac_f32_16x16x64_bf16 v[96:99], v[44:47], a[40:47], v33
 s_waitcnt lgkmcnt(4)
 v_smfmac_f32_16x16x64_bf16 v[92:95], v[48:51], a[48:55], v33
 v_smfmac_f32_16x16x64_bf16 v[96:99], v[48:51], a[56:63], v33
 s_nop 0
 s_waitcnt lgkmcnt(3)
 v_smfmac_f32_16x16x64_bf16 v[100:103], v[52:55], a[64:71], v33
 v_cvt_pk_bf16_f32 v152, v84, v85
 v_smfmac_f32_16x16x64_bf16 v[104:107], v[52:55], a[72:79], v33
 v_cvt_pk_bf16_f32 v153, v86, v87
 s_waitcnt lgkmcnt(2)
 v_smfmac_f32_16x16x64_bf16 v[100:103], v[56:59], a[80:87], v33
 v_cvt_pk_bf16_f32 v160, v88, v89
 v_smfmac_f32_16x16x64_bf16 v[104:107], v[56:59], a[88:95], v33
 v_cvt_pk_bf16_f32 v161, v90, v91
 s_waitcnt lgkmcnt(1)
 v_smfmac_f32_16x16x64_bf16 v[108:111], v[60:63], a[96:103], v33
 v_cvt_pk_bf16_f32 v154, v92, v93
 v_smfmac_f32_16x16x64_bf16 v[112:115], v[60:63], a[104:111], v33
 buffer_load_dwordx4 v[220:223], v12, s[4:7], s86 offen sc1
 v_cvt_pk_bf16_f32 v155, v94, v95
 s_waitcnt lgkmcnt(0)
 v_smfmac_f32_16x16x64_bf16 v[108:111], v[64:67], a[112:119], v33
 v_cvt_pk_bf16_f32 v162, v96, v97
 v_smfmac_f32_16x16x64_bf16 v[112:115], v[64:67], a[120:127], v33
 v_cvt_pk_bf16_f32 v163, v98, v99
 v_cvt_pk_bf16_f32 v156, v100, v101
 v_cvt_pk_bf16_f32 v157, v102, v103
 v_cvt_pk_bf16_f32 v164, v104, v105
 v_cvt_pk_bf16_f32 v165, v106, v107
 s_mul_i32 m0, s62, 3072
 s_add_u32 m0, m0, 32768
 s_nop 1
 v_cvt_pk_bf16_f32 v158, v108, v109
 v_cvt_pk_bf16_f32 v159, v110, v111
 v_cvt_pk_bf16_f32 v166, v112, v113
 v_cvt_pk_bf16_f32 v167, v114, v115
 s_cmp_lt_u32 s62, s83
 s_cbranch_scc1 L_or_pp_256
 s_waitcnt vmcnt(0)
 s_cmp_lt_u32 s64, 63
 s_cbranch_scc1 L_or_ppd_257
 s_branch L_pfirst_259
L_poll_258:
 s_sub_u32 s63, s63, 1
 s_cbranch_scc1 L_role_o_1_abort
L_pfirst_259:
 buffer_load_dwordx4 v[36:39], v12, s[4:7], s91 offen offset:0 sc1
 buffer_load_dwordx4 v[40:43], v12, s[4:7], s91 offen offset:1024 sc1
 buffer_load_dwordx4 v[44:47], v12, s[4:7], s91 offen offset:2048 sc1
 s_waitcnt vmcnt(0)
 v_max3_u32 v11, v36, v38, v40
 v_max3_u32 v11, v11, v42, v44
 v_max_u32 v11, v11, v46
 v_cmp_eq_u32 vcc, -1, v11
 s_cbranch_vccnz L_poll_258
 v_add_u32 v11, m0, v12
 ds_write_b128 v11, v[36:39] offset:0
 ds_write_b128 v11, v[40:43] offset:1024
 ds_write_b128 v11, v[44:47] offset:2048
 s_waitcnt lgkmcnt(0)
 s_branch L_or_pxwait_255
L_or_pp_256:
 buffer_load_dwordx4 v[220:223], v12, s[4:7], s86 offen sc1
 s_sub_u32 s63, s63, 1
 s_cbranch_scc1 L_role_o_1_abort
 s_waitcnt vmcnt(1)
 v_max3_u32 v11, v220, v221, v222
 v_max_u32 v11, v11, v223
 ds_write_b128 v14, v[220:223]
 v_cmp_eq_u32 vcc, -1, v11
 s_cbranch_vccnz L_or_pp_256
L_or_ppd_257:
 s_waitcnt lgkmcnt(0)
 s_barrier
 ds_read_b128 v[36:39], v12 offset:57344
 ds_read_b128 v[40:43], v12 offset:58368
 ds_read_b128 v[44:47], v12 offset:59392
 buffer_store_dword v17, v24, s[4:7], s69 offen sc1
 s_waitcnt lgkmcnt(2)
 v_smfmac_f32_16x16x64_bf16 v[224:227], v[36:39], v[120:127], v34
 v_smfmac_f32_16x16x64_bf16 v[228:231], v[36:39], v[136:143], v34
 s_waitcnt lgkmcnt(1)
 v_smfmac_f32_16x16x64_bf16 v[224:227], v[40:43], v[128:135], v34
 v_smfmac_f32_16x16x64_bf16 v[228:231], v[40:43], v[144:151], v34
 s_waitcnt lgkmcnt(0)
 v_smfmac_f32_16x16x64_bf16 v[224:227], v[44:47], v[152:159], v34
 v_smfmac_f32_16x16x64_bf16 v[228:231], v[44:47], v[160:167], v34
 s_nop 6
 v_pk_add_f32 v[224:225], v[224:225], v[226:227]
 v_pk_add_f32 v[228:229], v[228:229], v[230:231]
 v_cvt_pk_bf16_f32 v28, v224, v225
 v_cvt_pk_bf16_f32 v29, v228, v229
 v_cvt_pk_bf16_f32 v31, v228, v229
 v_min_u32 v30, -2, v28
 v_min_u32 v28, -2, v28
 v_permlane32_swap_b32 v29, v31
 s_nop 0
 v_permlane32_swap_b32 v28, v30
 buffer_store_dwordx4 v[28:31], v13, s[4:7], s87 offen sc1
 ds_read_b128 v[52:55], v12 offset:0
 ds_read_b128 v[56:59], v12 offset:1024
 ds_read_b128 v[60:63], v12 offset:2048
 ds_read_b128 v[64:67], v12 offset:3072
 ds_read_b128 v[68:71], v12 offset:8192
 ds_read_b128 v[72:75], v12 offset:9216
 s_waitcnt lgkmcnt(4)
 v_mfma_f32_16x16x32_bf16 v[84:87], v[52:55], a[0:3], 0
 ds_read_b128 v[76:79], v12 offset:10240
 v_mfma_f32_16x16x32_bf16 v[88:91], v[52:55], a[8:11], 0
 v_mfma_f32_16x16x32_bf16 v[84:87], v[56:59], a[4:7], v[84:87]
 ds_read_b128 v[80:83], v12 offset:11264
 v_mfma_f32_16x16x32_bf16 v[88:91], v[56:59], a[12:15], v[88:91]
 s_waitcnt lgkmcnt(4)
 v_mfma_f32_16x16x32_bf16 v[84:87], v[60:63], a[16:19], v[84:87]
 ds_read_b128 v[52:55], v12 offset:16384
 v_mfma_f32_16x16x32_bf16 v[88:91], v[60:63], a[24:27], v[88:91]
 v_mfma_f32_16x16x32_bf16 v[84:87], v[64:67], a[20:23], v[84:87]
 ds_read_b128 v[56:59], v12 offset:17408
 v_mfma_f32_16x16x32_bf16 v[88:91], v[64:67], a[28:31], v[88:91]
 s_waitcnt lgkmcnt(4)
 v_mfma_f32_16x16x32_bf16 v[92:95], v[68:71], a[32:35], 0
 ds_read_b128 v[60:63], v12 offset:18432
 v_mfma_f32_16x16x32_bf16 v[96:99], v[68:71], a[40:43], 0
 buffer_load_dwordx4 v12, s[4:7], s91 offen offset:0 sc1 lds
 v_mfma_f32_16x16x32_bf16 v[92:95], v[72:75], a[36:39], v[92:95]
 ds_read_b128 v[64:67], v12 offset:19456
 v_mfma_f32_16x16x32_bf16 v[96:99], v[72:75], a[44:47], v[96:99]
 s_waitcnt lgkmcnt(4)
 v_mfma_f32_16x16x32_bf16 v[92:95], v[76:79], a[48:51], v[92:95]
 ds_read_b128 v[68:71], v12 offset:24576
 v_mfma_f32_16x16x32_bf16 v[96:99], v[76:79], a[56:59], v[96:99]
 buffer_load_dwordx4 v12, s[4:7], s91 offen offset:1024 sc1 lds
 v_mfma_f32_16x16x32_bf16 v[92:95], v[80:83], a[52:55], v[92:95]
 ds_read_b128 v[72:75], v12 offset:25600
 v_mfma_f32_16x16x32_bf16 v[96:99], v[80:83], a[60:63], v[96:99]
 s_waitcnt lgkmcnt(4)
 v_mfma_f32_16x16x32_bf16 v[100:103], v[52:55], a[64:67], 0
 ds_read_b128 v[76:79], v12 offset:26624
 v_mfma_f32_16x16x32_bf16 v[104:107], v[52:55], a[72:75], 0
 buffer_load_dwordx4 v12, s[4:7], s91 offen offset:2048 sc1 lds
 v_cvt_pk_bf16_f32 v168, v84, v85
 v_mfma_f32_16x16x32_bf16 v[100:103], v[56:59], a[68:71], v[100:103]
 ds_read_b128 v[80:83], v12 offset:27648
 v_mfma_f32_16x16x32_bf16 v[104:107], v[56:59], a[76:79], v[104:107]
 v_cvt_pk_bf16_f32 v169, v86, v87
 s_waitcnt lgkmcnt(4)
 v_mfma_f32_16x16x32_bf16 v[100:103], v[60:63], a[80:83], v[100:103]
 ds_read_b128 v[52:55], v12 offset:4096
 v_mfma_f32_16x16x32_bf16 v[104:107], v[60:63], a[88:91], v[104:107]
 v_cvt_pk_bf16_f32 v184, v88, v89
 v_mfma_f32_16x16x32_bf16 v[100:103], v[64:67], a[84:87], v[100:103]
 ds_read_b128 v[56:59], v12 offset:5120
 v_mfma_f32_16x16x32_bf16 v[104:107], v[64:67], a[92:95], v[104:107]
 v_cvt_pk_bf16_f32 v185, v90, v91
 s_waitcnt lgkmcnt(4)
 v_mfma_f32_16x16x32_bf16 v[108:111], v[68:71], a[96:99], 0
 ds_read_b128 v[60:63], v12 offset:6144
 v_mfma_f32_16x16x32_bf16 v[112:115], v[68:71], a[104:107], 0
 v_cvt_pk_bf16_f32 v172, v92, v93
 v_mfma_f32_16x16x32_bf16 v[108:111], v[72:75], a[100:103], v[108:111]
 ds_read_b128 v[64:67], v12 offset:7168
 v_mfma_f32_16x16x32_bf16 v[112:115], v[72:75], a[108:111], v[112:115]
 v_cvt_pk_bf16_f32 v173, v94, v95
 s_waitcnt lgkmcnt(4)
 v_mfma_f32_16x16x32_bf16 v[108:111], v[76:79], a[112:115], v[108:111]
 ds_read_b128 v[68:71], v12 offset:12288
 v_mfma_f32_16x16x32_bf16 v[112:115], v[76:79], a[120:123], v[112:115]
 v_cvt_pk_bf16_f32 v188, v96, v97
 v_mfma_f32_16x16x32_bf16 v[108:111], v[80:83], a[116:119], v[108:111]
 ds_read_b128 v[72:75], v12 offset:13312
 v_mfma_f32_16x16x32_bf16 v[112:115], v[80:83], a[124:127], v[112:115]
 v_cvt_pk_bf16_f32 v189, v98, v99
 s_waitcnt lgkmcnt(4)
 v_mfma_f32_16x16x32_bf16 v[84:87], v[52:55], a[0:3], 0
 ds_read_b128 v[76:79], v12 offset:14336
 v_mfma_f32_16x16x32_bf16 v[88:91], v[52:55], a[8:11], 0
 v_cvt_pk_bf16_f32 v176, v100, v101
 v_mfma_f32_16x16x32_bf16 v[84:87], v[56:59], a[4:7], v[84:87]
 ds_read_b128 v[80:83], v12 offset:15360
 v_mfma_f32_16x16x32_bf16 v[88:91], v[56:59], a[12:15], v[88:91]
 v_cvt_pk_bf16_f32 v177, v102, v103
 s_waitcnt lgkmcnt(4)
 v_mfma_f32_16x16x32_bf16 v[84:87], v[60:63], a[16:19], v[84:87]
 ds_read_b128 v[52:55], v12 offset:20480
 v_mfma_f32_16x16x32_bf16 v[88:91], v[60:63], a[24:27], v[88:91]
 v_cvt_pk_bf16_f32 v192, v104, v105
 v_mfma_f32_16x16x32_bf16 v[84:87], v[64:67], a[20:23], v[84:87]
 ds_read_b128 v[56:59], v12 offset:21504
 v_mfma_f32_16x16x32_bf16 v[88:91], v[64:67], a[28:31], v[88:91]
 v_cvt_pk_bf16_f32 v193, v106, v107
 s_waitcnt lgkmcnt(4)
 v_mfma_f32_16x16x32_bf16 v[92:95], v[68:71], a[32:35], 0
 ds_read_b128 v[60:63], v12 offset:22528
 v_mfma_f32_16x16x32_bf16 v[96:99], v[68:71], a[40:43], 0
 v_cvt_pk_bf16_f32 v180, v108, v109
 v_mfma_f32_16x16x32_bf16 v[92:95], v[72:75], a[36:39], v[92:95]
 ds_read_b128 v[64:67], v12 offset:23552
 v_mfma_f32_16x16x32_bf16 v[96:99], v[72:75], a[44:47], v[96:99]
 buffer_store_dwordx4 v[20:23], v13, s[4:7], s88 offen sc1
 v_cvt_pk_bf16_f32 v181, v110, v111
 s_waitcnt lgkmcnt(4)
 v_mfma_f32_16x16x32_bf16 v[92:95], v[76:79], a[48:51], v[92:95]
 ds_read_b128 v[68:71], v12 offset:28672
 v_mfma_f32_16x16x32_bf16 v[96:99], v[76:79], a[56:59], v[96:99]
 v_cvt_pk_bf16_f32 v196, v112, v113
 v_mfma_f32_16x16x32_bf16 v[92:95], v[80:83], a[52:55], v[92:95]
 ds_read_b128 v[72:75], v12 offset:29696
 v_mfma_f32_16x16x32_bf16 v[96:99], v[80:83], a[60:63], v[96:99]
 buffer_store_dword v20, v24, s[4:7], s70 offen sc1
 v_cvt_pk_bf16_f32 v197, v114, v115
 s_waitcnt lgkmcnt(4)
 v_mfma_f32_16x16x32_bf16 v[100:103], v[52:55], a[64:67], 0
 ds_read_b128 v[76:79], v12 offset:30720
 v_mfma_f32_16x16x32_bf16 v[104:107], v[52:55], a[72:75], 0
 v_cvt_pk_bf16_f32 v170, v84, v85
 v_mfma_f32_16x16x32_bf16 v[100:103], v[56:59], a[68:71], v[100:103]
 ds_read_b128 v[80:83], v12 offset:31744
 v_mfma_f32_16x16x32_bf16 v[104:107], v[56:59], a[76:79], v[104:107]
 buffer_store_dwordx4 v[208:211], v32, s[4:7], s84 offen offset:0 sc1
 v_cvt_pk_bf16_f32 v171, v86, v87
 s_waitcnt lgkmcnt(4)
 v_mfma_f32_16x16x32_bf16 v[100:103], v[60:63], a[80:83], v[100:103]
 v_mfma_f32_16x16x32_bf16 v[104:107], v[60:63], a[88:91], v[104:107]
 v_cvt_pk_bf16_f32 v186, v88, v89
 v_mfma_f32_16x16x32_bf16 v[100:103], v[64:67], a[84:87], v[100:103]
 v_mfma_f32_16x16x32_bf16 v[104:107], v[64:67], a[92:95], v[104:107]
 buffer_store_dwordx4 v[212:215], v32, s[4:7], s84 offen offset:1024 sc1
 v_cvt_pk_bf16_f32 v187, v90, v91
 s_waitcnt lgkmcnt(2)
 v_mfma_f32_16x16x32_bf16 v[108:111], v[68:71], a[96:99], 0
 v_mfma_f32_16x16x32_bf16 v[112:115], v[68:71], a[104:107], 0
 v_cvt_pk_bf16_f32 v174, v92, v93
 v_mfma_f32_16x16x32_bf16 v[108:111], v[72:75], a[100:103], v[108:111]
 v_mfma_f32_16x16x32_bf16 v[112:115], v[72:75], a[108:111], v[112:115]
 s_sub_u32 s67, s64, 8
 s_cmp_lt_u32 s67, 8
 s_cbranch_scc0 L_or_clr_260
 s_lshl_b32 s67, s67, 10
 s_add_u32 s67, s67, s82
 s_add_u32 s67, s67, 122880
 s_waitcnt vmcnt(4)
 buffer_store_dwordx4 v[20:23], v12, s[4:7], s67 offen sc1
 s_branch L_or_clr_260x
 L_or_clr_260:
 s_waitcnt vmcnt(4)
 L_or_clr_260x:
 v_cvt_pk_bf16_f32 v175, v94, v95
 s_waitcnt lgkmcnt(0)
 v_mfma_f32_16x16x32_bf16 v[108:111], v[76:79], a[112:115], v[108:111]
 v_mfma_f32_16x16x32_bf16 v[112:115], v[76:79], a[120:123], v[112:115]
 v_cvt_pk_bf16_f32 v190, v96, v97
 v_mfma_f32_16x16x32_bf16 v[108:111], v[80:83], a[116:119], v[108:111]
 v_mfma_f32_16x16x32_bf16 v[112:115], v[80:83], a[124:127], v[112:115]
 v_cvt_pk_bf16_f32 v191, v98, v99
 v_cvt_pk_bf16_f32 v178, v100, v101
 v_cvt_pk_bf16_f32 v179, v102, v103
 v_cvt_pk_bf16_f32 v194, v104, v105
 v_cvt_pk_bf16_f32 v195, v106, v107
 s_nop 3
 v_cvt_pk_bf16_f32 v182, v108, v109
 v_cvt_pk_bf16_f32 v183, v110, v111
 v_cvt_pk_bf16_f32 v198, v112, v113
 v_cvt_pk_bf16_f32 v199, v114, v115
L_or_pxwait_255:
L_or_pxagain_262:
 s_barrier
 ds_read_b128 v[36:39], v12 offset:32768
 ds_read_b128 v[60:63], v12 offset:38912
 ds_read_b128 v[40:43], v12 offset:33792
 ds_read_b128 v[64:67], v12 offset:39936
 ds_read_b128 v[44:47], v12 offset:34816
 ds_read_b128 v[68:71], v12 offset:40960
 ds_read_b128 v[48:51], v12 offset:35840
 ds_read_b128 v[72:75], v12 offset:41984
 ds_read_b128 v[52:55], v12 offset:36864
 ds_read_b128 v[76:79], v12 offset:43008
 ds_read_b128 v[56:59], v12 offset:37888
 ds_read_b128 v[80:83], v12 offset:44032
 s_waitcnt lgkmcnt(11)
 v_mfma_f32_16x16x32_bf16 v[84:87], v[120:123], v[36:39], 0
 v_max_u32 v11, v36, v38
 v_mfma_f32_16x16x32_bf16 v[88:91], v[136:139], v[36:39], 0
 s_waitcnt lgkmcnt(10)
 v_mfma_f32_16x16x32_bf16 v[92:95], v[120:123], v[60:63], 0
 v_max3_u32 v11, v11, v60, v62
 v_mfma_f32_16x16x32_bf16 v[96:99], v[136:139], v[60:63], 0
 s_waitcnt lgkmcnt(9)
 v_mfma_f32_16x16x32_bf16 v[84:87], v[124:127], v[40:43], v[84:87]
 v_max3_u32 v11, v11, v40, v42
 v_mfma_f32_16x16x32_bf16 v[88:91], v[140:143], v[40:43], v[88:91]
 s_waitcnt lgkmcnt(8)
 v_mfma_f32_16x16x32_bf16 v[92:95], v[124:127], v[64:67], v[92:95]
 v_max3_u32 v11, v11, v64, v66
 v_mfma_f32_16x16x32_bf16 v[96:99], v[140:143], v[64:67], v[96:99]
 s_waitcnt lgkmcnt(7)
 v_mfma_f32_16x16x32_bf16 v[84:87], v[128:131], v[44:47], v[84:87]
 v_max3_u32 v11, v11, v44, v46
 v_mfma_f32_16x16x32_bf16 v[88:91], v[144:147], v[44:47], v[88:91]
 s_waitcnt lgkmcnt(6)
 v_mfma_f32_16x16x32_bf16 v[92:95], v[128:131], v[68:71], v[92:95]
 v_max3_u32 v11, v11, v68, v70
 v_mfma_f32_16x16x32_bf16 v[96:99], v[144:147], v[68:71], v[96:99]
 s_waitcnt lgkmcnt(5)
 v_mfma_f32_16x16x32_bf16 v[84:87], v[132:135], v[48:51], v[84:87]
 v_max3_u32 v11, v11, v48, v50
 v_mfma_f32_16x16x32_bf16 v[88:91], v[148:151], v[48:51], v[88:91]
 buffer_load_dwordx4 v[216:219], v17, s[4:7], s71 offen sc1
 s_waitcnt lgkmcnt(4)
 v_mfma_f32_16x16x32_bf16 v[92:95], v[132:135], v[72:75], v[92:95]
 v_max3_u32 v11, v11, v72, v74
 v_mfma_f32_16x16x32_bf16 v[96:99], v[148:151], v[72:75], v[96:99]
 s_waitcnt lgkmcnt(3)
 v_mfma_f32_16x16x32_bf16 v[84:87], v[152:155], v[52:55], v[84:87]
 v_max3_u32 v11, v11, v52, v54
 v_mfma_f32_16x16x32_bf16 v[88:91], v[160:163], v[52:55], v[88:91]
 s_waitcnt lgkmcnt(2)
 v_mfma_f32_16x16x32_bf16 v[92:95], v[152:155], v[76:79], v[92:95]
 v_max3_u32 v11, v11, v76, v78
 v_mfma_f32_16x16x32_bf16 v[96:99], v[160:163], v[76:79], v[96:99]
 s_waitcnt lgkmcnt(1)
 v_mfma_f32_16x16x32_bf16 v[84:87], v[156:159], v[56:59], v[84:87]
 v_max3_u32 v11, v11, v56, v58
 v_mfma_f32_16x16x32_bf16 v[88:91], v[164:167], v[56:59], v[88:91]
 s_waitcnt lgkmcnt(0)
 v_mfma_f32_16x16x32_bf16 v[92:95], v[156:159], v[80:83], v[92:95]
 v_max3_u32 v11, v11, v80, v82
 v_cmp_eq_u32 vcc, -1, v11
 v_mfma_f32_16x16x32_bf16 v[96:99], v[164:167], v[80:83], v[96:99]
 s_cbranch_vccnz L_or_pxretry_261
 s_cmp_eq_u32 s64, 63
 s_cbranch_scc1 L_or_tail_263
 s_add_u32 s64, s64, 1
 s_cmp_eq_u32 s64, 63
 s_cbranch_scc1 L_or_nf_264
 s_add_u32 s65, s64, 1
 s_and_b32 s66, s65, 3
 s_lshl_b32 s66, s66, 13
 s_add_u32 s89, s66, s76
 s_add_u32 s90, s89, 4096
 s_branch L_or_xd1_266
L_or_xd_265:
 buffer_load_dwordx4 v[216:219], v17, s[4:7], s71 offen sc1
 s_sub_u32 s63, s63, 1
 s_cbranch_scc1 L_role_o_1_abort
L_or_xd1_266:
 s_waitcnt vmcnt(0)
 v_min3_u32 v11, v216, v217, v218
 v_min_u32 v11, v11, v219
 v_cmp_ge_u32 vcc, s65, v11
 s_cbranch_vccnz L_or_xd_265
 s_lshl_b32 m0, s62, 13
 s_add_u32 m0, m0, 0
 s_nop 0
 buffer_load_dwordx4 v12, s[4:7], s89 offen offset:0 sc1 lds
 v_mov_b64 v[120:121], v[168:169]
 v_mov_b64 v[122:123], v[170:171]
 v_mov_b64 v[124:125], v[172:173]
 v_mov_b64 v[126:127], v[174:175]
 v_mov_b64 v[128:129], v[176:177]
 v_mov_b64 v[130:131], v[178:179]
 v_mov_b64 v[132:133], v[180:181]
 v_mov_b64 v[134:135], v[182:183]
 v_mov_b64 v[136:137], v[184:185]
 buffer_load_dwordx4 v12, s[4:7], s89 offen offset:1024 sc1 lds
 v_mov_b64 v[138:139], v[186:187]
 v_mov_b64 v[140:141], v[188:189]
 v_mov_b64 v[142:143], v[190:191]
 v_mov_b64 v[144:145], v[192:193]
 v_mov_b64 v[146:147], v[194:195]
 v_mov_b64 v[148:149], v[196:197]
 v_mov_b64 v[150:151], v[198:199]
 v_cvt_pk_bf16_f32 v208, v84, v85
 v_cvt_pk_bf16_f32 v210, v86, v87
 buffer_load_dwordx4 v12, s[4:7], s89 offen offset:2048 sc1 lds
 v_cvt_pk_bf16_f32 v209, v88, v89
 v_cvt_pk_bf16_f32 v211, v90, v91
 v_cvt_pk_bf16_f32 v212, v92, v93
 v_cvt_pk_bf16_f32 v214, v94, v95
 v_cvt_pk_bf16_f32 v213, v96, v97
 v_cvt_pk_bf16_f32 v215, v98, v99
 v_min_u32 v208, -2, v208
 v_min_u32 v210, -2, v210
 v_min_u32 v212, -2, v212
 buffer_load_dwordx4 v12, s[4:7], s89 offen offset:3072 sc1 lds
 v_min_u32 v214, -2, v214
 v_mov_b64 v[224:225], 0
 v_mov_b64 v[226:227], 0
 v_mov_b64 v[228:229], 0
 v_mov_b64 v[230:231], 0
 v_mov_b64 v[84:85], 0
 v_mov_b64 v[86:87], 0
 v_mov_b64 v[88:89], 0
 v_mov_b64 v[90:91], 0
 s_lshl_b32 m0, s62, 13
 s_add_u32 m0, m0, 4096
 s_nop 0
 buffer_load_dwordx4 v12, s[4:7], s90 offen offset:0 sc1 lds
 v_mov_b64 v[92:93], 0
 v_mov_b64 v[94:95], 0
 v_mov_b64 v[96:97], 0
 v_mov_b64 v[98:99], 0
 v_mov_b64 v[100:101], 0
 v_mov_b64 v[102:103], 0
 v_mov_b64 v[104:105], 0
 v_mov_b64 v[106:107], 0
 v_mov_b64 v[108:109], 0
 buffer_load_dwordx4 v12, s[4:7], s90 offen offset:1024 sc1 lds
 v_mov_b64 v[110:111], 0
 v_mov_b64 v[112:113], 0
 v_mov_b64 v[114:115], 0
 s_max_i32 s84, s64, 1
 s_sub_u32 s84, s84, 1
 s_lshl_b32 s84, s84, 11
 s_add_u32 s84, s84, s82
 s_and_b32 s65, s64, 3
 s_lshl_b32 s65, s65, 11
 buffer_load_dwordx4 v12, s[4:7], s90 offen offset:2048 sc1 lds
 s_add_u32 s85, s65, s75
 s_and_b32 s65, s64, 3
 s_lshl_b32 s86, s65, 12
 s_add_u32 s86, s86, s77
 s_lshl_b32 s91, s65, 14
 s_add_u32 s91, s91, s78
 s_lshl_b32 s87, s65, 18
 s_xor_b32 s88, s87, 0x80000
 s_add_u32 s87, s87, s79
 buffer_load_dwordx4 v12, s[4:7], s90 offen offset:3072 sc1 lds
 s_add_u32 s88, s88, s79
 s_lshl_b32 s69, s65, 10
 s_xor_b32 s70, s69, 2048
 s_add_u32 s69, s69, s81
 s_add_u32 s70, s70, s81
 s_cmp_lt_u32 s64, 63
 s_cselect_b32 s83, 3, 0
 s_branch L_or_loop_252
L_or_nf_264:
 v_mov_b64 v[120:121], v[168:169]
 v_mov_b64 v[122:123], v[170:171]
 v_mov_b64 v[124:125], v[172:173]
 v_mov_b64 v[126:127], v[174:175]
 v_mov_b64 v[128:129], v[176:177]
 v_mov_b64 v[130:131], v[178:179]
 v_mov_b64 v[132:133], v[180:181]
 v_mov_b64 v[134:135], v[182:183]
 v_mov_b64 v[136:137], v[184:185]
 v_mov_b64 v[138:139], v[186:187]
 v_mov_b64 v[140:141], v[188:189]
 v_mov_b64 v[142:143], v[190:191]
 v_mov_b64 v[144:145], v[192:193]
 v_mov_b64 v[146:147], v[194:195]
 v_mov_b64 v[148:149], v[196:197]
 v_mov_b64 v[150:151], v[198:199]
 v_cvt_pk_bf16_f32 v208, v84, v85
 v_cvt_pk_bf16_f32 v210, v86, v87
 v_cvt_pk_bf16_f32 v209, v88, v89
 v_cvt_pk_bf16_f32 v211, v90, v91
 v_cvt_pk_bf16_f32 v212, v92, v93
 v_cvt_pk_bf16_f32 v214, v94, v95
 v_cvt_pk_bf16_f32 v213, v96, v97
 v_cvt_pk_bf16_f32 v215, v98, v99
 v_min_u32 v208, -2, v208
 v_min_u32 v210, -2, v210
 v_min_u32 v212, -2, v212
 v_min_u32 v214, -2, v214
 v_mov_b64 v[224:225], 0
 v_mov_b64 v[226:227], 0
 v_mov_b64 v[228:229], 0
 v_mov_b64 v[230:231], 0
 v_mov_b64 v[84:85], 0
 v_mov_b64 v[86:87], 0
 v_mov_b64 v[88:89], 0
 v_mov_b64 v[90:91], 0
 v_mov_b64 v[92:93], 0
 v_mov_b64 v[94:95], 0
 v_mov_b64 v[96:97], 0
 v_mov_b64 v[98:99], 0
 v_mov_b64 v[100:101], 0
 v_mov_b64 v[102:103], 0
 v_mov_b64 v[104:105], 0
 v_mov_b64 v[106:107], 0
 v_mov_b64 v[108:109], 0
 v_mov_b64 v[110:111], 0
 v_mov_b64 v[112:113], 0
 v_mov_b64 v[114:115], 0
 s_max_i32 s84, s64, 1
 s_sub_u32 s84, s84, 1
 s_lshl_b32 s84, s84, 11
 s_add_u32 s84, s84, s82
 s_and_b32 s65, s64, 3
 s_lshl_b32 s65, s65, 11
 s_add_u32 s85, s65, s75
 s_and_b32 s65, s64, 3
 s_lshl_b32 s86, s65, 12
 s_add_u32 s86, s86, s77
 s_lshl_b32 s91, s65, 14
 s_add_u32 s91, s91, s78
 s_lshl_b32 s87, s65, 18
 s_xor_b32 s88, s87, 0x80000
 s_add_u32 s87, s87, s79
 s_add_u32 s88, s88, s79
 s_lshl_b32 s69, s65, 10
 s_xor_b32 s70, s69, 2048
 s_add_u32 s69, s69, s81
 s_add_u32 s70, s70, s81
 s_cmp_lt_u32 s64, 63
 s_cselect_b32 s83, 3, 0
 buffer_store_dwordx4 v[208:211], v32, s[4:7], s84 offen offset:0 sc1
 buffer_store_dwordx4 v[212:215], v32, s[4:7], s84 offen offset:1024 sc1
 s_branch L_or_loop_252
L_or_pxretry_261:
 s_barrier
 s_mul_i32 m0, s62, 3072
 s_add_u32 m0, m0, 32768
 s_nop 0
 buffer_load_dwordx4 v12, s[4:7], s91 offen offset:0 sc1 lds
 buffer_load_dwordx4 v12, s[4:7], s91 offen offset:1024 sc1 lds
 buffer_load_dwordx4 v12, s[4:7], s91 offen offset:2048 sc1 lds
 s_waitcnt vmcnt(0)
 s_sub_u32 s63, s63, 1
 s_cbranch_scc0 L_or_pxagain_262
 s_endpgm
L_or_tail_263:
 buffer_store_dword v17, v24, s[4:7], s69 offen sc1
 s_add_u32 s84, s84, 2048
 s_nop 2
 v_cvt_pk_bf16_f32 v208, v84, v85
 v_cvt_pk_bf16_f32 v210, v86, v87
 v_cvt_pk_bf16_f32 v209, v88, v89
 v_cvt_pk_bf16_f32 v211, v90, v91
 v_cvt_pk_bf16_f32 v212, v92, v93
 v_cvt_pk_bf16_f32 v214, v94, v95
 v_cvt_pk_bf16_f32 v213, v96, v97
 v_cvt_pk_bf16_f32 v215, v98, v99
 v_min_u32 v208, -2, v208
 v_min_u32 v210, -2, v210
 v_min_u32 v212, -2, v212
 v_min_u32 v214, -2, v214
 buffer_store_dwordx4 v[208:211], v32, s[4:7], s84 offen offset:0 sc1
 buffer_store_dwordx4 v[212:215], v32, s[4:7], s84 offen offset:1024 sc1
 s_endpgm
.section .rodata,"a"
.p2align 6
.amdhsa_kernel gated_mix__memory_aug_recurrent_mem_tr__spectral_gfnet__prompt_kernel
  .amdhsa_next_free_vgpr 512
  .amdhsa_next_free_sgpr 102
  .amdhsa_accum_offset 256
  .amdhsa_group_segment_fixed_size 0
  .amdhsa_kernarg_size 112
  .amdhsa_user_sgpr_count 2
  .amdhsa_user_sgpr_kernarg_segment_ptr 1
  .amdhsa_system_sgpr_workgroup_id_x 1
  .amdhsa_float_denorm_mode_32 3
.end_amdhsa_kernel
```
